```python
import torch

def _softmax(x, axis=-1):
    return torch.softmax(x, dim=axis)
def _gelu(x):
    return torch.nn.functional.gelu(x, approximate="tanh")
def _silu(x):
    return torch.nn.functional.silu(x)
def _sigmoid(x):
    return torch.sigmoid(x)
def _layernorm(x, axis=-1, eps=1e-5):
    m = x.mean(dim=axis, keepdim=True)
    v = x.var(dim=axis, keepdim=True, unbiased=False)
    return (x - m) / torch.sqrt(v + eps)
def _scatter_add(tgt, idx, src, axis=0):
    return tgt.clone().index_add_(axis, idx, src)
def _segment_sum(src, seg, n):
    out = torch.zeros((n,) + src.shape[1:], dtype=src.dtype)
    return out.index_add_(0, seg, src)
def _pad(x, pw):
    flat = tuple(v for pair in reversed(pw) for v in pair)
    return torch.nn.functional.pad(x, flat)

kernel_name = 'concat_heads__linear_attn_block__ssm_conv_h3__prompt'

def setup_inputs():

    _w = (lambda a: (lambda t: t.to(torch.bfloat16) if t.is_floating_point() else t)(torch.as_tensor(a)))
    def _A_setup():
        B, S, D = 1, 2048, 1024
        return {
            "x": _w((lambda *s: torch.randn(*s, dtype=torch.bfloat16) * 0.05)(B, S, D)),
            "wqkv": _w((lambda *s: torch.randn(*s, dtype=torch.bfloat16) * 1.6)(D, 3 * D)),
            "wo": _w((lambda *s: torch.randn(*s, dtype=torch.bfloat16) * 0.1)(D, D)),
        }
    _A_in = _A_setup()

    def _B_setup():
        B, S, D = 1, 2048, 1024
        ks = 4
        return {
            "q": _w((lambda *s: torch.randn(*s, dtype=torch.bfloat16) * 0.05)(B, S, D)),
            "k": _w((lambda *s: torch.randn(*s, dtype=torch.bfloat16) * 0.8)(B, S, D)),
            "v": _w((lambda *s: torch.randn(*s, dtype=torch.bfloat16) * 0.4)(B, S, D)),
            "shift_k": _w((lambda *s: torch.randn(*s, dtype=torch.bfloat16) * 0.8)(D, ks) * 0.5),
            "ssm_k": _w((lambda *s: torch.randn(*s, dtype=torch.bfloat16) * 3.2)(D, S) * (1.0 / S ** 0.5)),
            "ssm_D": _w((lambda *s: torch.randn(*s, dtype=torch.bfloat16) * 0.8)(D)),
        }
    _B_in = _B_setup()

    return {
        "A_x": _A_in["x"],
        "A_wqkv": _A_in["wqkv"],
        "A_wo": _A_in["wo"],
        "B_q": _B_in["q"],
        "B_k": _B_in["k"],
        "B_v": _B_in["v"],
        "B_shift_k": _B_in["shift_k"],
        "B_ssm_k": _B_in["ssm_k"],
        "B_ssm_D": _B_in["ssm_D"],
    }

def reference(A_x, A_wqkv, A_wo, B_q, B_k, B_v, B_shift_k, B_ssm_k, B_ssm_D):
    def _A_ref(x, wqkv, wo):
        B, S, D = x.shape
        H = 32; Dh = D // H
        qkv = (lambda x, *d: x.permute(*d))((x @ wqkv).reshape(B, S, 3, H, Dh), 2, 0, 3, 1, 4)
        q, k, v = qkv[0], qkv[1], qkv[2]
        phi = lambda t: torch.where(t > 0, t + 1, torch.exp(t)) + 1e-6
        pq, pk = phi(q), phi(k)
        kv = torch.einsum("bhsd,bhse->bhde", pk, v)
        z = torch.einsum("bhsd->bhd", pk)
        num = torch.einsum("bhqd,bhde->bhqe", pq, kv)
        den = torch.einsum("bhqd,bhd->bhq", pq, z)[..., None] + 1e-6
        o = num / den
        return (lambda x, *d: x.permute(*d))(o, 0, 2, 1, 3).reshape(B, S, D) @ wo

    def _B_ref(q, k, v, shift_k, ssm_k, ssm_D):
        B, S, D = q.shape
        ks = shift_k.shape[-1]
        k_pad = _pad(k, ((0, 0), (ks - 1, 0), (0, 0)))
        k_shift = torch.zeros_like(k)
        for t in range(ks):
            k_shift = k_shift + k_pad[:, t:t + S, :] * shift_k[:, ks - 1 - t][None, None, :]
        kv = k_shift * v
        L = 2 * S
        kv_pad = _pad(kv, ((0, 0), (0, S), (0, 0)))
        kf_pad = _pad(ssm_k, ((0, 0), (0, S)))
        kv_f = (lambda x, axes=(-2,-1): torch.fft.rfft2(x.float(), dim=axes))(kv_pad[:, None, :, :], axes=(1, 2))
        kf_f = (lambda x, axes=(-2,-1): torch.fft.rfft2(x.float(), dim=axes))(kf_pad[:, None, :], axes=(1, 2))
        kf_f = (lambda x, *d: x.permute(*d))(kf_f, 1, 2, 0)
        y_f = kv_f * kf_f[None, :, :, :]
        y = (lambda x, s, axes=(-2,-1): torch.fft.irfft2(x, s=s, dim=axes).to(torch.bfloat16))(y_f, (1, L), axes=(1, 2))[:, 0, :S, :]
        y = y + kv * ssm_D[None, None, :]
        return q * y

    a = _A_ref(A_x, A_wqkv, A_wo)
    b = _B_ref(B_q, B_k, B_v, B_shift_k, B_ssm_k, B_ssm_D)
    return torch.concatenate([a, b], axis=-1)
```

```asm
; @launch grid=(256,1,1) block=(512,1,1) lds=163840
.amdgcn_target "amdgcn-amd-amdhsa--gfx950"
.text
.globl concat_heads__linear_attn_block__ssm_conv_h3__prompt_kernel
.type concat_heads__linear_attn_block__ssm_conv_h3__prompt_kernel,@function
.p2align 8
concat_heads__linear_attn_block__ssm_conv_h3__prompt_kernel:
    s_cmp_ge_u32 s2, 256
    s_cbranch_scc1 L_exit
    s_load_dwordx16 s[4:19], s[0:1], 0
    s_load_dwordx8 s[20:27], s[0:1], 64
    s_getpc_b64 s[48:49]
L_pc:
    s_and_b32 s45, s2, 24
    s_lshl_b32 s45, s45, 4
    v_lshl_add_u32 v2, v0, 9, s45
    v_cmp_gt_u32 vcc, L_code_end-L_pc-4, v2
    s_and_saveexec_b64 s[50:51], vcc
    s_cbranch_execz L_pf
    global_load_dword v252, v2, s[48:49]
L_pf:
    s_mov_b64 exec, s[50:51]
    v_lshrrev_b32 v1, 6, v0
    v_and_b32 v4, 63, v0
    v_readfirstlane_b32 s3, v1
    v_lshlrev_b32 v5, 4, v4
    s_and_b32 s28, s2, 7
    s_lshr_b32 s29, s2, 3
    s_and_b32 s30, s28, 1
    s_lshl_b32 s30, s30, 3
    s_and_b32 s40, s29, 7
    s_add_u32 s30, s30, s40
    s_lshr_b32 s40, s28, 1
    s_lshl_b32 s41, s40, 2
    s_lshr_b32 s42, s29, 3
    s_add_u32 s31, s41, s42
    s_add_u32 s42, s42, 1
    s_and_b32 s42, s42, 3
    s_add_u32 s32, s41, s42
    s_and_b32 s41, s30, 1
    s_lshl_b32 s33, s41, 1
    s_and_b32 s41, s30, 2
    s_lshl_b32 s41, s41, 2
    s_add_u32 s33, s33, s41
    s_and_b32 s41, s28, 1
    s_lshl_b32 s41, s41, 2
    s_add_u32 s33, s33, s41
    s_and_b32 s41, s31, 1
    s_lshl_b32 s41, s41, 1
    s_add_u32 s33, s33, s41
    s_lshl_b32 s41, s40, 2
    s_add_u32 s33, s33, s41
    s_and_b32 s33, s33, 15
    s_cmp_lt_u32 s3, 4
    s_cbranch_scc1 L_comp
    s_sub_u32 s3, s3, 4
    v_lshrrev_b32 v1, 3, v4
    v_and_b32 v2, 7, v4
    v_lshrrev_b32 v3, 4, v4
    v_xor_b32 v6, v2, v3
    v_lshlrev_b32 v6, 4, v6
    v_lshl_add_u32 v6, v1, 11, v6
    s_lshl_b32 s60, s30, 7
    s_lshl_b32 s61, s3, 5
    s_add_u32 s60, s60, s61
    s_lshl_b32 s60, s60, 11
    v_add_u32 v8, s60, v6
    v_xor_b32 v6, 64, v8
    v_add_u32 v9, 15360, v6
    v_add_u32 v10, 30720, v8
    v_add_u32 v11, 46080, v6
    v_and_b32 v3, 1, v3
    v_lshlrev_b32 v3, 2, v3
    v_xor_b32 v7, v2, v3
    v_lshlrev_b32 v7, 4, v7
    v_xor_b32 v6, 32, v7
    s_movk_i32 s61, 6144
    v_mad_u32_u24 v7, v1, s61, v7
    v_mad_u32_u24 v6, v1, s61, v6
    s_mul_i32 s60, s3, 98304
    v_add_u32 v12, s60, v7
    s_add_u32 s60, s60, 48128
    v_add_u32 v13, s60, v6
    s_lshl_b32 s65, s3, 12
    s_lshl_b32 s66, s3, 11
    s_add_u32 s66, s66, 0x4000
    s_mov_b32 s64, 0
    s_mov_b32 s67, s33
    s_lshl_b32 s74, s32, 7
    s_lshl_b32 s75, s31, 7
    s_add_u32 s75, s75, 2048
    s_mov_b32 s42, 0x400000
    s_mov_b32 s43, 0x20000
    s_mov_b32 s46, 0x600000
    s_mov_b32 s47, 0x20000
    s_waitcnt lgkmcnt(0)
    s_mov_b64 s[40:41], s[4:5]
    s_mov_b64 s[44:45], s[6:7]
    s_add_u32 m0, s64, s65
    s_lshl_b32 s60, s67, 7
    s_mul_i32 s63, s67, 393216
    buffer_load_dwordx4 v8, s[40:43], s60 offen offset:0 lds
    buffer_load_dwordx4 v9, s[40:43], s60 offen offset:1024 lds
    buffer_load_dwordx4 v10, s[40:43], s60 offen offset:2048 lds
    buffer_load_dwordx4 v11, s[40:43], s60 offen offset:3072 lds
    s_add_u32 m0, s64, s66
    s_add_u32 s61, s63, s74
    s_add_u32 s62, s63, s75
    buffer_load_dwordx4 v12, s[44:47], s61 offen offset:0 lds
    buffer_load_dwordx4 v13, s[44:47], s61 offen offset:1024 lds
    s_add_u32 m0, m0, 8192
    s_add_u32 s63, s62, 2048
    buffer_load_dwordx4 v12, s[44:47], s62 offen offset:0 lds
    buffer_load_dwordx4 v13, s[44:47], s62 offen offset:1024 lds
    s_add_u32 m0, m0, 8192
    s_add_u32 s67, s67, 1
    buffer_load_dwordx4 v12, s[44:47], s63 offen offset:0 lds
    buffer_load_dwordx4 v13, s[44:47], s63 offen offset:1024 lds
    s_and_b32 s67, s67, 15
    s_add_u32 s64, s64, 40960
    s_cmp_eq_u32 s64, 122880
    s_cselect_b32 s64, 0, s64
    s_barrier
    s_and_b32 s34, s28, 3
    s_lshl_b32 s34, s34, 2
    s_and_b32 vcc_lo, s29, 3
    s_add_u32 s34, s34, vcc_lo
    s_lshr_b32 s35, s28, 2
    s_lshl_b32 s35, s35, 3
    s_lshr_b32 vcc_lo, s29, 2
    s_add_u32 s35, s35, vcc_lo
    s_lshl_b32 s39, vcc_lo, 2
    s_and_b32 s36, s29, 15
    s_lshr_b32 s37, s29, 4
    s_lshl_b32 vcc_lo, s28, 1
    s_add_u32 s37, s37, vcc_lo
    s_lshl_b32 s38, s28, 5
    s_add_u32 s38, s38, s29
    s_lshl_b32 s38, s38, 2
    s_mul_i32 s39, s34, 11
    s_lshr_b32 s39, s39, 5
    s_mul_i32 s39, s39, 3
    s_sub_u32 s39, s34, s39
    v_mov_b32 v6, 0
    v_mov_b32 v14, 1
    v_mov_b32 v15, 162816
    v_lshlrev_b32 v255, 7, v4
    s_nop 0
    s_mov_b32 s48, s26
    s_mov_b32 s49, s27
    s_mov_b32 s50, 0x2000000
    s_mov_b32 s51, 0x20000
    s_mov_b32 s52, s24
    s_mov_b32 s53, s25
    s_mov_b32 s54, 0x100
    s_mov_b32 s55, 0x20000
    s_or_b32 s60, s2, s3
    s_cmp_eq_u32 s60, 0
    s_cbranch_scc0 L_noep
    s_memrealtime s[60:61]
    s_waitcnt lgkmcnt(0)
    s_or_b32 s60, s60, 1
    v_mov_b32 v7, s60
    s_mov_b64 exec, 1
    buffer_store_dword v7, v6, s[52:55], 0 offen sc1
    s_mov_b64 exec, -1
L_noep:
    s_mul_i32 s68, s3, 4608
    s_add_u32 s68, s68, 139776
    s_lshl_b32 s69, s37, 7
    s_lshl_b32 s70, s3, 5
    s_add_u32 s69, s69, s70
    v_lshrrev_b32 v28, 4, v4
    v_bfe_u32 v29, v4, 2, 2
    v_and_b32 v30, 3, v4
    v_and_b32 v31, 15, v4
    s_lshl_b32 s60, s3, 12
    s_add_u32 s60, s60, 139776
    v_add_u32 v247, s60, v5
    s_and_b32 s60, s3, 1
    s_lshl_b32 s60, s60, 6
    v_xor_b32 v247, s60, v247
    v_xor_b32 v248, 16, v247
    v_xor_b32 v249, 32, v247
    v_xor_b32 v250, 48, v247
    v_lshlrev_b32 v3, 12, v28
    v_lshl_add_u32 v25, v31, 4, v3
    s_lshl_b32 s60, s36, 18
    s_lshl_b32 s61, s3, 16
    s_add_u32 s60, s60, s61
    s_lshl_b32 s61, s37, 8
    s_sub_u32 s60, s60, s61
    s_add_u32 s60, s60, 3840
    v_add_u32 v25, s60, v25
    v_lshlrev_b32 v26, 5, v4
    v_and_b32 v3, 1, v28
    v_lshlrev_b32 v3, 2, v3
    v_xor_b32 v3, v2, v3
    v_lshrrev_b32 v27, 5, v4
    v_lshlrev_b32 v27, 1, v27
    v_xor_b32 v3, v27, v3
    v_lshlrev_b32 v3, 4, v3
    v_lshl_add_u32 v3, v1, 11, v3
    s_lshl_b32 s60, s35, 7
    v_add_u32 v20, s60, v3
    v_add_u32 v21, 15360, v20
    v_add_u32 v22, 30720, v20
    v_add_u32 v23, 46080, v20
    s_mov_b32 s70, 0xffff0000
    v_and_b32 v3, 1, v28
    s_movk_i32 s60, 2304
    v_mul_u32_u24 v3, s60, v3
    v_lshl_add_u32 v3, v31, 4, v3
    v_add_u32 v251, s68, v3
    s_mul_i32 s71, s3, 8320
    s_add_u32 s71, s71, 98304
    v_add_u32 v19, s71, v5
    s_movk_i32 s61, 4160
    v_and_b32 v24, 1, v29
    v_mul_u32_u24 v24, s61, v24
    v_lshl_add_u32 v24, v30, 4, v24
    v_add_u32 v24, s71, v24
    v_add_u32 v3, 1, v31
    v_and_b32 v16, 1, v3
    v_add_u32 v17, v16, v31
    v_mul_u32_u24 v3, s61, v16
    v_lshl_add_u32 v3, v28, 5, v3
    v_lshlrev_b32 v17, 1, v17
    v_sub_u32 v3, v3, v17
    s_add_u32 s60, s71, 3486
    v_add_u32 v240, s60, v3
    v_subrev_u32 v241, 1024, v240
    v_subrev_u32 v242, 2048, v240
    v_subrev_u32 v243, 3072, v240
    v_add_u32 v3, v31, v28
    s_add_u32 s60, s68, 208
    v_lshlrev_b32 v3, 4, v3
    v_add_u32 v244, s60, v3
    v_lshlrev_b32 v3, 5, v31
    v_lshl_add_u32 v16, v28, 3, v3
    s_add_u32 s60, s71, 504
    v_sub_u32 v245, s60, v16
    v_and_b32 v16, 1, v28
    v_lshl_add_u32 v3, v16, 9, v3
    v_lshrrev_b32 v16, 5, v4
    v_lshl_add_u32 v246, v16, 4, v3
    v_lshlrev_b32 v27, 4, v2
    v_lshl_add_u32 v16, v1, 11, v27
    v_lshl_add_u32 v17, v1, 12, v27
    s_add_u32 s39, s38, s3
    s_and_b32 s60, s39, 0xfffffffe
    s_lshl_b32 s60, s60, 1
    s_load_dword s71, s[20:21], s60
    s_lshl_b32 s61, s39, 12
    v_mov_b64 v[160:161], 0
    v_mov_b64 v[162:163], 0
    v_mov_b64 v[164:165], 0
    v_mov_b64 v[166:167], 0
    v_mov_b64 v[168:169], 0
    v_mov_b64 v[170:171], 0
    v_mov_b64 v[172:173], 0
    v_mov_b64 v[174:175], 0
    v_mov_b64 v[176:177], 0
    v_mov_b64 v[178:179], 0
    v_mov_b64 v[180:181], 0
    v_mov_b64 v[182:183], 0
    v_mov_b64 v[184:185], 0
    v_mov_b64 v[186:187], 0
    v_mov_b64 v[188:189], 0
    v_mov_b64 v[190:191], 0
    s_add_u32 s52, s18, s61
    s_addc_u32 s53, s19, 0
    s_mov_b32 s54, 0x1000
    s_mov_b32 s55, 0x20000
    s_mov_b32 s56, s8
    s_mov_b32 s57, s9
    s_mov_b32 s58, 0x200000
    s_mov_b32 s59, 0x20000
    s_waitcnt lgkmcnt(0)
    s_mov_b32 s20, s10
    s_mov_b32 s21, s11
    s_waitcnt vmcnt(0)
    s_barrier
    s_add_u32 m0, s64, s65
    s_lshl_b32 s60, s67, 7
    s_mul_i32 s63, s67, 393216
    buffer_load_dwordx4 v8, s[40:43], s60 offen offset:0 lds
    buffer_load_dwordx4 v9, s[40:43], s60 offen offset:1024 lds
    buffer_load_dwordx4 v10, s[40:43], s60 offen offset:2048 lds
    buffer_load_dwordx4 v11, s[40:43], s60 offen offset:3072 lds
    s_add_u32 m0, s64, s66
    s_add_u32 s61, s63, s74
    s_add_u32 s62, s63, s75
    buffer_load_dwordx4 v12, s[44:47], s61 offen offset:0 lds
    buffer_load_dwordx4 v13, s[44:47], s61 offen offset:1024 lds
    s_add_u32 m0, m0, 8192
    s_add_u32 s63, s62, 2048
    buffer_load_dwordx4 v12, s[44:47], s62 offen offset:0 lds
    buffer_load_dwordx4 v13, s[44:47], s62 offen offset:1024 lds
    s_add_u32 m0, m0, 8192
    s_add_u32 s67, s67, 1
    buffer_load_dwordx4 v12, s[44:47], s63 offen offset:0 lds
    buffer_load_dwordx4 v13, s[44:47], s63 offen offset:1024 lds
    s_and_b32 s67, s67, 15
    s_add_u32 s64, s64, 40960
    s_cmp_eq_u32 s64, 122880
    s_cselect_b32 s64, 0, s64
    s_add_u32 m0, s64, s65
    s_lshl_b32 s60, s67, 7
    s_mul_i32 s63, s67, 393216
    buffer_load_dwordx4 v8, s[40:43], s60 offen offset:0 lds
    buffer_load_dwordx4 v9, s[40:43], s60 offen offset:1024 lds
    buffer_load_dwordx4 v10, s[40:43], s60 offen offset:2048 lds
    buffer_load_dwordx4 v11, s[40:43], s60 offen offset:3072 lds
    s_add_u32 m0, s64, s66
    s_add_u32 s61, s63, s74
    s_add_u32 s62, s63, s75
    buffer_load_dwordx4 v12, s[44:47], s61 offen offset:0 lds
    buffer_load_dwordx4 v13, s[44:47], s61 offen offset:1024 lds
    s_add_u32 m0, m0, 8192
    s_add_u32 s63, s62, 2048
    buffer_load_dwordx4 v12, s[44:47], s62 offen offset:0 lds
    buffer_load_dwordx4 v13, s[44:47], s62 offen offset:1024 lds
    s_add_u32 m0, m0, 8192
    s_add_u32 s67, s67, 1
    buffer_load_dwordx4 v12, s[44:47], s63 offen offset:0 lds
    buffer_load_dwordx4 v13, s[44:47], s63 offen offset:1024 lds
    s_and_b32 s67, s67, 15
    s_add_u32 s64, s64, 40960
    s_cmp_eq_u32 s64, 122880
    s_cselect_b32 s64, 0, s64
    s_waitcnt vmcnt(10)
    s_barrier
    ds_read_b128 v[32:35], v247 offset:0
    ds_read_b128 v[36:39], v248 offset:1024
    ds_read_b128 v[40:43], v249 offset:2048
    ds_read_b128 v[44:47], v250 offset:3072
    s_add_u32 m0, s64, s65
    s_lshl_b32 s60, s67, 7
    s_mul_i32 s63, s67, 393216
    buffer_load_dwordx4 v8, s[40:43], s60 offen offset:0 lds
    buffer_load_dwordx4 v9, s[40:43], s60 offen offset:1024 lds
    buffer_load_dwordx4 v10, s[40:43], s60 offen offset:2048 lds
    buffer_load_dwordx4 v11, s[40:43], s60 offen offset:3072 lds
    s_add_u32 m0, s64, s66
    s_add_u32 s61, s63, s74
    s_add_u32 s62, s63, s75
    buffer_load_dwordx4 v12, s[44:47], s61 offen offset:0 lds
    buffer_load_dwordx4 v13, s[44:47], s61 offen offset:1024 lds
    s_add_u32 m0, m0, 8192
    s_add_u32 s63, s62, 2048
    buffer_load_dwordx4 v12, s[44:47], s62 offen offset:0 lds
    buffer_load_dwordx4 v13, s[44:47], s62 offen offset:1024 lds
    s_add_u32 m0, m0, 8192
    s_add_u32 s67, s67, 1
    buffer_load_dwordx4 v12, s[44:47], s63 offen offset:0 lds
    buffer_load_dwordx4 v13, s[44:47], s63 offen offset:1024 lds
    s_and_b32 s67, s67, 15
    s_add_u32 s64, s64, 40960
    s_cmp_eq_u32 s64, 122880
    s_cselect_b32 s64, 0, s64
    s_movk_i32 s60, 0x4000
    s_mov_b32 s61, 0x8000
    s_mov_b32 s62, 0xc000
    s_waitcnt lgkmcnt(3)
    buffer_store_dwordx4 v[32:35], v25, s[48:51], 0 offen sc1
    s_waitcnt lgkmcnt(2)
    buffer_store_dwordx4 v[36:39], v25, s[48:51], s60 offen sc1
    s_waitcnt lgkmcnt(1)
    buffer_store_dwordx4 v[40:43], v25, s[48:51], s61 offen sc1
    s_waitcnt lgkmcnt(0)
    buffer_store_dwordx4 v[44:47], v25, s[48:51], s62 offen sc1
    global_load_dword v7, v6, s[24:25] sc1
    s_waitcnt vmcnt(15)
    s_barrier
    s_add_u32 m0, s64, s65
    s_lshl_b32 s60, s67, 7
    s_mul_i32 s63, s67, 393216
    buffer_load_dwordx4 v8, s[40:43], s60 offen offset:0 lds
    buffer_load_dwordx4 v9, s[40:43], s60 offen offset:1024 lds
    buffer_load_dwordx4 v10, s[40:43], s60 offen offset:2048 lds
    buffer_load_dwordx4 v11, s[40:43], s60 offen offset:3072 lds
    s_add_u32 m0, s64, s66
    s_add_u32 s61, s63, s74
    s_add_u32 s62, s63, s75
    buffer_load_dwordx4 v12, s[44:47], s61 offen offset:0 lds
    buffer_load_dwordx4 v13, s[44:47], s61 offen offset:1024 lds
    s_add_u32 m0, m0, 8192
    s_add_u32 s63, s62, 2048
    buffer_load_dwordx4 v12, s[44:47], s62 offen offset:0 lds
    buffer_load_dwordx4 v13, s[44:47], s62 offen offset:1024 lds
    s_add_u32 m0, m0, 8192
    s_add_u32 s67, s67, 1
    buffer_load_dwordx4 v12, s[44:47], s63 offen offset:0 lds
    buffer_load_dwordx4 v13, s[44:47], s63 offen offset:1024 lds
    s_and_b32 s67, s67, 15
    s_add_u32 s64, s64, 40960
    s_cmp_eq_u32 s64, 122880
    s_cselect_b32 s64, 0, s64
    s_waitcnt vmcnt(15)
    s_barrier
    s_waitcnt vmcnt(10)
    v_readfirstlane_b32 s72, v7
    s_lshl_b32 s33, s36, 2
    s_add_u32 s33, s33, s3
    s_lshl_b32 s33, s33, 4
    s_add_u32 s33, s33, s37
    s_lshl_b32 s33, s33, 2
    s_lshr_b32 vcc_lo, s33, 6
    s_mul_i32 vcc_lo, vcc_lo, 1984
    s_add_u32 s33, s33, vcc_lo
    s_add_u32 s33, s33, 0x940000
    s_mov_b32 s60, 0
    s_cmp_lg_u32 s72, 0
    s_cbranch_scc1 L_epok
L_eploop:
    global_load_dword v7, v6, s[24:25] sc1
    s_add_u32 s60, s60, 1
    s_waitcnt vmcnt(0)
    v_readfirstlane_b32 s72, v7
    s_cmp_gt_u32 s60, 0x4000
    s_cbranch_scc1 L_epok
    s_cmp_eq_u32 s72, 0
    s_cbranch_scc1 L_eploop
L_epok:
    s_mov_b32 s73, s72
    s_mov_b64 exec, 0xffff
    buffer_store_dword v7, v255, s[48:51], s33 offen sc1
    s_mov_b64 exec, -1
    s_add_u32 m0, s64, s65
    s_lshl_b32 s60, s67, 7
    s_mul_i32 s63, s67, 393216
    buffer_load_dwordx4 v8, s[40:43], s60 offen offset:0 lds
    buffer_load_dwordx4 v9, s[40:43], s60 offen offset:1024 lds
    buffer_load_dwordx4 v10, s[40:43], s60 offen offset:2048 lds
    buffer_load_dwordx4 v11, s[40:43], s60 offen offset:3072 lds
    s_add_u32 m0, s64, s66
    s_add_u32 s61, s63, s74
    s_add_u32 s62, s63, s75
    buffer_load_dwordx4 v12, s[44:47], s61 offen offset:0 lds
    buffer_load_dwordx4 v13, s[44:47], s61 offen offset:1024 lds
    s_add_u32 m0, m0, 8192
    s_add_u32 s63, s62, 2048
    buffer_load_dwordx4 v12, s[44:47], s62 offen offset:0 lds
    buffer_load_dwordx4 v13, s[44:47], s62 offen offset:1024 lds
    s_add_u32 m0, m0, 8192
    s_add_u32 s67, s67, 1
    buffer_load_dwordx4 v12, s[44:47], s63 offen offset:0 lds
    buffer_load_dwordx4 v13, s[44:47], s63 offen offset:1024 lds
    s_and_b32 s67, s67, 15
    s_add_u32 s64, s64, 40960
    s_cmp_eq_u32 s64, 122880
    s_cselect_b32 s64, 0, s64
    s_mov_b32 s33, 4
L_lloop:
    s_waitcnt vmcnt(10)
    s_barrier
    s_add_u32 m0, s64, s65
    s_lshl_b32 s60, s67, 7
    s_mul_i32 s63, s67, 393216
    buffer_load_dwordx4 v8, s[40:43], s60 offen offset:0 lds
    buffer_load_dwordx4 v9, s[40:43], s60 offen offset:1024 lds
    buffer_load_dwordx4 v10, s[40:43], s60 offen offset:2048 lds
    buffer_load_dwordx4 v11, s[40:43], s60 offen offset:3072 lds
    s_add_u32 m0, s64, s66
    s_add_u32 s61, s63, s74
    s_add_u32 s62, s63, s75
    buffer_load_dwordx4 v12, s[44:47], s61 offen offset:0 lds
    buffer_load_dwordx4 v13, s[44:47], s61 offen offset:1024 lds
    s_add_u32 m0, m0, 8192
    s_add_u32 s63, s62, 2048
    buffer_load_dwordx4 v12, s[44:47], s62 offen offset:0 lds
    buffer_load_dwordx4 v13, s[44:47], s62 offen offset:1024 lds
    s_add_u32 m0, m0, 8192
    s_add_u32 s67, s67, 1
    buffer_load_dwordx4 v12, s[44:47], s63 offen offset:0 lds
    buffer_load_dwordx4 v13, s[44:47], s63 offen offset:1024 lds
    s_and_b32 s67, s67, 15
    s_add_u32 s64, s64, 40960
    s_cmp_eq_u32 s64, 122880
    s_cselect_b32 s64, 0, s64
    s_add_u32 s33, s33, 1
    s_cmp_le_u32 s33, 13
    s_cbranch_scc1 L_lloop
    s_lshl_b32 s67, s39, 7
    s_add_u32 s67, s67, 0x940000
    s_load_dwordx16 s[4:19], s[26:27], s67 glc
    s_mov_b32 s40, s20
    s_mov_b32 s41, s21
    s_mov_b32 s42, 0x400000
    s_mov_b32 s43, 0x20000
    s_mov_b32 s44, s22
    s_mov_b32 s45, s23
    s_mov_b32 s46, 0x800000
    s_mov_b32 s47, 0x20000
    s_mov_b32 s74, s3
    s_add_u32 s75, s3, 4
    s_add_u32 s65, s3, 8
    s_add_u32 s66, s3, 12
    s_waitcnt vmcnt(10)
    s_barrier
    ds_write_b128 v251, v[160:163]
    s_add_u32 m0, s68, 256
    s_movk_i32 s60, 1024
    s_movk_i32 s61, 1040
    buffer_load_dwordx4 v26, s[52:55], 0 offen  lds
    buffer_load_dwordx4 v26, s[52:55], s60 offen offset:1024  lds
    s_add_u32 m0, s68, 2560
    s_nop 0
    buffer_load_dwordx4 v26, s[52:55], 16 offen  lds
    buffer_load_dwordx4 v26, s[52:55], s61 offen offset:1024  lds
    s_lshl_b32 s63, s39, 12
    s_add_u32 s52, s26, s63
    s_addc_u32 s53, s27, 0
    s_mov_b32 s54, 0x1000
    s_mov_b32 s55, 0x20000
    s_waitcnt lgkmcnt(0)
    s_cmp_eq_u64 s[4:5], s[72:73]
    s_cbranch_scc0 L_us
    s_cmp_eq_u64 s[6:7], s[72:73]
    s_cbranch_scc0 L_us
    s_cmp_eq_u64 s[8:9], s[72:73]
    s_cbranch_scc0 L_us
    s_cmp_eq_u64 s[10:11], s[72:73]
    s_cbranch_scc0 L_us
    s_cmp_eq_u64 s[12:13], s[72:73]
    s_cbranch_scc0 L_us
    s_cmp_eq_u64 s[14:15], s[72:73]
    s_cbranch_scc0 L_us
    s_cmp_eq_u64 s[16:17], s[72:73]
    s_cbranch_scc0 L_us
    s_cmp_eq_u64 s[18:19], s[72:73]
    s_cbranch_scc0 L_us
    s_branch L_upoll_done
L_us:
    s_mov_b32 s60, 0
    s_branch L_upoll_go
L_upoll:
    s_sleep 0
L_upoll_go:
    s_load_dwordx16 s[4:19], s[26:27], s67 glc
    s_add_u32 s60, s60, 1
    s_cmp_gt_u32 s60, 0x8000
    s_cbranch_scc1 L_upoll_done
    s_waitcnt lgkmcnt(0)
    s_cmp_eq_u64 s[4:5], s[72:73]
    s_cbranch_scc0 L_upoll
    s_cmp_eq_u64 s[6:7], s[72:73]
    s_cbranch_scc0 L_upoll
    s_cmp_eq_u64 s[8:9], s[72:73]
    s_cbranch_scc0 L_upoll
    s_cmp_eq_u64 s[10:11], s[72:73]
    s_cbranch_scc0 L_upoll
    s_cmp_eq_u64 s[12:13], s[72:73]
    s_cbranch_scc0 L_upoll
    s_cmp_eq_u64 s[14:15], s[72:73]
    s_cbranch_scc0 L_upoll
    s_cmp_eq_u64 s[16:17], s[72:73]
    s_cbranch_scc0 L_upoll
    s_cmp_eq_u64 s[18:19], s[72:73]
    s_cbranch_scc0 L_upoll
L_upoll_done:
    s_waitcnt lgkmcnt(0)
    buffer_load_dwordx4 v[32:35], v5, s[52:55], 0 offen offset:0 sc1
    buffer_load_dwordx4 v[36:39], v5, s[52:55], 0 offen offset:1024 sc1
    buffer_load_dwordx4 v[40:43], v5, s[52:55], 0 offen offset:2048 sc1
    buffer_load_dwordx4 v[44:47], v5, s[52:55], 0 offen offset:3072 sc1
    s_waitcnt vmcnt(8)
    s_barrier
    ds_write_b128 v24, v[160:163] offset:4096
    s_lshl_b32 m0, s65, 13
    s_lshl_b32 s60, s65, 17
    s_add_u32 s61, s60, 0x10000
    buffer_load_dwordx4 v20, s[56:59], s60 offen offset:0  lds
    buffer_load_dwordx4 v21, s[56:59], s60 offen offset:1024  lds
    buffer_load_dwordx4 v22, s[56:59], s60 offen offset:2048  lds
    buffer_load_dwordx4 v23, s[56:59], s60 offen offset:3072  lds
    s_add_u32 m0, m0, 4096
    s_nop 0
    buffer_load_dwordx4 v20, s[56:59], s61 offen offset:0  lds
    buffer_load_dwordx4 v21, s[56:59], s61 offen offset:1024  lds
    buffer_load_dwordx4 v22, s[56:59], s61 offen offset:2048  lds
    buffer_load_dwordx4 v23, s[56:59], s61 offen offset:3072  lds
    s_waitcnt vmcnt(8)
    v_mov_b32_dpp v48, v36 wave_rol:1 row_mask:0xf bank_mask:0xf
    v_mov_b32_dpp v49, v40 wave_rol:1 row_mask:0xf bank_mask:0xf
    v_mov_b32_dpp v50, v44 wave_rol:1 row_mask:0xf bank_mask:0xf
    v_mov_b32 v51, 0
    s_nop 0
    v_mov_b32_dpp v48, v32 wave_shl:1 row_mask:0xf bank_mask:0xf
    v_mov_b32_dpp v49, v36 wave_shl:1 row_mask:0xf bank_mask:0xf
    v_mov_b32_dpp v50, v40 wave_shl:1 row_mask:0xf bank_mask:0xf
    v_mov_b32_dpp v51, v44 wave_shl:1 row_mask:0xf bank_mask:0xf
    ds_write_b128 v19, v[32:35] offset:0
    v_alignbit_b32 v52, v33, v32, 16
    v_alignbit_b32 v53, v34, v33, 16
    v_alignbit_b32 v54, v35, v34, 16
    v_alignbit_b32 v55, v48, v35, 16
    ds_write_b128 v19, v[52:55] offset:4160
    ds_write_b128 v19, v[36:39] offset:1024
    v_alignbit_b32 v56, v37, v36, 16
    v_alignbit_b32 v57, v38, v37, 16
    v_alignbit_b32 v58, v39, v38, 16
    v_alignbit_b32 v59, v49, v39, 16
    ds_write_b128 v19, v[56:59] offset:5184
    ds_write_b128 v19, v[40:43] offset:2048
    v_alignbit_b32 v60, v41, v40, 16
    v_alignbit_b32 v61, v42, v41, 16
    v_alignbit_b32 v62, v43, v42, 16
    v_alignbit_b32 v63, v50, v43, 16
    ds_write_b128 v19, v[60:63] offset:6208
    ds_write_b128 v19, v[44:47] offset:3072
    v_alignbit_b32 v64, v45, v44, 16
    v_alignbit_b32 v65, v46, v45, 16
    v_alignbit_b32 v66, v47, v46, 16
    v_alignbit_b32 v67, v51, v47, 16
    ds_write_b128 v19, v[64:67] offset:7232
    s_mov_b32 s60, 0
L_fr:
    ds_read_b128 v[68:71], v15 offset:112
    s_add_u32 s60, s60, 1
    s_waitcnt lgkmcnt(0)
    v_and_b32 v68, v68, v69
    v_and_b32 v70, v70, v71
    v_and_b32 v68, v68, v70
    s_cmp_gt_u32 s60, 0x40000
    s_cbranch_scc1 L_fr_d
    v_readfirstlane_b32 s61, v68
    s_nop 3
    s_cmp_eq_u32 s61, 1
    s_cbranch_scc1 L_fr_d
    s_sleep 1
    s_branch L_fr
L_fr_d:
    s_lshl_b32 m0, s75, 13
    s_lshl_b32 s60, s75, 17
    s_add_u32 s61, s60, 0x10000
    buffer_load_dwordx4 v20, s[56:59], s60 offen offset:0  lds
    buffer_load_dwordx4 v21, s[56:59], s60 offen offset:1024  lds
    buffer_load_dwordx4 v22, s[56:59], s60 offen offset:2048  lds
    buffer_load_dwordx4 v23, s[56:59], s60 offen offset:3072  lds
    s_add_u32 m0, m0, 4096
    s_nop 0
    buffer_load_dwordx4 v20, s[56:59], s61 offen offset:0  lds
    buffer_load_dwordx4 v21, s[56:59], s61 offen offset:1024  lds
    buffer_load_dwordx4 v22, s[56:59], s61 offen offset:2048  lds
    buffer_load_dwordx4 v23, s[56:59], s61 offen offset:3072  lds
    s_lshl_b32 m0, s74, 13
    s_lshl_b32 s60, s74, 17
    s_add_u32 s61, s60, 0x10000
    buffer_load_dwordx4 v20, s[56:59], s60 offen offset:0  lds
    buffer_load_dwordx4 v21, s[56:59], s60 offen offset:1024  lds
    buffer_load_dwordx4 v22, s[56:59], s60 offen offset:2048  lds
    buffer_load_dwordx4 v23, s[56:59], s60 offen offset:3072  lds
    s_add_u32 m0, m0, 4096
    s_nop 0
    buffer_load_dwordx4 v20, s[56:59], s61 offen offset:0  lds
    buffer_load_dwordx4 v21, s[56:59], s61 offen offset:1024  lds
    buffer_load_dwordx4 v22, s[56:59], s61 offen offset:2048  lds
    buffer_load_dwordx4 v23, s[56:59], s61 offen offset:3072  lds
    s_lshl_b32 s30, s69, 11
    s_lshl_b32 s61, s36, 7
    s_add_u32 s30, s30, s61
    s_lshl_b32 s63, s69, 12
    s_add_u32 s63, s63, s61
    s_add_u32 s63, s63, 2048
    s_lshl_b32 s66, s34, 8
    s_lshl_b32 s61, s3, 6
    s_add_u32 s66, s66, s61
    s_lshr_b32 vcc_lo, s66, 6
    s_mul_i32 vcc_lo, vcc_lo, 1984
    s_add_u32 s66, s66, vcc_lo
    s_add_u32 s66, s66, 0x980000
    s_lshl_b32 vcc_lo, s35, 7
    s_add_u32 s66, s66, vcc_lo
    s_add_u32 s31, s3, 12
    s_bitcmp1_b32 s3, 0
    s_cselect_b32 s60, 0, 16
    s_cselect_b32 s33, 16, 0
    s_lshl_b32 s71, s71, s60
    s_and_b32 s71, s71, 0xffff0000
    s_lshr_b32 s60, s3, 1
    v_lshl_add_u32 v19, s60, 2, v15
    s_mov_b32 s32, s38
    s_lshr_b32 vcc_lo, s32, 6
    s_mul_i32 vcc_lo, vcc_lo, 8128
    s_add_u32 s32, s32, vcc_lo
    s_add_u32 s32, s32, 0x9a0000
    s_lshl_b32 s67, s36, 6
    s_lshl_b32 s60, s37, 2
    s_add_u32 s60, s60, s3
    s_lshr_b32 vcc_lo, s67, 6
    s_mul_i32 vcc_lo, vcc_lo, 8128
    s_add_u32 s67, s67, vcc_lo
    s_add_u32 s67, s67, 0x9a0000
    s_lshl_b32 vcc_lo, s60, 7
    s_add_u32 s67, s67, vcc_lo
    s_mov_b32 s64, 0
    ds_read2_b32 v[32:33], v240 offset0:132 offset1:133
    ds_read2_b32 v[34:35], v240 offset0:134 offset1:135
    ds_read_b128 v[64:67], v244 offset:2304
    ds_read2_b32 v[36:37], v240 offset0:4 offset1:5
    ds_read2_b32 v[38:39], v240 offset0:6 offset1:7
    ds_read_b128 v[68:71], v244 offset:2560
    ds_read2_b32 v[40:41], v241 offset0:132 offset1:133
    ds_read2_b32 v[42:43], v241 offset0:134 offset1:135
    ds_read_b128 v[72:75], v244 offset:2816
    ds_read2_b32 v[44:45], v241 offset0:4 offset1:5
    ds_read2_b32 v[46:47], v241 offset0:6 offset1:7
    ds_read_b128 v[76:79], v244 offset:3072
    ds_read2_b32 v[48:49], v242 offset0:132 offset1:133
    ds_read2_b32 v[50:51], v242 offset0:134 offset1:135
    ds_read_b128 v[80:83], v244 offset:3328
    ds_read2_b32 v[52:53], v242 offset0:4 offset1:5
    ds_read2_b32 v[54:55], v242 offset0:6 offset1:7
    ds_read_b128 v[84:87], v244 offset:3584
    ds_read2_b32 v[56:57], v243 offset0:132 offset1:133
    ds_read2_b32 v[58:59], v243 offset0:134 offset1:135
    ds_read_b128 v[88:91], v244 offset:3840
    ds_read2_b32 v[60:61], v243 offset0:4 offset1:5
    ds_read2_b32 v[62:63], v243 offset0:6 offset1:7
    ds_read_b128 v[92:95], v244 offset:4096
    s_mov_b32 s60, 0
L_kd:
    ds_read_b128 v[96:99], v15 offset:128
    s_add_u32 s60, s60, 1
    s_waitcnt lgkmcnt(0)
    v_and_b32 v96, v96, v97
    v_and_b32 v98, v98, v99
    v_and_b32 v96, v96, v98
    s_cmp_gt_u32 s60, 0x40000
    s_cbranch_scc1 L_kd_d
    v_readfirstlane_b32 s61, v96
    s_nop 3
    s_cmp_eq_u32 s61, 1
    s_cbranch_scc1 L_kd_d
    s_sleep 1
    s_branch L_kd
L_kd_d:
    s_setprio 0
    s_waitcnt lgkmcnt(0)
    v_mfma_f32_16x16x32_bf16 v[160:163], v[32:35], v[64:67], v[160:163]
    ds_read2_b32 v[96:97], v240 offset0:128 offset1:129
    v_mfma_f32_16x16x32_bf16 v[164:167], v[32:35], v[68:71], v[164:167]
    ds_read2_b32 v[98:99], v240 offset0:130 offset1:131
    v_mfma_f32_16x16x32_bf16 v[168:171], v[32:35], v[72:75], v[168:171]
    ds_read_b128 v[128:131], v244 offset:0
    v_mfma_f32_16x16x32_bf16 v[172:175], v[32:35], v[76:79], v[172:175]
    ds_read2_b32 v[100:101], v240 offset0:0 offset1:1
    v_mfma_f32_16x16x32_bf16 v[176:179], v[32:35], v[80:83], v[176:179]
    ds_read2_b32 v[102:103], v240 offset0:2 offset1:3
    v_mfma_f32_16x16x32_bf16 v[180:183], v[32:35], v[84:87], v[180:183]
    ds_read_b128 v[132:135], v244 offset:256
    v_mfma_f32_16x16x32_bf16 v[184:187], v[32:35], v[88:91], v[184:187]
    ds_read2_b32 v[104:105], v241 offset0:128 offset1:129
    v_mfma_f32_16x16x32_bf16 v[188:191], v[32:35], v[92:95], v[188:191]
    ds_read2_b32 v[106:107], v241 offset0:130 offset1:131
    v_mfma_f32_16x16x32_bf16 v[164:167], v[36:39], v[64:67], v[164:167]
    ds_read_b128 v[136:139], v244 offset:512
    v_mfma_f32_16x16x32_bf16 v[168:171], v[36:39], v[68:71], v[168:171]
    ds_read2_b32 v[108:109], v241 offset0:0 offset1:1
    v_mfma_f32_16x16x32_bf16 v[172:175], v[36:39], v[72:75], v[172:175]
    ds_read2_b32 v[110:111], v241 offset0:2 offset1:3
    v_mfma_f32_16x16x32_bf16 v[176:179], v[36:39], v[76:79], v[176:179]
    ds_read_b128 v[140:143], v244 offset:768
    v_mfma_f32_16x16x32_bf16 v[180:183], v[36:39], v[80:83], v[180:183]
    ds_read2_b32 v[112:113], v242 offset0:128 offset1:129
    v_mfma_f32_16x16x32_bf16 v[184:187], v[36:39], v[84:87], v[184:187]
    ds_read2_b32 v[114:115], v242 offset0:130 offset1:131
    v_mfma_f32_16x16x32_bf16 v[188:191], v[36:39], v[88:91], v[188:191]
    ds_read_b128 v[144:147], v244 offset:1024
    v_mfma_f32_16x16x32_bf16 v[168:171], v[40:43], v[64:67], v[168:171]
    ds_read2_b32 v[116:117], v242 offset0:0 offset1:1
    v_mfma_f32_16x16x32_bf16 v[172:175], v[40:43], v[68:71], v[172:175]
    ds_read2_b32 v[118:119], v242 offset0:2 offset1:3
    v_mfma_f32_16x16x32_bf16 v[176:179], v[40:43], v[72:75], v[176:179]
    ds_read_b128 v[148:151], v244 offset:1280
    v_mfma_f32_16x16x32_bf16 v[180:183], v[40:43], v[76:79], v[180:183]
    ds_read2_b32 v[120:121], v243 offset0:128 offset1:129
    v_mfma_f32_16x16x32_bf16 v[184:187], v[40:43], v[80:83], v[184:187]
    ds_read2_b32 v[122:123], v243 offset0:130 offset1:131
    v_mfma_f32_16x16x32_bf16 v[188:191], v[40:43], v[84:87], v[188:191]
    ds_read_b128 v[152:155], v244 offset:1536
    v_mfma_f32_16x16x32_bf16 v[172:175], v[44:47], v[64:67], v[172:175]
    ds_read2_b32 v[124:125], v243 offset0:0 offset1:1
    v_mfma_f32_16x16x32_bf16 v[176:179], v[44:47], v[68:71], v[176:179]
    ds_read2_b32 v[126:127], v243 offset0:2 offset1:3
    v_mfma_f32_16x16x32_bf16 v[180:183], v[44:47], v[72:75], v[180:183]
    ds_read_b128 v[156:159], v244 offset:1792
    v_mfma_f32_16x16x32_bf16 v[184:187], v[44:47], v[76:79], v[184:187]
    v_subrev_u32 v240, 128, v240
    v_mfma_f32_16x16x32_bf16 v[188:191], v[44:47], v[80:83], v[188:191]
    v_subrev_u32 v241, 128, v241
    v_mfma_f32_16x16x32_bf16 v[176:179], v[48:51], v[64:67], v[176:179]
    v_subrev_u32 v242, 128, v242
    v_mfma_f32_16x16x32_bf16 v[180:183], v[48:51], v[68:71], v[180:183]
    v_subrev_u32 v243, 128, v243
    v_mfma_f32_16x16x32_bf16 v[184:187], v[48:51], v[72:75], v[184:187]
    v_subrev_u32 v244, 64, v244
    v_mfma_f32_16x16x32_bf16 v[188:191], v[48:51], v[76:79], v[188:191]
    v_mfma_f32_16x16x32_bf16 v[180:183], v[52:55], v[64:67], v[180:183]
    v_mfma_f32_16x16x32_bf16 v[184:187], v[52:55], v[68:71], v[184:187]
    v_mfma_f32_16x16x32_bf16 v[188:191], v[52:55], v[72:75], v[188:191]
    v_mfma_f32_16x16x32_bf16 v[184:187], v[56:59], v[64:67], v[184:187]
    v_mfma_f32_16x16x32_bf16 v[188:191], v[56:59], v[68:71], v[188:191]
    v_mfma_f32_16x16x32_bf16 v[188:191], v[60:63], v[64:67], v[188:191]
    s_waitcnt lgkmcnt(0)
    s_waitcnt vmcnt(0)
    v_mfma_f32_16x16x32_bf16 v[160:163], v[96:99], v[128:131], v[160:163]
    ds_read2_b32 v[32:33], v240 offset0:132 offset1:133
    s_mov_b32 s29, 1
    v_mfma_f32_16x16x32_bf16 v[164:167], v[96:99], v[132:135], v[164:167]
    ds_read2_b32 v[34:35], v240 offset0:134 offset1:135
    s_lshl_b32 s60, s3, 1
    v_mfma_f32_16x16x32_bf16 v[168:171], v[96:99], v[136:139], v[168:171]
    ds_read_b128 v[64:67], v244 offset:2304
    s_lshl_b32 s60, 0x10101, s60
    v_mfma_f32_16x16x32_bf16 v[172:175], v[96:99], v[140:143], v[172:175]
    ds_read2_b32 v[36:37], v240 offset0:4 offset1:5
    v_mov_b32 v3, s60
    v_mfma_f32_16x16x32_bf16 v[176:179], v[96:99], v[144:147], v[176:179]
    ds_read2_b32 v[38:39], v240 offset0:6 offset1:7
    s_mov_b64 exec, 1
    ds_or_b32 v15, v3 offset:60
    s_mov_b64 exec, -1
    v_mfma_f32_16x16x32_bf16 v[180:183], v[96:99], v[148:151], v[180:183]
    ds_read_b128 v[68:71], v244 offset:2560
    s_lshl_b32 s60, s31, 17
    v_mfma_f32_16x16x32_bf16 v[184:187], v[96:99], v[152:155], v[184:187]
    ds_read2_b32 v[40:41], v241 offset0:132 offset1:133
    s_add_u32 s61, s60, 0x10000
    v_mfma_f32_16x16x32_bf16 v[188:191], v[96:99], v[156:159], v[188:191]
    ds_read2_b32 v[42:43], v241 offset0:134 offset1:135
    buffer_load_dwordx4 v[192:195], v20, s[56:59], s60 offen offset:0
    v_mfma_f32_16x16x32_bf16 v[164:167], v[100:103], v[128:131], v[164:167]
    ds_read_b128 v[72:75], v244 offset:2816
    buffer_load_dwordx4 v[196:199], v21, s[56:59], s60 offen offset:1024
    v_mfma_f32_16x16x32_bf16 v[168:171], v[100:103], v[132:135], v[168:171]
    ds_read2_b32 v[44:45], v241 offset0:4 offset1:5
    buffer_load_dwordx4 v[200:203], v22, s[56:59], s60 offen offset:2048
    v_mfma_f32_16x16x32_bf16 v[172:175], v[100:103], v[136:139], v[172:175]
    ds_read2_b32 v[46:47], v241 offset0:6 offset1:7
    buffer_load_dwordx4 v[204:207], v23, s[56:59], s60 offen offset:3072
    v_mfma_f32_16x16x32_bf16 v[176:179], v[100:103], v[140:143], v[176:179]
    ds_read_b128 v[76:79], v244 offset:3072
    buffer_load_dwordx4 v[208:211], v20, s[56:59], s61 offen offset:0
    v_mfma_f32_16x16x32_bf16 v[180:183], v[100:103], v[144:147], v[180:183]
    ds_read2_b32 v[48:49], v242 offset0:132 offset1:133
    buffer_load_dwordx4 v[212:215], v21, s[56:59], s61 offen offset:1024
    v_mfma_f32_16x16x32_bf16 v[184:187], v[100:103], v[148:151], v[184:187]
    ds_read2_b32 v[50:51], v242 offset0:134 offset1:135
    buffer_load_dwordx4 v[216:219], v22, s[56:59], s61 offen offset:2048
    v_mfma_f32_16x16x32_bf16 v[188:191], v[100:103], v[152:155], v[188:191]
    ds_read_b128 v[80:83], v244 offset:3328
    buffer_load_dwordx4 v[220:223], v23, s[56:59], s61 offen offset:3072
    v_mfma_f32_16x16x32_bf16 v[168:171], v[104:107], v[128:131], v[168:171]
    ds_read2_b32 v[52:53], v242 offset0:4 offset1:5
    buffer_load_dwordx4 v[224:227], v16, s[40:43], s30 offen
    v_mfma_f32_16x16x32_bf16 v[172:175], v[104:107], v[132:135], v[172:175]
    ds_read2_b32 v[54:55], v242 offset0:6 offset1:7
    s_add_u32 s30, s30, 0x4000
    v_mfma_f32_16x16x32_bf16 v[176:179], v[104:107], v[136:139], v[176:179]
    ds_read_b128 v[84:87], v244 offset:3584
    buffer_load_dwordx4 v[228:231], v16, s[40:43], s30 offen
    v_mfma_f32_16x16x32_bf16 v[180:183], v[104:107], v[140:143], v[180:183]
    ds_read2_b32 v[56:57], v243 offset0:132 offset1:133
    s_add_u32 s30, s30, 0x4000
    v_mfma_f32_16x16x32_bf16 v[184:187], v[104:107], v[144:147], v[184:187]
    ds_read2_b32 v[58:59], v243 offset0:134 offset1:135
    buffer_load_dwordx4 v[232:235], v16, s[40:43], s30 offen
    v_mfma_f32_16x16x32_bf16 v[188:191], v[104:107], v[148:151], v[188:191]
    ds_read_b128 v[88:91], v244 offset:3840
    s_add_u32 s30, s30, 0x4000
    v_mfma_f32_16x16x32_bf16 v[172:175], v[108:111], v[128:131], v[172:175]
    ds_read2_b32 v[60:61], v243 offset0:4 offset1:5
    buffer_load_dwordx4 v[236:239], v16, s[40:43], s30 offen
    v_mfma_f32_16x16x32_bf16 v[176:179], v[108:111], v[132:135], v[176:179]
    ds_read2_b32 v[62:63], v243 offset0:6 offset1:7
    v_mfma_f32_16x16x32_bf16 v[180:183], v[108:111], v[136:139], v[180:183]
    ds_read_b128 v[92:95], v244 offset:4096
    v_mfma_f32_16x16x32_bf16 v[184:187], v[108:111], v[140:143], v[184:187]
    v_mfma_f32_16x16x32_bf16 v[188:191], v[108:111], v[144:147], v[188:191]
    v_mfma_f32_16x16x32_bf16 v[176:179], v[112:115], v[128:131], v[176:179]
    v_mfma_f32_16x16x32_bf16 v[180:183], v[112:115], v[132:135], v[180:183]
    v_mfma_f32_16x16x32_bf16 v[184:187], v[112:115], v[136:139], v[184:187]
    v_mfma_f32_16x16x32_bf16 v[188:191], v[112:115], v[140:143], v[188:191]
    v_mfma_f32_16x16x32_bf16 v[180:183], v[116:119], v[128:131], v[180:183]
    v_mfma_f32_16x16x32_bf16 v[184:187], v[116:119], v[132:135], v[184:187]
    v_mfma_f32_16x16x32_bf16 v[188:191], v[116:119], v[136:139], v[188:191]
    v_mfma_f32_16x16x32_bf16 v[184:187], v[120:123], v[128:131], v[184:187]
    v_mfma_f32_16x16x32_bf16 v[188:191], v[120:123], v[132:135], v[188:191]
    v_mfma_f32_16x16x32_bf16 v[188:191], v[124:127], v[128:131], v[188:191]
L_cloop:
    s_waitcnt lgkmcnt(0)
    v_mfma_f32_16x16x32_bf16 v[160:163], v[32:35], v[64:67], v[160:163]
    ds_read2_b32 v[96:97], v240 offset0:128 offset1:129
    v_mfma_f32_16x16x32_bf16 v[164:167], v[32:35], v[68:71], v[164:167]
    ds_read2_b32 v[98:99], v240 offset0:130 offset1:131
    v_mfma_f32_16x16x32_bf16 v[168:171], v[32:35], v[72:75], v[168:171]
    ds_read_b128 v[128:131], v244 offset:0
    v_mfma_f32_16x16x32_bf16 v[172:175], v[32:35], v[76:79], v[172:175]
    ds_read2_b32 v[100:101], v240 offset0:0 offset1:1
    v_mfma_f32_16x16x32_bf16 v[176:179], v[32:35], v[80:83], v[176:179]
    ds_read2_b32 v[102:103], v240 offset0:2 offset1:3
    v_mfma_f32_16x16x32_bf16 v[180:183], v[32:35], v[84:87], v[180:183]
    ds_read_b128 v[132:135], v244 offset:256
    v_mfma_f32_16x16x32_bf16 v[184:187], v[32:35], v[88:91], v[184:187]
    ds_read2_b32 v[104:105], v241 offset0:128 offset1:129
    v_mfma_f32_16x16x32_bf16 v[188:191], v[32:35], v[92:95], v[188:191]
    ds_read2_b32 v[106:107], v241 offset0:130 offset1:131
    v_mfma_f32_16x16x32_bf16 v[164:167], v[36:39], v[64:67], v[164:167]
    ds_read_b128 v[136:139], v244 offset:512
    v_mfma_f32_16x16x32_bf16 v[168:171], v[36:39], v[68:71], v[168:171]
    ds_read2_b32 v[108:109], v241 offset0:0 offset1:1
    v_mfma_f32_16x16x32_bf16 v[172:175], v[36:39], v[72:75], v[172:175]
    ds_read2_b32 v[110:111], v241 offset0:2 offset1:3
    v_mfma_f32_16x16x32_bf16 v[176:179], v[36:39], v[76:79], v[176:179]
    ds_read_b128 v[140:143], v244 offset:768
    v_mfma_f32_16x16x32_bf16 v[180:183], v[36:39], v[80:83], v[180:183]
    ds_read2_b32 v[112:113], v242 offset0:128 offset1:129
    v_mfma_f32_16x16x32_bf16 v[184:187], v[36:39], v[84:87], v[184:187]
    ds_read2_b32 v[114:115], v242 offset0:130 offset1:131
    v_mfma_f32_16x16x32_bf16 v[188:191], v[36:39], v[88:91], v[188:191]
    ds_read_b128 v[144:147], v244 offset:1024
    v_mfma_f32_16x16x32_bf16 v[168:171], v[40:43], v[64:67], v[168:171]
    ds_read2_b32 v[116:117], v242 offset0:0 offset1:1
    v_mfma_f32_16x16x32_bf16 v[172:175], v[40:43], v[68:71], v[172:175]
    ds_read2_b32 v[118:119], v242 offset0:2 offset1:3
    v_mfma_f32_16x16x32_bf16 v[176:179], v[40:43], v[72:75], v[176:179]
    ds_read_b128 v[148:151], v244 offset:1280
    v_mfma_f32_16x16x32_bf16 v[180:183], v[40:43], v[76:79], v[180:183]
    ds_read2_b32 v[120:121], v243 offset0:128 offset1:129
    v_mfma_f32_16x16x32_bf16 v[184:187], v[40:43], v[80:83], v[184:187]
    ds_read2_b32 v[122:123], v243 offset0:130 offset1:131
    v_mfma_f32_16x16x32_bf16 v[188:191], v[40:43], v[84:87], v[188:191]
    ds_read_b128 v[152:155], v244 offset:1536
    v_mfma_f32_16x16x32_bf16 v[172:175], v[44:47], v[64:67], v[172:175]
    ds_read2_b32 v[124:125], v243 offset0:0 offset1:1
    v_mfma_f32_16x16x32_bf16 v[176:179], v[44:47], v[68:71], v[176:179]
    ds_read2_b32 v[126:127], v243 offset0:2 offset1:3
    v_mfma_f32_16x16x32_bf16 v[180:183], v[44:47], v[72:75], v[180:183]
    ds_read_b128 v[156:159], v244 offset:1792
    v_mfma_f32_16x16x32_bf16 v[184:187], v[44:47], v[76:79], v[184:187]
    v_subrev_u32 v240, 128, v240
    v_mfma_f32_16x16x32_bf16 v[188:191], v[44:47], v[80:83], v[188:191]
    v_subrev_u32 v241, 128, v241
    v_mfma_f32_16x16x32_bf16 v[176:179], v[48:51], v[64:67], v[176:179]
    v_subrev_u32 v242, 128, v242
    v_mfma_f32_16x16x32_bf16 v[180:183], v[48:51], v[68:71], v[180:183]
    v_subrev_u32 v243, 128, v243
    v_mfma_f32_16x16x32_bf16 v[184:187], v[48:51], v[72:75], v[184:187]
    v_subrev_u32 v244, 64, v244
    v_mfma_f32_16x16x32_bf16 v[188:191], v[48:51], v[76:79], v[188:191]
    v_mfma_f32_16x16x32_bf16 v[180:183], v[52:55], v[64:67], v[180:183]
    v_mfma_f32_16x16x32_bf16 v[184:187], v[52:55], v[68:71], v[184:187]
    v_mfma_f32_16x16x32_bf16 v[188:191], v[52:55], v[72:75], v[188:191]
    v_mfma_f32_16x16x32_bf16 v[184:187], v[56:59], v[64:67], v[184:187]
    v_mfma_f32_16x16x32_bf16 v[188:191], v[56:59], v[68:71], v[188:191]
    v_mfma_f32_16x16x32_bf16 v[188:191], v[60:63], v[64:67], v[188:191]
    s_waitcnt lgkmcnt(0)
    v_mfma_f32_16x16x32_bf16 v[160:163], v[96:99], v[128:131], v[160:163]
    ds_read2_b32 v[32:33], v240 offset0:132 offset1:133
    v_mfma_f32_16x16x32_bf16 v[164:167], v[96:99], v[132:135], v[164:167]
    ds_read2_b32 v[34:35], v240 offset0:134 offset1:135
    v_mfma_f32_16x16x32_bf16 v[168:171], v[96:99], v[136:139], v[168:171]
    ds_read_b128 v[64:67], v244 offset:2304
    v_mfma_f32_16x16x32_bf16 v[172:175], v[96:99], v[140:143], v[172:175]
    ds_read2_b32 v[36:37], v240 offset0:4 offset1:5
    v_mfma_f32_16x16x32_bf16 v[176:179], v[96:99], v[144:147], v[176:179]
    ds_read2_b32 v[38:39], v240 offset0:6 offset1:7
    v_mfma_f32_16x16x32_bf16 v[180:183], v[96:99], v[148:151], v[180:183]
    ds_read_b128 v[68:71], v244 offset:2560
    v_mfma_f32_16x16x32_bf16 v[184:187], v[96:99], v[152:155], v[184:187]
    ds_read2_b32 v[40:41], v241 offset0:132 offset1:133
    v_mfma_f32_16x16x32_bf16 v[188:191], v[96:99], v[156:159], v[188:191]
    ds_read2_b32 v[42:43], v241 offset0:134 offset1:135
    v_mfma_f32_16x16x32_bf16 v[164:167], v[100:103], v[128:131], v[164:167]
    ds_read_b128 v[72:75], v244 offset:2816
    v_mfma_f32_16x16x32_bf16 v[168:171], v[100:103], v[132:135], v[168:171]
    ds_read2_b32 v[44:45], v241 offset0:4 offset1:5
    v_mfma_f32_16x16x32_bf16 v[172:175], v[100:103], v[136:139], v[172:175]
    ds_read2_b32 v[46:47], v241 offset0:6 offset1:7
    v_mfma_f32_16x16x32_bf16 v[176:179], v[100:103], v[140:143], v[176:179]
    ds_read_b128 v[76:79], v244 offset:3072
    v_mfma_f32_16x16x32_bf16 v[180:183], v[100:103], v[144:147], v[180:183]
    ds_read2_b32 v[48:49], v242 offset0:132 offset1:133
    v_mfma_f32_16x16x32_bf16 v[184:187], v[100:103], v[148:151], v[184:187]
    ds_read2_b32 v[50:51], v242 offset0:134 offset1:135
    v_mfma_f32_16x16x32_bf16 v[188:191], v[100:103], v[152:155], v[188:191]
    ds_read_b128 v[80:83], v244 offset:3328
    v_mfma_f32_16x16x32_bf16 v[168:171], v[104:107], v[128:131], v[168:171]
    ds_read2_b32 v[52:53], v242 offset0:4 offset1:5
    v_mfma_f32_16x16x32_bf16 v[172:175], v[104:107], v[132:135], v[172:175]
    ds_read2_b32 v[54:55], v242 offset0:6 offset1:7
    v_mfma_f32_16x16x32_bf16 v[176:179], v[104:107], v[136:139], v[176:179]
    ds_read_b128 v[84:87], v244 offset:3584
    v_mfma_f32_16x16x32_bf16 v[180:183], v[104:107], v[140:143], v[180:183]
    ds_read2_b32 v[56:57], v243 offset0:132 offset1:133
    v_mfma_f32_16x16x32_bf16 v[184:187], v[104:107], v[144:147], v[184:187]
    ds_read2_b32 v[58:59], v243 offset0:134 offset1:135
    v_mfma_f32_16x16x32_bf16 v[188:191], v[104:107], v[148:151], v[188:191]
    ds_read_b128 v[88:91], v244 offset:3840
    v_mfma_f32_16x16x32_bf16 v[172:175], v[108:111], v[128:131], v[172:175]
    ds_read2_b32 v[60:61], v243 offset0:4 offset1:5
    v_mfma_f32_16x16x32_bf16 v[176:179], v[108:111], v[132:135], v[176:179]
    ds_read2_b32 v[62:63], v243 offset0:6 offset1:7
    v_mfma_f32_16x16x32_bf16 v[180:183], v[108:111], v[136:139], v[180:183]
    ds_read_b128 v[92:95], v244 offset:4096
    v_mfma_f32_16x16x32_bf16 v[184:187], v[108:111], v[140:143], v[184:187]
    s_add_u32 s29, s29, 1
    v_mfma_f32_16x16x32_bf16 v[188:191], v[108:111], v[144:147], v[188:191]
    s_cmp_lt_u32 s29, 4
    v_mfma_f32_16x16x32_bf16 v[176:179], v[112:115], v[128:131], v[176:179]
    v_mfma_f32_16x16x32_bf16 v[180:183], v[112:115], v[132:135], v[180:183]
    v_mfma_f32_16x16x32_bf16 v[184:187], v[112:115], v[136:139], v[184:187]
    v_mfma_f32_16x16x32_bf16 v[188:191], v[112:115], v[140:143], v[188:191]
    v_mfma_f32_16x16x32_bf16 v[180:183], v[116:119], v[128:131], v[180:183]
    v_mfma_f32_16x16x32_bf16 v[184:187], v[116:119], v[132:135], v[184:187]
    v_mfma_f32_16x16x32_bf16 v[188:191], v[116:119], v[136:139], v[188:191]
    v_mfma_f32_16x16x32_bf16 v[184:187], v[120:123], v[128:131], v[184:187]
    v_mfma_f32_16x16x32_bf16 v[188:191], v[120:123], v[132:135], v[188:191]
    v_mfma_f32_16x16x32_bf16 v[188:191], v[124:127], v[128:131], v[188:191]
    s_cbranch_scc1 L_cloop
    s_load_dwordx16 s[4:19], s[26:27], s66 glc
    ds_read_b64 v[136:137], v245 offset:3584
    ds_read_b64 v[138:139], v245 offset:3072
    ds_read_b64 v[140:141], v245 offset:2560
    ds_read_b64 v[142:143], v245 offset:2048
    ds_read_b64 v[144:145], v245 offset:1536
    ds_read_b64 v[146:147], v245 offset:1024
    ds_read_b64 v[148:149], v245 offset:512
    ds_read_b64 v[150:151], v245 offset:0
    s_mov_b64 exec, 1
    ds_add_u32 v15, v14 offset:36
    s_mov_b64 exec, -1
    s_setprio 1
    s_waitcnt lgkmcnt(0)
    s_mov_b32 s62, 0
    s_cmp_eq_u64 s[4:5], s[72:73]
    s_cselect_b32 s60, 0x1, 0
    s_or_b32 s62, s62, s60
    s_cmp_eq_u64 s[6:7], s[72:73]
    s_cselect_b32 s60, 0x4, 0
    s_or_b32 s62, s62, s60
    s_cmp_eq_u64 s[8:9], s[72:73]
    s_cselect_b32 s60, 0x10, 0
    s_or_b32 s62, s62, s60
    s_cmp_eq_u64 s[10:11], s[72:73]
    s_cselect_b32 s60, 0x40, 0
    s_or_b32 s62, s62, s60
    s_cmp_eq_u64 s[12:13], s[72:73]
    s_cselect_b32 s60, 0x100, 0
    s_or_b32 s62, s62, s60
    s_cmp_eq_u64 s[14:15], s[72:73]
    s_cselect_b32 s60, 0x400, 0
    s_or_b32 s62, s62, s60
    s_cmp_eq_u64 s[16:17], s[72:73]
    s_cselect_b32 s60, 0x1000, 0
    s_or_b32 s62, s62, s60
    s_cmp_eq_u64 s[18:19], s[72:73]
    s_cselect_b32 s60, 0x4000, 0
    s_or_b32 s62, s62, s60
    s_mov_b32 s64, s62
    s_lshl_b32 s60, s62, s33
    v_mov_b32 v3, s60
    s_mov_b64 exec, 1
    ds_or_b32 v19, v3 offset:64
    s_mov_b64 exec, -1
    s_load_dwordx16 s[4:19], s[26:27], s66 glc
    v_and_b32 v152, s70, v137
    v_lshlrev_b32 v153, 16, v137
    v_and_b32 v154, s70, v136
    v_lshlrev_b32 v155, 16, v136
    v_fmac_f32 v160, s71, v152
    v_fmac_f32 v161, s71, v153
    v_fmac_f32 v162, s71, v154
    v_fmac_f32 v163, s71, v155
    v_cvt_pk_bf16_f32 v136, v160, v161
    v_cvt_pk_bf16_f32 v137, v162, v163
    v_and_b32 v152, s70, v139
    v_lshlrev_b32 v153, 16, v139
    v_and_b32 v154, s70, v138
    v_lshlrev_b32 v155, 16, v138
    v_fmac_f32 v164, s71, v152
    v_fmac_f32 v165, s71, v153
    v_fmac_f32 v166, s71, v154
    v_fmac_f32 v167, s71, v155
    v_cvt_pk_bf16_f32 v138, v164, v165
    v_cvt_pk_bf16_f32 v139, v166, v167
    v_and_b32 v152, s70, v141
    v_lshlrev_b32 v153, 16, v141
    v_and_b32 v154, s70, v140
    v_lshlrev_b32 v155, 16, v140
    v_fmac_f32 v168, s71, v152
    v_fmac_f32 v169, s71, v153
    v_fmac_f32 v170, s71, v154
    v_fmac_f32 v171, s71, v155
    v_cvt_pk_bf16_f32 v140, v168, v169
    v_cvt_pk_bf16_f32 v141, v170, v171
    v_and_b32 v152, s70, v143
    v_lshlrev_b32 v153, 16, v143
    v_and_b32 v154, s70, v142
    v_lshlrev_b32 v155, 16, v142
    v_fmac_f32 v172, s71, v152
    v_fmac_f32 v173, s71, v153
    v_fmac_f32 v174, s71, v154
    v_fmac_f32 v175, s71, v155
    v_cvt_pk_bf16_f32 v142, v172, v173
    v_cvt_pk_bf16_f32 v143, v174, v175
    v_and_b32 v152, s70, v145
    v_lshlrev_b32 v153, 16, v145
    v_and_b32 v154, s70, v144
    v_lshlrev_b32 v155, 16, v144
    v_fmac_f32 v176, s71, v152
    v_fmac_f32 v177, s71, v153
    v_fmac_f32 v178, s71, v154
    v_fmac_f32 v179, s71, v155
    v_cvt_pk_bf16_f32 v144, v176, v177
    v_cvt_pk_bf16_f32 v145, v178, v179
    v_and_b32 v152, s70, v147
    v_lshlrev_b32 v153, 16, v147
    v_and_b32 v154, s70, v146
    v_lshlrev_b32 v155, 16, v146
    v_fmac_f32 v180, s71, v152
    v_fmac_f32 v181, s71, v153
    v_fmac_f32 v182, s71, v154
    v_fmac_f32 v183, s71, v155
    v_cvt_pk_bf16_f32 v146, v180, v181
    v_cvt_pk_bf16_f32 v147, v182, v183
    v_and_b32 v152, s70, v149
    v_lshlrev_b32 v153, 16, v149
    v_and_b32 v154, s70, v148
    v_lshlrev_b32 v155, 16, v148
    v_fmac_f32 v184, s71, v152
    v_fmac_f32 v185, s71, v153
    v_fmac_f32 v186, s71, v154
    v_fmac_f32 v187, s71, v155
    v_cvt_pk_bf16_f32 v148, v184, v185
    v_cvt_pk_bf16_f32 v149, v186, v187
    v_and_b32 v152, s70, v151
    v_lshlrev_b32 v153, 16, v151
    v_and_b32 v154, s70, v150
    v_lshlrev_b32 v155, 16, v150
    v_fmac_f32 v188, s71, v152
    v_fmac_f32 v189, s71, v153
    v_fmac_f32 v190, s71, v154
    v_fmac_f32 v191, s71, v155
    v_cvt_pk_bf16_f32 v150, v188, v189
    v_cvt_pk_bf16_f32 v151, v190, v191
    s_nop 1
    v_permlane16_swap_b32 v136, v138
    v_permlane16_swap_b32 v137, v139
    v_permlane16_swap_b32 v140, v142
    v_permlane16_swap_b32 v141, v143
    v_permlane16_swap_b32 v144, v146
    v_permlane16_swap_b32 v145, v147
    v_permlane16_swap_b32 v148, v150
    v_permlane16_swap_b32 v149, v151
    s_waitcnt vmcnt(4)
    buffer_store_dwordx4 v[136:139], v246, s[52:55], 0 offen offset:0 sc1
    buffer_store_dwordx4 v[140:143], v246, s[52:55], 0 offen offset:1024 sc1
    buffer_store_dwordx4 v[144:147], v246, s[52:55], 0 offen offset:2048 sc1
    buffer_store_dwordx4 v[148:151], v246, s[52:55], 0 offen offset:3072 sc1
    s_waitcnt lgkmcnt(0)
    s_mov_b32 s62, 0
    s_cmp_eq_u64 s[4:5], s[72:73]
    s_cselect_b32 s60, 0x1, 0
    s_or_b32 s62, s62, s60
    s_cmp_eq_u64 s[6:7], s[72:73]
    s_cselect_b32 s60, 0x4, 0
    s_or_b32 s62, s62, s60
    s_cmp_eq_u64 s[8:9], s[72:73]
    s_cselect_b32 s60, 0x10, 0
    s_or_b32 s62, s62, s60
    s_cmp_eq_u64 s[10:11], s[72:73]
    s_cselect_b32 s60, 0x40, 0
    s_or_b32 s62, s62, s60
    s_cmp_eq_u64 s[12:13], s[72:73]
    s_cselect_b32 s60, 0x100, 0
    s_or_b32 s62, s62, s60
    s_cmp_eq_u64 s[14:15], s[72:73]
    s_cselect_b32 s60, 0x400, 0
    s_or_b32 s62, s62, s60
    s_cmp_eq_u64 s[16:17], s[72:73]
    s_cselect_b32 s60, 0x1000, 0
    s_or_b32 s62, s62, s60
    s_cmp_eq_u64 s[18:19], s[72:73]
    s_cselect_b32 s60, 0x4000, 0
    s_or_b32 s62, s62, s60
    s_mov_b32 s64, s62
    s_lshl_b32 s60, s62, s33
    v_mov_b32 v3, s60
    s_mov_b64 exec, 1
    ds_or_b32 v19, v3 offset:64
    s_mov_b64 exec, -1
    s_mov_b32 s60, 0
L_cdspin:
    ds_read_b32 v3, v15 offset:36
    s_add_u32 s60, s60, 1
    s_waitcnt lgkmcnt(0)
    v_readfirstlane_b32 s61, v3
    s_cmp_gt_u32 s60, 0x40000
    s_cbranch_scc1 L_cdspin_done
    s_cmp_ge_u32 s61, 4
    s_cbranch_scc1 L_cdspin_done
    s_sleep 0
    s_branch L_cdspin
L_cdspin_done:
    s_load_dwordx16 s[4:19], s[26:27], s66 glc
    s_lshl_b32 s60, s31, 13
    v_add_u32 v18, s60, v5
    ds_write_b128 v18, v[192:195] offset:0
    ds_write_b128 v18, v[196:199] offset:1024
    ds_write_b128 v18, v[200:203] offset:2048
    ds_write_b128 v18, v[204:207] offset:3072
    ds_write_b128 v18, v[208:211] offset:4096
    ds_write_b128 v18, v[212:215] offset:5120
    ds_write_b128 v18, v[216:219] offset:6144
    ds_write_b128 v18, v[220:223] offset:7168
    s_lshl_b32 s60, s3, 1
    s_lshl_b32 s60, 0x1000000, s60
    v_mov_b32 v3, s60
    s_mov_b64 exec, 1
    ds_or_b32 v15, v3 offset:60
    s_mov_b64 exec, -1
    s_lshl_b32 s65, s36, 18
    s_lshl_b32 s60, s69, 1
    s_add_u32 s65, s65, s60
    s_add_u32 s65, s65, 0x0
    v_lshrrev_b32 v18, 2, v4
    v_lshlrev_b32 v18, 12, v18
    v_lshl_add_u32 v18, v30, 4, v18
    v_lshl_add_u32 v20, v28, 3, v29
    v_lshlrev_b32 v20, 6, v20
    v_lshl_add_u32 v20, v30, 3, v20
    v_add_u32 v20, s68, v20
    s_movk_i32 s60, 144
    v_mul_u32_u24 v24, s60, v31
    v_lshl_add_u32 v24, v28, 4, v24
    v_add_u32 v24, s68, v24
    v_mul_u32_u24 v25, s60, v1
    v_add3_u32 v25, v25, v27, s68
    s_mov_b32 m0, s68
    s_waitcnt lgkmcnt(0)
    s_mov_b32 s62, 0
    s_cmp_eq_u64 s[4:5], s[72:73]
    s_cselect_b32 s60, 0x1, 0
    s_or_b32 s62, s62, s60
    s_cmp_eq_u64 s[6:7], s[72:73]
    s_cselect_b32 s60, 0x4, 0
    s_or_b32 s62, s62, s60
    s_cmp_eq_u64 s[8:9], s[72:73]
    s_cselect_b32 s60, 0x10, 0
    s_or_b32 s62, s62, s60
    s_cmp_eq_u64 s[10:11], s[72:73]
    s_cselect_b32 s60, 0x40, 0
    s_or_b32 s62, s62, s60
    s_cmp_eq_u64 s[12:13], s[72:73]
    s_cselect_b32 s60, 0x100, 0
    s_or_b32 s62, s62, s60
    s_cmp_eq_u64 s[14:15], s[72:73]
    s_cselect_b32 s60, 0x400, 0
    s_or_b32 s62, s62, s60
    s_cmp_eq_u64 s[16:17], s[72:73]
    s_cselect_b32 s60, 0x1000, 0
    s_or_b32 s62, s62, s60
    s_cmp_eq_u64 s[18:19], s[72:73]
    s_cselect_b32 s60, 0x4000, 0
    s_or_b32 s62, s62, s60
    s_mov_b32 s64, s62
    s_lshl_b32 s60, s62, s33
    v_mov_b32 v3, s60
    s_mov_b64 exec, 1
    ds_or_b32 v19, v3 offset:64
    s_mov_b64 exec, -1
    s_waitcnt vmcnt(0)
    s_mov_b64 exec, 1
    ds_add_rtn_u32 v3, v15, v14 offset:32
    s_mov_b64 exec, -1
    s_waitcnt lgkmcnt(0)
    v_readfirstlane_b32 s60, v3
    s_nop 3
    s_cmp_eq_u32 s60, 3
    s_cbranch_scc0 L_yfl
    s_mov_b64 exec, -1
    buffer_store_dword v7, v255, s[48:51], s32 offen sc1
    s_mov_b64 exec, -1
L_yfl:
    s_setprio 0
    v_lshlrev_b32 v96, 16, v224
    v_and_b32 v97, s70, v224
    v_lshlrev_b32 v98, 16, v225
    v_and_b32 v99, s70, v225
    v_lshlrev_b32 v100, 16, v226
    v_and_b32 v101, s70, v226
    v_lshlrev_b32 v102, 16, v227
    v_and_b32 v103, s70, v227
    v_lshlrev_b32 v104, 16, v228
    v_and_b32 v105, s70, v228
    v_lshlrev_b32 v106, 16, v229
    v_and_b32 v107, s70, v229
    v_lshlrev_b32 v108, 16, v230
    v_and_b32 v109, s70, v230
    v_lshlrev_b32 v110, 16, v231
    v_and_b32 v111, s70, v231
    v_lshlrev_b32 v112, 16, v232
    v_and_b32 v113, s70, v232
    v_lshlrev_b32 v114, 16, v233
    v_and_b32 v115, s70, v233
    v_lshlrev_b32 v116, 16, v234
    v_and_b32 v117, s70, v234
    v_lshlrev_b32 v118, 16, v235
    v_and_b32 v119, s70, v235
    v_lshlrev_b32 v120, 16, v236
    v_and_b32 v121, s70, v236
    v_lshlrev_b32 v122, 16, v237
    v_and_b32 v123, s70, v237
    v_lshlrev_b32 v124, 16, v238
    v_and_b32 v125, s70, v238
    v_lshlrev_b32 v126, 16, v239
    v_and_b32 v127, s70, v239
    s_mov_b32 s61, 0
L_yloop:
    s_cmp_eq_u32 s64, 0x5555
    s_cbranch_scc1 L_ynop
    s_load_dwordx16 s[4:19], s[26:27], s66 glc
    s_waitcnt lgkmcnt(0)
    s_mov_b32 s62, 0
    s_cmp_eq_u64 s[4:5], s[72:73]
    s_cselect_b32 s60, 0x1, 0
    s_or_b32 s62, s62, s60
    s_cmp_eq_u64 s[6:7], s[72:73]
    s_cselect_b32 s60, 0x4, 0
    s_or_b32 s62, s62, s60
    s_cmp_eq_u64 s[8:9], s[72:73]
    s_cselect_b32 s60, 0x10, 0
    s_or_b32 s62, s62, s60
    s_cmp_eq_u64 s[10:11], s[72:73]
    s_cselect_b32 s60, 0x40, 0
    s_or_b32 s62, s62, s60
    s_cmp_eq_u64 s[12:13], s[72:73]
    s_cselect_b32 s60, 0x100, 0
    s_or_b32 s62, s62, s60
    s_cmp_eq_u64 s[14:15], s[72:73]
    s_cselect_b32 s60, 0x400, 0
    s_or_b32 s62, s62, s60
    s_cmp_eq_u64 s[16:17], s[72:73]
    s_cselect_b32 s60, 0x1000, 0
    s_or_b32 s62, s62, s60
    s_cmp_eq_u64 s[18:19], s[72:73]
    s_cselect_b32 s60, 0x4000, 0
    s_or_b32 s62, s62, s60
    s_mov_b32 s64, s62
    s_lshl_b32 s60, s62, s33
    v_mov_b32 v3, s60
    s_mov_b64 exec, 1
    ds_or_b32 v19, v3 offset:64
    s_mov_b64 exec, -1
L_ynop:
    s_load_dwordx16 s[4:19], s[26:27], s67 glc
    s_add_u32 s61, s61, 1
    s_cmp_gt_u32 s61, 0x8000
    s_cbranch_scc1 L_ydone
    s_waitcnt lgkmcnt(0)
    s_cmp_eq_u64 s[4:5], s[72:73]
    s_cbranch_scc0 L_yloop
    s_cmp_eq_u64 s[6:7], s[72:73]
    s_cbranch_scc0 L_yloop
    s_cmp_eq_u64 s[8:9], s[72:73]
    s_cbranch_scc0 L_yloop
    s_cmp_eq_u64 s[10:11], s[72:73]
    s_cbranch_scc0 L_yloop
    s_cmp_eq_u64 s[12:13], s[72:73]
    s_cbranch_scc0 L_yloop
    s_cmp_eq_u64 s[14:15], s[72:73]
    s_cbranch_scc0 L_yloop
    s_cmp_eq_u64 s[16:17], s[72:73]
    s_cbranch_scc0 L_yloop
    s_cmp_eq_u64 s[18:19], s[72:73]
    s_cbranch_scc0 L_yloop
L_ydone:
    s_waitcnt lgkmcnt(0)
    buffer_load_dwordx4 v18, s[48:51], s65 offen offset:0 sc1 lds
    s_add_u32 s65, s65, 64512
    buffer_load_dwordx4 v18, s[48:51], s65 offen offset:1024 sc1 lds
    s_add_u32 s65, s65, 64512
    buffer_load_dwordx4 v18, s[48:51], s65 offen offset:2048 sc1 lds
    s_add_u32 s65, s65, 64512
    buffer_load_dwordx4 v18, s[48:51], s65 offen offset:3072 sc1 lds
    s_waitcnt vmcnt(0)
    ds_read_b64_tr_b16 v[48:49], v20 offset:0
    ds_read_b64_tr_b16 v[50:51], v20 offset:256
    ds_read_b64_tr_b16 v[52:53], v20 offset:2048
    ds_read_b64_tr_b16 v[54:55], v20 offset:2304
    ds_read_b64_tr_b16 v[56:57], v20 offset:32
    ds_read_b64_tr_b16 v[58:59], v20 offset:288
    ds_read_b64_tr_b16 v[60:61], v20 offset:2080
    ds_read_b64_tr_b16 v[62:63], v20 offset:2336
    s_waitcnt lgkmcnt(0)
    ds_write_b128 v24, v[48:51] offset:0
    ds_write_b128 v24, v[52:55] offset:64
    ds_write_b128 v24, v[56:59] offset:2304
    ds_write_b128 v24, v[60:63] offset:2368
    ds_read_b128 v[80:83], v25 offset:0
    ds_read_b128 v[84:87], v25 offset:1152
    ds_read_b128 v[88:91], v25 offset:2304
    ds_read_b128 v[92:95], v25 offset:3456
    s_waitcnt lgkmcnt(3)
    v_lshlrev_b32 v64, 16, v80
    v_and_b32 v65, s70, v80
    v_lshlrev_b32 v66, 16, v81
    v_and_b32 v67, s70, v81
    v_lshlrev_b32 v68, 16, v82
    v_and_b32 v69, s70, v82
    v_lshlrev_b32 v70, 16, v83
    v_and_b32 v71, s70, v83
    v_mul_f32 v64, v64, v96
    v_mul_f32 v65, v65, v97
    v_mul_f32 v66, v66, v98
    v_mul_f32 v67, v67, v99
    v_mul_f32 v68, v68, v100
    v_mul_f32 v69, v69, v101
    v_mul_f32 v70, v70, v102
    v_mul_f32 v71, v71, v103
    v_cvt_pk_bf16_f32 v224, v64, v65
    v_cvt_pk_bf16_f32 v225, v66, v67
    v_cvt_pk_bf16_f32 v226, v68, v69
    v_cvt_pk_bf16_f32 v227, v70, v71
    buffer_store_dwordx4 v[224:227], v17, s[44:47], s63 offen sc1
    s_add_u32 s63, s63, 0x8000
    s_waitcnt lgkmcnt(2)
    v_lshlrev_b32 v64, 16, v84
    v_and_b32 v65, s70, v84
    v_lshlrev_b32 v66, 16, v85
    v_and_b32 v67, s70, v85
    v_lshlrev_b32 v68, 16, v86
    v_and_b32 v69, s70, v86
    v_lshlrev_b32 v70, 16, v87
    v_and_b32 v71, s70, v87
    v_mul_f32 v64, v64, v104
    v_mul_f32 v65, v65, v105
    v_mul_f32 v66, v66, v106
    v_mul_f32 v67, v67, v107
    v_mul_f32 v68, v68, v108
    v_mul_f32 v69, v69, v109
    v_mul_f32 v70, v70, v110
    v_mul_f32 v71, v71, v111
    v_cvt_pk_bf16_f32 v228, v64, v65
    v_cvt_pk_bf16_f32 v229, v66, v67
    v_cvt_pk_bf16_f32 v230, v68, v69
    v_cvt_pk_bf16_f32 v231, v70, v71
    buffer_store_dwordx4 v[228:231], v17, s[44:47], s63 offen sc1
    s_add_u32 s63, s63, 0x8000
    s_waitcnt lgkmcnt(1)
    v_lshlrev_b32 v64, 16, v88
    v_and_b32 v65, s70, v88
    v_lshlrev_b32 v66, 16, v89
    v_and_b32 v67, s70, v89
    v_lshlrev_b32 v68, 16, v90
    v_and_b32 v69, s70, v90
    v_lshlrev_b32 v70, 16, v91
    v_and_b32 v71, s70, v91
    v_mul_f32 v64, v64, v112
    v_mul_f32 v65, v65, v113
    v_mul_f32 v66, v66, v114
    v_mul_f32 v67, v67, v115
    v_mul_f32 v68, v68, v116
    v_mul_f32 v69, v69, v117
    v_mul_f32 v70, v70, v118
    v_mul_f32 v71, v71, v119
    v_cvt_pk_bf16_f32 v232, v64, v65
    v_cvt_pk_bf16_f32 v233, v66, v67
    v_cvt_pk_bf16_f32 v234, v68, v69
    v_cvt_pk_bf16_f32 v235, v70, v71
    buffer_store_dwordx4 v[232:235], v17, s[44:47], s63 offen sc1
    s_add_u32 s63, s63, 0x8000
    s_waitcnt lgkmcnt(0)
    v_lshlrev_b32 v64, 16, v92
    v_and_b32 v65, s70, v92
    v_lshlrev_b32 v66, 16, v93
    v_and_b32 v67, s70, v93
    v_lshlrev_b32 v68, 16, v94
    v_and_b32 v69, s70, v94
    v_lshlrev_b32 v70, 16, v95
    v_and_b32 v71, s70, v95
    v_mul_f32 v64, v64, v120
    v_mul_f32 v65, v65, v121
    v_mul_f32 v66, v66, v122
    v_mul_f32 v67, v67, v123
    v_mul_f32 v68, v68, v124
    v_mul_f32 v69, v69, v125
    v_mul_f32 v70, v70, v126
    v_mul_f32 v71, v71, v127
    v_cvt_pk_bf16_f32 v236, v64, v65
    v_cvt_pk_bf16_f32 v237, v66, v67
    v_cvt_pk_bf16_f32 v238, v68, v69
    v_cvt_pk_bf16_f32 v239, v70, v71
    buffer_store_dwordx4 v[236:239], v17, s[44:47], s63 offen sc1
    s_endpgm
L_comp:
    s_and_b32 s34, s28, 3
    s_lshl_b32 s34, s34, 2
    s_and_b32 vcc_lo, s29, 3
    s_add_u32 s34, s34, vcc_lo
    s_lshr_b32 s35, s28, 2
    s_lshl_b32 s35, s35, 3
    s_lshr_b32 vcc_lo, s29, 2
    s_add_u32 s35, s35, vcc_lo
    s_lshl_b32 s39, vcc_lo, 2
    s_and_b32 s36, s29, 15
    s_lshr_b32 s37, s29, 4
    s_lshl_b32 vcc_lo, s28, 1
    s_add_u32 s37, s37, vcc_lo
    s_lshl_b32 s38, s28, 5
    s_add_u32 s38, s38, s29
    s_lshl_b32 s38, s38, 2
    s_mul_i32 s39, s34, 11
    s_lshr_b32 s39, s39, 5
    s_mul_i32 s39, s39, 3
    s_sub_u32 s39, s34, s39
    s_lshl_b32 s45, s37, 18
    s_lshl_b32 s46, s3, 16
    s_add_u32 s45, s45, s46
    s_lshl_b32 s46, s36, 7
    s_add_u32 s45, s45, s46
    v_lshrrev_b32 v2, 4, v4
    v_and_b32 v1, 15, v4
    v_lshlrev_b32 v3, 3, v1
    v_lshl_add_u32 v16, v2, 14, v3
    v_add_u32 v16, s45, v16
    v_subrev_u32 v17, 6144, v16
    s_movk_i32 s57, 4096
    s_movk_i32 s58, 8192
    s_movk_i32 s59, 12288
    s_mov_b32 s62, 0x400000
    s_mov_b32 s63, 0x20000
    s_mov_b32 s66, 0x400000
    s_mov_b32 s67, 0x20000
    s_mov_b32 s70, 8192
    s_mov_b32 s71, 0x20000
    v_lshlrev_b32 v18, 5, v1
    s_lshl_b32 s46, s36, 9
    v_add_u32 v18, s46, v18
    v_sub_u32 v3, 3, v2
    s_lshl_b32 s45, s3, 2
    s_sub_u32 s45, 12, s45
    v_add_u32 v3, s45, v3
    v_and_b32 v6, 7, v4
    v_xor_b32 v3, v3, v6
    v_lshlrev_b32 v3, 4, v3
    v_lshl_add_u32 v3, v1, 10, v3
    v_add_u32 v19, 139776, v3
    s_and_b32 s40, s3, 1
    s_lshr_b32 s41, s3, 1
    v_bfe_u32 v3, v4, 1, 3
    v_xor_b32 v3, v2, v3
    v_lshlrev_b32 v3, 4, v3
    v_lshl_add_u32 v3, v1, 7, v3
    s_lshl_b32 s45, s40, 13
    v_add_u32 v8, s45, v3
    v_xor_b32 v9, 64, v8
    v_bfe_u32 v22, v4, 2, 2
    v_lshl_add_u32 v3, v2, 3, v22
    v_lshlrev_b32 v3, 7, v3
    v_and_b32 v7, 3, v4
    v_lshlrev_b32 v6, 3, v7
    s_lshl_b32 s45, s41, 6
    v_add_u32 v6, s45, v6
    v_bfe_u32 v7, v4, 3, 1
    v_lshlrev_b32 v7, 6, v7
    v_xor_b32 v6, v6, v7
    v_bfe_u32 v23, v4, 4, 1
    v_lshlrev_b32 v7, 5, v23
    v_xor_b32 v6, v6, v7
    v_add_u32 v3, v3, v6
    v_add_u32 v12, 0x4000, v3
    v_xor_b32 v13, 32, v12
    v_mov_b32 v14, v12
    v_mov_b32 v15, v13
    v_mov_b32 v10, v8
    v_mov_b32 v11, v9
    v_lshlrev_b32 v254, 7, v4
    v_mov_b32 v20, 162816
    v_mov_b32 v232, 1
    v_mov_b32 v233, 0
    v_lshlrev_b32 v6, 2, v4
    v_add_u32 v6, 162816, v6
    ds_write_b32 v6, v233
    s_lshl_b32 s45, s3, 2
    v_add_u32 v21, s45, v20
    s_mov_b32 s53, 1
    s_mov_b32 s56, 0xffff0000
    s_waitcnt lgkmcnt(0)
    s_nop 0
    s_mov_b64 s[60:61], s[12:13]
    s_mov_b64 s[64:65], s[14:15]
    s_mov_b64 s[68:69], s[16:17]
    s_barrier
    buffer_load_dwordx2 v[200:201], v17, s[60:63], 0 offen offset:0
    buffer_load_dwordx2 v[202:203], v17, s[60:63], 0 offen offset:2048
    buffer_load_dwordx2 v[204:205], v17, s[60:63], s57 offen offset:0
    buffer_load_dwordx2 v[206:207], v16, s[60:63], 0 offen offset:0
    buffer_load_dwordx2 v[208:209], v16, s[60:63], 0 offen offset:2048
    buffer_load_dwordx2 v[210:211], v16, s[60:63], s57 offen offset:0
    buffer_load_dwordx2 v[212:213], v16, s[60:63], s57 offen offset:2048
    buffer_load_dwordx2 v[214:215], v16, s[60:63], s58 offen offset:0
    buffer_load_dwordx2 v[216:217], v16, s[60:63], s58 offen offset:2048
    buffer_load_dwordx2 v[218:219], v16, s[60:63], s59 offen offset:0
    buffer_load_dwordx2 v[220:221], v16, s[60:63], s59 offen offset:2048
    buffer_load_dwordx4 v[242:245], v18, s[68:71], 0 offen offset:0
    buffer_load_dwordx4 v[246:249], v18, s[68:71], 0 offen offset:16
    buffer_load_dwordx2 v[222:223], v16, s[64:67], 0 offen offset:0
    buffer_load_dwordx2 v[224:225], v16, s[64:67], 0 offen offset:2048
    buffer_load_dwordx2 v[226:227], v16, s[64:67], s57 offen offset:0
    buffer_load_dwordx2 v[228:229], v16, s[64:67], s57 offen offset:2048
    buffer_load_dwordx2 v[230:231], v16, s[64:67], s58 offen offset:0
    buffer_load_dwordx2 v[236:237], v16, s[64:67], s58 offen offset:2048
    buffer_load_dwordx2 v[238:239], v16, s[64:67], s59 offen offset:0
    buffer_load_dwordx2 v[240:241], v16, s[64:67], s59 offen offset:2048
    s_barrier
    ds_read_b128 v[24:27], v10 offset:0
    ds_read_b64_tr_b16 v[40:41], v14 offset:0
    ds_read_b64_tr_b16 v[42:43], v14 offset:512
    ds_read_b64_tr_b16 v[44:45], v15 offset:0
    ds_read_b64_tr_b16 v[46:47], v15 offset:512
    ds_read_b64_tr_b16 v[48:49], v14 offset:8192
    ds_read_b64_tr_b16 v[50:51], v14 offset:8704
    ds_read_b64_tr_b16 v[52:53], v15 offset:8192
    ds_read_b64_tr_b16 v[54:55], v15 offset:8704
    ds_read_b64_tr_b16 v[56:57], v14 offset:16384
    ds_read_b64_tr_b16 v[58:59], v14 offset:16896
    ds_read_b64_tr_b16 v[60:61], v15 offset:16384
    ds_read_b64_tr_b16 v[62:63], v15 offset:16896
    ds_read_b128 v[28:31], v10 offset:2048
    ds_read_b128 v[32:35], v10 offset:4096
    ds_read_b128 v[36:39], v10 offset:6144
    s_mov_b32 s52, 40960
    v_add_u32 v10, s52, v8
    s_waitcnt lgkmcnt(0)
    v_mfma_f32_16x16x32_bf16 v[136:139], v[24:27], v[48:51], 0
    ds_read_b128 v[64:67], v11 offset:0
    v_mfma_f32_16x16x32_bf16 v[152:155], v[24:27], v[52:55], 0
    ds_read_b64_tr_b16 v[80:81], v14 offset:4096
    v_mfma_f32_16x16x32_bf16 v[168:171], v[24:27], v[56:59], 0
    ds_read_b64_tr_b16 v[82:83], v14 offset:4608
    v_mfma_f32_16x16x32_bf16 v[184:187], v[24:27], v[60:63], 0
    ds_read_b64_tr_b16 v[84:85], v15 offset:4096
    v_mfma_f32_16x16x32_bf16 v[104:107], v[40:43], v[24:27], 0
    ds_read_b64_tr_b16 v[86:87], v15 offset:4608
    v_mfma_f32_16x16x32_bf16 v[108:111], v[44:47], v[24:27], 0
    ds_read_b64_tr_b16 v[88:89], v14 offset:12288
    v_mfma_f32_16x16x32_bf16 v[140:143], v[28:31], v[48:51], 0
    ds_read_b64_tr_b16 v[90:91], v14 offset:12800
    v_mfma_f32_16x16x32_bf16 v[156:159], v[28:31], v[52:55], 0
    ds_read_b64_tr_b16 v[92:93], v15 offset:12288
    v_mfma_f32_16x16x32_bf16 v[172:175], v[28:31], v[56:59], 0
    ds_read_b64_tr_b16 v[94:95], v15 offset:12800
    v_mfma_f32_16x16x32_bf16 v[188:191], v[28:31], v[60:63], 0
    ds_read_b64_tr_b16 v[96:97], v14 offset:20480
    v_mfma_f32_16x16x32_bf16 v[112:115], v[40:43], v[28:31], 0
    ds_read_b64_tr_b16 v[98:99], v14 offset:20992
    v_mfma_f32_16x16x32_bf16 v[116:119], v[44:47], v[28:31], 0
    ds_read_b64_tr_b16 v[100:101], v15 offset:20480
    v_mfma_f32_16x16x32_bf16 v[144:147], v[32:35], v[48:51], 0
    ds_read_b64_tr_b16 v[102:103], v15 offset:20992
    v_mfma_f32_16x16x32_bf16 v[160:163], v[32:35], v[52:55], 0
    ds_read_b128 v[68:71], v11 offset:2048
    v_mfma_f32_16x16x32_bf16 v[176:179], v[32:35], v[56:59], 0
    ds_read_b128 v[72:75], v11 offset:4096
    v_mfma_f32_16x16x32_bf16 v[192:195], v[32:35], v[60:63], 0
    ds_read_b128 v[76:79], v11 offset:6144
    v_mfma_f32_16x16x32_bf16 v[120:123], v[40:43], v[32:35], 0
    v_add_u32 v11, s52, v9
    v_mfma_f32_16x16x32_bf16 v[124:127], v[44:47], v[32:35], 0
    v_add_u32 v14, s52, v12
    v_mfma_f32_16x16x32_bf16 v[148:151], v[36:39], v[48:51], 0
    v_add_u32 v15, s52, v13
    v_mfma_f32_16x16x32_bf16 v[164:167], v[36:39], v[52:55], 0
    v_mfma_f32_16x16x32_bf16 v[180:183], v[36:39], v[56:59], 0
    v_mfma_f32_16x16x32_bf16 v[196:199], v[36:39], v[60:63], 0
    v_mfma_f32_16x16x32_bf16 v[128:131], v[40:43], v[36:39], 0
    v_mfma_f32_16x16x32_bf16 v[132:135], v[44:47], v[36:39], 0
    s_waitcnt lgkmcnt(0)
    v_mfma_f32_16x16x32_bf16 v[136:139], v[64:67], v[88:91], v[136:139]
    s_mov_b32 s60, s26
    v_mfma_f32_16x16x32_bf16 v[152:155], v[64:67], v[92:95], v[152:155]
    s_mov_b32 s61, s27
    v_mfma_f32_16x16x32_bf16 v[168:171], v[64:67], v[96:99], v[168:171]
    s_mov_b32 s62, 0x2000000
    v_mfma_f32_16x16x32_bf16 v[184:187], v[64:67], v[100:103], v[184:187]
    s_mov_b32 s63, 0x20000
    v_mfma_f32_16x16x32_bf16 v[104:107], v[80:83], v[64:67], v[104:107]
    s_mov_b32 s68, s22
    v_mfma_f32_16x16x32_bf16 v[108:111], v[84:87], v[64:67], v[108:111]
    s_mov_b32 s69, s23
    v_mfma_f32_16x16x32_bf16 v[140:143], v[68:71], v[88:91], v[140:143]
    s_mov_b32 s70, 0x800000
    v_mfma_f32_16x16x32_bf16 v[156:159], v[68:71], v[92:95], v[156:159]
    s_mov_b32 s71, 0x20000
    v_mfma_f32_16x16x32_bf16 v[172:175], v[68:71], v[96:99], v[172:175]
    v_mfma_f32_16x16x32_bf16 v[188:191], v[68:71], v[100:103], v[188:191]
    v_mfma_f32_16x16x32_bf16 v[112:115], v[80:83], v[68:71], v[112:115]
    v_mfma_f32_16x16x32_bf16 v[116:119], v[84:87], v[68:71], v[116:119]
    v_mfma_f32_16x16x32_bf16 v[144:147], v[72:75], v[88:91], v[144:147]
    v_mfma_f32_16x16x32_bf16 v[160:163], v[72:75], v[92:95], v[160:163]
    v_mfma_f32_16x16x32_bf16 v[176:179], v[72:75], v[96:99], v[176:179]
    v_mfma_f32_16x16x32_bf16 v[192:195], v[72:75], v[100:103], v[192:195]
    v_mfma_f32_16x16x32_bf16 v[120:123], v[80:83], v[72:75], v[120:123]
    v_mfma_f32_16x16x32_bf16 v[124:127], v[84:87], v[72:75], v[124:127]
    v_mfma_f32_16x16x32_bf16 v[148:151], v[76:79], v[88:91], v[148:151]
    v_mfma_f32_16x16x32_bf16 v[164:167], v[76:79], v[92:95], v[164:167]
    v_mfma_f32_16x16x32_bf16 v[180:183], v[76:79], v[96:99], v[180:183]
    v_mfma_f32_16x16x32_bf16 v[196:199], v[76:79], v[100:103], v[196:199]
    v_mfma_f32_16x16x32_bf16 v[128:131], v[80:83], v[76:79], v[128:131]
    v_mfma_f32_16x16x32_bf16 v[132:135], v[84:87], v[76:79], v[132:135]
    s_waitcnt vmcnt(10)
    v_lshlrev_b32 v24, 16, v200
    v_and_b32 v25, s56, v200
    v_lshlrev_b32 v26, 16, v201
    v_and_b32 v27, s56, v201
    v_lshlrev_b32 v28, 16, v202
    v_and_b32 v29, s56, v202
    v_lshlrev_b32 v30, 16, v203
    v_and_b32 v31, s56, v203
    v_lshlrev_b32 v32, 16, v204
    v_and_b32 v33, s56, v204
    v_lshlrev_b32 v34, 16, v205
    v_and_b32 v35, s56, v205
    v_lshlrev_b32 v36, 16, v206
    v_and_b32 v37, s56, v206
    v_lshlrev_b32 v38, 16, v207
    v_and_b32 v39, s56, v207
    v_lshlrev_b32 v40, 16, v208
    v_and_b32 v41, s56, v208
    v_lshlrev_b32 v42, 16, v209
    v_and_b32 v43, s56, v209
    v_lshlrev_b32 v44, 16, v210
    v_and_b32 v45, s56, v210
    v_lshlrev_b32 v46, 16, v211
    v_and_b32 v47, s56, v211
    v_lshlrev_b32 v48, 16, v212
    v_and_b32 v49, s56, v212
    v_lshlrev_b32 v50, 16, v213
    v_and_b32 v51, s56, v213
    v_lshlrev_b32 v52, 16, v214
    v_and_b32 v53, s56, v214
    v_lshlrev_b32 v54, 16, v215
    v_and_b32 v55, s56, v215
    v_lshlrev_b32 v56, 16, v216
    v_and_b32 v57, s56, v216
    v_lshlrev_b32 v58, 16, v217
    v_and_b32 v59, s56, v217
    v_lshlrev_b32 v60, 16, v218
    v_and_b32 v61, s56, v218
    v_lshlrev_b32 v62, 16, v219
    v_and_b32 v63, s56, v219
    v_lshlrev_b32 v64, 16, v220
    v_and_b32 v65, s56, v220
    v_lshlrev_b32 v66, 16, v221
    v_and_b32 v67, s56, v221
    s_waitcnt vmcnt(8)
    v_lshlrev_b32 v68, 16, v242
    v_and_b32 v72, s56, v242
    v_lshlrev_b32 v76, 16, v243
    v_and_b32 v80, s56, v243
    v_lshlrev_b32 v69, 16, v244
    v_and_b32 v73, s56, v244
    v_lshlrev_b32 v77, 16, v245
    v_and_b32 v81, s56, v245
    v_lshlrev_b32 v70, 16, v246
    v_and_b32 v74, s56, v246
    v_lshlrev_b32 v78, 16, v247
    v_and_b32 v82, s56, v247
    v_lshlrev_b32 v71, 16, v248
    v_and_b32 v75, s56, v248
    v_lshlrev_b32 v79, 16, v249
    v_and_b32 v83, s56, v249
    v_pk_mul_f32 v[84:85], v[36:37], v[68:69]
    v_pk_mul_f32 v[86:87], v[38:39], v[70:71]
    v_pk_mul_f32 v[88:89], v[40:41], v[68:69]
    v_pk_mul_f32 v[90:91], v[42:43], v[70:71]
    v_pk_fma_f32 v[84:85], v[32:33], v[72:73], v[84:85]
    v_pk_fma_f32 v[86:87], v[34:35], v[74:75], v[86:87]
    v_pk_fma_f32 v[88:89], v[36:37], v[72:73], v[88:89]
    v_pk_fma_f32 v[90:91], v[38:39], v[74:75], v[90:91]
    v_pk_fma_f32 v[84:85], v[28:29], v[76:77], v[84:85]
    v_pk_fma_f32 v[86:87], v[30:31], v[78:79], v[86:87]
    v_pk_fma_f32 v[88:89], v[32:33], v[76:77], v[88:89]
    v_pk_fma_f32 v[90:91], v[34:35], v[78:79], v[90:91]
    v_pk_fma_f32 v[24:25], v[24:25], v[80:81], v[84:85]
    v_pk_fma_f32 v[26:27], v[26:27], v[82:83], v[86:87]
    v_pk_fma_f32 v[28:29], v[28:29], v[80:81], v[88:89]
    v_pk_fma_f32 v[30:31], v[30:31], v[82:83], v[90:91]
    v_pk_mul_f32 v[84:85], v[44:45], v[68:69]
    v_pk_mul_f32 v[86:87], v[46:47], v[70:71]
    v_pk_mul_f32 v[88:89], v[48:49], v[68:69]
    v_pk_mul_f32 v[90:91], v[50:51], v[70:71]
    v_pk_fma_f32 v[84:85], v[40:41], v[72:73], v[84:85]
    v_pk_fma_f32 v[86:87], v[42:43], v[74:75], v[86:87]
    v_pk_fma_f32 v[88:89], v[44:45], v[72:73], v[88:89]
    v_pk_fma_f32 v[90:91], v[46:47], v[74:75], v[90:91]
    v_pk_fma_f32 v[84:85], v[36:37], v[76:77], v[84:85]
    v_pk_fma_f32 v[86:87], v[38:39], v[78:79], v[86:87]
    v_pk_fma_f32 v[88:89], v[40:41], v[76:77], v[88:89]
    v_pk_fma_f32 v[90:91], v[42:43], v[78:79], v[90:91]
    v_pk_fma_f32 v[32:33], v[32:33], v[80:81], v[84:85]
    v_pk_fma_f32 v[34:35], v[34:35], v[82:83], v[86:87]
    v_pk_fma_f32 v[36:37], v[36:37], v[80:81], v[88:89]
    v_pk_fma_f32 v[38:39], v[38:39], v[82:83], v[90:91]
    v_pk_mul_f32 v[84:85], v[52:53], v[68:69]
    v_pk_mul_f32 v[86:87], v[54:55], v[70:71]
    v_pk_mul_f32 v[88:89], v[56:57], v[68:69]
    v_pk_mul_f32 v[90:91], v[58:59], v[70:71]
    v_pk_fma_f32 v[84:85], v[48:49], v[72:73], v[84:85]
    v_pk_fma_f32 v[86:87], v[50:51], v[74:75], v[86:87]
    v_pk_fma_f32 v[88:89], v[52:53], v[72:73], v[88:89]
    v_pk_fma_f32 v[90:91], v[54:55], v[74:75], v[90:91]
    v_pk_fma_f32 v[84:85], v[44:45], v[76:77], v[84:85]
    v_pk_fma_f32 v[86:87], v[46:47], v[78:79], v[86:87]
    v_pk_fma_f32 v[88:89], v[48:49], v[76:77], v[88:89]
    v_pk_fma_f32 v[90:91], v[50:51], v[78:79], v[90:91]
    v_pk_fma_f32 v[40:41], v[40:41], v[80:81], v[84:85]
    v_pk_fma_f32 v[42:43], v[42:43], v[82:83], v[86:87]
    v_pk_fma_f32 v[44:45], v[44:45], v[80:81], v[88:89]
    v_pk_fma_f32 v[46:47], v[46:47], v[82:83], v[90:91]
    v_pk_mul_f32 v[84:85], v[60:61], v[68:69]
    v_pk_mul_f32 v[86:87], v[62:63], v[70:71]
    v_pk_mul_f32 v[88:89], v[64:65], v[68:69]
    v_pk_mul_f32 v[90:91], v[66:67], v[70:71]
    v_pk_fma_f32 v[84:85], v[56:57], v[72:73], v[84:85]
    v_pk_fma_f32 v[86:87], v[58:59], v[74:75], v[86:87]
    v_pk_fma_f32 v[88:89], v[60:61], v[72:73], v[88:89]
    v_pk_fma_f32 v[90:91], v[62:63], v[74:75], v[90:91]
    v_pk_fma_f32 v[84:85], v[52:53], v[76:77], v[84:85]
    v_pk_fma_f32 v[86:87], v[54:55], v[78:79], v[86:87]
    v_pk_fma_f32 v[88:89], v[56:57], v[76:77], v[88:89]
    v_pk_fma_f32 v[90:91], v[58:59], v[78:79], v[90:91]
    v_pk_fma_f32 v[48:49], v[48:49], v[80:81], v[84:85]
    v_pk_fma_f32 v[50:51], v[50:51], v[82:83], v[86:87]
    v_pk_fma_f32 v[52:53], v[52:53], v[80:81], v[88:89]
    v_pk_fma_f32 v[54:55], v[54:55], v[82:83], v[90:91]
    s_waitcnt vmcnt(0)
    global_load_dword v234, v233, s[24:25] sc1
    v_lshlrev_b32 v56, 16, v222
    v_and_b32 v57, s56, v222
    v_lshlrev_b32 v58, 16, v223
    v_and_b32 v59, s56, v223
    v_lshlrev_b32 v60, 16, v224
    v_and_b32 v61, s56, v224
    v_lshlrev_b32 v62, 16, v225
    v_and_b32 v63, s56, v225
    v_lshlrev_b32 v64, 16, v226
    v_and_b32 v65, s56, v226
    v_lshlrev_b32 v66, 16, v227
    v_and_b32 v67, s56, v227
    v_lshlrev_b32 v68, 16, v228
    v_and_b32 v69, s56, v228
    v_lshlrev_b32 v70, 16, v229
    v_and_b32 v71, s56, v229
    v_lshlrev_b32 v72, 16, v230
    v_and_b32 v73, s56, v230
    v_lshlrev_b32 v74, 16, v231
    v_and_b32 v75, s56, v231
    v_lshlrev_b32 v76, 16, v236
    v_and_b32 v77, s56, v236
    v_lshlrev_b32 v78, 16, v237
    v_and_b32 v79, s56, v237
    v_lshlrev_b32 v80, 16, v238
    v_and_b32 v81, s56, v238
    v_lshlrev_b32 v82, 16, v239
    v_and_b32 v83, s56, v239
    v_lshlrev_b32 v84, 16, v240
    v_and_b32 v85, s56, v240
    v_lshlrev_b32 v86, 16, v241
    v_and_b32 v87, s56, v241
    v_pk_mul_f32 v[24:25], v[24:25], v[56:57]
    v_pk_mul_f32 v[28:29], v[28:29], v[60:61]
    v_pk_mul_f32 v[32:33], v[32:33], v[64:65]
    v_pk_mul_f32 v[36:37], v[36:37], v[68:69]
    v_pk_mul_f32 v[40:41], v[40:41], v[72:73]
    v_pk_mul_f32 v[44:45], v[44:45], v[76:77]
    v_pk_mul_f32 v[48:49], v[48:49], v[80:81]
    v_pk_mul_f32 v[52:53], v[52:53], v[84:85]
    v_cvt_pk_bf16_f32 v200, v52, v48
    v_cvt_pk_bf16_f32 v201, v44, v40
    v_cvt_pk_bf16_f32 v202, v36, v32
    v_cvt_pk_bf16_f32 v203, v28, v24
    ds_write_b128 v19, v[200:203] offset:0
    v_cvt_pk_bf16_f32 v204, v53, v49
    v_cvt_pk_bf16_f32 v205, v45, v41
    v_cvt_pk_bf16_f32 v206, v37, v33
    v_cvt_pk_bf16_f32 v207, v29, v25
    ds_write_b128 v19, v[204:207] offset:256
    v_pk_mul_f32 v[26:27], v[26:27], v[58:59]
    v_pk_mul_f32 v[30:31], v[30:31], v[62:63]
    v_pk_mul_f32 v[34:35], v[34:35], v[66:67]
    v_pk_mul_f32 v[38:39], v[38:39], v[70:71]
    v_pk_mul_f32 v[42:43], v[42:43], v[74:75]
    v_pk_mul_f32 v[46:47], v[46:47], v[78:79]
    v_pk_mul_f32 v[50:51], v[50:51], v[82:83]
    v_pk_mul_f32 v[54:55], v[54:55], v[86:87]
    v_cvt_pk_bf16_f32 v208, v54, v50
    v_cvt_pk_bf16_f32 v209, v46, v42
    v_cvt_pk_bf16_f32 v210, v38, v34
    v_cvt_pk_bf16_f32 v211, v30, v26
    ds_write_b128 v19, v[208:211] offset:512
    v_cvt_pk_bf16_f32 v212, v55, v51
    v_cvt_pk_bf16_f32 v213, v47, v43
    v_cvt_pk_bf16_f32 v214, v39, v35
    v_cvt_pk_bf16_f32 v215, v31, v27
    ds_write_b128 v19, v[212:215] offset:768
    s_waitcnt lgkmcnt(0)
    s_barrier
    ds_read_b128 v[24:27], v10 offset:0
    ds_read_b64_tr_b16 v[40:41], v14 offset:0
    ds_read_b64_tr_b16 v[42:43], v14 offset:512
    ds_read_b64_tr_b16 v[44:45], v15 offset:0
    ds_read_b64_tr_b16 v[46:47], v15 offset:512
    ds_read_b64_tr_b16 v[48:49], v14 offset:8192
    ds_read_b64_tr_b16 v[50:51], v14 offset:8704
    ds_read_b64_tr_b16 v[52:53], v15 offset:8192
    ds_read_b64_tr_b16 v[54:55], v15 offset:8704
    ds_read_b64_tr_b16 v[56:57], v14 offset:16384
    ds_read_b64_tr_b16 v[58:59], v14 offset:16896
    ds_read_b64_tr_b16 v[60:61], v15 offset:16384
    ds_read_b64_tr_b16 v[62:63], v15 offset:16896
    ds_read_b128 v[28:31], v10 offset:2048
    ds_read_b128 v[32:35], v10 offset:4096
    ds_read_b128 v[36:39], v10 offset:6144
L_loop1:
    s_add_u32 s52, s52, 40960
    s_cmp_eq_u32 s52, 122880
    s_cselect_b32 s52, 0, s52
    v_add_u32 v10, s52, v8
    s_waitcnt lgkmcnt(0)
    v_mfma_f32_16x16x32_bf16 v[136:139], v[24:27], v[48:51], v[136:139]
    ds_read_b128 v[64:67], v11 offset:0
    v_mfma_f32_16x16x32_bf16 v[152:155], v[24:27], v[52:55], v[152:155]
    ds_read_b64_tr_b16 v[80:81], v14 offset:4096
    v_mfma_f32_16x16x32_bf16 v[168:171], v[24:27], v[56:59], v[168:171]
    ds_read_b64_tr_b16 v[82:83], v14 offset:4608
    v_mfma_f32_16x16x32_bf16 v[184:187], v[24:27], v[60:63], v[184:187]
    ds_read_b64_tr_b16 v[84:85], v15 offset:4096
    v_mfma_f32_16x16x32_bf16 v[104:107], v[40:43], v[24:27], v[104:107]
    ds_read_b64_tr_b16 v[86:87], v15 offset:4608
    v_mfma_f32_16x16x32_bf16 v[108:111], v[44:47], v[24:27], v[108:111]
    ds_read_b64_tr_b16 v[88:89], v14 offset:12288
    v_mfma_f32_16x16x32_bf16 v[140:143], v[28:31], v[48:51], v[140:143]
    ds_read_b64_tr_b16 v[90:91], v14 offset:12800
    v_mfma_f32_16x16x32_bf16 v[156:159], v[28:31], v[52:55], v[156:159]
    ds_read_b64_tr_b16 v[92:93], v15 offset:12288
    v_mfma_f32_16x16x32_bf16 v[172:175], v[28:31], v[56:59], v[172:175]
    ds_read_b64_tr_b16 v[94:95], v15 offset:12800
    v_mfma_f32_16x16x32_bf16 v[188:191], v[28:31], v[60:63], v[188:191]
    ds_read_b64_tr_b16 v[96:97], v14 offset:20480
    v_mfma_f32_16x16x32_bf16 v[112:115], v[40:43], v[28:31], v[112:115]
    ds_read_b64_tr_b16 v[98:99], v14 offset:20992
    v_mfma_f32_16x16x32_bf16 v[116:119], v[44:47], v[28:31], v[116:119]
    ds_read_b64_tr_b16 v[100:101], v15 offset:20480
    v_mfma_f32_16x16x32_bf16 v[144:147], v[32:35], v[48:51], v[144:147]
    ds_read_b64_tr_b16 v[102:103], v15 offset:20992
    v_mfma_f32_16x16x32_bf16 v[160:163], v[32:35], v[52:55], v[160:163]
    ds_read_b128 v[68:71], v11 offset:2048
    v_mfma_f32_16x16x32_bf16 v[176:179], v[32:35], v[56:59], v[176:179]
    ds_read_b128 v[72:75], v11 offset:4096
    v_mfma_f32_16x16x32_bf16 v[192:195], v[32:35], v[60:63], v[192:195]
    ds_read_b128 v[76:79], v11 offset:6144
    v_mfma_f32_16x16x32_bf16 v[120:123], v[40:43], v[32:35], v[120:123]
    v_add_u32 v11, s52, v9
    v_mfma_f32_16x16x32_bf16 v[124:127], v[44:47], v[32:35], v[124:127]
    v_add_u32 v14, s52, v12
    v_mfma_f32_16x16x32_bf16 v[148:151], v[36:39], v[48:51], v[148:151]
    v_add_u32 v15, s52, v13
    v_mfma_f32_16x16x32_bf16 v[164:167], v[36:39], v[52:55], v[164:167]
    v_mfma_f32_16x16x32_bf16 v[180:183], v[36:39], v[56:59], v[180:183]
    v_mfma_f32_16x16x32_bf16 v[196:199], v[36:39], v[60:63], v[196:199]
    v_mfma_f32_16x16x32_bf16 v[128:131], v[40:43], v[36:39], v[128:131]
    v_mfma_f32_16x16x32_bf16 v[132:135], v[44:47], v[36:39], v[132:135]
    s_waitcnt lgkmcnt(0)
    v_mfma_f32_16x16x32_bf16 v[136:139], v[64:67], v[88:91], v[136:139]
    s_barrier
    v_mfma_f32_16x16x32_bf16 v[152:155], v[64:67], v[92:95], v[152:155]
    ds_read_b128 v[24:27], v10 offset:0
    v_mfma_f32_16x16x32_bf16 v[168:171], v[64:67], v[96:99], v[168:171]
    ds_read_b64_tr_b16 v[40:41], v14 offset:0
    v_mfma_f32_16x16x32_bf16 v[184:187], v[64:67], v[100:103], v[184:187]
    ds_read_b64_tr_b16 v[42:43], v14 offset:512
    v_mfma_f32_16x16x32_bf16 v[104:107], v[80:83], v[64:67], v[104:107]
    ds_read_b64_tr_b16 v[44:45], v15 offset:0
    v_mfma_f32_16x16x32_bf16 v[108:111], v[84:87], v[64:67], v[108:111]
    ds_read_b64_tr_b16 v[46:47], v15 offset:512
    v_mfma_f32_16x16x32_bf16 v[140:143], v[68:71], v[88:91], v[140:143]
    ds_read_b64_tr_b16 v[48:49], v14 offset:8192
    v_mfma_f32_16x16x32_bf16 v[156:159], v[68:71], v[92:95], v[156:159]
    ds_read_b64_tr_b16 v[50:51], v14 offset:8704
    v_mfma_f32_16x16x32_bf16 v[172:175], v[68:71], v[96:99], v[172:175]
    ds_read_b64_tr_b16 v[52:53], v15 offset:8192
    v_mfma_f32_16x16x32_bf16 v[188:191], v[68:71], v[100:103], v[188:191]
    ds_read_b64_tr_b16 v[54:55], v15 offset:8704
    v_mfma_f32_16x16x32_bf16 v[112:115], v[80:83], v[68:71], v[112:115]
    ds_read_b64_tr_b16 v[56:57], v14 offset:16384
    v_mfma_f32_16x16x32_bf16 v[116:119], v[84:87], v[68:71], v[116:119]
    ds_read_b64_tr_b16 v[58:59], v14 offset:16896
    v_mfma_f32_16x16x32_bf16 v[144:147], v[72:75], v[88:91], v[144:147]
    ds_read_b64_tr_b16 v[60:61], v15 offset:16384
    v_mfma_f32_16x16x32_bf16 v[160:163], v[72:75], v[92:95], v[160:163]
    ds_read_b64_tr_b16 v[62:63], v15 offset:16896
    v_mfma_f32_16x16x32_bf16 v[176:179], v[72:75], v[96:99], v[176:179]
    ds_read_b128 v[28:31], v10 offset:2048
    v_mfma_f32_16x16x32_bf16 v[192:195], v[72:75], v[100:103], v[192:195]
    ds_read_b128 v[32:35], v10 offset:4096
    v_mfma_f32_16x16x32_bf16 v[120:123], v[80:83], v[72:75], v[120:123]
    ds_read_b128 v[36:39], v10 offset:6144
    v_mfma_f32_16x16x32_bf16 v[124:127], v[84:87], v[72:75], v[124:127]
    s_add_u32 s53, s53, 1
    v_mfma_f32_16x16x32_bf16 v[148:151], v[76:79], v[88:91], v[148:151]
    s_cmp_lt_u32 s53, 15
    v_mfma_f32_16x16x32_bf16 v[164:167], v[76:79], v[92:95], v[164:167]
    v_mfma_f32_16x16x32_bf16 v[180:183], v[76:79], v[96:99], v[180:183]
    v_mfma_f32_16x16x32_bf16 v[196:199], v[76:79], v[100:103], v[196:199]
    v_mfma_f32_16x16x32_bf16 v[128:131], v[80:83], v[76:79], v[128:131]
    v_mfma_f32_16x16x32_bf16 v[132:135], v[84:87], v[76:79], v[132:135]
    s_cbranch_scc1 L_loop1
    s_waitcnt lgkmcnt(0)
    v_mfma_f32_16x16x32_bf16 v[136:139], v[24:27], v[48:51], v[136:139]
    ds_read_b128 v[64:67], v11 offset:0
    ds_read_b128 v[68:71], v11 offset:2048
    s_mov_b32 s54, 0x3fb8aa3b
    s_mov_b32 s55, 0x3fb8aa3b
    s_mov_b32 s56, 0x358637bd
    v_mfma_f32_16x16x32_bf16 v[140:143], v[28:31], v[48:51], v[140:143]
    ds_read_b128 v[72:75], v11 offset:4096
    ds_read_b128 v[76:79], v11 offset:6144
    s_lshl_b32 s57, s31, 2
    s_add_u32 s57, s57, s3
    s_lshl_b32 s57, s57, 4
    v_mfma_f32_16x16x32_bf16 v[144:147], v[32:35], v[48:51], v[144:147]
    ds_read_b64_tr_b16 v[88:89], v14 offset:12288
    ds_read_b64_tr_b16 v[90:91], v14 offset:12800
    s_add_u32 s57, s57, s30
    s_lshl_b32 s58, s57, 10
    s_add_u32 s58, s58, 0x800000
    v_mfma_f32_16x16x32_bf16 v[148:151], v[36:39], v[48:51], v[148:151]
    ds_read_b64_tr_b16 v[92:93], v15 offset:12288
    ds_read_b64_tr_b16 v[94:95], v15 offset:12800
    s_lshr_b32 s59, s57, 4
    s_lshl_b32 s59, s59, 11
    s_lshl_b32 s45, s30, 4
    v_mfma_f32_16x16x32_bf16 v[152:155], v[24:27], v[52:55], v[152:155]
    ds_read_b64_tr_b16 v[96:97], v14 offset:20480
    ds_read_b64_tr_b16 v[98:99], v14 offset:20992
    s_add_u32 s59, s59, s45
    s_add_u32 s59, s59, 0x900000
    s_lshl_b32 s57, s57, 2
    v_mfma_f32_16x16x32_bf16 v[156:159], v[28:31], v[52:55], v[156:159]
    ds_read_b64_tr_b16 v[100:101], v15 offset:20480
    ds_read_b64_tr_b16 v[102:103], v15 offset:20992
    s_lshr_b32 vcc_lo, s57, 6
    s_mul_i32 vcc_lo, vcc_lo, 1984
    s_add_u32 s57, s57, vcc_lo
    v_mfma_f32_16x16x32_bf16 v[160:163], v[32:35], v[52:55], v[160:163]
    ds_read_b64_tr_b16 v[80:81], v14 offset:4096
    ds_read_b64_tr_b16 v[82:83], v14 offset:4608
    s_add_u32 s57, s57, 0x960000
    s_lshl_b32 s45, s3, 11
    s_add_u32 s45, s45, 131584
    v_mfma_f32_16x16x32_bf16 v[164:167], v[36:39], v[52:55], v[164:167]
    ds_read_b64_tr_b16 v[84:85], v15 offset:4096
    ds_read_b64_tr_b16 v[86:87], v15 offset:4608
    v_add_u32 v6, s45, v5
    v_xor_b32 v7, 2048, v6
    s_lshl_b32 s45, s3, 7
    v_mfma_f32_16x16x32_bf16 v[168:171], v[24:27], v[56:59], v[168:171]
    s_add_u32 s45, s45, 162304
    v_and_b32 v3, 0x30, v4
    v_add_u32 v16, s45, v3
    v_mfma_f32_16x16x32_bf16 v[172:175], v[28:31], v[56:59], v[172:175]
    v_xor_b32 v17, 128, v16
    v_xor_b32 v18, 4, v21
    v_mov_b32 v200, 0x3f803f80
    v_mfma_f32_16x16x32_bf16 v[176:179], v[32:35], v[56:59], v[176:179]
    v_mov_b32 v201, 0x3f803f80
    v_mov_b32 v202, 0x3f803f80
    v_mov_b32 v203, 0x3f803f80
    v_mfma_f32_16x16x32_bf16 v[180:183], v[36:39], v[56:59], v[180:183]
    s_waitcnt lgkmcnt(8)
    v_mfma_f32_16x16x32_bf16 v[136:139], v[64:67], v[88:91], v[136:139]
    v_mfma_f32_16x16x32_bf16 v[140:143], v[68:71], v[88:91], v[140:143]
    v_mfma_f32_16x16x32_bf16 v[144:147], v[72:75], v[88:91], v[144:147]
    v_mfma_f32_16x16x32_bf16 v[148:151], v[76:79], v[88:91], v[148:151]
    v_mfma_f32_16x16x32_bf16 v[152:155], v[64:67], v[92:95], v[152:155]
    v_mfma_f32_16x16x32_bf16 v[156:159], v[68:71], v[92:95], v[156:159]
    s_waitcnt lgkmcnt(0)
    ds_write_b32 v21, v232 offset:112
    v_mfma_f32_16x16x32_bf16 v[160:163], v[72:75], v[92:95], v[160:163]
    v_mul_f32 v204, s54, v136
    v_mul_f32 v205, s54, v137
    v_mul_f32 v206, s54, v138
    v_mfma_f32_16x16x32_bf16 v[164:167], v[76:79], v[92:95], v[164:167]
    v_mul_f32 v207, s54, v139
    v_mul_f32 v208, s54, v140
    v_mul_f32 v209, s54, v141
    v_mfma_f32_16x16x32_bf16 v[184:187], v[24:27], v[60:63], v[184:187]
    v_mul_f32 v210, s54, v142
    v_mul_f32 v211, s54, v143
    v_exp_f32_e64 v204, v204 clamp
    v_mfma_f32_16x16x32_bf16 v[188:191], v[28:31], v[60:63], v[188:191]
    v_exp_f32_e64 v205, v205 clamp
    v_exp_f32_e64 v206, v206 clamp
    v_exp_f32_e64 v207, v207 clamp
    v_mfma_f32_16x16x32_bf16 v[192:195], v[32:35], v[60:63], v[192:195]
    v_exp_f32_e64 v208, v208 clamp
    v_exp_f32_e64 v209, v209 clamp
    v_exp_f32_e64 v210, v210 clamp
    v_mfma_f32_16x16x32_bf16 v[196:199], v[36:39], v[60:63], v[196:199]
    v_exp_f32_e64 v211, v211 clamp
    v_max_f32 v136, s56, v136
    v_max_f32 v137, s56, v137
    v_mfma_f32_16x16x32_bf16 v[168:171], v[64:67], v[96:99], v[168:171]
    v_max_f32 v138, s56, v138
    v_max_f32 v139, s56, v139
    v_max_f32 v140, s56, v140
    v_mfma_f32_16x16x32_bf16 v[172:175], v[68:71], v[96:99], v[172:175]
    v_max_f32 v141, s56, v141
    v_max_f32 v142, s56, v142
    v_max_f32 v143, s56, v143
    v_mfma_f32_16x16x32_bf16 v[176:179], v[72:75], v[96:99], v[176:179]
    v_add_f32 v204, v204, v136
    v_add_f32 v205, v205, v137
    v_add_f32 v206, v206, v138
    v_mfma_f32_16x16x32_bf16 v[180:183], v[76:79], v[96:99], v[180:183]
    v_add_f32 v207, v207, v139
    v_add_f32 v208, v208, v140
    v_add_f32 v209, v209, v141
    v_mfma_f32_16x16x32_bf16 v[184:187], v[64:67], v[100:103], v[184:187]
    v_add_f32 v210, v210, v142
    v_add_f32 v211, v211, v143
    v_cvt_pk_bf16_f32 v136, v204, v205
    v_mfma_f32_16x16x32_bf16 v[188:191], v[68:71], v[100:103], v[188:191]
    v_cvt_pk_bf16_f32 v137, v206, v207
    v_cvt_pk_bf16_f32 v138, v208, v209
    v_cvt_pk_bf16_f32 v139, v210, v211
    v_mfma_f32_16x16x32_bf16 v[192:195], v[72:75], v[100:103], v[192:195]
    v_mul_f32 v204, s54, v144
    v_mul_f32 v205, s54, v145
    v_mul_f32 v206, s54, v146
    v_mfma_f32_16x16x32_bf16 v[196:199], v[76:79], v[100:103], v[196:199]
    v_mul_f32 v207, s54, v147
    v_mul_f32 v208, s54, v148
    v_mul_f32 v209, s54, v149
    v_mul_f32 v210, s54, v150
    v_mul_f32 v211, s54, v151
    v_exp_f32_e64 v204, v204 clamp
    v_exp_f32_e64 v205, v205 clamp
    v_exp_f32_e64 v206, v206 clamp
    v_exp_f32_e64 v207, v207 clamp
    v_exp_f32_e64 v208, v208 clamp
    v_exp_f32_e64 v209, v209 clamp
    v_exp_f32_e64 v210, v210 clamp
    v_exp_f32_e64 v211, v211 clamp
    v_max_f32 v144, s56, v144
    v_max_f32 v145, s56, v145
    v_max_f32 v146, s56, v146
    v_max_f32 v147, s56, v147
    v_max_f32 v148, s56, v148
    v_max_f32 v149, s56, v149
    v_max_f32 v150, s56, v150
    v_max_f32 v151, s56, v151
    v_add_f32 v204, v204, v144
    v_add_f32 v205, v205, v145
    v_add_f32 v206, v206, v146
    v_add_f32 v207, v207, v147
    v_add_f32 v208, v208, v148
    v_add_f32 v209, v209, v149
    v_add_f32 v210, v210, v150
    v_add_f32 v211, v211, v151
    v_cvt_pk_bf16_f32 v140, v204, v205
    v_cvt_pk_bf16_f32 v141, v206, v207
    v_cvt_pk_bf16_f32 v142, v208, v209
    v_cvt_pk_bf16_f32 v143, v210, v211
    s_setprio 2
    v_cvt_pk_bf16_f32 v168, v168, v169
    v_cvt_pk_bf16_f32 v169, v170, v171
    v_cvt_pk_bf16_f32 v170, v172, v173
    v_cvt_pk_bf16_f32 v171, v174, v175
    v_cvt_pk_bf16_f32 v172, v176, v177
    v_cvt_pk_bf16_f32 v173, v178, v179
    v_cvt_pk_bf16_f32 v174, v180, v181
    v_cvt_pk_bf16_f32 v175, v182, v183
    v_cvt_pk_bf16_f32 v176, v184, v185
    v_cvt_pk_bf16_f32 v177, v186, v187
    v_cvt_pk_bf16_f32 v178, v188, v189
    v_cvt_pk_bf16_f32 v179, v190, v191
    v_cvt_pk_bf16_f32 v180, v192, v193
    v_cvt_pk_bf16_f32 v181, v194, v195
    v_cvt_pk_bf16_f32 v182, v196, v197
    v_cvt_pk_bf16_f32 v183, v198, v199
    s_nop 1
    v_mfma_f32_16x16x32_bf16 v[212:215], v[136:139], v[168:171], 0
    v_mfma_f32_16x16x32_bf16 v[220:223], v[136:139], v[176:179], 0
    v_mfma_f32_16x16x32_bf16 v[48:51], v[136:139], v[200:203], 0
    v_mfma_f32_16x16x32_bf16 v[212:215], v[140:143], v[172:175], v[212:215]
    v_mfma_f32_16x16x32_bf16 v[220:223], v[140:143], v[180:183], v[220:223]
    v_mfma_f32_16x16x32_bf16 v[48:51], v[140:143], v[200:203], v[48:51]
    v_pk_mul_f32 v[204:205], v[152:153], s[54:55]
    v_pk_mul_f32 v[206:207], v[154:155], s[54:55]
    v_pk_mul_f32 v[208:209], v[156:157], s[54:55]
    v_pk_mul_f32 v[210:211], v[158:159], s[54:55]
    v_exp_f32_e64 v204, v204 clamp
    v_exp_f32_e64 v205, v205 clamp
    v_exp_f32_e64 v206, v206 clamp
    v_exp_f32_e64 v207, v207 clamp
    v_exp_f32_e64 v208, v208 clamp
    v_exp_f32_e64 v209, v209 clamp
    v_exp_f32_e64 v210, v210 clamp
    v_exp_f32_e64 v211, v211 clamp
    v_max_f32 v152, s56, v152
    v_max_f32 v153, s56, v153
    v_max_f32 v154, s56, v154
    v_max_f32 v155, s56, v155
    v_max_f32 v156, s56, v156
    v_max_f32 v157, s56, v157
    v_max_f32 v158, s56, v158
    v_max_f32 v159, s56, v159
    v_pk_add_f32 v[204:205], v[204:205], v[152:153]
    v_pk_add_f32 v[206:207], v[206:207], v[154:155]
    v_pk_add_f32 v[208:209], v[208:209], v[156:157]
    v_pk_add_f32 v[210:211], v[210:211], v[158:159]
    v_cvt_pk_bf16_f32 v152, v204, v205
    v_cvt_pk_bf16_f32 v153, v206, v207
    v_cvt_pk_bf16_f32 v154, v208, v209
    v_cvt_pk_bf16_f32 v155, v210, v211
    v_pk_mul_f32 v[204:205], v[160:161], s[54:55]
    v_pk_mul_f32 v[206:207], v[162:163], s[54:55]
    v_pk_mul_f32 v[208:209], v[164:165], s[54:55]
    v_pk_mul_f32 v[210:211], v[166:167], s[54:55]
    v_exp_f32_e64 v204, v204 clamp
    v_exp_f32_e64 v205, v205 clamp
    v_exp_f32_e64 v206, v206 clamp
    v_exp_f32_e64 v207, v207 clamp
    v_exp_f32_e64 v208, v208 clamp
    v_exp_f32_e64 v209, v209 clamp
    v_exp_f32_e64 v210, v210 clamp
    v_exp_f32_e64 v211, v211 clamp
    v_max_f32 v160, s56, v160
    v_max_f32 v161, s56, v161
    v_max_f32 v162, s56, v162
    v_max_f32 v163, s56, v163
    v_max_f32 v164, s56, v164
    v_max_f32 v165, s56, v165
    v_max_f32 v166, s56, v166
    v_max_f32 v167, s56, v167
    v_pk_add_f32 v[204:205], v[204:205], v[160:161]
    v_pk_add_f32 v[206:207], v[206:207], v[162:163]
    v_pk_add_f32 v[208:209], v[208:209], v[164:165]
    v_pk_add_f32 v[210:211], v[210:211], v[166:167]
    v_cvt_pk_bf16_f32 v156, v204, v205
    v_cvt_pk_bf16_f32 v157, v206, v207
    v_cvt_pk_bf16_f32 v158, v208, v209
    v_cvt_pk_bf16_f32 v159, v210, v211
    s_nop 1
    v_mfma_f32_16x16x32_bf16 v[216:219], v[152:155], v[168:171], 0
    v_mfma_f32_16x16x32_bf16 v[224:227], v[152:155], v[176:179], 0
    v_mfma_f32_16x16x32_bf16 v[52:55], v[152:155], v[200:203], 0
    v_mfma_f32_16x16x32_bf16 v[216:219], v[156:159], v[172:175], v[216:219]
    v_mfma_f32_16x16x32_bf16 v[224:227], v[156:159], v[180:183], v[224:227]
    v_mfma_f32_16x16x32_bf16 v[52:55], v[156:159], v[200:203], v[52:55]
    s_cmp_eq_u32 s40, 0
    s_nop 5
    s_cbranch_scc1 L_x0
    v_swap_b32 v212, v220
    v_swap_b32 v213, v221
    v_swap_b32 v214, v222
    v_swap_b32 v215, v223
    v_swap_b32 v216, v224
    v_swap_b32 v217, v225
    v_swap_b32 v218, v226
    v_swap_b32 v219, v227
L_x0:
    ds_write_b128 v6, v[220:223]
    ds_write_b128 v6, v[224:227] offset:1024
    ds_write_b128 v16, v[48:51]
    ds_write_b128 v16, v[52:55] offset:64
    ds_write_b32 v21, v232 offset:0
    s_mov_b32 s45, 0
L_xspin:
    ds_read_b32 v235, v18 offset:0
    ds_read_b128 v[236:239], v7
    ds_read_b128 v[240:243], v7 offset:1024
    ds_read_b128 v[244:247], v17
    ds_read_b128 v[248:251], v17 offset:64
    s_add_u32 s45, s45, 1
    s_waitcnt lgkmcnt(4)
    v_readfirstlane_b32 s46, v235
    s_cmp_gt_u32 s45, 0x40000
    s_cbranch_scc1 L_xdone
    s_cmp_eq_u32 s46, 0
    s_cbranch_scc1 L_xspin
L_xdone:
    s_waitcnt lgkmcnt(2)
    v_pk_add_f32 v[212:213], v[212:213], v[236:237]
    v_pk_add_f32 v[214:215], v[214:215], v[238:239]
    v_pk_add_f32 v[216:217], v[216:217], v[240:241]
    v_pk_add_f32 v[218:219], v[218:219], v[242:243]
    v_cvt_pk_bf16_f32 v220, v212, v213
    v_cvt_pk_bf16_f32 v221, v214, v215
    v_cvt_pk_bf16_f32 v222, v216, v217
    v_cvt_pk_bf16_f32 v223, v218, v219
    buffer_store_dwordx4 v[220:223], v5, s[60:63], s58 offen sc1
    s_waitcnt lgkmcnt(0)
    v_pk_add_f32 v[48:49], v[48:49], v[244:245]
    v_pk_add_f32 v[50:51], v[50:51], v[246:247]
    v_pk_add_f32 v[52:53], v[52:53], v[248:249]
    v_pk_add_f32 v[54:55], v[54:55], v[250:251]
    v_cvt_pk_bf16_f32 v224, v48, v49
    v_cvt_pk_bf16_f32 v225, v50, v51
    v_cvt_pk_bf16_f32 v226, v52, v53
    v_cvt_pk_bf16_f32 v227, v54, v55
    s_mov_b32 exec_lo, 0x10001
    s_mov_b32 exec_hi, 0x10001
    buffer_store_dwordx4 v[224:227], v5, s[60:63], s59 offen sc1
    s_mov_b64 exec, -1
    ds_write_b32 v21, v232 offset:128
    v_mfma_f32_16x16x32_bf16 v[104:107], v[40:43], v[24:27], v[104:107]
    s_lshl_b32 s47, s32, 1
    s_add_u32 s47, s47, s41
    s_lshl_b32 s44, s32, 2
    s_add_u32 s44, s44, s3
    v_mfma_f32_16x16x32_bf16 v[108:111], v[44:47], v[24:27], v[108:111]
    s_lshl_b32 s58, s44, 14
    s_add_u32 s58, s58, 0x800000
    s_lshl_b32 s59, s44, 11
    s_add_u32 s59, s59, 0x900000
    v_mfma_f32_16x16x32_bf16 v[104:107], v[80:83], v[64:67], v[104:107]
    s_lshl_b32 s44, s44, 6
    s_lshr_b32 vcc_lo, s44, 6
    s_mul_i32 vcc_lo, vcc_lo, 1984
    s_add_u32 s44, s44, vcc_lo
    v_mfma_f32_16x16x32_bf16 v[108:111], v[84:87], v[64:67], v[108:111]
    s_add_u32 s44, s44, 0x960000
    s_lshl_b32 vcc_lo, s30, 7
    s_add_u32 s44, s44, vcc_lo
    s_lshl_b32 s45, s41, 2
    v_mfma_f32_16x16x32_bf16 v[112:115], v[40:43], v[28:31], v[112:115]
    v_add_u32 v14, s45, v20
    v_mov_b32 v6, 0x3f80
    v_and_b32 v7, 1, v4
    v_lshlrev_b32 v7, 4, v7
    v_mfma_f32_16x16x32_bf16 v[116:119], v[44:47], v[28:31], v[116:119]
    v_lshlrev_b32 v6, v7, v6
    v_lshrrev_b32 v2, 4, v4
    v_cmp_eq_u32 vcc, v2, v22
    v_bfe_u32 v7, v4, 1, 1
    v_mfma_f32_16x16x32_bf16 v[112:115], v[80:83], v[68:71], v[112:115]
    v_mov_b32 v8, 0
    v_cndmask_b32 v6, 0, v6, vcc
    v_cmp_eq_u32 vcc, 0, v7
    v_mov_b32 v9, 0
    v_mfma_f32_16x16x32_bf16 v[116:119], v[84:87], v[68:71], v[116:119]
    v_mov_b32 v12, 0
    v_cndmask_b32 v10, 0, v6, vcc
    v_cndmask_b32 v11, v6, v233, vcc
    v_mov_b32 v13, 0
    v_mfma_f32_16x16x32_bf16 v[120:123], v[40:43], v[32:35], v[120:123]
    s_lshl_b32 s45, s3, 10
    s_add_u32 s45, s45, 158208
    v_add_u32 v6, s45, v5
    s_xor_b32 s45, s3, 1
    v_mfma_f32_16x16x32_bf16 v[124:127], v[44:47], v[32:35], v[124:127]
    s_lshl_b32 s45, s45, 10
    s_add_u32 s45, s45, 158208
    v_add_u32 v7, s45, v5
    s_lshl_b32 s48, s30, 3
    v_mfma_f32_16x16x32_bf16 v[120:123], v[80:83], v[72:75], v[120:123]
    s_lshl_b32 s45, s40, 2
    s_add_u32 s48, s48, s45
    s_lshl_b32 s48, s48, 15
    s_lshl_b32 s45, s47, 10
    v_mfma_f32_16x16x32_bf16 v[124:127], v[84:87], v[72:75], v[124:127]
    s_add_u32 s48, s48, s45
    s_add_u32 s48, s48, 0x400000
    s_lshl_b32 s49, s30, 1
    s_add_u32 s49, s49, s40
    v_mfma_f32_16x16x32_bf16 v[128:131], v[40:43], v[36:39], v[128:131]
    s_lshl_b32 s49, s49, 7
    s_lshl_b32 s45, s47, 2
    s_add_u32 s49, s49, s45
    s_lshr_b32 vcc_lo, s49, 6
    v_mfma_f32_16x16x32_bf16 v[132:135], v[44:47], v[36:39], v[132:135]
    s_mul_i32 vcc_lo, vcc_lo, 1984
    s_add_u32 s49, s49, vcc_lo
    s_add_u32 s49, s49, 0x980000
    s_mov_b32 s50, 0
    v_mfma_f32_16x16x32_bf16 v[128:131], v[80:83], v[76:79], v[128:131]
    s_mov_b32 s51, 0
    s_mov_b32 s53, 0
    s_mov_b32 s46, 0
    v_mfma_f32_16x16x32_bf16 v[132:135], v[84:87], v[76:79], v[132:135]
    v_mul_f32 v204, s54, v104
    v_mul_f32 v205, s54, v105
    v_mul_f32 v206, s54, v106
    v_mul_f32 v207, s54, v107
    v_mul_f32 v208, s54, v108
    v_mul_f32 v209, s54, v109
    v_mul_f32 v210, s54, v110
    v_mul_f32 v211, s54, v111
    v_exp_f32_e64 v204, v204 clamp
    v_exp_f32_e64 v205, v205 clamp
    v_exp_f32_e64 v206, v206 clamp
    v_exp_f32_e64 v207, v207 clamp
    v_exp_f32_e64 v208, v208 clamp
    v_exp_f32_e64 v209, v209 clamp
    v_exp_f32_e64 v210, v210 clamp
    v_exp_f32_e64 v211, v211 clamp
    v_max_f32 v104, s56, v104
    v_max_f32 v105, s56, v105
    v_max_f32 v106, s56, v106
    v_max_f32 v107, s56, v107
    v_max_f32 v108, s56, v108
    v_max_f32 v109, s56, v109
    v_max_f32 v110, s56, v110
    v_max_f32 v111, s56, v111
    v_add_f32 v204, v204, v104
    v_add_f32 v205, v205, v105
    v_add_f32 v206, v206, v106
    v_add_f32 v207, v207, v107
    v_add_f32 v208, v208, v108
    v_add_f32 v209, v209, v109
    v_add_f32 v210, v210, v110
    v_add_f32 v211, v211, v111
    v_cvt_pk_bf16_f32 v104, v204, v205
    v_cvt_pk_bf16_f32 v105, v206, v207
    v_cvt_pk_bf16_f32 v106, v208, v209
    v_cvt_pk_bf16_f32 v107, v210, v211
    v_mul_f32 v204, s54, v112
    v_mul_f32 v205, s54, v113
    v_mul_f32 v206, s54, v114
    v_mul_f32 v207, s54, v115
    v_mul_f32 v208, s54, v116
    v_mul_f32 v209, s54, v117
    v_mul_f32 v210, s54, v118
    v_mul_f32 v211, s54, v119
    v_exp_f32_e64 v204, v204 clamp
    v_exp_f32_e64 v205, v205 clamp
    v_exp_f32_e64 v206, v206 clamp
    v_exp_f32_e64 v207, v207 clamp
    v_exp_f32_e64 v208, v208 clamp
    v_exp_f32_e64 v209, v209 clamp
    v_exp_f32_e64 v210, v210 clamp
    v_exp_f32_e64 v211, v211 clamp
    v_max_f32 v112, s56, v112
    v_max_f32 v113, s56, v113
    v_max_f32 v114, s56, v114
    v_max_f32 v115, s56, v115
    v_max_f32 v116, s56, v116
    v_max_f32 v117, s56, v117
    v_max_f32 v118, s56, v118
    v_max_f32 v119, s56, v119
    v_add_f32 v204, v204, v112
    v_add_f32 v205, v205, v113
    v_add_f32 v206, v206, v114
    v_add_f32 v207, v207, v115
    v_add_f32 v208, v208, v116
    v_add_f32 v209, v209, v117
    v_add_f32 v210, v210, v118
    v_add_f32 v211, v211, v119
    v_cvt_pk_bf16_f32 v108, v204, v205
    v_cvt_pk_bf16_f32 v109, v206, v207
    v_cvt_pk_bf16_f32 v110, v208, v209
    v_cvt_pk_bf16_f32 v111, v210, v211
    s_mov_b32 s45, 0
L_cep:
    s_waitcnt vmcnt(0)
    v_readfirstlane_b32 s72, v234
    s_add_u32 s45, s45, 1
    s_cmp_gt_u32 s45, 0x4000
    s_cbranch_scc1 L_cepok
    s_cmp_lg_u32 s72, 0
    s_cbranch_scc1 L_cepok
    global_load_dword v234, v233, s[24:25] sc1
    s_branch L_cep
L_cepok:
    s_mov_b32 s73, s72
    s_mov_b64 exec, 0xffff
    buffer_store_dword v234, v254, s[60:63], s57 offen sc1
    s_mov_b64 exec, -1
    s_load_dwordx16 s[4:19], s[26:27], s44 glc
    v_mul_f32 v204, s54, v120
    v_mul_f32 v205, s54, v121
    v_mul_f32 v206, s54, v122
    v_mul_f32 v207, s54, v123
    v_mul_f32 v208, s54, v124
    v_mul_f32 v209, s54, v125
    v_mul_f32 v210, s54, v126
    v_mul_f32 v211, s54, v127
    v_exp_f32_e64 v204, v204 clamp
    v_exp_f32_e64 v205, v205 clamp
    v_exp_f32_e64 v206, v206 clamp
    v_exp_f32_e64 v207, v207 clamp
    v_exp_f32_e64 v208, v208 clamp
    v_exp_f32_e64 v209, v209 clamp
    v_exp_f32_e64 v210, v210 clamp
    v_exp_f32_e64 v211, v211 clamp
    v_max_f32 v120, s56, v120
    v_max_f32 v121, s56, v121
    v_max_f32 v122, s56, v122
    v_max_f32 v123, s56, v123
    v_max_f32 v124, s56, v124
    v_max_f32 v125, s56, v125
    v_max_f32 v126, s56, v126
    v_max_f32 v127, s56, v127
    v_add_f32 v204, v204, v120
    v_add_f32 v205, v205, v121
    v_add_f32 v206, v206, v122
    v_add_f32 v207, v207, v123
    v_add_f32 v208, v208, v124
    v_add_f32 v209, v209, v125
    v_add_f32 v210, v210, v126
    v_add_f32 v211, v211, v127
    v_cvt_pk_bf16_f32 v112, v204, v205
    v_cvt_pk_bf16_f32 v113, v206, v207
    v_cvt_pk_bf16_f32 v114, v208, v209
    v_cvt_pk_bf16_f32 v115, v210, v211
    v_mul_f32 v204, s54, v128
    v_mul_f32 v205, s54, v129
    v_mul_f32 v206, s54, v130
    v_mul_f32 v207, s54, v131
    v_mul_f32 v208, s54, v132
    v_mul_f32 v209, s54, v133
    v_mul_f32 v210, s54, v134
    v_mul_f32 v211, s54, v135
    v_exp_f32_e64 v204, v204 clamp
    v_exp_f32_e64 v205, v205 clamp
    v_exp_f32_e64 v206, v206 clamp
    v_exp_f32_e64 v207, v207 clamp
    v_exp_f32_e64 v208, v208 clamp
    v_exp_f32_e64 v209, v209 clamp
    v_exp_f32_e64 v210, v210 clamp
    v_exp_f32_e64 v211, v211 clamp
    v_max_f32 v128, s56, v128
    v_max_f32 v129, s56, v129
    v_max_f32 v130, s56, v130
    v_max_f32 v131, s56, v131
    v_max_f32 v132, s56, v132
    v_max_f32 v133, s56, v133
    v_max_f32 v134, s56, v134
    v_max_f32 v135, s56, v135
    v_add_f32 v204, v204, v128
    v_add_f32 v205, v205, v129
    v_add_f32 v206, v206, v130
    v_add_f32 v207, v207, v131
    v_add_f32 v208, v208, v132
    v_add_f32 v209, v209, v133
    v_add_f32 v210, v210, v134
    v_add_f32 v211, v211, v135
    v_cvt_pk_bf16_f32 v116, v204, v205
    v_cvt_pk_bf16_f32 v117, v206, v207
    v_cvt_pk_bf16_f32 v118, v208, v209
    v_cvt_pk_bf16_f32 v119, v210, v211
    v_mov_b64 v[88:89], 0
    v_mov_b64 v[138:139], 0
    v_mov_b32 v168, s56
    v_mov_b64 v[90:91], 0
    v_mov_b64 v[142:143], 0
    v_mov_b32 v169, s56
    v_mov_b64 v[92:93], 0
    v_mov_b64 v[146:147], 0
    v_mov_b32 v170, s56
    v_mov_b64 v[94:95], 0
    v_mov_b64 v[150:151], 0
    v_mov_b32 v171, s56
    s_setprio 3
    s_cmp_eq_u32 s46, 0
    s_cbranch_scc1 L_poll0
L_go0:
    s_ff1_i32_b32 s45, s46
    s_bitset0_b32 s46, s45
    s_lshl_b32 s45, s45, 11
    s_add_u32 s45, s45, s58
    buffer_load_dwordx4 v[24:27], v5, s[60:63], s45 offen offset:0 sc1
    buffer_load_dwordx4 v[28:31], v5, s[60:63], s45 offen offset:1024 sc1
    s_bitset1_b32 s51, 0
    s_cmp_eq_u32 s46, 0
    s_cbranch_scc1 L_poll1
L_go1:
    s_ff1_i32_b32 s45, s46
    s_bitset0_b32 s46, s45
    s_lshl_b32 s45, s45, 11
    s_add_u32 s45, s45, s58
    buffer_load_dwordx4 v[32:35], v5, s[60:63], s45 offen offset:0 sc1
    buffer_load_dwordx4 v[36:39], v5, s[60:63], s45 offen offset:1024 sc1
    s_bitset1_b32 s51, 1
    s_cmp_eq_u32 s46, 0
    s_cbranch_scc1 L_poll2
L_go2:
    s_ff1_i32_b32 s45, s46
    s_bitset0_b32 s46, s45
    s_lshl_b32 s45, s45, 11
    s_add_u32 s45, s45, s58
    buffer_load_dwordx4 v[40:43], v5, s[60:63], s45 offen offset:0 sc1
    buffer_load_dwordx4 v[44:47], v5, s[60:63], s45 offen offset:1024 sc1
    s_bitset1_b32 s51, 2
    s_cmp_eq_u32 s46, 0
    s_cbranch_scc1 L_poll3
L_go3:
    s_ff1_i32_b32 s45, s46
    s_bitset0_b32 s46, s45
    s_lshl_b32 s45, s45, 11
    s_add_u32 s45, s45, s58
    buffer_load_dwordx4 v[48:51], v5, s[60:63], s45 offen offset:0 sc1
    buffer_load_dwordx4 v[52:55], v5, s[60:63], s45 offen offset:1024 sc1
    s_bitset1_b32 s51, 3
    s_cmp_eq_u32 s46, 0
    s_cbranch_scc1 L_poll4
L_go4:
    s_ff1_i32_b32 s45, s46
    s_bitset0_b32 s46, s45
    s_lshl_b32 s45, s45, 11
    s_add_u32 s45, s45, s58
    buffer_load_dwordx4 v[56:59], v5, s[60:63], s45 offen offset:0 sc1
    buffer_load_dwordx4 v[60:63], v5, s[60:63], s45 offen offset:1024 sc1
    s_bitset1_b32 s51, 4
    s_cmp_eq_u32 s46, 0
    s_cbranch_scc1 L_poll5
L_go5:
    s_ff1_i32_b32 s45, s46
    s_bitset0_b32 s46, s45
    s_lshl_b32 s45, s45, 11
    s_add_u32 s45, s45, s58
    buffer_load_dwordx4 v[64:67], v5, s[60:63], s45 offen offset:0 sc1
    buffer_load_dwordx4 v[68:71], v5, s[60:63], s45 offen offset:1024 sc1
    s_bitset1_b32 s51, 5
    s_cmp_eq_u32 s46, 0
    s_cbranch_scc1 L_poll6
L_go6:
    s_ff1_i32_b32 s45, s46
    s_bitset0_b32 s46, s45
    s_lshl_b32 s45, s45, 11
    s_add_u32 s45, s45, s58
    buffer_load_dwordx4 v[72:75], v5, s[60:63], s45 offen offset:0 sc1
    buffer_load_dwordx4 v[76:79], v5, s[60:63], s45 offen offset:1024 sc1
    s_bitset1_b32 s51, 6
    s_cmp_eq_u32 s46, 0
    s_cbranch_scc1 L_poll7
L_go7:
    s_ff1_i32_b32 s45, s46
    s_bitset0_b32 s46, s45
    s_lshl_b32 s45, s45, 11
    s_add_u32 s45, s45, s58
    buffer_load_dwordx4 v[80:83], v5, s[60:63], s45 offen offset:0 sc1
    buffer_load_dwordx4 v[84:87], v5, s[60:63], s45 offen offset:1024 sc1
    s_bitset1_b32 s51, 7
    s_branch L_fin
L_poll0:
    s_waitcnt lgkmcnt(0)
    s_cmp_eq_u64 s[18:19], s[72:73]
    s_addc_u32 s46, s46, s46
    s_cmp_eq_u64 s[16:17], s[72:73]
    s_addc_u32 s46, s46, s46
    s_cmp_eq_u64 s[14:15], s[72:73]
    s_addc_u32 s46, s46, s46
    s_cmp_eq_u64 s[12:13], s[72:73]
    s_addc_u32 s46, s46, s46
    s_cmp_eq_u64 s[10:11], s[72:73]
    s_addc_u32 s46, s46, s46
    s_cmp_eq_u64 s[8:9], s[72:73]
    s_addc_u32 s46, s46, s46
    s_cmp_eq_u64 s[6:7], s[72:73]
    s_addc_u32 s46, s46, s46
    s_cmp_eq_u64 s[4:5], s[72:73]
    s_addc_u32 s46, s46, s46
    s_add_u32 s53, s53, 1
    s_cmp_gt_u32 s53, 0x8000
    s_cselect_b32 s46, 0xff, s46
    s_andn2_b32 s46, s46, s50
    s_or_b32 s50, s50, s46
    s_cmp_eq_u32 s50, 0xff
    s_cbranch_scc0 L_pm0
    buffer_load_dwordx4 v[96:99], v5, s[60:63], s59 offen sc1
    s_mov_b32 s47, s51
    s_mov_b32 s52, 0
    s_branch L_go0
L_pm0:
    s_load_dwordx16 s[4:19], s[26:27], s44 glc
    s_cmp_lg_u32 s46, 0
    s_cbranch_scc1 L_go0
    s_branch L_poll0
L_poll1:
    s_waitcnt lgkmcnt(0)
    s_cmp_eq_u64 s[18:19], s[72:73]
    s_addc_u32 s46, s46, s46
    s_cmp_eq_u64 s[16:17], s[72:73]
    s_addc_u32 s46, s46, s46
    s_cmp_eq_u64 s[14:15], s[72:73]
    s_addc_u32 s46, s46, s46
    s_cmp_eq_u64 s[12:13], s[72:73]
    s_addc_u32 s46, s46, s46
    s_cmp_eq_u64 s[10:11], s[72:73]
    s_addc_u32 s46, s46, s46
    s_cmp_eq_u64 s[8:9], s[72:73]
    s_addc_u32 s46, s46, s46
    s_cmp_eq_u64 s[6:7], s[72:73]
    s_addc_u32 s46, s46, s46
    s_cmp_eq_u64 s[4:5], s[72:73]
    s_addc_u32 s46, s46, s46
    s_add_u32 s53, s53, 1
    s_cmp_gt_u32 s53, 0x8000
    s_cselect_b32 s46, 0xff, s46
    s_andn2_b32 s46, s46, s50
    s_or_b32 s50, s50, s46
    s_cmp_eq_u32 s50, 0xff
    s_cbranch_scc0 L_pm1
    buffer_load_dwordx4 v[96:99], v5, s[60:63], s59 offen sc1
    s_mov_b32 s47, s51
    s_mov_b32 s52, 1
    s_branch L_go1
L_pm1:
    s_load_dwordx16 s[4:19], s[26:27], s44 glc
    s_cmp_lg_u32 s46, 0
    s_cbranch_scc1 L_go1
    s_cmp_eq_u32 s51, 0
    s_cbranch_scc1 L_poll1
    s_mov_b32 s52, 1
    s_branch L_acc
L_poll2:
    s_waitcnt lgkmcnt(0)
    s_cmp_eq_u64 s[18:19], s[72:73]
    s_addc_u32 s46, s46, s46
    s_cmp_eq_u64 s[16:17], s[72:73]
    s_addc_u32 s46, s46, s46
    s_cmp_eq_u64 s[14:15], s[72:73]
    s_addc_u32 s46, s46, s46
    s_cmp_eq_u64 s[12:13], s[72:73]
    s_addc_u32 s46, s46, s46
    s_cmp_eq_u64 s[10:11], s[72:73]
    s_addc_u32 s46, s46, s46
    s_cmp_eq_u64 s[8:9], s[72:73]
    s_addc_u32 s46, s46, s46
    s_cmp_eq_u64 s[6:7], s[72:73]
    s_addc_u32 s46, s46, s46
    s_cmp_eq_u64 s[4:5], s[72:73]
    s_addc_u32 s46, s46, s46
    s_add_u32 s53, s53, 1
    s_cmp_gt_u32 s53, 0x8000
    s_cselect_b32 s46, 0xff, s46
    s_andn2_b32 s46, s46, s50
    s_or_b32 s50, s50, s46
    s_cmp_eq_u32 s50, 0xff
    s_cbranch_scc0 L_pm2
    buffer_load_dwordx4 v[96:99], v5, s[60:63], s59 offen sc1
    s_mov_b32 s47, s51
    s_mov_b32 s52, 2
    s_branch L_go2
L_pm2:
    s_load_dwordx16 s[4:19], s[26:27], s44 glc
    s_cmp_lg_u32 s46, 0
    s_cbranch_scc1 L_go2
    s_cmp_eq_u32 s51, 0
    s_cbranch_scc1 L_poll2
    s_mov_b32 s52, 2
    s_branch L_acc
L_poll3:
    s_waitcnt lgkmcnt(0)
    s_cmp_eq_u64 s[18:19], s[72:73]
    s_addc_u32 s46, s46, s46
    s_cmp_eq_u64 s[16:17], s[72:73]
    s_addc_u32 s46, s46, s46
    s_cmp_eq_u64 s[14:15], s[72:73]
    s_addc_u32 s46, s46, s46
    s_cmp_eq_u64 s[12:13], s[72:73]
    s_addc_u32 s46, s46, s46
    s_cmp_eq_u64 s[10:11], s[72:73]
    s_addc_u32 s46, s46, s46
    s_cmp_eq_u64 s[8:9], s[72:73]
    s_addc_u32 s46, s46, s46
    s_cmp_eq_u64 s[6:7], s[72:73]
    s_addc_u32 s46, s46, s46
    s_cmp_eq_u64 s[4:5], s[72:73]
    s_addc_u32 s46, s46, s46
    s_add_u32 s53, s53, 1
    s_cmp_gt_u32 s53, 0x8000
    s_cselect_b32 s46, 0xff, s46
    s_andn2_b32 s46, s46, s50
    s_or_b32 s50, s50, s46
    s_cmp_eq_u32 s50, 0xff
    s_cbranch_scc0 L_pm3
    buffer_load_dwordx4 v[96:99], v5, s[60:63], s59 offen sc1
    s_mov_b32 s47, s51
    s_mov_b32 s52, 3
    s_branch L_go3
L_pm3:
    s_load_dwordx16 s[4:19], s[26:27], s44 glc
    s_cmp_lg_u32 s46, 0
    s_cbranch_scc1 L_go3
    s_cmp_eq_u32 s51, 0
    s_cbranch_scc1 L_poll3
    s_mov_b32 s52, 3
    s_branch L_acc
L_poll4:
    s_waitcnt lgkmcnt(0)
    s_cmp_eq_u64 s[18:19], s[72:73]
    s_addc_u32 s46, s46, s46
    s_cmp_eq_u64 s[16:17], s[72:73]
    s_addc_u32 s46, s46, s46
    s_cmp_eq_u64 s[14:15], s[72:73]
    s_addc_u32 s46, s46, s46
    s_cmp_eq_u64 s[12:13], s[72:73]
    s_addc_u32 s46, s46, s46
    s_cmp_eq_u64 s[10:11], s[72:73]
    s_addc_u32 s46, s46, s46
    s_cmp_eq_u64 s[8:9], s[72:73]
    s_addc_u32 s46, s46, s46
    s_cmp_eq_u64 s[6:7], s[72:73]
    s_addc_u32 s46, s46, s46
    s_cmp_eq_u64 s[4:5], s[72:73]
    s_addc_u32 s46, s46, s46
    s_add_u32 s53, s53, 1
    s_cmp_gt_u32 s53, 0x8000
    s_cselect_b32 s46, 0xff, s46
    s_andn2_b32 s46, s46, s50
    s_or_b32 s50, s50, s46
    s_cmp_eq_u32 s50, 0xff
    s_cbranch_scc0 L_pm4
    buffer_load_dwordx4 v[96:99], v5, s[60:63], s59 offen sc1
    s_mov_b32 s47, s51
    s_mov_b32 s52, 4
    s_branch L_go4
L_pm4:
    s_load_dwordx16 s[4:19], s[26:27], s44 glc
    s_cmp_lg_u32 s46, 0
    s_cbranch_scc1 L_go4
    s_cmp_eq_u32 s51, 0
    s_cbranch_scc1 L_poll4
    s_mov_b32 s52, 4
    s_branch L_acc
L_poll5:
    s_waitcnt lgkmcnt(0)
    s_cmp_eq_u64 s[18:19], s[72:73]
    s_addc_u32 s46, s46, s46
    s_cmp_eq_u64 s[16:17], s[72:73]
    s_addc_u32 s46, s46, s46
    s_cmp_eq_u64 s[14:15], s[72:73]
    s_addc_u32 s46, s46, s46
    s_cmp_eq_u64 s[12:13], s[72:73]
    s_addc_u32 s46, s46, s46
    s_cmp_eq_u64 s[10:11], s[72:73]
    s_addc_u32 s46, s46, s46
    s_cmp_eq_u64 s[8:9], s[72:73]
    s_addc_u32 s46, s46, s46
    s_cmp_eq_u64 s[6:7], s[72:73]
    s_addc_u32 s46, s46, s46
    s_cmp_eq_u64 s[4:5], s[72:73]
    s_addc_u32 s46, s46, s46
    s_add_u32 s53, s53, 1
    s_cmp_gt_u32 s53, 0x8000
    s_cselect_b32 s46, 0xff, s46
    s_andn2_b32 s46, s46, s50
    s_or_b32 s50, s50, s46
    s_cmp_eq_u32 s50, 0xff
    s_cbranch_scc0 L_pm5
    buffer_load_dwordx4 v[96:99], v5, s[60:63], s59 offen sc1
    s_mov_b32 s47, s51
    s_mov_b32 s52, 5
    s_branch L_go5
L_pm5:
    s_load_dwordx16 s[4:19], s[26:27], s44 glc
    s_cmp_lg_u32 s46, 0
    s_cbranch_scc1 L_go5
    s_cmp_eq_u32 s51, 0
    s_cbranch_scc1 L_poll5
    s_mov_b32 s52, 5
    s_branch L_acc
L_poll6:
    s_waitcnt lgkmcnt(0)
    s_cmp_eq_u64 s[18:19], s[72:73]
    s_addc_u32 s46, s46, s46
    s_cmp_eq_u64 s[16:17], s[72:73]
    s_addc_u32 s46, s46, s46
    s_cmp_eq_u64 s[14:15], s[72:73]
    s_addc_u32 s46, s46, s46
    s_cmp_eq_u64 s[12:13], s[72:73]
    s_addc_u32 s46, s46, s46
    s_cmp_eq_u64 s[10:11], s[72:73]
    s_addc_u32 s46, s46, s46
    s_cmp_eq_u64 s[8:9], s[72:73]
    s_addc_u32 s46, s46, s46
    s_cmp_eq_u64 s[6:7], s[72:73]
    s_addc_u32 s46, s46, s46
    s_cmp_eq_u64 s[4:5], s[72:73]
    s_addc_u32 s46, s46, s46
    s_add_u32 s53, s53, 1
    s_cmp_gt_u32 s53, 0x8000
    s_cselect_b32 s46, 0xff, s46
    s_andn2_b32 s46, s46, s50
    s_or_b32 s50, s50, s46
    s_cmp_eq_u32 s50, 0xff
    s_cbranch_scc0 L_pm6
    buffer_load_dwordx4 v[96:99], v5, s[60:63], s59 offen sc1
    s_mov_b32 s47, s51
    s_mov_b32 s52, 6
    s_branch L_go6
L_pm6:
    s_load_dwordx16 s[4:19], s[26:27], s44 glc
    s_cmp_lg_u32 s46, 0
    s_cbranch_scc1 L_go6
    s_cmp_eq_u32 s51, 0
    s_cbranch_scc1 L_poll6
    s_mov_b32 s52, 6
    s_branch L_acc
L_poll7:
    s_waitcnt lgkmcnt(0)
    s_cmp_eq_u64 s[18:19], s[72:73]
    s_addc_u32 s46, s46, s46
    s_cmp_eq_u64 s[16:17], s[72:73]
    s_addc_u32 s46, s46, s46
    s_cmp_eq_u64 s[14:15], s[72:73]
    s_addc_u32 s46, s46, s46
    s_cmp_eq_u64 s[12:13], s[72:73]
    s_addc_u32 s46, s46, s46
    s_cmp_eq_u64 s[10:11], s[72:73]
    s_addc_u32 s46, s46, s46
    s_cmp_eq_u64 s[8:9], s[72:73]
    s_addc_u32 s46, s46, s46
    s_cmp_eq_u64 s[6:7], s[72:73]
    s_addc_u32 s46, s46, s46
    s_cmp_eq_u64 s[4:5], s[72:73]
    s_addc_u32 s46, s46, s46
    s_add_u32 s53, s53, 1
    s_cmp_gt_u32 s53, 0x8000
    s_cselect_b32 s46, 0xff, s46
    s_andn2_b32 s46, s46, s50
    s_or_b32 s50, s50, s46
    s_cmp_eq_u32 s50, 0xff
    s_cbranch_scc0 L_pm7
    buffer_load_dwordx4 v[96:99], v5, s[60:63], s59 offen sc1
    s_mov_b32 s47, s51
    s_mov_b32 s52, 7
    s_branch L_go7
L_pm7:
    s_load_dwordx16 s[4:19], s[26:27], s44 glc
    s_cmp_lg_u32 s46, 0
    s_cbranch_scc1 L_go7
    s_cmp_eq_u32 s51, 0
    s_cbranch_scc1 L_poll7
    s_mov_b32 s52, 7
    s_branch L_acc
L_acc:
    s_waitcnt vmcnt(0)
    s_bitcmp1_b32 s51, 0
    s_cbranch_scc0 L_ac0
    v_mfma_f32_16x16x32_bf16 v[88:91], v[10:13], v[24:27], v[88:91]
    v_mfma_f32_16x16x32_bf16 v[92:95], v[8:11], v[24:27], v[92:95]
    v_mfma_f32_16x16x32_bf16 v[88:91], v[10:13], v[28:31], v[88:91]
    v_mfma_f32_16x16x32_bf16 v[92:95], v[8:11], v[28:31], v[92:95]
L_ac0:
    s_bitcmp1_b32 s51, 1
    s_cbranch_scc0 L_ac1
    v_mfma_f32_16x16x32_bf16 v[88:91], v[10:13], v[32:35], v[88:91]
    v_mfma_f32_16x16x32_bf16 v[92:95], v[8:11], v[32:35], v[92:95]
    v_mfma_f32_16x16x32_bf16 v[88:91], v[10:13], v[36:39], v[88:91]
    v_mfma_f32_16x16x32_bf16 v[92:95], v[8:11], v[36:39], v[92:95]
L_ac1:
    s_bitcmp1_b32 s51, 2
    s_cbranch_scc0 L_ac2
    v_mfma_f32_16x16x32_bf16 v[88:91], v[10:13], v[40:43], v[88:91]
    v_mfma_f32_16x16x32_bf16 v[92:95], v[8:11], v[40:43], v[92:95]
    v_mfma_f32_16x16x32_bf16 v[88:91], v[10:13], v[44:47], v[88:91]
    v_mfma_f32_16x16x32_bf16 v[92:95], v[8:11], v[44:47], v[92:95]
L_ac2:
    s_bitcmp1_b32 s51, 3
    s_cbranch_scc0 L_ac3
    v_mfma_f32_16x16x32_bf16 v[88:91], v[10:13], v[48:51], v[88:91]
    v_mfma_f32_16x16x32_bf16 v[92:95], v[8:11], v[48:51], v[92:95]
    v_mfma_f32_16x16x32_bf16 v[88:91], v[10:13], v[52:55], v[88:91]
    v_mfma_f32_16x16x32_bf16 v[92:95], v[8:11], v[52:55], v[92:95]
L_ac3:
    s_bitcmp1_b32 s51, 4
    s_cbranch_scc0 L_ac4
    v_mfma_f32_16x16x32_bf16 v[88:91], v[10:13], v[56:59], v[88:91]
    v_mfma_f32_16x16x32_bf16 v[92:95], v[8:11], v[56:59], v[92:95]
    v_mfma_f32_16x16x32_bf16 v[88:91], v[10:13], v[60:63], v[88:91]
    v_mfma_f32_16x16x32_bf16 v[92:95], v[8:11], v[60:63], v[92:95]
L_ac4:
    s_bitcmp1_b32 s51, 5
    s_cbranch_scc0 L_ac5
    v_mfma_f32_16x16x32_bf16 v[88:91], v[10:13], v[64:67], v[88:91]
    v_mfma_f32_16x16x32_bf16 v[92:95], v[8:11], v[64:67], v[92:95]
    v_mfma_f32_16x16x32_bf16 v[88:91], v[10:13], v[68:71], v[88:91]
    v_mfma_f32_16x16x32_bf16 v[92:95], v[8:11], v[68:71], v[92:95]
L_ac5:
    s_bitcmp1_b32 s51, 6
    s_cbranch_scc0 L_ac6
    v_mfma_f32_16x16x32_bf16 v[88:91], v[10:13], v[72:75], v[88:91]
    v_mfma_f32_16x16x32_bf16 v[92:95], v[8:11], v[72:75], v[92:95]
    v_mfma_f32_16x16x32_bf16 v[88:91], v[10:13], v[76:79], v[88:91]
    v_mfma_f32_16x16x32_bf16 v[92:95], v[8:11], v[76:79], v[92:95]
L_ac6:
    s_mov_b32 s51, 0
    s_cmp_eq_u32 s52, 1
    s_cbranch_scc1 L_poll1
    s_cmp_eq_u32 s52, 2
    s_cbranch_scc1 L_poll2
    s_cmp_eq_u32 s52, 3
    s_cbranch_scc1 L_poll3
    s_cmp_eq_u32 s52, 4
    s_cbranch_scc1 L_poll4
    s_cmp_eq_u32 s52, 5
    s_cbranch_scc1 L_poll5
    s_cmp_eq_u32 s52, 6
    s_cbranch_scc1 L_poll6
    s_branch L_poll7
L_fin:
    s_andn2_b32 s46, s51, s47
    s_cmp_eq_u32 s52, 0
    s_cbranch_scc1 L_pw0
    s_cmp_eq_u32 s52, 1
    s_cbranch_scc1 L_pw1
    s_cmp_eq_u32 s52, 2
    s_cbranch_scc1 L_pw2
    s_cmp_eq_u32 s52, 3
    s_cbranch_scc1 L_pw3
    s_cmp_eq_u32 s52, 4
    s_cbranch_scc1 L_pw4
    s_cmp_eq_u32 s52, 5
    s_cbranch_scc1 L_pw5
    s_cmp_eq_u32 s52, 6
    s_cbranch_scc1 L_pw6
    s_waitcnt vmcnt(2)
    s_branch L_pwd
L_pw0:
    s_waitcnt vmcnt(16)
    s_branch L_pwd
L_pw1:
    s_waitcnt vmcnt(14)
    s_branch L_pwd
L_pw2:
    s_waitcnt vmcnt(12)
    s_branch L_pwd
L_pw3:
    s_waitcnt vmcnt(10)
    s_branch L_pwd
L_pw4:
    s_waitcnt vmcnt(8)
    s_branch L_pwd
L_pw5:
    s_waitcnt vmcnt(6)
    s_branch L_pwd
L_pw6:
    s_waitcnt vmcnt(4)
L_pwd:
    v_mfma_f32_16x16x32_bf16 v[120:123], v[96:99], v[104:107], 0
    v_mfma_f32_16x16x32_bf16 v[124:127], v[96:99], v[108:111], 0
    v_mfma_f32_16x16x32_bf16 v[128:131], v[96:99], v[112:115], 0
    v_mfma_f32_16x16x32_bf16 v[132:135], v[96:99], v[116:119], 0
    s_bitcmp1_b32 s47, 0
    s_cbranch_scc0 L_ao0
    v_mfma_f32_16x16x32_bf16 v[88:91], v[10:13], v[24:27], v[88:91]
    v_mfma_f32_16x16x32_bf16 v[92:95], v[8:11], v[24:27], v[92:95]
    v_mfma_f32_16x16x32_bf16 v[88:91], v[10:13], v[28:31], v[88:91]
    v_mfma_f32_16x16x32_bf16 v[92:95], v[8:11], v[28:31], v[92:95]
L_ao0:
    s_bitcmp1_b32 s47, 1
    s_cbranch_scc0 L_ao1
    v_mfma_f32_16x16x32_bf16 v[88:91], v[10:13], v[32:35], v[88:91]
    v_mfma_f32_16x16x32_bf16 v[92:95], v[8:11], v[32:35], v[92:95]
    v_mfma_f32_16x16x32_bf16 v[88:91], v[10:13], v[36:39], v[88:91]
    v_mfma_f32_16x16x32_bf16 v[92:95], v[8:11], v[36:39], v[92:95]
L_ao1:
    s_bitcmp1_b32 s47, 2
    s_cbranch_scc0 L_ao2
    v_mfma_f32_16x16x32_bf16 v[88:91], v[10:13], v[40:43], v[88:91]
    v_mfma_f32_16x16x32_bf16 v[92:95], v[8:11], v[40:43], v[92:95]
    v_mfma_f32_16x16x32_bf16 v[88:91], v[10:13], v[44:47], v[88:91]
    v_mfma_f32_16x16x32_bf16 v[92:95], v[8:11], v[44:47], v[92:95]
L_ao2:
    s_bitcmp1_b32 s47, 3
    s_cbranch_scc0 L_ao3
    v_mfma_f32_16x16x32_bf16 v[88:91], v[10:13], v[48:51], v[88:91]
    v_mfma_f32_16x16x32_bf16 v[92:95], v[8:11], v[48:51], v[92:95]
    v_mfma_f32_16x16x32_bf16 v[88:91], v[10:13], v[52:55], v[88:91]
    v_mfma_f32_16x16x32_bf16 v[92:95], v[8:11], v[52:55], v[92:95]
L_ao3:
    s_bitcmp1_b32 s47, 4
    s_cbranch_scc0 L_ao4
    v_mfma_f32_16x16x32_bf16 v[88:91], v[10:13], v[56:59], v[88:91]
    v_mfma_f32_16x16x32_bf16 v[92:95], v[8:11], v[56:59], v[92:95]
    v_mfma_f32_16x16x32_bf16 v[88:91], v[10:13], v[60:63], v[88:91]
    v_mfma_f32_16x16x32_bf16 v[92:95], v[8:11], v[60:63], v[92:95]
L_ao4:
    s_bitcmp1_b32 s47, 5
    s_cbranch_scc0 L_ao5
    v_mfma_f32_16x16x32_bf16 v[88:91], v[10:13], v[64:67], v[88:91]
    v_mfma_f32_16x16x32_bf16 v[92:95], v[8:11], v[64:67], v[92:95]
    v_mfma_f32_16x16x32_bf16 v[88:91], v[10:13], v[68:71], v[88:91]
    v_mfma_f32_16x16x32_bf16 v[92:95], v[8:11], v[68:71], v[92:95]
L_ao5:
    s_bitcmp1_b32 s47, 6
    s_cbranch_scc0 L_ao6
    v_mfma_f32_16x16x32_bf16 v[88:91], v[10:13], v[72:75], v[88:91]
    v_mfma_f32_16x16x32_bf16 v[92:95], v[8:11], v[72:75], v[92:95]
    v_mfma_f32_16x16x32_bf16 v[88:91], v[10:13], v[76:79], v[88:91]
    v_mfma_f32_16x16x32_bf16 v[92:95], v[8:11], v[76:79], v[92:95]
L_ao6:
    v_cvt_pk_bf16_f32 v136, v120, v121
    v_cvt_pk_bf16_f32 v137, v122, v123
    v_cvt_pk_bf16_f32 v140, v124, v125
    v_cvt_pk_bf16_f32 v141, v126, v127
    v_cvt_pk_bf16_f32 v144, v128, v129
    v_cvt_pk_bf16_f32 v145, v130, v131
    v_cvt_pk_bf16_f32 v148, v132, v133
    v_cvt_pk_bf16_f32 v149, v134, v135
    s_nop 0
    v_mfma_f32_16x16x32_bf16 v[152:155], v[200:203], v[136:139], v[168:171]
    v_mfma_f32_16x16x32_bf16 v[156:159], v[200:203], v[140:143], v[168:171]
    v_mfma_f32_16x16x32_bf16 v[160:163], v[200:203], v[144:147], v[168:171]
    v_mfma_f32_16x16x32_bf16 v[164:167], v[200:203], v[148:151], v[168:171]
    s_bitcmp1_b32 s46, 0
    s_cbranch_scc0 L_an0
    s_waitcnt vmcnt(14)
    v_mfma_f32_16x16x32_bf16 v[88:91], v[10:13], v[24:27], v[88:91]
    v_mfma_f32_16x16x32_bf16 v[92:95], v[8:11], v[24:27], v[92:95]
    v_mfma_f32_16x16x32_bf16 v[88:91], v[10:13], v[28:31], v[88:91]
    v_mfma_f32_16x16x32_bf16 v[92:95], v[8:11], v[28:31], v[92:95]
L_an0:
    s_bitcmp1_b32 s46, 1
    s_cbranch_scc0 L_an1
    s_waitcnt vmcnt(12)
    v_mfma_f32_16x16x32_bf16 v[88:91], v[10:13], v[32:35], v[88:91]
    v_mfma_f32_16x16x32_bf16 v[92:95], v[8:11], v[32:35], v[92:95]
    v_mfma_f32_16x16x32_bf16 v[88:91], v[10:13], v[36:39], v[88:91]
    v_mfma_f32_16x16x32_bf16 v[92:95], v[8:11], v[36:39], v[92:95]
L_an1:
    s_bitcmp1_b32 s46, 2
    s_cbranch_scc0 L_an2
    s_waitcnt vmcnt(10)
    v_mfma_f32_16x16x32_bf16 v[88:91], v[10:13], v[40:43], v[88:91]
    v_mfma_f32_16x16x32_bf16 v[92:95], v[8:11], v[40:43], v[92:95]
    v_mfma_f32_16x16x32_bf16 v[88:91], v[10:13], v[44:47], v[88:91]
    v_mfma_f32_16x16x32_bf16 v[92:95], v[8:11], v[44:47], v[92:95]
L_an2:
    s_bitcmp1_b32 s46, 3
    s_cbranch_scc0 L_an3
    s_waitcnt vmcnt(8)
    v_mfma_f32_16x16x32_bf16 v[88:91], v[10:13], v[48:51], v[88:91]
    v_mfma_f32_16x16x32_bf16 v[92:95], v[8:11], v[48:51], v[92:95]
    v_mfma_f32_16x16x32_bf16 v[88:91], v[10:13], v[52:55], v[88:91]
    v_mfma_f32_16x16x32_bf16 v[92:95], v[8:11], v[52:55], v[92:95]
L_an3:
    s_bitcmp1_b32 s46, 4
    s_cbranch_scc0 L_an4
    s_waitcnt vmcnt(6)
    v_mfma_f32_16x16x32_bf16 v[88:91], v[10:13], v[56:59], v[88:91]
    v_mfma_f32_16x16x32_bf16 v[92:95], v[8:11], v[56:59], v[92:95]
    v_mfma_f32_16x16x32_bf16 v[88:91], v[10:13], v[60:63], v[88:91]
    v_mfma_f32_16x16x32_bf16 v[92:95], v[8:11], v[60:63], v[92:95]
L_an4:
    s_bitcmp1_b32 s46, 5
    s_cbranch_scc0 L_an5
    s_waitcnt vmcnt(4)
    v_mfma_f32_16x16x32_bf16 v[88:91], v[10:13], v[64:67], v[88:91]
    v_mfma_f32_16x16x32_bf16 v[92:95], v[8:11], v[64:67], v[92:95]
    v_mfma_f32_16x16x32_bf16 v[88:91], v[10:13], v[68:71], v[88:91]
    v_mfma_f32_16x16x32_bf16 v[92:95], v[8:11], v[68:71], v[92:95]
L_an5:
    s_bitcmp1_b32 s46, 6
    s_cbranch_scc0 L_an6
    s_waitcnt vmcnt(2)
    v_mfma_f32_16x16x32_bf16 v[88:91], v[10:13], v[72:75], v[88:91]
    v_mfma_f32_16x16x32_bf16 v[92:95], v[8:11], v[72:75], v[92:95]
    v_mfma_f32_16x16x32_bf16 v[88:91], v[10:13], v[76:79], v[88:91]
    v_mfma_f32_16x16x32_bf16 v[92:95], v[8:11], v[76:79], v[92:95]
L_an6:
    s_bitcmp1_b32 s46, 7
    s_cbranch_scc0 L_an7
    s_waitcnt vmcnt(0)
    v_mfma_f32_16x16x32_bf16 v[88:91], v[10:13], v[80:83], v[88:91]
    v_mfma_f32_16x16x32_bf16 v[92:95], v[8:11], v[80:83], v[92:95]
    v_mfma_f32_16x16x32_bf16 v[88:91], v[10:13], v[84:87], v[88:91]
    v_mfma_f32_16x16x32_bf16 v[92:95], v[8:11], v[84:87], v[92:95]
L_an7:
    s_nop 3
    v_rcp_f32 v152, v152
    v_rcp_f32 v156, v156
    v_rcp_f32 v160, v160
    v_rcp_f32 v164, v164
    v_cvt_pk_bf16_f32 v172, v88, v89
    v_cvt_pk_bf16_f32 v173, v90, v91
    v_cvt_pk_bf16_f32 v174, v92, v93
    v_cvt_pk_bf16_f32 v175, v94, v95
    ds_write_b128 v6, v[172:175]
    ds_write_b32 v21, v232 offset:40
    ds_read_b32 v235, v18 offset:40
    ds_read_b128 v[176:179], v7
    v_mfma_f32_16x16x32_bf16 v[24:27], v[172:175], v[104:107], 0
    v_mfma_f32_16x16x32_bf16 v[28:31], v[172:175], v[108:111], 0
    v_mfma_f32_16x16x32_bf16 v[32:35], v[172:175], v[112:115], 0
    v_mfma_f32_16x16x32_bf16 v[36:39], v[172:175], v[116:119], 0
    s_mov_b32 s45, 0
    s_nop 3
    s_cmp_eq_u32 s40, 0
    v_mul_f32 v24, v24, v152
    v_mul_f32 v25, v25, v152
    v_mul_f32 v26, v26, v152
    v_mul_f32 v27, v27, v152
    v_mul_f32 v28, v28, v156
    v_mul_f32 v29, v29, v156
    v_mul_f32 v30, v30, v156
    v_mul_f32 v31, v31, v156
    v_mul_f32 v32, v32, v160
    v_mul_f32 v33, v33, v160
    v_mul_f32 v34, v34, v160
    v_mul_f32 v35, v35, v160
    v_mul_f32 v36, v36, v164
    v_mul_f32 v37, v37, v164
    v_mul_f32 v38, v38, v164
    v_mul_f32 v39, v39, v164
    s_cbranch_scc0 L_o1
    v_cvt_pk_bf16_f32 v56, v24, v25
    v_cvt_pk_bf16_f32 v57, v26, v27
    v_cvt_pk_bf16_f32 v60, v28, v29
    v_cvt_pk_bf16_f32 v61, v30, v31
    v_cvt_pk_bf16_f32 v64, v32, v33
    v_cvt_pk_bf16_f32 v65, v34, v35
    v_cvt_pk_bf16_f32 v68, v36, v37
    v_cvt_pk_bf16_f32 v69, v38, v39
    s_branch L_ks0g
L_ks0:
    ds_read_b32 v235, v18 offset:40
    ds_read_b128 v[176:179], v7
L_ks0g:
    s_add_u32 s45, s45, 1
    s_waitcnt lgkmcnt(0)
    v_readfirstlane_b32 s46, v235
    s_cmp_gt_u32 s45, 0x40000
    s_cbranch_scc1 L_kd0
    s_cmp_eq_u32 s46, 0
    s_cbranch_scc1 L_ks0
L_kd0:
    v_mfma_f32_16x16x32_bf16 v[40:43], v[176:179], v[104:107], 0
    v_mfma_f32_16x16x32_bf16 v[44:47], v[176:179], v[108:111], 0
    v_mfma_f32_16x16x32_bf16 v[48:51], v[176:179], v[112:115], 0
    v_mfma_f32_16x16x32_bf16 v[52:55], v[176:179], v[116:119], 0
    s_nop 4
    v_mul_f32 v40, v40, v152
    v_mul_f32 v41, v41, v152
    v_mul_f32 v42, v42, v152
    v_mul_f32 v43, v43, v152
    v_cvt_pk_bf16_f32 v58, v40, v41
    v_cvt_pk_bf16_f32 v59, v42, v43
    buffer_store_dwordx4 v[56:59], v5, s[60:63], s48 offen sc1
    s_add_u32 s48, s48, 0x8000
    v_mul_f32 v44, v44, v156
    v_mul_f32 v45, v45, v156
    v_mul_f32 v46, v46, v156
    v_mul_f32 v47, v47, v156
    v_cvt_pk_bf16_f32 v62, v44, v45
    v_cvt_pk_bf16_f32 v63, v46, v47
    buffer_store_dwordx4 v[60:63], v5, s[60:63], s48 offen sc1
    s_add_u32 s48, s48, 0x8000
    v_mul_f32 v48, v48, v160
    v_mul_f32 v49, v49, v160
    v_mul_f32 v50, v50, v160
    v_mul_f32 v51, v51, v160
    v_cvt_pk_bf16_f32 v66, v48, v49
    v_cvt_pk_bf16_f32 v67, v50, v51
    buffer_store_dwordx4 v[64:67], v5, s[60:63], s48 offen sc1
    s_add_u32 s48, s48, 0x8000
    v_mul_f32 v52, v52, v164
    v_mul_f32 v53, v53, v164
    v_mul_f32 v54, v54, v164
    v_mul_f32 v55, v55, v164
    v_cvt_pk_bf16_f32 v70, v52, v53
    v_cvt_pk_bf16_f32 v71, v54, v55
    buffer_store_dwordx4 v[68:71], v5, s[60:63], s48 offen sc1
    s_branch L_o2
L_o1:
    v_cvt_pk_bf16_f32 v58, v24, v25
    v_cvt_pk_bf16_f32 v59, v26, v27
    v_cvt_pk_bf16_f32 v62, v28, v29
    v_cvt_pk_bf16_f32 v63, v30, v31
    v_cvt_pk_bf16_f32 v66, v32, v33
    v_cvt_pk_bf16_f32 v67, v34, v35
    v_cvt_pk_bf16_f32 v70, v36, v37
    v_cvt_pk_bf16_f32 v71, v38, v39
    s_branch L_ks1g
L_ks1:
    ds_read_b32 v235, v18 offset:40
    ds_read_b128 v[176:179], v7
L_ks1g:
    s_add_u32 s45, s45, 1
    s_waitcnt lgkmcnt(0)
    v_readfirstlane_b32 s46, v235
    s_cmp_gt_u32 s45, 0x40000
    s_cbranch_scc1 L_kd1
    s_cmp_eq_u32 s46, 0
    s_cbranch_scc1 L_ks1
L_kd1:
    v_mfma_f32_16x16x32_bf16 v[40:43], v[176:179], v[104:107], 0
    v_mfma_f32_16x16x32_bf16 v[44:47], v[176:179], v[108:111], 0
    v_mfma_f32_16x16x32_bf16 v[48:51], v[176:179], v[112:115], 0
    v_mfma_f32_16x16x32_bf16 v[52:55], v[176:179], v[116:119], 0
    s_nop 4
    v_mul_f32 v40, v40, v152
    v_mul_f32 v41, v41, v152
    v_mul_f32 v42, v42, v152
    v_mul_f32 v43, v43, v152
    v_cvt_pk_bf16_f32 v56, v40, v41
    v_cvt_pk_bf16_f32 v57, v42, v43
    buffer_store_dwordx4 v[56:59], v5, s[60:63], s48 offen sc1
    s_add_u32 s48, s48, 0x8000
    v_mul_f32 v44, v44, v156
    v_mul_f32 v45, v45, v156
    v_mul_f32 v46, v46, v156
    v_mul_f32 v47, v47, v156
    v_cvt_pk_bf16_f32 v60, v44, v45
    v_cvt_pk_bf16_f32 v61, v46, v47
    buffer_store_dwordx4 v[60:63], v5, s[60:63], s48 offen sc1
    s_add_u32 s48, s48, 0x8000
    v_mul_f32 v48, v48, v160
    v_mul_f32 v49, v49, v160
    v_mul_f32 v50, v50, v160
    v_mul_f32 v51, v51, v160
    v_cvt_pk_bf16_f32 v64, v48, v49
    v_cvt_pk_bf16_f32 v65, v50, v51
    buffer_store_dwordx4 v[64:67], v5, s[60:63], s48 offen sc1
    s_add_u32 s48, s48, 0x8000
    v_mul_f32 v52, v52, v164
    v_mul_f32 v53, v53, v164
    v_mul_f32 v54, v54, v164
    v_mul_f32 v55, v55, v164
    v_cvt_pk_bf16_f32 v68, v52, v53
    v_cvt_pk_bf16_f32 v69, v54, v55
    buffer_store_dwordx4 v[68:71], v5, s[60:63], s48 offen sc1
L_o2:
    s_lshl_b32 s59, s34, 3
    s_lshl_b32 s45, s3, 1
    s_add_u32 s59, s59, s45
    s_lshl_b32 s45, s59, 15
    s_add_u32 s45, s45, 0x400000
    v_add_u32 v242, 0x8000, v5
    s_mov_b32 s51, 0x55555555
    s_add_u32 s64, s26, s45
    s_addc_u32 s65, s27, 0
    s_mov_b32 s66, 0x10000
    s_mov_b32 s67, 0x20000
    s_lshl_b32 s52, s34, 8
    s_lshl_b32 s46, s3, 6
    s_add_u32 s52, s52, s46
    s_lshr_b32 vcc_lo, s52, 6
    s_mul_i32 vcc_lo, vcc_lo, 1984
    s_add_u32 s52, s52, vcc_lo
    s_add_u32 s52, s52, 0x980000
    s_lshl_b32 vcc_lo, s35, 7
    s_add_u32 s52, s52, vcc_lo
    v_lshrrev_b32 v6, 2, v4
    v_lshlrev_b32 v6, 7, v6
    v_and_b32 v7, 3, v4
    v_lshl_add_u32 v6, v7, 3, v6
    v_bfe_u32 v7, v4, 3, 1
    v_lshl_add_u32 v6, v7, 6, v6
    v_lshl_add_u32 v236, v23, 5, v6
    v_xor_b32 v237, 32, v236
    v_xor_b32 v238, 64, v236
    v_xor_b32 v239, 0x60, v236
    s_lshl_b32 s57, s3, 11
    s_add_u32 s57, s57, 131584
    v_lshrrev_b32 v7, 5, v4
    v_lshl_add_u32 v6, v23, 1, v7
    v_and_b32 v7, 7, v4
    v_xor_b32 v6, v6, v7
    v_lshlrev_b32 v6, 4, v6
    v_and_b32 v3, 15, v4
    v_lshl_add_u32 v6, v3, 7, v6
    v_add_u32 v15, s57, v6
    v_xor_b32 v18, 64, v15
    v_lshrrev_b32 v6, 3, v4
    v_lshlrev_b32 v3, 4, v7
    v_lshl_add_u32 v17, v6, 12, v3
    v_xor_b32 v7, v7, v6
    v_lshlrev_b32 v7, 4, v7
    v_lshl_add_u32 v6, v6, 7, v7
    v_add_u32 v16, s57, v6
    s_mov_b32 s50, 0
    s_mov_b32 s53, 0
    s_mov_b32 s54, 0
    s_lshl_b32 s55, s40, 4
    v_mov_b64 v[120:121], 0
    v_mov_b64 v[122:123], 0
    v_mov_b64 v[124:125], 0
    v_mov_b64 v[126:127], 0
    v_mov_b64 v[128:129], 0
    v_mov_b64 v[130:131], 0
    v_mov_b64 v[132:133], 0
    v_mov_b64 v[134:135], 0
    v_mov_b64 v[136:137], 0
    v_mov_b64 v[138:139], 0
    v_mov_b64 v[140:141], 0
    v_mov_b64 v[142:143], 0
    v_mov_b64 v[144:145], 0
    v_mov_b64 v[146:147], 0
    v_mov_b64 v[148:149], 0
    v_mov_b64 v[150:151], 0
    s_waitcnt vmcnt(0)
    s_mov_b64 exec, 0xffff
    buffer_store_dword v234, v254, s[60:63], s49 offen sc1
    s_mov_b64 exec, -1
    s_setprio 2
    s_cmp_lg_u32 s50, 0
    s_cbranch_scc1 L_sel0_ok
    s_mov_b32 s45, 0
    s_cmp_lg_u32 s51, 0
    s_cbranch_scc1 L_sel0
    s_mov_b32 s66, 0
    s_mov_b32 s50, 0x55555555
    s_branch L_sel0_ok
L_sel0:
    ds_read_b32 v235, v14 offset:64
    ds_read_b32 v13, v20 offset:60
    s_add_u32 s45, s45, 1
    s_waitcnt lgkmcnt(0)
    v_and_b32 v13, v13, v235
    s_cmp_gt_u32 s45, 0x40000
    s_cselect_b32 s46, -1, 0
    v_readfirstlane_b32 s50, v13
    s_nop 3
    s_or_b32 s50, s50, s46
    s_and_b32 s50, s50, s51
    s_cbranch_scc1 L_sel0_ok
    s_cmp_lg_u32 s54, 0x5555
    s_cbranch_scc1 L_sel0_p
    s_sleep 1
    s_branch L_sel0
L_sel0_p:
    s_load_dwordx16 s[4:19], s[26:27], s52 glc
    s_add_u32 s45, s45, 8
    s_waitcnt lgkmcnt(0)
    s_mov_b32 s54, 0
    s_cmp_eq_u64 s[4:5], s[72:73]
    s_cselect_b32 s46, 0x1, 0
    s_or_b32 s54, s54, s46
    s_cmp_eq_u64 s[6:7], s[72:73]
    s_cselect_b32 s46, 0x4, 0
    s_or_b32 s54, s54, s46
    s_cmp_eq_u64 s[8:9], s[72:73]
    s_cselect_b32 s46, 0x10, 0
    s_or_b32 s54, s54, s46
    s_cmp_eq_u64 s[10:11], s[72:73]
    s_cselect_b32 s46, 0x40, 0
    s_or_b32 s54, s54, s46
    s_cmp_eq_u64 s[12:13], s[72:73]
    s_cselect_b32 s46, 0x100, 0
    s_or_b32 s54, s54, s46
    s_cmp_eq_u64 s[14:15], s[72:73]
    s_cselect_b32 s46, 0x400, 0
    s_or_b32 s54, s54, s46
    s_cmp_eq_u64 s[16:17], s[72:73]
    s_cselect_b32 s46, 0x1000, 0
    s_or_b32 s54, s54, s46
    s_cmp_eq_u64 s[18:19], s[72:73]
    s_cselect_b32 s46, 0x4000, 0
    s_or_b32 s54, s54, s46
    s_lshl_b32 s46, s54, s55
    v_mov_b32 v235, s46
    s_mov_b64 exec, 1
    ds_or_b32 v14, v235 offset:64
    s_mov_b64 exec, -1
    s_branch L_sel0
L_sel0_ok:
    s_ff1_i32_b32 s46, s50
    s_bitset0_b32 s50, s46
    s_lshl_b32 s48, s46, 10
    s_bitset0_b32 s51, s46
    s_lshl_b32 s28, s46, 12
    buffer_load_dwordx4 v[24:27], v5, s[64:67], s48 offen offset:0 sc1
    buffer_load_dwordx4 v[28:31], v242, s[64:67], s48 offen offset:0 sc1
    buffer_load_dwordx4 v[32:35], v5, s[64:67], s48 offen offset:1024 sc1
    buffer_load_dwordx4 v[36:39], v242, s[64:67], s48 offen offset:1024 sc1
    s_cmp_lg_u32 s50, 0
    s_cbranch_scc1 L_sel1_ok
    s_mov_b32 s45, 0
    s_cmp_lg_u32 s51, 0
    s_cbranch_scc1 L_sel1
    s_mov_b32 s66, 0
    s_mov_b32 s50, 0x55555555
    s_branch L_sel1_ok
L_sel1:
    ds_read_b32 v235, v14 offset:64
    ds_read_b32 v13, v20 offset:60
    s_add_u32 s45, s45, 1
    s_waitcnt lgkmcnt(0)
    v_and_b32 v13, v13, v235
    s_cmp_gt_u32 s45, 0x40000
    s_cselect_b32 s46, -1, 0
    v_readfirstlane_b32 s50, v13
    s_nop 3
    s_or_b32 s50, s50, s46
    s_and_b32 s50, s50, s51
    s_cbranch_scc1 L_sel1_ok
    s_cmp_lg_u32 s54, 0x5555
    s_cbranch_scc1 L_sel1_p
    s_sleep 1
    s_branch L_sel1
L_sel1_p:
    s_load_dwordx16 s[4:19], s[26:27], s52 glc
    s_add_u32 s45, s45, 8
    s_waitcnt lgkmcnt(0)
    s_mov_b32 s54, 0
    s_cmp_eq_u64 s[4:5], s[72:73]
    s_cselect_b32 s46, 0x1, 0
    s_or_b32 s54, s54, s46
    s_cmp_eq_u64 s[6:7], s[72:73]
    s_cselect_b32 s46, 0x4, 0
    s_or_b32 s54, s54, s46
    s_cmp_eq_u64 s[8:9], s[72:73]
    s_cselect_b32 s46, 0x10, 0
    s_or_b32 s54, s54, s46
    s_cmp_eq_u64 s[10:11], s[72:73]
    s_cselect_b32 s46, 0x40, 0
    s_or_b32 s54, s54, s46
    s_cmp_eq_u64 s[12:13], s[72:73]
    s_cselect_b32 s46, 0x100, 0
    s_or_b32 s54, s54, s46
    s_cmp_eq_u64 s[14:15], s[72:73]
    s_cselect_b32 s46, 0x400, 0
    s_or_b32 s54, s54, s46
    s_cmp_eq_u64 s[16:17], s[72:73]
    s_cselect_b32 s46, 0x1000, 0
    s_or_b32 s54, s54, s46
    s_cmp_eq_u64 s[18:19], s[72:73]
    s_cselect_b32 s46, 0x4000, 0
    s_or_b32 s54, s54, s46
    s_lshl_b32 s46, s54, s55
    v_mov_b32 v235, s46
    s_mov_b64 exec, 1
    ds_or_b32 v14, v235 offset:64
    s_mov_b64 exec, -1
    s_branch L_sel1
L_sel1_ok:
    s_ff1_i32_b32 s46, s50
    s_bitset0_b32 s50, s46
    s_lshl_b32 s48, s46, 10
    s_bitset0_b32 s51, s46
    s_lshl_b32 s29, s46, 12
    buffer_load_dwordx4 v[40:43], v5, s[64:67], s48 offen offset:0 sc1
    buffer_load_dwordx4 v[44:47], v242, s[64:67], s48 offen offset:0 sc1
    buffer_load_dwordx4 v[48:51], v5, s[64:67], s48 offen offset:1024 sc1
    buffer_load_dwordx4 v[52:55], v242, s[64:67], s48 offen offset:1024 sc1
    s_cmp_lg_u32 s50, 0
    s_cbranch_scc1 L_sel2_ok
    s_mov_b32 s45, 0
    s_cmp_lg_u32 s51, 0
    s_cbranch_scc1 L_sel2
    s_mov_b32 s66, 0
    s_mov_b32 s50, 0x55555555
    s_branch L_sel2_ok
L_sel2:
    ds_read_b32 v235, v14 offset:64
    ds_read_b32 v13, v20 offset:60
    s_add_u32 s45, s45, 1
    s_waitcnt lgkmcnt(0)
    v_and_b32 v13, v13, v235
    s_cmp_gt_u32 s45, 0x40000
    s_cselect_b32 s46, -1, 0
    v_readfirstlane_b32 s50, v13
    s_nop 3
    s_or_b32 s50, s50, s46
    s_and_b32 s50, s50, s51
    s_cbranch_scc1 L_sel2_ok
    s_cmp_lg_u32 s54, 0x5555
    s_cbranch_scc1 L_sel2_p
    s_sleep 1
    s_branch L_sel2
L_sel2_p:
    s_load_dwordx16 s[4:19], s[26:27], s52 glc
    s_add_u32 s45, s45, 8
    s_waitcnt lgkmcnt(0)
    s_mov_b32 s54, 0
    s_cmp_eq_u64 s[4:5], s[72:73]
    s_cselect_b32 s46, 0x1, 0
    s_or_b32 s54, s54, s46
    s_cmp_eq_u64 s[6:7], s[72:73]
    s_cselect_b32 s46, 0x4, 0
    s_or_b32 s54, s54, s46
    s_cmp_eq_u64 s[8:9], s[72:73]
    s_cselect_b32 s46, 0x10, 0
    s_or_b32 s54, s54, s46
    s_cmp_eq_u64 s[10:11], s[72:73]
    s_cselect_b32 s46, 0x40, 0
    s_or_b32 s54, s54, s46
    s_cmp_eq_u64 s[12:13], s[72:73]
    s_cselect_b32 s46, 0x100, 0
    s_or_b32 s54, s54, s46
    s_cmp_eq_u64 s[14:15], s[72:73]
    s_cselect_b32 s46, 0x400, 0
    s_or_b32 s54, s54, s46
    s_cmp_eq_u64 s[16:17], s[72:73]
    s_cselect_b32 s46, 0x1000, 0
    s_or_b32 s54, s54, s46
    s_cmp_eq_u64 s[18:19], s[72:73]
    s_cselect_b32 s46, 0x4000, 0
    s_or_b32 s54, s54, s46
    s_lshl_b32 s46, s54, s55
    v_mov_b32 v235, s46
    s_mov_b64 exec, 1
    ds_or_b32 v14, v235 offset:64
    s_mov_b64 exec, -1
    s_branch L_sel2
L_sel2_ok:
    s_ff1_i32_b32 s46, s50
    s_bitset0_b32 s50, s46
    s_lshl_b32 s48, s46, 10
    s_bitset0_b32 s51, s46
    s_lshl_b32 s30, s46, 12
    buffer_load_dwordx4 v[56:59], v5, s[64:67], s48 offen offset:0 sc1
    buffer_load_dwordx4 v[60:63], v242, s[64:67], s48 offen offset:0 sc1
    buffer_load_dwordx4 v[64:67], v5, s[64:67], s48 offen offset:1024 sc1
    buffer_load_dwordx4 v[68:71], v242, s[64:67], s48 offen offset:1024 sc1
    v_add_u32 v8, s28, v236
    v_add_u32 v9, s28, v237
    v_add_u32 v10, s28, v238
    v_add_u32 v11, s28, v239
    ds_read_b64_tr_b16 v[88:89], v8 offset:0
    ds_read_b64_tr_b16 v[90:91], v8 offset:2048
    ds_read_b64_tr_b16 v[92:93], v9 offset:0
    ds_read_b64_tr_b16 v[94:95], v9 offset:2048
    ds_read_b64_tr_b16 v[96:97], v10 offset:0
    ds_read_b64_tr_b16 v[98:99], v10 offset:2048
    ds_read_b64_tr_b16 v[100:101], v11 offset:0
    ds_read_b64_tr_b16 v[102:103], v11 offset:2048
L_gloop:
    s_cmp_lg_u32 s50, 0
    s_cbranch_scc1 L_sel3_ok
    s_mov_b32 s45, 0
    s_cmp_lg_u32 s51, 0
    s_cbranch_scc1 L_sel3
    s_mov_b32 s66, 0
    s_mov_b32 s50, 0x55555555
    s_branch L_sel3_ok
L_sel3:
    ds_read_b32 v235, v14 offset:64
    ds_read_b32 v13, v20 offset:60
    s_add_u32 s45, s45, 1
    s_waitcnt lgkmcnt(0)
    v_and_b32 v13, v13, v235
    s_cmp_gt_u32 s45, 0x40000
    s_cselect_b32 s46, -1, 0
    v_readfirstlane_b32 s50, v13
    s_nop 3
    s_or_b32 s50, s50, s46
    s_and_b32 s50, s50, s51
    s_cbranch_scc1 L_sel3_ok
    s_cmp_lg_u32 s54, 0x5555
    s_cbranch_scc1 L_sel3_p
    s_sleep 1
    s_branch L_sel3
L_sel3_p:
    s_load_dwordx16 s[4:19], s[26:27], s52 glc
    s_add_u32 s45, s45, 8
    s_waitcnt lgkmcnt(0)
    s_mov_b32 s54, 0
    s_cmp_eq_u64 s[4:5], s[72:73]
    s_cselect_b32 s46, 0x1, 0
    s_or_b32 s54, s54, s46
    s_cmp_eq_u64 s[6:7], s[72:73]
    s_cselect_b32 s46, 0x4, 0
    s_or_b32 s54, s54, s46
    s_cmp_eq_u64 s[8:9], s[72:73]
    s_cselect_b32 s46, 0x10, 0
    s_or_b32 s54, s54, s46
    s_cmp_eq_u64 s[10:11], s[72:73]
    s_cselect_b32 s46, 0x40, 0
    s_or_b32 s54, s54, s46
    s_cmp_eq_u64 s[12:13], s[72:73]
    s_cselect_b32 s46, 0x100, 0
    s_or_b32 s54, s54, s46
    s_cmp_eq_u64 s[14:15], s[72:73]
    s_cselect_b32 s46, 0x400, 0
    s_or_b32 s54, s54, s46
    s_cmp_eq_u64 s[16:17], s[72:73]
    s_cselect_b32 s46, 0x1000, 0
    s_or_b32 s54, s54, s46
    s_cmp_eq_u64 s[18:19], s[72:73]
    s_cselect_b32 s46, 0x4000, 0
    s_or_b32 s54, s54, s46
    s_lshl_b32 s46, s54, s55
    v_mov_b32 v235, s46
    s_mov_b64 exec, 1
    ds_or_b32 v14, v235 offset:64
    s_mov_b64 exec, -1
    s_branch L_sel3
L_sel3_ok:
    s_waitcnt vmcnt(10) lgkmcnt(0)
    v_mfma_f32_16x16x32_bf16 v[120:123], v[88:91], v[24:27], v[120:123]
    ds_read_b64_tr_b16 v[104:105], v8 offset:4096
    ds_read_b64_tr_b16 v[106:107], v8 offset:6144
    v_mfma_f32_16x16x32_bf16 v[124:127], v[92:95], v[24:27], v[124:127]
    ds_read_b64_tr_b16 v[108:109], v9 offset:4096
    ds_read_b64_tr_b16 v[110:111], v9 offset:6144
    v_mfma_f32_16x16x32_bf16 v[128:131], v[96:99], v[24:27], v[128:131]
    ds_read_b64_tr_b16 v[112:113], v10 offset:4096
    ds_read_b64_tr_b16 v[114:115], v10 offset:6144
    v_mfma_f32_16x16x32_bf16 v[132:135], v[100:103], v[24:27], v[132:135]
    ds_read_b64_tr_b16 v[116:117], v11 offset:4096
    ds_read_b64_tr_b16 v[118:119], v11 offset:6144
    v_mfma_f32_16x16x32_bf16 v[136:139], v[88:91], v[28:31], v[136:139]
    v_add_u32 v244, s29, v236
    v_add_u32 v245, s29, v237
    v_mfma_f32_16x16x32_bf16 v[140:143], v[92:95], v[28:31], v[140:143]
    v_add_u32 v246, s29, v238
    v_add_u32 v247, s29, v239
    v_mfma_f32_16x16x32_bf16 v[144:147], v[96:99], v[28:31], v[144:147]
    s_ff1_i32_b32 s46, s50
    s_bitset0_b32 s50, s46
    v_mfma_f32_16x16x32_bf16 v[148:151], v[100:103], v[28:31], v[148:151]
    s_lshl_b32 s48, s46, 10
    s_bitset0_b32 s51, s46
    s_waitcnt vmcnt(8) lgkmcnt(0)
    v_mfma_f32_16x16x32_bf16 v[120:123], v[104:107], v[32:35], v[120:123]
    ds_read_b64_tr_b16 v[88:89], v244 offset:0
    ds_read_b64_tr_b16 v[90:91], v244 offset:2048
    v_mfma_f32_16x16x32_bf16 v[124:127], v[108:111], v[32:35], v[124:127]
    ds_read_b64_tr_b16 v[92:93], v245 offset:0
    ds_read_b64_tr_b16 v[94:95], v245 offset:2048
    v_mfma_f32_16x16x32_bf16 v[128:131], v[112:115], v[32:35], v[128:131]
    ds_read_b64_tr_b16 v[96:97], v246 offset:0
    ds_read_b64_tr_b16 v[98:99], v246 offset:2048
    v_mfma_f32_16x16x32_bf16 v[132:135], v[116:119], v[32:35], v[132:135]
    ds_read_b64_tr_b16 v[100:101], v247 offset:0
    ds_read_b64_tr_b16 v[102:103], v247 offset:2048
    v_mfma_f32_16x16x32_bf16 v[136:139], v[104:107], v[36:39], v[136:139]
    buffer_load_dwordx4 v[72:75], v5, s[64:67], s48 offen offset:0 sc1
    s_lshl_b32 s31, s46, 12
    v_mfma_f32_16x16x32_bf16 v[140:143], v[108:111], v[36:39], v[140:143]
    buffer_load_dwordx4 v[76:79], v242, s[64:67], s48 offen offset:0 sc1
    v_mfma_f32_16x16x32_bf16 v[144:147], v[112:115], v[36:39], v[144:147]
    buffer_load_dwordx4 v[80:83], v5, s[64:67], s48 offen offset:1024 sc1
    v_mfma_f32_16x16x32_bf16 v[148:151], v[116:119], v[36:39], v[148:151]
    buffer_load_dwordx4 v[84:87], v242, s[64:67], s48 offen offset:1024 sc1
    s_cmp_lg_u32 s50, 0
    s_cbranch_scc1 L_sel4_ok
    s_mov_b32 s45, 0
    s_cmp_lg_u32 s51, 0
    s_cbranch_scc1 L_sel4
    s_mov_b32 s66, 0
    s_mov_b32 s50, 0x55555555
    s_branch L_sel4_ok
L_sel4:
    ds_read_b32 v235, v14 offset:64
    ds_read_b32 v13, v20 offset:60
    s_add_u32 s45, s45, 1
    s_waitcnt lgkmcnt(0)
    v_and_b32 v13, v13, v235
    s_cmp_gt_u32 s45, 0x40000
    s_cselect_b32 s46, -1, 0
    v_readfirstlane_b32 s50, v13
    s_nop 3
    s_or_b32 s50, s50, s46
    s_and_b32 s50, s50, s51
    s_cbranch_scc1 L_sel4_ok
    s_cmp_lg_u32 s54, 0x5555
    s_cbranch_scc1 L_sel4_p
    s_sleep 1
    s_branch L_sel4
L_sel4_p:
    s_load_dwordx16 s[4:19], s[26:27], s52 glc
    s_add_u32 s45, s45, 8
    s_waitcnt lgkmcnt(0)
    s_mov_b32 s54, 0
    s_cmp_eq_u64 s[4:5], s[72:73]
    s_cselect_b32 s46, 0x1, 0
    s_or_b32 s54, s54, s46
    s_cmp_eq_u64 s[6:7], s[72:73]
    s_cselect_b32 s46, 0x4, 0
    s_or_b32 s54, s54, s46
    s_cmp_eq_u64 s[8:9], s[72:73]
    s_cselect_b32 s46, 0x10, 0
    s_or_b32 s54, s54, s46
    s_cmp_eq_u64 s[10:11], s[72:73]
    s_cselect_b32 s46, 0x40, 0
    s_or_b32 s54, s54, s46
    s_cmp_eq_u64 s[12:13], s[72:73]
    s_cselect_b32 s46, 0x100, 0
    s_or_b32 s54, s54, s46
    s_cmp_eq_u64 s[14:15], s[72:73]
    s_cselect_b32 s46, 0x400, 0
    s_or_b32 s54, s54, s46
    s_cmp_eq_u64 s[16:17], s[72:73]
    s_cselect_b32 s46, 0x1000, 0
    s_or_b32 s54, s54, s46
    s_cmp_eq_u64 s[18:19], s[72:73]
    s_cselect_b32 s46, 0x4000, 0
    s_or_b32 s54, s54, s46
    s_lshl_b32 s46, s54, s55
    v_mov_b32 v235, s46
    s_mov_b64 exec, 1
    ds_or_b32 v14, v235 offset:64
    s_mov_b64 exec, -1
    s_branch L_sel4
L_sel4_ok:
    s_waitcnt vmcnt(10) lgkmcnt(0)
    v_mfma_f32_16x16x32_bf16 v[120:123], v[88:91], v[40:43], v[120:123]
    ds_read_b64_tr_b16 v[104:105], v244 offset:4096
    ds_read_b64_tr_b16 v[106:107], v244 offset:6144
    v_mfma_f32_16x16x32_bf16 v[124:127], v[92:95], v[40:43], v[124:127]
    ds_read_b64_tr_b16 v[108:109], v245 offset:4096
    ds_read_b64_tr_b16 v[110:111], v245 offset:6144
    v_mfma_f32_16x16x32_bf16 v[128:131], v[96:99], v[40:43], v[128:131]
    ds_read_b64_tr_b16 v[112:113], v246 offset:4096
    ds_read_b64_tr_b16 v[114:115], v246 offset:6144
    v_mfma_f32_16x16x32_bf16 v[132:135], v[100:103], v[40:43], v[132:135]
    ds_read_b64_tr_b16 v[116:117], v247 offset:4096
    ds_read_b64_tr_b16 v[118:119], v247 offset:6144
    v_mfma_f32_16x16x32_bf16 v[136:139], v[88:91], v[44:47], v[136:139]
    v_add_u32 v8, s30, v236
    v_add_u32 v9, s30, v237
    v_mfma_f32_16x16x32_bf16 v[140:143], v[92:95], v[44:47], v[140:143]
    v_add_u32 v10, s30, v238
    v_add_u32 v11, s30, v239
    v_mfma_f32_16x16x32_bf16 v[144:147], v[96:99], v[44:47], v[144:147]
    s_ff1_i32_b32 s46, s50
    s_bitset0_b32 s50, s46
    v_mfma_f32_16x16x32_bf16 v[148:151], v[100:103], v[44:47], v[148:151]
    s_lshl_b32 s48, s46, 10
    s_bitset0_b32 s51, s46
    s_waitcnt vmcnt(8) lgkmcnt(0)
    v_mfma_f32_16x16x32_bf16 v[120:123], v[104:107], v[48:51], v[120:123]
    ds_read_b64_tr_b16 v[88:89], v8 offset:0
    ds_read_b64_tr_b16 v[90:91], v8 offset:2048
    v_mfma_f32_16x16x32_bf16 v[124:127], v[108:111], v[48:51], v[124:127]
    ds_read_b64_tr_b16 v[92:93], v9 offset:0
    ds_read_b64_tr_b16 v[94:95], v9 offset:2048
    v_mfma_f32_16x16x32_bf16 v[128:131], v[112:115], v[48:51], v[128:131]
    ds_read_b64_tr_b16 v[96:97], v10 offset:0
    ds_read_b64_tr_b16 v[98:99], v10 offset:2048
    v_mfma_f32_16x16x32_bf16 v[132:135], v[116:119], v[48:51], v[132:135]
    ds_read_b64_tr_b16 v[100:101], v11 offset:0
    ds_read_b64_tr_b16 v[102:103], v11 offset:2048
    v_mfma_f32_16x16x32_bf16 v[136:139], v[104:107], v[52:55], v[136:139]
    buffer_load_dwordx4 v[24:27], v5, s[64:67], s48 offen offset:0 sc1
    s_lshl_b32 s28, s46, 12
    v_mfma_f32_16x16x32_bf16 v[140:143], v[108:111], v[52:55], v[140:143]
    buffer_load_dwordx4 v[28:31], v242, s[64:67], s48 offen offset:0 sc1
    v_mfma_f32_16x16x32_bf16 v[144:147], v[112:115], v[52:55], v[144:147]
    buffer_load_dwordx4 v[32:35], v5, s[64:67], s48 offen offset:1024 sc1
    v_mfma_f32_16x16x32_bf16 v[148:151], v[116:119], v[52:55], v[148:151]
    buffer_load_dwordx4 v[36:39], v242, s[64:67], s48 offen offset:1024 sc1
    s_cmp_lg_u32 s50, 0
    s_cbranch_scc1 L_sel5_ok
    s_mov_b32 s45, 0
    s_cmp_lg_u32 s51, 0
    s_cbranch_scc1 L_sel5
    s_mov_b32 s66, 0
    s_mov_b32 s50, 0x55555555
    s_branch L_sel5_ok
L_sel5:
    ds_read_b32 v235, v14 offset:64
    ds_read_b32 v13, v20 offset:60
    s_add_u32 s45, s45, 1
    s_waitcnt lgkmcnt(0)
    v_and_b32 v13, v13, v235
    s_cmp_gt_u32 s45, 0x40000
    s_cselect_b32 s46, -1, 0
    v_readfirstlane_b32 s50, v13
    s_nop 3
    s_or_b32 s50, s50, s46
    s_and_b32 s50, s50, s51
    s_cbranch_scc1 L_sel5_ok
    s_cmp_lg_u32 s54, 0x5555
    s_cbranch_scc1 L_sel5_p
    s_sleep 1
    s_branch L_sel5
L_sel5_p:
    s_load_dwordx16 s[4:19], s[26:27], s52 glc
    s_add_u32 s45, s45, 8
    s_waitcnt lgkmcnt(0)
    s_mov_b32 s54, 0
    s_cmp_eq_u64 s[4:5], s[72:73]
    s_cselect_b32 s46, 0x1, 0
    s_or_b32 s54, s54, s46
    s_cmp_eq_u64 s[6:7], s[72:73]
    s_cselect_b32 s46, 0x4, 0
    s_or_b32 s54, s54, s46
    s_cmp_eq_u64 s[8:9], s[72:73]
    s_cselect_b32 s46, 0x10, 0
    s_or_b32 s54, s54, s46
    s_cmp_eq_u64 s[10:11], s[72:73]
    s_cselect_b32 s46, 0x40, 0
    s_or_b32 s54, s54, s46
    s_cmp_eq_u64 s[12:13], s[72:73]
    s_cselect_b32 s46, 0x100, 0
    s_or_b32 s54, s54, s46
    s_cmp_eq_u64 s[14:15], s[72:73]
    s_cselect_b32 s46, 0x400, 0
    s_or_b32 s54, s54, s46
    s_cmp_eq_u64 s[16:17], s[72:73]
    s_cselect_b32 s46, 0x1000, 0
    s_or_b32 s54, s54, s46
    s_cmp_eq_u64 s[18:19], s[72:73]
    s_cselect_b32 s46, 0x4000, 0
    s_or_b32 s54, s54, s46
    s_lshl_b32 s46, s54, s55
    v_mov_b32 v235, s46
    s_mov_b64 exec, 1
    ds_or_b32 v14, v235 offset:64
    s_mov_b64 exec, -1
    s_branch L_sel5
L_sel5_ok:
    s_waitcnt vmcnt(10) lgkmcnt(0)
    v_mfma_f32_16x16x32_bf16 v[120:123], v[88:91], v[56:59], v[120:123]
    ds_read_b64_tr_b16 v[104:105], v8 offset:4096
    ds_read_b64_tr_b16 v[106:107], v8 offset:6144
    v_mfma_f32_16x16x32_bf16 v[124:127], v[92:95], v[56:59], v[124:127]
    ds_read_b64_tr_b16 v[108:109], v9 offset:4096
    ds_read_b64_tr_b16 v[110:111], v9 offset:6144
    v_mfma_f32_16x16x32_bf16 v[128:131], v[96:99], v[56:59], v[128:131]
    ds_read_b64_tr_b16 v[112:113], v10 offset:4096
    ds_read_b64_tr_b16 v[114:115], v10 offset:6144
    v_mfma_f32_16x16x32_bf16 v[132:135], v[100:103], v[56:59], v[132:135]
    ds_read_b64_tr_b16 v[116:117], v11 offset:4096
    ds_read_b64_tr_b16 v[118:119], v11 offset:6144
    v_mfma_f32_16x16x32_bf16 v[136:139], v[88:91], v[60:63], v[136:139]
    v_add_u32 v244, s31, v236
    v_add_u32 v245, s31, v237
    v_mfma_f32_16x16x32_bf16 v[140:143], v[92:95], v[60:63], v[140:143]
    v_add_u32 v246, s31, v238
    v_add_u32 v247, s31, v239
    v_mfma_f32_16x16x32_bf16 v[144:147], v[96:99], v[60:63], v[144:147]
    s_ff1_i32_b32 s46, s50
    s_bitset0_b32 s50, s46
    v_mfma_f32_16x16x32_bf16 v[148:151], v[100:103], v[60:63], v[148:151]
    s_lshl_b32 s48, s46, 10
    s_bitset0_b32 s51, s46
    s_waitcnt vmcnt(8) lgkmcnt(0)
    v_mfma_f32_16x16x32_bf16 v[120:123], v[104:107], v[64:67], v[120:123]
    ds_read_b64_tr_b16 v[88:89], v244 offset:0
    ds_read_b64_tr_b16 v[90:91], v244 offset:2048
    v_mfma_f32_16x16x32_bf16 v[124:127], v[108:111], v[64:67], v[124:127]
    ds_read_b64_tr_b16 v[92:93], v245 offset:0
    ds_read_b64_tr_b16 v[94:95], v245 offset:2048
    v_mfma_f32_16x16x32_bf16 v[128:131], v[112:115], v[64:67], v[128:131]
    ds_read_b64_tr_b16 v[96:97], v246 offset:0
    ds_read_b64_tr_b16 v[98:99], v246 offset:2048
    v_mfma_f32_16x16x32_bf16 v[132:135], v[116:119], v[64:67], v[132:135]
    ds_read_b64_tr_b16 v[100:101], v247 offset:0
    ds_read_b64_tr_b16 v[102:103], v247 offset:2048
    v_mfma_f32_16x16x32_bf16 v[136:139], v[104:107], v[68:71], v[136:139]
    buffer_load_dwordx4 v[40:43], v5, s[64:67], s48 offen offset:0 sc1
    s_lshl_b32 s29, s46, 12
    v_mfma_f32_16x16x32_bf16 v[140:143], v[108:111], v[68:71], v[140:143]
    buffer_load_dwordx4 v[44:47], v242, s[64:67], s48 offen offset:0 sc1
    v_mfma_f32_16x16x32_bf16 v[144:147], v[112:115], v[68:71], v[144:147]
    buffer_load_dwordx4 v[48:51], v5, s[64:67], s48 offen offset:1024 sc1
    v_mfma_f32_16x16x32_bf16 v[148:151], v[116:119], v[68:71], v[148:151]
    buffer_load_dwordx4 v[52:55], v242, s[64:67], s48 offen offset:1024 sc1
    s_cmp_lg_u32 s50, 0
    s_cbranch_scc1 L_sel6_ok
    s_mov_b32 s45, 0
    s_cmp_lg_u32 s51, 0
    s_cbranch_scc1 L_sel6
    s_mov_b32 s66, 0
    s_mov_b32 s50, 0x55555555
    s_branch L_sel6_ok
L_sel6:
    ds_read_b32 v235, v14 offset:64
    ds_read_b32 v13, v20 offset:60
    s_add_u32 s45, s45, 1
    s_waitcnt lgkmcnt(0)
    v_and_b32 v13, v13, v235
    s_cmp_gt_u32 s45, 0x40000
    s_cselect_b32 s46, -1, 0
    v_readfirstlane_b32 s50, v13
    s_nop 3
    s_or_b32 s50, s50, s46
    s_and_b32 s50, s50, s51
    s_cbranch_scc1 L_sel6_ok
    s_cmp_lg_u32 s54, 0x5555
    s_cbranch_scc1 L_sel6_p
    s_sleep 1
    s_branch L_sel6
L_sel6_p:
    s_load_dwordx16 s[4:19], s[26:27], s52 glc
    s_add_u32 s45, s45, 8
    s_waitcnt lgkmcnt(0)
    s_mov_b32 s54, 0
    s_cmp_eq_u64 s[4:5], s[72:73]
    s_cselect_b32 s46, 0x1, 0
    s_or_b32 s54, s54, s46
    s_cmp_eq_u64 s[6:7], s[72:73]
    s_cselect_b32 s46, 0x4, 0
    s_or_b32 s54, s54, s46
    s_cmp_eq_u64 s[8:9], s[72:73]
    s_cselect_b32 s46, 0x10, 0
    s_or_b32 s54, s54, s46
    s_cmp_eq_u64 s[10:11], s[72:73]
    s_cselect_b32 s46, 0x40, 0
    s_or_b32 s54, s54, s46
    s_cmp_eq_u64 s[12:13], s[72:73]
    s_cselect_b32 s46, 0x100, 0
    s_or_b32 s54, s54, s46
    s_cmp_eq_u64 s[14:15], s[72:73]
    s_cselect_b32 s46, 0x400, 0
    s_or_b32 s54, s54, s46
    s_cmp_eq_u64 s[16:17], s[72:73]
    s_cselect_b32 s46, 0x1000, 0
    s_or_b32 s54, s54, s46
    s_cmp_eq_u64 s[18:19], s[72:73]
    s_cselect_b32 s46, 0x4000, 0
    s_or_b32 s54, s54, s46
    s_lshl_b32 s46, s54, s55
    v_mov_b32 v235, s46
    s_mov_b64 exec, 1
    ds_or_b32 v14, v235 offset:64
    s_mov_b64 exec, -1
    s_branch L_sel6
L_sel6_ok:
    s_waitcnt vmcnt(10) lgkmcnt(0)
    v_mfma_f32_16x16x32_bf16 v[120:123], v[88:91], v[72:75], v[120:123]
    ds_read_b64_tr_b16 v[104:105], v244 offset:4096
    ds_read_b64_tr_b16 v[106:107], v244 offset:6144
    v_mfma_f32_16x16x32_bf16 v[124:127], v[92:95], v[72:75], v[124:127]
    ds_read_b64_tr_b16 v[108:109], v245 offset:4096
    ds_read_b64_tr_b16 v[110:111], v245 offset:6144
    v_mfma_f32_16x16x32_bf16 v[128:131], v[96:99], v[72:75], v[128:131]
    ds_read_b64_tr_b16 v[112:113], v246 offset:4096
    ds_read_b64_tr_b16 v[114:115], v246 offset:6144
    v_mfma_f32_16x16x32_bf16 v[132:135], v[100:103], v[72:75], v[132:135]
    ds_read_b64_tr_b16 v[116:117], v247 offset:4096
    ds_read_b64_tr_b16 v[118:119], v247 offset:6144
    v_mfma_f32_16x16x32_bf16 v[136:139], v[88:91], v[76:79], v[136:139]
    v_add_u32 v8, s28, v236
    v_add_u32 v9, s28, v237
    v_mfma_f32_16x16x32_bf16 v[140:143], v[92:95], v[76:79], v[140:143]
    v_add_u32 v10, s28, v238
    v_add_u32 v11, s28, v239
    v_mfma_f32_16x16x32_bf16 v[144:147], v[96:99], v[76:79], v[144:147]
    s_ff1_i32_b32 s46, s50
    s_bitset0_b32 s50, s46
    v_mfma_f32_16x16x32_bf16 v[148:151], v[100:103], v[76:79], v[148:151]
    s_lshl_b32 s48, s46, 10
    s_bitset0_b32 s51, s46
    s_waitcnt vmcnt(8) lgkmcnt(0)
    v_mfma_f32_16x16x32_bf16 v[120:123], v[104:107], v[80:83], v[120:123]
    ds_read_b64_tr_b16 v[88:89], v8 offset:0
    ds_read_b64_tr_b16 v[90:91], v8 offset:2048
    v_mfma_f32_16x16x32_bf16 v[124:127], v[108:111], v[80:83], v[124:127]
    ds_read_b64_tr_b16 v[92:93], v9 offset:0
    ds_read_b64_tr_b16 v[94:95], v9 offset:2048
    v_mfma_f32_16x16x32_bf16 v[128:131], v[112:115], v[80:83], v[128:131]
    ds_read_b64_tr_b16 v[96:97], v10 offset:0
    ds_read_b64_tr_b16 v[98:99], v10 offset:2048
    v_mfma_f32_16x16x32_bf16 v[132:135], v[116:119], v[80:83], v[132:135]
    ds_read_b64_tr_b16 v[100:101], v11 offset:0
    ds_read_b64_tr_b16 v[102:103], v11 offset:2048
    v_mfma_f32_16x16x32_bf16 v[136:139], v[104:107], v[84:87], v[136:139]
    buffer_load_dwordx4 v[56:59], v5, s[64:67], s48 offen offset:0 sc1
    buffer_load_dwordx4 v[60:63], v242, s[64:67], s48 offen offset:0 sc1
    v_mfma_f32_16x16x32_bf16 v[140:143], v[108:111], v[84:87], v[140:143]
    s_lshl_b32 s30, s46, 12
    buffer_load_dwordx4 v[64:67], v5, s[64:67], s48 offen offset:1024 sc1
    v_mfma_f32_16x16x32_bf16 v[144:147], v[112:115], v[84:87], v[144:147]
    s_add_u32 s53, s53, 1
    buffer_load_dwordx4 v[68:71], v242, s[64:67], s48 offen offset:1024 sc1
    v_mfma_f32_16x16x32_bf16 v[148:151], v[116:119], v[84:87], v[148:151]
    s_cmp_lt_u32 s53, 4
    s_cbranch_scc1 L_gloop
    s_lshl_b32 s48, s59, 16
    s_lshl_b32 s49, s35, 7
    s_add_u32 s48, s48, s49
    s_add_u32 s49, s48, 0x8000
    s_add_u32 s50, s48, 0x10000
    s_add_u32 s51, s48, 0x18000
    s_waitcnt lgkmcnt(0)
    v_cvt_pk_bf16_f32 v172, v120, v121
    v_cvt_pk_bf16_f32 v173, v122, v123
    v_cvt_pk_bf16_f32 v174, v124, v125
    v_cvt_pk_bf16_f32 v175, v126, v127
    v_cvt_pk_bf16_f32 v176, v128, v129
    v_cvt_pk_bf16_f32 v177, v130, v131
    v_cvt_pk_bf16_f32 v178, v132, v133
    v_cvt_pk_bf16_f32 v179, v134, v135
    v_cvt_pk_bf16_f32 v180, v136, v137
    v_cvt_pk_bf16_f32 v181, v138, v139
    v_cvt_pk_bf16_f32 v182, v140, v141
    v_cvt_pk_bf16_f32 v183, v142, v143
    v_cvt_pk_bf16_f32 v184, v144, v145
    v_cvt_pk_bf16_f32 v185, v146, v147
    v_cvt_pk_bf16_f32 v186, v148, v149
    v_cvt_pk_bf16_f32 v187, v150, v151
    s_nop 1
    v_permlane16_swap_b32 v172, v174
    v_permlane16_swap_b32 v173, v175
    v_permlane16_swap_b32 v176, v178
    v_permlane16_swap_b32 v177, v179
    v_permlane16_swap_b32 v180, v182
    v_permlane16_swap_b32 v181, v183
    v_permlane16_swap_b32 v184, v186
    v_permlane16_swap_b32 v185, v187
    ds_write_b128 v15, v[172:175]
    ds_write_b128 v18, v[176:179]
    ds_read_b128 v[88:91], v16 offset:0
    ds_read_b128 v[92:95], v16 offset:1024
    ds_write_b128 v15, v[180:183]
    ds_write_b128 v18, v[184:187]
    ds_read_b128 v[96:99], v16 offset:0
    ds_read_b128 v[100:103], v16 offset:1024
    s_waitcnt lgkmcnt(5)
    buffer_store_dwordx4 v[88:91], v17, s[68:71], s48 offen sc1
    s_waitcnt lgkmcnt(4)
    buffer_store_dwordx4 v[92:95], v17, s[68:71], s49 offen sc1
    s_waitcnt lgkmcnt(1)
    buffer_store_dwordx4 v[96:99], v17, s[68:71], s50 offen sc1
    s_waitcnt lgkmcnt(0)
    buffer_store_dwordx4 v[100:103], v17, s[68:71], s51 offen sc1
    s_endpgm
L_exit:
    s_endpgm
L_code_end:
.section .rodata,"a"
.p2align 6
.amdhsa_kernel concat_heads__linear_attn_block__ssm_conv_h3__prompt_kernel
  .amdhsa_next_free_vgpr 256
  .amdhsa_next_free_sgpr 102
  .amdhsa_accum_offset 256
  .amdhsa_group_segment_fixed_size 0
  .amdhsa_kernarg_size 96
  .amdhsa_user_sgpr_count 2
  .amdhsa_user_sgpr_kernarg_segment_ptr 1
  .amdhsa_system_sgpr_workgroup_id_x 1
.end_amdhsa_kernel
```

```asm
; @launch grid=(256,1,1) block=(512,1,1) lds=163840
.amdgcn_target "amdgcn-amd-amdhsa--gfx950"
.text
.globl concat_heads__linear_attn_block__ssm_conv_h3__prompt_kernel
.type concat_heads__linear_attn_block__ssm_conv_h3__prompt_kernel,@function
.p2align 8
concat_heads__linear_attn_block__ssm_conv_h3__prompt_kernel:
    s_cmp_ge_u32 s2, 256
    s_cbranch_scc1 L_exit
    s_load_dwordx16 s[4:19], s[0:1], 0
    s_load_dwordx8 s[20:27], s[0:1], 64
    s_getpc_b64 s[48:49]
L_pc:
    s_and_b32 s45, s2, 24
    s_lshl_b32 s45, s45, 4
    v_lshl_add_u32 v2, v0, 9, s45
    v_cmp_gt_u32 vcc, L_code_end-L_pc-4, v2
    s_and_saveexec_b64 s[50:51], vcc
    s_cbranch_execz L_pf
    global_load_dword v252, v2, s[48:49]
L_pf:
    s_mov_b64 exec, s[50:51]
    v_lshrrev_b32 v1, 6, v0
    v_and_b32 v4, 63, v0
    v_readfirstlane_b32 s3, v1
    v_lshlrev_b32 v5, 4, v4
    s_and_b32 s28, s2, 7
    s_lshr_b32 s29, s2, 3
    s_and_b32 s30, s28, 1
    s_lshl_b32 s30, s30, 3
    s_and_b32 s40, s29, 7
    s_add_u32 s30, s30, s40
    s_lshr_b32 s40, s28, 1
    s_lshl_b32 s41, s40, 2
    s_lshr_b32 s42, s29, 3
    s_add_u32 s31, s41, s42
    s_add_u32 s42, s42, 1
    s_and_b32 s42, s42, 3
    s_add_u32 s32, s41, s42
    s_and_b32 s41, s30, 1
    s_lshl_b32 s33, s41, 1
    s_and_b32 s41, s30, 2
    s_lshl_b32 s41, s41, 2
    s_add_u32 s33, s33, s41
    s_and_b32 s41, s28, 1
    s_lshl_b32 s41, s41, 2
    s_add_u32 s33, s33, s41
    s_and_b32 s41, s31, 1
    s_lshl_b32 s41, s41, 1
    s_add_u32 s33, s33, s41
    s_lshl_b32 s41, s40, 2
    s_add_u32 s33, s33, s41
    s_and_b32 s33, s33, 15
    s_cmp_lt_u32 s3, 4
    s_cbranch_scc1 L_comp
    s_sub_u32 s3, s3, 4
    v_lshrrev_b32 v1, 3, v4
    v_and_b32 v2, 7, v4
    v_lshrrev_b32 v3, 4, v4
    v_xor_b32 v6, v2, v3
    v_lshlrev_b32 v6, 4, v6
    v_lshl_add_u32 v6, v1, 11, v6
    s_lshl_b32 s60, s30, 7
    s_lshl_b32 s61, s3, 5
    s_add_u32 s60, s60, s61
    s_lshl_b32 s60, s60, 11
    v_add_u32 v8, s60, v6
    v_xor_b32 v6, 64, v8
    v_add_u32 v9, 15360, v6
    v_add_u32 v10, 30720, v8
    v_add_u32 v11, 46080, v6
    v_and_b32 v3, 1, v3
    v_lshlrev_b32 v3, 2, v3
    v_xor_b32 v7, v2, v3
    v_lshlrev_b32 v7, 4, v7
    v_xor_b32 v6, 32, v7
    s_movk_i32 s61, 6144
    v_mad_u32_u24 v7, v1, s61, v7
    v_mad_u32_u24 v6, v1, s61, v6
    s_mul_i32 s60, s3, 98304
    v_add_u32 v12, s60, v7
    s_add_u32 s60, s60, 48128
    v_add_u32 v13, s60, v6
    s_lshl_b32 s65, s3, 12
    s_lshl_b32 s66, s3, 11
    s_add_u32 s66, s66, 0x4000
    s_mov_b32 s64, 0
    s_mov_b32 s67, s33
    s_lshl_b32 s74, s32, 7
    s_lshl_b32 s75, s31, 7
    s_add_u32 s75, s75, 2048
    s_mov_b32 s42, 0x400000
    s_mov_b32 s43, 0x20000
    s_mov_b32 s46, 0x600000
    s_mov_b32 s47, 0x20000
    s_waitcnt lgkmcnt(0)
    s_mov_b64 s[40:41], s[4:5]
    s_mov_b64 s[44:45], s[6:7]
    s_add_u32 m0, s64, s65
    s_lshl_b32 s60, s67, 7
    s_mul_i32 s63, s67, 393216
    buffer_load_dwordx4 v8, s[40:43], s60 offen offset:0 lds
    buffer_load_dwordx4 v9, s[40:43], s60 offen offset:1024 lds
    buffer_load_dwordx4 v10, s[40:43], s60 offen offset:2048 lds
    buffer_load_dwordx4 v11, s[40:43], s60 offen offset:3072 lds
    s_add_u32 m0, s64, s66
    s_add_u32 s61, s63, s74
    s_add_u32 s62, s63, s75
    buffer_load_dwordx4 v12, s[44:47], s61 offen offset:0 lds
    buffer_load_dwordx4 v13, s[44:47], s61 offen offset:1024 lds
    s_add_u32 m0, m0, 8192
    s_add_u32 s63, s62, 2048
    buffer_load_dwordx4 v12, s[44:47], s62 offen offset:0 lds
    buffer_load_dwordx4 v13, s[44:47], s62 offen offset:1024 lds
    s_add_u32 m0, m0, 8192
    s_add_u32 s67, s67, 1
    buffer_load_dwordx4 v12, s[44:47], s63 offen offset:0 lds
    buffer_load_dwordx4 v13, s[44:47], s63 offen offset:1024 lds
    s_and_b32 s67, s67, 15
    s_add_u32 s64, s64, 40960
    s_cmp_eq_u32 s64, 122880
    s_cselect_b32 s64, 0, s64
    s_barrier
    s_and_b32 s34, s28, 3
    s_lshl_b32 s34, s34, 2
    s_and_b32 vcc_lo, s29, 3
    s_add_u32 s34, s34, vcc_lo
    s_lshr_b32 s35, s28, 2
    s_lshl_b32 s35, s35, 3
    s_lshr_b32 vcc_lo, s29, 2
    s_add_u32 s35, s35, vcc_lo
    s_lshl_b32 s39, vcc_lo, 2
    s_and_b32 s36, s29, 15
    s_lshr_b32 s37, s29, 4
    s_lshl_b32 vcc_lo, s28, 1
    s_add_u32 s37, s37, vcc_lo
    s_lshl_b32 s38, s28, 5
    s_add_u32 s38, s38, s29
    s_lshl_b32 s38, s38, 2
    s_mul_i32 s39, s34, 11
    s_lshr_b32 s39, s39, 5
    s_mul_i32 s39, s39, 3
    s_sub_u32 s39, s34, s39
    v_mov_b32 v6, 0
    v_mov_b32 v14, 1
    v_mov_b32 v15, 162816
    v_lshlrev_b32 v255, 7, v4
    s_nop 0
    s_mov_b32 s48, s26
    s_mov_b32 s49, s27
    s_mov_b32 s50, 0x2000000
    s_mov_b32 s51, 0x20000
    s_mov_b32 s52, s24
    s_mov_b32 s53, s25
    s_mov_b32 s54, 0x100
    s_mov_b32 s55, 0x20000
    s_or_b32 s60, s2, s3
    s_cmp_eq_u32 s60, 0
    s_cbranch_scc0 L_noep
    s_memrealtime s[60:61]
    s_waitcnt lgkmcnt(0)
    s_or_b32 s60, s60, 1
    v_mov_b32 v7, s60
    s_mov_b64 exec, 1
    buffer_store_dword v7, v6, s[52:55], 0 offen sc1
    s_mov_b64 exec, -1
L_noep:
    s_mul_i32 s68, s3, 4608
    s_add_u32 s68, s68, 139776
    s_lshl_b32 s69, s37, 7
    s_lshl_b32 s70, s3, 5
    s_add_u32 s69, s69, s70
    v_lshrrev_b32 v28, 4, v4
    v_bfe_u32 v29, v4, 2, 2
    v_and_b32 v30, 3, v4
    v_and_b32 v31, 15, v4
    s_lshl_b32 s60, s3, 12
    s_add_u32 s60, s60, 139776
    v_add_u32 v247, s60, v5
    s_and_b32 s60, s3, 1
    s_lshl_b32 s60, s60, 6
    v_xor_b32 v247, s60, v247
    v_xor_b32 v248, 16, v247
    v_xor_b32 v249, 32, v247
    v_xor_b32 v250, 48, v247
    v_lshlrev_b32 v3, 12, v28
    v_lshl_add_u32 v25, v31, 4, v3
    s_lshl_b32 s60, s36, 18
    s_lshl_b32 s61, s3, 16
    s_add_u32 s60, s60, s61
    s_lshl_b32 s61, s37, 8
    s_sub_u32 s60, s60, s61
    s_add_u32 s60, s60, 3840
    v_add_u32 v25, s60, v25
    v_lshlrev_b32 v26, 5, v4
    v_and_b32 v3, 1, v28
    v_lshlrev_b32 v3, 2, v3
    v_xor_b32 v3, v2, v3
    v_lshrrev_b32 v27, 5, v4
    v_lshlrev_b32 v27, 1, v27
    v_xor_b32 v3, v27, v3
    v_lshlrev_b32 v3, 4, v3
    v_lshl_add_u32 v3, v1, 11, v3
    s_lshl_b32 s60, s35, 7
    v_add_u32 v20, s60, v3
    v_add_u32 v21, 15360, v20
    v_add_u32 v22, 30720, v20
    v_add_u32 v23, 46080, v20
    s_mov_b32 s70, 0xffff0000
    v_and_b32 v3, 1, v28
    s_movk_i32 s60, 2304
    v_mul_u32_u24 v3, s60, v3
    v_lshl_add_u32 v3, v31, 4, v3
    v_add_u32 v251, s68, v3
    s_mul_i32 s71, s3, 8320
    s_add_u32 s71, s71, 98304
    v_add_u32 v19, s71, v5
    s_movk_i32 s61, 4160
    v_and_b32 v24, 1, v29
    v_mul_u32_u24 v24, s61, v24
    v_lshl_add_u32 v24, v30, 4, v24
    v_add_u32 v24, s71, v24
    v_add_u32 v3, 1, v31
    v_and_b32 v16, 1, v3
    v_add_u32 v17, v16, v31
    v_mul_u32_u24 v3, s61, v16
    v_lshl_add_u32 v3, v28, 5, v3
    v_lshlrev_b32 v17, 1, v17
    v_sub_u32 v3, v3, v17
    s_add_u32 s60, s71, 3486
    v_add_u32 v240, s60, v3
    v_subrev_u32 v241, 1024, v240
    v_subrev_u32 v242, 2048, v240
    v_subrev_u32 v243, 3072, v240
    v_add_u32 v3, v31, v28
    s_add_u32 s60, s68, 208
    v_lshlrev_b32 v3, 4, v3
    v_add_u32 v244, s60, v3
    v_lshlrev_b32 v3, 5, v31
    v_lshl_add_u32 v16, v28, 3, v3
    s_add_u32 s60, s71, 504
    v_sub_u32 v245, s60, v16
    v_and_b32 v16, 1, v28
    v_lshl_add_u32 v3, v16, 9, v3
    v_lshrrev_b32 v16, 5, v4
    v_lshl_add_u32 v246, v16, 4, v3
    v_lshlrev_b32 v27, 4, v2
    v_lshl_add_u32 v16, v1, 11, v27
    v_lshl_add_u32 v17, v1, 12, v27
    s_add_u32 s39, s38, s3
    s_and_b32 s60, s39, 0xfffffffe
    s_lshl_b32 s60, s60, 1
    s_load_dword s71, s[20:21], s60
    s_lshl_b32 s61, s39, 12
    v_mov_b64 v[160:161], 0
    v_mov_b64 v[162:163], 0
    v_mov_b64 v[164:165], 0
    v_mov_b64 v[166:167], 0
    v_mov_b64 v[168:169], 0
    v_mov_b64 v[170:171], 0
    v_mov_b64 v[172:173], 0
    v_mov_b64 v[174:175], 0
    v_mov_b64 v[176:177], 0
    v_mov_b64 v[178:179], 0
    v_mov_b64 v[180:181], 0
    v_mov_b64 v[182:183], 0
    v_mov_b64 v[184:185], 0
    v_mov_b64 v[186:187], 0
    v_mov_b64 v[188:189], 0
    v_mov_b64 v[190:191], 0
    s_add_u32 s52, s18, s61
    s_addc_u32 s53, s19, 0
    s_mov_b32 s54, 0x1000
    s_mov_b32 s55, 0x20000
    s_mov_b32 s56, s8
    s_mov_b32 s57, s9
    s_mov_b32 s58, 0x200000
    s_mov_b32 s59, 0x20000
    s_waitcnt lgkmcnt(0)
    s_mov_b32 s20, s10
    s_mov_b32 s21, s11
    s_waitcnt vmcnt(0)
    s_barrier
    s_add_u32 m0, s64, s65
    s_lshl_b32 s60, s67, 7
    s_mul_i32 s63, s67, 393216
    buffer_load_dwordx4 v8, s[40:43], s60 offen offset:0 lds
    buffer_load_dwordx4 v9, s[40:43], s60 offen offset:1024 lds
    buffer_load_dwordx4 v10, s[40:43], s60 offen offset:2048 lds
    buffer_load_dwordx4 v11, s[40:43], s60 offen offset:3072 lds
    s_add_u32 m0, s64, s66
    s_add_u32 s61, s63, s74
    s_add_u32 s62, s63, s75
    buffer_load_dwordx4 v12, s[44:47], s61 offen offset:0 lds
    buffer_load_dwordx4 v13, s[44:47], s61 offen offset:1024 lds
    s_add_u32 m0, m0, 8192
    s_add_u32 s63, s62, 2048
    buffer_load_dwordx4 v12, s[44:47], s62 offen offset:0 lds
    buffer_load_dwordx4 v13, s[44:47], s62 offen offset:1024 lds
    s_add_u32 m0, m0, 8192
    s_add_u32 s67, s67, 1
    buffer_load_dwordx4 v12, s[44:47], s63 offen offset:0 lds
    buffer_load_dwordx4 v13, s[44:47], s63 offen offset:1024 lds
    s_and_b32 s67, s67, 15
    s_add_u32 s64, s64, 40960
    s_cmp_eq_u32 s64, 122880
    s_cselect_b32 s64, 0, s64
    s_add_u32 m0, s64, s65
    s_lshl_b32 s60, s67, 7
    s_mul_i32 s63, s67, 393216
    buffer_load_dwordx4 v8, s[40:43], s60 offen offset:0 lds
    buffer_load_dwordx4 v9, s[40:43], s60 offen offset:1024 lds
    buffer_load_dwordx4 v10, s[40:43], s60 offen offset:2048 lds
    buffer_load_dwordx4 v11, s[40:43], s60 offen offset:3072 lds
    s_add_u32 m0, s64, s66
    s_add_u32 s61, s63, s74
    s_add_u32 s62, s63, s75
    buffer_load_dwordx4 v12, s[44:47], s61 offen offset:0 lds
    buffer_load_dwordx4 v13, s[44:47], s61 offen offset:1024 lds
    s_add_u32 m0, m0, 8192
    s_add_u32 s63, s62, 2048
    buffer_load_dwordx4 v12, s[44:47], s62 offen offset:0 lds
    buffer_load_dwordx4 v13, s[44:47], s62 offen offset:1024 lds
    s_add_u32 m0, m0, 8192
    s_add_u32 s67, s67, 1
    buffer_load_dwordx4 v12, s[44:47], s63 offen offset:0 lds
    buffer_load_dwordx4 v13, s[44:47], s63 offen offset:1024 lds
    s_and_b32 s67, s67, 15
    s_add_u32 s64, s64, 40960
    s_cmp_eq_u32 s64, 122880
    s_cselect_b32 s64, 0, s64
    s_waitcnt vmcnt(10)
    s_barrier
    s_add_u32 m0, s64, s65
    s_lshl_b32 s60, s67, 7
    s_mul_i32 s63, s67, 393216
    buffer_load_dwordx4 v8, s[40:43], s60 offen offset:0 lds
    buffer_load_dwordx4 v9, s[40:43], s60 offen offset:1024 lds
    buffer_load_dwordx4 v10, s[40:43], s60 offen offset:2048 lds
    buffer_load_dwordx4 v11, s[40:43], s60 offen offset:3072 lds
    s_add_u32 m0, s64, s66
    s_add_u32 s61, s63, s74
    s_add_u32 s62, s63, s75
    buffer_load_dwordx4 v12, s[44:47], s61 offen offset:0 lds
    buffer_load_dwordx4 v13, s[44:47], s61 offen offset:1024 lds
    s_add_u32 m0, m0, 8192
    s_add_u32 s63, s62, 2048
    buffer_load_dwordx4 v12, s[44:47], s62 offen offset:0 lds
    buffer_load_dwordx4 v13, s[44:47], s62 offen offset:1024 lds
    s_add_u32 m0, m0, 8192
    s_add_u32 s67, s67, 1
    buffer_load_dwordx4 v12, s[44:47], s63 offen offset:0 lds
    buffer_load_dwordx4 v13, s[44:47], s63 offen offset:1024 lds
    s_and_b32 s67, s67, 15
    s_add_u32 s64, s64, 40960
    s_cmp_eq_u32 s64, 122880
    s_cselect_b32 s64, 0, s64
    s_waitcnt vmcnt(10)
    s_barrier
    s_add_u32 m0, s64, s65
    s_lshl_b32 s60, s67, 7
    s_mul_i32 s63, s67, 393216
    buffer_load_dwordx4 v8, s[40:43], s60 offen offset:0 lds
    buffer_load_dwordx4 v9, s[40:43], s60 offen offset:1024 lds
    buffer_load_dwordx4 v10, s[40:43], s60 offen offset:2048 lds
    buffer_load_dwordx4 v11, s[40:43], s60 offen offset:3072 lds
    s_add_u32 m0, s64, s66
    s_add_u32 s61, s63, s74
    s_add_u32 s62, s63, s75
    buffer_load_dwordx4 v12, s[44:47], s61 offen offset:0 lds
    buffer_load_dwordx4 v13, s[44:47], s61 offen offset:1024 lds
    s_add_u32 m0, m0, 8192
    s_add_u32 s63, s62, 2048
    buffer_load_dwordx4 v12, s[44:47], s62 offen offset:0 lds
    buffer_load_dwordx4 v13, s[44:47], s62 offen offset:1024 lds
    s_add_u32 m0, m0, 8192
    s_add_u32 s67, s67, 1
    buffer_load_dwordx4 v12, s[44:47], s63 offen offset:0 lds
    buffer_load_dwordx4 v13, s[44:47], s63 offen offset:1024 lds
    s_and_b32 s67, s67, 15
    s_add_u32 s64, s64, 40960
    s_cmp_eq_u32 s64, 122880
    s_cselect_b32 s64, 0, s64
    s_load_dword s72, s[24:25], 0
    s_lshl_b32 s33, s39, 7
    s_add_u32 s33, s33, 0x940000
    s_lshl_b32 s39, s39, 12
    s_waitcnt vmcnt(10)
    s_barrier
    s_waitcnt lgkmcnt(0)
    s_mov_b32 s60, 0
L_eploop:
    s_cmp_lg_u32 s72, 0
    s_cbranch_scc1 L_epok
    s_sleep 8
    s_load_dword s72, s[24:25], 0 glc
    s_add_u32 s60, s60, 1
    s_cmp_gt_u32 s60, 0x4000
    s_waitcnt lgkmcnt(0)
    s_cbranch_scc0 L_eploop
L_epok:
    s_mov_b32 s73, s72
    v_mov_b32 v7, s72
    ds_write_b32 v15, v7 offset:56
    ds_write_b128 v251, v[160:163]
    s_add_u32 m0, s64, s65
    s_lshl_b32 s60, s67, 7
    s_mul_i32 s63, s67, 393216
    buffer_load_dwordx4 v8, s[40:43], s60 offen offset:0 lds
    buffer_load_dwordx4 v9, s[40:43], s60 offen offset:1024 lds
    buffer_load_dwordx4 v10, s[40:43], s60 offen offset:2048 lds
    buffer_load_dwordx4 v11, s[40:43], s60 offen offset:3072 lds
    s_add_u32 m0, s64, s66
    s_add_u32 s61, s63, s74
    s_add_u32 s62, s63, s75
    buffer_load_dwordx4 v12, s[44:47], s61 offen offset:0 lds
    buffer_load_dwordx4 v13, s[44:47], s61 offen offset:1024 lds
    s_add_u32 m0, m0, 8192
    s_add_u32 s63, s62, 2048
    buffer_load_dwordx4 v12, s[44:47], s62 offen offset:0 lds
    buffer_load_dwordx4 v13, s[44:47], s62 offen offset:1024 lds
    s_add_u32 m0, m0, 8192
    s_add_u32 s67, s67, 1
    buffer_load_dwordx4 v12, s[44:47], s63 offen offset:0 lds
    buffer_load_dwordx4 v13, s[44:47], s63 offen offset:1024 lds
    s_and_b32 s67, s67, 15
    s_add_u32 s64, s64, 40960
    s_cmp_eq_u32 s64, 122880
    s_cselect_b32 s64, 0, s64
    s_waitcnt vmcnt(10)
    s_barrier
    s_add_u32 m0, s64, s65
    s_lshl_b32 s60, s67, 7
    s_mul_i32 s63, s67, 393216
    buffer_load_dwordx4 v8, s[40:43], s60 offen offset:0 lds
    buffer_load_dwordx4 v9, s[40:43], s60 offen offset:1024 lds
    buffer_load_dwordx4 v10, s[40:43], s60 offen offset:2048 lds
    buffer_load_dwordx4 v11, s[40:43], s60 offen offset:3072 lds
    s_add_u32 m0, s64, s66
    s_add_u32 s61, s63, s74
    s_add_u32 s62, s63, s75
    buffer_load_dwordx4 v12, s[44:47], s61 offen offset:0 lds
    buffer_load_dwordx4 v13, s[44:47], s61 offen offset:1024 lds
    s_add_u32 m0, m0, 8192
    s_add_u32 s63, s62, 2048
    buffer_load_dwordx4 v12, s[44:47], s62 offen offset:0 lds
    buffer_load_dwordx4 v13, s[44:47], s62 offen offset:1024 lds
    s_add_u32 m0, m0, 8192
    s_add_u32 s67, s67, 1
    buffer_load_dwordx4 v12, s[44:47], s63 offen offset:0 lds
    buffer_load_dwordx4 v13, s[44:47], s63 offen offset:1024 lds
    s_and_b32 s67, s67, 15
    s_add_u32 s64, s64, 40960
    s_cmp_eq_u32 s64, 122880
    s_cselect_b32 s64, 0, s64
    s_waitcnt vmcnt(10)
    s_barrier
    s_add_u32 m0, s64, s65
    s_lshl_b32 s60, s67, 7
    s_mul_i32 s63, s67, 393216
    buffer_load_dwordx4 v8, s[40:43], s60 offen offset:0 lds
    buffer_load_dwordx4 v9, s[40:43], s60 offen offset:1024 lds
    buffer_load_dwordx4 v10, s[40:43], s60 offen offset:2048 lds
    buffer_load_dwordx4 v11, s[40:43], s60 offen offset:3072 lds
    s_add_u32 m0, s64, s66
    s_add_u32 s61, s63, s74
    s_add_u32 s62, s63, s75
    buffer_load_dwordx4 v12, s[44:47], s61 offen offset:0 lds
    buffer_load_dwordx4 v13, s[44:47], s61 offen offset:1024 lds
    s_add_u32 m0, m0, 8192
    s_add_u32 s63, s62, 2048
    buffer_load_dwordx4 v12, s[44:47], s62 offen offset:0 lds
    buffer_load_dwordx4 v13, s[44:47], s62 offen offset:1024 lds
    s_add_u32 m0, m0, 8192
    s_add_u32 s67, s67, 1
    buffer_load_dwordx4 v12, s[44:47], s63 offen offset:0 lds
    buffer_load_dwordx4 v13, s[44:47], s63 offen offset:1024 lds
    s_and_b32 s67, s67, 15
    s_add_u32 s64, s64, 40960
    s_cmp_eq_u32 s64, 122880
    s_cselect_b32 s64, 0, s64
    s_waitcnt vmcnt(10)
    s_barrier
    s_add_u32 m0, s64, s65
    s_lshl_b32 s60, s67, 7
    s_mul_i32 s63, s67, 393216
    buffer_load_dwordx4 v8, s[40:43], s60 offen offset:0 lds
    buffer_load_dwordx4 v9, s[40:43], s60 offen offset:1024 lds
    buffer_load_dwordx4 v10, s[40:43], s60 offen offset:2048 lds
    buffer_load_dwordx4 v11, s[40:43], s60 offen offset:3072 lds
    s_add_u32 m0, s64, s66
    s_add_u32 s61, s63, s74
    s_add_u32 s62, s63, s75
    buffer_load_dwordx4 v12, s[44:47], s61 offen offset:0 lds
    buffer_load_dwordx4 v13, s[44:47], s61 offen offset:1024 lds
    s_add_u32 m0, m0, 8192
    s_add_u32 s63, s62, 2048
    buffer_load_dwordx4 v12, s[44:47], s62 offen offset:0 lds
    buffer_load_dwordx4 v13, s[44:47], s62 offen offset:1024 lds
    s_add_u32 m0, m0, 8192
    s_add_u32 s67, s67, 1
    buffer_load_dwordx4 v12, s[44:47], s63 offen offset:0 lds
    buffer_load_dwordx4 v13, s[44:47], s63 offen offset:1024 lds
    s_and_b32 s67, s67, 15
    s_add_u32 s64, s64, 40960
    s_cmp_eq_u32 s64, 122880
    s_cselect_b32 s64, 0, s64
    s_waitcnt vmcnt(10)
    s_barrier
    s_add_u32 m0, s64, s65
    s_lshl_b32 s60, s67, 7
    s_mul_i32 s63, s67, 393216
    buffer_load_dwordx4 v8, s[40:43], s60 offen offset:0 lds
    buffer_load_dwordx4 v9, s[40:43], s60 offen offset:1024 lds
    buffer_load_dwordx4 v10, s[40:43], s60 offen offset:2048 lds
    buffer_load_dwordx4 v11, s[40:43], s60 offen offset:3072 lds
    s_add_u32 m0, s64, s66
    s_add_u32 s61, s63, s74
    s_add_u32 s62, s63, s75
    buffer_load_dwordx4 v12, s[44:47], s61 offen offset:0 lds
    buffer_load_dwordx4 v13, s[44:47], s61 offen offset:1024 lds
    s_add_u32 m0, m0, 8192
    s_add_u32 s63, s62, 2048
    buffer_load_dwordx4 v12, s[44:47], s62 offen offset:0 lds
    buffer_load_dwordx4 v13, s[44:47], s62 offen offset:1024 lds
    s_add_u32 m0, m0, 8192
    s_add_u32 s67, s67, 1
    buffer_load_dwordx4 v12, s[44:47], s63 offen offset:0 lds
    buffer_load_dwordx4 v13, s[44:47], s63 offen offset:1024 lds
    s_and_b32 s67, s67, 15
    s_add_u32 s64, s64, 40960
    s_cmp_eq_u32 s64, 122880
    s_cselect_b32 s64, 0, s64
    s_waitcnt vmcnt(10)
    s_barrier
    s_add_u32 m0, s64, s65
    s_lshl_b32 s60, s67, 7
    s_mul_i32 s63, s67, 393216
    buffer_load_dwordx4 v8, s[40:43], s60 offen offset:0 lds
    buffer_load_dwordx4 v9, s[40:43], s60 offen offset:1024 lds
    buffer_load_dwordx4 v10, s[40:43], s60 offen offset:2048 lds
    buffer_load_dwordx4 v11, s[40:43], s60 offen offset:3072 lds
    s_add_u32 m0, s64, s66
    s_add_u32 s61, s63, s74
    s_add_u32 s62, s63, s75
    buffer_load_dwordx4 v12, s[44:47], s61 offen offset:0 lds
    buffer_load_dwordx4 v13, s[44:47], s61 offen offset:1024 lds
    s_add_u32 m0, m0, 8192
    s_add_u32 s63, s62, 2048
    buffer_load_dwordx4 v12, s[44:47], s62 offen offset:0 lds
    buffer_load_dwordx4 v13, s[44:47], s62 offen offset:1024 lds
    s_add_u32 m0, m0, 8192
    s_add_u32 s67, s67, 1
    buffer_load_dwordx4 v12, s[44:47], s63 offen offset:0 lds
    buffer_load_dwordx4 v13, s[44:47], s63 offen offset:1024 lds
    s_and_b32 s67, s67, 15
    s_add_u32 s64, s64, 40960
    s_cmp_eq_u32 s64, 122880
    s_cselect_b32 s64, 0, s64
    s_waitcnt vmcnt(10)
    s_barrier
    s_add_u32 m0, s64, s65
    s_lshl_b32 s60, s67, 7
    s_mul_i32 s63, s67, 393216
    buffer_load_dwordx4 v8, s[40:43], s60 offen offset:0 lds
    buffer_load_dwordx4 v9, s[40:43], s60 offen offset:1024 lds
    buffer_load_dwordx4 v10, s[40:43], s60 offen offset:2048 lds
    buffer_load_dwordx4 v11, s[40:43], s60 offen offset:3072 lds
    s_add_u32 m0, s64, s66
    s_add_u32 s61, s63, s74
    s_add_u32 s62, s63, s75
    buffer_load_dwordx4 v12, s[44:47], s61 offen offset:0 lds
    buffer_load_dwordx4 v13, s[44:47], s61 offen offset:1024 lds
    s_add_u32 m0, m0, 8192
    s_add_u32 s63, s62, 2048
    buffer_load_dwordx4 v12, s[44:47], s62 offen offset:0 lds
    buffer_load_dwordx4 v13, s[44:47], s62 offen offset:1024 lds
    s_add_u32 m0, m0, 8192
    s_add_u32 s67, s67, 1
    buffer_load_dwordx4 v12, s[44:47], s63 offen offset:0 lds
    buffer_load_dwordx4 v13, s[44:47], s63 offen offset:1024 lds
    s_and_b32 s67, s67, 15
    s_add_u32 s64, s64, 40960
    s_cmp_eq_u32 s64, 122880
    s_cselect_b32 s64, 0, s64
    s_waitcnt vmcnt(10)
    s_barrier
    s_add_u32 m0, s64, s65
    s_lshl_b32 s60, s67, 7
    s_mul_i32 s63, s67, 393216
    buffer_load_dwordx4 v8, s[40:43], s60 offen offset:0 lds
    buffer_load_dwordx4 v9, s[40:43], s60 offen offset:1024 lds
    buffer_load_dwordx4 v10, s[40:43], s60 offen offset:2048 lds
    buffer_load_dwordx4 v11, s[40:43], s60 offen offset:3072 lds
    s_add_u32 m0, s64, s66
    s_add_u32 s61, s63, s74
    s_add_u32 s62, s63, s75
    buffer_load_dwordx4 v12, s[44:47], s61 offen offset:0 lds
    buffer_load_dwordx4 v13, s[44:47], s61 offen offset:1024 lds
    s_add_u32 m0, m0, 8192
    s_add_u32 s63, s62, 2048
    buffer_load_dwordx4 v12, s[44:47], s62 offen offset:0 lds
    buffer_load_dwordx4 v13, s[44:47], s62 offen offset:1024 lds
    s_add_u32 m0, m0, 8192
    s_add_u32 s67, s67, 1
    buffer_load_dwordx4 v12, s[44:47], s63 offen offset:0 lds
    buffer_load_dwordx4 v13, s[44:47], s63 offen offset:1024 lds
    s_and_b32 s67, s67, 15
    s_add_u32 s64, s64, 40960
    s_cmp_eq_u32 s64, 122880
    s_cselect_b32 s64, 0, s64
    s_waitcnt vmcnt(10)
    s_barrier
    s_add_u32 m0, s64, s65
    s_lshl_b32 s60, s67, 7
    s_mul_i32 s63, s67, 393216
    buffer_load_dwordx4 v8, s[40:43], s60 offen offset:0 lds
    buffer_load_dwordx4 v9, s[40:43], s60 offen offset:1024 lds
    buffer_load_dwordx4 v10, s[40:43], s60 offen offset:2048 lds
    buffer_load_dwordx4 v11, s[40:43], s60 offen offset:3072 lds
    s_add_u32 m0, s64, s66
    s_add_u32 s61, s63, s74
    s_add_u32 s62, s63, s75
    buffer_load_dwordx4 v12, s[44:47], s61 offen offset:0 lds
    buffer_load_dwordx4 v13, s[44:47], s61 offen offset:1024 lds
    s_add_u32 m0, m0, 8192
    s_add_u32 s63, s62, 2048
    buffer_load_dwordx4 v12, s[44:47], s62 offen offset:0 lds
    buffer_load_dwordx4 v13, s[44:47], s62 offen offset:1024 lds
    s_add_u32 m0, m0, 8192
    s_add_u32 s67, s67, 1
    buffer_load_dwordx4 v12, s[44:47], s63 offen offset:0 lds
    buffer_load_dwordx4 v13, s[44:47], s63 offen offset:1024 lds
    s_and_b32 s67, s67, 15
    s_add_u32 s64, s64, 40960
    s_cmp_eq_u32 s64, 122880
    s_cselect_b32 s64, 0, s64
    s_waitcnt vmcnt(10)
    s_barrier
    s_add_u32 m0, s64, s65
    s_lshl_b32 s60, s67, 7
    s_mul_i32 s63, s67, 393216
    buffer_load_dwordx4 v8, s[40:43], s60 offen offset:0 lds
    buffer_load_dwordx4 v9, s[40:43], s60 offen offset:1024 lds
    buffer_load_dwordx4 v10, s[40:43], s60 offen offset:2048 lds
    buffer_load_dwordx4 v11, s[40:43], s60 offen offset:3072 lds
    s_add_u32 m0, s64, s66
    s_add_u32 s61, s63, s74
    s_add_u32 s62, s63, s75
    buffer_load_dwordx4 v12, s[44:47], s61 offen offset:0 lds
    buffer_load_dwordx4 v13, s[44:47], s61 offen offset:1024 lds
    s_add_u32 m0, m0, 8192
    s_add_u32 s63, s62, 2048
    buffer_load_dwordx4 v12, s[44:47], s62 offen offset:0 lds
    buffer_load_dwordx4 v13, s[44:47], s62 offen offset:1024 lds
    s_add_u32 m0, m0, 8192
    s_add_u32 s67, s67, 1
    buffer_load_dwordx4 v12, s[44:47], s63 offen offset:0 lds
    buffer_load_dwordx4 v13, s[44:47], s63 offen offset:1024 lds
    s_and_b32 s67, s67, 15
    s_add_u32 s64, s64, 40960
    s_cmp_eq_u32 s64, 122880
    s_cselect_b32 s64, 0, s64
    s_waitcnt vmcnt(10)
    s_barrier
    s_add_u32 m0, s64, s65
    s_lshl_b32 s60, s67, 7
    s_mul_i32 s63, s67, 393216
    buffer_load_dwordx4 v8, s[40:43], s60 offen offset:0 lds
    buffer_load_dwordx4 v9, s[40:43], s60 offen offset:1024 lds
    buffer_load_dwordx4 v10, s[40:43], s60 offen offset:2048 lds
    buffer_load_dwordx4 v11, s[40:43], s60 offen offset:3072 lds
    s_add_u32 m0, s64, s66
    s_add_u32 s61, s63, s74
    s_add_u32 s62, s63, s75
    buffer_load_dwordx4 v12, s[44:47], s61 offen offset:0 lds
    buffer_load_dwordx4 v13, s[44:47], s61 offen offset:1024 lds
    s_add_u32 m0, m0, 8192
    s_add_u32 s63, s62, 2048
    buffer_load_dwordx4 v12, s[44:47], s62 offen offset:0 lds
    buffer_load_dwordx4 v13, s[44:47], s62 offen offset:1024 lds
    s_add_u32 m0, m0, 8192
    s_add_u32 s67, s67, 1
    buffer_load_dwordx4 v12, s[44:47], s63 offen offset:0 lds
    buffer_load_dwordx4 v13, s[44:47], s63 offen offset:1024 lds
    s_and_b32 s67, s67, 15
    s_add_u32 s64, s64, 40960
    s_cmp_eq_u32 s64, 122880
    s_cselect_b32 s64, 0, s64
    s_load_dwordx16 s[4:19], s[26:27], s33 glc
    s_mov_b32 s40, s20
    s_mov_b32 s41, s21
    s_mov_b32 s42, 0x400000
    s_mov_b32 s43, 0x20000
    s_mov_b32 s44, s22
    s_mov_b32 s45, s23
    s_mov_b32 s46, 0x800000
    s_mov_b32 s47, 0x20000
    s_and_b32 s28, s34, 3
    s_lshl_b32 s74, s28, 2
    s_lshl_b32 s28, s28, 3
    s_add_u32 s65, s3, 5
    s_add_u32 s75, s3, 9
    s_cmp_eq_u32 s3, 3
    s_cselect_b32 s75, 4, s75
    s_add_u32 s31, s3, 12
    s_waitcnt vmcnt(10)
    s_barrier
    s_waitcnt lgkmcnt(0)
    s_cmp_eq_u64 s[4:5], s[72:73]
    s_cbranch_scc0 L_us
    s_cmp_eq_u64 s[6:7], s[72:73]
    s_cbranch_scc0 L_us
    s_cmp_eq_u64 s[8:9], s[72:73]
    s_cbranch_scc0 L_us
    s_cmp_eq_u64 s[10:11], s[72:73]
    s_cbranch_scc0 L_us
    s_cmp_eq_u64 s[12:13], s[72:73]
    s_cbranch_scc0 L_us
    s_cmp_eq_u64 s[14:15], s[72:73]
    s_cbranch_scc0 L_us
    s_cmp_eq_u64 s[16:17], s[72:73]
    s_cbranch_scc0 L_us
    s_cmp_eq_u64 s[18:19], s[72:73]
    s_cbranch_scc0 L_us
    s_branch L_upoll_done
L_us:
    s_mov_b32 s60, 0
    s_branch L_upoll_go
L_upoll:
    s_sleep 0
L_upoll_go:
    s_load_dwordx16 s[4:19], s[26:27], s33 glc
    s_add_u32 s60, s60, 1
    s_cmp_gt_u32 s60, 0x8000
    s_cbranch_scc1 L_upoll_done
    s_waitcnt lgkmcnt(0)
    s_cmp_eq_u64 s[4:5], s[72:73]
    s_cbranch_scc0 L_upoll
    s_cmp_eq_u64 s[6:7], s[72:73]
    s_cbranch_scc0 L_upoll
    s_cmp_eq_u64 s[8:9], s[72:73]
    s_cbranch_scc0 L_upoll
    s_cmp_eq_u64 s[10:11], s[72:73]
    s_cbranch_scc0 L_upoll
    s_cmp_eq_u64 s[12:13], s[72:73]
    s_cbranch_scc0 L_upoll
    s_cmp_eq_u64 s[14:15], s[72:73]
    s_cbranch_scc0 L_upoll
    s_cmp_eq_u64 s[16:17], s[72:73]
    s_cbranch_scc0 L_upoll
    s_cmp_eq_u64 s[18:19], s[72:73]
    s_cbranch_scc0 L_upoll
L_upoll_done:
    s_waitcnt lgkmcnt(0)
    buffer_load_dwordx4 v[32:35], v5, s[48:51], s39 offen offset:0 sc1
    buffer_load_dwordx4 v[36:39], v5, s[48:51], s39 offen offset:1024 sc1
    buffer_load_dwordx4 v[40:43], v5, s[48:51], s39 offen offset:2048 sc1
    buffer_load_dwordx4 v[44:47], v5, s[48:51], s39 offen offset:3072 sc1
    s_add_u32 m0, s68, 256
    s_nop 0
    buffer_load_dwordx4 v26, s[52:55], 0 offen  lds
    s_add_u32 m0, s68, 256
    s_movk_i32 s60, 1024
    s_nop 0
    buffer_load_dwordx4 v26, s[52:55], s60 offen offset:1024  lds
    s_add_u32 m0, s68, 2560
    s_nop 0
    buffer_load_dwordx4 v26, s[52:55], 16 offen  lds
    s_add_u32 m0, s68, 2560
    s_movk_i32 s60, 1040
    s_nop 0
    buffer_load_dwordx4 v26, s[52:55], s60 offen offset:1024  lds
    s_waitcnt vmcnt(8)
    s_barrier
    ds_write_b128 v24, v[160:163] offset:4096
    s_lshl_b32 m0, s65, 13
    s_add_u32 s60, s65, s74
    s_and_b32 s60, s60, 15
    s_lshl_b32 s60, s60, 17
    s_add_u32 s61, s60, 0x10000
    buffer_load_dwordx4 v20, s[56:59], s60 offen offset:0  lds
    buffer_load_dwordx4 v21, s[56:59], s60 offen offset:1024  lds
    buffer_load_dwordx4 v22, s[56:59], s60 offen offset:2048  lds
    buffer_load_dwordx4 v23, s[56:59], s60 offen offset:3072  lds
    s_add_u32 m0, m0, 4096
    s_nop 0
    buffer_load_dwordx4 v20, s[56:59], s61 offen offset:0  lds
    buffer_load_dwordx4 v21, s[56:59], s61 offen offset:1024  lds
    buffer_load_dwordx4 v22, s[56:59], s61 offen offset:2048  lds
    buffer_load_dwordx4 v23, s[56:59], s61 offen offset:3072  lds
    s_waitcnt vmcnt(12)
    v_mov_b32_dpp v48, v36 wave_rol:1 row_mask:0xf bank_mask:0xf
    v_mov_b32_dpp v49, v40 wave_rol:1 row_mask:0xf bank_mask:0xf
    v_mov_b32_dpp v50, v44 wave_rol:1 row_mask:0xf bank_mask:0xf
    v_mov_b32 v51, 0
    s_nop 0
    v_mov_b32_dpp v48, v32 wave_shl:1 row_mask:0xf bank_mask:0xf
    v_mov_b32_dpp v49, v36 wave_shl:1 row_mask:0xf bank_mask:0xf
    v_mov_b32_dpp v50, v40 wave_shl:1 row_mask:0xf bank_mask:0xf
    v_mov_b32_dpp v51, v44 wave_shl:1 row_mask:0xf bank_mask:0xf
    ds_write_b128 v19, v[32:35] offset:0
    v_alignbit_b32 v52, v33, v32, 16
    v_alignbit_b32 v53, v34, v33, 16
    v_alignbit_b32 v54, v35, v34, 16
    v_alignbit_b32 v55, v48, v35, 16
    ds_write_b128 v19, v[52:55] offset:4160
    ds_write_b128 v19, v[36:39] offset:1024
    v_alignbit_b32 v56, v37, v36, 16
    v_alignbit_b32 v57, v38, v37, 16
    v_alignbit_b32 v58, v39, v38, 16
    v_alignbit_b32 v59, v49, v39, 16
    ds_write_b128 v19, v[56:59] offset:5184
    ds_write_b128 v19, v[40:43] offset:2048
    v_alignbit_b32 v60, v41, v40, 16
    v_alignbit_b32 v61, v42, v41, 16
    v_alignbit_b32 v62, v43, v42, 16
    v_alignbit_b32 v63, v50, v43, 16
    ds_write_b128 v19, v[60:63] offset:6208
    ds_write_b128 v19, v[44:47] offset:3072
    v_alignbit_b32 v64, v45, v44, 16
    v_alignbit_b32 v65, v46, v45, 16
    v_alignbit_b32 v66, v47, v46, 16
    v_alignbit_b32 v67, v51, v47, 16
    ds_write_b128 v19, v[64:67] offset:7232
    s_mov_b32 s60, 0
L_fr:
    ds_read_b128 v[68:71], v15 offset:112
    s_add_u32 s60, s60, 1
    s_waitcnt lgkmcnt(0)
    v_and_b32 v68, v68, v69
    v_and_b32 v70, v70, v71
    v_and_b32 v68, v68, v70
    s_cmp_gt_u32 s60, 0x40000
    s_cbranch_scc1 L_fr_d
    v_readfirstlane_b32 s61, v68
    s_nop 3
    s_cmp_eq_u32 s61, 1
    s_cbranch_scc1 L_fr_d
    s_sleep 1
    s_branch L_fr
L_fr_d:
    s_lshl_b32 m0, s75, 13
    s_add_u32 s60, s75, s74
    s_and_b32 s60, s60, 15
    s_lshl_b32 s60, s60, 17
    s_add_u32 s61, s60, 0x10000
    buffer_load_dwordx4 v20, s[56:59], s60 offen offset:0  lds
    buffer_load_dwordx4 v21, s[56:59], s60 offen offset:1024  lds
    buffer_load_dwordx4 v22, s[56:59], s60 offen offset:2048  lds
    buffer_load_dwordx4 v23, s[56:59], s60 offen offset:3072  lds
    s_add_u32 m0, m0, 4096
    s_nop 0
    buffer_load_dwordx4 v20, s[56:59], s61 offen offset:0  lds
    buffer_load_dwordx4 v21, s[56:59], s61 offen offset:1024  lds
    buffer_load_dwordx4 v22, s[56:59], s61 offen offset:2048  lds
    buffer_load_dwordx4 v23, s[56:59], s61 offen offset:3072  lds
    s_lshl_b32 m0, s3, 13
    s_add_u32 s60, s3, s74
    s_and_b32 s60, s60, 15
    s_lshl_b32 s60, s60, 17
    s_add_u32 s61, s60, 0x10000
    buffer_load_dwordx4 v20, s[56:59], s60 offen offset:0  lds
    buffer_load_dwordx4 v21, s[56:59], s60 offen offset:1024  lds
    buffer_load_dwordx4 v22, s[56:59], s60 offen offset:2048  lds
    buffer_load_dwordx4 v23, s[56:59], s60 offen offset:3072  lds
    s_add_u32 m0, m0, 4096
    s_nop 0
    buffer_load_dwordx4 v20, s[56:59], s61 offen offset:0  lds
    buffer_load_dwordx4 v21, s[56:59], s61 offen offset:1024  lds
    buffer_load_dwordx4 v22, s[56:59], s61 offen offset:2048  lds
    buffer_load_dwordx4 v23, s[56:59], s61 offen offset:3072  lds
    s_lshl_b32 s30, s69, 11
    s_lshl_b32 s61, s36, 7
    s_add_u32 s30, s30, s61
    s_lshl_b32 s63, s69, 12
    s_add_u32 s63, s63, s61
    s_add_u32 s63, s63, 2048
    s_lshl_b32 s66, s34, 8
    s_lshl_b32 s61, s3, 6
    s_add_u32 s66, s66, s61
    s_lshr_b32 vcc_lo, s66, 6
    s_mul_i32 vcc_lo, vcc_lo, 1984
    s_add_u32 s66, s66, vcc_lo
    s_add_u32 s66, s66, 0x980000
    s_lshl_b32 vcc_lo, s35, 7
    s_add_u32 s66, s66, vcc_lo
    s_bitcmp1_b32 s3, 0
    s_cselect_b32 s60, 0, 16
    s_cselect_b32 s33, 16, 0
    s_lshl_b32 s71, s71, s60
    s_and_b32 s71, s71, 0xffff0000
    s_lshr_b32 s60, s3, 1
    v_lshl_add_u32 v19, s60, 2, v15
    s_mov_b32 s32, s38
    s_lshr_b32 vcc_lo, s32, 6
    s_mul_i32 vcc_lo, vcc_lo, 8128
    s_add_u32 s32, s32, vcc_lo
    s_add_u32 s32, s32, 0x9a0000
    s_lshl_b32 s67, s36, 6
    s_lshl_b32 s60, s37, 2
    s_add_u32 s60, s60, s3
    s_lshr_b32 vcc_lo, s67, 6
    s_mul_i32 vcc_lo, vcc_lo, 8128
    s_add_u32 s67, s67, vcc_lo
    s_add_u32 s67, s67, 0x9a0000
    s_lshl_b32 vcc_lo, s60, 7
    s_add_u32 s67, s67, vcc_lo
    s_mov_b32 s64, 0
    s_waitcnt vmcnt(24)
    ds_read2_b32 v[32:33], v240 offset0:132 offset1:133
    ds_read2_b32 v[34:35], v240 offset0:134 offset1:135
    ds_read_b128 v[64:67], v244 offset:2304
    ds_read2_b32 v[36:37], v240 offset0:4 offset1:5
    ds_read2_b32 v[38:39], v240 offset0:6 offset1:7
    ds_read_b128 v[68:71], v244 offset:2560
    ds_read2_b32 v[40:41], v241 offset0:132 offset1:133
    ds_read2_b32 v[42:43], v241 offset0:134 offset1:135
    ds_read_b128 v[72:75], v244 offset:2816
    ds_read2_b32 v[44:45], v241 offset0:4 offset1:5
    ds_read2_b32 v[46:47], v241 offset0:6 offset1:7
    ds_read_b128 v[76:79], v244 offset:3072
    ds_read2_b32 v[48:49], v242 offset0:132 offset1:133
    ds_read2_b32 v[50:51], v242 offset0:134 offset1:135
    ds_read_b128 v[80:83], v244 offset:3328
    ds_read2_b32 v[52:53], v242 offset0:4 offset1:5
    ds_read2_b32 v[54:55], v242 offset0:6 offset1:7
    ds_read_b128 v[84:87], v244 offset:3584
    ds_read2_b32 v[56:57], v243 offset0:132 offset1:133
    ds_read2_b32 v[58:59], v243 offset0:134 offset1:135
    ds_read_b128 v[88:91], v244 offset:3840
    ds_read2_b32 v[60:61], v243 offset0:4 offset1:5
    ds_read2_b32 v[62:63], v243 offset0:6 offset1:7
    ds_read_b128 v[92:95], v244 offset:4096
    s_mov_b32 s60, 0
L_kd:
    ds_read_b128 v[96:99], v15 offset:128
    s_add_u32 s60, s60, 1
    s_waitcnt lgkmcnt(0)
    v_and_b32 v96, v96, v97
    v_and_b32 v98, v98, v99
    v_and_b32 v96, v96, v98
    s_cmp_gt_u32 s60, 0x40000
    s_cbranch_scc1 L_kd_d
    v_readfirstlane_b32 s61, v96
    s_nop 3
    s_cmp_eq_u32 s61, 1
    s_cbranch_scc1 L_kd_d
    s_sleep 1
    s_branch L_kd
L_kd_d:
    s_setprio 0
    s_waitcnt lgkmcnt(0)
    v_mfma_f32_16x16x32_bf16 v[188:191], v[32:35], v[92:95], v[188:191]
    ds_read2_b32 v[96:97], v240 offset0:128 offset1:129
    v_mfma_f32_16x16x32_bf16 v[188:191], v[36:39], v[88:91], v[188:191]
    ds_read2_b32 v[98:99], v240 offset0:130 offset1:131
    v_mfma_f32_16x16x32_bf16 v[188:191], v[40:43], v[84:87], v[188:191]
    ds_read_b128 v[128:131], v244 offset:0
    v_mfma_f32_16x16x32_bf16 v[188:191], v[44:47], v[80:83], v[188:191]
    ds_read2_b32 v[100:101], v240 offset0:0 offset1:1
    v_mfma_f32_16x16x32_bf16 v[188:191], v[48:51], v[76:79], v[188:191]
    ds_read2_b32 v[102:103], v240 offset0:2 offset1:3
    v_mfma_f32_16x16x32_bf16 v[188:191], v[52:55], v[72:75], v[188:191]
    ds_read_b128 v[132:135], v244 offset:256
    v_mfma_f32_16x16x32_bf16 v[188:191], v[56:59], v[68:71], v[188:191]
    ds_read2_b32 v[104:105], v241 offset0:128 offset1:129
    v_mfma_f32_16x16x32_bf16 v[188:191], v[60:63], v[64:67], v[188:191]
    ds_read2_b32 v[106:107], v241 offset0:130 offset1:131
    v_mfma_f32_16x16x32_bf16 v[184:187], v[32:35], v[88:91], v[184:187]
    ds_read_b128 v[136:139], v244 offset:512
    v_mfma_f32_16x16x32_bf16 v[184:187], v[36:39], v[84:87], v[184:187]
    ds_read2_b32 v[108:109], v241 offset0:0 offset1:1
    v_mfma_f32_16x16x32_bf16 v[184:187], v[40:43], v[80:83], v[184:187]
    ds_read2_b32 v[110:111], v241 offset0:2 offset1:3
    v_mfma_f32_16x16x32_bf16 v[184:187], v[44:47], v[76:79], v[184:187]
    ds_read_b128 v[140:143], v244 offset:768
    v_mfma_f32_16x16x32_bf16 v[184:187], v[48:51], v[72:75], v[184:187]
    ds_read2_b32 v[112:113], v242 offset0:128 offset1:129
    v_mfma_f32_16x16x32_bf16 v[184:187], v[52:55], v[68:71], v[184:187]
    ds_read2_b32 v[114:115], v242 offset0:130 offset1:131
    v_mfma_f32_16x16x32_bf16 v[184:187], v[56:59], v[64:67], v[184:187]
    ds_read_b128 v[144:147], v244 offset:1024
    v_mfma_f32_16x16x32_bf16 v[180:183], v[32:35], v[84:87], v[180:183]
    ds_read2_b32 v[116:117], v242 offset0:0 offset1:1
    v_mfma_f32_16x16x32_bf16 v[180:183], v[36:39], v[80:83], v[180:183]
    ds_read2_b32 v[118:119], v242 offset0:2 offset1:3
    v_mfma_f32_16x16x32_bf16 v[180:183], v[40:43], v[76:79], v[180:183]
    ds_read_b128 v[148:151], v244 offset:1280
    v_mfma_f32_16x16x32_bf16 v[180:183], v[44:47], v[72:75], v[180:183]
    ds_read2_b32 v[120:121], v243 offset0:128 offset1:129
    v_mfma_f32_16x16x32_bf16 v[180:183], v[48:51], v[68:71], v[180:183]
    ds_read2_b32 v[122:123], v243 offset0:130 offset1:131
    v_mfma_f32_16x16x32_bf16 v[180:183], v[52:55], v[64:67], v[180:183]
    ds_read_b128 v[152:155], v244 offset:1536
    v_mfma_f32_16x16x32_bf16 v[176:179], v[32:35], v[80:83], v[176:179]
    ds_read2_b32 v[124:125], v243 offset0:0 offset1:1
    v_mfma_f32_16x16x32_bf16 v[176:179], v[36:39], v[76:79], v[176:179]
    ds_read2_b32 v[126:127], v243 offset0:2 offset1:3
    v_mfma_f32_16x16x32_bf16 v[176:179], v[40:43], v[72:75], v[176:179]
    ds_read_b128 v[156:159], v244 offset:1792
    v_mfma_f32_16x16x32_bf16 v[176:179], v[44:47], v[68:71], v[176:179]
    v_subrev_u32 v240, 128, v240
    v_mfma_f32_16x16x32_bf16 v[176:179], v[48:51], v[64:67], v[176:179]
    v_subrev_u32 v241, 128, v241
    v_mfma_f32_16x16x32_bf16 v[172:175], v[32:35], v[76:79], v[172:175]
    v_subrev_u32 v242, 128, v242
    v_mfma_f32_16x16x32_bf16 v[172:175], v[36:39], v[72:75], v[172:175]
    v_subrev_u32 v243, 128, v243
    v_mfma_f32_16x16x32_bf16 v[172:175], v[40:43], v[68:71], v[172:175]
    v_subrev_u32 v244, 64, v244
    v_mfma_f32_16x16x32_bf16 v[172:175], v[44:47], v[64:67], v[172:175]
    v_mfma_f32_16x16x32_bf16 v[168:171], v[32:35], v[72:75], v[168:171]
    v_mfma_f32_16x16x32_bf16 v[168:171], v[36:39], v[68:71], v[168:171]
    v_mfma_f32_16x16x32_bf16 v[168:171], v[40:43], v[64:67], v[168:171]
    v_mfma_f32_16x16x32_bf16 v[164:167], v[32:35], v[68:71], v[164:167]
    v_mfma_f32_16x16x32_bf16 v[164:167], v[36:39], v[64:67], v[164:167]
    v_mfma_f32_16x16x32_bf16 v[160:163], v[32:35], v[64:67], v[160:163]
    s_waitcnt lgkmcnt(0)
    s_waitcnt vmcnt(0)
    v_mfma_f32_16x16x32_bf16 v[188:191], v[96:99], v[156:159], v[188:191]
    ds_read2_b32 v[32:33], v240 offset0:132 offset1:133
    s_mov_b32 s29, 1
    v_mfma_f32_16x16x32_bf16 v[188:191], v[100:103], v[152:155], v[188:191]
    ds_read2_b32 v[34:35], v240 offset0:134 offset1:135
    s_mov_b32 s61, 0
    v_mfma_f32_16x16x32_bf16 v[188:191], v[104:107], v[148:151], v[188:191]
    ds_read_b128 v[64:67], v244 offset:2304
    s_lshl_b32 s60, s3, 1
    v_mfma_f32_16x16x32_bf16 v[188:191], v[108:111], v[144:147], v[188:191]
    ds_read2_b32 v[36:37], v240 offset0:4 offset1:5
    s_bitset1_b32 s61, s60
    v_mfma_f32_16x16x32_bf16 v[188:191], v[112:115], v[140:143], v[188:191]
    ds_read2_b32 v[38:39], v240 offset0:6 offset1:7
    s_lshl_b32 s60, s75, 1
    v_mfma_f32_16x16x32_bf16 v[188:191], v[116:119], v[136:139], v[188:191]
    ds_read_b128 v[68:71], v244 offset:2560
    s_bitset1_b32 s61, s60
    v_mfma_f32_16x16x32_bf16 v[188:191], v[120:123], v[132:135], v[188:191]
    ds_read2_b32 v[40:41], v241 offset0:132 offset1:133
    s_lshl_b32 s60, s65, 1
    v_mfma_f32_16x16x32_bf16 v[188:191], v[124:127], v[128:131], v[188:191]
    ds_read2_b32 v[42:43], v241 offset0:134 offset1:135
    s_bitset1_b32 s61, s60
    v_mfma_f32_16x16x32_bf16 v[184:187], v[96:99], v[152:155], v[184:187]
    ds_read_b128 v[72:75], v244 offset:2816
    v_mov_b32 v3, s61
    v_mfma_f32_16x16x32_bf16 v[184:187], v[100:103], v[148:151], v[184:187]
    ds_read2_b32 v[44:45], v241 offset0:4 offset1:5
    s_mov_b64 exec, 1
    ds_or_b32 v15, v3 offset:60
    s_mov_b64 exec, -1
    v_mfma_f32_16x16x32_bf16 v[184:187], v[104:107], v[144:147], v[184:187]
    ds_read2_b32 v[46:47], v241 offset0:6 offset1:7
    s_add_u32 s60, s31, s74
    v_mfma_f32_16x16x32_bf16 v[184:187], v[108:111], v[140:143], v[184:187]
    ds_read_b128 v[76:79], v244 offset:3072
    s_and_b32 s60, s60, 15
    v_mfma_f32_16x16x32_bf16 v[184:187], v[112:115], v[136:139], v[184:187]
    ds_read2_b32 v[48:49], v242 offset0:132 offset1:133
    s_lshl_b32 s60, s60, 17
    v_mfma_f32_16x16x32_bf16 v[184:187], v[116:119], v[132:135], v[184:187]
    ds_read2_b32 v[50:51], v242 offset0:134 offset1:135
    s_add_u32 s61, s60, 0x10000
    v_mfma_f32_16x16x32_bf16 v[184:187], v[120:123], v[128:131], v[184:187]
    ds_read_b128 v[80:83], v244 offset:3328
    buffer_load_dwordx4 v[192:195], v20, s[56:59], s60 offen offset:0
    v_mfma_f32_16x16x32_bf16 v[180:183], v[96:99], v[148:151], v[180:183]
    ds_read2_b32 v[52:53], v242 offset0:4 offset1:5
    buffer_load_dwordx4 v[196:199], v21, s[56:59], s60 offen offset:1024
    v_mfma_f32_16x16x32_bf16 v[180:183], v[100:103], v[144:147], v[180:183]
    ds_read2_b32 v[54:55], v242 offset0:6 offset1:7
    buffer_load_dwordx4 v[200:203], v22, s[56:59], s60 offen offset:2048
    v_mfma_f32_16x16x32_bf16 v[180:183], v[104:107], v[140:143], v[180:183]
    ds_read_b128 v[84:87], v244 offset:3584
    buffer_load_dwordx4 v[204:207], v23, s[56:59], s60 offen offset:3072
    v_mfma_f32_16x16x32_bf16 v[180:183], v[108:111], v[136:139], v[180:183]
    ds_read2_b32 v[56:57], v243 offset0:132 offset1:133
    buffer_load_dwordx4 v[208:211], v20, s[56:59], s61 offen offset:0
    v_mfma_f32_16x16x32_bf16 v[180:183], v[112:115], v[132:135], v[180:183]
    ds_read2_b32 v[58:59], v243 offset0:134 offset1:135
    buffer_load_dwordx4 v[212:215], v21, s[56:59], s61 offen offset:1024
    v_mfma_f32_16x16x32_bf16 v[180:183], v[116:119], v[128:131], v[180:183]
    ds_read_b128 v[88:91], v244 offset:3840
    buffer_load_dwordx4 v[216:219], v22, s[56:59], s61 offen offset:2048
    v_mfma_f32_16x16x32_bf16 v[176:179], v[96:99], v[144:147], v[176:179]
    ds_read2_b32 v[60:61], v243 offset0:4 offset1:5
    buffer_load_dwordx4 v[220:223], v23, s[56:59], s61 offen offset:3072
    v_mfma_f32_16x16x32_bf16 v[176:179], v[100:103], v[140:143], v[176:179]
    ds_read2_b32 v[62:63], v243 offset0:6 offset1:7
    buffer_load_dwordx4 v[224:227], v16, s[40:43], s30 offen
    v_mfma_f32_16x16x32_bf16 v[176:179], v[104:107], v[136:139], v[176:179]
    ds_read_b128 v[92:95], v244 offset:4096
    s_add_u32 s30, s30, 0x4000
    v_mfma_f32_16x16x32_bf16 v[176:179], v[108:111], v[132:135], v[176:179]
    buffer_load_dwordx4 v[228:231], v16, s[40:43], s30 offen
    v_mfma_f32_16x16x32_bf16 v[176:179], v[112:115], v[128:131], v[176:179]
    s_add_u32 s30, s30, 0x4000
    v_mfma_f32_16x16x32_bf16 v[172:175], v[96:99], v[140:143], v[172:175]
    buffer_load_dwordx4 v[232:235], v16, s[40:43], s30 offen
    v_mfma_f32_16x16x32_bf16 v[172:175], v[100:103], v[136:139], v[172:175]
    s_add_u32 s30, s30, 0x4000
    v_mfma_f32_16x16x32_bf16 v[172:175], v[104:107], v[132:135], v[172:175]
    buffer_load_dwordx4 v[236:239], v16, s[40:43], s30 offen
    v_mfma_f32_16x16x32_bf16 v[172:175], v[108:111], v[128:131], v[172:175]
    v_mfma_f32_16x16x32_bf16 v[168:171], v[96:99], v[136:139], v[168:171]
    v_mfma_f32_16x16x32_bf16 v[168:171], v[100:103], v[132:135], v[168:171]
    v_mfma_f32_16x16x32_bf16 v[168:171], v[104:107], v[128:131], v[168:171]
    v_mfma_f32_16x16x32_bf16 v[164:167], v[96:99], v[132:135], v[164:167]
    v_mfma_f32_16x16x32_bf16 v[164:167], v[100:103], v[128:131], v[164:167]
    v_mfma_f32_16x16x32_bf16 v[160:163], v[96:99], v[128:131], v[160:163]
L_cloop:
    s_waitcnt lgkmcnt(0)
    v_mfma_f32_16x16x32_bf16 v[188:191], v[32:35], v[92:95], v[188:191]
    ds_read2_b32 v[96:97], v240 offset0:128 offset1:129
    v_mfma_f32_16x16x32_bf16 v[188:191], v[36:39], v[88:91], v[188:191]
    ds_read2_b32 v[98:99], v240 offset0:130 offset1:131
    v_mfma_f32_16x16x32_bf16 v[188:191], v[40:43], v[84:87], v[188:191]
    ds_read_b128 v[128:131], v244 offset:0
    v_mfma_f32_16x16x32_bf16 v[188:191], v[44:47], v[80:83], v[188:191]
    ds_read2_b32 v[100:101], v240 offset0:0 offset1:1
    v_mfma_f32_16x16x32_bf16 v[188:191], v[48:51], v[76:79], v[188:191]
    ds_read2_b32 v[102:103], v240 offset0:2 offset1:3
    v_mfma_f32_16x16x32_bf16 v[188:191], v[52:55], v[72:75], v[188:191]
    ds_read_b128 v[132:135], v244 offset:256
    v_mfma_f32_16x16x32_bf16 v[188:191], v[56:59], v[68:71], v[188:191]
    ds_read2_b32 v[104:105], v241 offset0:128 offset1:129
    v_mfma_f32_16x16x32_bf16 v[188:191], v[60:63], v[64:67], v[188:191]
    ds_read2_b32 v[106:107], v241 offset0:130 offset1:131
    v_mfma_f32_16x16x32_bf16 v[184:187], v[32:35], v[88:91], v[184:187]
    ds_read_b128 v[136:139], v244 offset:512
    v_mfma_f32_16x16x32_bf16 v[184:187], v[36:39], v[84:87], v[184:187]
    ds_read2_b32 v[108:109], v241 offset0:0 offset1:1
    v_mfma_f32_16x16x32_bf16 v[184:187], v[40:43], v[80:83], v[184:187]
    ds_read2_b32 v[110:111], v241 offset0:2 offset1:3
    v_mfma_f32_16x16x32_bf16 v[184:187], v[44:47], v[76:79], v[184:187]
    ds_read_b128 v[140:143], v244 offset:768
    v_mfma_f32_16x16x32_bf16 v[184:187], v[48:51], v[72:75], v[184:187]
    ds_read2_b32 v[112:113], v242 offset0:128 offset1:129
    v_mfma_f32_16x16x32_bf16 v[184:187], v[52:55], v[68:71], v[184:187]
    ds_read2_b32 v[114:115], v242 offset0:130 offset1:131
    v_mfma_f32_16x16x32_bf16 v[184:187], v[56:59], v[64:67], v[184:187]
    ds_read_b128 v[144:147], v244 offset:1024
    v_mfma_f32_16x16x32_bf16 v[180:183], v[32:35], v[84:87], v[180:183]
    ds_read2_b32 v[116:117], v242 offset0:0 offset1:1
    v_mfma_f32_16x16x32_bf16 v[180:183], v[36:39], v[80:83], v[180:183]
    ds_read2_b32 v[118:119], v242 offset0:2 offset1:3
    v_mfma_f32_16x16x32_bf16 v[180:183], v[40:43], v[76:79], v[180:183]
    ds_read_b128 v[148:151], v244 offset:1280
    v_mfma_f32_16x16x32_bf16 v[180:183], v[44:47], v[72:75], v[180:183]
    ds_read2_b32 v[120:121], v243 offset0:128 offset1:129
    v_mfma_f32_16x16x32_bf16 v[180:183], v[48:51], v[68:71], v[180:183]
    ds_read2_b32 v[122:123], v243 offset0:130 offset1:131
    v_mfma_f32_16x16x32_bf16 v[180:183], v[52:55], v[64:67], v[180:183]
    ds_read_b128 v[152:155], v244 offset:1536
    v_mfma_f32_16x16x32_bf16 v[176:179], v[32:35], v[80:83], v[176:179]
    ds_read2_b32 v[124:125], v243 offset0:0 offset1:1
    v_mfma_f32_16x16x32_bf16 v[176:179], v[36:39], v[76:79], v[176:179]
    ds_read2_b32 v[126:127], v243 offset0:2 offset1:3
    v_mfma_f32_16x16x32_bf16 v[176:179], v[40:43], v[72:75], v[176:179]
    ds_read_b128 v[156:159], v244 offset:1792
    v_mfma_f32_16x16x32_bf16 v[176:179], v[44:47], v[68:71], v[176:179]
    v_subrev_u32 v240, 128, v240
    v_mfma_f32_16x16x32_bf16 v[176:179], v[48:51], v[64:67], v[176:179]
    v_subrev_u32 v241, 128, v241
    v_mfma_f32_16x16x32_bf16 v[172:175], v[32:35], v[76:79], v[172:175]
    v_subrev_u32 v242, 128, v242
    v_mfma_f32_16x16x32_bf16 v[172:175], v[36:39], v[72:75], v[172:175]
    v_subrev_u32 v243, 128, v243
    v_mfma_f32_16x16x32_bf16 v[172:175], v[40:43], v[68:71], v[172:175]
    v_subrev_u32 v244, 64, v244
    v_mfma_f32_16x16x32_bf16 v[172:175], v[44:47], v[64:67], v[172:175]
    v_mfma_f32_16x16x32_bf16 v[168:171], v[32:35], v[72:75], v[168:171]
    v_mfma_f32_16x16x32_bf16 v[168:171], v[36:39], v[68:71], v[168:171]
    v_mfma_f32_16x16x32_bf16 v[168:171], v[40:43], v[64:67], v[168:171]
    v_mfma_f32_16x16x32_bf16 v[164:167], v[32:35], v[68:71], v[164:167]
    v_mfma_f32_16x16x32_bf16 v[164:167], v[36:39], v[64:67], v[164:167]
    v_mfma_f32_16x16x32_bf16 v[160:163], v[32:35], v[64:67], v[160:163]
    s_waitcnt lgkmcnt(0)
    v_mfma_f32_16x16x32_bf16 v[188:191], v[96:99], v[156:159], v[188:191]
    ds_read2_b32 v[32:33], v240 offset0:132 offset1:133
    v_mfma_f32_16x16x32_bf16 v[188:191], v[100:103], v[152:155], v[188:191]
    ds_read2_b32 v[34:35], v240 offset0:134 offset1:135
    v_mfma_f32_16x16x32_bf16 v[188:191], v[104:107], v[148:151], v[188:191]
    ds_read_b128 v[64:67], v244 offset:2304
    v_mfma_f32_16x16x32_bf16 v[188:191], v[108:111], v[144:147], v[188:191]
    ds_read2_b32 v[36:37], v240 offset0:4 offset1:5
    v_mfma_f32_16x16x32_bf16 v[188:191], v[112:115], v[140:143], v[188:191]
    ds_read2_b32 v[38:39], v240 offset0:6 offset1:7
    v_mfma_f32_16x16x32_bf16 v[188:191], v[116:119], v[136:139], v[188:191]
    ds_read_b128 v[68:71], v244 offset:2560
    v_mfma_f32_16x16x32_bf16 v[188:191], v[120:123], v[132:135], v[188:191]
    ds_read2_b32 v[40:41], v241 offset0:132 offset1:133
    v_mfma_f32_16x16x32_bf16 v[188:191], v[124:127], v[128:131], v[188:191]
    ds_read2_b32 v[42:43], v241 offset0:134 offset1:135
    v_mfma_f32_16x16x32_bf16 v[184:187], v[96:99], v[152:155], v[184:187]
    ds_read_b128 v[72:75], v244 offset:2816
    v_mfma_f32_16x16x32_bf16 v[184:187], v[100:103], v[148:151], v[184:187]
    ds_read2_b32 v[44:45], v241 offset0:4 offset1:5
    v_mfma_f32_16x16x32_bf16 v[184:187], v[104:107], v[144:147], v[184:187]
    ds_read2_b32 v[46:47], v241 offset0:6 offset1:7
    v_mfma_f32_16x16x32_bf16 v[184:187], v[108:111], v[140:143], v[184:187]
    ds_read_b128 v[76:79], v244 offset:3072
    v_mfma_f32_16x16x32_bf16 v[184:187], v[112:115], v[136:139], v[184:187]
    ds_read2_b32 v[48:49], v242 offset0:132 offset1:133
    v_mfma_f32_16x16x32_bf16 v[184:187], v[116:119], v[132:135], v[184:187]
    ds_read2_b32 v[50:51], v242 offset0:134 offset1:135
    v_mfma_f32_16x16x32_bf16 v[184:187], v[120:123], v[128:131], v[184:187]
    ds_read_b128 v[80:83], v244 offset:3328
    v_mfma_f32_16x16x32_bf16 v[180:183], v[96:99], v[148:151], v[180:183]
    ds_read2_b32 v[52:53], v242 offset0:4 offset1:5
    v_mfma_f32_16x16x32_bf16 v[180:183], v[100:103], v[144:147], v[180:183]
    ds_read2_b32 v[54:55], v242 offset0:6 offset1:7
    v_mfma_f32_16x16x32_bf16 v[180:183], v[104:107], v[140:143], v[180:183]
    ds_read_b128 v[84:87], v244 offset:3584
    v_mfma_f32_16x16x32_bf16 v[180:183], v[108:111], v[136:139], v[180:183]
    ds_read2_b32 v[56:57], v243 offset0:132 offset1:133
    v_mfma_f32_16x16x32_bf16 v[180:183], v[112:115], v[132:135], v[180:183]
    ds_read2_b32 v[58:59], v243 offset0:134 offset1:135
    v_mfma_f32_16x16x32_bf16 v[180:183], v[116:119], v[128:131], v[180:183]
    ds_read_b128 v[88:91], v244 offset:3840
    v_mfma_f32_16x16x32_bf16 v[176:179], v[96:99], v[144:147], v[176:179]
    ds_read2_b32 v[60:61], v243 offset0:4 offset1:5
    v_mfma_f32_16x16x32_bf16 v[176:179], v[100:103], v[140:143], v[176:179]
    ds_read2_b32 v[62:63], v243 offset0:6 offset1:7
    v_mfma_f32_16x16x32_bf16 v[176:179], v[104:107], v[136:139], v[176:179]
    ds_read_b128 v[92:95], v244 offset:4096
    v_mfma_f32_16x16x32_bf16 v[176:179], v[108:111], v[132:135], v[176:179]
    s_add_u32 s29, s29, 1
    v_mfma_f32_16x16x32_bf16 v[176:179], v[112:115], v[128:131], v[176:179]
    s_cmp_lt_u32 s29, 4
    v_mfma_f32_16x16x32_bf16 v[172:175], v[96:99], v[140:143], v[172:175]
    v_mfma_f32_16x16x32_bf16 v[172:175], v[100:103], v[136:139], v[172:175]
    v_mfma_f32_16x16x32_bf16 v[172:175], v[104:107], v[132:135], v[172:175]
    v_mfma_f32_16x16x32_bf16 v[172:175], v[108:111], v[128:131], v[172:175]
    v_mfma_f32_16x16x32_bf16 v[168:171], v[96:99], v[136:139], v[168:171]
    v_mfma_f32_16x16x32_bf16 v[168:171], v[100:103], v[132:135], v[168:171]
    v_mfma_f32_16x16x32_bf16 v[168:171], v[104:107], v[128:131], v[168:171]
    v_mfma_f32_16x16x32_bf16 v[164:167], v[96:99], v[132:135], v[164:167]
    v_mfma_f32_16x16x32_bf16 v[164:167], v[100:103], v[128:131], v[164:167]
    v_mfma_f32_16x16x32_bf16 v[160:163], v[96:99], v[128:131], v[160:163]
    s_cbranch_scc1 L_cloop
    ds_read_b64 v[136:137], v245 offset:3584
    ds_read_b64 v[138:139], v245 offset:3072
    ds_read_b64 v[140:141], v245 offset:2560
    ds_read_b64 v[142:143], v245 offset:2048
    ds_read_b64 v[144:145], v245 offset:1536
    ds_read_b64 v[146:147], v245 offset:1024
    ds_read_b64 v[148:149], v245 offset:512
    ds_read_b64 v[150:151], v245 offset:0
    s_mov_b64 exec, 1
    ds_add_u32 v15, v14 offset:36
    s_mov_b64 exec, -1
    s_setprio 3
    s_waitcnt lgkmcnt(0)
    v_and_b32 v152, s70, v137
    v_lshlrev_b32 v153, 16, v137
    v_and_b32 v154, s70, v136
    v_lshlrev_b32 v155, 16, v136
    v_fmac_f32 v160, s71, v152
    v_fmac_f32 v161, s71, v153
    v_fmac_f32 v162, s71, v154
    v_fmac_f32 v163, s71, v155
    v_cvt_pk_bf16_f32 v136, v160, v161
    v_cvt_pk_bf16_f32 v137, v162, v163
    v_and_b32 v152, s70, v139
    v_lshlrev_b32 v153, 16, v139
    v_and_b32 v154, s70, v138
    v_lshlrev_b32 v155, 16, v138
    v_fmac_f32 v164, s71, v152
    v_fmac_f32 v165, s71, v153
    v_fmac_f32 v166, s71, v154
    v_fmac_f32 v167, s71, v155
    v_cvt_pk_bf16_f32 v138, v164, v165
    v_cvt_pk_bf16_f32 v139, v166, v167
    v_and_b32 v152, s70, v141
    v_lshlrev_b32 v153, 16, v141
    v_and_b32 v154, s70, v140
    v_lshlrev_b32 v155, 16, v140
    v_fmac_f32 v168, s71, v152
    v_fmac_f32 v169, s71, v153
    v_fmac_f32 v170, s71, v154
    v_fmac_f32 v171, s71, v155
    v_cvt_pk_bf16_f32 v140, v168, v169
    v_cvt_pk_bf16_f32 v141, v170, v171
    v_and_b32 v152, s70, v143
    v_lshlrev_b32 v153, 16, v143
    v_and_b32 v154, s70, v142
    v_lshlrev_b32 v155, 16, v142
    v_fmac_f32 v172, s71, v152
    v_fmac_f32 v173, s71, v153
    v_fmac_f32 v174, s71, v154
    v_fmac_f32 v175, s71, v155
    v_cvt_pk_bf16_f32 v142, v172, v173
    v_cvt_pk_bf16_f32 v143, v174, v175
    v_and_b32 v152, s70, v145
    v_lshlrev_b32 v153, 16, v145
    v_and_b32 v154, s70, v144
    v_lshlrev_b32 v155, 16, v144
    v_fmac_f32 v176, s71, v152
    v_fmac_f32 v177, s71, v153
    v_fmac_f32 v178, s71, v154
    v_fmac_f32 v179, s71, v155
    v_cvt_pk_bf16_f32 v144, v176, v177
    v_cvt_pk_bf16_f32 v145, v178, v179
    v_and_b32 v152, s70, v147
    v_lshlrev_b32 v153, 16, v147
    v_and_b32 v154, s70, v146
    v_lshlrev_b32 v155, 16, v146
    v_fmac_f32 v180, s71, v152
    v_fmac_f32 v181, s71, v153
    v_fmac_f32 v182, s71, v154
    v_fmac_f32 v183, s71, v155
    v_cvt_pk_bf16_f32 v146, v180, v181
    v_cvt_pk_bf16_f32 v147, v182, v183
    v_and_b32 v152, s70, v149
    v_lshlrev_b32 v153, 16, v149
    v_and_b32 v154, s70, v148
    v_lshlrev_b32 v155, 16, v148
    v_fmac_f32 v184, s71, v152
    v_fmac_f32 v185, s71, v153
    v_fmac_f32 v186, s71, v154
    v_fmac_f32 v187, s71, v155
    v_cvt_pk_bf16_f32 v148, v184, v185
    v_cvt_pk_bf16_f32 v149, v186, v187
    v_and_b32 v152, s70, v151
    v_lshlrev_b32 v153, 16, v151
    v_and_b32 v154, s70, v150
    v_lshlrev_b32 v155, 16, v150
    v_fmac_f32 v188, s71, v152
    v_fmac_f32 v189, s71, v153
    v_fmac_f32 v190, s71, v154
    v_fmac_f32 v191, s71, v155
    v_cvt_pk_bf16_f32 v150, v188, v189
    v_cvt_pk_bf16_f32 v151, v190, v191
    s_nop 1
    v_permlane16_swap_b32 v136, v138
    v_permlane16_swap_b32 v137, v139
    v_permlane16_swap_b32 v140, v142
    v_permlane16_swap_b32 v141, v143
    v_permlane16_swap_b32 v144, v146
    v_permlane16_swap_b32 v145, v147
    v_permlane16_swap_b32 v148, v150
    v_permlane16_swap_b32 v149, v151
    s_waitcnt vmcnt(4)
    buffer_store_dwordx4 v[136:139], v246, s[48:51], s39 offen offset:0 sc1
    buffer_store_dwordx4 v[140:143], v246, s[48:51], s39 offen offset:1024 sc1
    buffer_store_dwordx4 v[144:147], v246, s[48:51], s39 offen offset:2048 sc1
    buffer_store_dwordx4 v[148:151], v246, s[48:51], s39 offen offset:3072 sc1
    s_mov_b32 s60, 0
L_cdspin:
    ds_read_b32 v3, v15 offset:36
    s_add_u32 s60, s60, 1
    s_waitcnt lgkmcnt(0)
    v_readfirstlane_b32 s61, v3
    s_cmp_gt_u32 s60, 0x40000
    s_cbranch_scc1 L_cdspin_done
    s_cmp_ge_u32 s61, 4
    s_cbranch_scc1 L_cdspin_done
    s_sleep 0
    s_branch L_cdspin
L_cdspin_done:
    s_lshl_b32 s60, s3, 13
    s_add_u32 s60, s60, 98304
    v_add_u32 v18, s60, v5
    ds_write_b128 v18, v[192:195] offset:0
    ds_write_b128 v18, v[196:199] offset:1024
    ds_write_b128 v18, v[200:203] offset:2048
    ds_write_b128 v18, v[204:207] offset:3072
    ds_write_b128 v18, v[208:211] offset:4096
    ds_write_b128 v18, v[212:215] offset:5120
    ds_write_b128 v18, v[216:219] offset:6144
    ds_write_b128 v18, v[220:223] offset:7168
    s_mov_b32 s61, 0
    s_lshl_b32 s60, s31, 1
    s_bitset1_b32 s61, s60
    v_mov_b32 v3, s61
    s_mov_b64 exec, 1
    ds_or_b32 v15, v3 offset:60
    s_mov_b64 exec, -1
    s_lshl_b32 s65, s36, 18
    s_lshl_b32 s60, s69, 1
    s_add_u32 s65, s65, s60
    s_add_u32 s65, s65, 0x0
    v_lshrrev_b32 v18, 2, v4
    v_lshlrev_b32 v18, 12, v18
    v_lshl_add_u32 v18, v30, 4, v18
    v_lshl_add_u32 v20, v28, 3, v29
    v_lshlrev_b32 v20, 6, v20
    v_lshl_add_u32 v20, v30, 3, v20
    v_add_u32 v20, s68, v20
    s_movk_i32 s60, 144
    v_mul_u32_u24 v24, s60, v31
    v_lshl_add_u32 v24, v28, 4, v24
    v_add_u32 v24, s68, v24
    v_mul_u32_u24 v25, s60, v1
    v_add3_u32 v25, v25, v27, s68
    s_mov_b32 m0, s68
    s_waitcnt vmcnt(0)
    s_mov_b64 exec, 1
    ds_add_rtn_u32 v3, v15, v14 offset:32
    s_mov_b64 exec, -1
    s_waitcnt lgkmcnt(0)
    v_readfirstlane_b32 s60, v3
    s_nop 3
    s_cmp_eq_u32 s60, 3
    s_cbranch_scc0 L_yfl
    s_mov_b64 exec, -1
    buffer_store_dword v7, v255, s[48:51], s32 offen sc1
    s_mov_b64 exec, -1
L_yfl:
    s_setprio 0
    v_lshlrev_b32 v96, 16, v224
    v_and_b32 v97, s70, v224
    v_lshlrev_b32 v98, 16, v225
    v_and_b32 v99, s70, v225
    v_lshlrev_b32 v100, 16, v226
    v_and_b32 v101, s70, v226
    v_lshlrev_b32 v102, 16, v227
    v_and_b32 v103, s70, v227
    v_lshlrev_b32 v104, 16, v228
    v_and_b32 v105, s70, v228
    v_lshlrev_b32 v106, 16, v229
    v_and_b32 v107, s70, v229
    v_lshlrev_b32 v108, 16, v230
    v_and_b32 v109, s70, v230
    v_lshlrev_b32 v110, 16, v231
    v_and_b32 v111, s70, v231
    v_lshlrev_b32 v112, 16, v232
    v_and_b32 v113, s70, v232
    v_lshlrev_b32 v114, 16, v233
    v_and_b32 v115, s70, v233
    v_lshlrev_b32 v116, 16, v234
    v_and_b32 v117, s70, v234
    v_lshlrev_b32 v118, 16, v235
    v_and_b32 v119, s70, v235
    v_lshlrev_b32 v120, 16, v236
    v_and_b32 v121, s70, v236
    v_lshlrev_b32 v122, 16, v237
    v_and_b32 v123, s70, v237
    v_lshlrev_b32 v124, 16, v238
    v_and_b32 v125, s70, v238
    v_lshlrev_b32 v126, 16, v239
    v_and_b32 v127, s70, v239
    s_mov_b32 s29, 0
L_yloop:
    s_cmp_eq_u32 s64, 0x5555
    s_cbranch_scc1 L_ynop
    s_load_dwordx16 s[4:19], s[26:27], s66 glc
    s_waitcnt lgkmcnt(0)
    s_mov_b32 s62, 0
    s_cmp_eq_u64 s[4:5], s[72:73]
    s_cselect_b32 s60, 0x1, 0
    s_or_b32 s62, s62, s60
    s_cmp_eq_u64 s[6:7], s[72:73]
    s_cselect_b32 s60, 0x4, 0
    s_or_b32 s62, s62, s60
    s_cmp_eq_u64 s[8:9], s[72:73]
    s_cselect_b32 s60, 0x10, 0
    s_or_b32 s62, s62, s60
    s_cmp_eq_u64 s[10:11], s[72:73]
    s_cselect_b32 s60, 0x40, 0
    s_or_b32 s62, s62, s60
    s_cmp_eq_u64 s[12:13], s[72:73]
    s_cselect_b32 s60, 0x100, 0
    s_or_b32 s62, s62, s60
    s_cmp_eq_u64 s[14:15], s[72:73]
    s_cselect_b32 s60, 0x400, 0
    s_or_b32 s62, s62, s60
    s_cmp_eq_u64 s[16:17], s[72:73]
    s_cselect_b32 s60, 0x1000, 0
    s_or_b32 s62, s62, s60
    s_cmp_eq_u64 s[18:19], s[72:73]
    s_cselect_b32 s60, 0x4000, 0
    s_or_b32 s62, s62, s60
    s_mov_b32 s64, s62
    s_lshl_b32 s60, s62, s33
    s_mov_b32 s61, s60
    s_lshr_b64 s[60:61], s[60:61], s28
    v_mov_b32 v3, s60
    s_mov_b64 exec, 1
    ds_or_b32 v19, v3 offset:64
    s_mov_b64 exec, -1
L_ynop:
    s_load_dwordx16 s[4:19], s[26:27], s67 glc
    s_add_u32 s29, s29, 1
    s_cmp_gt_u32 s29, 0x8000
    s_cbranch_scc1 L_ydone
    s_waitcnt lgkmcnt(0)
    s_cmp_eq_u64 s[4:5], s[72:73]
    s_cbranch_scc0 L_yloop
    s_cmp_eq_u64 s[6:7], s[72:73]
    s_cbranch_scc0 L_yloop
    s_cmp_eq_u64 s[8:9], s[72:73]
    s_cbranch_scc0 L_yloop
    s_cmp_eq_u64 s[10:11], s[72:73]
    s_cbranch_scc0 L_yloop
    s_cmp_eq_u64 s[12:13], s[72:73]
    s_cbranch_scc0 L_yloop
    s_cmp_eq_u64 s[14:15], s[72:73]
    s_cbranch_scc0 L_yloop
    s_cmp_eq_u64 s[16:17], s[72:73]
    s_cbranch_scc0 L_yloop
    s_cmp_eq_u64 s[18:19], s[72:73]
    s_cbranch_scc0 L_yloop
L_ydone:
    s_waitcnt lgkmcnt(0)
    buffer_load_dwordx4 v18, s[48:51], s65 offen offset:0 sc1 lds
    s_add_u32 s65, s65, 64512
    buffer_load_dwordx4 v18, s[48:51], s65 offen offset:1024 sc1 lds
    s_add_u32 s65, s65, 64512
    buffer_load_dwordx4 v18, s[48:51], s65 offen offset:2048 sc1 lds
    s_add_u32 s65, s65, 64512
    buffer_load_dwordx4 v18, s[48:51], s65 offen offset:3072 sc1 lds
    s_waitcnt vmcnt(0)
    ds_read_b64_tr_b16 v[48:49], v20 offset:0
    ds_read_b64_tr_b16 v[50:51], v20 offset:256
    ds_read_b64_tr_b16 v[52:53], v20 offset:2048
    ds_read_b64_tr_b16 v[54:55], v20 offset:2304
    ds_read_b64_tr_b16 v[56:57], v20 offset:32
    ds_read_b64_tr_b16 v[58:59], v20 offset:288
    ds_read_b64_tr_b16 v[60:61], v20 offset:2080
    ds_read_b64_tr_b16 v[62:63], v20 offset:2336
    s_waitcnt lgkmcnt(0)
    ds_write_b128 v24, v[48:51] offset:0
    ds_write_b128 v24, v[52:55] offset:64
    ds_write_b128 v24, v[56:59] offset:2304
    ds_write_b128 v24, v[60:63] offset:2368
    ds_read_b128 v[80:83], v25 offset:0
    ds_read_b128 v[84:87], v25 offset:1152
    ds_read_b128 v[88:91], v25 offset:2304
    ds_read_b128 v[92:95], v25 offset:3456
    s_waitcnt lgkmcnt(3)
    v_lshlrev_b32 v64, 16, v80
    v_and_b32 v65, s70, v80
    v_lshlrev_b32 v66, 16, v81
    v_and_b32 v67, s70, v81
    v_lshlrev_b32 v68, 16, v82
    v_and_b32 v69, s70, v82
    v_lshlrev_b32 v70, 16, v83
    v_and_b32 v71, s70, v83
    v_mul_f32 v64, v64, v96
    v_mul_f32 v65, v65, v97
    v_mul_f32 v66, v66, v98
    v_mul_f32 v67, v67, v99
    v_mul_f32 v68, v68, v100
    v_mul_f32 v69, v69, v101
    v_mul_f32 v70, v70, v102
    v_mul_f32 v71, v71, v103
    v_cvt_pk_bf16_f32 v224, v64, v65
    v_cvt_pk_bf16_f32 v225, v66, v67
    v_cvt_pk_bf16_f32 v226, v68, v69
    v_cvt_pk_bf16_f32 v227, v70, v71
    buffer_store_dwordx4 v[224:227], v17, s[44:47], s63 offen sc1
    s_add_u32 s63, s63, 0x8000
    s_waitcnt lgkmcnt(2)
    v_lshlrev_b32 v64, 16, v84
    v_and_b32 v65, s70, v84
    v_lshlrev_b32 v66, 16, v85
    v_and_b32 v67, s70, v85
    v_lshlrev_b32 v68, 16, v86
    v_and_b32 v69, s70, v86
    v_lshlrev_b32 v70, 16, v87
    v_and_b32 v71, s70, v87
    v_mul_f32 v64, v64, v104
    v_mul_f32 v65, v65, v105
    v_mul_f32 v66, v66, v106
    v_mul_f32 v67, v67, v107
    v_mul_f32 v68, v68, v108
    v_mul_f32 v69, v69, v109
    v_mul_f32 v70, v70, v110
    v_mul_f32 v71, v71, v111
    v_cvt_pk_bf16_f32 v228, v64, v65
    v_cvt_pk_bf16_f32 v229, v66, v67
    v_cvt_pk_bf16_f32 v230, v68, v69
    v_cvt_pk_bf16_f32 v231, v70, v71
    buffer_store_dwordx4 v[228:231], v17, s[44:47], s63 offen sc1
    s_add_u32 s63, s63, 0x8000
    s_waitcnt lgkmcnt(1)
    v_lshlrev_b32 v64, 16, v88
    v_and_b32 v65, s70, v88
    v_lshlrev_b32 v66, 16, v89
    v_and_b32 v67, s70, v89
    v_lshlrev_b32 v68, 16, v90
    v_and_b32 v69, s70, v90
    v_lshlrev_b32 v70, 16, v91
    v_and_b32 v71, s70, v91
    v_mul_f32 v64, v64, v112
    v_mul_f32 v65, v65, v113
    v_mul_f32 v66, v66, v114
    v_mul_f32 v67, v67, v115
    v_mul_f32 v68, v68, v116
    v_mul_f32 v69, v69, v117
    v_mul_f32 v70, v70, v118
    v_mul_f32 v71, v71, v119
    v_cvt_pk_bf16_f32 v232, v64, v65
    v_cvt_pk_bf16_f32 v233, v66, v67
    v_cvt_pk_bf16_f32 v234, v68, v69
    v_cvt_pk_bf16_f32 v235, v70, v71
    buffer_store_dwordx4 v[232:235], v17, s[44:47], s63 offen sc1
    s_add_u32 s63, s63, 0x8000
    s_waitcnt lgkmcnt(0)
    v_lshlrev_b32 v64, 16, v92
    v_and_b32 v65, s70, v92
    v_lshlrev_b32 v66, 16, v93
    v_and_b32 v67, s70, v93
    v_lshlrev_b32 v68, 16, v94
    v_and_b32 v69, s70, v94
    v_lshlrev_b32 v70, 16, v95
    v_and_b32 v71, s70, v95
    v_mul_f32 v64, v64, v120
    v_mul_f32 v65, v65, v121
    v_mul_f32 v66, v66, v122
    v_mul_f32 v67, v67, v123
    v_mul_f32 v68, v68, v124
    v_mul_f32 v69, v69, v125
    v_mul_f32 v70, v70, v126
    v_mul_f32 v71, v71, v127
    v_cvt_pk_bf16_f32 v236, v64, v65
    v_cvt_pk_bf16_f32 v237, v66, v67
    v_cvt_pk_bf16_f32 v238, v68, v69
    v_cvt_pk_bf16_f32 v239, v70, v71
    buffer_store_dwordx4 v[236:239], v17, s[44:47], s63 offen sc1
    s_endpgm
L_comp:
    s_and_b32 s34, s28, 3
    s_lshl_b32 s34, s34, 2
    s_and_b32 vcc_lo, s29, 3
    s_add_u32 s34, s34, vcc_lo
    s_lshr_b32 s35, s28, 2
    s_lshl_b32 s35, s35, 3
    s_lshr_b32 vcc_lo, s29, 2
    s_add_u32 s35, s35, vcc_lo
    s_lshl_b32 s39, vcc_lo, 2
    s_and_b32 s36, s29, 15
    s_lshr_b32 s37, s29, 4
    s_lshl_b32 vcc_lo, s28, 1
    s_add_u32 s37, s37, vcc_lo
    s_lshl_b32 s38, s28, 5
    s_add_u32 s38, s38, s29
    s_lshl_b32 s38, s38, 2
    s_mul_i32 s39, s34, 11
    s_lshr_b32 s39, s39, 5
    s_mul_i32 s39, s39, 3
    s_sub_u32 s39, s34, s39
    s_lshl_b32 s45, s37, 18
    s_lshl_b32 s46, s3, 16
    s_add_u32 s45, s45, s46
    s_lshl_b32 s46, s36, 7
    s_add_u32 s45, s45, s46
    v_lshrrev_b32 v2, 4, v4
    v_and_b32 v1, 15, v4
    v_lshlrev_b32 v3, 3, v1
    v_lshl_add_u32 v16, v2, 14, v3
    v_add_u32 v16, s45, v16
    v_subrev_u32 v17, 6144, v16
    s_movk_i32 s57, 4096
    s_movk_i32 s58, 8192
    s_movk_i32 s59, 12288
    s_mov_b32 s62, 0x400000
    s_mov_b32 s63, 0x20000
    s_mov_b32 s66, 0x400000
    s_mov_b32 s67, 0x20000
    s_mov_b32 s70, 8192
    s_mov_b32 s71, 0x20000
    v_lshlrev_b32 v18, 5, v1
    s_lshl_b32 s46, s36, 9
    v_add_u32 v18, s46, v18
    v_sub_u32 v3, 3, v2
    s_lshl_b32 s45, s3, 2
    s_sub_u32 s45, 12, s45
    v_add_u32 v3, s45, v3
    v_and_b32 v6, 7, v4
    v_xor_b32 v3, v3, v6
    v_lshlrev_b32 v3, 4, v3
    v_lshl_add_u32 v3, v1, 10, v3
    v_add_u32 v19, 139776, v3
    s_and_b32 s40, s3, 1
    s_lshr_b32 s41, s3, 1
    v_bfe_u32 v3, v4, 1, 3
    v_xor_b32 v3, v2, v3
    v_lshlrev_b32 v3, 4, v3
    v_lshl_add_u32 v3, v1, 7, v3
    s_lshl_b32 s45, s40, 13
    v_add_u32 v8, s45, v3
    v_xor_b32 v9, 64, v8
    v_bfe_u32 v22, v4, 2, 2
    v_lshl_add_u32 v3, v2, 3, v22
    v_lshlrev_b32 v3, 7, v3
    v_and_b32 v7, 3, v4
    v_lshlrev_b32 v6, 3, v7
    s_lshl_b32 s45, s41, 6
    v_add_u32 v6, s45, v6
    v_bfe_u32 v7, v4, 3, 1
    v_lshlrev_b32 v7, 6, v7
    v_xor_b32 v6, v6, v7
    v_bfe_u32 v23, v4, 4, 1
    v_lshlrev_b32 v7, 5, v23
    v_xor_b32 v6, v6, v7
    v_add_u32 v3, v3, v6
    v_add_u32 v12, 0x4000, v3
    v_xor_b32 v13, 32, v12
    v_mov_b32 v14, v12
    v_mov_b32 v15, v13
    v_mov_b32 v10, v8
    v_mov_b32 v11, v9
    v_lshlrev_b32 v254, 7, v4
    v_mov_b32 v20, 162816
    v_mov_b32 v232, 1
    v_mov_b32 v233, 0
    v_lshlrev_b32 v6, 2, v4
    v_add_u32 v6, 162816, v6
    ds_write_b32 v6, v233
    s_lshl_b32 s45, s3, 2
    v_add_u32 v21, s45, v20
    s_mov_b32 s53, 0
    s_mov_b32 s56, 0xffff0000
    s_waitcnt lgkmcnt(0)
    s_nop 0
    s_mov_b64 s[60:61], s[12:13]
    s_mov_b64 s[64:65], s[14:15]
    s_mov_b64 s[68:69], s[16:17]
    s_barrier
    buffer_load_dwordx2 v[200:201], v17, s[60:63], 0 offen offset:0
    buffer_load_dwordx2 v[202:203], v17, s[60:63], 0 offen offset:2048
    buffer_load_dwordx2 v[204:205], v17, s[60:63], s57 offen offset:0
    buffer_load_dwordx2 v[206:207], v16, s[60:63], 0 offen offset:0
    buffer_load_dwordx2 v[208:209], v16, s[60:63], 0 offen offset:2048
    buffer_load_dwordx2 v[210:211], v16, s[60:63], s57 offen offset:0
    buffer_load_dwordx2 v[212:213], v16, s[60:63], s57 offen offset:2048
    buffer_load_dwordx2 v[214:215], v16, s[60:63], s58 offen offset:0
    buffer_load_dwordx2 v[216:217], v16, s[60:63], s58 offen offset:2048
    buffer_load_dwordx2 v[218:219], v16, s[60:63], s59 offen offset:0
    buffer_load_dwordx2 v[220:221], v16, s[60:63], s59 offen offset:2048
    buffer_load_dwordx4 v[242:245], v18, s[68:71], 0 offen offset:0
    buffer_load_dwordx4 v[246:249], v18, s[68:71], 0 offen offset:16
    buffer_load_dwordx2 v[222:223], v16, s[64:67], 0 offen offset:0
    buffer_load_dwordx2 v[224:225], v16, s[64:67], 0 offen offset:2048
    buffer_load_dwordx2 v[226:227], v16, s[64:67], s57 offen offset:0
    buffer_load_dwordx2 v[228:229], v16, s[64:67], s57 offen offset:2048
    buffer_load_dwordx2 v[230:231], v16, s[64:67], s58 offen offset:0
    buffer_load_dwordx2 v[236:237], v16, s[64:67], s58 offen offset:2048
    buffer_load_dwordx2 v[238:239], v16, s[64:67], s59 offen offset:0
    buffer_load_dwordx2 v[240:241], v16, s[64:67], s59 offen offset:2048
    s_barrier
    ds_read_b128 v[24:27], v10 offset:0
    ds_read_b128 v[28:31], v11 offset:0
    ds_read_b64_tr_b16 v[56:57], v14 offset:8192
    ds_read_b64_tr_b16 v[58:59], v14 offset:8704
    ds_read_b64_tr_b16 v[60:61], v14 offset:12288
    ds_read_b64_tr_b16 v[62:63], v14 offset:12800
    ds_read_b128 v[32:35], v10 offset:2048
    ds_read_b128 v[36:39], v11 offset:2048
    ds_read_b128 v[40:43], v10 offset:4096
    ds_read_b128 v[44:47], v11 offset:4096
    ds_read_b128 v[48:51], v10 offset:6144
    ds_read_b128 v[52:55], v11 offset:6144
    ds_read_b64_tr_b16 v[64:65], v15 offset:8192
    ds_read_b64_tr_b16 v[66:67], v15 offset:8704
    ds_read_b64_tr_b16 v[68:69], v15 offset:12288
    ds_read_b64_tr_b16 v[70:71], v15 offset:12800
    s_mov_b32 s52, 0
    s_waitcnt lgkmcnt(10)
    v_mfma_f32_16x16x32_bf16 v[136:139], v[24:27], v[56:59], 0
    v_mfma_f32_16x16x32_bf16 v[136:139], v[28:31], v[60:63], v[136:139]
    ds_read_b64_tr_b16 v[72:73], v14 offset:16384
    ds_read_b64_tr_b16 v[74:75], v14 offset:16896
    ds_read_b64_tr_b16 v[76:77], v14 offset:20480
    ds_read_b64_tr_b16 v[78:79], v14 offset:20992
    s_waitcnt lgkmcnt(8)
    v_mfma_f32_16x16x32_bf16 v[140:143], v[32:35], v[56:59], 0
    ds_read_b64_tr_b16 v[80:81], v15 offset:16384
    v_mfma_f32_16x16x32_bf16 v[140:143], v[36:39], v[60:63], v[140:143]
    ds_read_b64_tr_b16 v[82:83], v15 offset:16896
    v_mfma_f32_16x16x32_bf16 v[144:147], v[40:43], v[56:59], 0
    ds_read_b64_tr_b16 v[84:85], v15 offset:20480
    v_mfma_f32_16x16x32_bf16 v[144:147], v[44:47], v[60:63], v[144:147]
    ds_read_b64_tr_b16 v[86:87], v15 offset:20992
    v_mfma_f32_16x16x32_bf16 v[148:151], v[48:51], v[56:59], 0
    ds_read_b64_tr_b16 v[88:89], v14 offset:0
    v_mfma_f32_16x16x32_bf16 v[148:151], v[52:55], v[60:63], v[148:151]
    ds_read_b64_tr_b16 v[90:91], v14 offset:512
    s_waitcnt lgkmcnt(10)
    v_mfma_f32_16x16x32_bf16 v[152:155], v[24:27], v[64:67], 0
    ds_read_b64_tr_b16 v[92:93], v14 offset:4096
    v_mfma_f32_16x16x32_bf16 v[152:155], v[28:31], v[68:71], v[152:155]
    ds_read_b64_tr_b16 v[94:95], v14 offset:4608
    v_mfma_f32_16x16x32_bf16 v[156:159], v[32:35], v[64:67], 0
    ds_read_b64_tr_b16 v[96:97], v15 offset:0
    v_mfma_f32_16x16x32_bf16 v[156:159], v[36:39], v[68:71], v[156:159]
    ds_read_b64_tr_b16 v[98:99], v15 offset:512
    v_mfma_f32_16x16x32_bf16 v[160:163], v[40:43], v[64:67], 0
    ds_read_b64_tr_b16 v[100:101], v15 offset:4096
    v_mfma_f32_16x16x32_bf16 v[160:163], v[44:47], v[68:71], v[160:163]
    ds_read_b64_tr_b16 v[102:103], v15 offset:4608
    v_mfma_f32_16x16x32_bf16 v[164:167], v[48:51], v[64:67], 0
    v_mfma_f32_16x16x32_bf16 v[164:167], v[52:55], v[68:71], v[164:167]
    s_waitcnt lgkmcnt(0)
    v_mfma_f32_16x16x32_bf16 v[168:171], v[24:27], v[72:75], 0
    s_add_u32 s52, s52, 40960
    s_cmp_eq_u32 s52, 122880
    v_mfma_f32_16x16x32_bf16 v[168:171], v[28:31], v[76:79], v[168:171]
    s_cselect_b32 s52, 0, s52
    v_add_u32 v10, s52, v8
    v_mfma_f32_16x16x32_bf16 v[172:175], v[32:35], v[72:75], 0
    v_add_u32 v11, s52, v9
    v_add_u32 v14, s52, v12
    v_mfma_f32_16x16x32_bf16 v[172:175], v[36:39], v[76:79], v[172:175]
    v_add_u32 v15, s52, v13
    s_mov_b32 s60, s26
    v_mfma_f32_16x16x32_bf16 v[176:179], v[40:43], v[72:75], 0
    s_mov_b32 s61, s27
    s_mov_b32 s62, 0x2000000
    v_mfma_f32_16x16x32_bf16 v[176:179], v[44:47], v[76:79], v[176:179]
    s_mov_b32 s63, 0x20000
    s_mov_b32 s68, s22
    v_mfma_f32_16x16x32_bf16 v[180:183], v[48:51], v[72:75], 0
    s_mov_b32 s69, s23
    s_mov_b32 s70, 0x800000
    v_mfma_f32_16x16x32_bf16 v[180:183], v[52:55], v[76:79], v[180:183]
    s_mov_b32 s71, 0x20000
    v_lshlrev_b32 v3, 12, v2
    v_mfma_f32_16x16x32_bf16 v[184:187], v[24:27], v[80:83], 0
    v_lshl_add_u32 v16, v1, 4, v3
    s_lshl_b32 s45, s36, 18
    v_mfma_f32_16x16x32_bf16 v[184:187], v[28:31], v[84:87], v[184:187]
    s_lshl_b32 s46, s3, 16
    s_add_u32 s45, s45, s46
    v_mfma_f32_16x16x32_bf16 v[188:191], v[32:35], v[80:83], 0
    s_lshl_b32 s46, s37, 8
    s_sub_u32 s45, s45, s46
    v_mfma_f32_16x16x32_bf16 v[188:191], v[36:39], v[84:87], v[188:191]
    s_add_u32 s45, s45, 3840
    v_add_u32 v16, s45, v16
    v_mfma_f32_16x16x32_bf16 v[192:195], v[40:43], v[80:83], 0
    s_lshl_b32 s45, s3, 12
    s_add_u32 s45, s45, 139776
    v_mfma_f32_16x16x32_bf16 v[192:195], v[44:47], v[84:87], v[192:195]
    v_add_u32 v1, s45, v5
    s_lshl_b32 s45, s40, 6
    v_mfma_f32_16x16x32_bf16 v[196:199], v[48:51], v[80:83], 0
    v_xor_b32 v1, s45, v1
    v_xor_b32 v2, 16, v1
    v_mfma_f32_16x16x32_bf16 v[196:199], v[52:55], v[84:87], v[196:199]
    v_xor_b32 v3, 32, v1
    v_xor_b32 v6, 48, v1
    v_mfma_f32_16x16x32_bf16 v[104:107], v[88:91], v[24:27], 0
    s_movk_i32 s57, 0x4000
    s_mov_b32 s58, 0x8000
    v_mfma_f32_16x16x32_bf16 v[104:107], v[92:95], v[28:31], v[104:107]
    s_mov_b32 s59, 0xc000
    s_lshl_b32 s43, s36, 2
    v_mfma_f32_16x16x32_bf16 v[112:115], v[88:91], v[32:35], 0
    s_add_u32 s43, s43, s3
    s_lshl_b32 s43, s43, 4
    v_mfma_f32_16x16x32_bf16 v[112:115], v[92:95], v[36:39], v[112:115]
    s_add_u32 s43, s43, s37
    s_lshl_b32 s43, s43, 2
    v_mfma_f32_16x16x32_bf16 v[120:123], v[88:91], v[40:43], 0
    s_lshr_b32 vcc_lo, s43, 6
    s_mul_i32 vcc_lo, vcc_lo, 1984
    v_mfma_f32_16x16x32_bf16 v[120:123], v[92:95], v[44:47], v[120:123]
    s_add_u32 s43, s43, vcc_lo
    s_add_u32 s43, s43, 0x940000
    v_mfma_f32_16x16x32_bf16 v[128:131], v[88:91], v[48:51], 0
    s_movk_i32 s42, 5
    v_mfma_f32_16x16x32_bf16 v[128:131], v[92:95], v[52:55], v[128:131]
    v_mfma_f32_16x16x32_bf16 v[108:111], v[96:99], v[24:27], 0
    v_mfma_f32_16x16x32_bf16 v[108:111], v[100:103], v[28:31], v[108:111]
    v_mfma_f32_16x16x32_bf16 v[116:119], v[96:99], v[32:35], 0
    v_mfma_f32_16x16x32_bf16 v[116:119], v[100:103], v[36:39], v[116:119]
    v_mfma_f32_16x16x32_bf16 v[124:127], v[96:99], v[40:43], 0
    v_mfma_f32_16x16x32_bf16 v[124:127], v[100:103], v[44:47], v[124:127]
    v_mfma_f32_16x16x32_bf16 v[132:135], v[96:99], v[48:51], 0
    v_mfma_f32_16x16x32_bf16 v[132:135], v[100:103], v[52:55], v[132:135]
    s_waitcnt vmcnt(10)
    v_lshlrev_b32 v24, 16, v200
    v_and_b32 v25, s56, v200
    v_lshlrev_b32 v26, 16, v201
    v_and_b32 v27, s56, v201
    v_lshlrev_b32 v28, 16, v202
    v_and_b32 v29, s56, v202
    v_lshlrev_b32 v30, 16, v203
    v_and_b32 v31, s56, v203
    v_lshlrev_b32 v32, 16, v204
    v_and_b32 v33, s56, v204
    v_lshlrev_b32 v34, 16, v205
    v_and_b32 v35, s56, v205
    v_lshlrev_b32 v36, 16, v206
    v_and_b32 v37, s56, v206
    v_lshlrev_b32 v38, 16, v207
    v_and_b32 v39, s56, v207
    v_lshlrev_b32 v40, 16, v208
    v_and_b32 v41, s56, v208
    v_lshlrev_b32 v42, 16, v209
    v_and_b32 v43, s56, v209
    v_lshlrev_b32 v44, 16, v210
    v_and_b32 v45, s56, v210
    v_lshlrev_b32 v46, 16, v211
    v_and_b32 v47, s56, v211
    v_lshlrev_b32 v48, 16, v212
    v_and_b32 v49, s56, v212
    v_lshlrev_b32 v50, 16, v213
    v_and_b32 v51, s56, v213
    v_lshlrev_b32 v52, 16, v214
    v_and_b32 v53, s56, v214
    v_lshlrev_b32 v54, 16, v215
    v_and_b32 v55, s56, v215
    v_lshlrev_b32 v56, 16, v216
    v_and_b32 v57, s56, v216
    v_lshlrev_b32 v58, 16, v217
    v_and_b32 v59, s56, v217
    v_lshlrev_b32 v60, 16, v218
    v_and_b32 v61, s56, v218
    v_lshlrev_b32 v62, 16, v219
    v_and_b32 v63, s56, v219
    v_lshlrev_b32 v64, 16, v220
    v_and_b32 v65, s56, v220
    v_lshlrev_b32 v66, 16, v221
    v_and_b32 v67, s56, v221
    s_waitcnt vmcnt(8)
    v_lshlrev_b32 v68, 16, v242
    v_and_b32 v72, s56, v242
    v_lshlrev_b32 v76, 16, v243
    v_and_b32 v80, s56, v243
    v_lshlrev_b32 v69, 16, v244
    v_and_b32 v73, s56, v244
    v_lshlrev_b32 v77, 16, v245
    v_and_b32 v81, s56, v245
    v_lshlrev_b32 v70, 16, v246
    v_and_b32 v74, s56, v246
    v_lshlrev_b32 v78, 16, v247
    v_and_b32 v82, s56, v247
    v_lshlrev_b32 v71, 16, v248
    v_and_b32 v75, s56, v248
    v_lshlrev_b32 v79, 16, v249
    v_and_b32 v83, s56, v249
    v_pk_mul_f32 v[84:85], v[36:37], v[68:69]
    v_pk_mul_f32 v[86:87], v[38:39], v[70:71]
    v_pk_mul_f32 v[88:89], v[40:41], v[68:69]
    v_pk_mul_f32 v[90:91], v[42:43], v[70:71]
    v_pk_fma_f32 v[84:85], v[32:33], v[72:73], v[84:85]
    v_pk_fma_f32 v[86:87], v[34:35], v[74:75], v[86:87]
    v_pk_fma_f32 v[88:89], v[36:37], v[72:73], v[88:89]
    v_pk_fma_f32 v[90:91], v[38:39], v[74:75], v[90:91]
    v_pk_fma_f32 v[84:85], v[28:29], v[76:77], v[84:85]
    v_pk_fma_f32 v[86:87], v[30:31], v[78:79], v[86:87]
    v_pk_fma_f32 v[88:89], v[32:33], v[76:77], v[88:89]
    v_pk_fma_f32 v[90:91], v[34:35], v[78:79], v[90:91]
    v_pk_fma_f32 v[24:25], v[24:25], v[80:81], v[84:85]
    v_pk_fma_f32 v[26:27], v[26:27], v[82:83], v[86:87]
    v_pk_fma_f32 v[28:29], v[28:29], v[80:81], v[88:89]
    v_pk_fma_f32 v[30:31], v[30:31], v[82:83], v[90:91]
    v_pk_mul_f32 v[84:85], v[44:45], v[68:69]
    v_pk_mul_f32 v[86:87], v[46:47], v[70:71]
    v_pk_mul_f32 v[88:89], v[48:49], v[68:69]
    v_pk_mul_f32 v[90:91], v[50:51], v[70:71]
    v_pk_fma_f32 v[84:85], v[40:41], v[72:73], v[84:85]
    v_pk_fma_f32 v[86:87], v[42:43], v[74:75], v[86:87]
    v_pk_fma_f32 v[88:89], v[44:45], v[72:73], v[88:89]
    v_pk_fma_f32 v[90:91], v[46:47], v[74:75], v[90:91]
    v_pk_fma_f32 v[84:85], v[36:37], v[76:77], v[84:85]
    v_pk_fma_f32 v[86:87], v[38:39], v[78:79], v[86:87]
    v_pk_fma_f32 v[88:89], v[40:41], v[76:77], v[88:89]
    v_pk_fma_f32 v[90:91], v[42:43], v[78:79], v[90:91]
    v_pk_fma_f32 v[32:33], v[32:33], v[80:81], v[84:85]
    v_pk_fma_f32 v[34:35], v[34:35], v[82:83], v[86:87]
    v_pk_fma_f32 v[36:37], v[36:37], v[80:81], v[88:89]
    v_pk_fma_f32 v[38:39], v[38:39], v[82:83], v[90:91]
    v_pk_mul_f32 v[84:85], v[52:53], v[68:69]
    v_pk_mul_f32 v[86:87], v[54:55], v[70:71]
    v_pk_mul_f32 v[88:89], v[56:57], v[68:69]
    v_pk_mul_f32 v[90:91], v[58:59], v[70:71]
    v_pk_fma_f32 v[84:85], v[48:49], v[72:73], v[84:85]
    v_pk_fma_f32 v[86:87], v[50:51], v[74:75], v[86:87]
    v_pk_fma_f32 v[88:89], v[52:53], v[72:73], v[88:89]
    v_pk_fma_f32 v[90:91], v[54:55], v[74:75], v[90:91]
    v_pk_fma_f32 v[84:85], v[44:45], v[76:77], v[84:85]
    v_pk_fma_f32 v[86:87], v[46:47], v[78:79], v[86:87]
    v_pk_fma_f32 v[88:89], v[48:49], v[76:77], v[88:89]
    v_pk_fma_f32 v[90:91], v[50:51], v[78:79], v[90:91]
    v_pk_fma_f32 v[40:41], v[40:41], v[80:81], v[84:85]
    v_pk_fma_f32 v[42:43], v[42:43], v[82:83], v[86:87]
    v_pk_fma_f32 v[44:45], v[44:45], v[80:81], v[88:89]
    v_pk_fma_f32 v[46:47], v[46:47], v[82:83], v[90:91]
    v_pk_mul_f32 v[84:85], v[60:61], v[68:69]
    v_pk_mul_f32 v[86:87], v[62:63], v[70:71]
    v_pk_mul_f32 v[88:89], v[64:65], v[68:69]
    v_pk_mul_f32 v[90:91], v[66:67], v[70:71]
    v_pk_fma_f32 v[84:85], v[56:57], v[72:73], v[84:85]
    v_pk_fma_f32 v[86:87], v[58:59], v[74:75], v[86:87]
    v_pk_fma_f32 v[88:89], v[60:61], v[72:73], v[88:89]
    v_pk_fma_f32 v[90:91], v[62:63], v[74:75], v[90:91]
    v_pk_fma_f32 v[84:85], v[52:53], v[76:77], v[84:85]
    v_pk_fma_f32 v[86:87], v[54:55], v[78:79], v[86:87]
    v_pk_fma_f32 v[88:89], v[56:57], v[76:77], v[88:89]
    v_pk_fma_f32 v[90:91], v[58:59], v[78:79], v[90:91]
    v_pk_fma_f32 v[48:49], v[48:49], v[80:81], v[84:85]
    v_pk_fma_f32 v[50:51], v[50:51], v[82:83], v[86:87]
    v_pk_fma_f32 v[52:53], v[52:53], v[80:81], v[88:89]
    v_pk_fma_f32 v[54:55], v[54:55], v[82:83], v[90:91]
    s_waitcnt vmcnt(0)
    v_lshlrev_b32 v56, 16, v222
    v_and_b32 v57, s56, v222
    v_lshlrev_b32 v58, 16, v223
    v_and_b32 v59, s56, v223
    v_lshlrev_b32 v60, 16, v224
    v_and_b32 v61, s56, v224
    v_lshlrev_b32 v62, 16, v225
    v_and_b32 v63, s56, v225
    v_lshlrev_b32 v64, 16, v226
    v_and_b32 v65, s56, v226
    v_lshlrev_b32 v66, 16, v227
    v_and_b32 v67, s56, v227
    v_lshlrev_b32 v68, 16, v228
    v_and_b32 v69, s56, v228
    v_lshlrev_b32 v70, 16, v229
    v_and_b32 v71, s56, v229
    v_lshlrev_b32 v72, 16, v230
    v_and_b32 v73, s56, v230
    v_lshlrev_b32 v74, 16, v231
    v_and_b32 v75, s56, v231
    v_lshlrev_b32 v76, 16, v236
    v_and_b32 v77, s56, v236
    v_lshlrev_b32 v78, 16, v237
    v_and_b32 v79, s56, v237
    v_lshlrev_b32 v80, 16, v238
    v_and_b32 v81, s56, v238
    v_lshlrev_b32 v82, 16, v239
    v_and_b32 v83, s56, v239
    v_lshlrev_b32 v84, 16, v240
    v_and_b32 v85, s56, v240
    v_lshlrev_b32 v86, 16, v241
    v_and_b32 v87, s56, v241
    v_pk_mul_f32 v[24:25], v[24:25], v[56:57]
    v_pk_mul_f32 v[28:29], v[28:29], v[60:61]
    v_pk_mul_f32 v[32:33], v[32:33], v[64:65]
    v_pk_mul_f32 v[36:37], v[36:37], v[68:69]
    v_pk_mul_f32 v[40:41], v[40:41], v[72:73]
    v_pk_mul_f32 v[44:45], v[44:45], v[76:77]
    v_pk_mul_f32 v[48:49], v[48:49], v[80:81]
    v_pk_mul_f32 v[52:53], v[52:53], v[84:85]
    v_cvt_pk_bf16_f32 v200, v52, v48
    v_cvt_pk_bf16_f32 v201, v44, v40
    v_cvt_pk_bf16_f32 v202, v36, v32
    v_cvt_pk_bf16_f32 v203, v28, v24
    ds_write_b128 v19, v[200:203] offset:0
    v_cvt_pk_bf16_f32 v204, v53, v49
    v_cvt_pk_bf16_f32 v205, v45, v41
    v_cvt_pk_bf16_f32 v206, v37, v33
    v_cvt_pk_bf16_f32 v207, v29, v25
    ds_write_b128 v19, v[204:207] offset:256
    v_pk_mul_f32 v[26:27], v[26:27], v[58:59]
    v_pk_mul_f32 v[30:31], v[30:31], v[62:63]
    v_pk_mul_f32 v[34:35], v[34:35], v[66:67]
    v_pk_mul_f32 v[38:39], v[38:39], v[70:71]
    v_pk_mul_f32 v[42:43], v[42:43], v[74:75]
    v_pk_mul_f32 v[46:47], v[46:47], v[78:79]
    v_pk_mul_f32 v[50:51], v[50:51], v[82:83]
    v_pk_mul_f32 v[54:55], v[54:55], v[86:87]
    v_cvt_pk_bf16_f32 v208, v54, v50
    v_cvt_pk_bf16_f32 v209, v46, v42
    v_cvt_pk_bf16_f32 v210, v38, v34
    v_cvt_pk_bf16_f32 v211, v30, v26
    ds_write_b128 v19, v[208:211] offset:512
    v_cvt_pk_bf16_f32 v212, v55, v51
    v_cvt_pk_bf16_f32 v213, v47, v43
    v_cvt_pk_bf16_f32 v214, v39, v35
    v_cvt_pk_bf16_f32 v215, v31, v27
    ds_write_b128 v19, v[212:215] offset:768
    s_waitcnt lgkmcnt(0)
    s_barrier
    ds_read_b128 v[24:27], v10 offset:0
    ds_read_b128 v[28:31], v11 offset:0
    ds_read_b64_tr_b16 v[56:57], v14 offset:8192
    ds_read_b64_tr_b16 v[58:59], v14 offset:8704
    ds_read_b64_tr_b16 v[60:61], v14 offset:12288
    ds_read_b64_tr_b16 v[62:63], v14 offset:12800
    ds_read_b128 v[32:35], v10 offset:2048
    ds_read_b128 v[36:39], v11 offset:2048
    ds_read_b128 v[40:43], v10 offset:4096
    ds_read_b128 v[44:47], v11 offset:4096
    ds_read_b128 v[48:51], v10 offset:6144
    ds_read_b128 v[52:55], v11 offset:6144
    s_waitcnt lgkmcnt(6)
    ds_read_b64_tr_b16 v[64:65], v15 offset:8192
    ds_read_b64_tr_b16 v[66:67], v15 offset:8704
    ds_read_b64_tr_b16 v[68:69], v15 offset:12288
    ds_read_b64_tr_b16 v[70:71], v15 offset:12800
    ds_read_b64_tr_b16 v[72:73], v14 offset:16384
    ds_read_b64_tr_b16 v[74:75], v14 offset:16896
    ds_read_b64_tr_b16 v[76:77], v14 offset:20480
    ds_read_b64_tr_b16 v[78:79], v14 offset:20992
    s_waitcnt lgkmcnt(8)
    ds_read_b64_tr_b16 v[80:81], v15 offset:16384
    ds_read_b64_tr_b16 v[82:83], v15 offset:16896
    ds_read_b64_tr_b16 v[84:85], v15 offset:20480
    ds_read_b64_tr_b16 v[86:87], v15 offset:20992
    ds_read_b64_tr_b16 v[88:89], v14 offset:0
    ds_read_b64_tr_b16 v[90:91], v14 offset:512
    ds_read_b64_tr_b16 v[92:93], v14 offset:4096
    ds_read_b64_tr_b16 v[94:95], v14 offset:4608
    s_waitcnt lgkmcnt(8)
    ds_read_b128 v[236:239], v1 offset:0
    ds_read_b128 v[240:243], v2 offset:1024
    ds_read_b128 v[244:247], v3 offset:2048
    ds_read_b128 v[248:251], v6 offset:3072
    s_branch L_loop1
L_side:
    s_cmp_eq_u32 s53, 0
    s_cbranch_scc0 L_side2
    buffer_store_dwordx4 v[236:239], v16, s[60:63], 0 offen sc1
    buffer_store_dwordx4 v[240:243], v16, s[60:63], s57 offen sc1
    buffer_store_dwordx4 v[244:247], v16, s[60:63], s58 offen sc1
    buffer_store_dwordx4 v[248:251], v16, s[60:63], s59 offen sc1
    s_branch L_back
L_side2:
    v_readfirstlane_b32 s72, v234
    s_mov_b32 s45, 0
    s_waitcnt vmcnt(0)
    s_cmp_lg_u32 s72, 0
    s_cbranch_scc1 L_cepok
L_cep:
    ds_read_b32 v234, v20 offset:56
    s_add_u32 s45, s45, 1
    s_waitcnt lgkmcnt(0)
    v_readfirstlane_b32 s72, v234
    s_cmp_gt_u32 s45, 0x40000
    s_cbranch_scc1 L_cepok
    s_cmp_eq_u32 s72, 0
    s_cbranch_scc1 L_cep
L_cepok:
    s_mov_b32 s73, s72
    s_mov_b64 exec, 0xffff
    buffer_store_dword v234, v254, s[60:63], s43 offen sc1
    s_mov_b64 exec, -1
    s_branch L_back

L_loop1:
    v_mfma_f32_16x16x32_bf16 v[136:139], v[24:27], v[56:59], v[136:139]
    ds_read_b64_tr_b16 v[96:97], v15 offset:0
    v_mfma_f32_16x16x32_bf16 v[136:139], v[28:31], v[60:63], v[136:139]
    ds_read_b64_tr_b16 v[98:99], v15 offset:512
    v_mfma_f32_16x16x32_bf16 v[140:143], v[32:35], v[56:59], v[140:143]
    ds_read_b64_tr_b16 v[100:101], v15 offset:4096
    v_mfma_f32_16x16x32_bf16 v[140:143], v[36:39], v[60:63], v[140:143]
    ds_read_b64_tr_b16 v[102:103], v15 offset:4608
    v_mfma_f32_16x16x32_bf16 v[144:147], v[40:43], v[56:59], v[144:147]
    s_add_u32 s52, s52, 40960
    s_cmp_eq_u32 s52, 122880
    s_cselect_b32 s52, 0, s52
    v_mfma_f32_16x16x32_bf16 v[144:147], v[44:47], v[60:63], v[144:147]
    v_add_u32 v10, s52, v8
    v_add_u32 v11, s52, v9
    v_mfma_f32_16x16x32_bf16 v[148:151], v[48:51], v[56:59], v[148:151]
    v_add_u32 v14, s52, v12
    v_add_u32 v15, s52, v13
    v_mfma_f32_16x16x32_bf16 v[148:151], v[52:55], v[60:63], v[148:151]
    s_waitcnt lgkmcnt(0)
    v_mfma_f32_16x16x32_bf16 v[152:155], v[24:27], v[64:67], v[152:155]
    s_barrier
    v_mfma_f32_16x16x32_bf16 v[152:155], v[28:31], v[68:71], v[152:155]
    ds_read_b64_tr_b16 v[56:57], v14 offset:8192
    v_mfma_f32_16x16x32_bf16 v[156:159], v[32:35], v[64:67], v[156:159]
    ds_read_b64_tr_b16 v[58:59], v14 offset:8704
    v_mfma_f32_16x16x32_bf16 v[156:159], v[36:39], v[68:71], v[156:159]
    ds_read_b64_tr_b16 v[60:61], v14 offset:12288
    v_mfma_f32_16x16x32_bf16 v[160:163], v[40:43], v[64:67], v[160:163]
    ds_read_b64_tr_b16 v[62:63], v14 offset:12800
    v_mfma_f32_16x16x32_bf16 v[160:163], v[44:47], v[68:71], v[160:163]
    ds_read_b128 v[200:203], v10 offset:0
    v_mfma_f32_16x16x32_bf16 v[164:167], v[48:51], v[64:67], v[164:167]
    ds_read_b128 v[204:207], v11 offset:0
    v_mfma_f32_16x16x32_bf16 v[164:167], v[52:55], v[68:71], v[164:167]
    ds_read_b128 v[208:211], v10 offset:2048
    v_mfma_f32_16x16x32_bf16 v[168:171], v[24:27], v[72:75], v[168:171]
    ds_read_b64_tr_b16 v[64:65], v15 offset:8192
    v_mfma_f32_16x16x32_bf16 v[168:171], v[28:31], v[76:79], v[168:171]
    ds_read_b64_tr_b16 v[66:67], v15 offset:8704
    v_mfma_f32_16x16x32_bf16 v[172:175], v[32:35], v[72:75], v[172:175]
    ds_read_b64_tr_b16 v[68:69], v15 offset:12288
    v_mfma_f32_16x16x32_bf16 v[172:175], v[36:39], v[76:79], v[172:175]
    ds_read_b64_tr_b16 v[70:71], v15 offset:12800
    v_mfma_f32_16x16x32_bf16 v[176:179], v[40:43], v[72:75], v[176:179]
    ds_read_b128 v[212:215], v11 offset:2048
    v_mfma_f32_16x16x32_bf16 v[176:179], v[44:47], v[76:79], v[176:179]
    ds_read_b128 v[216:219], v10 offset:4096
    v_mfma_f32_16x16x32_bf16 v[180:183], v[48:51], v[72:75], v[180:183]
    ds_read_b128 v[220:223], v11 offset:4096
    v_mfma_f32_16x16x32_bf16 v[180:183], v[52:55], v[76:79], v[180:183]
    ds_read_b128 v[224:227], v10 offset:6144
    v_mfma_f32_16x16x32_bf16 v[184:187], v[24:27], v[80:83], v[184:187]
    ds_read_b64_tr_b16 v[72:73], v14 offset:16384
    v_mfma_f32_16x16x32_bf16 v[184:187], v[28:31], v[84:87], v[184:187]
    ds_read_b64_tr_b16 v[74:75], v14 offset:16896
    v_mfma_f32_16x16x32_bf16 v[188:191], v[32:35], v[80:83], v[188:191]
    ds_read_b64_tr_b16 v[76:77], v14 offset:20480
    v_mfma_f32_16x16x32_bf16 v[188:191], v[36:39], v[84:87], v[188:191]
    ds_read_b64_tr_b16 v[78:79], v14 offset:20992
    v_mfma_f32_16x16x32_bf16 v[192:195], v[40:43], v[80:83], v[192:195]
    ds_read_b128 v[228:231], v11 offset:6144
    v_mfma_f32_16x16x32_bf16 v[192:195], v[44:47], v[84:87], v[192:195]
    s_bitcmp1_b32 s42, s53
    v_mfma_f32_16x16x32_bf16 v[196:199], v[48:51], v[80:83], v[196:199]
    s_cbranch_scc1 L_side
L_back:
    v_mfma_f32_16x16x32_bf16 v[196:199], v[52:55], v[84:87], v[196:199]
    v_mfma_f32_16x16x32_bf16 v[104:107], v[88:91], v[24:27], v[104:107]
    ds_read_b64_tr_b16 v[80:81], v15 offset:16384
    v_mfma_f32_16x16x32_bf16 v[104:107], v[92:95], v[28:31], v[104:107]
    ds_read_b64_tr_b16 v[82:83], v15 offset:16896
    v_mfma_f32_16x16x32_bf16 v[112:115], v[88:91], v[32:35], v[112:115]
    ds_read_b64_tr_b16 v[84:85], v15 offset:20480
    v_mfma_f32_16x16x32_bf16 v[112:115], v[92:95], v[36:39], v[112:115]
    ds_read_b64_tr_b16 v[86:87], v15 offset:20992
    v_mfma_f32_16x16x32_bf16 v[120:123], v[88:91], v[40:43], v[120:123]
    ds_read_b32 v234, v20 offset:56
    v_mfma_f32_16x16x32_bf16 v[120:123], v[92:95], v[44:47], v[120:123]
    v_mfma_f32_16x16x32_bf16 v[128:131], v[88:91], v[48:51], v[128:131]
    v_mfma_f32_16x16x32_bf16 v[128:131], v[92:95], v[52:55], v[128:131]
    v_mfma_f32_16x16x32_bf16 v[108:111], v[96:99], v[24:27], v[108:111]
    s_waitcnt lgkmcnt(4)
    ds_read_b64_tr_b16 v[88:89], v14 offset:0
    v_mfma_f32_16x16x32_bf16 v[108:111], v[100:103], v[28:31], v[108:111]
    ds_read_b64_tr_b16 v[90:91], v14 offset:512
    v_mfma_f32_16x16x32_bf16 v[116:119], v[96:99], v[32:35], v[116:119]
    ds_read_b64_tr_b16 v[92:93], v14 offset:4096
    v_mfma_f32_16x16x32_bf16 v[116:119], v[100:103], v[36:39], v[116:119]
    ds_read_b64_tr_b16 v[94:95], v14 offset:4608
    v_mfma_f32_16x16x32_bf16 v[124:127], v[96:99], v[40:43], v[124:127]
    v_mfma_f32_16x16x32_bf16 v[124:127], v[100:103], v[44:47], v[124:127]
    v_mfma_f32_16x16x32_bf16 v[132:135], v[96:99], v[48:51], v[132:135]
    v_mfma_f32_16x16x32_bf16 v[132:135], v[100:103], v[52:55], v[132:135]
    v_mfma_f32_16x16x32_bf16 v[136:139], v[200:203], v[56:59], v[136:139]
    ds_read_b64_tr_b16 v[96:97], v15 offset:0
    v_mfma_f32_16x16x32_bf16 v[136:139], v[204:207], v[60:63], v[136:139]
    ds_read_b64_tr_b16 v[98:99], v15 offset:512
    v_mfma_f32_16x16x32_bf16 v[140:143], v[208:211], v[56:59], v[140:143]
    ds_read_b64_tr_b16 v[100:101], v15 offset:4096
    v_mfma_f32_16x16x32_bf16 v[140:143], v[212:215], v[60:63], v[140:143]
    ds_read_b64_tr_b16 v[102:103], v15 offset:4608
    v_mfma_f32_16x16x32_bf16 v[144:147], v[216:219], v[56:59], v[144:147]
    s_add_u32 s52, s52, 40960
    s_cmp_eq_u32 s52, 122880
    s_cselect_b32 s52, 0, s52
    v_mfma_f32_16x16x32_bf16 v[144:147], v[220:223], v[60:63], v[144:147]
    v_add_u32 v10, s52, v8
    v_add_u32 v11, s52, v9
    v_mfma_f32_16x16x32_bf16 v[148:151], v[224:227], v[56:59], v[148:151]
    v_add_u32 v14, s52, v12
    v_add_u32 v15, s52, v13
    v_mfma_f32_16x16x32_bf16 v[148:151], v[228:231], v[60:63], v[148:151]
    s_waitcnt lgkmcnt(0)
    v_mfma_f32_16x16x32_bf16 v[152:155], v[200:203], v[64:67], v[152:155]
    s_barrier
    v_mfma_f32_16x16x32_bf16 v[152:155], v[204:207], v[68:71], v[152:155]
    ds_read_b64_tr_b16 v[56:57], v14 offset:8192
    v_mfma_f32_16x16x32_bf16 v[156:159], v[208:211], v[64:67], v[156:159]
    ds_read_b64_tr_b16 v[58:59], v14 offset:8704
    v_mfma_f32_16x16x32_bf16 v[156:159], v[212:215], v[68:71], v[156:159]
    ds_read_b64_tr_b16 v[60:61], v14 offset:12288
    v_mfma_f32_16x16x32_bf16 v[160:163], v[216:219], v[64:67], v[160:163]
    ds_read_b64_tr_b16 v[62:63], v14 offset:12800
    v_mfma_f32_16x16x32_bf16 v[160:163], v[220:223], v[68:71], v[160:163]
    ds_read_b128 v[24:27], v10 offset:0
    v_mfma_f32_16x16x32_bf16 v[164:167], v[224:227], v[64:67], v[164:167]
    ds_read_b128 v[28:31], v11 offset:0
    v_mfma_f32_16x16x32_bf16 v[164:167], v[228:231], v[68:71], v[164:167]
    ds_read_b128 v[32:35], v10 offset:2048
    v_mfma_f32_16x16x32_bf16 v[168:171], v[200:203], v[72:75], v[168:171]
    ds_read_b64_tr_b16 v[64:65], v15 offset:8192
    v_mfma_f32_16x16x32_bf16 v[168:171], v[204:207], v[76:79], v[168:171]
    ds_read_b64_tr_b16 v[66:67], v15 offset:8704
    v_mfma_f32_16x16x32_bf16 v[172:175], v[208:211], v[72:75], v[172:175]
    ds_read_b64_tr_b16 v[68:69], v15 offset:12288
    v_mfma_f32_16x16x32_bf16 v[172:175], v[212:215], v[76:79], v[172:175]
    ds_read_b64_tr_b16 v[70:71], v15 offset:12800
    v_mfma_f32_16x16x32_bf16 v[176:179], v[216:219], v[72:75], v[176:179]
    ds_read_b128 v[36:39], v11 offset:2048
    v_mfma_f32_16x16x32_bf16 v[176:179], v[220:223], v[76:79], v[176:179]
    ds_read_b128 v[40:43], v10 offset:4096
    v_mfma_f32_16x16x32_bf16 v[180:183], v[224:227], v[72:75], v[180:183]
    ds_read_b128 v[44:47], v11 offset:4096
    v_mfma_f32_16x16x32_bf16 v[180:183], v[228:231], v[76:79], v[180:183]
    ds_read_b128 v[48:51], v10 offset:6144
    v_mfma_f32_16x16x32_bf16 v[184:187], v[200:203], v[80:83], v[184:187]
    ds_read_b64_tr_b16 v[72:73], v14 offset:16384
    v_mfma_f32_16x16x32_bf16 v[184:187], v[204:207], v[84:87], v[184:187]
    ds_read_b64_tr_b16 v[74:75], v14 offset:16896
    v_mfma_f32_16x16x32_bf16 v[188:191], v[208:211], v[80:83], v[188:191]
    ds_read_b64_tr_b16 v[76:77], v14 offset:20480
    v_mfma_f32_16x16x32_bf16 v[188:191], v[212:215], v[84:87], v[188:191]
    ds_read_b64_tr_b16 v[78:79], v14 offset:20992
    v_mfma_f32_16x16x32_bf16 v[192:195], v[216:219], v[80:83], v[192:195]
    ds_read_b128 v[52:55], v11 offset:6144
    v_mfma_f32_16x16x32_bf16 v[192:195], v[220:223], v[84:87], v[192:195]
    v_mfma_f32_16x16x32_bf16 v[196:199], v[224:227], v[80:83], v[196:199]
    v_mfma_f32_16x16x32_bf16 v[196:199], v[228:231], v[84:87], v[196:199]
    v_mfma_f32_16x16x32_bf16 v[104:107], v[88:91], v[200:203], v[104:107]
    ds_read_b64_tr_b16 v[80:81], v15 offset:16384
    v_mfma_f32_16x16x32_bf16 v[104:107], v[92:95], v[204:207], v[104:107]
    ds_read_b64_tr_b16 v[82:83], v15 offset:16896
    v_mfma_f32_16x16x32_bf16 v[112:115], v[88:91], v[208:211], v[112:115]
    ds_read_b64_tr_b16 v[84:85], v15 offset:20480
    v_mfma_f32_16x16x32_bf16 v[112:115], v[92:95], v[212:215], v[112:115]
    ds_read_b64_tr_b16 v[86:87], v15 offset:20992
    v_mfma_f32_16x16x32_bf16 v[120:123], v[88:91], v[216:219], v[120:123]
    v_mfma_f32_16x16x32_bf16 v[120:123], v[92:95], v[220:223], v[120:123]
    v_mfma_f32_16x16x32_bf16 v[128:131], v[88:91], v[224:227], v[128:131]
    v_mfma_f32_16x16x32_bf16 v[128:131], v[92:95], v[228:231], v[128:131]
    v_mfma_f32_16x16x32_bf16 v[108:111], v[96:99], v[200:203], v[108:111]
    s_waitcnt lgkmcnt(4)
    ds_read_b64_tr_b16 v[88:89], v14 offset:0
    v_mfma_f32_16x16x32_bf16 v[108:111], v[100:103], v[204:207], v[108:111]
    ds_read_b64_tr_b16 v[90:91], v14 offset:512
    v_mfma_f32_16x16x32_bf16 v[116:119], v[96:99], v[208:211], v[116:119]
    ds_read_b64_tr_b16 v[92:93], v14 offset:4096
    v_mfma_f32_16x16x32_bf16 v[116:119], v[100:103], v[212:215], v[116:119]
    ds_read_b64_tr_b16 v[94:95], v14 offset:4608
    v_mfma_f32_16x16x32_bf16 v[124:127], v[96:99], v[216:219], v[124:127]
    s_add_u32 s53, s53, 1
    v_mfma_f32_16x16x32_bf16 v[124:127], v[100:103], v[220:223], v[124:127]
    s_cmp_lt_u32 s53, 7
    v_mfma_f32_16x16x32_bf16 v[132:135], v[96:99], v[224:227], v[132:135]
    v_mfma_f32_16x16x32_bf16 v[132:135], v[100:103], v[228:231], v[132:135]
    s_cbranch_scc1 L_loop1
    v_mfma_f32_16x16x32_bf16 v[136:139], v[24:27], v[56:59], v[136:139]
    ds_read_b64_tr_b16 v[96:97], v15 offset:0
    s_mov_b32 s54, 0x3fb8aa3b
    s_mov_b32 s55, 0x3fb8aa3b
    s_mov_b32 s56, 0x358637bd
    s_lshl_b32 s57, s31, 2
    v_mfma_f32_16x16x32_bf16 v[136:139], v[28:31], v[60:63], v[136:139]
    ds_read_b64_tr_b16 v[98:99], v15 offset:512
    s_add_u32 s57, s57, s3
    s_lshl_b32 s57, s57, 4
    s_add_u32 s57, s57, s30
    s_lshl_b32 s58, s57, 10
    v_mfma_f32_16x16x32_bf16 v[140:143], v[32:35], v[56:59], v[140:143]
    ds_read_b64_tr_b16 v[100:101], v15 offset:4096
    s_add_u32 s58, s58, 0x800000
    s_lshr_b32 s59, s57, 4
    s_lshl_b32 s59, s59, 11
    s_lshl_b32 s45, s30, 4
    v_mfma_f32_16x16x32_bf16 v[140:143], v[36:39], v[60:63], v[140:143]
    ds_read_b64_tr_b16 v[102:103], v15 offset:4608
    s_add_u32 s59, s59, s45
    s_add_u32 s59, s59, 0x900000
    s_lshr_b32 s57, s57, 4
    s_lshl_b32 s57, s57, 11
    v_mfma_f32_16x16x32_bf16 v[144:147], v[40:43], v[56:59], v[144:147]
    s_add_u32 s57, s57, 0x960000
    v_and_b32 v19, 7, v4
    v_lshlrev_b32 v19, 1, v19
    v_sub_u32 v19, s30, v19
    v_mfma_f32_16x16x32_bf16 v[144:147], v[44:47], v[60:63], v[144:147]
    v_and_b32 v19, 15, v19
    v_lshl_add_u32 v19, v19, 2, v254
    s_lshl_b32 s45, s3, 11
    s_add_u32 s45, s45, 131584
    v_mfma_f32_16x16x32_bf16 v[148:151], v[48:51], v[56:59], v[148:151]
    v_add_u32 v6, s45, v5
    v_xor_b32 v7, 2048, v6
    s_lshl_b32 s45, s3, 7
    s_add_u32 s45, s45, 162304
    v_mfma_f32_16x16x32_bf16 v[148:151], v[52:55], v[60:63], v[148:151]
    v_and_b32 v3, 0x30, v4
    v_add_u32 v16, s45, v3
    v_xor_b32 v17, 128, v16
    v_xor_b32 v18, 4, v21
    v_mfma_f32_16x16x32_bf16 v[152:155], v[24:27], v[64:67], v[152:155]
    v_mov_b32 v200, 0x3f803f80
    v_mov_b32 v201, 0x3f803f80
    v_mov_b32 v202, 0x3f803f80
    v_mov_b32 v203, 0x3f803f80
    v_mfma_f32_16x16x32_bf16 v[152:155], v[28:31], v[68:71], v[152:155]
    s_waitcnt lgkmcnt(0)
    ds_write_b32 v21, v232 offset:112
    v_mfma_f32_16x16x32_bf16 v[156:159], v[32:35], v[64:67], v[156:159]
    v_mul_f32 v204, s54, v136
    v_mul_f32 v205, s54, v137
    v_mul_f32 v206, s54, v138
    v_mfma_f32_16x16x32_bf16 v[156:159], v[36:39], v[68:71], v[156:159]
    v_mul_f32 v207, s54, v139
    v_mul_f32 v208, s54, v140
    v_mul_f32 v209, s54, v141
    v_mfma_f32_16x16x32_bf16 v[160:163], v[40:43], v[64:67], v[160:163]
    v_mul_f32 v210, s54, v142
    v_mul_f32 v211, s54, v143
    v_exp_f32_e64 v204, v204 clamp
    v_mfma_f32_16x16x32_bf16 v[160:163], v[44:47], v[68:71], v[160:163]
    v_exp_f32_e64 v205, v205 clamp
    v_exp_f32_e64 v206, v206 clamp
    v_exp_f32_e64 v207, v207 clamp
    v_mfma_f32_16x16x32_bf16 v[164:167], v[48:51], v[64:67], v[164:167]
    v_exp_f32_e64 v208, v208 clamp
    v_exp_f32_e64 v209, v209 clamp
    v_exp_f32_e64 v210, v210 clamp
    v_mfma_f32_16x16x32_bf16 v[164:167], v[52:55], v[68:71], v[164:167]
    v_exp_f32_e64 v211, v211 clamp
    v_max_f32 v136, s56, v136
    v_max_f32 v137, s56, v137
    v_mfma_f32_16x16x32_bf16 v[168:171], v[24:27], v[72:75], v[168:171]
    v_max_f32 v138, s56, v138
    v_max_f32 v139, s56, v139
    v_max_f32 v140, s56, v140
    v_mfma_f32_16x16x32_bf16 v[168:171], v[28:31], v[76:79], v[168:171]
    v_max_f32 v141, s56, v141
    v_max_f32 v142, s56, v142
    v_max_f32 v143, s56, v143
    v_mfma_f32_16x16x32_bf16 v[172:175], v[32:35], v[72:75], v[172:175]
    v_add_f32 v204, v204, v136
    v_add_f32 v205, v205, v137
    v_add_f32 v206, v206, v138
    v_mfma_f32_16x16x32_bf16 v[172:175], v[36:39], v[76:79], v[172:175]
    v_add_f32 v207, v207, v139
    v_add_f32 v208, v208, v140
    v_add_f32 v209, v209, v141
    v_mfma_f32_16x16x32_bf16 v[176:179], v[40:43], v[72:75], v[176:179]
    v_add_f32 v210, v210, v142
    v_add_f32 v211, v211, v143
    v_cvt_pk_bf16_f32 v136, v204, v205
    v_mfma_f32_16x16x32_bf16 v[176:179], v[44:47], v[76:79], v[176:179]
    v_cvt_pk_bf16_f32 v137, v206, v207
    v_cvt_pk_bf16_f32 v138, v208, v209
    v_cvt_pk_bf16_f32 v139, v210, v211
    v_mfma_f32_16x16x32_bf16 v[180:183], v[48:51], v[72:75], v[180:183]
    v_mul_f32 v204, s54, v144
    v_mul_f32 v205, s54, v145
    v_mul_f32 v206, s54, v146
    v_mfma_f32_16x16x32_bf16 v[180:183], v[52:55], v[76:79], v[180:183]
    v_mul_f32 v207, s54, v147
    v_mul_f32 v208, s54, v148
    v_mul_f32 v209, s54, v149
    v_mfma_f32_16x16x32_bf16 v[184:187], v[24:27], v[80:83], v[184:187]
    v_mul_f32 v210, s54, v150
    v_mul_f32 v211, s54, v151
    v_exp_f32_e64 v204, v204 clamp
    v_mfma_f32_16x16x32_bf16 v[184:187], v[28:31], v[84:87], v[184:187]
    v_exp_f32_e64 v205, v205 clamp
    v_exp_f32_e64 v206, v206 clamp
    v_exp_f32_e64 v207, v207 clamp
    v_mfma_f32_16x16x32_bf16 v[188:191], v[32:35], v[80:83], v[188:191]
    v_exp_f32_e64 v208, v208 clamp
    v_exp_f32_e64 v209, v209 clamp
    v_exp_f32_e64 v210, v210 clamp
    v_mfma_f32_16x16x32_bf16 v[188:191], v[36:39], v[84:87], v[188:191]
    v_exp_f32_e64 v211, v211 clamp
    v_max_f32 v144, s56, v144
    v_max_f32 v145, s56, v145
    v_mfma_f32_16x16x32_bf16 v[192:195], v[40:43], v[80:83], v[192:195]
    v_max_f32 v146, s56, v146
    v_max_f32 v147, s56, v147
    v_max_f32 v148, s56, v148
    v_mfma_f32_16x16x32_bf16 v[192:195], v[44:47], v[84:87], v[192:195]
    v_max_f32 v149, s56, v149
    v_max_f32 v150, s56, v150
    v_max_f32 v151, s56, v151
    v_mfma_f32_16x16x32_bf16 v[196:199], v[48:51], v[80:83], v[196:199]
    v_add_f32 v204, v204, v144
    v_add_f32 v205, v205, v145
    v_add_f32 v206, v206, v146
    v_mfma_f32_16x16x32_bf16 v[196:199], v[52:55], v[84:87], v[196:199]
    v_add_f32 v207, v207, v147
    v_add_f32 v208, v208, v148
    v_add_f32 v209, v209, v149
    v_add_f32 v210, v210, v150
    v_add_f32 v211, v211, v151
    v_cvt_pk_bf16_f32 v140, v204, v205
    v_cvt_pk_bf16_f32 v141, v206, v207
    v_cvt_pk_bf16_f32 v142, v208, v209
    v_cvt_pk_bf16_f32 v143, v210, v211
    s_setprio 2
    v_cvt_pk_bf16_f32 v168, v168, v169
    v_cvt_pk_bf16_f32 v169, v170, v171
    v_cvt_pk_bf16_f32 v170, v172, v173
    v_cvt_pk_bf16_f32 v171, v174, v175
    v_cvt_pk_bf16_f32 v172, v176, v177
    v_cvt_pk_bf16_f32 v173, v178, v179
    v_cvt_pk_bf16_f32 v174, v180, v181
    v_cvt_pk_bf16_f32 v175, v182, v183
    v_cvt_pk_bf16_f32 v176, v184, v185
    v_cvt_pk_bf16_f32 v177, v186, v187
    v_cvt_pk_bf16_f32 v178, v188, v189
    v_cvt_pk_bf16_f32 v179, v190, v191
    v_cvt_pk_bf16_f32 v180, v192, v193
    v_cvt_pk_bf16_f32 v181, v194, v195
    v_cvt_pk_bf16_f32 v182, v196, v197
    v_cvt_pk_bf16_f32 v183, v198, v199
    s_nop 1
    v_mfma_f32_16x16x32_bf16 v[212:215], v[136:139], v[168:171], 0
    v_mfma_f32_16x16x32_bf16 v[220:223], v[136:139], v[176:179], 0
    v_mfma_f32_16x16x32_bf16 v[56:59], v[136:139], v[200:203], 0
    v_mfma_f32_16x16x32_bf16 v[212:215], v[140:143], v[172:175], v[212:215]
    v_mfma_f32_16x16x32_bf16 v[220:223], v[140:143], v[180:183], v[220:223]
    v_mfma_f32_16x16x32_bf16 v[56:59], v[140:143], v[200:203], v[56:59]
    v_pk_mul_f32 v[204:205], v[152:153], s[54:55]
    v_pk_mul_f32 v[206:207], v[154:155], s[54:55]
    v_pk_mul_f32 v[208:209], v[156:157], s[54:55]
    v_pk_mul_f32 v[210:211], v[158:159], s[54:55]
    v_exp_f32_e64 v204, v204 clamp
    v_exp_f32_e64 v205, v205 clamp
    v_exp_f32_e64 v206, v206 clamp
    v_exp_f32_e64 v207, v207 clamp
    v_exp_f32_e64 v208, v208 clamp
    v_exp_f32_e64 v209, v209 clamp
    v_exp_f32_e64 v210, v210 clamp
    v_exp_f32_e64 v211, v211 clamp
    v_max_f32 v152, s56, v152
    v_max_f32 v153, s56, v153
    v_max_f32 v154, s56, v154
    v_max_f32 v155, s56, v155
    v_max_f32 v156, s56, v156
    v_max_f32 v157, s56, v157
    v_max_f32 v158, s56, v158
    v_max_f32 v159, s56, v159
    v_pk_add_f32 v[204:205], v[204:205], v[152:153]
    v_pk_add_f32 v[206:207], v[206:207], v[154:155]
    v_pk_add_f32 v[208:209], v[208:209], v[156:157]
    v_pk_add_f32 v[210:211], v[210:211], v[158:159]
    v_cvt_pk_bf16_f32 v152, v204, v205
    v_cvt_pk_bf16_f32 v153, v206, v207
    v_cvt_pk_bf16_f32 v154, v208, v209
    v_cvt_pk_bf16_f32 v155, v210, v211
    v_pk_mul_f32 v[204:205], v[160:161], s[54:55]
    v_pk_mul_f32 v[206:207], v[162:163], s[54:55]
    v_pk_mul_f32 v[208:209], v[164:165], s[54:55]
    v_pk_mul_f32 v[210:211], v[166:167], s[54:55]
    v_exp_f32_e64 v204, v204 clamp
    v_exp_f32_e64 v205, v205 clamp
    v_exp_f32_e64 v206, v206 clamp
    v_exp_f32_e64 v207, v207 clamp
    v_exp_f32_e64 v208, v208 clamp
    v_exp_f32_e64 v209, v209 clamp
    v_exp_f32_e64 v210, v210 clamp
    v_exp_f32_e64 v211, v211 clamp
    v_max_f32 v160, s56, v160
    v_max_f32 v161, s56, v161
    v_max_f32 v162, s56, v162
    v_max_f32 v163, s56, v163
    v_max_f32 v164, s56, v164
    v_max_f32 v165, s56, v165
    v_max_f32 v166, s56, v166
    v_max_f32 v167, s56, v167
    v_pk_add_f32 v[204:205], v[204:205], v[160:161]
    v_pk_add_f32 v[206:207], v[206:207], v[162:163]
    v_pk_add_f32 v[208:209], v[208:209], v[164:165]
    v_pk_add_f32 v[210:211], v[210:211], v[166:167]
    v_cvt_pk_bf16_f32 v156, v204, v205
    v_cvt_pk_bf16_f32 v157, v206, v207
    v_cvt_pk_bf16_f32 v158, v208, v209
    v_cvt_pk_bf16_f32 v159, v210, v211
    s_nop 1
    v_mfma_f32_16x16x32_bf16 v[216:219], v[152:155], v[168:171], 0
    v_mfma_f32_16x16x32_bf16 v[224:227], v[152:155], v[176:179], 0
    v_mfma_f32_16x16x32_bf16 v[60:63], v[152:155], v[200:203], 0
    v_mfma_f32_16x16x32_bf16 v[216:219], v[156:159], v[172:175], v[216:219]
    v_mfma_f32_16x16x32_bf16 v[224:227], v[156:159], v[180:183], v[224:227]
    v_mfma_f32_16x16x32_bf16 v[60:63], v[156:159], v[200:203], v[60:63]
    s_cmp_eq_u32 s40, 0
    s_nop 5
    s_cbranch_scc1 L_x0
    v_swap_b32 v212, v220
    v_swap_b32 v213, v221
    v_swap_b32 v214, v222
    v_swap_b32 v215, v223
    v_swap_b32 v216, v224
    v_swap_b32 v217, v225
    v_swap_b32 v218, v226
    v_swap_b32 v219, v227
L_x0:
    ds_write_b128 v6, v[220:223]
    ds_write_b128 v6, v[224:227] offset:1024
    ds_write_b128 v16, v[56:59]
    ds_write_b128 v16, v[60:63] offset:64
    ds_write_b32 v21, v232 offset:0
    s_mov_b32 s45, 0
L_xspin:
    ds_read_b32 v235, v18 offset:0
    ds_read_b128 v[236:239], v7
    ds_read_b128 v[240:243], v7 offset:1024
    ds_read_b128 v[244:247], v17
    ds_read_b128 v[248:251], v17 offset:64
    s_add_u32 s45, s45, 1
    s_waitcnt lgkmcnt(4)
    v_readfirstlane_b32 s46, v235
    s_cmp_gt_u32 s45, 0x40000
    s_cbranch_scc1 L_xdone
    s_cmp_eq_u32 s46, 0
    s_cbranch_scc1 L_xspin
L_xdone:
    s_waitcnt lgkmcnt(2)
    v_pk_add_f32 v[212:213], v[212:213], v[236:237]
    v_pk_add_f32 v[214:215], v[214:215], v[238:239]
    v_pk_add_f32 v[216:217], v[216:217], v[240:241]
    v_pk_add_f32 v[218:219], v[218:219], v[242:243]
    v_cvt_pk_bf16_f32 v220, v212, v213
    v_cvt_pk_bf16_f32 v221, v214, v215
    v_cvt_pk_bf16_f32 v222, v216, v217
    v_cvt_pk_bf16_f32 v223, v218, v219
    buffer_store_dwordx4 v[220:223], v5, s[60:63], s58 offen sc1
    s_waitcnt lgkmcnt(0)
    v_pk_add_f32 v[56:57], v[56:57], v[244:245]
    v_pk_add_f32 v[58:59], v[58:59], v[246:247]
    v_pk_add_f32 v[60:61], v[60:61], v[248:249]
    v_pk_add_f32 v[62:63], v[62:63], v[250:251]
    v_cvt_pk_bf16_f32 v224, v56, v57
    v_cvt_pk_bf16_f32 v225, v58, v59
    v_cvt_pk_bf16_f32 v226, v60, v61
    v_cvt_pk_bf16_f32 v227, v62, v63
    s_mov_b32 exec_lo, 0x10001
    s_mov_b32 exec_hi, 0x10001
    buffer_store_dwordx4 v[224:227], v5, s[60:63], s59 offen sc1
    s_mov_b64 exec, -1
    ds_write_b32 v21, v232 offset:128
    v_mfma_f32_16x16x32_bf16 v[104:107], v[88:91], v[24:27], v[104:107]
    s_lshl_b32 s47, s32, 1
    s_add_u32 s47, s47, s41
    s_lshl_b32 s44, s32, 2
    s_add_u32 s44, s44, s3
    v_mfma_f32_16x16x32_bf16 v[104:107], v[92:95], v[28:31], v[104:107]
    s_lshl_b32 s58, s44, 14
    s_add_u32 s58, s58, 0x800000
    s_lshl_b32 s59, s44, 11
    s_add_u32 s59, s59, 0x900000
    v_mfma_f32_16x16x32_bf16 v[108:111], v[96:99], v[24:27], v[108:111]
    s_lshl_b32 s44, s44, 6
    s_lshr_b32 vcc_lo, s44, 6
    s_mul_i32 vcc_lo, vcc_lo, 1984
    s_add_u32 s44, s44, vcc_lo
    v_mfma_f32_16x16x32_bf16 v[108:111], v[100:103], v[28:31], v[108:111]
    s_add_u32 s44, s44, 0x960000
    s_lshl_b32 vcc_lo, s30, 7
    s_add_u32 s44, s44, vcc_lo
    s_lshl_b32 s45, s41, 2
    v_mfma_f32_16x16x32_bf16 v[112:115], v[88:91], v[32:35], v[112:115]
    v_add_u32 v14, s45, v20
    v_mov_b32 v6, 0x3f80
    v_and_b32 v7, 1, v4
    v_lshlrev_b32 v7, 4, v7
    v_mfma_f32_16x16x32_bf16 v[112:115], v[92:95], v[36:39], v[112:115]
    v_lshlrev_b32 v6, v7, v6
    v_lshrrev_b32 v2, 4, v4
    v_cmp_eq_u32 vcc, v2, v22
    v_bfe_u32 v7, v4, 1, 1
    v_mfma_f32_16x16x32_bf16 v[116:119], v[96:99], v[32:35], v[116:119]
    v_mov_b32 v8, 0
    v_cndmask_b32 v6, 0, v6, vcc
    v_cmp_eq_u32 vcc, 0, v7
    v_mov_b32 v9, 0
    v_mfma_f32_16x16x32_bf16 v[116:119], v[100:103], v[36:39], v[116:119]
    v_mov_b32 v12, 0
    v_cndmask_b32 v10, 0, v6, vcc
    v_cndmask_b32 v11, v6, v233, vcc
    v_mov_b32 v13, 0
    v_mfma_f32_16x16x32_bf16 v[120:123], v[88:91], v[40:43], v[120:123]
    s_lshl_b32 s45, s3, 10
    s_add_u32 s45, s45, 158208
    v_add_u32 v6, s45, v5
    s_xor_b32 s45, s3, 1
    v_mfma_f32_16x16x32_bf16 v[120:123], v[92:95], v[44:47], v[120:123]
    s_lshl_b32 s45, s45, 10
    s_add_u32 s45, s45, 158208
    v_add_u32 v7, s45, v5
    s_lshl_b32 s48, s30, 3
    v_mfma_f32_16x16x32_bf16 v[124:127], v[96:99], v[40:43], v[124:127]
    s_lshl_b32 s45, s40, 2
    s_add_u32 s48, s48, s45
    s_lshl_b32 s48, s48, 15
    s_lshl_b32 s45, s47, 10
    v_mfma_f32_16x16x32_bf16 v[124:127], v[100:103], v[44:47], v[124:127]
    s_add_u32 s48, s48, s45
    s_add_u32 s48, s48, 0x400000
    s_lshl_b32 s49, s30, 1
    s_add_u32 s49, s49, s40
    v_mfma_f32_16x16x32_bf16 v[128:131], v[88:91], v[48:51], v[128:131]
    s_lshl_b32 s49, s49, 7
    s_lshl_b32 s45, s47, 2
    s_add_u32 s49, s49, s45
    s_lshr_b32 vcc_lo, s49, 6
    v_mfma_f32_16x16x32_bf16 v[128:131], v[92:95], v[52:55], v[128:131]
    s_mul_i32 vcc_lo, vcc_lo, 1984
    s_add_u32 s49, s49, vcc_lo
    s_add_u32 s49, s49, 0x980000
    s_mov_b32 s50, 0
    v_mfma_f32_16x16x32_bf16 v[132:135], v[96:99], v[48:51], v[132:135]
    s_mov_b32 s51, 0
    s_mov_b32 s53, 0
    s_mov_b32 s46, 0
    s_and_b32 s43, s30, 7
    v_mfma_f32_16x16x32_bf16 v[132:135], v[100:103], v[52:55], v[132:135]
    v_mul_f32 v204, s54, v104
    v_mul_f32 v205, s54, v105
    v_mul_f32 v206, s54, v106
    v_mul_f32 v207, s54, v107
    v_mul_f32 v208, s54, v108
    v_mul_f32 v209, s54, v109
    v_mul_f32 v210, s54, v110
    v_mul_f32 v211, s54, v111
    v_exp_f32_e64 v204, v204 clamp
    v_exp_f32_e64 v205, v205 clamp
    v_exp_f32_e64 v206, v206 clamp
    v_exp_f32_e64 v207, v207 clamp
    v_exp_f32_e64 v208, v208 clamp
    v_exp_f32_e64 v209, v209 clamp
    v_exp_f32_e64 v210, v210 clamp
    v_exp_f32_e64 v211, v211 clamp
    v_max_f32 v104, s56, v104
    v_max_f32 v105, s56, v105
    v_max_f32 v106, s56, v106
    v_max_f32 v107, s56, v107
    v_max_f32 v108, s56, v108
    v_max_f32 v109, s56, v109
    v_max_f32 v110, s56, v110
    v_max_f32 v111, s56, v111
    v_add_f32 v204, v204, v104
    v_add_f32 v205, v205, v105
    v_add_f32 v206, v206, v106
    v_add_f32 v207, v207, v107
    v_add_f32 v208, v208, v108
    v_add_f32 v209, v209, v109
    v_add_f32 v210, v210, v110
    v_add_f32 v211, v211, v111
    v_cvt_pk_bf16_f32 v104, v204, v205
    v_cvt_pk_bf16_f32 v105, v206, v207
    v_cvt_pk_bf16_f32 v106, v208, v209
    v_cvt_pk_bf16_f32 v107, v210, v211
    v_mul_f32 v204, s54, v112
    v_mul_f32 v205, s54, v113
    v_mul_f32 v206, s54, v114
    v_mul_f32 v207, s54, v115
    v_mul_f32 v208, s54, v116
    v_mul_f32 v209, s54, v117
    v_mul_f32 v210, s54, v118
    v_mul_f32 v211, s54, v119
    v_exp_f32_e64 v204, v204 clamp
    v_exp_f32_e64 v205, v205 clamp
    v_exp_f32_e64 v206, v206 clamp
    v_exp_f32_e64 v207, v207 clamp
    v_exp_f32_e64 v208, v208 clamp
    v_exp_f32_e64 v209, v209 clamp
    v_exp_f32_e64 v210, v210 clamp
    v_exp_f32_e64 v211, v211 clamp
    v_max_f32 v112, s56, v112
    v_max_f32 v113, s56, v113
    v_max_f32 v114, s56, v114
    v_max_f32 v115, s56, v115
    v_max_f32 v116, s56, v116
    v_max_f32 v117, s56, v117
    v_max_f32 v118, s56, v118
    v_max_f32 v119, s56, v119
    v_add_f32 v204, v204, v112
    v_add_f32 v205, v205, v113
    v_add_f32 v206, v206, v114
    v_add_f32 v207, v207, v115
    v_add_f32 v208, v208, v116
    v_add_f32 v209, v209, v117
    v_add_f32 v210, v210, v118
    v_add_f32 v211, v211, v119
    v_cvt_pk_bf16_f32 v108, v204, v205
    v_cvt_pk_bf16_f32 v109, v206, v207
    v_cvt_pk_bf16_f32 v110, v208, v209
    v_cvt_pk_bf16_f32 v111, v210, v211
    s_waitcnt vmcnt(0)
    s_mov_b64 exec, 0xffff
    buffer_store_dword v234, v19, s[60:63], s57 offen sc1
    s_mov_b64 exec, -1
    s_load_dwordx16 s[4:19], s[26:27], s44 glc
    v_mul_f32 v204, s54, v120
    v_mul_f32 v205, s54, v121
    v_mul_f32 v206, s54, v122
    v_mul_f32 v207, s54, v123
    v_mul_f32 v208, s54, v124
    v_mul_f32 v209, s54, v125
    v_mul_f32 v210, s54, v126
    v_mul_f32 v211, s54, v127
    v_exp_f32_e64 v204, v204 clamp
    v_exp_f32_e64 v205, v205 clamp
    v_exp_f32_e64 v206, v206 clamp
    v_exp_f32_e64 v207, v207 clamp
    v_exp_f32_e64 v208, v208 clamp
    v_exp_f32_e64 v209, v209 clamp
    v_exp_f32_e64 v210, v210 clamp
    v_exp_f32_e64 v211, v211 clamp
    v_max_f32 v120, s56, v120
    v_max_f32 v121, s56, v121
    v_max_f32 v122, s56, v122
    v_max_f32 v123, s56, v123
    v_max_f32 v124, s56, v124
    v_max_f32 v125, s56, v125
    v_max_f32 v126, s56, v126
    v_max_f32 v127, s56, v127
    v_add_f32 v204, v204, v120
    v_add_f32 v205, v205, v121
    v_add_f32 v206, v206, v122
    v_add_f32 v207, v207, v123
    v_add_f32 v208, v208, v124
    v_add_f32 v209, v209, v125
    v_add_f32 v210, v210, v126
    v_add_f32 v211, v211, v127
    v_cvt_pk_bf16_f32 v112, v204, v205
    v_cvt_pk_bf16_f32 v113, v206, v207
    v_cvt_pk_bf16_f32 v114, v208, v209
    v_cvt_pk_bf16_f32 v115, v210, v211
    v_mul_f32 v204, s54, v128
    v_mul_f32 v205, s54, v129
    v_mul_f32 v206, s54, v130
    v_mul_f32 v207, s54, v131
    v_mul_f32 v208, s54, v132
    v_mul_f32 v209, s54, v133
    v_mul_f32 v210, s54, v134
    v_mul_f32 v211, s54, v135
    v_exp_f32_e64 v204, v204 clamp
    v_exp_f32_e64 v205, v205 clamp
    v_exp_f32_e64 v206, v206 clamp
    v_exp_f32_e64 v207, v207 clamp
    v_exp_f32_e64 v208, v208 clamp
    v_exp_f32_e64 v209, v209 clamp
    v_exp_f32_e64 v210, v210 clamp
    v_exp_f32_e64 v211, v211 clamp
    v_max_f32 v128, s56, v128
    v_max_f32 v129, s56, v129
    v_max_f32 v130, s56, v130
    v_max_f32 v131, s56, v131
    v_max_f32 v132, s56, v132
    v_max_f32 v133, s56, v133
    v_max_f32 v134, s56, v134
    v_max_f32 v135, s56, v135
    v_add_f32 v204, v204, v128
    v_add_f32 v205, v205, v129
    v_add_f32 v206, v206, v130
    v_add_f32 v207, v207, v131
    v_add_f32 v208, v208, v132
    v_add_f32 v209, v209, v133
    v_add_f32 v210, v210, v134
    v_add_f32 v211, v211, v135
    v_cvt_pk_bf16_f32 v116, v204, v205
    v_cvt_pk_bf16_f32 v117, v206, v207
    v_cvt_pk_bf16_f32 v118, v208, v209
    v_cvt_pk_bf16_f32 v119, v210, v211
    v_mov_b64 v[88:89], 0
    v_mov_b64 v[138:139], 0
    v_mov_b32 v168, s56
    v_mov_b64 v[90:91], 0
    v_mov_b64 v[142:143], 0
    v_mov_b32 v169, s56
    v_mov_b64 v[92:93], 0
    v_mov_b64 v[146:147], 0
    v_mov_b32 v170, s56
    v_mov_b64 v[94:95], 0
    v_mov_b64 v[150:151], 0
    v_mov_b32 v171, s56
    s_setprio 3
    s_cmp_eq_u32 s46, 0
    s_cbranch_scc1 L_poll0
L_go0:
    s_ff1_i32_b32 s45, s46
    s_bitset0_b32 s46, s45
    s_add_u32 s45, s45, s43
    s_and_b32 s45, s45, 7
    s_lshl_b32 s45, s45, 11
    s_add_u32 s45, s45, s58
    buffer_load_dwordx4 v[24:27], v5, s[60:63], s45 offen offset:0 sc1
    buffer_load_dwordx4 v[28:31], v5, s[60:63], s45 offen offset:1024 sc1
    s_bitset1_b32 s51, 0
    s_cmp_eq_u32 s46, 0
    s_cbranch_scc1 L_poll1
L_go1:
    s_ff1_i32_b32 s45, s46
    s_bitset0_b32 s46, s45
    s_add_u32 s45, s45, s43
    s_and_b32 s45, s45, 7
    s_lshl_b32 s45, s45, 11
    s_add_u32 s45, s45, s58
    buffer_load_dwordx4 v[32:35], v5, s[60:63], s45 offen offset:0 sc1
    buffer_load_dwordx4 v[36:39], v5, s[60:63], s45 offen offset:1024 sc1
    s_bitset1_b32 s51, 1
    s_cmp_eq_u32 s46, 0
    s_cbranch_scc1 L_poll2
L_go2:
    s_ff1_i32_b32 s45, s46
    s_bitset0_b32 s46, s45
    s_add_u32 s45, s45, s43
    s_and_b32 s45, s45, 7
    s_lshl_b32 s45, s45, 11
    s_add_u32 s45, s45, s58
    buffer_load_dwordx4 v[40:43], v5, s[60:63], s45 offen offset:0 sc1
    buffer_load_dwordx4 v[44:47], v5, s[60:63], s45 offen offset:1024 sc1
    s_bitset1_b32 s51, 2
    s_cmp_eq_u32 s46, 0
    s_cbranch_scc1 L_poll3
L_go3:
    s_ff1_i32_b32 s45, s46
    s_bitset0_b32 s46, s45
    s_add_u32 s45, s45, s43
    s_and_b32 s45, s45, 7
    s_lshl_b32 s45, s45, 11
    s_add_u32 s45, s45, s58
    buffer_load_dwordx4 v[48:51], v5, s[60:63], s45 offen offset:0 sc1
    buffer_load_dwordx4 v[52:55], v5, s[60:63], s45 offen offset:1024 sc1
    s_bitset1_b32 s51, 3
    s_cmp_eq_u32 s46, 0
    s_cbranch_scc1 L_poll4
L_go4:
    s_ff1_i32_b32 s45, s46
    s_bitset0_b32 s46, s45
    s_add_u32 s45, s45, s43
    s_and_b32 s45, s45, 7
    s_lshl_b32 s45, s45, 11
    s_add_u32 s45, s45, s58
    buffer_load_dwordx4 v[56:59], v5, s[60:63], s45 offen offset:0 sc1
    buffer_load_dwordx4 v[60:63], v5, s[60:63], s45 offen offset:1024 sc1
    s_bitset1_b32 s51, 4
    s_cmp_eq_u32 s46, 0
    s_cbranch_scc1 L_poll5
L_go5:
    s_ff1_i32_b32 s45, s46
    s_bitset0_b32 s46, s45
    s_add_u32 s45, s45, s43
    s_and_b32 s45, s45, 7
    s_lshl_b32 s45, s45, 11
    s_add_u32 s45, s45, s58
    buffer_load_dwordx4 v[64:67], v5, s[60:63], s45 offen offset:0 sc1
    buffer_load_dwordx4 v[68:71], v5, s[60:63], s45 offen offset:1024 sc1
    s_bitset1_b32 s51, 5
    s_cmp_eq_u32 s46, 0
    s_cbranch_scc1 L_poll6
L_go6:
    s_ff1_i32_b32 s45, s46
    s_bitset0_b32 s46, s45
    s_add_u32 s45, s45, s43
    s_and_b32 s45, s45, 7
    s_lshl_b32 s45, s45, 11
    s_add_u32 s45, s45, s58
    buffer_load_dwordx4 v[72:75], v5, s[60:63], s45 offen offset:0 sc1
    buffer_load_dwordx4 v[76:79], v5, s[60:63], s45 offen offset:1024 sc1
    s_bitset1_b32 s51, 6
    s_cmp_eq_u32 s46, 0
    s_cbranch_scc1 L_poll7
L_go7:
    s_ff1_i32_b32 s45, s46
    s_bitset0_b32 s46, s45
    s_add_u32 s45, s45, s43
    s_and_b32 s45, s45, 7
    s_lshl_b32 s45, s45, 11
    s_add_u32 s45, s45, s58
    buffer_load_dwordx4 v[80:83], v5, s[60:63], s45 offen offset:0 sc1
    buffer_load_dwordx4 v[84:87], v5, s[60:63], s45 offen offset:1024 sc1
    s_bitset1_b32 s51, 7
    s_branch L_fin
L_poll0:
    s_waitcnt lgkmcnt(0)
    s_cmp_eq_u64 s[18:19], s[72:73]
    s_addc_u32 s46, s46, s46
    s_cmp_eq_u64 s[16:17], s[72:73]
    s_addc_u32 s46, s46, s46
    s_cmp_eq_u64 s[14:15], s[72:73]
    s_addc_u32 s46, s46, s46
    s_cmp_eq_u64 s[12:13], s[72:73]
    s_addc_u32 s46, s46, s46
    s_cmp_eq_u64 s[10:11], s[72:73]
    s_addc_u32 s46, s46, s46
    s_cmp_eq_u64 s[8:9], s[72:73]
    s_addc_u32 s46, s46, s46
    s_cmp_eq_u64 s[6:7], s[72:73]
    s_addc_u32 s46, s46, s46
    s_cmp_eq_u64 s[4:5], s[72:73]
    s_addc_u32 s46, s46, s46
    s_add_u32 s53, s53, 1
    s_cmp_gt_u32 s53, 0x8000
    s_cselect_b32 s46, 0xff, s46
    s_andn2_b32 s46, s46, s50
    s_or_b32 s50, s50, s46
    s_cmp_eq_u32 s50, 0xff
    s_cbranch_scc0 L_pm0
    buffer_load_dwordx4 v[96:99], v5, s[60:63], s59 offen sc1
    s_mov_b32 s47, s51
    s_mov_b32 s52, 0
    s_branch L_go0
L_pm0:
    s_load_dwordx16 s[4:19], s[26:27], s44 glc
    s_cmp_lg_u32 s46, 0
    s_cbranch_scc1 L_go0
    s_branch L_poll0
L_poll1:
    s_waitcnt lgkmcnt(0)
    s_cmp_eq_u64 s[18:19], s[72:73]
    s_addc_u32 s46, s46, s46
    s_cmp_eq_u64 s[16:17], s[72:73]
    s_addc_u32 s46, s46, s46
    s_cmp_eq_u64 s[14:15], s[72:73]
    s_addc_u32 s46, s46, s46
    s_cmp_eq_u64 s[12:13], s[72:73]
    s_addc_u32 s46, s46, s46
    s_cmp_eq_u64 s[10:11], s[72:73]
    s_addc_u32 s46, s46, s46
    s_cmp_eq_u64 s[8:9], s[72:73]
    s_addc_u32 s46, s46, s46
    s_cmp_eq_u64 s[6:7], s[72:73]
    s_addc_u32 s46, s46, s46
    s_cmp_eq_u64 s[4:5], s[72:73]
    s_addc_u32 s46, s46, s46
    s_add_u32 s53, s53, 1
    s_cmp_gt_u32 s53, 0x8000
    s_cselect_b32 s46, 0xff, s46
    s_andn2_b32 s46, s46, s50
    s_or_b32 s50, s50, s46
    s_cmp_eq_u32 s50, 0xff
    s_cbranch_scc0 L_pm1
    buffer_load_dwordx4 v[96:99], v5, s[60:63], s59 offen sc1
    s_mov_b32 s47, s51
    s_mov_b32 s52, 1
    s_branch L_go1
L_pm1:
    s_load_dwordx16 s[4:19], s[26:27], s44 glc
    s_cmp_lg_u32 s46, 0
    s_cbranch_scc1 L_go1
    s_cmp_eq_u32 s51, 0
    s_cbranch_scc1 L_poll1
    s_mov_b32 s52, 1
    s_branch L_acc
L_poll2:
    s_waitcnt lgkmcnt(0)
    s_cmp_eq_u64 s[18:19], s[72:73]
    s_addc_u32 s46, s46, s46
    s_cmp_eq_u64 s[16:17], s[72:73]
    s_addc_u32 s46, s46, s46
    s_cmp_eq_u64 s[14:15], s[72:73]
    s_addc_u32 s46, s46, s46
    s_cmp_eq_u64 s[12:13], s[72:73]
    s_addc_u32 s46, s46, s46
    s_cmp_eq_u64 s[10:11], s[72:73]
    s_addc_u32 s46, s46, s46
    s_cmp_eq_u64 s[8:9], s[72:73]
    s_addc_u32 s46, s46, s46
    s_cmp_eq_u64 s[6:7], s[72:73]
    s_addc_u32 s46, s46, s46
    s_cmp_eq_u64 s[4:5], s[72:73]
    s_addc_u32 s46, s46, s46
    s_add_u32 s53, s53, 1
    s_cmp_gt_u32 s53, 0x8000
    s_cselect_b32 s46, 0xff, s46
    s_andn2_b32 s46, s46, s50
    s_or_b32 s50, s50, s46
    s_cmp_eq_u32 s50, 0xff
    s_cbranch_scc0 L_pm2
    buffer_load_dwordx4 v[96:99], v5, s[60:63], s59 offen sc1
    s_mov_b32 s47, s51
    s_mov_b32 s52, 2
    s_branch L_go2
L_pm2:
    s_load_dwordx16 s[4:19], s[26:27], s44 glc
    s_cmp_lg_u32 s46, 0
    s_cbranch_scc1 L_go2
    s_cmp_eq_u32 s51, 0
    s_cbranch_scc1 L_poll2
    s_mov_b32 s52, 2
    s_branch L_acc
L_poll3:
    s_waitcnt lgkmcnt(0)
    s_cmp_eq_u64 s[18:19], s[72:73]
    s_addc_u32 s46, s46, s46
    s_cmp_eq_u64 s[16:17], s[72:73]
    s_addc_u32 s46, s46, s46
    s_cmp_eq_u64 s[14:15], s[72:73]
    s_addc_u32 s46, s46, s46
    s_cmp_eq_u64 s[12:13], s[72:73]
    s_addc_u32 s46, s46, s46
    s_cmp_eq_u64 s[10:11], s[72:73]
    s_addc_u32 s46, s46, s46
    s_cmp_eq_u64 s[8:9], s[72:73]
    s_addc_u32 s46, s46, s46
    s_cmp_eq_u64 s[6:7], s[72:73]
    s_addc_u32 s46, s46, s46
    s_cmp_eq_u64 s[4:5], s[72:73]
    s_addc_u32 s46, s46, s46
    s_add_u32 s53, s53, 1
    s_cmp_gt_u32 s53, 0x8000
    s_cselect_b32 s46, 0xff, s46
    s_andn2_b32 s46, s46, s50
    s_or_b32 s50, s50, s46
    s_cmp_eq_u32 s50, 0xff
    s_cbranch_scc0 L_pm3
    buffer_load_dwordx4 v[96:99], v5, s[60:63], s59 offen sc1
    s_mov_b32 s47, s51
    s_mov_b32 s52, 3
    s_branch L_go3
L_pm3:
    s_load_dwordx16 s[4:19], s[26:27], s44 glc
    s_cmp_lg_u32 s46, 0
    s_cbranch_scc1 L_go3
    s_cmp_eq_u32 s51, 0
    s_cbranch_scc1 L_poll3
    s_mov_b32 s52, 3
    s_branch L_acc
L_poll4:
    s_waitcnt lgkmcnt(0)
    s_cmp_eq_u64 s[18:19], s[72:73]
    s_addc_u32 s46, s46, s46
    s_cmp_eq_u64 s[16:17], s[72:73]
    s_addc_u32 s46, s46, s46
    s_cmp_eq_u64 s[14:15], s[72:73]
    s_addc_u32 s46, s46, s46
    s_cmp_eq_u64 s[12:13], s[72:73]
    s_addc_u32 s46, s46, s46
    s_cmp_eq_u64 s[10:11], s[72:73]
    s_addc_u32 s46, s46, s46
    s_cmp_eq_u64 s[8:9], s[72:73]
    s_addc_u32 s46, s46, s46
    s_cmp_eq_u64 s[6:7], s[72:73]
    s_addc_u32 s46, s46, s46
    s_cmp_eq_u64 s[4:5], s[72:73]
    s_addc_u32 s46, s46, s46
    s_add_u32 s53, s53, 1
    s_cmp_gt_u32 s53, 0x8000
    s_cselect_b32 s46, 0xff, s46
    s_andn2_b32 s46, s46, s50
    s_or_b32 s50, s50, s46
    s_cmp_eq_u32 s50, 0xff
    s_cbranch_scc0 L_pm4
    buffer_load_dwordx4 v[96:99], v5, s[60:63], s59 offen sc1
    s_mov_b32 s47, s51
    s_mov_b32 s52, 4
    s_branch L_go4
L_pm4:
    s_load_dwordx16 s[4:19], s[26:27], s44 glc
    s_cmp_lg_u32 s46, 0
    s_cbranch_scc1 L_go4
    s_cmp_eq_u32 s51, 0
    s_cbranch_scc1 L_poll4
    s_mov_b32 s52, 4
    s_branch L_acc
L_poll5:
    s_waitcnt lgkmcnt(0)
    s_cmp_eq_u64 s[18:19], s[72:73]
    s_addc_u32 s46, s46, s46
    s_cmp_eq_u64 s[16:17], s[72:73]
    s_addc_u32 s46, s46, s46
    s_cmp_eq_u64 s[14:15], s[72:73]
    s_addc_u32 s46, s46, s46
    s_cmp_eq_u64 s[12:13], s[72:73]
    s_addc_u32 s46, s46, s46
    s_cmp_eq_u64 s[10:11], s[72:73]
    s_addc_u32 s46, s46, s46
    s_cmp_eq_u64 s[8:9], s[72:73]
    s_addc_u32 s46, s46, s46
    s_cmp_eq_u64 s[6:7], s[72:73]
    s_addc_u32 s46, s46, s46
    s_cmp_eq_u64 s[4:5], s[72:73]
    s_addc_u32 s46, s46, s46
    s_add_u32 s53, s53, 1
    s_cmp_gt_u32 s53, 0x8000
    s_cselect_b32 s46, 0xff, s46
    s_andn2_b32 s46, s46, s50
    s_or_b32 s50, s50, s46
    s_cmp_eq_u32 s50, 0xff
    s_cbranch_scc0 L_pm5
    buffer_load_dwordx4 v[96:99], v5, s[60:63], s59 offen sc1
    s_mov_b32 s47, s51
    s_mov_b32 s52, 5
    s_branch L_go5
L_pm5:
    s_load_dwordx16 s[4:19], s[26:27], s44 glc
    s_cmp_lg_u32 s46, 0
    s_cbranch_scc1 L_go5
    s_cmp_eq_u32 s51, 0
    s_cbranch_scc1 L_poll5
    s_mov_b32 s52, 5
    s_branch L_acc
L_poll6:
    s_waitcnt lgkmcnt(0)
    s_cmp_eq_u64 s[18:19], s[72:73]
    s_addc_u32 s46, s46, s46
    s_cmp_eq_u64 s[16:17], s[72:73]
    s_addc_u32 s46, s46, s46
    s_cmp_eq_u64 s[14:15], s[72:73]
    s_addc_u32 s46, s46, s46
    s_cmp_eq_u64 s[12:13], s[72:73]
    s_addc_u32 s46, s46, s46
    s_cmp_eq_u64 s[10:11], s[72:73]
    s_addc_u32 s46, s46, s46
    s_cmp_eq_u64 s[8:9], s[72:73]
    s_addc_u32 s46, s46, s46
    s_cmp_eq_u64 s[6:7], s[72:73]
    s_addc_u32 s46, s46, s46
    s_cmp_eq_u64 s[4:5], s[72:73]
    s_addc_u32 s46, s46, s46
    s_add_u32 s53, s53, 1
    s_cmp_gt_u32 s53, 0x8000
    s_cselect_b32 s46, 0xff, s46
    s_andn2_b32 s46, s46, s50
    s_or_b32 s50, s50, s46
    s_cmp_eq_u32 s50, 0xff
    s_cbranch_scc0 L_pm6
    buffer_load_dwordx4 v[96:99], v5, s[60:63], s59 offen sc1
    s_mov_b32 s47, s51
    s_mov_b32 s52, 6
    s_branch L_go6
L_pm6:
    s_load_dwordx16 s[4:19], s[26:27], s44 glc
    s_cmp_lg_u32 s46, 0
    s_cbranch_scc1 L_go6
    s_cmp_eq_u32 s51, 0
    s_cbranch_scc1 L_poll6
    s_mov_b32 s52, 6
    s_branch L_acc
L_poll7:
    s_waitcnt lgkmcnt(0)
    s_cmp_eq_u64 s[18:19], s[72:73]
    s_addc_u32 s46, s46, s46
    s_cmp_eq_u64 s[16:17], s[72:73]
    s_addc_u32 s46, s46, s46
    s_cmp_eq_u64 s[14:15], s[72:73]
    s_addc_u32 s46, s46, s46
    s_cmp_eq_u64 s[12:13], s[72:73]
    s_addc_u32 s46, s46, s46
    s_cmp_eq_u64 s[10:11], s[72:73]
    s_addc_u32 s46, s46, s46
    s_cmp_eq_u64 s[8:9], s[72:73]
    s_addc_u32 s46, s46, s46
    s_cmp_eq_u64 s[6:7], s[72:73]
    s_addc_u32 s46, s46, s46
    s_cmp_eq_u64 s[4:5], s[72:73]
    s_addc_u32 s46, s46, s46
    s_add_u32 s53, s53, 1
    s_cmp_gt_u32 s53, 0x8000
    s_cselect_b32 s46, 0xff, s46
    s_andn2_b32 s46, s46, s50
    s_or_b32 s50, s50, s46
    s_cmp_eq_u32 s50, 0xff
    s_cbranch_scc0 L_pm7
    buffer_load_dwordx4 v[96:99], v5, s[60:63], s59 offen sc1
    s_mov_b32 s47, s51
    s_mov_b32 s52, 7
    s_branch L_go7
L_pm7:
    s_load_dwordx16 s[4:19], s[26:27], s44 glc
    s_cmp_lg_u32 s46, 0
    s_cbranch_scc1 L_go7
    s_cmp_eq_u32 s51, 0
    s_cbranch_scc1 L_poll7
    s_mov_b32 s52, 7
    s_branch L_acc
L_acc:
    s_waitcnt vmcnt(0)
    s_bitcmp1_b32 s51, 0
    s_cbranch_scc0 L_ac0
    v_mfma_f32_16x16x32_bf16 v[88:91], v[10:13], v[24:27], v[88:91]
    v_mfma_f32_16x16x32_bf16 v[92:95], v[8:11], v[24:27], v[92:95]
    v_mfma_f32_16x16x32_bf16 v[88:91], v[10:13], v[28:31], v[88:91]
    v_mfma_f32_16x16x32_bf16 v[92:95], v[8:11], v[28:31], v[92:95]
L_ac0:
    s_bitcmp1_b32 s51, 1
    s_cbranch_scc0 L_ac1
    v_mfma_f32_16x16x32_bf16 v[88:91], v[10:13], v[32:35], v[88:91]
    v_mfma_f32_16x16x32_bf16 v[92:95], v[8:11], v[32:35], v[92:95]
    v_mfma_f32_16x16x32_bf16 v[88:91], v[10:13], v[36:39], v[88:91]
    v_mfma_f32_16x16x32_bf16 v[92:95], v[8:11], v[36:39], v[92:95]
L_ac1:
    s_bitcmp1_b32 s51, 2
    s_cbranch_scc0 L_ac2
    v_mfma_f32_16x16x32_bf16 v[88:91], v[10:13], v[40:43], v[88:91]
    v_mfma_f32_16x16x32_bf16 v[92:95], v[8:11], v[40:43], v[92:95]
    v_mfma_f32_16x16x32_bf16 v[88:91], v[10:13], v[44:47], v[88:91]
    v_mfma_f32_16x16x32_bf16 v[92:95], v[8:11], v[44:47], v[92:95]
L_ac2:
    s_bitcmp1_b32 s51, 3
    s_cbranch_scc0 L_ac3
    v_mfma_f32_16x16x32_bf16 v[88:91], v[10:13], v[48:51], v[88:91]
    v_mfma_f32_16x16x32_bf16 v[92:95], v[8:11], v[48:51], v[92:95]
    v_mfma_f32_16x16x32_bf16 v[88:91], v[10:13], v[52:55], v[88:91]
    v_mfma_f32_16x16x32_bf16 v[92:95], v[8:11], v[52:55], v[92:95]
L_ac3:
    s_bitcmp1_b32 s51, 4
    s_cbranch_scc0 L_ac4
    v_mfma_f32_16x16x32_bf16 v[88:91], v[10:13], v[56:59], v[88:91]
    v_mfma_f32_16x16x32_bf16 v[92:95], v[8:11], v[56:59], v[92:95]
    v_mfma_f32_16x16x32_bf16 v[88:91], v[10:13], v[60:63], v[88:91]
    v_mfma_f32_16x16x32_bf16 v[92:95], v[8:11], v[60:63], v[92:95]
L_ac4:
    s_bitcmp1_b32 s51, 5
    s_cbranch_scc0 L_ac5
    v_mfma_f32_16x16x32_bf16 v[88:91], v[10:13], v[64:67], v[88:91]
    v_mfma_f32_16x16x32_bf16 v[92:95], v[8:11], v[64:67], v[92:95]
    v_mfma_f32_16x16x32_bf16 v[88:91], v[10:13], v[68:71], v[88:91]
    v_mfma_f32_16x16x32_bf16 v[92:95], v[8:11], v[68:71], v[92:95]
L_ac5:
    s_bitcmp1_b32 s51, 6
    s_cbranch_scc0 L_ac6
    v_mfma_f32_16x16x32_bf16 v[88:91], v[10:13], v[72:75], v[88:91]
    v_mfma_f32_16x16x32_bf16 v[92:95], v[8:11], v[72:75], v[92:95]
    v_mfma_f32_16x16x32_bf16 v[88:91], v[10:13], v[76:79], v[88:91]
    v_mfma_f32_16x16x32_bf16 v[92:95], v[8:11], v[76:79], v[92:95]
L_ac6:
    s_mov_b32 s51, 0
    s_cmp_eq_u32 s52, 1
    s_cbranch_scc1 L_poll1
    s_cmp_eq_u32 s52, 2
    s_cbranch_scc1 L_poll2
    s_cmp_eq_u32 s52, 3
    s_cbranch_scc1 L_poll3
    s_cmp_eq_u32 s52, 4
    s_cbranch_scc1 L_poll4
    s_cmp_eq_u32 s52, 5
    s_cbranch_scc1 L_poll5
    s_cmp_eq_u32 s52, 6
    s_cbranch_scc1 L_poll6
    s_branch L_poll7
L_fin:
    s_andn2_b32 s46, s51, s47
    s_cmp_eq_u32 s52, 0
    s_cbranch_scc1 L_pw0
    s_cmp_eq_u32 s52, 1
    s_cbranch_scc1 L_pw1
    s_cmp_eq_u32 s52, 2
    s_cbranch_scc1 L_pw2
    s_cmp_eq_u32 s52, 3
    s_cbranch_scc1 L_pw3
    s_cmp_eq_u32 s52, 4
    s_cbranch_scc1 L_pw4
    s_cmp_eq_u32 s52, 5
    s_cbranch_scc1 L_pw5
    s_cmp_eq_u32 s52, 6
    s_cbranch_scc1 L_pw6
    s_waitcnt vmcnt(2)
    s_branch L_pwd
L_pw0:
    s_waitcnt vmcnt(16)
    s_branch L_pwd
L_pw1:
    s_waitcnt vmcnt(14)
    s_branch L_pwd
L_pw2:
    s_waitcnt vmcnt(12)
    s_branch L_pwd
L_pw3:
    s_waitcnt vmcnt(10)
    s_branch L_pwd
L_pw4:
    s_waitcnt vmcnt(8)
    s_branch L_pwd
L_pw5:
    s_waitcnt vmcnt(6)
    s_branch L_pwd
L_pw6:
    s_waitcnt vmcnt(4)
L_pwd:
    v_mfma_f32_16x16x32_bf16 v[120:123], v[96:99], v[104:107], 0
    v_mfma_f32_16x16x32_bf16 v[124:127], v[96:99], v[108:111], 0
    v_mfma_f32_16x16x32_bf16 v[128:131], v[96:99], v[112:115], 0
    v_mfma_f32_16x16x32_bf16 v[132:135], v[96:99], v[116:119], 0
    s_bitcmp1_b32 s47, 0
    s_cbranch_scc0 L_ao0
    v_mfma_f32_16x16x32_bf16 v[88:91], v[10:13], v[24:27], v[88:91]
    v_mfma_f32_16x16x32_bf16 v[92:95], v[8:11], v[24:27], v[92:95]
    v_mfma_f32_16x16x32_bf16 v[88:91], v[10:13], v[28:31], v[88:91]
    v_mfma_f32_16x16x32_bf16 v[92:95], v[8:11], v[28:31], v[92:95]
L_ao0:
    s_bitcmp1_b32 s47, 1
    s_cbranch_scc0 L_ao1
    v_mfma_f32_16x16x32_bf16 v[88:91], v[10:13], v[32:35], v[88:91]
    v_mfma_f32_16x16x32_bf16 v[92:95], v[8:11], v[32:35], v[92:95]
    v_mfma_f32_16x16x32_bf16 v[88:91], v[10:13], v[36:39], v[88:91]
    v_mfma_f32_16x16x32_bf16 v[92:95], v[8:11], v[36:39], v[92:95]
L_ao1:
    s_bitcmp1_b32 s47, 2
    s_cbranch_scc0 L_ao2
    v_mfma_f32_16x16x32_bf16 v[88:91], v[10:13], v[40:43], v[88:91]
    v_mfma_f32_16x16x32_bf16 v[92:95], v[8:11], v[40:43], v[92:95]
    v_mfma_f32_16x16x32_bf16 v[88:91], v[10:13], v[44:47], v[88:91]
    v_mfma_f32_16x16x32_bf16 v[92:95], v[8:11], v[44:47], v[92:95]
L_ao2:
    s_bitcmp1_b32 s47, 3
    s_cbranch_scc0 L_ao3
    v_mfma_f32_16x16x32_bf16 v[88:91], v[10:13], v[48:51], v[88:91]
    v_mfma_f32_16x16x32_bf16 v[92:95], v[8:11], v[48:51], v[92:95]
    v_mfma_f32_16x16x32_bf16 v[88:91], v[10:13], v[52:55], v[88:91]
    v_mfma_f32_16x16x32_bf16 v[92:95], v[8:11], v[52:55], v[92:95]
L_ao3:
    s_bitcmp1_b32 s47, 4
    s_cbranch_scc0 L_ao4
    v_mfma_f32_16x16x32_bf16 v[88:91], v[10:13], v[56:59], v[88:91]
    v_mfma_f32_16x16x32_bf16 v[92:95], v[8:11], v[56:59], v[92:95]
    v_mfma_f32_16x16x32_bf16 v[88:91], v[10:13], v[60:63], v[88:91]
    v_mfma_f32_16x16x32_bf16 v[92:95], v[8:11], v[60:63], v[92:95]
L_ao4:
    s_bitcmp1_b32 s47, 5
    s_cbranch_scc0 L_ao5
    v_mfma_f32_16x16x32_bf16 v[88:91], v[10:13], v[64:67], v[88:91]
    v_mfma_f32_16x16x32_bf16 v[92:95], v[8:11], v[64:67], v[92:95]
    v_mfma_f32_16x16x32_bf16 v[88:91], v[10:13], v[68:71], v[88:91]
    v_mfma_f32_16x16x32_bf16 v[92:95], v[8:11], v[68:71], v[92:95]
L_ao5:
    s_bitcmp1_b32 s47, 6
    s_cbranch_scc0 L_ao6
    v_mfma_f32_16x16x32_bf16 v[88:91], v[10:13], v[72:75], v[88:91]
    v_mfma_f32_16x16x32_bf16 v[92:95], v[8:11], v[72:75], v[92:95]
    v_mfma_f32_16x16x32_bf16 v[88:91], v[10:13], v[76:79], v[88:91]
    v_mfma_f32_16x16x32_bf16 v[92:95], v[8:11], v[76:79], v[92:95]
L_ao6:
    v_cvt_pk_bf16_f32 v136, v120, v121
    v_cvt_pk_bf16_f32 v137, v122, v123
    v_cvt_pk_bf16_f32 v140, v124, v125
    v_cvt_pk_bf16_f32 v141, v126, v127
    v_cvt_pk_bf16_f32 v144, v128, v129
    v_cvt_pk_bf16_f32 v145, v130, v131
    v_cvt_pk_bf16_f32 v148, v132, v133
    v_cvt_pk_bf16_f32 v149, v134, v135
    s_nop 0
    v_mfma_f32_16x16x32_bf16 v[152:155], v[200:203], v[136:139], v[168:171]
    v_mfma_f32_16x16x32_bf16 v[156:159], v[200:203], v[140:143], v[168:171]
    v_mfma_f32_16x16x32_bf16 v[160:163], v[200:203], v[144:147], v[168:171]
    v_mfma_f32_16x16x32_bf16 v[164:167], v[200:203], v[148:151], v[168:171]
    s_bitcmp1_b32 s46, 0
    s_cbranch_scc0 L_an0
    s_waitcnt vmcnt(14)
    v_mfma_f32_16x16x32_bf16 v[88:91], v[10:13], v[24:27], v[88:91]
    v_mfma_f32_16x16x32_bf16 v[92:95], v[8:11], v[24:27], v[92:95]
    v_mfma_f32_16x16x32_bf16 v[88:91], v[10:13], v[28:31], v[88:91]
    v_mfma_f32_16x16x32_bf16 v[92:95], v[8:11], v[28:31], v[92:95]
L_an0:
    s_bitcmp1_b32 s46, 1
    s_cbranch_scc0 L_an1
    s_waitcnt vmcnt(12)
    v_mfma_f32_16x16x32_bf16 v[88:91], v[10:13], v[32:35], v[88:91]
    v_mfma_f32_16x16x32_bf16 v[92:95], v[8:11], v[32:35], v[92:95]
    v_mfma_f32_16x16x32_bf16 v[88:91], v[10:13], v[36:39], v[88:91]
    v_mfma_f32_16x16x32_bf16 v[92:95], v[8:11], v[36:39], v[92:95]
L_an1:
    s_bitcmp1_b32 s46, 2
    s_cbranch_scc0 L_an2
    s_waitcnt vmcnt(10)
    v_mfma_f32_16x16x32_bf16 v[88:91], v[10:13], v[40:43], v[88:91]
    v_mfma_f32_16x16x32_bf16 v[92:95], v[8:11], v[40:43], v[92:95]
    v_mfma_f32_16x16x32_bf16 v[88:91], v[10:13], v[44:47], v[88:91]
    v_mfma_f32_16x16x32_bf16 v[92:95], v[8:11], v[44:47], v[92:95]
L_an2:
    s_bitcmp1_b32 s46, 3
    s_cbranch_scc0 L_an3
    s_waitcnt vmcnt(8)
    v_mfma_f32_16x16x32_bf16 v[88:91], v[10:13], v[48:51], v[88:91]
    v_mfma_f32_16x16x32_bf16 v[92:95], v[8:11], v[48:51], v[92:95]
    v_mfma_f32_16x16x32_bf16 v[88:91], v[10:13], v[52:55], v[88:91]
    v_mfma_f32_16x16x32_bf16 v[92:95], v[8:11], v[52:55], v[92:95]
L_an3:
    s_bitcmp1_b32 s46, 4
    s_cbranch_scc0 L_an4
    s_waitcnt vmcnt(6)
    v_mfma_f32_16x16x32_bf16 v[88:91], v[10:13], v[56:59], v[88:91]
    v_mfma_f32_16x16x32_bf16 v[92:95], v[8:11], v[56:59], v[92:95]
    v_mfma_f32_16x16x32_bf16 v[88:91], v[10:13], v[60:63], v[88:91]
    v_mfma_f32_16x16x32_bf16 v[92:95], v[8:11], v[60:63], v[92:95]
L_an4:
    s_bitcmp1_b32 s46, 5
    s_cbranch_scc0 L_an5
    s_waitcnt vmcnt(4)
    v_mfma_f32_16x16x32_bf16 v[88:91], v[10:13], v[64:67], v[88:91]
    v_mfma_f32_16x16x32_bf16 v[92:95], v[8:11], v[64:67], v[92:95]
    v_mfma_f32_16x16x32_bf16 v[88:91], v[10:13], v[68:71], v[88:91]
    v_mfma_f32_16x16x32_bf16 v[92:95], v[8:11], v[68:71], v[92:95]
L_an5:
    s_bitcmp1_b32 s46, 6
    s_cbranch_scc0 L_an6
    s_waitcnt vmcnt(2)
    v_mfma_f32_16x16x32_bf16 v[88:91], v[10:13], v[72:75], v[88:91]
    v_mfma_f32_16x16x32_bf16 v[92:95], v[8:11], v[72:75], v[92:95]
    v_mfma_f32_16x16x32_bf16 v[88:91], v[10:13], v[76:79], v[88:91]
    v_mfma_f32_16x16x32_bf16 v[92:95], v[8:11], v[76:79], v[92:95]
L_an6:
    s_bitcmp1_b32 s46, 7
    s_cbranch_scc0 L_an7
    s_waitcnt vmcnt(0)
    v_mfma_f32_16x16x32_bf16 v[88:91], v[10:13], v[80:83], v[88:91]
    v_mfma_f32_16x16x32_bf16 v[92:95], v[8:11], v[80:83], v[92:95]
    v_mfma_f32_16x16x32_bf16 v[88:91], v[10:13], v[84:87], v[88:91]
    v_mfma_f32_16x16x32_bf16 v[92:95], v[8:11], v[84:87], v[92:95]
L_an7:
    s_nop 3
    v_rcp_f32 v152, v152
    v_rcp_f32 v156, v156
    v_rcp_f32 v160, v160
    v_rcp_f32 v164, v164
    v_cvt_pk_bf16_f32 v172, v88, v89
    v_cvt_pk_bf16_f32 v173, v90, v91
    v_cvt_pk_bf16_f32 v174, v92, v93
    v_cvt_pk_bf16_f32 v175, v94, v95
    ds_write_b128 v6, v[172:175]
    ds_write_b32 v21, v232 offset:40
    ds_read_b32 v235, v18 offset:40
    ds_read_b128 v[176:179], v7
    v_mfma_f32_16x16x32_bf16 v[24:27], v[172:175], v[104:107], 0
    v_mfma_f32_16x16x32_bf16 v[28:31], v[172:175], v[108:111], 0
    v_mfma_f32_16x16x32_bf16 v[32:35], v[172:175], v[112:115], 0
    v_mfma_f32_16x16x32_bf16 v[36:39], v[172:175], v[116:119], 0
    s_mov_b32 s45, 0
    s_nop 3
    s_cmp_eq_u32 s40, 0
    v_mul_f32 v24, v24, v152
    v_mul_f32 v25, v25, v152
    v_mul_f32 v26, v26, v152
    v_mul_f32 v27, v27, v152
    v_mul_f32 v28, v28, v156
    v_mul_f32 v29, v29, v156
    v_mul_f32 v30, v30, v156
    v_mul_f32 v31, v31, v156
    v_mul_f32 v32, v32, v160
    v_mul_f32 v33, v33, v160
    v_mul_f32 v34, v34, v160
    v_mul_f32 v35, v35, v160
    v_mul_f32 v36, v36, v164
    v_mul_f32 v37, v37, v164
    v_mul_f32 v38, v38, v164
    v_mul_f32 v39, v39, v164
    s_cbranch_scc0 L_o1
    v_cvt_pk_bf16_f32 v56, v24, v25
    v_cvt_pk_bf16_f32 v57, v26, v27
    v_cvt_pk_bf16_f32 v60, v28, v29
    v_cvt_pk_bf16_f32 v61, v30, v31
    v_cvt_pk_bf16_f32 v64, v32, v33
    v_cvt_pk_bf16_f32 v65, v34, v35
    v_cvt_pk_bf16_f32 v68, v36, v37
    v_cvt_pk_bf16_f32 v69, v38, v39
    s_branch L_ks0g
L_ks0:
    ds_read_b32 v235, v18 offset:40
    ds_read_b128 v[176:179], v7
L_ks0g:
    s_add_u32 s45, s45, 1
    s_waitcnt lgkmcnt(0)
    v_readfirstlane_b32 s46, v235
    s_cmp_gt_u32 s45, 0x40000
    s_cbranch_scc1 L_kd0
    s_cmp_eq_u32 s46, 0
    s_cbranch_scc1 L_ks0
L_kd0:
    v_mfma_f32_16x16x32_bf16 v[40:43], v[176:179], v[104:107], 0
    v_mfma_f32_16x16x32_bf16 v[44:47], v[176:179], v[108:111], 0
    v_mfma_f32_16x16x32_bf16 v[48:51], v[176:179], v[112:115], 0
    v_mfma_f32_16x16x32_bf16 v[52:55], v[176:179], v[116:119], 0
    s_nop 4
    v_mul_f32 v40, v40, v152
    v_mul_f32 v41, v41, v152
    v_mul_f32 v42, v42, v152
    v_mul_f32 v43, v43, v152
    v_cvt_pk_bf16_f32 v58, v40, v41
    v_cvt_pk_bf16_f32 v59, v42, v43
    buffer_store_dwordx4 v[56:59], v5, s[60:63], s48 offen sc1
    s_add_u32 s48, s48, 0x8000
    v_mul_f32 v44, v44, v156
    v_mul_f32 v45, v45, v156
    v_mul_f32 v46, v46, v156
    v_mul_f32 v47, v47, v156
    v_cvt_pk_bf16_f32 v62, v44, v45
    v_cvt_pk_bf16_f32 v63, v46, v47
    buffer_store_dwordx4 v[60:63], v5, s[60:63], s48 offen sc1
    s_add_u32 s48, s48, 0x8000
    v_mul_f32 v48, v48, v160
    v_mul_f32 v49, v49, v160
    v_mul_f32 v50, v50, v160
    v_mul_f32 v51, v51, v160
    v_cvt_pk_bf16_f32 v66, v48, v49
    v_cvt_pk_bf16_f32 v67, v50, v51
    buffer_store_dwordx4 v[64:67], v5, s[60:63], s48 offen sc1
    s_add_u32 s48, s48, 0x8000
    v_mul_f32 v52, v52, v164
    v_mul_f32 v53, v53, v164
    v_mul_f32 v54, v54, v164
    v_mul_f32 v55, v55, v164
    v_cvt_pk_bf16_f32 v70, v52, v53
    v_cvt_pk_bf16_f32 v71, v54, v55
    buffer_store_dwordx4 v[68:71], v5, s[60:63], s48 offen sc1
    s_branch L_o2
L_o1:
    v_cvt_pk_bf16_f32 v58, v24, v25
    v_cvt_pk_bf16_f32 v59, v26, v27
    v_cvt_pk_bf16_f32 v62, v28, v29
    v_cvt_pk_bf16_f32 v63, v30, v31
    v_cvt_pk_bf16_f32 v66, v32, v33
    v_cvt_pk_bf16_f32 v67, v34, v35
    v_cvt_pk_bf16_f32 v70, v36, v37
    v_cvt_pk_bf16_f32 v71, v38, v39
    s_branch L_ks1g
L_ks1:
    ds_read_b32 v235, v18 offset:40
    ds_read_b128 v[176:179], v7
L_ks1g:
    s_add_u32 s45, s45, 1
    s_waitcnt lgkmcnt(0)
    v_readfirstlane_b32 s46, v235
    s_cmp_gt_u32 s45, 0x40000
    s_cbranch_scc1 L_kd1
    s_cmp_eq_u32 s46, 0
    s_cbranch_scc1 L_ks1
L_kd1:
    v_mfma_f32_16x16x32_bf16 v[40:43], v[176:179], v[104:107], 0
    v_mfma_f32_16x16x32_bf16 v[44:47], v[176:179], v[108:111], 0
    v_mfma_f32_16x16x32_bf16 v[48:51], v[176:179], v[112:115], 0
    v_mfma_f32_16x16x32_bf16 v[52:55], v[176:179], v[116:119], 0
    s_nop 4
    v_mul_f32 v40, v40, v152
    v_mul_f32 v41, v41, v152
    v_mul_f32 v42, v42, v152
    v_mul_f32 v43, v43, v152
    v_cvt_pk_bf16_f32 v56, v40, v41
    v_cvt_pk_bf16_f32 v57, v42, v43
    buffer_store_dwordx4 v[56:59], v5, s[60:63], s48 offen sc1
    s_add_u32 s48, s48, 0x8000
    v_mul_f32 v44, v44, v156
    v_mul_f32 v45, v45, v156
    v_mul_f32 v46, v46, v156
    v_mul_f32 v47, v47, v156
    v_cvt_pk_bf16_f32 v60, v44, v45
    v_cvt_pk_bf16_f32 v61, v46, v47
    buffer_store_dwordx4 v[60:63], v5, s[60:63], s48 offen sc1
    s_add_u32 s48, s48, 0x8000
    v_mul_f32 v48, v48, v160
    v_mul_f32 v49, v49, v160
    v_mul_f32 v50, v50, v160
    v_mul_f32 v51, v51, v160
    v_cvt_pk_bf16_f32 v64, v48, v49
    v_cvt_pk_bf16_f32 v65, v50, v51
    buffer_store_dwordx4 v[64:67], v5, s[60:63], s48 offen sc1
    s_add_u32 s48, s48, 0x8000
    v_mul_f32 v52, v52, v164
    v_mul_f32 v53, v53, v164
    v_mul_f32 v54, v54, v164
    v_mul_f32 v55, v55, v164
    v_cvt_pk_bf16_f32 v68, v52, v53
    v_cvt_pk_bf16_f32 v69, v54, v55
    buffer_store_dwordx4 v[68:71], v5, s[60:63], s48 offen sc1
L_o2:
    s_lshl_b32 s59, s34, 3
    s_lshl_b32 s45, s3, 1
    s_add_u32 s59, s59, s45
    s_lshl_b32 s45, s59, 15
    s_add_u32 s45, s45, 0x400000
    v_add_u32 v242, 0x8000, v5
    s_mov_b32 s51, 0x55555555
    s_add_u32 s64, s26, s45
    s_addc_u32 s65, s27, 0
    s_mov_b32 s66, 0x10000
    s_mov_b32 s67, 0x20000
    s_lshl_b32 s52, s34, 8
    s_lshl_b32 s46, s3, 6
    s_add_u32 s52, s52, s46
    s_lshr_b32 vcc_lo, s52, 6
    s_mul_i32 vcc_lo, vcc_lo, 1984
    s_add_u32 s52, s52, vcc_lo
    s_add_u32 s52, s52, 0x980000
    s_lshl_b32 vcc_lo, s35, 7
    s_add_u32 s52, s52, vcc_lo
    v_lshrrev_b32 v6, 2, v4
    v_lshlrev_b32 v6, 7, v6
    v_and_b32 v7, 3, v4
    v_lshl_add_u32 v6, v7, 3, v6
    v_bfe_u32 v7, v4, 3, 1
    v_lshl_add_u32 v6, v7, 6, v6
    v_lshl_add_u32 v236, v23, 5, v6
    v_xor_b32 v237, 32, v236
    v_xor_b32 v238, 64, v236
    v_xor_b32 v239, 0x60, v236
    s_lshl_b32 s57, s3, 11
    s_add_u32 s57, s57, 131584
    v_lshrrev_b32 v7, 5, v4
    v_lshl_add_u32 v6, v23, 1, v7
    v_and_b32 v7, 7, v4
    v_xor_b32 v6, v6, v7
    v_lshlrev_b32 v6, 4, v6
    v_and_b32 v3, 15, v4
    v_lshl_add_u32 v6, v3, 7, v6
    v_add_u32 v15, s57, v6
    v_xor_b32 v18, 64, v15
    v_lshrrev_b32 v6, 3, v4
    v_lshlrev_b32 v3, 4, v7
    v_lshl_add_u32 v17, v6, 12, v3
    v_xor_b32 v7, v7, v6
    v_lshlrev_b32 v7, 4, v7
    v_lshl_add_u32 v6, v6, 7, v7
    v_add_u32 v16, s57, v6
    s_mov_b32 s50, 0
    s_mov_b32 s53, 0
    s_mov_b32 s54, 0
    s_lshl_b32 s55, s40, 4
    s_and_b32 s42, s34, 3
    s_lshl_b32 s42, s42, 3
    v_mov_b64 v[120:121], 0
    v_mov_b64 v[122:123], 0
    v_mov_b64 v[124:125], 0
    v_mov_b64 v[126:127], 0
    v_mov_b64 v[128:129], 0
    v_mov_b64 v[130:131], 0
    v_mov_b64 v[132:133], 0
    v_mov_b64 v[134:135], 0
    v_mov_b64 v[136:137], 0
    v_mov_b64 v[138:139], 0
    s_load_dwordx16 s[4:19], s[26:27], s52 glc
    v_mov_b64 v[140:141], 0
    v_mov_b64 v[142:143], 0
    v_mov_b64 v[144:145], 0
    v_mov_b64 v[146:147], 0
    v_mov_b64 v[148:149], 0
    v_mov_b64 v[150:151], 0
    s_waitcnt vmcnt(0)
    s_mov_b64 exec, 0xffff
    buffer_store_dword v234, v254, s[60:63], s49 offen sc1
    s_mov_b64 exec, -1
    s_waitcnt lgkmcnt(0)
    s_mov_b32 s54, 0
    s_cmp_eq_u64 s[4:5], s[72:73]
    s_cselect_b32 s46, 0x1, 0
    s_or_b32 s54, s54, s46
    s_cmp_eq_u64 s[6:7], s[72:73]
    s_cselect_b32 s46, 0x4, 0
    s_or_b32 s54, s54, s46
    s_cmp_eq_u64 s[8:9], s[72:73]
    s_cselect_b32 s46, 0x10, 0
    s_or_b32 s54, s54, s46
    s_cmp_eq_u64 s[10:11], s[72:73]
    s_cselect_b32 s46, 0x40, 0
    s_or_b32 s54, s54, s46
    s_cmp_eq_u64 s[12:13], s[72:73]
    s_cselect_b32 s46, 0x100, 0
    s_or_b32 s54, s54, s46
    s_cmp_eq_u64 s[14:15], s[72:73]
    s_cselect_b32 s46, 0x400, 0
    s_or_b32 s54, s54, s46
    s_cmp_eq_u64 s[16:17], s[72:73]
    s_cselect_b32 s46, 0x1000, 0
    s_or_b32 s54, s54, s46
    s_cmp_eq_u64 s[18:19], s[72:73]
    s_cselect_b32 s46, 0x4000, 0
    s_or_b32 s54, s54, s46
    s_lshl_b32 s46, s54, s55
    s_mov_b32 s47, s46
    s_lshr_b64 s[46:47], s[46:47], s42
    v_mov_b32 v235, s46
    s_mov_b64 exec, 1
    ds_or_b32 v14, v235 offset:64
    s_mov_b64 exec, -1
    s_setprio 2
    s_cmp_lg_u32 s50, 0
    s_cbranch_scc1 L_sel0_ok
    s_mov_b32 s45, 0
    s_cmp_lg_u32 s51, 0
    s_cbranch_scc1 L_sel0
    s_mov_b32 s66, 0
    s_mov_b32 s50, 0x55555555
    s_branch L_sel0_ok
L_sel0:
    ds_read_b32 v235, v14 offset:64
    ds_read_b32 v13, v20 offset:60
    s_add_u32 s45, s45, 1
    s_waitcnt lgkmcnt(0)
    v_and_b32 v13, v13, v235
    s_cmp_gt_u32 s45, 0x40000
    s_cselect_b32 s46, -1, 0
    v_readfirstlane_b32 s50, v13
    s_nop 3
    s_or_b32 s50, s50, s46
    s_and_b32 s50, s50, s51
    s_cbranch_scc1 L_sel0_ok
    s_cmp_lg_u32 s54, 0x5555
    s_cbranch_scc1 L_sel0_p
    s_sleep 1
    s_branch L_sel0
L_sel0_p:
    s_load_dwordx16 s[4:19], s[26:27], s52 glc
    s_add_u32 s45, s45, 8
    s_waitcnt lgkmcnt(0)
    s_mov_b32 s54, 0
    s_cmp_eq_u64 s[4:5], s[72:73]
    s_cselect_b32 s46, 0x1, 0
    s_or_b32 s54, s54, s46
    s_cmp_eq_u64 s[6:7], s[72:73]
    s_cselect_b32 s46, 0x4, 0
    s_or_b32 s54, s54, s46
    s_cmp_eq_u64 s[8:9], s[72:73]
    s_cselect_b32 s46, 0x10, 0
    s_or_b32 s54, s54, s46
    s_cmp_eq_u64 s[10:11], s[72:73]
    s_cselect_b32 s46, 0x40, 0
    s_or_b32 s54, s54, s46
    s_cmp_eq_u64 s[12:13], s[72:73]
    s_cselect_b32 s46, 0x100, 0
    s_or_b32 s54, s54, s46
    s_cmp_eq_u64 s[14:15], s[72:73]
    s_cselect_b32 s46, 0x400, 0
    s_or_b32 s54, s54, s46
    s_cmp_eq_u64 s[16:17], s[72:73]
    s_cselect_b32 s46, 0x1000, 0
    s_or_b32 s54, s54, s46
    s_cmp_eq_u64 s[18:19], s[72:73]
    s_cselect_b32 s46, 0x4000, 0
    s_or_b32 s54, s54, s46
    s_lshl_b32 s46, s54, s55
    s_mov_b32 s47, s46
    s_lshr_b64 s[46:47], s[46:47], s42
    v_mov_b32 v235, s46
    s_mov_b64 exec, 1
    ds_or_b32 v14, v235 offset:64
    s_mov_b64 exec, -1
    s_branch L_sel0
L_sel0_ok:
    s_ff1_i32_b32 s46, s50
    s_bitset0_b32 s50, s46
    s_add_u32 s48, s46, s42
    s_and_b32 s48, s48, 31
    s_lshl_b32 s48, s48, 10
    s_bitset0_b32 s51, s46
    s_lshl_b32 s28, s46, 12
    buffer_load_dwordx4 v[24:27], v5, s[64:67], s48 offen offset:0 sc1
    buffer_load_dwordx4 v[28:31], v242, s[64:67], s48 offen offset:0 sc1
    buffer_load_dwordx4 v[32:35], v5, s[64:67], s48 offen offset:1024 sc1
    buffer_load_dwordx4 v[36:39], v242, s[64:67], s48 offen offset:1024 sc1
    s_cmp_lg_u32 s50, 0
    s_cbranch_scc1 L_sel1_ok
    s_mov_b32 s45, 0
    s_cmp_lg_u32 s51, 0
    s_cbranch_scc1 L_sel1
    s_mov_b32 s66, 0
    s_mov_b32 s50, 0x55555555
    s_branch L_sel1_ok
L_sel1:
    ds_read_b32 v235, v14 offset:64
    ds_read_b32 v13, v20 offset:60
    s_add_u32 s45, s45, 1
    s_waitcnt lgkmcnt(0)
    v_and_b32 v13, v13, v235
    s_cmp_gt_u32 s45, 0x40000
    s_cselect_b32 s46, -1, 0
    v_readfirstlane_b32 s50, v13
    s_nop 3
    s_or_b32 s50, s50, s46
    s_and_b32 s50, s50, s51
    s_cbranch_scc1 L_sel1_ok
    s_cmp_lg_u32 s54, 0x5555
    s_cbranch_scc1 L_sel1_p
    s_sleep 1
    s_branch L_sel1
L_sel1_p:
    s_load_dwordx16 s[4:19], s[26:27], s52 glc
    s_add_u32 s45, s45, 8
    s_waitcnt lgkmcnt(0)
    s_mov_b32 s54, 0
    s_cmp_eq_u64 s[4:5], s[72:73]
    s_cselect_b32 s46, 0x1, 0
    s_or_b32 s54, s54, s46
    s_cmp_eq_u64 s[6:7], s[72:73]
    s_cselect_b32 s46, 0x4, 0
    s_or_b32 s54, s54, s46
    s_cmp_eq_u64 s[8:9], s[72:73]
    s_cselect_b32 s46, 0x10, 0
    s_or_b32 s54, s54, s46
    s_cmp_eq_u64 s[10:11], s[72:73]
    s_cselect_b32 s46, 0x40, 0
    s_or_b32 s54, s54, s46
    s_cmp_eq_u64 s[12:13], s[72:73]
    s_cselect_b32 s46, 0x100, 0
    s_or_b32 s54, s54, s46
    s_cmp_eq_u64 s[14:15], s[72:73]
    s_cselect_b32 s46, 0x400, 0
    s_or_b32 s54, s54, s46
    s_cmp_eq_u64 s[16:17], s[72:73]
    s_cselect_b32 s46, 0x1000, 0
    s_or_b32 s54, s54, s46
    s_cmp_eq_u64 s[18:19], s[72:73]
    s_cselect_b32 s46, 0x4000, 0
    s_or_b32 s54, s54, s46
    s_lshl_b32 s46, s54, s55
    s_mov_b32 s47, s46
    s_lshr_b64 s[46:47], s[46:47], s42
    v_mov_b32 v235, s46
    s_mov_b64 exec, 1
    ds_or_b32 v14, v235 offset:64
    s_mov_b64 exec, -1
    s_branch L_sel1
L_sel1_ok:
    s_ff1_i32_b32 s46, s50
    s_bitset0_b32 s50, s46
    s_add_u32 s48, s46, s42
    s_and_b32 s48, s48, 31
    s_lshl_b32 s48, s48, 10
    s_bitset0_b32 s51, s46
    s_lshl_b32 s29, s46, 12
    buffer_load_dwordx4 v[40:43], v5, s[64:67], s48 offen offset:0 sc1
    buffer_load_dwordx4 v[44:47], v242, s[64:67], s48 offen offset:0 sc1
    buffer_load_dwordx4 v[48:51], v5, s[64:67], s48 offen offset:1024 sc1
    buffer_load_dwordx4 v[52:55], v242, s[64:67], s48 offen offset:1024 sc1
    s_cmp_lg_u32 s50, 0
    s_cbranch_scc1 L_sel2_ok
    s_mov_b32 s45, 0
    s_cmp_lg_u32 s51, 0
    s_cbranch_scc1 L_sel2
    s_mov_b32 s66, 0
    s_mov_b32 s50, 0x55555555
    s_branch L_sel2_ok
L_sel2:
    ds_read_b32 v235, v14 offset:64
    ds_read_b32 v13, v20 offset:60
    s_add_u32 s45, s45, 1
    s_waitcnt lgkmcnt(0)
    v_and_b32 v13, v13, v235
    s_cmp_gt_u32 s45, 0x40000
    s_cselect_b32 s46, -1, 0
    v_readfirstlane_b32 s50, v13
    s_nop 3
    s_or_b32 s50, s50, s46
    s_and_b32 s50, s50, s51
    s_cbranch_scc1 L_sel2_ok
    s_cmp_lg_u32 s54, 0x5555
    s_cbranch_scc1 L_sel2_p
    s_sleep 1
    s_branch L_sel2
L_sel2_p:
    s_load_dwordx16 s[4:19], s[26:27], s52 glc
    s_add_u32 s45, s45, 8
    s_waitcnt lgkmcnt(0)
    s_mov_b32 s54, 0
    s_cmp_eq_u64 s[4:5], s[72:73]
    s_cselect_b32 s46, 0x1, 0
    s_or_b32 s54, s54, s46
    s_cmp_eq_u64 s[6:7], s[72:73]
    s_cselect_b32 s46, 0x4, 0
    s_or_b32 s54, s54, s46
    s_cmp_eq_u64 s[8:9], s[72:73]
    s_cselect_b32 s46, 0x10, 0
    s_or_b32 s54, s54, s46
    s_cmp_eq_u64 s[10:11], s[72:73]
    s_cselect_b32 s46, 0x40, 0
    s_or_b32 s54, s54, s46
    s_cmp_eq_u64 s[12:13], s[72:73]
    s_cselect_b32 s46, 0x100, 0
    s_or_b32 s54, s54, s46
    s_cmp_eq_u64 s[14:15], s[72:73]
    s_cselect_b32 s46, 0x400, 0
    s_or_b32 s54, s54, s46
    s_cmp_eq_u64 s[16:17], s[72:73]
    s_cselect_b32 s46, 0x1000, 0
    s_or_b32 s54, s54, s46
    s_cmp_eq_u64 s[18:19], s[72:73]
    s_cselect_b32 s46, 0x4000, 0
    s_or_b32 s54, s54, s46
    s_lshl_b32 s46, s54, s55
    s_mov_b32 s47, s46
    s_lshr_b64 s[46:47], s[46:47], s42
    v_mov_b32 v235, s46
    s_mov_b64 exec, 1
    ds_or_b32 v14, v235 offset:64
    s_mov_b64 exec, -1
    s_branch L_sel2
L_sel2_ok:
    s_ff1_i32_b32 s46, s50
    s_bitset0_b32 s50, s46
    s_add_u32 s48, s46, s42
    s_and_b32 s48, s48, 31
    s_lshl_b32 s48, s48, 10
    s_bitset0_b32 s51, s46
    s_lshl_b32 s30, s46, 12
    buffer_load_dwordx4 v[56:59], v5, s[64:67], s48 offen offset:0 sc1
    buffer_load_dwordx4 v[60:63], v242, s[64:67], s48 offen offset:0 sc1
    buffer_load_dwordx4 v[64:67], v5, s[64:67], s48 offen offset:1024 sc1
    buffer_load_dwordx4 v[68:71], v242, s[64:67], s48 offen offset:1024 sc1
    v_add_u32 v8, s28, v236
    v_add_u32 v9, s28, v237
    v_add_u32 v10, s28, v238
    v_add_u32 v11, s28, v239
    ds_read_b64_tr_b16 v[88:89], v8 offset:0
    ds_read_b64_tr_b16 v[90:91], v8 offset:2048
    ds_read_b64_tr_b16 v[92:93], v9 offset:0
    ds_read_b64_tr_b16 v[94:95], v9 offset:2048
    ds_read_b64_tr_b16 v[96:97], v10 offset:0
    ds_read_b64_tr_b16 v[98:99], v10 offset:2048
    ds_read_b64_tr_b16 v[100:101], v11 offset:0
    ds_read_b64_tr_b16 v[102:103], v11 offset:2048
L_gloop:
    s_cmp_lg_u32 s50, 0
    s_cbranch_scc1 L_sel3_ok
    s_mov_b32 s45, 0
    s_cmp_lg_u32 s51, 0
    s_cbranch_scc1 L_sel3
    s_mov_b32 s66, 0
    s_mov_b32 s50, 0x55555555
    s_branch L_sel3_ok
L_sel3:
    ds_read_b32 v235, v14 offset:64
    ds_read_b32 v13, v20 offset:60
    s_add_u32 s45, s45, 1
    s_waitcnt lgkmcnt(0)
    v_and_b32 v13, v13, v235
    s_cmp_gt_u32 s45, 0x40000
    s_cselect_b32 s46, -1, 0
    v_readfirstlane_b32 s50, v13
    s_nop 3
    s_or_b32 s50, s50, s46
    s_and_b32 s50, s50, s51
    s_cbranch_scc1 L_sel3_ok
    s_cmp_lg_u32 s54, 0x5555
    s_cbranch_scc1 L_sel3_p
    s_sleep 1
    s_branch L_sel3
L_sel3_p:
    s_load_dwordx16 s[4:19], s[26:27], s52 glc
    s_add_u32 s45, s45, 8
    s_waitcnt lgkmcnt(0)
    s_mov_b32 s54, 0
    s_cmp_eq_u64 s[4:5], s[72:73]
    s_cselect_b32 s46, 0x1, 0
    s_or_b32 s54, s54, s46
    s_cmp_eq_u64 s[6:7], s[72:73]
    s_cselect_b32 s46, 0x4, 0
    s_or_b32 s54, s54, s46
    s_cmp_eq_u64 s[8:9], s[72:73]
    s_cselect_b32 s46, 0x10, 0
    s_or_b32 s54, s54, s46
    s_cmp_eq_u64 s[10:11], s[72:73]
    s_cselect_b32 s46, 0x40, 0
    s_or_b32 s54, s54, s46
    s_cmp_eq_u64 s[12:13], s[72:73]
    s_cselect_b32 s46, 0x100, 0
    s_or_b32 s54, s54, s46
    s_cmp_eq_u64 s[14:15], s[72:73]
    s_cselect_b32 s46, 0x400, 0
    s_or_b32 s54, s54, s46
    s_cmp_eq_u64 s[16:17], s[72:73]
    s_cselect_b32 s46, 0x1000, 0
    s_or_b32 s54, s54, s46
    s_cmp_eq_u64 s[18:19], s[72:73]
    s_cselect_b32 s46, 0x4000, 0
    s_or_b32 s54, s54, s46
    s_lshl_b32 s46, s54, s55
    s_mov_b32 s47, s46
    s_lshr_b64 s[46:47], s[46:47], s42
    v_mov_b32 v235, s46
    s_mov_b64 exec, 1
    ds_or_b32 v14, v235 offset:64
    s_mov_b64 exec, -1
    s_branch L_sel3
L_sel3_ok:
    s_waitcnt vmcnt(10) lgkmcnt(0)
    v_mfma_f32_16x16x32_bf16 v[120:123], v[88:91], v[24:27], v[120:123]
    ds_read_b64_tr_b16 v[104:105], v8 offset:4096
    ds_read_b64_tr_b16 v[106:107], v8 offset:6144
    v_mfma_f32_16x16x32_bf16 v[124:127], v[92:95], v[24:27], v[124:127]
    ds_read_b64_tr_b16 v[108:109], v9 offset:4096
    ds_read_b64_tr_b16 v[110:111], v9 offset:6144
    v_mfma_f32_16x16x32_bf16 v[128:131], v[96:99], v[24:27], v[128:131]
    ds_read_b64_tr_b16 v[112:113], v10 offset:4096
    ds_read_b64_tr_b16 v[114:115], v10 offset:6144
    v_mfma_f32_16x16x32_bf16 v[132:135], v[100:103], v[24:27], v[132:135]
    ds_read_b64_tr_b16 v[116:117], v11 offset:4096
    ds_read_b64_tr_b16 v[118:119], v11 offset:6144
    v_mfma_f32_16x16x32_bf16 v[136:139], v[88:91], v[28:31], v[136:139]
    v_add_u32 v244, s29, v236
    v_add_u32 v245, s29, v237
    v_mfma_f32_16x16x32_bf16 v[140:143], v[92:95], v[28:31], v[140:143]
    v_add_u32 v246, s29, v238
    v_add_u32 v247, s29, v239
    v_mfma_f32_16x16x32_bf16 v[144:147], v[96:99], v[28:31], v[144:147]
    s_ff1_i32_b32 s46, s50
    s_bitset0_b32 s50, s46
    s_add_u32 s48, s46, s42
    v_mfma_f32_16x16x32_bf16 v[148:151], v[100:103], v[28:31], v[148:151]
    s_and_b32 s48, s48, 31
    s_lshl_b32 s48, s48, 10
    s_bitset0_b32 s51, s46
    s_waitcnt vmcnt(8) lgkmcnt(0)
    v_mfma_f32_16x16x32_bf16 v[120:123], v[104:107], v[32:35], v[120:123]
    ds_read_b64_tr_b16 v[88:89], v244 offset:0
    ds_read_b64_tr_b16 v[90:91], v244 offset:2048
    v_mfma_f32_16x16x32_bf16 v[124:127], v[108:111], v[32:35], v[124:127]
    ds_read_b64_tr_b16 v[92:93], v245 offset:0
    ds_read_b64_tr_b16 v[94:95], v245 offset:2048
    v_mfma_f32_16x16x32_bf16 v[128:131], v[112:115], v[32:35], v[128:131]
    ds_read_b64_tr_b16 v[96:97], v246 offset:0
    ds_read_b64_tr_b16 v[98:99], v246 offset:2048
    v_mfma_f32_16x16x32_bf16 v[132:135], v[116:119], v[32:35], v[132:135]
    ds_read_b64_tr_b16 v[100:101], v247 offset:0
    ds_read_b64_tr_b16 v[102:103], v247 offset:2048
    v_mfma_f32_16x16x32_bf16 v[136:139], v[104:107], v[36:39], v[136:139]
    buffer_load_dwordx4 v[72:75], v5, s[64:67], s48 offen offset:0 sc1
    s_lshl_b32 s31, s46, 12
    v_mfma_f32_16x16x32_bf16 v[140:143], v[108:111], v[36:39], v[140:143]
    buffer_load_dwordx4 v[76:79], v242, s[64:67], s48 offen offset:0 sc1
    v_mfma_f32_16x16x32_bf16 v[144:147], v[112:115], v[36:39], v[144:147]
    buffer_load_dwordx4 v[80:83], v5, s[64:67], s48 offen offset:1024 sc1
    v_mfma_f32_16x16x32_bf16 v[148:151], v[116:119], v[36:39], v[148:151]
    buffer_load_dwordx4 v[84:87], v242, s[64:67], s48 offen offset:1024 sc1
    s_cmp_lg_u32 s50, 0
    s_cbranch_scc1 L_sel4_ok
    s_mov_b32 s45, 0
    s_cmp_lg_u32 s51, 0
    s_cbranch_scc1 L_sel4
    s_mov_b32 s66, 0
    s_mov_b32 s50, 0x55555555
    s_branch L_sel4_ok
L_sel4:
    ds_read_b32 v235, v14 offset:64
    ds_read_b32 v13, v20 offset:60
    s_add_u32 s45, s45, 1
    s_waitcnt lgkmcnt(0)
    v_and_b32 v13, v13, v235
    s_cmp_gt_u32 s45, 0x40000
    s_cselect_b32 s46, -1, 0
    v_readfirstlane_b32 s50, v13
    s_nop 3
    s_or_b32 s50, s50, s46
    s_and_b32 s50, s50, s51
    s_cbranch_scc1 L_sel4_ok
    s_cmp_lg_u32 s54, 0x5555
    s_cbranch_scc1 L_sel4_p
    s_sleep 1
    s_branch L_sel4
L_sel4_p:
    s_load_dwordx16 s[4:19], s[26:27], s52 glc
    s_add_u32 s45, s45, 8
    s_waitcnt lgkmcnt(0)
    s_mov_b32 s54, 0
    s_cmp_eq_u64 s[4:5], s[72:73]
    s_cselect_b32 s46, 0x1, 0
    s_or_b32 s54, s54, s46
    s_cmp_eq_u64 s[6:7], s[72:73]
    s_cselect_b32 s46, 0x4, 0
    s_or_b32 s54, s54, s46
    s_cmp_eq_u64 s[8:9], s[72:73]
    s_cselect_b32 s46, 0x10, 0
    s_or_b32 s54, s54, s46
    s_cmp_eq_u64 s[10:11], s[72:73]
    s_cselect_b32 s46, 0x40, 0
    s_or_b32 s54, s54, s46
    s_cmp_eq_u64 s[12:13], s[72:73]
    s_cselect_b32 s46, 0x100, 0
    s_or_b32 s54, s54, s46
    s_cmp_eq_u64 s[14:15], s[72:73]
    s_cselect_b32 s46, 0x400, 0
    s_or_b32 s54, s54, s46
    s_cmp_eq_u64 s[16:17], s[72:73]
    s_cselect_b32 s46, 0x1000, 0
    s_or_b32 s54, s54, s46
    s_cmp_eq_u64 s[18:19], s[72:73]
    s_cselect_b32 s46, 0x4000, 0
    s_or_b32 s54, s54, s46
    s_lshl_b32 s46, s54, s55
    s_mov_b32 s47, s46
    s_lshr_b64 s[46:47], s[46:47], s42
    v_mov_b32 v235, s46
    s_mov_b64 exec, 1
    ds_or_b32 v14, v235 offset:64
    s_mov_b64 exec, -1
    s_branch L_sel4
L_sel4_ok:
    s_waitcnt vmcnt(10) lgkmcnt(0)
    v_mfma_f32_16x16x32_bf16 v[120:123], v[88:91], v[40:43], v[120:123]
    ds_read_b64_tr_b16 v[104:105], v244 offset:4096
    ds_read_b64_tr_b16 v[106:107], v244 offset:6144
    v_mfma_f32_16x16x32_bf16 v[124:127], v[92:95], v[40:43], v[124:127]
    ds_read_b64_tr_b16 v[108:109], v245 offset:4096
    ds_read_b64_tr_b16 v[110:111], v245 offset:6144
    v_mfma_f32_16x16x32_bf16 v[128:131], v[96:99], v[40:43], v[128:131]
    ds_read_b64_tr_b16 v[112:113], v246 offset:4096
    ds_read_b64_tr_b16 v[114:115], v246 offset:6144
    v_mfma_f32_16x16x32_bf16 v[132:135], v[100:103], v[40:43], v[132:135]
    ds_read_b64_tr_b16 v[116:117], v247 offset:4096
    ds_read_b64_tr_b16 v[118:119], v247 offset:6144
    v_mfma_f32_16x16x32_bf16 v[136:139], v[88:91], v[44:47], v[136:139]
    v_add_u32 v8, s30, v236
    v_add_u32 v9, s30, v237
    v_mfma_f32_16x16x32_bf16 v[140:143], v[92:95], v[44:47], v[140:143]
    v_add_u32 v10, s30, v238
    v_add_u32 v11, s30, v239
    v_mfma_f32_16x16x32_bf16 v[144:147], v[96:99], v[44:47], v[144:147]
    s_ff1_i32_b32 s46, s50
    s_bitset0_b32 s50, s46
    s_add_u32 s48, s46, s42
    v_mfma_f32_16x16x32_bf16 v[148:151], v[100:103], v[44:47], v[148:151]
    s_and_b32 s48, s48, 31
    s_lshl_b32 s48, s48, 10
    s_bitset0_b32 s51, s46
    s_waitcnt vmcnt(8) lgkmcnt(0)
    v_mfma_f32_16x16x32_bf16 v[120:123], v[104:107], v[48:51], v[120:123]
    ds_read_b64_tr_b16 v[88:89], v8 offset:0
    ds_read_b64_tr_b16 v[90:91], v8 offset:2048
    v_mfma_f32_16x16x32_bf16 v[124:127], v[108:111], v[48:51], v[124:127]
    ds_read_b64_tr_b16 v[92:93], v9 offset:0
    ds_read_b64_tr_b16 v[94:95], v9 offset:2048
    v_mfma_f32_16x16x32_bf16 v[128:131], v[112:115], v[48:51], v[128:131]
    ds_read_b64_tr_b16 v[96:97], v10 offset:0
    ds_read_b64_tr_b16 v[98:99], v10 offset:2048
    v_mfma_f32_16x16x32_bf16 v[132:135], v[116:119], v[48:51], v[132:135]
    ds_read_b64_tr_b16 v[100:101], v11 offset:0
    ds_read_b64_tr_b16 v[102:103], v11 offset:2048
    v_mfma_f32_16x16x32_bf16 v[136:139], v[104:107], v[52:55], v[136:139]
    buffer_load_dwordx4 v[24:27], v5, s[64:67], s48 offen offset:0 sc1
    s_lshl_b32 s28, s46, 12
    v_mfma_f32_16x16x32_bf16 v[140:143], v[108:111], v[52:55], v[140:143]
    buffer_load_dwordx4 v[28:31], v242, s[64:67], s48 offen offset:0 sc1
    v_mfma_f32_16x16x32_bf16 v[144:147], v[112:115], v[52:55], v[144:147]
    buffer_load_dwordx4 v[32:35], v5, s[64:67], s48 offen offset:1024 sc1
    v_mfma_f32_16x16x32_bf16 v[148:151], v[116:119], v[52:55], v[148:151]
    buffer_load_dwordx4 v[36:39], v242, s[64:67], s48 offen offset:1024 sc1
    s_cmp_lg_u32 s50, 0
    s_cbranch_scc1 L_sel5_ok
    s_mov_b32 s45, 0
    s_cmp_lg_u32 s51, 0
    s_cbranch_scc1 L_sel5
    s_mov_b32 s66, 0
    s_mov_b32 s50, 0x55555555
    s_branch L_sel5_ok
L_sel5:
    ds_read_b32 v235, v14 offset:64
    ds_read_b32 v13, v20 offset:60
    s_add_u32 s45, s45, 1
    s_waitcnt lgkmcnt(0)
    v_and_b32 v13, v13, v235
    s_cmp_gt_u32 s45, 0x40000
    s_cselect_b32 s46, -1, 0
    v_readfirstlane_b32 s50, v13
    s_nop 3
    s_or_b32 s50, s50, s46
    s_and_b32 s50, s50, s51
    s_cbranch_scc1 L_sel5_ok
    s_cmp_lg_u32 s54, 0x5555
    s_cbranch_scc1 L_sel5_p
    s_sleep 1
    s_branch L_sel5
L_sel5_p:
    s_load_dwordx16 s[4:19], s[26:27], s52 glc
    s_add_u32 s45, s45, 8
    s_waitcnt lgkmcnt(0)
    s_mov_b32 s54, 0
    s_cmp_eq_u64 s[4:5], s[72:73]
    s_cselect_b32 s46, 0x1, 0
    s_or_b32 s54, s54, s46
    s_cmp_eq_u64 s[6:7], s[72:73]
    s_cselect_b32 s46, 0x4, 0
    s_or_b32 s54, s54, s46
    s_cmp_eq_u64 s[8:9], s[72:73]
    s_cselect_b32 s46, 0x10, 0
    s_or_b32 s54, s54, s46
    s_cmp_eq_u64 s[10:11], s[72:73]
    s_cselect_b32 s46, 0x40, 0
    s_or_b32 s54, s54, s46
    s_cmp_eq_u64 s[12:13], s[72:73]
    s_cselect_b32 s46, 0x100, 0
    s_or_b32 s54, s54, s46
    s_cmp_eq_u64 s[14:15], s[72:73]
    s_cselect_b32 s46, 0x400, 0
    s_or_b32 s54, s54, s46
    s_cmp_eq_u64 s[16:17], s[72:73]
    s_cselect_b32 s46, 0x1000, 0
    s_or_b32 s54, s54, s46
    s_cmp_eq_u64 s[18:19], s[72:73]
    s_cselect_b32 s46, 0x4000, 0
    s_or_b32 s54, s54, s46
    s_lshl_b32 s46, s54, s55
    s_mov_b32 s47, s46
    s_lshr_b64 s[46:47], s[46:47], s42
    v_mov_b32 v235, s46
    s_mov_b64 exec, 1
    ds_or_b32 v14, v235 offset:64
    s_mov_b64 exec, -1
    s_branch L_sel5
L_sel5_ok:
    s_waitcnt vmcnt(10) lgkmcnt(0)
    v_mfma_f32_16x16x32_bf16 v[120:123], v[88:91], v[56:59], v[120:123]
    ds_read_b64_tr_b16 v[104:105], v8 offset:4096
    ds_read_b64_tr_b16 v[106:107], v8 offset:6144
    v_mfma_f32_16x16x32_bf16 v[124:127], v[92:95], v[56:59], v[124:127]
    ds_read_b64_tr_b16 v[108:109], v9 offset:4096
    ds_read_b64_tr_b16 v[110:111], v9 offset:6144
    v_mfma_f32_16x16x32_bf16 v[128:131], v[96:99], v[56:59], v[128:131]
    ds_read_b64_tr_b16 v[112:113], v10 offset:4096
    ds_read_b64_tr_b16 v[114:115], v10 offset:6144
    v_mfma_f32_16x16x32_bf16 v[132:135], v[100:103], v[56:59], v[132:135]
    ds_read_b64_tr_b16 v[116:117], v11 offset:4096
    ds_read_b64_tr_b16 v[118:119], v11 offset:6144
    v_mfma_f32_16x16x32_bf16 v[136:139], v[88:91], v[60:63], v[136:139]
    v_add_u32 v244, s31, v236
    v_add_u32 v245, s31, v237
    v_mfma_f32_16x16x32_bf16 v[140:143], v[92:95], v[60:63], v[140:143]
    v_add_u32 v246, s31, v238
    v_add_u32 v247, s31, v239
    v_mfma_f32_16x16x32_bf16 v[144:147], v[96:99], v[60:63], v[144:147]
    s_ff1_i32_b32 s46, s50
    s_bitset0_b32 s50, s46
    s_add_u32 s48, s46, s42
    v_mfma_f32_16x16x32_bf16 v[148:151], v[100:103], v[60:63], v[148:151]
    s_and_b32 s48, s48, 31
    s_lshl_b32 s48, s48, 10
    s_bitset0_b32 s51, s46
    s_waitcnt vmcnt(8) lgkmcnt(0)
    v_mfma_f32_16x16x32_bf16 v[120:123], v[104:107], v[64:67], v[120:123]
    ds_read_b64_tr_b16 v[88:89], v244 offset:0
    ds_read_b64_tr_b16 v[90:91], v244 offset:2048
    v_mfma_f32_16x16x32_bf16 v[124:127], v[108:111], v[64:67], v[124:127]
    ds_read_b64_tr_b16 v[92:93], v245 offset:0
    ds_read_b64_tr_b16 v[94:95], v245 offset:2048
    v_mfma_f32_16x16x32_bf16 v[128:131], v[112:115], v[64:67], v[128:131]
    ds_read_b64_tr_b16 v[96:97], v246 offset:0
    ds_read_b64_tr_b16 v[98:99], v246 offset:2048
    v_mfma_f32_16x16x32_bf16 v[132:135], v[116:119], v[64:67], v[132:135]
    ds_read_b64_tr_b16 v[100:101], v247 offset:0
    ds_read_b64_tr_b16 v[102:103], v247 offset:2048
    v_mfma_f32_16x16x32_bf16 v[136:139], v[104:107], v[68:71], v[136:139]
    buffer_load_dwordx4 v[40:43], v5, s[64:67], s48 offen offset:0 sc1
    s_lshl_b32 s29, s46, 12
    v_mfma_f32_16x16x32_bf16 v[140:143], v[108:111], v[68:71], v[140:143]
    buffer_load_dwordx4 v[44:47], v242, s[64:67], s48 offen offset:0 sc1
    v_mfma_f32_16x16x32_bf16 v[144:147], v[112:115], v[68:71], v[144:147]
    buffer_load_dwordx4 v[48:51], v5, s[64:67], s48 offen offset:1024 sc1
    v_mfma_f32_16x16x32_bf16 v[148:151], v[116:119], v[68:71], v[148:151]
    buffer_load_dwordx4 v[52:55], v242, s[64:67], s48 offen offset:1024 sc1
    s_cmp_lg_u32 s50, 0
    s_cbranch_scc1 L_sel6_ok
    s_mov_b32 s45, 0
    s_cmp_lg_u32 s51, 0
    s_cbranch_scc1 L_sel6
    s_mov_b32 s66, 0
    s_mov_b32 s50, 0x55555555
    s_branch L_sel6_ok
L_sel6:
    ds_read_b32 v235, v14 offset:64
    ds_read_b32 v13, v20 offset:60
    s_add_u32 s45, s45, 1
    s_waitcnt lgkmcnt(0)
    v_and_b32 v13, v13, v235
    s_cmp_gt_u32 s45, 0x40000
    s_cselect_b32 s46, -1, 0
    v_readfirstlane_b32 s50, v13
    s_nop 3
    s_or_b32 s50, s50, s46
    s_and_b32 s50, s50, s51
    s_cbranch_scc1 L_sel6_ok
    s_cmp_lg_u32 s54, 0x5555
    s_cbranch_scc1 L_sel6_p
    s_sleep 1
    s_branch L_sel6
L_sel6_p:
    s_load_dwordx16 s[4:19], s[26:27], s52 glc
    s_add_u32 s45, s45, 8
    s_waitcnt lgkmcnt(0)
    s_mov_b32 s54, 0
    s_cmp_eq_u64 s[4:5], s[72:73]
    s_cselect_b32 s46, 0x1, 0
    s_or_b32 s54, s54, s46
    s_cmp_eq_u64 s[6:7], s[72:73]
    s_cselect_b32 s46, 0x4, 0
    s_or_b32 s54, s54, s46
    s_cmp_eq_u64 s[8:9], s[72:73]
    s_cselect_b32 s46, 0x10, 0
    s_or_b32 s54, s54, s46
    s_cmp_eq_u64 s[10:11], s[72:73]
    s_cselect_b32 s46, 0x40, 0
    s_or_b32 s54, s54, s46
    s_cmp_eq_u64 s[12:13], s[72:73]
    s_cselect_b32 s46, 0x100, 0
    s_or_b32 s54, s54, s46
    s_cmp_eq_u64 s[14:15], s[72:73]
    s_cselect_b32 s46, 0x400, 0
    s_or_b32 s54, s54, s46
    s_cmp_eq_u64 s[16:17], s[72:73]
    s_cselect_b32 s46, 0x1000, 0
    s_or_b32 s54, s54, s46
    s_cmp_eq_u64 s[18:19], s[72:73]
    s_cselect_b32 s46, 0x4000, 0
    s_or_b32 s54, s54, s46
    s_lshl_b32 s46, s54, s55
    s_mov_b32 s47, s46
    s_lshr_b64 s[46:47], s[46:47], s42
    v_mov_b32 v235, s46
    s_mov_b64 exec, 1
    ds_or_b32 v14, v235 offset:64
    s_mov_b64 exec, -1
    s_branch L_sel6
L_sel6_ok:
    s_waitcnt vmcnt(10) lgkmcnt(0)
    v_mfma_f32_16x16x32_bf16 v[120:123], v[88:91], v[72:75], v[120:123]
    ds_read_b64_tr_b16 v[104:105], v244 offset:4096
    ds_read_b64_tr_b16 v[106:107], v244 offset:6144
    v_mfma_f32_16x16x32_bf16 v[124:127], v[92:95], v[72:75], v[124:127]
    ds_read_b64_tr_b16 v[108:109], v245 offset:4096
    ds_read_b64_tr_b16 v[110:111], v245 offset:6144
    v_mfma_f32_16x16x32_bf16 v[128:131], v[96:99], v[72:75], v[128:131]
    ds_read_b64_tr_b16 v[112:113], v246 offset:4096
    ds_read_b64_tr_b16 v[114:115], v246 offset:6144
    v_mfma_f32_16x16x32_bf16 v[132:135], v[100:103], v[72:75], v[132:135]
    ds_read_b64_tr_b16 v[116:117], v247 offset:4096
    ds_read_b64_tr_b16 v[118:119], v247 offset:6144
    v_mfma_f32_16x16x32_bf16 v[136:139], v[88:91], v[76:79], v[136:139]
    v_add_u32 v8, s28, v236
    v_add_u32 v9, s28, v237
    v_mfma_f32_16x16x32_bf16 v[140:143], v[92:95], v[76:79], v[140:143]
    v_add_u32 v10, s28, v238
    v_add_u32 v11, s28, v239
    v_mfma_f32_16x16x32_bf16 v[144:147], v[96:99], v[76:79], v[144:147]
    s_ff1_i32_b32 s46, s50
    s_bitset0_b32 s50, s46
    s_add_u32 s48, s46, s42
    v_mfma_f32_16x16x32_bf16 v[148:151], v[100:103], v[76:79], v[148:151]
    s_and_b32 s48, s48, 31
    s_lshl_b32 s48, s48, 10
    s_bitset0_b32 s51, s46
    s_waitcnt vmcnt(8) lgkmcnt(0)
    v_mfma_f32_16x16x32_bf16 v[120:123], v[104:107], v[80:83], v[120:123]
    ds_read_b64_tr_b16 v[88:89], v8 offset:0
    ds_read_b64_tr_b16 v[90:91], v8 offset:2048
    v_mfma_f32_16x16x32_bf16 v[124:127], v[108:111], v[80:83], v[124:127]
    ds_read_b64_tr_b16 v[92:93], v9 offset:0
    ds_read_b64_tr_b16 v[94:95], v9 offset:2048
    v_mfma_f32_16x16x32_bf16 v[128:131], v[112:115], v[80:83], v[128:131]
    ds_read_b64_tr_b16 v[96:97], v10 offset:0
    ds_read_b64_tr_b16 v[98:99], v10 offset:2048
    v_mfma_f32_16x16x32_bf16 v[132:135], v[116:119], v[80:83], v[132:135]
    ds_read_b64_tr_b16 v[100:101], v11 offset:0
    ds_read_b64_tr_b16 v[102:103], v11 offset:2048
    v_mfma_f32_16x16x32_bf16 v[136:139], v[104:107], v[84:87], v[136:139]
    buffer_load_dwordx4 v[56:59], v5, s[64:67], s48 offen offset:0 sc1
    buffer_load_dwordx4 v[60:63], v242, s[64:67], s48 offen offset:0 sc1
    v_mfma_f32_16x16x32_bf16 v[140:143], v[108:111], v[84:87], v[140:143]
    s_lshl_b32 s30, s46, 12
    buffer_load_dwordx4 v[64:67], v5, s[64:67], s48 offen offset:1024 sc1
    v_mfma_f32_16x16x32_bf16 v[144:147], v[112:115], v[84:87], v[144:147]
    s_add_u32 s53, s53, 1
    buffer_load_dwordx4 v[68:71], v242, s[64:67], s48 offen offset:1024 sc1
    v_mfma_f32_16x16x32_bf16 v[148:151], v[116:119], v[84:87], v[148:151]
    s_cmp_lt_u32 s53, 4
    s_cbranch_scc1 L_gloop
    s_lshl_b32 s48, s59, 16
    s_lshl_b32 s49, s35, 7
    s_add_u32 s48, s48, s49
    s_add_u32 s49, s48, 0x8000
    s_add_u32 s50, s48, 0x10000
    s_add_u32 s51, s48, 0x18000
    s_waitcnt lgkmcnt(0)
    v_cvt_pk_bf16_f32 v172, v120, v121
    v_cvt_pk_bf16_f32 v173, v122, v123
    v_cvt_pk_bf16_f32 v174, v124, v125
    v_cvt_pk_bf16_f32 v175, v126, v127
    v_cvt_pk_bf16_f32 v176, v128, v129
    v_cvt_pk_bf16_f32 v177, v130, v131
    v_cvt_pk_bf16_f32 v178, v132, v133
    v_cvt_pk_bf16_f32 v179, v134, v135
    v_cvt_pk_bf16_f32 v180, v136, v137
    v_cvt_pk_bf16_f32 v181, v138, v139
    v_cvt_pk_bf16_f32 v182, v140, v141
    v_cvt_pk_bf16_f32 v183, v142, v143
    v_cvt_pk_bf16_f32 v184, v144, v145
    v_cvt_pk_bf16_f32 v185, v146, v147
    v_cvt_pk_bf16_f32 v186, v148, v149
    v_cvt_pk_bf16_f32 v187, v150, v151
    s_nop 1
    v_permlane16_swap_b32 v172, v174
    v_permlane16_swap_b32 v173, v175
    v_permlane16_swap_b32 v176, v178
    v_permlane16_swap_b32 v177, v179
    v_permlane16_swap_b32 v180, v182
    v_permlane16_swap_b32 v181, v183
    v_permlane16_swap_b32 v184, v186
    v_permlane16_swap_b32 v185, v187
    ds_write_b128 v15, v[172:175]
    ds_write_b128 v18, v[176:179]
    ds_read_b128 v[88:91], v16 offset:0
    ds_read_b128 v[92:95], v16 offset:1024
    ds_write_b128 v15, v[180:183]
    ds_write_b128 v18, v[184:187]
    ds_read_b128 v[96:99], v16 offset:0
    ds_read_b128 v[100:103], v16 offset:1024
    s_waitcnt lgkmcnt(5)
    buffer_store_dwordx4 v[88:91], v17, s[68:71], s48 offen sc1
    s_waitcnt lgkmcnt(4)
    buffer_store_dwordx4 v[92:95], v17, s[68:71], s49 offen sc1
    s_waitcnt lgkmcnt(1)
    buffer_store_dwordx4 v[96:99], v17, s[68:71], s50 offen sc1
    s_waitcnt lgkmcnt(0)
    buffer_store_dwordx4 v[100:103], v17, s[68:71], s51 offen sc1
    s_endpgm
L_exit:
    s_endpgm
L_code_end:
.section .rodata,"a"
.p2align 6
.amdhsa_kernel concat_heads__linear_attn_block__ssm_conv_h3__prompt_kernel
  .amdhsa_next_free_vgpr 256
  .amdhsa_next_free_sgpr 102
  .amdhsa_accum_offset 256
  .amdhsa_group_segment_fixed_size 0
  .amdhsa_kernarg_size 96
  .amdhsa_user_sgpr_count 2
  .amdhsa_user_sgpr_kernarg_segment_ptr 1
  .amdhsa_system_sgpr_workgroup_id_x 1
.end_amdhsa_kernel
```

```asm
; @launch grid=(256,1,1) block=(512,1,1) lds=163840
.amdgcn_target "amdgcn-amd-amdhsa--gfx950"
.text
.globl concat_heads__linear_attn_block__ssm_conv_h3__prompt_kernel
.type concat_heads__linear_attn_block__ssm_conv_h3__prompt_kernel,@function
.p2align 8
concat_heads__linear_attn_block__ssm_conv_h3__prompt_kernel:
    s_cmp_ge_u32 s2, 256
    s_cbranch_scc1 L_exit
    s_load_dwordx16 s[4:19], s[0:1], 0
    s_load_dwordx8 s[20:27], s[0:1], 64
    s_getpc_b64 s[48:49]
L_pc:
    s_and_b32 s45, s2, 24
    s_lshl_b32 s45, s45, 4
    v_lshl_add_u32 v2, v0, 9, s45
    v_cmp_gt_u32 vcc, L_code_end-L_pc-4, v2
    s_and_saveexec_b64 s[50:51], vcc
    s_cbranch_execz L_pf
    global_load_dword v252, v2, s[48:49]
L_pf:
    s_mov_b64 exec, s[50:51]
    v_lshrrev_b32 v1, 6, v0
    v_and_b32 v4, 63, v0
    v_readfirstlane_b32 s3, v1
    v_lshlrev_b32 v5, 4, v4
    s_and_b32 s28, s2, 7
    s_lshr_b32 s29, s2, 3
    s_and_b32 s30, s28, 1
    s_lshl_b32 s30, s30, 3
    s_and_b32 s40, s29, 7
    s_add_u32 s30, s30, s40
    s_lshr_b32 s40, s28, 1
    s_and_b32 s41, s28, 4
    s_and_b32 s42, s28, 2
    s_lshl2_add_u32 s41, s42, s41
    s_lshr_b32 s42, s29, 3
    s_add_u32 s32, s41, s42
    s_add_u32 s42, s42, 3
    s_and_b32 s42, s42, 3
    s_add_u32 s31, s41, s42
    s_and_b32 s41, s30, 1
    s_lshl_b32 s33, s41, 1
    s_and_b32 s41, s30, 2
    s_lshl_b32 s41, s41, 2
    s_add_u32 s33, s33, s41
    s_and_b32 s41, s28, 1
    s_lshl_b32 s41, s41, 2
    s_add_u32 s33, s33, s41
    s_and_b32 s41, s31, 1
    s_lshl_b32 s41, s41, 1
    s_add_u32 s33, s33, s41
    s_lshl_b32 s41, s40, 2
    s_add_u32 s33, s33, s41
    s_and_b32 s33, s33, 15
    s_cmp_lt_u32 s3, 4
    s_cbranch_scc1 L_comp
    s_sub_u32 s3, s3, 4
    v_lshrrev_b32 v1, 3, v4
    v_and_b32 v2, 7, v4
    v_lshrrev_b32 v3, 4, v4
    v_xor_b32 v6, v2, v3
    v_lshlrev_b32 v6, 4, v6
    v_lshl_add_u32 v6, v1, 11, v6
    s_lshl_b32 s60, s30, 7
    s_lshl_b32 s61, s3, 5
    s_add_u32 s60, s60, s61
    s_lshl_b32 s60, s60, 11
    v_add_u32 v8, s60, v6
    v_xor_b32 v6, 64, v8
    v_add_u32 v9, 15360, v6
    v_add_u32 v10, 30720, v8
    v_add_u32 v11, 46080, v6
    v_and_b32 v3, 1, v3
    v_lshlrev_b32 v3, 2, v3
    v_xor_b32 v7, v2, v3
    v_lshlrev_b32 v7, 4, v7
    v_xor_b32 v6, 32, v7
    s_movk_i32 s61, 6144
    v_mad_u32_u24 v7, v1, s61, v7
    v_mad_u32_u24 v6, v1, s61, v6
    s_mul_i32 s60, s3, 98304
    v_add_u32 v12, s60, v7
    s_add_u32 s60, s60, 48128
    v_add_u32 v13, s60, v6
    s_lshl_b32 s65, s3, 12
    s_lshl_b32 s66, s3, 11
    s_add_u32 s66, s66, 0x4000
    s_mov_b32 s64, 0
    s_mov_b32 s67, s33
    s_lshl_b32 s74, s32, 7
    s_lshl_b32 s75, s31, 7
    s_add_u32 s75, s75, 2048
    s_mov_b32 s42, 0x400000
    s_mov_b32 s43, 0x20000
    s_mov_b32 s46, 0x600000
    s_mov_b32 s47, 0x20000
    s_waitcnt lgkmcnt(0)
    s_mov_b64 s[40:41], s[4:5]
    s_mov_b64 s[44:45], s[6:7]
    s_add_u32 m0, s64, s65
    s_lshl_b32 s60, s67, 7
    s_mul_i32 s63, s67, 393216
    buffer_load_dwordx4 v8, s[40:43], s60 offen offset:0 lds
    buffer_load_dwordx4 v9, s[40:43], s60 offen offset:1024 lds
    buffer_load_dwordx4 v10, s[40:43], s60 offen offset:2048 lds
    buffer_load_dwordx4 v11, s[40:43], s60 offen offset:3072 lds
    s_add_u32 m0, s64, s66
    s_add_u32 s61, s63, s74
    s_add_u32 s62, s63, s75
    buffer_load_dwordx4 v12, s[44:47], s61 offen offset:0 lds
    buffer_load_dwordx4 v13, s[44:47], s61 offen offset:1024 lds
    s_add_u32 m0, m0, 8192
    s_add_u32 s63, s62, 2048
    buffer_load_dwordx4 v12, s[44:47], s62 offen offset:0 lds
    buffer_load_dwordx4 v13, s[44:47], s62 offen offset:1024 lds
    s_add_u32 m0, m0, 8192
    s_add_u32 s67, s67, 1
    buffer_load_dwordx4 v12, s[44:47], s63 offen offset:0 lds
    buffer_load_dwordx4 v13, s[44:47], s63 offen offset:1024 lds
    s_and_b32 s67, s67, 15
    s_add_u32 s64, s64, 40960
    s_cmp_eq_u32 s64, 122880
    s_cselect_b32 s64, 0, s64
    s_barrier
    s_and_b32 s34, s28, 3
    s_lshl_b32 s34, s34, 2
    s_and_b32 vcc_lo, s29, 3
    s_add_u32 s34, s34, vcc_lo
    s_lshr_b32 s35, s28, 2
    s_lshl_b32 s35, s35, 3
    s_lshr_b32 vcc_lo, s29, 2
    s_add_u32 s35, s35, vcc_lo
    s_and_b32 s36, s29, 15
    s_lshr_b32 s37, s29, 4
    s_lshl_b32 vcc_lo, s28, 1
    s_add_u32 s37, s37, vcc_lo
    s_lshl_b32 s38, s28, 5
    s_add_u32 s38, s38, s29
    s_lshl_b32 s38, s38, 2
    v_mov_b32 v6, 0
    v_mov_b32 v14, 1
    v_mov_b32 v15, 162816
    v_lshlrev_b32 v255, 7, v4
    s_nop 0
    s_mov_b32 s48, s26
    s_mov_b32 s49, s27
    s_mov_b32 s50, 0x2000000
    s_mov_b32 s51, 0x20000
    s_mov_b32 s52, s24
    s_mov_b32 s53, s25
    s_mov_b32 s54, 0x100
    s_mov_b32 s55, 0x20000
    s_or_b32 s60, s2, s3
    s_cmp_eq_u32 s60, 0
    s_cbranch_scc0 L_noep
    s_memrealtime s[60:61]
    s_waitcnt lgkmcnt(0)
    s_or_b32 s60, s60, 1
    v_mov_b32 v7, s60
    s_mov_b64 exec, 1
    buffer_store_dword v7, v6, s[52:55], 0 offen sc1
    s_mov_b64 exec, -1
L_noep:
    s_mul_i32 s68, s3, 4608
    s_add_u32 s68, s68, 139776
    s_lshl_b32 s69, s37, 7
    s_lshl_b32 s70, s3, 5
    s_add_u32 s69, s69, s70
    v_lshrrev_b32 v28, 4, v4
    v_bfe_u32 v29, v4, 2, 2
    v_and_b32 v30, 3, v4
    v_and_b32 v31, 15, v4
    s_lshl_b32 s60, s3, 12
    s_add_u32 s60, s60, 139776
    v_add_u32 v247, s60, v5
    s_and_b32 s60, s3, 1
    s_lshl_b32 s60, s60, 6
    v_xor_b32 v247, s60, v247
    v_xor_b32 v248, 16, v247
    v_xor_b32 v249, 32, v247
    v_xor_b32 v250, 48, v247
    v_lshlrev_b32 v3, 12, v28
    v_lshl_add_u32 v25, v31, 4, v3
    s_lshl_b32 s60, s36, 18
    s_lshl_b32 s61, s3, 16
    s_add_u32 s60, s60, s61
    s_lshl_b32 s61, s37, 8
    s_sub_u32 s60, s60, s61
    s_add_u32 s60, s60, 3840
    v_add_u32 v25, s60, v25
    v_lshlrev_b32 v26, 5, v4
    v_and_b32 v3, 1, v28
    v_lshlrev_b32 v3, 2, v3
    v_xor_b32 v3, v2, v3
    v_lshrrev_b32 v27, 5, v4
    v_lshlrev_b32 v27, 1, v27
    v_xor_b32 v3, v27, v3
    v_lshlrev_b32 v3, 4, v3
    v_lshl_add_u32 v3, v1, 11, v3
    s_lshl_b32 s60, s35, 7
    v_add_u32 v20, s60, v3
    v_add_u32 v21, 15360, v20
    v_add_u32 v22, 30720, v20
    v_add_u32 v23, 46080, v20
    s_mov_b32 s70, 0xffff0000
    v_and_b32 v3, 1, v28
    s_movk_i32 s60, 2304
    v_mul_u32_u24 v3, s60, v3
    v_lshl_add_u32 v3, v31, 4, v3
    v_add_u32 v251, s68, v3
    s_mul_i32 s71, s3, 8320
    s_add_u32 s71, s71, 98304
    v_add_u32 v19, s71, v5
    s_movk_i32 s61, 4160
    v_and_b32 v24, 1, v29
    v_mul_u32_u24 v24, s61, v24
    v_lshl_add_u32 v24, v30, 4, v24
    v_add_u32 v24, s71, v24
    v_add_u32 v3, 1, v31
    v_and_b32 v16, 1, v3
    v_add_u32 v17, v16, v31
    v_mul_u32_u24 v3, s61, v16
    v_lshl_add_u32 v3, v28, 5, v3
    v_lshlrev_b32 v17, 1, v17
    v_sub_u32 v3, v3, v17
    s_add_u32 s60, s71, 3486
    v_add_u32 v240, s60, v3
    v_subrev_u32 v241, 1024, v240
    v_subrev_u32 v242, 2048, v240
    v_subrev_u32 v243, 3072, v240
    v_add_u32 v3, v31, v28
    s_add_u32 s60, s68, 208
    v_lshlrev_b32 v3, 4, v3
    v_add_u32 v244, s60, v3
    v_lshlrev_b32 v3, 5, v31
    v_lshl_add_u32 v16, v28, 3, v3
    s_add_u32 s60, s71, 504
    v_sub_u32 v245, s60, v16
    v_and_b32 v16, 1, v28
    v_lshl_add_u32 v3, v16, 9, v3
    v_lshrrev_b32 v16, 5, v4
    v_lshl_add_u32 v246, v16, 4, v3
    v_lshlrev_b32 v27, 4, v2
    v_lshl_add_u32 v16, v1, 11, v27
    v_lshl_add_u32 v17, v1, 12, v27
    s_add_u32 s39, s38, s3
    s_and_b32 s60, s39, 0xfffffffe
    s_lshl_b32 s60, s60, 1
    s_load_dword s71, s[20:21], s60
    s_lshl_b32 s61, s39, 12
    v_mov_b64 v[160:161], 0
    v_mov_b64 v[162:163], 0
    v_mov_b64 v[164:165], 0
    v_mov_b64 v[166:167], 0
    v_mov_b64 v[168:169], 0
    v_mov_b64 v[170:171], 0
    v_mov_b64 v[172:173], 0
    v_mov_b64 v[174:175], 0
    v_mov_b64 v[176:177], 0
    v_mov_b64 v[178:179], 0
    v_mov_b64 v[180:181], 0
    v_mov_b64 v[182:183], 0
    v_mov_b64 v[184:185], 0
    v_mov_b64 v[186:187], 0
    v_mov_b64 v[188:189], 0
    v_mov_b64 v[190:191], 0
    s_add_u32 s52, s18, s61
    s_addc_u32 s53, s19, 0
    s_mov_b32 s54, 0x1000
    s_mov_b32 s55, 0x20000
    s_mov_b32 s56, s8
    s_mov_b32 s57, s9
    s_mov_b32 s58, 0x200000
    s_mov_b32 s59, 0x20000
    s_waitcnt lgkmcnt(0)
    s_mov_b32 s20, s10
    s_mov_b32 s21, s11
    s_waitcnt vmcnt(0)
    s_barrier
    s_add_u32 m0, s64, s65
    s_lshl_b32 s60, s67, 7
    s_mul_i32 s63, s67, 393216
    buffer_load_dwordx4 v8, s[40:43], s60 offen offset:0 lds
    buffer_load_dwordx4 v9, s[40:43], s60 offen offset:1024 lds
    buffer_load_dwordx4 v10, s[40:43], s60 offen offset:2048 lds
    buffer_load_dwordx4 v11, s[40:43], s60 offen offset:3072 lds
    s_add_u32 m0, s64, s66
    s_add_u32 s61, s63, s74
    s_add_u32 s62, s63, s75
    buffer_load_dwordx4 v12, s[44:47], s61 offen offset:0 lds
    buffer_load_dwordx4 v13, s[44:47], s61 offen offset:1024 lds
    s_add_u32 m0, m0, 8192
    s_add_u32 s63, s62, 2048
    buffer_load_dwordx4 v12, s[44:47], s62 offen offset:0 lds
    buffer_load_dwordx4 v13, s[44:47], s62 offen offset:1024 lds
    s_add_u32 m0, m0, 8192
    s_add_u32 s67, s67, 1
    buffer_load_dwordx4 v12, s[44:47], s63 offen offset:0 lds
    buffer_load_dwordx4 v13, s[44:47], s63 offen offset:1024 lds
    s_and_b32 s67, s67, 15
    s_add_u32 s64, s64, 40960
    s_cmp_eq_u32 s64, 122880
    s_cselect_b32 s64, 0, s64
    s_add_u32 m0, s64, s65
    s_lshl_b32 s60, s67, 7
    s_mul_i32 s63, s67, 393216
    buffer_load_dwordx4 v8, s[40:43], s60 offen offset:0 lds
    buffer_load_dwordx4 v9, s[40:43], s60 offen offset:1024 lds
    buffer_load_dwordx4 v10, s[40:43], s60 offen offset:2048 lds
    buffer_load_dwordx4 v11, s[40:43], s60 offen offset:3072 lds
    s_add_u32 m0, s64, s66
    s_add_u32 s61, s63, s74
    s_add_u32 s62, s63, s75
    buffer_load_dwordx4 v12, s[44:47], s61 offen offset:0 lds
    buffer_load_dwordx4 v13, s[44:47], s61 offen offset:1024 lds
    s_add_u32 m0, m0, 8192
    s_add_u32 s63, s62, 2048
    buffer_load_dwordx4 v12, s[44:47], s62 offen offset:0 lds
    buffer_load_dwordx4 v13, s[44:47], s62 offen offset:1024 lds
    s_add_u32 m0, m0, 8192
    s_add_u32 s67, s67, 1
    buffer_load_dwordx4 v12, s[44:47], s63 offen offset:0 lds
    buffer_load_dwordx4 v13, s[44:47], s63 offen offset:1024 lds
    s_and_b32 s67, s67, 15
    s_add_u32 s64, s64, 40960
    s_cmp_eq_u32 s64, 122880
    s_cselect_b32 s64, 0, s64
    s_waitcnt vmcnt(10)
    s_barrier
    s_add_u32 m0, s64, s65
    s_lshl_b32 s60, s67, 7
    s_mul_i32 s63, s67, 393216
    buffer_load_dwordx4 v8, s[40:43], s60 offen offset:0 lds
    buffer_load_dwordx4 v9, s[40:43], s60 offen offset:1024 lds
    buffer_load_dwordx4 v10, s[40:43], s60 offen offset:2048 lds
    buffer_load_dwordx4 v11, s[40:43], s60 offen offset:3072 lds
    s_add_u32 m0, s64, s66
    s_add_u32 s61, s63, s74
    s_add_u32 s62, s63, s75
    buffer_load_dwordx4 v12, s[44:47], s61 offen offset:0 lds
    buffer_load_dwordx4 v13, s[44:47], s61 offen offset:1024 lds
    s_add_u32 m0, m0, 8192
    s_add_u32 s63, s62, 2048
    buffer_load_dwordx4 v12, s[44:47], s62 offen offset:0 lds
    buffer_load_dwordx4 v13, s[44:47], s62 offen offset:1024 lds
    s_add_u32 m0, m0, 8192
    s_add_u32 s67, s67, 1
    buffer_load_dwordx4 v12, s[44:47], s63 offen offset:0 lds
    buffer_load_dwordx4 v13, s[44:47], s63 offen offset:1024 lds
    s_and_b32 s67, s67, 15
    s_add_u32 s64, s64, 40960
    s_cmp_eq_u32 s64, 122880
    s_cselect_b32 s64, 0, s64
    s_waitcnt vmcnt(10)
    s_barrier
    s_add_u32 m0, s64, s65
    s_lshl_b32 s60, s67, 7
    s_mul_i32 s63, s67, 393216
    buffer_load_dwordx4 v8, s[40:43], s60 offen offset:0 lds
    buffer_load_dwordx4 v9, s[40:43], s60 offen offset:1024 lds
    buffer_load_dwordx4 v10, s[40:43], s60 offen offset:2048 lds
    buffer_load_dwordx4 v11, s[40:43], s60 offen offset:3072 lds
    s_add_u32 m0, s64, s66
    s_add_u32 s61, s63, s74
    s_add_u32 s62, s63, s75
    buffer_load_dwordx4 v12, s[44:47], s61 offen offset:0 lds
    buffer_load_dwordx4 v13, s[44:47], s61 offen offset:1024 lds
    s_add_u32 m0, m0, 8192
    s_add_u32 s63, s62, 2048
    buffer_load_dwordx4 v12, s[44:47], s62 offen offset:0 lds
    buffer_load_dwordx4 v13, s[44:47], s62 offen offset:1024 lds
    s_add_u32 m0, m0, 8192
    s_add_u32 s67, s67, 1
    buffer_load_dwordx4 v12, s[44:47], s63 offen offset:0 lds
    buffer_load_dwordx4 v13, s[44:47], s63 offen offset:1024 lds
    s_and_b32 s67, s67, 15
    s_add_u32 s64, s64, 40960
    s_cmp_eq_u32 s64, 122880
    s_cselect_b32 s64, 0, s64
    s_load_dword s72, s[24:25], 0
    s_lshl_b32 s33, s39, 7
    s_add_u32 s33, s33, 0x940000
    s_lshl_b32 s39, s39, 12
    s_waitcnt vmcnt(10)
    s_barrier
    s_waitcnt lgkmcnt(0)
    s_mov_b32 s60, 0
L_eploop:
    s_cmp_lg_u32 s72, 0
    s_cbranch_scc1 L_epok
    s_sleep 8
    s_load_dword s72, s[24:25], 0 glc
    s_add_u32 s60, s60, 1
    s_cmp_gt_u32 s60, 0x4000
    s_waitcnt lgkmcnt(0)
    s_cbranch_scc0 L_eploop
L_epok:
    s_mov_b32 s73, s72
    v_mov_b32 v7, s72
    ds_write_b32 v15, v7 offset:56
    ds_write_b128 v251, v[160:163]
    s_add_u32 m0, s64, s65
    s_lshl_b32 s60, s67, 7
    s_mul_i32 s63, s67, 393216
    buffer_load_dwordx4 v8, s[40:43], s60 offen offset:0 lds
    buffer_load_dwordx4 v9, s[40:43], s60 offen offset:1024 lds
    buffer_load_dwordx4 v10, s[40:43], s60 offen offset:2048 lds
    buffer_load_dwordx4 v11, s[40:43], s60 offen offset:3072 lds
    s_add_u32 m0, s64, s66
    s_add_u32 s61, s63, s74
    s_add_u32 s62, s63, s75
    buffer_load_dwordx4 v12, s[44:47], s61 offen offset:0 lds
    buffer_load_dwordx4 v13, s[44:47], s61 offen offset:1024 lds
    s_add_u32 m0, m0, 8192
    s_add_u32 s63, s62, 2048
    buffer_load_dwordx4 v12, s[44:47], s62 offen offset:0 lds
    buffer_load_dwordx4 v13, s[44:47], s62 offen offset:1024 lds
    s_add_u32 m0, m0, 8192
    s_add_u32 s67, s67, 1
    buffer_load_dwordx4 v12, s[44:47], s63 offen offset:0 lds
    buffer_load_dwordx4 v13, s[44:47], s63 offen offset:1024 lds
    s_and_b32 s67, s67, 15
    s_add_u32 s64, s64, 40960
    s_cmp_eq_u32 s64, 122880
    s_cselect_b32 s64, 0, s64
    s_waitcnt vmcnt(10)
    s_barrier
    s_add_u32 m0, s64, s65
    s_lshl_b32 s60, s67, 7
    s_mul_i32 s63, s67, 393216
    buffer_load_dwordx4 v8, s[40:43], s60 offen offset:0 lds
    buffer_load_dwordx4 v9, s[40:43], s60 offen offset:1024 lds
    buffer_load_dwordx4 v10, s[40:43], s60 offen offset:2048 lds
    buffer_load_dwordx4 v11, s[40:43], s60 offen offset:3072 lds
    s_add_u32 m0, s64, s66
    s_add_u32 s61, s63, s74
    s_add_u32 s62, s63, s75
    buffer_load_dwordx4 v12, s[44:47], s61 offen offset:0 lds
    buffer_load_dwordx4 v13, s[44:47], s61 offen offset:1024 lds
    s_add_u32 m0, m0, 8192
    s_add_u32 s63, s62, 2048
    buffer_load_dwordx4 v12, s[44:47], s62 offen offset:0 lds
    buffer_load_dwordx4 v13, s[44:47], s62 offen offset:1024 lds
    s_add_u32 m0, m0, 8192
    s_add_u32 s67, s67, 1
    buffer_load_dwordx4 v12, s[44:47], s63 offen offset:0 lds
    buffer_load_dwordx4 v13, s[44:47], s63 offen offset:1024 lds
    s_and_b32 s67, s67, 15
    s_add_u32 s64, s64, 40960
    s_cmp_eq_u32 s64, 122880
    s_cselect_b32 s64, 0, s64
    s_waitcnt vmcnt(10)
    s_barrier
    s_add_u32 m0, s64, s65
    s_lshl_b32 s60, s67, 7
    s_mul_i32 s63, s67, 393216
    buffer_load_dwordx4 v8, s[40:43], s60 offen offset:0 lds
    buffer_load_dwordx4 v9, s[40:43], s60 offen offset:1024 lds
    buffer_load_dwordx4 v10, s[40:43], s60 offen offset:2048 lds
    buffer_load_dwordx4 v11, s[40:43], s60 offen offset:3072 lds
    s_add_u32 m0, s64, s66
    s_add_u32 s61, s63, s74
    s_add_u32 s62, s63, s75
    buffer_load_dwordx4 v12, s[44:47], s61 offen offset:0 lds
    buffer_load_dwordx4 v13, s[44:47], s61 offen offset:1024 lds
    s_add_u32 m0, m0, 8192
    s_add_u32 s63, s62, 2048
    buffer_load_dwordx4 v12, s[44:47], s62 offen offset:0 lds
    buffer_load_dwordx4 v13, s[44:47], s62 offen offset:1024 lds
    s_add_u32 m0, m0, 8192
    s_add_u32 s67, s67, 1
    buffer_load_dwordx4 v12, s[44:47], s63 offen offset:0 lds
    buffer_load_dwordx4 v13, s[44:47], s63 offen offset:1024 lds
    s_and_b32 s67, s67, 15
    s_add_u32 s64, s64, 40960
    s_cmp_eq_u32 s64, 122880
    s_cselect_b32 s64, 0, s64
    s_waitcnt vmcnt(10)
    s_barrier
    s_add_u32 m0, s64, s65
    s_lshl_b32 s60, s67, 7
    s_mul_i32 s63, s67, 393216
    buffer_load_dwordx4 v8, s[40:43], s60 offen offset:0 lds
    buffer_load_dwordx4 v9, s[40:43], s60 offen offset:1024 lds
    buffer_load_dwordx4 v10, s[40:43], s60 offen offset:2048 lds
    buffer_load_dwordx4 v11, s[40:43], s60 offen offset:3072 lds
    s_add_u32 m0, s64, s66
    s_add_u32 s61, s63, s74
    s_add_u32 s62, s63, s75
    buffer_load_dwordx4 v12, s[44:47], s61 offen offset:0 lds
    buffer_load_dwordx4 v13, s[44:47], s61 offen offset:1024 lds
    s_add_u32 m0, m0, 8192
    s_add_u32 s63, s62, 2048
    buffer_load_dwordx4 v12, s[44:47], s62 offen offset:0 lds
    buffer_load_dwordx4 v13, s[44:47], s62 offen offset:1024 lds
    s_add_u32 m0, m0, 8192
    s_add_u32 s67, s67, 1
    buffer_load_dwordx4 v12, s[44:47], s63 offen offset:0 lds
    buffer_load_dwordx4 v13, s[44:47], s63 offen offset:1024 lds
    s_and_b32 s67, s67, 15
    s_add_u32 s64, s64, 40960
    s_cmp_eq_u32 s64, 122880
    s_cselect_b32 s64, 0, s64
    s_waitcnt vmcnt(10)
    s_barrier
    s_add_u32 m0, s64, s65
    s_lshl_b32 s60, s67, 7
    s_mul_i32 s63, s67, 393216
    buffer_load_dwordx4 v8, s[40:43], s60 offen offset:0 lds
    buffer_load_dwordx4 v9, s[40:43], s60 offen offset:1024 lds
    buffer_load_dwordx4 v10, s[40:43], s60 offen offset:2048 lds
    buffer_load_dwordx4 v11, s[40:43], s60 offen offset:3072 lds
    s_add_u32 m0, s64, s66
    s_add_u32 s61, s63, s74
    s_add_u32 s62, s63, s75
    buffer_load_dwordx4 v12, s[44:47], s61 offen offset:0 lds
    buffer_load_dwordx4 v13, s[44:47], s61 offen offset:1024 lds
    s_add_u32 m0, m0, 8192
    s_add_u32 s63, s62, 2048
    buffer_load_dwordx4 v12, s[44:47], s62 offen offset:0 lds
    buffer_load_dwordx4 v13, s[44:47], s62 offen offset:1024 lds
    s_add_u32 m0, m0, 8192
    s_add_u32 s67, s67, 1
    buffer_load_dwordx4 v12, s[44:47], s63 offen offset:0 lds
    buffer_load_dwordx4 v13, s[44:47], s63 offen offset:1024 lds
    s_and_b32 s67, s67, 15
    s_add_u32 s64, s64, 40960
    s_cmp_eq_u32 s64, 122880
    s_cselect_b32 s64, 0, s64
    s_waitcnt vmcnt(10)
    s_barrier
    s_add_u32 m0, s64, s65
    s_lshl_b32 s60, s67, 7
    s_mul_i32 s63, s67, 393216
    buffer_load_dwordx4 v8, s[40:43], s60 offen offset:0 lds
    buffer_load_dwordx4 v9, s[40:43], s60 offen offset:1024 lds
    buffer_load_dwordx4 v10, s[40:43], s60 offen offset:2048 lds
    buffer_load_dwordx4 v11, s[40:43], s60 offen offset:3072 lds
    s_add_u32 m0, s64, s66
    s_add_u32 s61, s63, s74
    s_add_u32 s62, s63, s75
    buffer_load_dwordx4 v12, s[44:47], s61 offen offset:0 lds
    buffer_load_dwordx4 v13, s[44:47], s61 offen offset:1024 lds
    s_add_u32 m0, m0, 8192
    s_add_u32 s63, s62, 2048
    buffer_load_dwordx4 v12, s[44:47], s62 offen offset:0 lds
    buffer_load_dwordx4 v13, s[44:47], s62 offen offset:1024 lds
    s_add_u32 m0, m0, 8192
    s_add_u32 s67, s67, 1
    buffer_load_dwordx4 v12, s[44:47], s63 offen offset:0 lds
    buffer_load_dwordx4 v13, s[44:47], s63 offen offset:1024 lds
    s_and_b32 s67, s67, 15
    s_add_u32 s64, s64, 40960
    s_cmp_eq_u32 s64, 122880
    s_cselect_b32 s64, 0, s64
    s_waitcnt vmcnt(10)
    s_barrier
    s_add_u32 m0, s64, s65
    s_lshl_b32 s60, s67, 7
    s_mul_i32 s63, s67, 393216
    buffer_load_dwordx4 v8, s[40:43], s60 offen offset:0 lds
    buffer_load_dwordx4 v9, s[40:43], s60 offen offset:1024 lds
    buffer_load_dwordx4 v10, s[40:43], s60 offen offset:2048 lds
    buffer_load_dwordx4 v11, s[40:43], s60 offen offset:3072 lds
    s_add_u32 m0, s64, s66
    s_add_u32 s61, s63, s74
    s_add_u32 s62, s63, s75
    buffer_load_dwordx4 v12, s[44:47], s61 offen offset:0 lds
    buffer_load_dwordx4 v13, s[44:47], s61 offen offset:1024 lds
    s_add_u32 m0, m0, 8192
    s_add_u32 s63, s62, 2048
    buffer_load_dwordx4 v12, s[44:47], s62 offen offset:0 lds
    buffer_load_dwordx4 v13, s[44:47], s62 offen offset:1024 lds
    s_add_u32 m0, m0, 8192
    s_add_u32 s67, s67, 1
    buffer_load_dwordx4 v12, s[44:47], s63 offen offset:0 lds
    buffer_load_dwordx4 v13, s[44:47], s63 offen offset:1024 lds
    s_and_b32 s67, s67, 15
    s_add_u32 s64, s64, 40960
    s_cmp_eq_u32 s64, 122880
    s_cselect_b32 s64, 0, s64
    s_waitcnt vmcnt(10)
    s_barrier
    s_add_u32 m0, s64, s65
    s_lshl_b32 s60, s67, 7
    s_mul_i32 s63, s67, 393216
    buffer_load_dwordx4 v8, s[40:43], s60 offen offset:0 lds
    buffer_load_dwordx4 v9, s[40:43], s60 offen offset:1024 lds
    buffer_load_dwordx4 v10, s[40:43], s60 offen offset:2048 lds
    buffer_load_dwordx4 v11, s[40:43], s60 offen offset:3072 lds
    s_add_u32 m0, s64, s66
    s_add_u32 s61, s63, s74
    s_add_u32 s62, s63, s75
    buffer_load_dwordx4 v12, s[44:47], s61 offen offset:0 lds
    buffer_load_dwordx4 v13, s[44:47], s61 offen offset:1024 lds
    s_add_u32 m0, m0, 8192
    s_add_u32 s63, s62, 2048
    buffer_load_dwordx4 v12, s[44:47], s62 offen offset:0 lds
    buffer_load_dwordx4 v13, s[44:47], s62 offen offset:1024 lds
    s_add_u32 m0, m0, 8192
    s_add_u32 s67, s67, 1
    buffer_load_dwordx4 v12, s[44:47], s63 offen offset:0 lds
    buffer_load_dwordx4 v13, s[44:47], s63 offen offset:1024 lds
    s_and_b32 s67, s67, 15
    s_add_u32 s64, s64, 40960
    s_cmp_eq_u32 s64, 122880
    s_cselect_b32 s64, 0, s64
    s_waitcnt vmcnt(10)
    s_barrier
    s_add_u32 m0, s64, s65
    s_lshl_b32 s60, s67, 7
    s_mul_i32 s63, s67, 393216
    buffer_load_dwordx4 v8, s[40:43], s60 offen offset:0 lds
    buffer_load_dwordx4 v9, s[40:43], s60 offen offset:1024 lds
    buffer_load_dwordx4 v10, s[40:43], s60 offen offset:2048 lds
    buffer_load_dwordx4 v11, s[40:43], s60 offen offset:3072 lds
    s_add_u32 m0, s64, s66
    s_add_u32 s61, s63, s74
    s_add_u32 s62, s63, s75
    buffer_load_dwordx4 v12, s[44:47], s61 offen offset:0 lds
    buffer_load_dwordx4 v13, s[44:47], s61 offen offset:1024 lds
    s_add_u32 m0, m0, 8192
    s_add_u32 s63, s62, 2048
    buffer_load_dwordx4 v12, s[44:47], s62 offen offset:0 lds
    buffer_load_dwordx4 v13, s[44:47], s62 offen offset:1024 lds
    s_add_u32 m0, m0, 8192
    s_add_u32 s67, s67, 1
    buffer_load_dwordx4 v12, s[44:47], s63 offen offset:0 lds
    buffer_load_dwordx4 v13, s[44:47], s63 offen offset:1024 lds
    s_and_b32 s67, s67, 15
    s_add_u32 s64, s64, 40960
    s_cmp_eq_u32 s64, 122880
    s_cselect_b32 s64, 0, s64
    s_waitcnt vmcnt(10)
    s_barrier
    s_add_u32 m0, s64, s65
    s_lshl_b32 s60, s67, 7
    s_mul_i32 s63, s67, 393216
    buffer_load_dwordx4 v8, s[40:43], s60 offen offset:0 lds
    buffer_load_dwordx4 v9, s[40:43], s60 offen offset:1024 lds
    buffer_load_dwordx4 v10, s[40:43], s60 offen offset:2048 lds
    buffer_load_dwordx4 v11, s[40:43], s60 offen offset:3072 lds
    s_add_u32 m0, s64, s66
    s_add_u32 s61, s63, s74
    s_add_u32 s62, s63, s75
    buffer_load_dwordx4 v12, s[44:47], s61 offen offset:0 lds
    buffer_load_dwordx4 v13, s[44:47], s61 offen offset:1024 lds
    s_add_u32 m0, m0, 8192
    s_add_u32 s63, s62, 2048
    buffer_load_dwordx4 v12, s[44:47], s62 offen offset:0 lds
    buffer_load_dwordx4 v13, s[44:47], s62 offen offset:1024 lds
    s_add_u32 m0, m0, 8192
    s_add_u32 s67, s67, 1
    buffer_load_dwordx4 v12, s[44:47], s63 offen offset:0 lds
    buffer_load_dwordx4 v13, s[44:47], s63 offen offset:1024 lds
    s_and_b32 s67, s67, 15
    s_add_u32 s64, s64, 40960
    s_cmp_eq_u32 s64, 122880
    s_cselect_b32 s64, 0, s64
    s_waitcnt vmcnt(10)
    s_barrier
    s_add_u32 m0, s64, s65
    s_lshl_b32 s60, s67, 7
    s_mul_i32 s63, s67, 393216
    buffer_load_dwordx4 v8, s[40:43], s60 offen offset:0 lds
    buffer_load_dwordx4 v9, s[40:43], s60 offen offset:1024 lds
    buffer_load_dwordx4 v10, s[40:43], s60 offen offset:2048 lds
    buffer_load_dwordx4 v11, s[40:43], s60 offen offset:3072 lds
    s_add_u32 m0, s64, s66
    s_add_u32 s61, s63, s74
    s_add_u32 s62, s63, s75
    buffer_load_dwordx4 v12, s[44:47], s61 offen offset:0 lds
    buffer_load_dwordx4 v13, s[44:47], s61 offen offset:1024 lds
    s_add_u32 m0, m0, 8192
    s_add_u32 s63, s62, 2048
    buffer_load_dwordx4 v12, s[44:47], s62 offen offset:0 lds
    buffer_load_dwordx4 v13, s[44:47], s62 offen offset:1024 lds
    s_add_u32 m0, m0, 8192
    s_add_u32 s67, s67, 1
    buffer_load_dwordx4 v12, s[44:47], s63 offen offset:0 lds
    buffer_load_dwordx4 v13, s[44:47], s63 offen offset:1024 lds
    s_and_b32 s67, s67, 15
    s_add_u32 s64, s64, 40960
    s_cmp_eq_u32 s64, 122880
    s_cselect_b32 s64, 0, s64
    s_load_dwordx16 s[4:19], s[26:27], s33 glc
    s_mov_b32 s40, s20
    s_mov_b32 s41, s21
    s_mov_b32 s42, 0x400000
    s_mov_b32 s43, 0x20000
    s_mov_b32 s44, s22
    s_mov_b32 s45, s23
    s_mov_b32 s46, 0x800000
    s_mov_b32 s47, 0x20000
    s_and_b32 s28, s34, 3
    s_lshl_b32 s74, s28, 2
    s_lshl_b32 s28, s28, 3
    s_add_u32 s65, s3, 5
    s_add_u32 s75, s3, 9
    s_cmp_eq_u32 s3, 3
    s_cselect_b32 s75, 4, s75
    s_add_u32 s31, s3, 12
    s_waitcnt vmcnt(10)
    s_barrier
    s_waitcnt lgkmcnt(0)
    s_cmp_eq_u64 s[4:5], s[72:73]
    s_cbranch_scc0 L_us
    s_cmp_eq_u64 s[6:7], s[72:73]
    s_cbranch_scc0 L_us
    s_cmp_eq_u64 s[8:9], s[72:73]
    s_cbranch_scc0 L_us
    s_cmp_eq_u64 s[10:11], s[72:73]
    s_cbranch_scc0 L_us
    s_cmp_eq_u64 s[12:13], s[72:73]
    s_cbranch_scc0 L_us
    s_cmp_eq_u64 s[14:15], s[72:73]
    s_cbranch_scc0 L_us
    s_cmp_eq_u64 s[16:17], s[72:73]
    s_cbranch_scc0 L_us
    s_cmp_eq_u64 s[18:19], s[72:73]
    s_cbranch_scc0 L_us
    s_branch L_upoll_done
L_us:
    s_mov_b32 s60, 0
    s_branch L_upoll_go
L_upoll:
    s_sleep 0
L_upoll_go:
    s_load_dwordx16 s[4:19], s[26:27], s33 glc
    s_add_u32 s60, s60, 1
    s_cmp_gt_u32 s60, 0x8000
    s_cbranch_scc1 L_upoll_done
    s_waitcnt lgkmcnt(0)
    s_cmp_eq_u64 s[4:5], s[72:73]
    s_cbranch_scc0 L_upoll
    s_cmp_eq_u64 s[6:7], s[72:73]
    s_cbranch_scc0 L_upoll
    s_cmp_eq_u64 s[8:9], s[72:73]
    s_cbranch_scc0 L_upoll
    s_cmp_eq_u64 s[10:11], s[72:73]
    s_cbranch_scc0 L_upoll
    s_cmp_eq_u64 s[12:13], s[72:73]
    s_cbranch_scc0 L_upoll
    s_cmp_eq_u64 s[14:15], s[72:73]
    s_cbranch_scc0 L_upoll
    s_cmp_eq_u64 s[16:17], s[72:73]
    s_cbranch_scc0 L_upoll
    s_cmp_eq_u64 s[18:19], s[72:73]
    s_cbranch_scc0 L_upoll
L_upoll_done:
    s_waitcnt lgkmcnt(0)
    buffer_load_dwordx4 v[32:35], v5, s[48:51], s39 offen offset:0 sc1
    buffer_load_dwordx4 v[36:39], v5, s[48:51], s39 offen offset:1024 sc1
    buffer_load_dwordx4 v[40:43], v5, s[48:51], s39 offen offset:2048 sc1
    buffer_load_dwordx4 v[44:47], v5, s[48:51], s39 offen offset:3072 sc1
    s_add_u32 m0, s68, 256
    s_nop 0
    buffer_load_dwordx4 v26, s[52:55], 0 offen  lds
    s_add_u32 m0, s68, 256
    s_movk_i32 s60, 1024
    s_nop 0
    buffer_load_dwordx4 v26, s[52:55], s60 offen offset:1024  lds
    s_add_u32 m0, s68, 2560
    s_nop 0
    buffer_load_dwordx4 v26, s[52:55], 16 offen  lds
    s_add_u32 m0, s68, 2560
    s_movk_i32 s60, 1040
    s_nop 0
    buffer_load_dwordx4 v26, s[52:55], s60 offen offset:1024  lds
    s_waitcnt vmcnt(8)
    s_barrier
    ds_write_b128 v24, v[160:163] offset:4096
    s_lshl_b32 m0, s65, 13
    s_add_u32 s60, s65, s74
    s_and_b32 s60, s60, 15
    s_lshl_b32 s60, s60, 17
    s_add_u32 s61, s60, 0x10000
    buffer_load_dwordx4 v20, s[56:59], s60 offen offset:0  lds
    buffer_load_dwordx4 v21, s[56:59], s60 offen offset:1024  lds
    buffer_load_dwordx4 v22, s[56:59], s60 offen offset:2048  lds
    buffer_load_dwordx4 v23, s[56:59], s60 offen offset:3072  lds
    s_add_u32 m0, m0, 4096
    s_nop 0
    buffer_load_dwordx4 v20, s[56:59], s61 offen offset:0  lds
    buffer_load_dwordx4 v21, s[56:59], s61 offen offset:1024  lds
    buffer_load_dwordx4 v22, s[56:59], s61 offen offset:2048  lds
    buffer_load_dwordx4 v23, s[56:59], s61 offen offset:3072  lds
    s_waitcnt vmcnt(12)
    v_mov_b32_dpp v48, v36 wave_rol:1 row_mask:0xf bank_mask:0xf
    v_mov_b32_dpp v49, v40 wave_rol:1 row_mask:0xf bank_mask:0xf
    v_mov_b32_dpp v50, v44 wave_rol:1 row_mask:0xf bank_mask:0xf
    v_mov_b32 v51, 0
    s_nop 0
    v_mov_b32_dpp v48, v32 wave_shl:1 row_mask:0xf bank_mask:0xf
    v_mov_b32_dpp v49, v36 wave_shl:1 row_mask:0xf bank_mask:0xf
    v_mov_b32_dpp v50, v40 wave_shl:1 row_mask:0xf bank_mask:0xf
    v_mov_b32_dpp v51, v44 wave_shl:1 row_mask:0xf bank_mask:0xf
    ds_write_b128 v19, v[32:35] offset:0
    v_alignbit_b32 v52, v33, v32, 16
    v_alignbit_b32 v53, v34, v33, 16
    v_alignbit_b32 v54, v35, v34, 16
    v_alignbit_b32 v55, v48, v35, 16
    ds_write_b128 v19, v[52:55] offset:4160
    ds_write_b128 v19, v[36:39] offset:1024
    v_alignbit_b32 v56, v37, v36, 16
    v_alignbit_b32 v57, v38, v37, 16
    v_alignbit_b32 v58, v39, v38, 16
    v_alignbit_b32 v59, v49, v39, 16
    ds_write_b128 v19, v[56:59] offset:5184
    ds_write_b128 v19, v[40:43] offset:2048
    v_alignbit_b32 v60, v41, v40, 16
    v_alignbit_b32 v61, v42, v41, 16
    v_alignbit_b32 v62, v43, v42, 16
    v_alignbit_b32 v63, v50, v43, 16
    ds_write_b128 v19, v[60:63] offset:6208
    ds_write_b128 v19, v[44:47] offset:3072
    v_alignbit_b32 v64, v45, v44, 16
    v_alignbit_b32 v65, v46, v45, 16
    v_alignbit_b32 v66, v47, v46, 16
    v_alignbit_b32 v67, v51, v47, 16
    ds_write_b128 v19, v[64:67] offset:7232
    s_mov_b32 s60, 0
L_fr:
    ds_read_b128 v[68:71], v15 offset:112
    s_add_u32 s60, s60, 1
    s_waitcnt lgkmcnt(0)
    v_and_b32 v68, v68, v69
    v_and_b32 v70, v70, v71
    v_and_b32 v68, v68, v70
    s_cmp_gt_u32 s60, 0x40000
    s_cbranch_scc1 L_fr_d
    v_readfirstlane_b32 s61, v68
    s_nop 3
    s_cmp_eq_u32 s61, 1
    s_cbranch_scc1 L_fr_d
    s_sleep 1
    s_branch L_fr
L_fr_d:
    s_lshl_b32 m0, s75, 13
    s_add_u32 s60, s75, s74
    s_and_b32 s60, s60, 15
    s_lshl_b32 s60, s60, 17
    s_add_u32 s61, s60, 0x10000
    buffer_load_dwordx4 v20, s[56:59], s60 offen offset:0  lds
    buffer_load_dwordx4 v21, s[56:59], s60 offen offset:1024  lds
    buffer_load_dwordx4 v22, s[56:59], s60 offen offset:2048  lds
    buffer_load_dwordx4 v23, s[56:59], s60 offen offset:3072  lds
    s_add_u32 m0, m0, 4096
    s_nop 0
    buffer_load_dwordx4 v20, s[56:59], s61 offen offset:0  lds
    buffer_load_dwordx4 v21, s[56:59], s61 offen offset:1024  lds
    buffer_load_dwordx4 v22, s[56:59], s61 offen offset:2048  lds
    buffer_load_dwordx4 v23, s[56:59], s61 offen offset:3072  lds
    s_lshl_b32 m0, s3, 13
    s_add_u32 s60, s3, s74
    s_and_b32 s60, s60, 15
    s_lshl_b32 s60, s60, 17
    s_add_u32 s61, s60, 0x10000
    buffer_load_dwordx4 v20, s[56:59], s60 offen offset:0  lds
    buffer_load_dwordx4 v21, s[56:59], s60 offen offset:1024  lds
    buffer_load_dwordx4 v22, s[56:59], s60 offen offset:2048  lds
    buffer_load_dwordx4 v23, s[56:59], s60 offen offset:3072  lds
    s_add_u32 m0, m0, 4096
    s_nop 0
    buffer_load_dwordx4 v20, s[56:59], s61 offen offset:0  lds
    buffer_load_dwordx4 v21, s[56:59], s61 offen offset:1024  lds
    buffer_load_dwordx4 v22, s[56:59], s61 offen offset:2048  lds
    buffer_load_dwordx4 v23, s[56:59], s61 offen offset:3072  lds
    s_lshl_b32 s30, s69, 11
    s_lshl_b32 s61, s36, 7
    s_add_u32 s30, s30, s61
    s_lshl_b32 s63, s69, 12
    s_add_u32 s63, s63, s61
    s_add_u32 s63, s63, 2048
    s_lshl_b32 s66, s34, 8
    s_lshl_b32 s61, s3, 6
    s_add_u32 s66, s66, s61
    s_lshr_b32 vcc_lo, s66, 6
    s_mul_i32 vcc_lo, vcc_lo, 1984
    s_add_u32 s66, s66, vcc_lo
    s_add_u32 s66, s66, 0x980000
    s_lshl_b32 vcc_lo, s35, 7
    s_add_u32 s66, s66, vcc_lo
    s_bitcmp1_b32 s3, 0
    s_cselect_b32 s60, 0, 16
    s_cselect_b32 s33, 16, 0
    s_lshl_b32 s71, s71, s60
    s_and_b32 s71, s71, 0xffff0000
    s_lshr_b32 s60, s3, 1
    v_lshl_add_u32 v19, s60, 2, v15
    s_mov_b32 s32, s38
    s_lshr_b32 vcc_lo, s32, 6
    s_mul_i32 vcc_lo, vcc_lo, 8128
    s_add_u32 s32, s32, vcc_lo
    s_add_u32 s32, s32, 0x9a0000
    s_lshl_b32 s67, s36, 6
    s_lshl_b32 s60, s37, 2
    s_add_u32 s60, s60, s3
    s_lshr_b32 vcc_lo, s67, 6
    s_mul_i32 vcc_lo, vcc_lo, 8128
    s_add_u32 s67, s67, vcc_lo
    s_add_u32 s67, s67, 0x9a0000
    s_lshl_b32 vcc_lo, s60, 7
    s_add_u32 s67, s67, vcc_lo
    s_mov_b32 s64, 0
    s_waitcnt vmcnt(24)
    ds_read2_b32 v[32:33], v240 offset0:132 offset1:133
    ds_read2_b32 v[34:35], v240 offset0:134 offset1:135
    ds_read_b128 v[64:67], v244 offset:2304
    ds_read2_b32 v[36:37], v240 offset0:4 offset1:5
    ds_read2_b32 v[38:39], v240 offset0:6 offset1:7
    ds_read_b128 v[68:71], v244 offset:2560
    ds_read2_b32 v[40:41], v241 offset0:132 offset1:133
    ds_read2_b32 v[42:43], v241 offset0:134 offset1:135
    ds_read_b128 v[72:75], v244 offset:2816
    ds_read2_b32 v[44:45], v241 offset0:4 offset1:5
    ds_read2_b32 v[46:47], v241 offset0:6 offset1:7
    ds_read_b128 v[76:79], v244 offset:3072
    ds_read2_b32 v[48:49], v242 offset0:132 offset1:133
    ds_read2_b32 v[50:51], v242 offset0:134 offset1:135
    ds_read_b128 v[80:83], v244 offset:3328
    ds_read2_b32 v[52:53], v242 offset0:4 offset1:5
    ds_read2_b32 v[54:55], v242 offset0:6 offset1:7
    ds_read_b128 v[84:87], v244 offset:3584
    ds_read2_b32 v[56:57], v243 offset0:132 offset1:133
    ds_read2_b32 v[58:59], v243 offset0:134 offset1:135
    ds_read_b128 v[88:91], v244 offset:3840
    ds_read2_b32 v[60:61], v243 offset0:4 offset1:5
    ds_read2_b32 v[62:63], v243 offset0:6 offset1:7
    ds_read_b128 v[92:95], v244 offset:4096
    s_mov_b32 s60, 0
L_kd:
    ds_read_b128 v[96:99], v15 offset:128
    s_add_u32 s60, s60, 1
    s_waitcnt lgkmcnt(0)
    v_and_b32 v96, v96, v97
    v_and_b32 v98, v98, v99
    v_and_b32 v96, v96, v98
    s_cmp_gt_u32 s60, 0x40000
    s_cbranch_scc1 L_kd_d
    v_readfirstlane_b32 s61, v96
    s_nop 3
    s_cmp_eq_u32 s61, 1
    s_cbranch_scc1 L_kd_d
    s_sleep 1
    s_branch L_kd
L_kd_d:
    s_setprio 0
    s_waitcnt lgkmcnt(0)
    v_mfma_f32_16x16x32_bf16 v[188:191], v[32:35], v[92:95], v[188:191]
    ds_read2_b32 v[96:97], v240 offset0:128 offset1:129
    v_mfma_f32_16x16x32_bf16 v[188:191], v[36:39], v[88:91], v[188:191]
    ds_read2_b32 v[98:99], v240 offset0:130 offset1:131
    v_mfma_f32_16x16x32_bf16 v[188:191], v[40:43], v[84:87], v[188:191]
    ds_read_b128 v[128:131], v244 offset:0
    v_mfma_f32_16x16x32_bf16 v[188:191], v[44:47], v[80:83], v[188:191]
    ds_read2_b32 v[100:101], v240 offset0:0 offset1:1
    v_mfma_f32_16x16x32_bf16 v[188:191], v[48:51], v[76:79], v[188:191]
    ds_read2_b32 v[102:103], v240 offset0:2 offset1:3
    v_mfma_f32_16x16x32_bf16 v[188:191], v[52:55], v[72:75], v[188:191]
    ds_read_b128 v[132:135], v244 offset:256
    v_mfma_f32_16x16x32_bf16 v[188:191], v[56:59], v[68:71], v[188:191]
    ds_read2_b32 v[104:105], v241 offset0:128 offset1:129
    v_mfma_f32_16x16x32_bf16 v[188:191], v[60:63], v[64:67], v[188:191]
    ds_read2_b32 v[106:107], v241 offset0:130 offset1:131
    v_mfma_f32_16x16x32_bf16 v[184:187], v[32:35], v[88:91], v[184:187]
    ds_read_b128 v[136:139], v244 offset:512
    v_mfma_f32_16x16x32_bf16 v[184:187], v[36:39], v[84:87], v[184:187]
    ds_read2_b32 v[108:109], v241 offset0:0 offset1:1
    v_mfma_f32_16x16x32_bf16 v[184:187], v[40:43], v[80:83], v[184:187]
    ds_read2_b32 v[110:111], v241 offset0:2 offset1:3
    v_mfma_f32_16x16x32_bf16 v[184:187], v[44:47], v[76:79], v[184:187]
    ds_read_b128 v[140:143], v244 offset:768
    v_mfma_f32_16x16x32_bf16 v[184:187], v[48:51], v[72:75], v[184:187]
    ds_read2_b32 v[112:113], v242 offset0:128 offset1:129
    v_mfma_f32_16x16x32_bf16 v[184:187], v[52:55], v[68:71], v[184:187]
    ds_read2_b32 v[114:115], v242 offset0:130 offset1:131
    v_mfma_f32_16x16x32_bf16 v[184:187], v[56:59], v[64:67], v[184:187]
    ds_read_b128 v[144:147], v244 offset:1024
    v_mfma_f32_16x16x32_bf16 v[180:183], v[32:35], v[84:87], v[180:183]
    ds_read2_b32 v[116:117], v242 offset0:0 offset1:1
    v_mfma_f32_16x16x32_bf16 v[180:183], v[36:39], v[80:83], v[180:183]
    ds_read2_b32 v[118:119], v242 offset0:2 offset1:3
    v_mfma_f32_16x16x32_bf16 v[180:183], v[40:43], v[76:79], v[180:183]
    ds_read_b128 v[148:151], v244 offset:1280
    v_mfma_f32_16x16x32_bf16 v[180:183], v[44:47], v[72:75], v[180:183]
    ds_read2_b32 v[120:121], v243 offset0:128 offset1:129
    v_mfma_f32_16x16x32_bf16 v[180:183], v[48:51], v[68:71], v[180:183]
    ds_read2_b32 v[122:123], v243 offset0:130 offset1:131
    v_mfma_f32_16x16x32_bf16 v[180:183], v[52:55], v[64:67], v[180:183]
    ds_read_b128 v[152:155], v244 offset:1536
    v_mfma_f32_16x16x32_bf16 v[176:179], v[32:35], v[80:83], v[176:179]
    ds_read2_b32 v[124:125], v243 offset0:0 offset1:1
    v_mfma_f32_16x16x32_bf16 v[176:179], v[36:39], v[76:79], v[176:179]
    ds_read2_b32 v[126:127], v243 offset0:2 offset1:3
    v_mfma_f32_16x16x32_bf16 v[176:179], v[40:43], v[72:75], v[176:179]
    ds_read_b128 v[156:159], v244 offset:1792
    v_mfma_f32_16x16x32_bf16 v[176:179], v[44:47], v[68:71], v[176:179]
    v_subrev_u32 v240, 128, v240
    v_mfma_f32_16x16x32_bf16 v[176:179], v[48:51], v[64:67], v[176:179]
    v_subrev_u32 v241, 128, v241
    v_mfma_f32_16x16x32_bf16 v[172:175], v[32:35], v[76:79], v[172:175]
    v_subrev_u32 v242, 128, v242
    v_mfma_f32_16x16x32_bf16 v[172:175], v[36:39], v[72:75], v[172:175]
    v_subrev_u32 v243, 128, v243
    v_mfma_f32_16x16x32_bf16 v[172:175], v[40:43], v[68:71], v[172:175]
    v_subrev_u32 v244, 64, v244
    v_mfma_f32_16x16x32_bf16 v[172:175], v[44:47], v[64:67], v[172:175]
    v_mfma_f32_16x16x32_bf16 v[168:171], v[32:35], v[72:75], v[168:171]
    v_mfma_f32_16x16x32_bf16 v[168:171], v[36:39], v[68:71], v[168:171]
    v_mfma_f32_16x16x32_bf16 v[168:171], v[40:43], v[64:67], v[168:171]
    v_mfma_f32_16x16x32_bf16 v[164:167], v[32:35], v[68:71], v[164:167]
    v_mfma_f32_16x16x32_bf16 v[164:167], v[36:39], v[64:67], v[164:167]
    v_mfma_f32_16x16x32_bf16 v[160:163], v[32:35], v[64:67], v[160:163]
    s_waitcnt lgkmcnt(0)
    s_waitcnt vmcnt(0)
    v_mfma_f32_16x16x32_bf16 v[188:191], v[96:99], v[156:159], v[188:191]
    ds_read2_b32 v[32:33], v240 offset0:132 offset1:133
    s_mov_b32 s29, 1
    v_mfma_f32_16x16x32_bf16 v[188:191], v[100:103], v[152:155], v[188:191]
    ds_read2_b32 v[34:35], v240 offset0:134 offset1:135
    s_mov_b32 s61, 0
    v_mfma_f32_16x16x32_bf16 v[188:191], v[104:107], v[148:151], v[188:191]
    ds_read_b128 v[64:67], v244 offset:2304
    s_lshl_b32 s60, s3, 1
    v_mfma_f32_16x16x32_bf16 v[188:191], v[108:111], v[144:147], v[188:191]
    ds_read2_b32 v[36:37], v240 offset0:4 offset1:5
    s_bitset1_b32 s61, s60
    v_mfma_f32_16x16x32_bf16 v[188:191], v[112:115], v[140:143], v[188:191]
    ds_read2_b32 v[38:39], v240 offset0:6 offset1:7
    s_lshl_b32 s60, s75, 1
    v_mfma_f32_16x16x32_bf16 v[188:191], v[116:119], v[136:139], v[188:191]
    ds_read_b128 v[68:71], v244 offset:2560
    s_bitset1_b32 s61, s60
    v_mfma_f32_16x16x32_bf16 v[188:191], v[120:123], v[132:135], v[188:191]
    ds_read2_b32 v[40:41], v241 offset0:132 offset1:133
    s_lshl_b32 s60, s65, 1
    v_mfma_f32_16x16x32_bf16 v[188:191], v[124:127], v[128:131], v[188:191]
    ds_read2_b32 v[42:43], v241 offset0:134 offset1:135
    s_bitset1_b32 s61, s60
    v_mfma_f32_16x16x32_bf16 v[184:187], v[96:99], v[152:155], v[184:187]
    ds_read_b128 v[72:75], v244 offset:2816
    v_mov_b32 v3, s61
    v_mfma_f32_16x16x32_bf16 v[184:187], v[100:103], v[148:151], v[184:187]
    ds_read2_b32 v[44:45], v241 offset0:4 offset1:5
    s_mov_b64 exec, 1
    ds_or_b32 v15, v3 offset:60
    s_mov_b64 exec, -1
    v_mfma_f32_16x16x32_bf16 v[184:187], v[104:107], v[144:147], v[184:187]
    ds_read2_b32 v[46:47], v241 offset0:6 offset1:7
    s_add_u32 s60, s31, s74
    v_mfma_f32_16x16x32_bf16 v[184:187], v[108:111], v[140:143], v[184:187]
    ds_read_b128 v[76:79], v244 offset:3072
    s_and_b32 s60, s60, 15
    v_mfma_f32_16x16x32_bf16 v[184:187], v[112:115], v[136:139], v[184:187]
    ds_read2_b32 v[48:49], v242 offset0:132 offset1:133
    s_lshl_b32 s60, s60, 17
    v_mfma_f32_16x16x32_bf16 v[184:187], v[116:119], v[132:135], v[184:187]
    ds_read2_b32 v[50:51], v242 offset0:134 offset1:135
    s_add_u32 s61, s60, 0x10000
    v_mfma_f32_16x16x32_bf16 v[184:187], v[120:123], v[128:131], v[184:187]
    ds_read_b128 v[80:83], v244 offset:3328
    buffer_load_dwordx4 v[192:195], v20, s[56:59], s60 offen offset:0
    v_mfma_f32_16x16x32_bf16 v[180:183], v[96:99], v[148:151], v[180:183]
    ds_read2_b32 v[52:53], v242 offset0:4 offset1:5
    buffer_load_dwordx4 v[196:199], v21, s[56:59], s60 offen offset:1024
    v_mfma_f32_16x16x32_bf16 v[180:183], v[100:103], v[144:147], v[180:183]
    ds_read2_b32 v[54:55], v242 offset0:6 offset1:7
    buffer_load_dwordx4 v[200:203], v22, s[56:59], s60 offen offset:2048
    v_mfma_f32_16x16x32_bf16 v[180:183], v[104:107], v[140:143], v[180:183]
    ds_read_b128 v[84:87], v244 offset:3584
    buffer_load_dwordx4 v[204:207], v23, s[56:59], s60 offen offset:3072
    v_mfma_f32_16x16x32_bf16 v[180:183], v[108:111], v[136:139], v[180:183]
    ds_read2_b32 v[56:57], v243 offset0:132 offset1:133
    buffer_load_dwordx4 v[208:211], v20, s[56:59], s61 offen offset:0
    v_mfma_f32_16x16x32_bf16 v[180:183], v[112:115], v[132:135], v[180:183]
    ds_read2_b32 v[58:59], v243 offset0:134 offset1:135
    buffer_load_dwordx4 v[212:215], v21, s[56:59], s61 offen offset:1024
    v_mfma_f32_16x16x32_bf16 v[180:183], v[116:119], v[128:131], v[180:183]
    ds_read_b128 v[88:91], v244 offset:3840
    buffer_load_dwordx4 v[216:219], v22, s[56:59], s61 offen offset:2048
    v_mfma_f32_16x16x32_bf16 v[176:179], v[96:99], v[144:147], v[176:179]
    ds_read2_b32 v[60:61], v243 offset0:4 offset1:5
    buffer_load_dwordx4 v[220:223], v23, s[56:59], s61 offen offset:3072
    v_mfma_f32_16x16x32_bf16 v[176:179], v[100:103], v[140:143], v[176:179]
    ds_read2_b32 v[62:63], v243 offset0:6 offset1:7
    buffer_load_dwordx4 v[224:227], v16, s[40:43], s30 offen
    v_mfma_f32_16x16x32_bf16 v[176:179], v[104:107], v[136:139], v[176:179]
    ds_read_b128 v[92:95], v244 offset:4096
    s_add_u32 s30, s30, 0x4000
    v_mfma_f32_16x16x32_bf16 v[176:179], v[108:111], v[132:135], v[176:179]
    buffer_load_dwordx4 v[228:231], v16, s[40:43], s30 offen
    v_mfma_f32_16x16x32_bf16 v[176:179], v[112:115], v[128:131], v[176:179]
    s_add_u32 s30, s30, 0x4000
    v_mfma_f32_16x16x32_bf16 v[172:175], v[96:99], v[140:143], v[172:175]
    buffer_load_dwordx4 v[232:235], v16, s[40:43], s30 offen
    v_mfma_f32_16x16x32_bf16 v[172:175], v[100:103], v[136:139], v[172:175]
    s_add_u32 s30, s30, 0x4000
    v_mfma_f32_16x16x32_bf16 v[172:175], v[104:107], v[132:135], v[172:175]
    buffer_load_dwordx4 v[236:239], v16, s[40:43], s30 offen
    v_mfma_f32_16x16x32_bf16 v[172:175], v[108:111], v[128:131], v[172:175]
    v_mfma_f32_16x16x32_bf16 v[168:171], v[96:99], v[136:139], v[168:171]
    v_mfma_f32_16x16x32_bf16 v[168:171], v[100:103], v[132:135], v[168:171]
    v_mfma_f32_16x16x32_bf16 v[168:171], v[104:107], v[128:131], v[168:171]
    v_mfma_f32_16x16x32_bf16 v[164:167], v[96:99], v[132:135], v[164:167]
    v_mfma_f32_16x16x32_bf16 v[164:167], v[100:103], v[128:131], v[164:167]
    v_mfma_f32_16x16x32_bf16 v[160:163], v[96:99], v[128:131], v[160:163]
L_cloop:
    s_waitcnt lgkmcnt(0)
    v_mfma_f32_16x16x32_bf16 v[188:191], v[32:35], v[92:95], v[188:191]
    ds_read2_b32 v[96:97], v240 offset0:128 offset1:129
    v_mfma_f32_16x16x32_bf16 v[188:191], v[36:39], v[88:91], v[188:191]
    ds_read2_b32 v[98:99], v240 offset0:130 offset1:131
    v_mfma_f32_16x16x32_bf16 v[188:191], v[40:43], v[84:87], v[188:191]
    ds_read_b128 v[128:131], v244 offset:0
    v_mfma_f32_16x16x32_bf16 v[188:191], v[44:47], v[80:83], v[188:191]
    ds_read2_b32 v[100:101], v240 offset0:0 offset1:1
    v_mfma_f32_16x16x32_bf16 v[188:191], v[48:51], v[76:79], v[188:191]
    ds_read2_b32 v[102:103], v240 offset0:2 offset1:3
    v_mfma_f32_16x16x32_bf16 v[188:191], v[52:55], v[72:75], v[188:191]
    ds_read_b128 v[132:135], v244 offset:256
    v_mfma_f32_16x16x32_bf16 v[188:191], v[56:59], v[68:71], v[188:191]
    ds_read2_b32 v[104:105], v241 offset0:128 offset1:129
    v_mfma_f32_16x16x32_bf16 v[188:191], v[60:63], v[64:67], v[188:191]
    ds_read2_b32 v[106:107], v241 offset0:130 offset1:131
    v_mfma_f32_16x16x32_bf16 v[184:187], v[32:35], v[88:91], v[184:187]
    ds_read_b128 v[136:139], v244 offset:512
    v_mfma_f32_16x16x32_bf16 v[184:187], v[36:39], v[84:87], v[184:187]
    ds_read2_b32 v[108:109], v241 offset0:0 offset1:1
    v_mfma_f32_16x16x32_bf16 v[184:187], v[40:43], v[80:83], v[184:187]
    ds_read2_b32 v[110:111], v241 offset0:2 offset1:3
    v_mfma_f32_16x16x32_bf16 v[184:187], v[44:47], v[76:79], v[184:187]
    ds_read_b128 v[140:143], v244 offset:768
    v_mfma_f32_16x16x32_bf16 v[184:187], v[48:51], v[72:75], v[184:187]
    ds_read2_b32 v[112:113], v242 offset0:128 offset1:129
    v_mfma_f32_16x16x32_bf16 v[184:187], v[52:55], v[68:71], v[184:187]
    ds_read2_b32 v[114:115], v242 offset0:130 offset1:131
    v_mfma_f32_16x16x32_bf16 v[184:187], v[56:59], v[64:67], v[184:187]
    ds_read_b128 v[144:147], v244 offset:1024
    v_mfma_f32_16x16x32_bf16 v[180:183], v[32:35], v[84:87], v[180:183]
    ds_read2_b32 v[116:117], v242 offset0:0 offset1:1
    v_mfma_f32_16x16x32_bf16 v[180:183], v[36:39], v[80:83], v[180:183]
    ds_read2_b32 v[118:119], v242 offset0:2 offset1:3
    v_mfma_f32_16x16x32_bf16 v[180:183], v[40:43], v[76:79], v[180:183]
    ds_read_b128 v[148:151], v244 offset:1280
    v_mfma_f32_16x16x32_bf16 v[180:183], v[44:47], v[72:75], v[180:183]
    ds_read2_b32 v[120:121], v243 offset0:128 offset1:129
    v_mfma_f32_16x16x32_bf16 v[180:183], v[48:51], v[68:71], v[180:183]
    ds_read2_b32 v[122:123], v243 offset0:130 offset1:131
    v_mfma_f32_16x16x32_bf16 v[180:183], v[52:55], v[64:67], v[180:183]
    ds_read_b128 v[152:155], v244 offset:1536
    v_mfma_f32_16x16x32_bf16 v[176:179], v[32:35], v[80:83], v[176:179]
    ds_read2_b32 v[124:125], v243 offset0:0 offset1:1
    v_mfma_f32_16x16x32_bf16 v[176:179], v[36:39], v[76:79], v[176:179]
    ds_read2_b32 v[126:127], v243 offset0:2 offset1:3
    v_mfma_f32_16x16x32_bf16 v[176:179], v[40:43], v[72:75], v[176:179]
    ds_read_b128 v[156:159], v244 offset:1792
    v_mfma_f32_16x16x32_bf16 v[176:179], v[44:47], v[68:71], v[176:179]
    v_subrev_u32 v240, 128, v240
    v_mfma_f32_16x16x32_bf16 v[176:179], v[48:51], v[64:67], v[176:179]
    v_subrev_u32 v241, 128, v241
    v_mfma_f32_16x16x32_bf16 v[172:175], v[32:35], v[76:79], v[172:175]
    v_subrev_u32 v242, 128, v242
    v_mfma_f32_16x16x32_bf16 v[172:175], v[36:39], v[72:75], v[172:175]
    v_subrev_u32 v243, 128, v243
    v_mfma_f32_16x16x32_bf16 v[172:175], v[40:43], v[68:71], v[172:175]
    v_subrev_u32 v244, 64, v244
    v_mfma_f32_16x16x32_bf16 v[172:175], v[44:47], v[64:67], v[172:175]
    v_mfma_f32_16x16x32_bf16 v[168:171], v[32:35], v[72:75], v[168:171]
    v_mfma_f32_16x16x32_bf16 v[168:171], v[36:39], v[68:71], v[168:171]
    v_mfma_f32_16x16x32_bf16 v[168:171], v[40:43], v[64:67], v[168:171]
    v_mfma_f32_16x16x32_bf16 v[164:167], v[32:35], v[68:71], v[164:167]
    v_mfma_f32_16x16x32_bf16 v[164:167], v[36:39], v[64:67], v[164:167]
    v_mfma_f32_16x16x32_bf16 v[160:163], v[32:35], v[64:67], v[160:163]
    s_waitcnt lgkmcnt(0)
    v_mfma_f32_16x16x32_bf16 v[188:191], v[96:99], v[156:159], v[188:191]
    ds_read2_b32 v[32:33], v240 offset0:132 offset1:133
    v_mfma_f32_16x16x32_bf16 v[188:191], v[100:103], v[152:155], v[188:191]
    ds_read2_b32 v[34:35], v240 offset0:134 offset1:135
    v_mfma_f32_16x16x32_bf16 v[188:191], v[104:107], v[148:151], v[188:191]
    ds_read_b128 v[64:67], v244 offset:2304
    v_mfma_f32_16x16x32_bf16 v[188:191], v[108:111], v[144:147], v[188:191]
    ds_read2_b32 v[36:37], v240 offset0:4 offset1:5
    v_mfma_f32_16x16x32_bf16 v[188:191], v[112:115], v[140:143], v[188:191]
    ds_read2_b32 v[38:39], v240 offset0:6 offset1:7
    v_mfma_f32_16x16x32_bf16 v[188:191], v[116:119], v[136:139], v[188:191]
    ds_read_b128 v[68:71], v244 offset:2560
    v_mfma_f32_16x16x32_bf16 v[188:191], v[120:123], v[132:135], v[188:191]
    ds_read2_b32 v[40:41], v241 offset0:132 offset1:133
    v_mfma_f32_16x16x32_bf16 v[188:191], v[124:127], v[128:131], v[188:191]
    ds_read2_b32 v[42:43], v241 offset0:134 offset1:135
    v_mfma_f32_16x16x32_bf16 v[184:187], v[96:99], v[152:155], v[184:187]
    ds_read_b128 v[72:75], v244 offset:2816
    v_mfma_f32_16x16x32_bf16 v[184:187], v[100:103], v[148:151], v[184:187]
    ds_read2_b32 v[44:45], v241 offset0:4 offset1:5
    v_mfma_f32_16x16x32_bf16 v[184:187], v[104:107], v[144:147], v[184:187]
    ds_read2_b32 v[46:47], v241 offset0:6 offset1:7
    v_mfma_f32_16x16x32_bf16 v[184:187], v[108:111], v[140:143], v[184:187]
    ds_read_b128 v[76:79], v244 offset:3072
    v_mfma_f32_16x16x32_bf16 v[184:187], v[112:115], v[136:139], v[184:187]
    ds_read2_b32 v[48:49], v242 offset0:132 offset1:133
    v_mfma_f32_16x16x32_bf16 v[184:187], v[116:119], v[132:135], v[184:187]
    ds_read2_b32 v[50:51], v242 offset0:134 offset1:135
    v_mfma_f32_16x16x32_bf16 v[184:187], v[120:123], v[128:131], v[184:187]
    ds_read_b128 v[80:83], v244 offset:3328
    v_mfma_f32_16x16x32_bf16 v[180:183], v[96:99], v[148:151], v[180:183]
    ds_read2_b32 v[52:53], v242 offset0:4 offset1:5
    v_mfma_f32_16x16x32_bf16 v[180:183], v[100:103], v[144:147], v[180:183]
    ds_read2_b32 v[54:55], v242 offset0:6 offset1:7
    v_mfma_f32_16x16x32_bf16 v[180:183], v[104:107], v[140:143], v[180:183]
    ds_read_b128 v[84:87], v244 offset:3584
    v_mfma_f32_16x16x32_bf16 v[180:183], v[108:111], v[136:139], v[180:183]
    ds_read2_b32 v[56:57], v243 offset0:132 offset1:133
    v_mfma_f32_16x16x32_bf16 v[180:183], v[112:115], v[132:135], v[180:183]
    ds_read2_b32 v[58:59], v243 offset0:134 offset1:135
    v_mfma_f32_16x16x32_bf16 v[180:183], v[116:119], v[128:131], v[180:183]
    ds_read_b128 v[88:91], v244 offset:3840
    v_mfma_f32_16x16x32_bf16 v[176:179], v[96:99], v[144:147], v[176:179]
    ds_read2_b32 v[60:61], v243 offset0:4 offset1:5
    v_mfma_f32_16x16x32_bf16 v[176:179], v[100:103], v[140:143], v[176:179]
    ds_read2_b32 v[62:63], v243 offset0:6 offset1:7
    v_mfma_f32_16x16x32_bf16 v[176:179], v[104:107], v[136:139], v[176:179]
    ds_read_b128 v[92:95], v244 offset:4096
    v_mfma_f32_16x16x32_bf16 v[176:179], v[108:111], v[132:135], v[176:179]
    s_add_u32 s29, s29, 1
    v_mfma_f32_16x16x32_bf16 v[176:179], v[112:115], v[128:131], v[176:179]
    s_cmp_lt_u32 s29, 4
    v_mfma_f32_16x16x32_bf16 v[172:175], v[96:99], v[140:143], v[172:175]
    v_mfma_f32_16x16x32_bf16 v[172:175], v[100:103], v[136:139], v[172:175]
    v_mfma_f32_16x16x32_bf16 v[172:175], v[104:107], v[132:135], v[172:175]
    v_mfma_f32_16x16x32_bf16 v[172:175], v[108:111], v[128:131], v[172:175]
    v_mfma_f32_16x16x32_bf16 v[168:171], v[96:99], v[136:139], v[168:171]
    v_mfma_f32_16x16x32_bf16 v[168:171], v[100:103], v[132:135], v[168:171]
    v_mfma_f32_16x16x32_bf16 v[168:171], v[104:107], v[128:131], v[168:171]
    v_mfma_f32_16x16x32_bf16 v[164:167], v[96:99], v[132:135], v[164:167]
    v_mfma_f32_16x16x32_bf16 v[164:167], v[100:103], v[128:131], v[164:167]
    v_mfma_f32_16x16x32_bf16 v[160:163], v[96:99], v[128:131], v[160:163]
    s_cbranch_scc1 L_cloop
    ds_read_b64 v[136:137], v245 offset:3584
    ds_read_b64 v[138:139], v245 offset:3072
    ds_read_b64 v[140:141], v245 offset:2560
    ds_read_b64 v[142:143], v245 offset:2048
    ds_read_b64 v[144:145], v245 offset:1536
    ds_read_b64 v[146:147], v245 offset:1024
    ds_read_b64 v[148:149], v245 offset:512
    ds_read_b64 v[150:151], v245 offset:0
    s_mov_b64 exec, 1
    ds_add_u32 v15, v14 offset:36
    s_mov_b64 exec, -1
    s_setprio 3
    s_waitcnt lgkmcnt(0)
    v_and_b32 v152, s70, v137
    v_lshlrev_b32 v153, 16, v137
    v_and_b32 v154, s70, v136
    v_lshlrev_b32 v155, 16, v136
    v_fmac_f32 v160, s71, v152
    v_fmac_f32 v161, s71, v153
    v_fmac_f32 v162, s71, v154
    v_fmac_f32 v163, s71, v155
    v_cvt_pk_bf16_f32 v136, v160, v161
    v_cvt_pk_bf16_f32 v137, v162, v163
    v_and_b32 v152, s70, v139
    v_lshlrev_b32 v153, 16, v139
    v_and_b32 v154, s70, v138
    v_lshlrev_b32 v155, 16, v138
    v_fmac_f32 v164, s71, v152
    v_fmac_f32 v165, s71, v153
    v_fmac_f32 v166, s71, v154
    v_fmac_f32 v167, s71, v155
    v_cvt_pk_bf16_f32 v138, v164, v165
    v_cvt_pk_bf16_f32 v139, v166, v167
    v_and_b32 v152, s70, v141
    v_lshlrev_b32 v153, 16, v141
    v_and_b32 v154, s70, v140
    v_lshlrev_b32 v155, 16, v140
    v_fmac_f32 v168, s71, v152
    v_fmac_f32 v169, s71, v153
    v_fmac_f32 v170, s71, v154
    v_fmac_f32 v171, s71, v155
    v_cvt_pk_bf16_f32 v140, v168, v169
    v_cvt_pk_bf16_f32 v141, v170, v171
    v_and_b32 v152, s70, v143
    v_lshlrev_b32 v153, 16, v143
    v_and_b32 v154, s70, v142
    v_lshlrev_b32 v155, 16, v142
    v_fmac_f32 v172, s71, v152
    v_fmac_f32 v173, s71, v153
    v_fmac_f32 v174, s71, v154
    v_fmac_f32 v175, s71, v155
    v_cvt_pk_bf16_f32 v142, v172, v173
    v_cvt_pk_bf16_f32 v143, v174, v175
    v_and_b32 v152, s70, v145
    v_lshlrev_b32 v153, 16, v145
    v_and_b32 v154, s70, v144
    v_lshlrev_b32 v155, 16, v144
    v_fmac_f32 v176, s71, v152
    v_fmac_f32 v177, s71, v153
    v_fmac_f32 v178, s71, v154
    v_fmac_f32 v179, s71, v155
    v_cvt_pk_bf16_f32 v144, v176, v177
    v_cvt_pk_bf16_f32 v145, v178, v179
    v_and_b32 v152, s70, v147
    v_lshlrev_b32 v153, 16, v147
    v_and_b32 v154, s70, v146
    v_lshlrev_b32 v155, 16, v146
    v_fmac_f32 v180, s71, v152
    v_fmac_f32 v181, s71, v153
    v_fmac_f32 v182, s71, v154
    v_fmac_f32 v183, s71, v155
    v_cvt_pk_bf16_f32 v146, v180, v181
    v_cvt_pk_bf16_f32 v147, v182, v183
    v_and_b32 v152, s70, v149
    v_lshlrev_b32 v153, 16, v149
    v_and_b32 v154, s70, v148
    v_lshlrev_b32 v155, 16, v148
    v_fmac_f32 v184, s71, v152
    v_fmac_f32 v185, s71, v153
    v_fmac_f32 v186, s71, v154
    v_fmac_f32 v187, s71, v155
    v_cvt_pk_bf16_f32 v148, v184, v185
    v_cvt_pk_bf16_f32 v149, v186, v187
    v_and_b32 v152, s70, v151
    v_lshlrev_b32 v153, 16, v151
    v_and_b32 v154, s70, v150
    v_lshlrev_b32 v155, 16, v150
    v_fmac_f32 v188, s71, v152
    v_fmac_f32 v189, s71, v153
    v_fmac_f32 v190, s71, v154
    v_fmac_f32 v191, s71, v155
    v_cvt_pk_bf16_f32 v150, v188, v189
    v_cvt_pk_bf16_f32 v151, v190, v191
    s_nop 1
    v_permlane16_swap_b32 v136, v138
    v_permlane16_swap_b32 v137, v139
    v_permlane16_swap_b32 v140, v142
    v_permlane16_swap_b32 v141, v143
    v_permlane16_swap_b32 v144, v146
    v_permlane16_swap_b32 v145, v147
    v_permlane16_swap_b32 v148, v150
    v_permlane16_swap_b32 v149, v151
    s_waitcnt vmcnt(4)
    buffer_store_dwordx4 v[136:139], v246, s[48:51], s39 offen offset:0 sc1
    buffer_store_dwordx4 v[140:143], v246, s[48:51], s39 offen offset:1024 sc1
    buffer_store_dwordx4 v[144:147], v246, s[48:51], s39 offen offset:2048 sc1
    buffer_store_dwordx4 v[148:151], v246, s[48:51], s39 offen offset:3072 sc1
    s_mov_b32 s60, 0
L_cdspin:
    ds_read_b32 v3, v15 offset:36
    s_add_u32 s60, s60, 1
    s_waitcnt lgkmcnt(0)
    v_readfirstlane_b32 s61, v3
    s_cmp_gt_u32 s60, 0x40000
    s_cbranch_scc1 L_cdspin_done
    s_cmp_ge_u32 s61, 4
    s_cbranch_scc1 L_cdspin_done
    s_sleep 0
    s_branch L_cdspin
L_cdspin_done:
    s_lshl_b32 s60, s3, 13
    s_add_u32 s60, s60, 98304
    v_add_u32 v18, s60, v5
    ds_write_b128 v18, v[192:195] offset:0
    ds_write_b128 v18, v[196:199] offset:1024
    ds_write_b128 v18, v[200:203] offset:2048
    ds_write_b128 v18, v[204:207] offset:3072
    ds_write_b128 v18, v[208:211] offset:4096
    ds_write_b128 v18, v[212:215] offset:5120
    ds_write_b128 v18, v[216:219] offset:6144
    ds_write_b128 v18, v[220:223] offset:7168
    s_mov_b32 s61, 0
    s_lshl_b32 s60, s31, 1
    s_bitset1_b32 s61, s60
    v_mov_b32 v3, s61
    s_mov_b64 exec, 1
    ds_or_b32 v15, v3 offset:60
    s_mov_b64 exec, -1
    s_lshl_b32 s65, s36, 18
    s_lshl_b32 s60, s69, 1
    s_add_u32 s65, s65, s60
    s_add_u32 s65, s65, 0x0
    v_lshrrev_b32 v18, 2, v4
    v_lshlrev_b32 v18, 12, v18
    v_lshl_add_u32 v18, v30, 4, v18
    v_lshl_add_u32 v20, v28, 3, v29
    v_lshlrev_b32 v20, 6, v20
    v_lshl_add_u32 v20, v30, 3, v20
    v_add_u32 v20, s68, v20
    s_movk_i32 s60, 144
    v_mul_u32_u24 v24, s60, v31
    v_lshl_add_u32 v24, v28, 4, v24
    v_add_u32 v24, s68, v24
    v_mul_u32_u24 v25, s60, v1
    v_add3_u32 v25, v25, v27, s68
    s_mov_b32 m0, s68
    s_waitcnt vmcnt(0)
    s_mov_b64 exec, 1
    ds_add_rtn_u32 v3, v15, v14 offset:32
    s_mov_b64 exec, -1
    s_waitcnt lgkmcnt(0)
    v_readfirstlane_b32 s60, v3
    s_nop 3
    s_cmp_eq_u32 s60, 3
    s_cbranch_scc0 L_yfl
    s_mov_b64 exec, -1
    buffer_store_dword v7, v255, s[48:51], s32 offen sc1
    s_mov_b64 exec, -1
L_yfl:
    s_setprio 0
    v_lshlrev_b32 v96, 16, v224
    v_and_b32 v97, s70, v224
    v_lshlrev_b32 v98, 16, v225
    v_and_b32 v99, s70, v225
    v_lshlrev_b32 v100, 16, v226
    v_and_b32 v101, s70, v226
    v_lshlrev_b32 v102, 16, v227
    v_and_b32 v103, s70, v227
    v_lshlrev_b32 v104, 16, v228
    v_and_b32 v105, s70, v228
    v_lshlrev_b32 v106, 16, v229
    v_and_b32 v107, s70, v229
    v_lshlrev_b32 v108, 16, v230
    v_and_b32 v109, s70, v230
    v_lshlrev_b32 v110, 16, v231
    v_and_b32 v111, s70, v231
    v_lshlrev_b32 v112, 16, v232
    v_and_b32 v113, s70, v232
    v_lshlrev_b32 v114, 16, v233
    v_and_b32 v115, s70, v233
    v_lshlrev_b32 v116, 16, v234
    v_and_b32 v117, s70, v234
    v_lshlrev_b32 v118, 16, v235
    v_and_b32 v119, s70, v235
    v_lshlrev_b32 v120, 16, v236
    v_and_b32 v121, s70, v236
    v_lshlrev_b32 v122, 16, v237
    v_and_b32 v123, s70, v237
    v_lshlrev_b32 v124, 16, v238
    v_and_b32 v125, s70, v238
    v_lshlrev_b32 v126, 16, v239
    v_and_b32 v127, s70, v239
    s_mov_b32 s29, 0
L_yloop:
    s_cmp_eq_u32 s64, 0x5555
    s_cbranch_scc1 L_ynop
    s_load_dwordx16 s[4:19], s[26:27], s66 glc
    s_waitcnt lgkmcnt(0)
    s_mov_b32 s62, 0
    s_cmp_eq_u64 s[4:5], s[72:73]
    s_cselect_b32 s60, 0x1, 0
    s_or_b32 s62, s62, s60
    s_cmp_eq_u64 s[6:7], s[72:73]
    s_cselect_b32 s60, 0x4, 0
    s_or_b32 s62, s62, s60
    s_cmp_eq_u64 s[8:9], s[72:73]
    s_cselect_b32 s60, 0x10, 0
    s_or_b32 s62, s62, s60
    s_cmp_eq_u64 s[10:11], s[72:73]
    s_cselect_b32 s60, 0x40, 0
    s_or_b32 s62, s62, s60
    s_cmp_eq_u64 s[12:13], s[72:73]
    s_cselect_b32 s60, 0x100, 0
    s_or_b32 s62, s62, s60
    s_cmp_eq_u64 s[14:15], s[72:73]
    s_cselect_b32 s60, 0x400, 0
    s_or_b32 s62, s62, s60
    s_cmp_eq_u64 s[16:17], s[72:73]
    s_cselect_b32 s60, 0x1000, 0
    s_or_b32 s62, s62, s60
    s_cmp_eq_u64 s[18:19], s[72:73]
    s_cselect_b32 s60, 0x4000, 0
    s_or_b32 s62, s62, s60
    s_mov_b32 s64, s62
    s_lshl_b32 s60, s62, s33
    s_mov_b32 s61, s60
    s_lshr_b64 s[60:61], s[60:61], s28
    v_mov_b32 v3, s60
    s_mov_b64 exec, 1
    ds_or_b32 v19, v3 offset:64
    s_mov_b64 exec, -1
L_ynop:
    s_load_dwordx16 s[4:19], s[26:27], s67 glc
    s_add_u32 s29, s29, 1
    s_cmp_gt_u32 s29, 0x8000
    s_cbranch_scc1 L_ydone
    s_waitcnt lgkmcnt(0)
    s_cmp_eq_u64 s[4:5], s[72:73]
    s_cbranch_scc0 L_yloop
    s_cmp_eq_u64 s[6:7], s[72:73]
    s_cbranch_scc0 L_yloop
    s_cmp_eq_u64 s[8:9], s[72:73]
    s_cbranch_scc0 L_yloop
    s_cmp_eq_u64 s[10:11], s[72:73]
    s_cbranch_scc0 L_yloop
    s_cmp_eq_u64 s[12:13], s[72:73]
    s_cbranch_scc0 L_yloop
    s_cmp_eq_u64 s[14:15], s[72:73]
    s_cbranch_scc0 L_yloop
    s_cmp_eq_u64 s[16:17], s[72:73]
    s_cbranch_scc0 L_yloop
    s_cmp_eq_u64 s[18:19], s[72:73]
    s_cbranch_scc0 L_yloop
L_ydone:
    s_waitcnt lgkmcnt(0)
    buffer_load_dwordx4 v18, s[48:51], s65 offen offset:0 sc1 lds
    s_add_u32 s65, s65, 64512
    buffer_load_dwordx4 v18, s[48:51], s65 offen offset:1024 sc1 lds
    s_add_u32 s65, s65, 64512
    buffer_load_dwordx4 v18, s[48:51], s65 offen offset:2048 sc1 lds
    s_add_u32 s65, s65, 64512
    buffer_load_dwordx4 v18, s[48:51], s65 offen offset:3072 sc1 lds
    s_waitcnt vmcnt(0)
    ds_read_b64_tr_b16 v[48:49], v20 offset:0
    ds_read_b64_tr_b16 v[50:51], v20 offset:256
    ds_read_b64_tr_b16 v[52:53], v20 offset:2048
    ds_read_b64_tr_b16 v[54:55], v20 offset:2304
    ds_read_b64_tr_b16 v[56:57], v20 offset:32
    ds_read_b64_tr_b16 v[58:59], v20 offset:288
    ds_read_b64_tr_b16 v[60:61], v20 offset:2080
    ds_read_b64_tr_b16 v[62:63], v20 offset:2336
    s_waitcnt lgkmcnt(0)
    ds_write_b128 v24, v[48:51] offset:0
    ds_write_b128 v24, v[52:55] offset:64
    ds_write_b128 v24, v[56:59] offset:2304
    ds_write_b128 v24, v[60:63] offset:2368
    ds_read_b128 v[80:83], v25 offset:0
    ds_read_b128 v[84:87], v25 offset:1152
    ds_read_b128 v[88:91], v25 offset:2304
    ds_read_b128 v[92:95], v25 offset:3456
    s_waitcnt lgkmcnt(3)
    v_lshlrev_b32 v64, 16, v80
    v_and_b32 v65, s70, v80
    v_lshlrev_b32 v66, 16, v81
    v_and_b32 v67, s70, v81
    v_lshlrev_b32 v68, 16, v82
    v_and_b32 v69, s70, v82
    v_lshlrev_b32 v70, 16, v83
    v_and_b32 v71, s70, v83
    v_mul_f32 v64, v64, v96
    v_mul_f32 v65, v65, v97
    v_mul_f32 v66, v66, v98
    v_mul_f32 v67, v67, v99
    v_mul_f32 v68, v68, v100
    v_mul_f32 v69, v69, v101
    v_mul_f32 v70, v70, v102
    v_mul_f32 v71, v71, v103
    v_cvt_pk_bf16_f32 v224, v64, v65
    v_cvt_pk_bf16_f32 v225, v66, v67
    v_cvt_pk_bf16_f32 v226, v68, v69
    v_cvt_pk_bf16_f32 v227, v70, v71
    buffer_store_dwordx4 v[224:227], v17, s[44:47], s63 offen sc1
    s_add_u32 s63, s63, 0x8000
    s_waitcnt lgkmcnt(2)
    v_lshlrev_b32 v64, 16, v84
    v_and_b32 v65, s70, v84
    v_lshlrev_b32 v66, 16, v85
    v_and_b32 v67, s70, v85
    v_lshlrev_b32 v68, 16, v86
    v_and_b32 v69, s70, v86
    v_lshlrev_b32 v70, 16, v87
    v_and_b32 v71, s70, v87
    v_mul_f32 v64, v64, v104
    v_mul_f32 v65, v65, v105
    v_mul_f32 v66, v66, v106
    v_mul_f32 v67, v67, v107
    v_mul_f32 v68, v68, v108
    v_mul_f32 v69, v69, v109
    v_mul_f32 v70, v70, v110
    v_mul_f32 v71, v71, v111
    v_cvt_pk_bf16_f32 v228, v64, v65
    v_cvt_pk_bf16_f32 v229, v66, v67
    v_cvt_pk_bf16_f32 v230, v68, v69
    v_cvt_pk_bf16_f32 v231, v70, v71
    buffer_store_dwordx4 v[228:231], v17, s[44:47], s63 offen sc1
    s_add_u32 s63, s63, 0x8000
    s_waitcnt lgkmcnt(1)
    v_lshlrev_b32 v64, 16, v88
    v_and_b32 v65, s70, v88
    v_lshlrev_b32 v66, 16, v89
    v_and_b32 v67, s70, v89
    v_lshlrev_b32 v68, 16, v90
    v_and_b32 v69, s70, v90
    v_lshlrev_b32 v70, 16, v91
    v_and_b32 v71, s70, v91
    v_mul_f32 v64, v64, v112
    v_mul_f32 v65, v65, v113
    v_mul_f32 v66, v66, v114
    v_mul_f32 v67, v67, v115
    v_mul_f32 v68, v68, v116
    v_mul_f32 v69, v69, v117
    v_mul_f32 v70, v70, v118
    v_mul_f32 v71, v71, v119
    v_cvt_pk_bf16_f32 v232, v64, v65
    v_cvt_pk_bf16_f32 v233, v66, v67
    v_cvt_pk_bf16_f32 v234, v68, v69
    v_cvt_pk_bf16_f32 v235, v70, v71
    buffer_store_dwordx4 v[232:235], v17, s[44:47], s63 offen sc1
    s_add_u32 s63, s63, 0x8000
    s_waitcnt lgkmcnt(0)
    v_lshlrev_b32 v64, 16, v92
    v_and_b32 v65, s70, v92
    v_lshlrev_b32 v66, 16, v93
    v_and_b32 v67, s70, v93
    v_lshlrev_b32 v68, 16, v94
    v_and_b32 v69, s70, v94
    v_lshlrev_b32 v70, 16, v95
    v_and_b32 v71, s70, v95
    v_mul_f32 v64, v64, v120
    v_mul_f32 v65, v65, v121
    v_mul_f32 v66, v66, v122
    v_mul_f32 v67, v67, v123
    v_mul_f32 v68, v68, v124
    v_mul_f32 v69, v69, v125
    v_mul_f32 v70, v70, v126
    v_mul_f32 v71, v71, v127
    v_cvt_pk_bf16_f32 v236, v64, v65
    v_cvt_pk_bf16_f32 v237, v66, v67
    v_cvt_pk_bf16_f32 v238, v68, v69
    v_cvt_pk_bf16_f32 v239, v70, v71
    buffer_store_dwordx4 v[236:239], v17, s[44:47], s63 offen sc1
    s_endpgm
L_comp:
    s_and_b32 s34, s28, 3
    s_lshl_b32 s34, s34, 2
    s_and_b32 vcc_lo, s29, 3
    s_add_u32 s34, s34, vcc_lo
    s_lshr_b32 s35, s28, 2
    s_lshl_b32 s35, s35, 3
    s_lshr_b32 vcc_lo, s29, 2
    s_add_u32 s35, s35, vcc_lo
    s_and_b32 s36, s29, 15
    s_lshr_b32 s37, s29, 4
    s_lshl_b32 vcc_lo, s28, 1
    s_add_u32 s37, s37, vcc_lo
    s_lshl_b32 s38, s28, 5
    s_add_u32 s38, s38, s29
    s_lshl_b32 s38, s38, 2
    s_lshl_b32 s45, s37, 18
    s_lshl_b32 s46, s3, 16
    s_add_u32 s45, s45, s46
    s_lshl_b32 s46, s36, 7
    s_add_u32 s45, s45, s46
    v_lshrrev_b32 v2, 4, v4
    v_and_b32 v1, 15, v4
    v_lshlrev_b32 v3, 3, v1
    v_lshl_add_u32 v16, v2, 14, v3
    v_add_u32 v16, s45, v16
    v_subrev_u32 v17, 6144, v16
    s_movk_i32 s57, 4096
    s_movk_i32 s58, 8192
    s_movk_i32 s59, 12288
    s_mov_b32 s62, 0x400000
    s_mov_b32 s63, 0x20000
    s_mov_b32 s66, 0x400000
    s_mov_b32 s67, 0x20000
    s_mov_b32 s70, 8192
    s_mov_b32 s71, 0x20000
    v_lshlrev_b32 v18, 5, v1
    s_lshl_b32 s46, s36, 9
    v_add_u32 v18, s46, v18
    v_sub_u32 v3, 3, v2
    s_lshl_b32 s45, s3, 2
    s_sub_u32 s45, 12, s45
    v_add_u32 v3, s45, v3
    v_and_b32 v6, 7, v4
    v_xor_b32 v3, v3, v6
    v_lshlrev_b32 v3, 4, v3
    v_lshl_add_u32 v3, v1, 10, v3
    v_add_u32 v19, 139776, v3
    s_and_b32 s40, s3, 1
    s_lshr_b32 s41, s3, 1
    v_bfe_u32 v3, v4, 1, 3
    v_xor_b32 v3, v2, v3
    v_lshlrev_b32 v3, 4, v3
    v_lshl_add_u32 v3, v1, 7, v3
    s_lshl_b32 s45, s40, 13
    v_add_u32 v8, s45, v3
    v_xor_b32 v9, 64, v8
    v_bfe_u32 v22, v4, 2, 2
    v_lshl_add_u32 v3, v2, 3, v22
    v_lshlrev_b32 v3, 7, v3
    v_and_b32 v7, 3, v4
    v_lshlrev_b32 v6, 3, v7
    s_lshl_b32 s45, s41, 6
    v_add_u32 v6, s45, v6
    v_bfe_u32 v7, v4, 3, 1
    v_lshlrev_b32 v7, 6, v7
    v_xor_b32 v6, v6, v7
    v_bfe_u32 v23, v4, 4, 1
    v_lshlrev_b32 v7, 5, v23
    v_xor_b32 v6, v6, v7
    v_add_u32 v3, v3, v6
    v_add_u32 v12, 0x4000, v3
    v_xor_b32 v13, 32, v12
    v_mov_b32 v14, v12
    v_mov_b32 v15, v13
    v_mov_b32 v10, v8
    v_mov_b32 v11, v9
    v_lshlrev_b32 v254, 7, v4
    v_mov_b32 v20, 162816
    v_mov_b32 v232, 1
    v_mov_b32 v233, 0
    v_lshlrev_b32 v6, 2, v4
    v_add_u32 v6, 162816, v6
    ds_write_b32 v6, v233
    s_lshl_b32 s45, s3, 2
    v_add_u32 v21, s45, v20
    s_mov_b32 s53, 0
    s_mov_b32 s56, 0xffff0000
    s_waitcnt lgkmcnt(0)
    s_nop 0
    s_mov_b64 s[60:61], s[12:13]
    s_mov_b64 s[64:65], s[14:15]
    s_mov_b64 s[68:69], s[16:17]
    s_barrier
    buffer_load_dwordx2 v[200:201], v17, s[60:63], 0 offen offset:0
    buffer_load_dwordx2 v[202:203], v17, s[60:63], 0 offen offset:2048
    buffer_load_dwordx2 v[204:205], v17, s[60:63], s57 offen offset:0
    buffer_load_dwordx2 v[206:207], v16, s[60:63], 0 offen offset:0
    buffer_load_dwordx2 v[208:209], v16, s[60:63], 0 offen offset:2048
    buffer_load_dwordx2 v[210:211], v16, s[60:63], s57 offen offset:0
    buffer_load_dwordx2 v[212:213], v16, s[60:63], s57 offen offset:2048
    buffer_load_dwordx2 v[214:215], v16, s[60:63], s58 offen offset:0
    buffer_load_dwordx2 v[216:217], v16, s[60:63], s58 offen offset:2048
    buffer_load_dwordx2 v[218:219], v16, s[60:63], s59 offen offset:0
    buffer_load_dwordx2 v[220:221], v16, s[60:63], s59 offen offset:2048
    buffer_load_dwordx4 v[242:245], v18, s[68:71], 0 offen offset:0
    buffer_load_dwordx4 v[246:249], v18, s[68:71], 0 offen offset:16
    buffer_load_dwordx2 v[222:223], v16, s[64:67], 0 offen offset:0
    buffer_load_dwordx2 v[224:225], v16, s[64:67], 0 offen offset:2048
    buffer_load_dwordx2 v[226:227], v16, s[64:67], s57 offen offset:0
    buffer_load_dwordx2 v[228:229], v16, s[64:67], s57 offen offset:2048
    buffer_load_dwordx2 v[230:231], v16, s[64:67], s58 offen offset:0
    buffer_load_dwordx2 v[236:237], v16, s[64:67], s58 offen offset:2048
    buffer_load_dwordx2 v[238:239], v16, s[64:67], s59 offen offset:0
    buffer_load_dwordx2 v[240:241], v16, s[64:67], s59 offen offset:2048
    s_barrier
    ds_read_b128 v[24:27], v10 offset:0
    ds_read_b128 v[28:31], v11 offset:0
    ds_read_b64_tr_b16 v[56:57], v14 offset:8192
    ds_read_b64_tr_b16 v[58:59], v14 offset:8704
    ds_read_b64_tr_b16 v[60:61], v14 offset:12288
    ds_read_b64_tr_b16 v[62:63], v14 offset:12800
    ds_read_b128 v[32:35], v10 offset:2048
    ds_read_b128 v[36:39], v11 offset:2048
    ds_read_b128 v[40:43], v10 offset:4096
    ds_read_b128 v[44:47], v11 offset:4096
    ds_read_b128 v[48:51], v10 offset:6144
    ds_read_b128 v[52:55], v11 offset:6144
    ds_read_b64_tr_b16 v[64:65], v15 offset:8192
    ds_read_b64_tr_b16 v[66:67], v15 offset:8704
    ds_read_b64_tr_b16 v[68:69], v15 offset:12288
    ds_read_b64_tr_b16 v[70:71], v15 offset:12800
    s_mov_b32 s52, 0
    s_waitcnt lgkmcnt(10)
    v_mfma_f32_16x16x32_bf16 v[136:139], v[24:27], v[56:59], 0
    v_mfma_f32_16x16x32_bf16 v[136:139], v[28:31], v[60:63], v[136:139]
    ds_read_b64_tr_b16 v[72:73], v14 offset:16384
    ds_read_b64_tr_b16 v[74:75], v14 offset:16896
    ds_read_b64_tr_b16 v[76:77], v14 offset:20480
    ds_read_b64_tr_b16 v[78:79], v14 offset:20992
    s_waitcnt lgkmcnt(8)
    v_mfma_f32_16x16x32_bf16 v[140:143], v[32:35], v[56:59], 0
    ds_read_b64_tr_b16 v[80:81], v15 offset:16384
    v_mfma_f32_16x16x32_bf16 v[140:143], v[36:39], v[60:63], v[140:143]
    ds_read_b64_tr_b16 v[82:83], v15 offset:16896
    v_mfma_f32_16x16x32_bf16 v[144:147], v[40:43], v[56:59], 0
    ds_read_b64_tr_b16 v[84:85], v15 offset:20480
    v_mfma_f32_16x16x32_bf16 v[144:147], v[44:47], v[60:63], v[144:147]
    ds_read_b64_tr_b16 v[86:87], v15 offset:20992
    v_mfma_f32_16x16x32_bf16 v[148:151], v[48:51], v[56:59], 0
    ds_read_b64_tr_b16 v[88:89], v14 offset:0
    v_mfma_f32_16x16x32_bf16 v[148:151], v[52:55], v[60:63], v[148:151]
    ds_read_b64_tr_b16 v[90:91], v14 offset:512
    s_waitcnt lgkmcnt(10)
    v_mfma_f32_16x16x32_bf16 v[152:155], v[24:27], v[64:67], 0
    ds_read_b64_tr_b16 v[92:93], v14 offset:4096
    v_mfma_f32_16x16x32_bf16 v[152:155], v[28:31], v[68:71], v[152:155]
    ds_read_b64_tr_b16 v[94:95], v14 offset:4608
    v_mfma_f32_16x16x32_bf16 v[156:159], v[32:35], v[64:67], 0
    ds_read_b64_tr_b16 v[96:97], v15 offset:0
    v_mfma_f32_16x16x32_bf16 v[156:159], v[36:39], v[68:71], v[156:159]
    ds_read_b64_tr_b16 v[98:99], v15 offset:512
    v_mfma_f32_16x16x32_bf16 v[160:163], v[40:43], v[64:67], 0
    ds_read_b64_tr_b16 v[100:101], v15 offset:4096
    v_mfma_f32_16x16x32_bf16 v[160:163], v[44:47], v[68:71], v[160:163]
    ds_read_b64_tr_b16 v[102:103], v15 offset:4608
    v_mfma_f32_16x16x32_bf16 v[164:167], v[48:51], v[64:67], 0
    v_mfma_f32_16x16x32_bf16 v[164:167], v[52:55], v[68:71], v[164:167]
    s_waitcnt lgkmcnt(0)
    v_mfma_f32_16x16x32_bf16 v[168:171], v[24:27], v[72:75], 0
    s_add_u32 s52, s52, 40960
    s_cmp_eq_u32 s52, 122880
    v_mfma_f32_16x16x32_bf16 v[168:171], v[28:31], v[76:79], v[168:171]
    s_cselect_b32 s52, 0, s52
    v_add_u32 v10, s52, v8
    v_mfma_f32_16x16x32_bf16 v[172:175], v[32:35], v[72:75], 0
    v_add_u32 v11, s52, v9
    v_add_u32 v14, s52, v12
    v_mfma_f32_16x16x32_bf16 v[172:175], v[36:39], v[76:79], v[172:175]
    v_add_u32 v15, s52, v13
    s_mov_b32 s60, s26
    v_mfma_f32_16x16x32_bf16 v[176:179], v[40:43], v[72:75], 0
    s_mov_b32 s61, s27
    s_mov_b32 s62, 0x2000000
    v_mfma_f32_16x16x32_bf16 v[176:179], v[44:47], v[76:79], v[176:179]
    s_mov_b32 s63, 0x20000
    s_mov_b32 s68, s22
    v_mfma_f32_16x16x32_bf16 v[180:183], v[48:51], v[72:75], 0
    s_mov_b32 s69, s23
    s_mov_b32 s70, 0x800000
    v_mfma_f32_16x16x32_bf16 v[180:183], v[52:55], v[76:79], v[180:183]
    s_mov_b32 s71, 0x20000
    v_lshlrev_b32 v3, 12, v2
    v_mfma_f32_16x16x32_bf16 v[184:187], v[24:27], v[80:83], 0
    v_lshl_add_u32 v16, v1, 4, v3
    s_lshl_b32 s45, s36, 18
    v_mfma_f32_16x16x32_bf16 v[184:187], v[28:31], v[84:87], v[184:187]
    s_lshl_b32 s46, s3, 16
    s_add_u32 s45, s45, s46
    v_mfma_f32_16x16x32_bf16 v[188:191], v[32:35], v[80:83], 0
    s_lshl_b32 s46, s37, 8
    s_sub_u32 s45, s45, s46
    v_mfma_f32_16x16x32_bf16 v[188:191], v[36:39], v[84:87], v[188:191]
    s_add_u32 s45, s45, 3840
    v_add_u32 v16, s45, v16
    v_mfma_f32_16x16x32_bf16 v[192:195], v[40:43], v[80:83], 0
    s_lshl_b32 s45, s3, 12
    s_add_u32 s45, s45, 139776
    v_mfma_f32_16x16x32_bf16 v[192:195], v[44:47], v[84:87], v[192:195]
    v_add_u32 v1, s45, v5
    s_lshl_b32 s45, s40, 6
    v_mfma_f32_16x16x32_bf16 v[196:199], v[48:51], v[80:83], 0
    v_xor_b32 v1, s45, v1
    v_xor_b32 v2, 16, v1
    v_mfma_f32_16x16x32_bf16 v[196:199], v[52:55], v[84:87], v[196:199]
    v_xor_b32 v3, 32, v1
    v_xor_b32 v6, 48, v1
    v_mfma_f32_16x16x32_bf16 v[104:107], v[88:91], v[24:27], 0
    s_movk_i32 s57, 0x4000
    s_mov_b32 s58, 0x8000
    v_mfma_f32_16x16x32_bf16 v[104:107], v[92:95], v[28:31], v[104:107]
    s_mov_b32 s59, 0xc000
    s_lshl_b32 s43, s36, 2
    v_mfma_f32_16x16x32_bf16 v[112:115], v[88:91], v[32:35], 0
    s_add_u32 s43, s43, s3
    s_lshl_b32 s43, s43, 4
    v_mfma_f32_16x16x32_bf16 v[112:115], v[92:95], v[36:39], v[112:115]
    s_add_u32 s43, s43, s37
    s_lshl_b32 s43, s43, 2
    v_mfma_f32_16x16x32_bf16 v[120:123], v[88:91], v[40:43], 0
    s_lshr_b32 vcc_lo, s43, 6
    s_mul_i32 vcc_lo, vcc_lo, 1984
    v_mfma_f32_16x16x32_bf16 v[120:123], v[92:95], v[44:47], v[120:123]
    s_add_u32 s43, s43, vcc_lo
    s_add_u32 s43, s43, 0x940000
    v_mfma_f32_16x16x32_bf16 v[128:131], v[88:91], v[48:51], 0
    s_movk_i32 s42, 5
    v_mfma_f32_16x16x32_bf16 v[128:131], v[92:95], v[52:55], v[128:131]
    v_mfma_f32_16x16x32_bf16 v[108:111], v[96:99], v[24:27], 0
    v_mfma_f32_16x16x32_bf16 v[108:111], v[100:103], v[28:31], v[108:111]
    v_mfma_f32_16x16x32_bf16 v[116:119], v[96:99], v[32:35], 0
    v_mfma_f32_16x16x32_bf16 v[116:119], v[100:103], v[36:39], v[116:119]
    v_mfma_f32_16x16x32_bf16 v[124:127], v[96:99], v[40:43], 0
    v_mfma_f32_16x16x32_bf16 v[124:127], v[100:103], v[44:47], v[124:127]
    v_mfma_f32_16x16x32_bf16 v[132:135], v[96:99], v[48:51], 0
    v_mfma_f32_16x16x32_bf16 v[132:135], v[100:103], v[52:55], v[132:135]
    s_waitcnt vmcnt(10)
    v_lshlrev_b32 v24, 16, v200
    v_and_b32 v25, s56, v200
    v_lshlrev_b32 v26, 16, v201
    v_and_b32 v27, s56, v201
    v_lshlrev_b32 v28, 16, v202
    v_and_b32 v29, s56, v202
    v_lshlrev_b32 v30, 16, v203
    v_and_b32 v31, s56, v203
    v_lshlrev_b32 v32, 16, v204
    v_and_b32 v33, s56, v204
    v_lshlrev_b32 v34, 16, v205
    v_and_b32 v35, s56, v205
    v_lshlrev_b32 v36, 16, v206
    v_and_b32 v37, s56, v206
    v_lshlrev_b32 v38, 16, v207
    v_and_b32 v39, s56, v207
    v_lshlrev_b32 v40, 16, v208
    v_and_b32 v41, s56, v208
    v_lshlrev_b32 v42, 16, v209
    v_and_b32 v43, s56, v209
    v_lshlrev_b32 v44, 16, v210
    v_and_b32 v45, s56, v210
    v_lshlrev_b32 v46, 16, v211
    v_and_b32 v47, s56, v211
    v_lshlrev_b32 v48, 16, v212
    v_and_b32 v49, s56, v212
    v_lshlrev_b32 v50, 16, v213
    v_and_b32 v51, s56, v213
    v_lshlrev_b32 v52, 16, v214
    v_and_b32 v53, s56, v214
    v_lshlrev_b32 v54, 16, v215
    v_and_b32 v55, s56, v215
    v_lshlrev_b32 v56, 16, v216
    v_and_b32 v57, s56, v216
    v_lshlrev_b32 v58, 16, v217
    v_and_b32 v59, s56, v217
    v_lshlrev_b32 v60, 16, v218
    v_and_b32 v61, s56, v218
    v_lshlrev_b32 v62, 16, v219
    v_and_b32 v63, s56, v219
    v_lshlrev_b32 v64, 16, v220
    v_and_b32 v65, s56, v220
    v_lshlrev_b32 v66, 16, v221
    v_and_b32 v67, s56, v221
    s_waitcnt vmcnt(8)
    v_lshlrev_b32 v68, 16, v242
    v_and_b32 v72, s56, v242
    v_lshlrev_b32 v76, 16, v243
    v_and_b32 v80, s56, v243
    v_lshlrev_b32 v69, 16, v244
    v_and_b32 v73, s56, v244
    v_lshlrev_b32 v77, 16, v245
    v_and_b32 v81, s56, v245
    v_lshlrev_b32 v70, 16, v246
    v_and_b32 v74, s56, v246
    v_lshlrev_b32 v78, 16, v247
    v_and_b32 v82, s56, v247
    v_lshlrev_b32 v71, 16, v248
    v_and_b32 v75, s56, v248
    v_lshlrev_b32 v79, 16, v249
    v_and_b32 v83, s56, v249
    v_pk_mul_f32 v[84:85], v[36:37], v[68:69]
    v_pk_mul_f32 v[86:87], v[38:39], v[70:71]
    v_pk_mul_f32 v[88:89], v[40:41], v[68:69]
    v_pk_mul_f32 v[90:91], v[42:43], v[70:71]
    v_pk_fma_f32 v[84:85], v[32:33], v[72:73], v[84:85]
    v_pk_fma_f32 v[86:87], v[34:35], v[74:75], v[86:87]
    v_pk_fma_f32 v[88:89], v[36:37], v[72:73], v[88:89]
    v_pk_fma_f32 v[90:91], v[38:39], v[74:75], v[90:91]
    v_pk_fma_f32 v[84:85], v[28:29], v[76:77], v[84:85]
    v_pk_fma_f32 v[86:87], v[30:31], v[78:79], v[86:87]
    v_pk_fma_f32 v[88:89], v[32:33], v[76:77], v[88:89]
    v_pk_fma_f32 v[90:91], v[34:35], v[78:79], v[90:91]
    v_pk_fma_f32 v[24:25], v[24:25], v[80:81], v[84:85]
    v_pk_fma_f32 v[26:27], v[26:27], v[82:83], v[86:87]
    v_pk_fma_f32 v[28:29], v[28:29], v[80:81], v[88:89]
    v_pk_fma_f32 v[30:31], v[30:31], v[82:83], v[90:91]
    v_pk_mul_f32 v[84:85], v[44:45], v[68:69]
    v_pk_mul_f32 v[86:87], v[46:47], v[70:71]
    v_pk_mul_f32 v[88:89], v[48:49], v[68:69]
    v_pk_mul_f32 v[90:91], v[50:51], v[70:71]
    v_pk_fma_f32 v[84:85], v[40:41], v[72:73], v[84:85]
    v_pk_fma_f32 v[86:87], v[42:43], v[74:75], v[86:87]
    v_pk_fma_f32 v[88:89], v[44:45], v[72:73], v[88:89]
    v_pk_fma_f32 v[90:91], v[46:47], v[74:75], v[90:91]
    v_pk_fma_f32 v[84:85], v[36:37], v[76:77], v[84:85]
    v_pk_fma_f32 v[86:87], v[38:39], v[78:79], v[86:87]
    v_pk_fma_f32 v[88:89], v[40:41], v[76:77], v[88:89]
    v_pk_fma_f32 v[90:91], v[42:43], v[78:79], v[90:91]
    v_pk_fma_f32 v[32:33], v[32:33], v[80:81], v[84:85]
    v_pk_fma_f32 v[34:35], v[34:35], v[82:83], v[86:87]
    v_pk_fma_f32 v[36:37], v[36:37], v[80:81], v[88:89]
    v_pk_fma_f32 v[38:39], v[38:39], v[82:83], v[90:91]
    v_pk_mul_f32 v[84:85], v[52:53], v[68:69]
    v_pk_mul_f32 v[86:87], v[54:55], v[70:71]
    v_pk_mul_f32 v[88:89], v[56:57], v[68:69]
    v_pk_mul_f32 v[90:91], v[58:59], v[70:71]
    v_pk_fma_f32 v[84:85], v[48:49], v[72:73], v[84:85]
    v_pk_fma_f32 v[86:87], v[50:51], v[74:75], v[86:87]
    v_pk_fma_f32 v[88:89], v[52:53], v[72:73], v[88:89]
    v_pk_fma_f32 v[90:91], v[54:55], v[74:75], v[90:91]
    v_pk_fma_f32 v[84:85], v[44:45], v[76:77], v[84:85]
    v_pk_fma_f32 v[86:87], v[46:47], v[78:79], v[86:87]
    v_pk_fma_f32 v[88:89], v[48:49], v[76:77], v[88:89]
    v_pk_fma_f32 v[90:91], v[50:51], v[78:79], v[90:91]
    v_pk_fma_f32 v[40:41], v[40:41], v[80:81], v[84:85]
    v_pk_fma_f32 v[42:43], v[42:43], v[82:83], v[86:87]
    v_pk_fma_f32 v[44:45], v[44:45], v[80:81], v[88:89]
    v_pk_fma_f32 v[46:47], v[46:47], v[82:83], v[90:91]
    v_pk_mul_f32 v[84:85], v[60:61], v[68:69]
    v_pk_mul_f32 v[86:87], v[62:63], v[70:71]
    v_pk_mul_f32 v[88:89], v[64:65], v[68:69]
    v_pk_mul_f32 v[90:91], v[66:67], v[70:71]
    v_pk_fma_f32 v[84:85], v[56:57], v[72:73], v[84:85]
    v_pk_fma_f32 v[86:87], v[58:59], v[74:75], v[86:87]
    v_pk_fma_f32 v[88:89], v[60:61], v[72:73], v[88:89]
    v_pk_fma_f32 v[90:91], v[62:63], v[74:75], v[90:91]
    v_pk_fma_f32 v[84:85], v[52:53], v[76:77], v[84:85]
    v_pk_fma_f32 v[86:87], v[54:55], v[78:79], v[86:87]
    v_pk_fma_f32 v[88:89], v[56:57], v[76:77], v[88:89]
    v_pk_fma_f32 v[90:91], v[58:59], v[78:79], v[90:91]
    v_pk_fma_f32 v[48:49], v[48:49], v[80:81], v[84:85]
    v_pk_fma_f32 v[50:51], v[50:51], v[82:83], v[86:87]
    v_pk_fma_f32 v[52:53], v[52:53], v[80:81], v[88:89]
    v_pk_fma_f32 v[54:55], v[54:55], v[82:83], v[90:91]
    s_waitcnt vmcnt(0)
    v_lshlrev_b32 v56, 16, v222
    v_and_b32 v57, s56, v222
    v_lshlrev_b32 v58, 16, v223
    v_and_b32 v59, s56, v223
    v_lshlrev_b32 v60, 16, v224
    v_and_b32 v61, s56, v224
    v_lshlrev_b32 v62, 16, v225
    v_and_b32 v63, s56, v225
    v_lshlrev_b32 v64, 16, v226
    v_and_b32 v65, s56, v226
    v_lshlrev_b32 v66, 16, v227
    v_and_b32 v67, s56, v227
    v_lshlrev_b32 v68, 16, v228
    v_and_b32 v69, s56, v228
    v_lshlrev_b32 v70, 16, v229
    v_and_b32 v71, s56, v229
    v_lshlrev_b32 v72, 16, v230
    v_and_b32 v73, s56, v230
    v_lshlrev_b32 v74, 16, v231
    v_and_b32 v75, s56, v231
    v_lshlrev_b32 v76, 16, v236
    v_and_b32 v77, s56, v236
    v_lshlrev_b32 v78, 16, v237
    v_and_b32 v79, s56, v237
    v_lshlrev_b32 v80, 16, v238
    v_and_b32 v81, s56, v238
    v_lshlrev_b32 v82, 16, v239
    v_and_b32 v83, s56, v239
    v_lshlrev_b32 v84, 16, v240
    v_and_b32 v85, s56, v240
    v_lshlrev_b32 v86, 16, v241
    v_and_b32 v87, s56, v241
    v_pk_mul_f32 v[24:25], v[24:25], v[56:57]
    v_pk_mul_f32 v[28:29], v[28:29], v[60:61]
    v_pk_mul_f32 v[32:33], v[32:33], v[64:65]
    v_pk_mul_f32 v[36:37], v[36:37], v[68:69]
    v_pk_mul_f32 v[40:41], v[40:41], v[72:73]
    v_pk_mul_f32 v[44:45], v[44:45], v[76:77]
    v_pk_mul_f32 v[48:49], v[48:49], v[80:81]
    v_pk_mul_f32 v[52:53], v[52:53], v[84:85]
    v_cvt_pk_bf16_f32 v200, v52, v48
    v_cvt_pk_bf16_f32 v201, v44, v40
    v_cvt_pk_bf16_f32 v202, v36, v32
    v_cvt_pk_bf16_f32 v203, v28, v24
    ds_write_b128 v19, v[200:203] offset:0
    v_cvt_pk_bf16_f32 v204, v53, v49
    v_cvt_pk_bf16_f32 v205, v45, v41
    v_cvt_pk_bf16_f32 v206, v37, v33
    v_cvt_pk_bf16_f32 v207, v29, v25
    ds_write_b128 v19, v[204:207] offset:256
    v_pk_mul_f32 v[26:27], v[26:27], v[58:59]
    v_pk_mul_f32 v[30:31], v[30:31], v[62:63]
    v_pk_mul_f32 v[34:35], v[34:35], v[66:67]
    v_pk_mul_f32 v[38:39], v[38:39], v[70:71]
    v_pk_mul_f32 v[42:43], v[42:43], v[74:75]
    v_pk_mul_f32 v[46:47], v[46:47], v[78:79]
    v_pk_mul_f32 v[50:51], v[50:51], v[82:83]
    v_pk_mul_f32 v[54:55], v[54:55], v[86:87]
    v_cvt_pk_bf16_f32 v208, v54, v50
    v_cvt_pk_bf16_f32 v209, v46, v42
    v_cvt_pk_bf16_f32 v210, v38, v34
    v_cvt_pk_bf16_f32 v211, v30, v26
    ds_write_b128 v19, v[208:211] offset:512
    v_cvt_pk_bf16_f32 v212, v55, v51
    v_cvt_pk_bf16_f32 v213, v47, v43
    v_cvt_pk_bf16_f32 v214, v39, v35
    v_cvt_pk_bf16_f32 v215, v31, v27
    ds_write_b128 v19, v[212:215] offset:768
    s_waitcnt lgkmcnt(0)
    s_barrier
    ds_read_b128 v[24:27], v10 offset:0
    ds_read_b128 v[28:31], v11 offset:0
    ds_read_b64_tr_b16 v[56:57], v14 offset:8192
    ds_read_b64_tr_b16 v[58:59], v14 offset:8704
    ds_read_b64_tr_b16 v[60:61], v14 offset:12288
    ds_read_b64_tr_b16 v[62:63], v14 offset:12800
    ds_read_b128 v[32:35], v10 offset:2048
    ds_read_b128 v[36:39], v11 offset:2048
    ds_read_b128 v[40:43], v10 offset:4096
    ds_read_b128 v[44:47], v11 offset:4096
    ds_read_b128 v[48:51], v10 offset:6144
    ds_read_b128 v[52:55], v11 offset:6144
    s_waitcnt lgkmcnt(6)
    ds_read_b64_tr_b16 v[64:65], v15 offset:8192
    ds_read_b64_tr_b16 v[66:67], v15 offset:8704
    ds_read_b64_tr_b16 v[68:69], v15 offset:12288
    ds_read_b64_tr_b16 v[70:71], v15 offset:12800
    ds_read_b64_tr_b16 v[72:73], v14 offset:16384
    ds_read_b64_tr_b16 v[74:75], v14 offset:16896
    ds_read_b64_tr_b16 v[76:77], v14 offset:20480
    ds_read_b64_tr_b16 v[78:79], v14 offset:20992
    s_waitcnt lgkmcnt(8)
    ds_read_b64_tr_b16 v[80:81], v15 offset:16384
    ds_read_b64_tr_b16 v[82:83], v15 offset:16896
    ds_read_b64_tr_b16 v[84:85], v15 offset:20480
    ds_read_b64_tr_b16 v[86:87], v15 offset:20992
    ds_read_b64_tr_b16 v[88:89], v14 offset:0
    ds_read_b64_tr_b16 v[90:91], v14 offset:512
    ds_read_b64_tr_b16 v[92:93], v14 offset:4096
    ds_read_b64_tr_b16 v[94:95], v14 offset:4608
    s_waitcnt lgkmcnt(8)
    ds_read_b128 v[236:239], v1 offset:0
    ds_read_b128 v[240:243], v2 offset:1024
    ds_read_b128 v[244:247], v3 offset:2048
    ds_read_b128 v[248:251], v6 offset:3072
    s_branch L_loop1
L_side:
    s_cmp_eq_u32 s53, 0
    s_cbranch_scc0 L_side2
    buffer_store_dwordx4 v[236:239], v16, s[60:63], 0 offen sc1
    buffer_store_dwordx4 v[240:243], v16, s[60:63], s57 offen sc1
    buffer_store_dwordx4 v[244:247], v16, s[60:63], s58 offen sc1
    buffer_store_dwordx4 v[248:251], v16, s[60:63], s59 offen sc1
    s_branch L_back
L_side2:
    v_readfirstlane_b32 s72, v234
    s_mov_b32 s45, 0
    s_waitcnt vmcnt(0)
    s_cmp_lg_u32 s72, 0
    s_cbranch_scc1 L_cepok
L_cep:
    ds_read_b32 v234, v20 offset:56
    s_add_u32 s45, s45, 1
    s_waitcnt lgkmcnt(0)
    v_readfirstlane_b32 s72, v234
    s_cmp_gt_u32 s45, 0x40000
    s_cbranch_scc1 L_cepok
    s_cmp_eq_u32 s72, 0
    s_cbranch_scc1 L_cep
L_cepok:
    s_mov_b32 s73, s72
    s_mov_b64 exec, 0xffff
    buffer_store_dword v234, v254, s[60:63], s43 offen sc1
    s_mov_b64 exec, -1
    s_branch L_back

L_loop1:
    v_mfma_f32_16x16x32_bf16 v[136:139], v[24:27], v[56:59], v[136:139]
    ds_read_b64_tr_b16 v[96:97], v15 offset:0
    v_mfma_f32_16x16x32_bf16 v[136:139], v[28:31], v[60:63], v[136:139]
    ds_read_b64_tr_b16 v[98:99], v15 offset:512
    v_mfma_f32_16x16x32_bf16 v[140:143], v[32:35], v[56:59], v[140:143]
    ds_read_b64_tr_b16 v[100:101], v15 offset:4096
    v_mfma_f32_16x16x32_bf16 v[140:143], v[36:39], v[60:63], v[140:143]
    ds_read_b64_tr_b16 v[102:103], v15 offset:4608
    v_mfma_f32_16x16x32_bf16 v[144:147], v[40:43], v[56:59], v[144:147]
    s_add_u32 s52, s52, 40960
    s_cmp_eq_u32 s52, 122880
    s_cselect_b32 s52, 0, s52
    v_mfma_f32_16x16x32_bf16 v[144:147], v[44:47], v[60:63], v[144:147]
    v_add_u32 v10, s52, v8
    v_add_u32 v11, s52, v9
    v_mfma_f32_16x16x32_bf16 v[148:151], v[48:51], v[56:59], v[148:151]
    v_add_u32 v14, s52, v12
    v_add_u32 v15, s52, v13
    v_mfma_f32_16x16x32_bf16 v[148:151], v[52:55], v[60:63], v[148:151]
    s_waitcnt lgkmcnt(0)
    v_mfma_f32_16x16x32_bf16 v[152:155], v[24:27], v[64:67], v[152:155]
    s_barrier
    v_mfma_f32_16x16x32_bf16 v[152:155], v[28:31], v[68:71], v[152:155]
    ds_read_b64_tr_b16 v[56:57], v14 offset:8192
    v_mfma_f32_16x16x32_bf16 v[156:159], v[32:35], v[64:67], v[156:159]
    ds_read_b64_tr_b16 v[58:59], v14 offset:8704
    v_mfma_f32_16x16x32_bf16 v[156:159], v[36:39], v[68:71], v[156:159]
    ds_read_b64_tr_b16 v[60:61], v14 offset:12288
    v_mfma_f32_16x16x32_bf16 v[160:163], v[40:43], v[64:67], v[160:163]
    ds_read_b64_tr_b16 v[62:63], v14 offset:12800
    v_mfma_f32_16x16x32_bf16 v[160:163], v[44:47], v[68:71], v[160:163]
    ds_read_b128 v[200:203], v10 offset:0
    v_mfma_f32_16x16x32_bf16 v[164:167], v[48:51], v[64:67], v[164:167]
    ds_read_b128 v[204:207], v11 offset:0
    v_mfma_f32_16x16x32_bf16 v[164:167], v[52:55], v[68:71], v[164:167]
    ds_read_b128 v[208:211], v10 offset:2048
    v_mfma_f32_16x16x32_bf16 v[168:171], v[24:27], v[72:75], v[168:171]
    ds_read_b64_tr_b16 v[64:65], v15 offset:8192
    v_mfma_f32_16x16x32_bf16 v[168:171], v[28:31], v[76:79], v[168:171]
    ds_read_b64_tr_b16 v[66:67], v15 offset:8704
    v_mfma_f32_16x16x32_bf16 v[172:175], v[32:35], v[72:75], v[172:175]
    ds_read_b64_tr_b16 v[68:69], v15 offset:12288
    v_mfma_f32_16x16x32_bf16 v[172:175], v[36:39], v[76:79], v[172:175]
    ds_read_b64_tr_b16 v[70:71], v15 offset:12800
    v_mfma_f32_16x16x32_bf16 v[176:179], v[40:43], v[72:75], v[176:179]
    ds_read_b128 v[212:215], v11 offset:2048
    v_mfma_f32_16x16x32_bf16 v[176:179], v[44:47], v[76:79], v[176:179]
    ds_read_b128 v[216:219], v10 offset:4096
    v_mfma_f32_16x16x32_bf16 v[180:183], v[48:51], v[72:75], v[180:183]
    ds_read_b128 v[220:223], v11 offset:4096
    v_mfma_f32_16x16x32_bf16 v[180:183], v[52:55], v[76:79], v[180:183]
    ds_read_b128 v[224:227], v10 offset:6144
    v_mfma_f32_16x16x32_bf16 v[184:187], v[24:27], v[80:83], v[184:187]
    ds_read_b64_tr_b16 v[72:73], v14 offset:16384
    v_mfma_f32_16x16x32_bf16 v[184:187], v[28:31], v[84:87], v[184:187]
    ds_read_b64_tr_b16 v[74:75], v14 offset:16896
    v_mfma_f32_16x16x32_bf16 v[188:191], v[32:35], v[80:83], v[188:191]
    ds_read_b64_tr_b16 v[76:77], v14 offset:20480
    v_mfma_f32_16x16x32_bf16 v[188:191], v[36:39], v[84:87], v[188:191]
    ds_read_b64_tr_b16 v[78:79], v14 offset:20992
    v_mfma_f32_16x16x32_bf16 v[192:195], v[40:43], v[80:83], v[192:195]
    ds_read_b128 v[228:231], v11 offset:6144
    v_mfma_f32_16x16x32_bf16 v[192:195], v[44:47], v[84:87], v[192:195]
    s_bitcmp1_b32 s42, s53
    v_mfma_f32_16x16x32_bf16 v[196:199], v[48:51], v[80:83], v[196:199]
    s_cbranch_scc1 L_side
L_back:
    v_mfma_f32_16x16x32_bf16 v[196:199], v[52:55], v[84:87], v[196:199]
    v_mfma_f32_16x16x32_bf16 v[104:107], v[88:91], v[24:27], v[104:107]
    ds_read_b64_tr_b16 v[80:81], v15 offset:16384
    v_mfma_f32_16x16x32_bf16 v[104:107], v[92:95], v[28:31], v[104:107]
    ds_read_b64_tr_b16 v[82:83], v15 offset:16896
    v_mfma_f32_16x16x32_bf16 v[112:115], v[88:91], v[32:35], v[112:115]
    ds_read_b64_tr_b16 v[84:85], v15 offset:20480
    v_mfma_f32_16x16x32_bf16 v[112:115], v[92:95], v[36:39], v[112:115]
    ds_read_b64_tr_b16 v[86:87], v15 offset:20992
    v_mfma_f32_16x16x32_bf16 v[120:123], v[88:91], v[40:43], v[120:123]
    ds_read_b32 v234, v20 offset:56
    v_mfma_f32_16x16x32_bf16 v[120:123], v[92:95], v[44:47], v[120:123]
    v_mfma_f32_16x16x32_bf16 v[128:131], v[88:91], v[48:51], v[128:131]
    v_mfma_f32_16x16x32_bf16 v[128:131], v[92:95], v[52:55], v[128:131]
    v_mfma_f32_16x16x32_bf16 v[108:111], v[96:99], v[24:27], v[108:111]
    s_waitcnt lgkmcnt(4)
    ds_read_b64_tr_b16 v[88:89], v14 offset:0
    v_mfma_f32_16x16x32_bf16 v[108:111], v[100:103], v[28:31], v[108:111]
    ds_read_b64_tr_b16 v[90:91], v14 offset:512
    v_mfma_f32_16x16x32_bf16 v[116:119], v[96:99], v[32:35], v[116:119]
    ds_read_b64_tr_b16 v[92:93], v14 offset:4096
    v_mfma_f32_16x16x32_bf16 v[116:119], v[100:103], v[36:39], v[116:119]
    ds_read_b64_tr_b16 v[94:95], v14 offset:4608
    v_mfma_f32_16x16x32_bf16 v[124:127], v[96:99], v[40:43], v[124:127]
    v_mfma_f32_16x16x32_bf16 v[124:127], v[100:103], v[44:47], v[124:127]
    v_mfma_f32_16x16x32_bf16 v[132:135], v[96:99], v[48:51], v[132:135]
    v_mfma_f32_16x16x32_bf16 v[132:135], v[100:103], v[52:55], v[132:135]
    v_mfma_f32_16x16x32_bf16 v[136:139], v[200:203], v[56:59], v[136:139]
    ds_read_b64_tr_b16 v[96:97], v15 offset:0
    v_mfma_f32_16x16x32_bf16 v[136:139], v[204:207], v[60:63], v[136:139]
    ds_read_b64_tr_b16 v[98:99], v15 offset:512
    v_mfma_f32_16x16x32_bf16 v[140:143], v[208:211], v[56:59], v[140:143]
    ds_read_b64_tr_b16 v[100:101], v15 offset:4096
    v_mfma_f32_16x16x32_bf16 v[140:143], v[212:215], v[60:63], v[140:143]
    ds_read_b64_tr_b16 v[102:103], v15 offset:4608
    v_mfma_f32_16x16x32_bf16 v[144:147], v[216:219], v[56:59], v[144:147]
    s_add_u32 s52, s52, 40960
    s_cmp_eq_u32 s52, 122880
    s_cselect_b32 s52, 0, s52
    v_mfma_f32_16x16x32_bf16 v[144:147], v[220:223], v[60:63], v[144:147]
    v_add_u32 v10, s52, v8
    v_add_u32 v11, s52, v9
    v_mfma_f32_16x16x32_bf16 v[148:151], v[224:227], v[56:59], v[148:151]
    v_add_u32 v14, s52, v12
    v_add_u32 v15, s52, v13
    v_mfma_f32_16x16x32_bf16 v[148:151], v[228:231], v[60:63], v[148:151]
    s_waitcnt lgkmcnt(0)
    v_mfma_f32_16x16x32_bf16 v[152:155], v[200:203], v[64:67], v[152:155]
    s_barrier
    v_mfma_f32_16x16x32_bf16 v[152:155], v[204:207], v[68:71], v[152:155]
    ds_read_b64_tr_b16 v[56:57], v14 offset:8192
    v_mfma_f32_16x16x32_bf16 v[156:159], v[208:211], v[64:67], v[156:159]
    ds_read_b64_tr_b16 v[58:59], v14 offset:8704
    v_mfma_f32_16x16x32_bf16 v[156:159], v[212:215], v[68:71], v[156:159]
    ds_read_b64_tr_b16 v[60:61], v14 offset:12288
    v_mfma_f32_16x16x32_bf16 v[160:163], v[216:219], v[64:67], v[160:163]
    ds_read_b64_tr_b16 v[62:63], v14 offset:12800
    v_mfma_f32_16x16x32_bf16 v[160:163], v[220:223], v[68:71], v[160:163]
    ds_read_b128 v[24:27], v10 offset:0
    v_mfma_f32_16x16x32_bf16 v[164:167], v[224:227], v[64:67], v[164:167]
    ds_read_b128 v[28:31], v11 offset:0
    v_mfma_f32_16x16x32_bf16 v[164:167], v[228:231], v[68:71], v[164:167]
    ds_read_b128 v[32:35], v10 offset:2048
    v_mfma_f32_16x16x32_bf16 v[168:171], v[200:203], v[72:75], v[168:171]
    ds_read_b64_tr_b16 v[64:65], v15 offset:8192
    v_mfma_f32_16x16x32_bf16 v[168:171], v[204:207], v[76:79], v[168:171]
    ds_read_b64_tr_b16 v[66:67], v15 offset:8704
    v_mfma_f32_16x16x32_bf16 v[172:175], v[208:211], v[72:75], v[172:175]
    ds_read_b64_tr_b16 v[68:69], v15 offset:12288
    v_mfma_f32_16x16x32_bf16 v[172:175], v[212:215], v[76:79], v[172:175]
    ds_read_b64_tr_b16 v[70:71], v15 offset:12800
    v_mfma_f32_16x16x32_bf16 v[176:179], v[216:219], v[72:75], v[176:179]
    ds_read_b128 v[36:39], v11 offset:2048
    v_mfma_f32_16x16x32_bf16 v[176:179], v[220:223], v[76:79], v[176:179]
    ds_read_b128 v[40:43], v10 offset:4096
    v_mfma_f32_16x16x32_bf16 v[180:183], v[224:227], v[72:75], v[180:183]
    ds_read_b128 v[44:47], v11 offset:4096
    v_mfma_f32_16x16x32_bf16 v[180:183], v[228:231], v[76:79], v[180:183]
    ds_read_b128 v[48:51], v10 offset:6144
    v_mfma_f32_16x16x32_bf16 v[184:187], v[200:203], v[80:83], v[184:187]
    ds_read_b64_tr_b16 v[72:73], v14 offset:16384
    v_mfma_f32_16x16x32_bf16 v[184:187], v[204:207], v[84:87], v[184:187]
    ds_read_b64_tr_b16 v[74:75], v14 offset:16896
    v_mfma_f32_16x16x32_bf16 v[188:191], v[208:211], v[80:83], v[188:191]
    ds_read_b64_tr_b16 v[76:77], v14 offset:20480
    v_mfma_f32_16x16x32_bf16 v[188:191], v[212:215], v[84:87], v[188:191]
    ds_read_b64_tr_b16 v[78:79], v14 offset:20992
    v_mfma_f32_16x16x32_bf16 v[192:195], v[216:219], v[80:83], v[192:195]
    ds_read_b128 v[52:55], v11 offset:6144
    v_mfma_f32_16x16x32_bf16 v[192:195], v[220:223], v[84:87], v[192:195]
    v_mfma_f32_16x16x32_bf16 v[196:199], v[224:227], v[80:83], v[196:199]
    v_mfma_f32_16x16x32_bf16 v[196:199], v[228:231], v[84:87], v[196:199]
    v_mfma_f32_16x16x32_bf16 v[104:107], v[88:91], v[200:203], v[104:107]
    ds_read_b64_tr_b16 v[80:81], v15 offset:16384
    v_mfma_f32_16x16x32_bf16 v[104:107], v[92:95], v[204:207], v[104:107]
    ds_read_b64_tr_b16 v[82:83], v15 offset:16896
    v_mfma_f32_16x16x32_bf16 v[112:115], v[88:91], v[208:211], v[112:115]
    ds_read_b64_tr_b16 v[84:85], v15 offset:20480
    v_mfma_f32_16x16x32_bf16 v[112:115], v[92:95], v[212:215], v[112:115]
    ds_read_b64_tr_b16 v[86:87], v15 offset:20992
    v_mfma_f32_16x16x32_bf16 v[120:123], v[88:91], v[216:219], v[120:123]
    v_mfma_f32_16x16x32_bf16 v[120:123], v[92:95], v[220:223], v[120:123]
    v_mfma_f32_16x16x32_bf16 v[128:131], v[88:91], v[224:227], v[128:131]
    v_mfma_f32_16x16x32_bf16 v[128:131], v[92:95], v[228:231], v[128:131]
    v_mfma_f32_16x16x32_bf16 v[108:111], v[96:99], v[200:203], v[108:111]
    s_waitcnt lgkmcnt(4)
    ds_read_b64_tr_b16 v[88:89], v14 offset:0
    v_mfma_f32_16x16x32_bf16 v[108:111], v[100:103], v[204:207], v[108:111]
    ds_read_b64_tr_b16 v[90:91], v14 offset:512
    v_mfma_f32_16x16x32_bf16 v[116:119], v[96:99], v[208:211], v[116:119]
    ds_read_b64_tr_b16 v[92:93], v14 offset:4096
    v_mfma_f32_16x16x32_bf16 v[116:119], v[100:103], v[212:215], v[116:119]
    ds_read_b64_tr_b16 v[94:95], v14 offset:4608
    v_mfma_f32_16x16x32_bf16 v[124:127], v[96:99], v[216:219], v[124:127]
    s_add_u32 s53, s53, 1
    v_mfma_f32_16x16x32_bf16 v[124:127], v[100:103], v[220:223], v[124:127]
    s_cmp_lt_u32 s53, 7
    v_mfma_f32_16x16x32_bf16 v[132:135], v[96:99], v[224:227], v[132:135]
    v_mfma_f32_16x16x32_bf16 v[132:135], v[100:103], v[228:231], v[132:135]
    s_cbranch_scc1 L_loop1
    v_mfma_f32_16x16x32_bf16 v[136:139], v[24:27], v[56:59], v[136:139]
    ds_read_b64_tr_b16 v[96:97], v15 offset:0
    s_mov_b32 s54, 0x3fb8aa3b
    s_mov_b32 s55, 0x3fb8aa3b
    s_mov_b32 s56, 0x358637bd
    s_lshl_b32 s57, s31, 2
    v_mfma_f32_16x16x32_bf16 v[136:139], v[28:31], v[60:63], v[136:139]
    ds_read_b64_tr_b16 v[98:99], v15 offset:512
    s_add_u32 s57, s57, s3
    s_lshl_b32 s57, s57, 4
    s_add_u32 s57, s57, s30
    s_lshl_b32 s58, s57, 10
    v_mfma_f32_16x16x32_bf16 v[140:143], v[32:35], v[56:59], v[140:143]
    ds_read_b64_tr_b16 v[100:101], v15 offset:4096
    s_add_u32 s58, s58, 0x800000
    s_lshr_b32 s59, s57, 4
    s_lshl_b32 s59, s59, 11
    s_lshl_b32 s45, s30, 4
    v_mfma_f32_16x16x32_bf16 v[140:143], v[36:39], v[60:63], v[140:143]
    ds_read_b64_tr_b16 v[102:103], v15 offset:4608
    s_add_u32 s59, s59, s45
    s_add_u32 s59, s59, 0x900000
    s_lshr_b32 s57, s57, 4
    s_lshl_b32 s57, s57, 11
    v_mfma_f32_16x16x32_bf16 v[144:147], v[40:43], v[56:59], v[144:147]
    s_add_u32 s57, s57, 0x960000
    v_and_b32 v19, 7, v4
    v_lshlrev_b32 v19, 1, v19
    v_sub_u32 v19, s30, v19
    v_mfma_f32_16x16x32_bf16 v[144:147], v[44:47], v[60:63], v[144:147]
    v_and_b32 v19, 15, v19
    v_lshl_add_u32 v19, v19, 2, v254
    s_lshl_b32 s45, s3, 11
    s_add_u32 s45, s45, 131584
    v_mfma_f32_16x16x32_bf16 v[148:151], v[48:51], v[56:59], v[148:151]
    v_add_u32 v6, s45, v5
    v_xor_b32 v7, 2048, v6
    s_lshl_b32 s45, s3, 7
    s_add_u32 s45, s45, 162304
    v_mfma_f32_16x16x32_bf16 v[148:151], v[52:55], v[60:63], v[148:151]
    v_and_b32 v3, 0x30, v4
    v_add_u32 v16, s45, v3
    v_xor_b32 v17, 128, v16
    v_xor_b32 v18, 4, v21
    v_mfma_f32_16x16x32_bf16 v[152:155], v[24:27], v[64:67], v[152:155]
    v_mov_b32 v200, 0x3f803f80
    v_mov_b32 v201, 0x3f803f80
    v_mov_b32 v202, 0x3f803f80
    v_mov_b32 v203, 0x3f803f80
    v_mfma_f32_16x16x32_bf16 v[152:155], v[28:31], v[68:71], v[152:155]
    s_waitcnt lgkmcnt(0)
    ds_write_b32 v21, v232 offset:112
    v_mfma_f32_16x16x32_bf16 v[156:159], v[32:35], v[64:67], v[156:159]
    v_mul_f32 v204, s54, v136
    v_mul_f32 v205, s54, v137
    v_mul_f32 v206, s54, v138
    v_mfma_f32_16x16x32_bf16 v[156:159], v[36:39], v[68:71], v[156:159]
    v_mul_f32 v207, s54, v139
    v_mul_f32 v208, s54, v140
    v_mul_f32 v209, s54, v141
    v_mfma_f32_16x16x32_bf16 v[160:163], v[40:43], v[64:67], v[160:163]
    v_mul_f32 v210, s54, v142
    v_mul_f32 v211, s54, v143
    v_exp_f32_e64 v204, v204 clamp
    v_mfma_f32_16x16x32_bf16 v[160:163], v[44:47], v[68:71], v[160:163]
    v_exp_f32_e64 v205, v205 clamp
    v_exp_f32_e64 v206, v206 clamp
    v_exp_f32_e64 v207, v207 clamp
    v_mfma_f32_16x16x32_bf16 v[164:167], v[48:51], v[64:67], v[164:167]
    v_exp_f32_e64 v208, v208 clamp
    v_exp_f32_e64 v209, v209 clamp
    v_exp_f32_e64 v210, v210 clamp
    v_mfma_f32_16x16x32_bf16 v[164:167], v[52:55], v[68:71], v[164:167]
    v_exp_f32_e64 v211, v211 clamp
    v_max_f32 v136, s56, v136
    v_max_f32 v137, s56, v137
    v_mfma_f32_16x16x32_bf16 v[168:171], v[24:27], v[72:75], v[168:171]
    v_max_f32 v138, s56, v138
    v_max_f32 v139, s56, v139
    v_max_f32 v140, s56, v140
    v_mfma_f32_16x16x32_bf16 v[168:171], v[28:31], v[76:79], v[168:171]
    v_max_f32 v141, s56, v141
    v_max_f32 v142, s56, v142
    v_max_f32 v143, s56, v143
    v_mfma_f32_16x16x32_bf16 v[172:175], v[32:35], v[72:75], v[172:175]
    v_add_f32 v204, v204, v136
    v_add_f32 v205, v205, v137
    v_add_f32 v206, v206, v138
    v_mfma_f32_16x16x32_bf16 v[172:175], v[36:39], v[76:79], v[172:175]
    v_add_f32 v207, v207, v139
    v_add_f32 v208, v208, v140
    v_add_f32 v209, v209, v141
    v_mfma_f32_16x16x32_bf16 v[176:179], v[40:43], v[72:75], v[176:179]
    v_add_f32 v210, v210, v142
    v_add_f32 v211, v211, v143
    v_cvt_pk_bf16_f32 v136, v204, v205
    v_mfma_f32_16x16x32_bf16 v[176:179], v[44:47], v[76:79], v[176:179]
    v_cvt_pk_bf16_f32 v137, v206, v207
    v_cvt_pk_bf16_f32 v138, v208, v209
    v_cvt_pk_bf16_f32 v139, v210, v211
    v_mfma_f32_16x16x32_bf16 v[180:183], v[48:51], v[72:75], v[180:183]
    v_mul_f32 v204, s54, v144
    v_mul_f32 v205, s54, v145
    v_mul_f32 v206, s54, v146
    v_mfma_f32_16x16x32_bf16 v[180:183], v[52:55], v[76:79], v[180:183]
    v_mul_f32 v207, s54, v147
    v_mul_f32 v208, s54, v148
    v_mul_f32 v209, s54, v149
    v_mfma_f32_16x16x32_bf16 v[184:187], v[24:27], v[80:83], v[184:187]
    v_mul_f32 v210, s54, v150
    v_mul_f32 v211, s54, v151
    v_exp_f32_e64 v204, v204 clamp
    v_mfma_f32_16x16x32_bf16 v[184:187], v[28:31], v[84:87], v[184:187]
    v_exp_f32_e64 v205, v205 clamp
    v_exp_f32_e64 v206, v206 clamp
    v_exp_f32_e64 v207, v207 clamp
    v_mfma_f32_16x16x32_bf16 v[188:191], v[32:35], v[80:83], v[188:191]
    v_exp_f32_e64 v208, v208 clamp
    v_exp_f32_e64 v209, v209 clamp
    v_exp_f32_e64 v210, v210 clamp
    v_mfma_f32_16x16x32_bf16 v[188:191], v[36:39], v[84:87], v[188:191]
    v_exp_f32_e64 v211, v211 clamp
    v_max_f32 v144, s56, v144
    v_max_f32 v145, s56, v145
    v_mfma_f32_16x16x32_bf16 v[192:195], v[40:43], v[80:83], v[192:195]
    v_max_f32 v146, s56, v146
    v_max_f32 v147, s56, v147
    v_max_f32 v148, s56, v148
    v_mfma_f32_16x16x32_bf16 v[192:195], v[44:47], v[84:87], v[192:195]
    v_max_f32 v149, s56, v149
    v_max_f32 v150, s56, v150
    v_max_f32 v151, s56, v151
    v_mfma_f32_16x16x32_bf16 v[196:199], v[48:51], v[80:83], v[196:199]
    v_add_f32 v204, v204, v144
    v_add_f32 v205, v205, v145
    v_add_f32 v206, v206, v146
    v_mfma_f32_16x16x32_bf16 v[196:199], v[52:55], v[84:87], v[196:199]
    v_add_f32 v207, v207, v147
    v_add_f32 v208, v208, v148
    v_add_f32 v209, v209, v149
    v_add_f32 v210, v210, v150
    v_add_f32 v211, v211, v151
    v_cvt_pk_bf16_f32 v140, v204, v205
    v_cvt_pk_bf16_f32 v141, v206, v207
    v_cvt_pk_bf16_f32 v142, v208, v209
    v_cvt_pk_bf16_f32 v143, v210, v211
    s_setprio 2
    v_cvt_pk_bf16_f32 v168, v168, v169
    v_cvt_pk_bf16_f32 v169, v170, v171
    v_cvt_pk_bf16_f32 v170, v172, v173
    v_cvt_pk_bf16_f32 v171, v174, v175
    v_cvt_pk_bf16_f32 v172, v176, v177
    v_cvt_pk_bf16_f32 v173, v178, v179
    v_cvt_pk_bf16_f32 v174, v180, v181
    v_cvt_pk_bf16_f32 v175, v182, v183
    v_cvt_pk_bf16_f32 v176, v184, v185
    v_cvt_pk_bf16_f32 v177, v186, v187
    v_cvt_pk_bf16_f32 v178, v188, v189
    v_cvt_pk_bf16_f32 v179, v190, v191
    v_cvt_pk_bf16_f32 v180, v192, v193
    v_cvt_pk_bf16_f32 v181, v194, v195
    v_cvt_pk_bf16_f32 v182, v196, v197
    v_cvt_pk_bf16_f32 v183, v198, v199
    s_nop 1
    v_mfma_f32_16x16x32_bf16 v[212:215], v[136:139], v[168:171], 0
    v_mfma_f32_16x16x32_bf16 v[220:223], v[136:139], v[176:179], 0
    v_mfma_f32_16x16x32_bf16 v[56:59], v[136:139], v[200:203], 0
    v_mfma_f32_16x16x32_bf16 v[212:215], v[140:143], v[172:175], v[212:215]
    v_mfma_f32_16x16x32_bf16 v[220:223], v[140:143], v[180:183], v[220:223]
    v_mfma_f32_16x16x32_bf16 v[56:59], v[140:143], v[200:203], v[56:59]
    v_pk_mul_f32 v[204:205], v[152:153], s[54:55]
    v_pk_mul_f32 v[206:207], v[154:155], s[54:55]
    v_pk_mul_f32 v[208:209], v[156:157], s[54:55]
    v_pk_mul_f32 v[210:211], v[158:159], s[54:55]
    v_exp_f32_e64 v204, v204 clamp
    v_exp_f32_e64 v205, v205 clamp
    v_exp_f32_e64 v206, v206 clamp
    v_exp_f32_e64 v207, v207 clamp
    v_exp_f32_e64 v208, v208 clamp
    v_exp_f32_e64 v209, v209 clamp
    v_exp_f32_e64 v210, v210 clamp
    v_exp_f32_e64 v211, v211 clamp
    v_max_f32 v152, s56, v152
    v_max_f32 v153, s56, v153
    v_max_f32 v154, s56, v154
    v_max_f32 v155, s56, v155
    v_max_f32 v156, s56, v156
    v_max_f32 v157, s56, v157
    v_max_f32 v158, s56, v158
    v_max_f32 v159, s56, v159
    v_pk_add_f32 v[204:205], v[204:205], v[152:153]
    v_pk_add_f32 v[206:207], v[206:207], v[154:155]
    v_pk_add_f32 v[208:209], v[208:209], v[156:157]
    v_pk_add_f32 v[210:211], v[210:211], v[158:159]
    v_cvt_pk_bf16_f32 v152, v204, v205
    v_cvt_pk_bf16_f32 v153, v206, v207
    v_cvt_pk_bf16_f32 v154, v208, v209
    v_cvt_pk_bf16_f32 v155, v210, v211
    v_pk_mul_f32 v[204:205], v[160:161], s[54:55]
    v_pk_mul_f32 v[206:207], v[162:163], s[54:55]
    v_pk_mul_f32 v[208:209], v[164:165], s[54:55]
    v_pk_mul_f32 v[210:211], v[166:167], s[54:55]
    v_exp_f32_e64 v204, v204 clamp
    v_exp_f32_e64 v205, v205 clamp
    v_exp_f32_e64 v206, v206 clamp
    v_exp_f32_e64 v207, v207 clamp
    v_exp_f32_e64 v208, v208 clamp
    v_exp_f32_e64 v209, v209 clamp
    v_exp_f32_e64 v210, v210 clamp
    v_exp_f32_e64 v211, v211 clamp
    v_max_f32 v160, s56, v160
    v_max_f32 v161, s56, v161
    v_max_f32 v162, s56, v162
    v_max_f32 v163, s56, v163
    v_max_f32 v164, s56, v164
    v_max_f32 v165, s56, v165
    v_max_f32 v166, s56, v166
    v_max_f32 v167, s56, v167
    v_pk_add_f32 v[204:205], v[204:205], v[160:161]
    v_pk_add_f32 v[206:207], v[206:207], v[162:163]
    v_pk_add_f32 v[208:209], v[208:209], v[164:165]
    v_pk_add_f32 v[210:211], v[210:211], v[166:167]
    v_cvt_pk_bf16_f32 v156, v204, v205
    v_cvt_pk_bf16_f32 v157, v206, v207
    v_cvt_pk_bf16_f32 v158, v208, v209
    v_cvt_pk_bf16_f32 v159, v210, v211
    s_nop 1
    v_mfma_f32_16x16x32_bf16 v[216:219], v[152:155], v[168:171], 0
    v_mfma_f32_16x16x32_bf16 v[224:227], v[152:155], v[176:179], 0
    v_mfma_f32_16x16x32_bf16 v[60:63], v[152:155], v[200:203], 0
    v_mfma_f32_16x16x32_bf16 v[216:219], v[156:159], v[172:175], v[216:219]
    v_mfma_f32_16x16x32_bf16 v[224:227], v[156:159], v[180:183], v[224:227]
    v_mfma_f32_16x16x32_bf16 v[60:63], v[156:159], v[200:203], v[60:63]
    s_cmp_eq_u32 s40, 0
    s_nop 5
    s_cbranch_scc1 L_x0
    v_swap_b32 v212, v220
    v_swap_b32 v213, v221
    v_swap_b32 v214, v222
    v_swap_b32 v215, v223
    v_swap_b32 v216, v224
    v_swap_b32 v217, v225
    v_swap_b32 v218, v226
    v_swap_b32 v219, v227
L_x0:
    ds_write_b128 v6, v[220:223]
    ds_write_b128 v6, v[224:227] offset:1024
    ds_write_b128 v16, v[56:59]
    ds_write_b128 v16, v[60:63] offset:64
    ds_write_b32 v21, v232 offset:0
    s_mov_b32 s45, 0
L_xspin:
    ds_read_b32 v235, v18 offset:0
    ds_read_b128 v[236:239], v7
    ds_read_b128 v[240:243], v7 offset:1024
    ds_read_b128 v[244:247], v17
    ds_read_b128 v[248:251], v17 offset:64
    s_add_u32 s45, s45, 1
    s_waitcnt lgkmcnt(4)
    v_readfirstlane_b32 s46, v235
    s_cmp_gt_u32 s45, 0x40000
    s_cbranch_scc1 L_xdone
    s_cmp_eq_u32 s46, 0
    s_cbranch_scc1 L_xspin
L_xdone:
    s_waitcnt lgkmcnt(2)
    v_pk_add_f32 v[212:213], v[212:213], v[236:237]
    v_pk_add_f32 v[214:215], v[214:215], v[238:239]
    v_pk_add_f32 v[216:217], v[216:217], v[240:241]
    v_pk_add_f32 v[218:219], v[218:219], v[242:243]
    v_cvt_pk_bf16_f32 v220, v212, v213
    v_cvt_pk_bf16_f32 v221, v214, v215
    v_cvt_pk_bf16_f32 v222, v216, v217
    v_cvt_pk_bf16_f32 v223, v218, v219
    buffer_store_dwordx4 v[220:223], v5, s[60:63], s58 offen sc1
    s_waitcnt lgkmcnt(0)
    v_pk_add_f32 v[56:57], v[56:57], v[244:245]
    v_pk_add_f32 v[58:59], v[58:59], v[246:247]
    v_pk_add_f32 v[60:61], v[60:61], v[248:249]
    v_pk_add_f32 v[62:63], v[62:63], v[250:251]
    v_cvt_pk_bf16_f32 v224, v56, v57
    v_cvt_pk_bf16_f32 v225, v58, v59
    v_cvt_pk_bf16_f32 v226, v60, v61
    v_cvt_pk_bf16_f32 v227, v62, v63
    s_mov_b32 exec_lo, 0x10001
    s_mov_b32 exec_hi, 0x10001
    buffer_store_dwordx4 v[224:227], v5, s[60:63], s59 offen sc1
    s_mov_b64 exec, -1
    ds_write_b32 v21, v232 offset:128
    v_mfma_f32_16x16x32_bf16 v[104:107], v[88:91], v[24:27], v[104:107]
    s_lshl_b32 s47, s32, 1
    s_add_u32 s47, s47, s41
    s_lshl_b32 s44, s32, 2
    s_add_u32 s44, s44, s3
    v_mfma_f32_16x16x32_bf16 v[104:107], v[92:95], v[28:31], v[104:107]
    s_lshl_b32 s58, s44, 14
    s_add_u32 s58, s58, 0x800000
    s_lshl_b32 s59, s44, 11
    s_add_u32 s59, s59, 0x900000
    v_mfma_f32_16x16x32_bf16 v[108:111], v[96:99], v[24:27], v[108:111]
    s_lshl_b32 s44, s44, 6
    s_lshr_b32 vcc_lo, s44, 6
    s_mul_i32 vcc_lo, vcc_lo, 1984
    s_add_u32 s44, s44, vcc_lo
    v_mfma_f32_16x16x32_bf16 v[108:111], v[100:103], v[28:31], v[108:111]
    s_add_u32 s44, s44, 0x960000
    s_lshl_b32 vcc_lo, s30, 7
    s_add_u32 s44, s44, vcc_lo
    s_lshl_b32 s45, s41, 2
    v_mfma_f32_16x16x32_bf16 v[112:115], v[88:91], v[32:35], v[112:115]
    v_add_u32 v14, s45, v20
    v_mov_b32 v6, 0x3f80
    v_and_b32 v7, 1, v4
    v_lshlrev_b32 v7, 4, v7
    v_mfma_f32_16x16x32_bf16 v[112:115], v[92:95], v[36:39], v[112:115]
    v_lshlrev_b32 v6, v7, v6
    v_lshrrev_b32 v2, 4, v4
    v_cmp_eq_u32 vcc, v2, v22
    v_bfe_u32 v7, v4, 1, 1
    v_mfma_f32_16x16x32_bf16 v[116:119], v[96:99], v[32:35], v[116:119]
    v_mov_b32 v8, 0
    v_cndmask_b32 v6, 0, v6, vcc
    v_cmp_eq_u32 vcc, 0, v7
    v_mov_b32 v9, 0
    v_mfma_f32_16x16x32_bf16 v[116:119], v[100:103], v[36:39], v[116:119]
    v_mov_b32 v12, 0
    v_cndmask_b32 v10, 0, v6, vcc
    v_cndmask_b32 v11, v6, v233, vcc
    v_mov_b32 v13, 0
    v_mfma_f32_16x16x32_bf16 v[120:123], v[88:91], v[40:43], v[120:123]
    s_lshl_b32 s45, s3, 10
    s_add_u32 s45, s45, 158208
    v_add_u32 v6, s45, v5
    s_xor_b32 s45, s3, 1
    v_mfma_f32_16x16x32_bf16 v[120:123], v[92:95], v[44:47], v[120:123]
    s_lshl_b32 s45, s45, 10
    s_add_u32 s45, s45, 158208
    v_add_u32 v7, s45, v5
    s_lshl_b32 s48, s30, 3
    v_mfma_f32_16x16x32_bf16 v[124:127], v[96:99], v[40:43], v[124:127]
    s_lshl_b32 s45, s40, 2
    s_add_u32 s48, s48, s45
    s_lshl_b32 s48, s48, 15
    s_lshl_b32 s45, s47, 10
    v_mfma_f32_16x16x32_bf16 v[124:127], v[100:103], v[44:47], v[124:127]
    s_add_u32 s48, s48, s45
    s_add_u32 s48, s48, 0x400000
    s_lshl_b32 s49, s30, 1
    s_add_u32 s49, s49, s40
    v_mfma_f32_16x16x32_bf16 v[128:131], v[88:91], v[48:51], v[128:131]
    s_lshl_b32 s49, s49, 7
    s_lshl_b32 s45, s47, 2
    s_add_u32 s49, s49, s45
    s_lshr_b32 vcc_lo, s49, 6
    v_mfma_f32_16x16x32_bf16 v[128:131], v[92:95], v[52:55], v[128:131]
    s_mul_i32 vcc_lo, vcc_lo, 1984
    s_add_u32 s49, s49, vcc_lo
    s_add_u32 s49, s49, 0x980000
    s_mov_b32 s50, 0
    v_mfma_f32_16x16x32_bf16 v[132:135], v[96:99], v[48:51], v[132:135]
    s_mov_b32 s51, 0
    s_mov_b32 s53, 0
    s_mov_b32 s46, 0
    s_and_b32 s43, s30, 7
    v_mfma_f32_16x16x32_bf16 v[132:135], v[100:103], v[52:55], v[132:135]
    v_mul_f32 v204, s54, v104
    v_mul_f32 v205, s54, v105
    v_mul_f32 v206, s54, v106
    v_mul_f32 v207, s54, v107
    v_mul_f32 v208, s54, v108
    v_mul_f32 v209, s54, v109
    v_mul_f32 v210, s54, v110
    v_mul_f32 v211, s54, v111
    v_exp_f32_e64 v204, v204 clamp
    v_exp_f32_e64 v205, v205 clamp
    v_exp_f32_e64 v206, v206 clamp
    v_exp_f32_e64 v207, v207 clamp
    v_exp_f32_e64 v208, v208 clamp
    v_exp_f32_e64 v209, v209 clamp
    v_exp_f32_e64 v210, v210 clamp
    v_exp_f32_e64 v211, v211 clamp
    v_max_f32 v104, s56, v104
    v_max_f32 v105, s56, v105
    v_max_f32 v106, s56, v106
    v_max_f32 v107, s56, v107
    v_max_f32 v108, s56, v108
    v_max_f32 v109, s56, v109
    v_max_f32 v110, s56, v110
    v_max_f32 v111, s56, v111
    v_add_f32 v204, v204, v104
    v_add_f32 v205, v205, v105
    v_add_f32 v206, v206, v106
    v_add_f32 v207, v207, v107
    v_add_f32 v208, v208, v108
    v_add_f32 v209, v209, v109
    v_add_f32 v210, v210, v110
    v_add_f32 v211, v211, v111
    v_cvt_pk_bf16_f32 v104, v204, v205
    v_cvt_pk_bf16_f32 v105, v206, v207
    v_cvt_pk_bf16_f32 v106, v208, v209
    v_cvt_pk_bf16_f32 v107, v210, v211
    v_mul_f32 v204, s54, v112
    v_mul_f32 v205, s54, v113
    v_mul_f32 v206, s54, v114
    v_mul_f32 v207, s54, v115
    v_mul_f32 v208, s54, v116
    v_mul_f32 v209, s54, v117
    v_mul_f32 v210, s54, v118
    v_mul_f32 v211, s54, v119
    v_exp_f32_e64 v204, v204 clamp
    v_exp_f32_e64 v205, v205 clamp
    v_exp_f32_e64 v206, v206 clamp
    v_exp_f32_e64 v207, v207 clamp
    v_exp_f32_e64 v208, v208 clamp
    v_exp_f32_e64 v209, v209 clamp
    v_exp_f32_e64 v210, v210 clamp
    v_exp_f32_e64 v211, v211 clamp
    v_max_f32 v112, s56, v112
    v_max_f32 v113, s56, v113
    v_max_f32 v114, s56, v114
    v_max_f32 v115, s56, v115
    v_max_f32 v116, s56, v116
    v_max_f32 v117, s56, v117
    v_max_f32 v118, s56, v118
    v_max_f32 v119, s56, v119
    v_add_f32 v204, v204, v112
    v_add_f32 v205, v205, v113
    v_add_f32 v206, v206, v114
    v_add_f32 v207, v207, v115
    v_add_f32 v208, v208, v116
    v_add_f32 v209, v209, v117
    v_add_f32 v210, v210, v118
    v_add_f32 v211, v211, v119
    v_cvt_pk_bf16_f32 v108, v204, v205
    v_cvt_pk_bf16_f32 v109, v206, v207
    v_cvt_pk_bf16_f32 v110, v208, v209
    v_cvt_pk_bf16_f32 v111, v210, v211
    s_waitcnt vmcnt(0)
    s_mov_b64 exec, 0xffff
    buffer_store_dword v234, v19, s[60:63], s57 offen sc1
    s_mov_b64 exec, -1
    s_load_dwordx16 s[4:19], s[26:27], s44 glc
    v_mul_f32 v204, s54, v120
    v_mul_f32 v205, s54, v121
    v_mul_f32 v206, s54, v122
    v_mul_f32 v207, s54, v123
    v_mul_f32 v208, s54, v124
    v_mul_f32 v209, s54, v125
    v_mul_f32 v210, s54, v126
    v_mul_f32 v211, s54, v127
    v_exp_f32_e64 v204, v204 clamp
    v_exp_f32_e64 v205, v205 clamp
    v_exp_f32_e64 v206, v206 clamp
    v_exp_f32_e64 v207, v207 clamp
    v_exp_f32_e64 v208, v208 clamp
    v_exp_f32_e64 v209, v209 clamp
    v_exp_f32_e64 v210, v210 clamp
    v_exp_f32_e64 v211, v211 clamp
    v_max_f32 v120, s56, v120
    v_max_f32 v121, s56, v121
    v_max_f32 v122, s56, v122
    v_max_f32 v123, s56, v123
    v_max_f32 v124, s56, v124
    v_max_f32 v125, s56, v125
    v_max_f32 v126, s56, v126
    v_max_f32 v127, s56, v127
    v_add_f32 v204, v204, v120
    v_add_f32 v205, v205, v121
    v_add_f32 v206, v206, v122
    v_add_f32 v207, v207, v123
    v_add_f32 v208, v208, v124
    v_add_f32 v209, v209, v125
    v_add_f32 v210, v210, v126
    v_add_f32 v211, v211, v127
    v_cvt_pk_bf16_f32 v112, v204, v205
    v_cvt_pk_bf16_f32 v113, v206, v207
    v_cvt_pk_bf16_f32 v114, v208, v209
    v_cvt_pk_bf16_f32 v115, v210, v211
    v_mul_f32 v204, s54, v128
    v_mul_f32 v205, s54, v129
    v_mul_f32 v206, s54, v130
    v_mul_f32 v207, s54, v131
    v_mul_f32 v208, s54, v132
    v_mul_f32 v209, s54, v133
    v_mul_f32 v210, s54, v134
    v_mul_f32 v211, s54, v135
    v_exp_f32_e64 v204, v204 clamp
    v_exp_f32_e64 v205, v205 clamp
    v_exp_f32_e64 v206, v206 clamp
    v_exp_f32_e64 v207, v207 clamp
    v_exp_f32_e64 v208, v208 clamp
    v_exp_f32_e64 v209, v209 clamp
    v_exp_f32_e64 v210, v210 clamp
    v_exp_f32_e64 v211, v211 clamp
    v_max_f32 v128, s56, v128
    v_max_f32 v129, s56, v129
    v_max_f32 v130, s56, v130
    v_max_f32 v131, s56, v131
    v_max_f32 v132, s56, v132
    v_max_f32 v133, s56, v133
    v_max_f32 v134, s56, v134
    v_max_f32 v135, s56, v135
    v_add_f32 v204, v204, v128
    v_add_f32 v205, v205, v129
    v_add_f32 v206, v206, v130
    v_add_f32 v207, v207, v131
    v_add_f32 v208, v208, v132
    v_add_f32 v209, v209, v133
    v_add_f32 v210, v210, v134
    v_add_f32 v211, v211, v135
    v_cvt_pk_bf16_f32 v116, v204, v205
    v_cvt_pk_bf16_f32 v117, v206, v207
    v_cvt_pk_bf16_f32 v118, v208, v209
    v_cvt_pk_bf16_f32 v119, v210, v211
    v_mov_b64 v[88:89], 0
    v_mov_b64 v[138:139], 0
    v_mov_b32 v168, s56
    v_mov_b64 v[90:91], 0
    v_mov_b64 v[142:143], 0
    v_mov_b32 v169, s56
    v_mov_b64 v[92:93], 0
    v_mov_b64 v[146:147], 0
    v_mov_b32 v170, s56
    v_mov_b64 v[94:95], 0
    v_mov_b64 v[150:151], 0
    v_mov_b32 v171, s56
    s_setprio 3
    s_cmp_eq_u32 s46, 0
    s_cbranch_scc1 L_poll0
L_go0:
    s_ff1_i32_b32 s45, s46
    s_bitset0_b32 s46, s45
    s_add_u32 s45, s45, s43
    s_and_b32 s45, s45, 7
    s_lshl_b32 s45, s45, 11
    s_add_u32 s45, s45, s58
    buffer_load_dwordx4 v[24:27], v5, s[60:63], s45 offen offset:0 sc1
    buffer_load_dwordx4 v[28:31], v5, s[60:63], s45 offen offset:1024 sc1
    s_bitset1_b32 s51, 0
    s_cmp_eq_u32 s46, 0
    s_cbranch_scc1 L_poll1
L_go1:
    s_ff1_i32_b32 s45, s46
    s_bitset0_b32 s46, s45
    s_add_u32 s45, s45, s43
    s_and_b32 s45, s45, 7
    s_lshl_b32 s45, s45, 11
    s_add_u32 s45, s45, s58
    buffer_load_dwordx4 v[32:35], v5, s[60:63], s45 offen offset:0 sc1
    buffer_load_dwordx4 v[36:39], v5, s[60:63], s45 offen offset:1024 sc1
    s_bitset1_b32 s51, 1
    s_cmp_eq_u32 s46, 0
    s_cbranch_scc1 L_poll2
L_go2:
    s_ff1_i32_b32 s45, s46
    s_bitset0_b32 s46, s45
    s_add_u32 s45, s45, s43
    s_and_b32 s45, s45, 7
    s_lshl_b32 s45, s45, 11
    s_add_u32 s45, s45, s58
    buffer_load_dwordx4 v[40:43], v5, s[60:63], s45 offen offset:0 sc1
    buffer_load_dwordx4 v[44:47], v5, s[60:63], s45 offen offset:1024 sc1
    s_bitset1_b32 s51, 2
    s_cmp_eq_u32 s46, 0
    s_cbranch_scc1 L_poll3
L_go3:
    s_ff1_i32_b32 s45, s46
    s_bitset0_b32 s46, s45
    s_add_u32 s45, s45, s43
    s_and_b32 s45, s45, 7
    s_lshl_b32 s45, s45, 11
    s_add_u32 s45, s45, s58
    buffer_load_dwordx4 v[48:51], v5, s[60:63], s45 offen offset:0 sc1
    buffer_load_dwordx4 v[52:55], v5, s[60:63], s45 offen offset:1024 sc1
    s_bitset1_b32 s51, 3
    s_cmp_eq_u32 s46, 0
    s_cbranch_scc1 L_poll4
L_go4:
    s_ff1_i32_b32 s45, s46
    s_bitset0_b32 s46, s45
    s_add_u32 s45, s45, s43
    s_and_b32 s45, s45, 7
    s_lshl_b32 s45, s45, 11
    s_add_u32 s45, s45, s58
    buffer_load_dwordx4 v[56:59], v5, s[60:63], s45 offen offset:0 sc1
    buffer_load_dwordx4 v[60:63], v5, s[60:63], s45 offen offset:1024 sc1
    s_bitset1_b32 s51, 4
    s_cmp_eq_u32 s46, 0
    s_cbranch_scc1 L_poll5
L_go5:
    s_ff1_i32_b32 s45, s46
    s_bitset0_b32 s46, s45
    s_add_u32 s45, s45, s43
    s_and_b32 s45, s45, 7
    s_lshl_b32 s45, s45, 11
    s_add_u32 s45, s45, s58
    buffer_load_dwordx4 v[64:67], v5, s[60:63], s45 offen offset:0 sc1
    buffer_load_dwordx4 v[68:71], v5, s[60:63], s45 offen offset:1024 sc1
    s_bitset1_b32 s51, 5
    s_cmp_eq_u32 s46, 0
    s_cbranch_scc1 L_poll6
L_go6:
    s_ff1_i32_b32 s45, s46
    s_bitset0_b32 s46, s45
    s_add_u32 s45, s45, s43
    s_and_b32 s45, s45, 7
    s_lshl_b32 s45, s45, 11
    s_add_u32 s45, s45, s58
    buffer_load_dwordx4 v[72:75], v5, s[60:63], s45 offen offset:0 sc1
    buffer_load_dwordx4 v[76:79], v5, s[60:63], s45 offen offset:1024 sc1
    s_bitset1_b32 s51, 6
    s_cmp_eq_u32 s46, 0
    s_cbranch_scc1 L_poll7
L_go7:
    s_ff1_i32_b32 s45, s46
    s_bitset0_b32 s46, s45
    s_add_u32 s45, s45, s43
    s_and_b32 s45, s45, 7
    s_lshl_b32 s45, s45, 11
    s_add_u32 s45, s45, s58
    buffer_load_dwordx4 v[80:83], v5, s[60:63], s45 offen offset:0 sc1
    buffer_load_dwordx4 v[84:87], v5, s[60:63], s45 offen offset:1024 sc1
    s_bitset1_b32 s51, 7
    s_branch L_fin
L_poll0:
    s_waitcnt lgkmcnt(0)
    s_cmp_eq_u64 s[18:19], s[72:73]
    s_addc_u32 s46, s46, s46
    s_cmp_eq_u64 s[16:17], s[72:73]
    s_addc_u32 s46, s46, s46
    s_cmp_eq_u64 s[14:15], s[72:73]
    s_addc_u32 s46, s46, s46
    s_cmp_eq_u64 s[12:13], s[72:73]
    s_addc_u32 s46, s46, s46
    s_cmp_eq_u64 s[10:11], s[72:73]
    s_addc_u32 s46, s46, s46
    s_cmp_eq_u64 s[8:9], s[72:73]
    s_addc_u32 s46, s46, s46
    s_cmp_eq_u64 s[6:7], s[72:73]
    s_addc_u32 s46, s46, s46
    s_cmp_eq_u64 s[4:5], s[72:73]
    s_addc_u32 s46, s46, s46
    s_add_u32 s53, s53, 1
    s_cmp_gt_u32 s53, 0x8000
    s_cselect_b32 s46, 0xff, s46
    s_andn2_b32 s46, s46, s50
    s_or_b32 s50, s50, s46
    s_cmp_eq_u32 s50, 0xff
    s_cbranch_scc0 L_pm0
    buffer_load_dwordx4 v[96:99], v5, s[60:63], s59 offen sc1
    s_mov_b32 s47, s51
    s_mov_b32 s52, 0
    s_branch L_go0
L_pm0:
    s_load_dwordx16 s[4:19], s[26:27], s44 glc
    s_cmp_lg_u32 s46, 0
    s_cbranch_scc1 L_go0
    s_branch L_poll0
L_poll1:
    s_waitcnt lgkmcnt(0)
    s_cmp_eq_u64 s[18:19], s[72:73]
    s_addc_u32 s46, s46, s46
    s_cmp_eq_u64 s[16:17], s[72:73]
    s_addc_u32 s46, s46, s46
    s_cmp_eq_u64 s[14:15], s[72:73]
    s_addc_u32 s46, s46, s46
    s_cmp_eq_u64 s[12:13], s[72:73]
    s_addc_u32 s46, s46, s46
    s_cmp_eq_u64 s[10:11], s[72:73]
    s_addc_u32 s46, s46, s46
    s_cmp_eq_u64 s[8:9], s[72:73]
    s_addc_u32 s46, s46, s46
    s_cmp_eq_u64 s[6:7], s[72:73]
    s_addc_u32 s46, s46, s46
    s_cmp_eq_u64 s[4:5], s[72:73]
    s_addc_u32 s46, s46, s46
    s_add_u32 s53, s53, 1
    s_cmp_gt_u32 s53, 0x8000
    s_cselect_b32 s46, 0xff, s46
    s_andn2_b32 s46, s46, s50
    s_or_b32 s50, s50, s46
    s_cmp_eq_u32 s50, 0xff
    s_cbranch_scc0 L_pm1
    buffer_load_dwordx4 v[96:99], v5, s[60:63], s59 offen sc1
    s_mov_b32 s47, s51
    s_mov_b32 s52, 1
    s_branch L_go1
L_pm1:
    s_load_dwordx16 s[4:19], s[26:27], s44 glc
    s_cmp_lg_u32 s46, 0
    s_cbranch_scc1 L_go1
    s_cmp_eq_u32 s51, 0
    s_cbranch_scc1 L_poll1
    s_mov_b32 s52, 1
    s_branch L_acc
L_poll2:
    s_waitcnt lgkmcnt(0)
    s_cmp_eq_u64 s[18:19], s[72:73]
    s_addc_u32 s46, s46, s46
    s_cmp_eq_u64 s[16:17], s[72:73]
    s_addc_u32 s46, s46, s46
    s_cmp_eq_u64 s[14:15], s[72:73]
    s_addc_u32 s46, s46, s46
    s_cmp_eq_u64 s[12:13], s[72:73]
    s_addc_u32 s46, s46, s46
    s_cmp_eq_u64 s[10:11], s[72:73]
    s_addc_u32 s46, s46, s46
    s_cmp_eq_u64 s[8:9], s[72:73]
    s_addc_u32 s46, s46, s46
    s_cmp_eq_u64 s[6:7], s[72:73]
    s_addc_u32 s46, s46, s46
    s_cmp_eq_u64 s[4:5], s[72:73]
    s_addc_u32 s46, s46, s46
    s_add_u32 s53, s53, 1
    s_cmp_gt_u32 s53, 0x8000
    s_cselect_b32 s46, 0xff, s46
    s_andn2_b32 s46, s46, s50
    s_or_b32 s50, s50, s46
    s_cmp_eq_u32 s50, 0xff
    s_cbranch_scc0 L_pm2
    buffer_load_dwordx4 v[96:99], v5, s[60:63], s59 offen sc1
    s_mov_b32 s47, s51
    s_mov_b32 s52, 2
    s_branch L_go2
L_pm2:
    s_load_dwordx16 s[4:19], s[26:27], s44 glc
    s_cmp_lg_u32 s46, 0
    s_cbranch_scc1 L_go2
    s_cmp_eq_u32 s51, 0
    s_cbranch_scc1 L_poll2
    s_mov_b32 s52, 2
    s_branch L_acc
L_poll3:
    s_waitcnt lgkmcnt(0)
    s_cmp_eq_u64 s[18:19], s[72:73]
    s_addc_u32 s46, s46, s46
    s_cmp_eq_u64 s[16:17], s[72:73]
    s_addc_u32 s46, s46, s46
    s_cmp_eq_u64 s[14:15], s[72:73]
    s_addc_u32 s46, s46, s46
    s_cmp_eq_u64 s[12:13], s[72:73]
    s_addc_u32 s46, s46, s46
    s_cmp_eq_u64 s[10:11], s[72:73]
    s_addc_u32 s46, s46, s46
    s_cmp_eq_u64 s[8:9], s[72:73]
    s_addc_u32 s46, s46, s46
    s_cmp_eq_u64 s[6:7], s[72:73]
    s_addc_u32 s46, s46, s46
    s_cmp_eq_u64 s[4:5], s[72:73]
    s_addc_u32 s46, s46, s46
    s_add_u32 s53, s53, 1
    s_cmp_gt_u32 s53, 0x8000
    s_cselect_b32 s46, 0xff, s46
    s_andn2_b32 s46, s46, s50
    s_or_b32 s50, s50, s46
    s_cmp_eq_u32 s50, 0xff
    s_cbranch_scc0 L_pm3
    buffer_load_dwordx4 v[96:99], v5, s[60:63], s59 offen sc1
    s_mov_b32 s47, s51
    s_mov_b32 s52, 3
    s_branch L_go3
L_pm3:
    s_load_dwordx16 s[4:19], s[26:27], s44 glc
    s_cmp_lg_u32 s46, 0
    s_cbranch_scc1 L_go3
    s_cmp_eq_u32 s51, 0
    s_cbranch_scc1 L_poll3
    s_mov_b32 s52, 3
    s_branch L_acc
L_poll4:
    s_waitcnt lgkmcnt(0)
    s_cmp_eq_u64 s[18:19], s[72:73]
    s_addc_u32 s46, s46, s46
    s_cmp_eq_u64 s[16:17], s[72:73]
    s_addc_u32 s46, s46, s46
    s_cmp_eq_u64 s[14:15], s[72:73]
    s_addc_u32 s46, s46, s46
    s_cmp_eq_u64 s[12:13], s[72:73]
    s_addc_u32 s46, s46, s46
    s_cmp_eq_u64 s[10:11], s[72:73]
    s_addc_u32 s46, s46, s46
    s_cmp_eq_u64 s[8:9], s[72:73]
    s_addc_u32 s46, s46, s46
    s_cmp_eq_u64 s[6:7], s[72:73]
    s_addc_u32 s46, s46, s46
    s_cmp_eq_u64 s[4:5], s[72:73]
    s_addc_u32 s46, s46, s46
    s_add_u32 s53, s53, 1
    s_cmp_gt_u32 s53, 0x8000
    s_cselect_b32 s46, 0xff, s46
    s_andn2_b32 s46, s46, s50
    s_or_b32 s50, s50, s46
    s_cmp_eq_u32 s50, 0xff
    s_cbranch_scc0 L_pm4
    buffer_load_dwordx4 v[96:99], v5, s[60:63], s59 offen sc1
    s_mov_b32 s47, s51
    s_mov_b32 s52, 4
    s_branch L_go4
L_pm4:
    s_load_dwordx16 s[4:19], s[26:27], s44 glc
    s_cmp_lg_u32 s46, 0
    s_cbranch_scc1 L_go4
    s_cmp_eq_u32 s51, 0
    s_cbranch_scc1 L_poll4
    s_mov_b32 s52, 4
    s_branch L_acc
L_poll5:
    s_waitcnt lgkmcnt(0)
    s_cmp_eq_u64 s[18:19], s[72:73]
    s_addc_u32 s46, s46, s46
    s_cmp_eq_u64 s[16:17], s[72:73]
    s_addc_u32 s46, s46, s46
    s_cmp_eq_u64 s[14:15], s[72:73]
    s_addc_u32 s46, s46, s46
    s_cmp_eq_u64 s[12:13], s[72:73]
    s_addc_u32 s46, s46, s46
    s_cmp_eq_u64 s[10:11], s[72:73]
    s_addc_u32 s46, s46, s46
    s_cmp_eq_u64 s[8:9], s[72:73]
    s_addc_u32 s46, s46, s46
    s_cmp_eq_u64 s[6:7], s[72:73]
    s_addc_u32 s46, s46, s46
    s_cmp_eq_u64 s[4:5], s[72:73]
    s_addc_u32 s46, s46, s46
    s_add_u32 s53, s53, 1
    s_cmp_gt_u32 s53, 0x8000
    s_cselect_b32 s46, 0xff, s46
    s_andn2_b32 s46, s46, s50
    s_or_b32 s50, s50, s46
    s_cmp_eq_u32 s50, 0xff
    s_cbranch_scc0 L_pm5
    buffer_load_dwordx4 v[96:99], v5, s[60:63], s59 offen sc1
    s_mov_b32 s47, s51
    s_mov_b32 s52, 5
    s_branch L_go5
L_pm5:
    s_load_dwordx16 s[4:19], s[26:27], s44 glc
    s_cmp_lg_u32 s46, 0
    s_cbranch_scc1 L_go5
    s_cmp_eq_u32 s51, 0
    s_cbranch_scc1 L_poll5
    s_mov_b32 s52, 5
    s_branch L_acc
L_poll6:
    s_waitcnt lgkmcnt(0)
    s_cmp_eq_u64 s[18:19], s[72:73]
    s_addc_u32 s46, s46, s46
    s_cmp_eq_u64 s[16:17], s[72:73]
    s_addc_u32 s46, s46, s46
    s_cmp_eq_u64 s[14:15], s[72:73]
    s_addc_u32 s46, s46, s46
    s_cmp_eq_u64 s[12:13], s[72:73]
    s_addc_u32 s46, s46, s46
    s_cmp_eq_u64 s[10:11], s[72:73]
    s_addc_u32 s46, s46, s46
    s_cmp_eq_u64 s[8:9], s[72:73]
    s_addc_u32 s46, s46, s46
    s_cmp_eq_u64 s[6:7], s[72:73]
    s_addc_u32 s46, s46, s46
    s_cmp_eq_u64 s[4:5], s[72:73]
    s_addc_u32 s46, s46, s46
    s_add_u32 s53, s53, 1
    s_cmp_gt_u32 s53, 0x8000
    s_cselect_b32 s46, 0xff, s46
    s_andn2_b32 s46, s46, s50
    s_or_b32 s50, s50, s46
    s_cmp_eq_u32 s50, 0xff
    s_cbranch_scc0 L_pm6
    buffer_load_dwordx4 v[96:99], v5, s[60:63], s59 offen sc1
    s_mov_b32 s47, s51
    s_mov_b32 s52, 6
    s_branch L_go6
L_pm6:
    s_load_dwordx16 s[4:19], s[26:27], s44 glc
    s_cmp_lg_u32 s46, 0
    s_cbranch_scc1 L_go6
    s_cmp_eq_u32 s51, 0
    s_cbranch_scc1 L_poll6
    s_mov_b32 s52, 6
    s_branch L_acc
L_poll7:
    s_waitcnt lgkmcnt(0)
    s_cmp_eq_u64 s[18:19], s[72:73]
    s_addc_u32 s46, s46, s46
    s_cmp_eq_u64 s[16:17], s[72:73]
    s_addc_u32 s46, s46, s46
    s_cmp_eq_u64 s[14:15], s[72:73]
    s_addc_u32 s46, s46, s46
    s_cmp_eq_u64 s[12:13], s[72:73]
    s_addc_u32 s46, s46, s46
    s_cmp_eq_u64 s[10:11], s[72:73]
    s_addc_u32 s46, s46, s46
    s_cmp_eq_u64 s[8:9], s[72:73]
    s_addc_u32 s46, s46, s46
    s_cmp_eq_u64 s[6:7], s[72:73]
    s_addc_u32 s46, s46, s46
    s_cmp_eq_u64 s[4:5], s[72:73]
    s_addc_u32 s46, s46, s46
    s_add_u32 s53, s53, 1
    s_cmp_gt_u32 s53, 0x8000
    s_cselect_b32 s46, 0xff, s46
    s_andn2_b32 s46, s46, s50
    s_or_b32 s50, s50, s46
    s_cmp_eq_u32 s50, 0xff
    s_cbranch_scc0 L_pm7
    buffer_load_dwordx4 v[96:99], v5, s[60:63], s59 offen sc1
    s_mov_b32 s47, s51
    s_mov_b32 s52, 7
    s_branch L_go7
L_pm7:
    s_load_dwordx16 s[4:19], s[26:27], s44 glc
    s_cmp_lg_u32 s46, 0
    s_cbranch_scc1 L_go7
    s_cmp_eq_u32 s51, 0
    s_cbranch_scc1 L_poll7
    s_mov_b32 s52, 7
    s_branch L_acc
L_acc:
    s_waitcnt vmcnt(0)
    s_bitcmp1_b32 s51, 0
    s_cbranch_scc0 L_ac0
    v_mfma_f32_16x16x32_bf16 v[88:91], v[10:13], v[24:27], v[88:91]
    v_mfma_f32_16x16x32_bf16 v[92:95], v[8:11], v[24:27], v[92:95]
    v_mfma_f32_16x16x32_bf16 v[88:91], v[10:13], v[28:31], v[88:91]
    v_mfma_f32_16x16x32_bf16 v[92:95], v[8:11], v[28:31], v[92:95]
L_ac0:
    s_bitcmp1_b32 s51, 1
    s_cbranch_scc0 L_ac1
    v_mfma_f32_16x16x32_bf16 v[88:91], v[10:13], v[32:35], v[88:91]
    v_mfma_f32_16x16x32_bf16 v[92:95], v[8:11], v[32:35], v[92:95]
    v_mfma_f32_16x16x32_bf16 v[88:91], v[10:13], v[36:39], v[88:91]
    v_mfma_f32_16x16x32_bf16 v[92:95], v[8:11], v[36:39], v[92:95]
L_ac1:
    s_bitcmp1_b32 s51, 2
    s_cbranch_scc0 L_ac2
    v_mfma_f32_16x16x32_bf16 v[88:91], v[10:13], v[40:43], v[88:91]
    v_mfma_f32_16x16x32_bf16 v[92:95], v[8:11], v[40:43], v[92:95]
    v_mfma_f32_16x16x32_bf16 v[88:91], v[10:13], v[44:47], v[88:91]
    v_mfma_f32_16x16x32_bf16 v[92:95], v[8:11], v[44:47], v[92:95]
L_ac2:
    s_bitcmp1_b32 s51, 3
    s_cbranch_scc0 L_ac3
    v_mfma_f32_16x16x32_bf16 v[88:91], v[10:13], v[48:51], v[88:91]
    v_mfma_f32_16x16x32_bf16 v[92:95], v[8:11], v[48:51], v[92:95]
    v_mfma_f32_16x16x32_bf16 v[88:91], v[10:13], v[52:55], v[88:91]
    v_mfma_f32_16x16x32_bf16 v[92:95], v[8:11], v[52:55], v[92:95]
L_ac3:
    s_bitcmp1_b32 s51, 4
    s_cbranch_scc0 L_ac4
    v_mfma_f32_16x16x32_bf16 v[88:91], v[10:13], v[56:59], v[88:91]
    v_mfma_f32_16x16x32_bf16 v[92:95], v[8:11], v[56:59], v[92:95]
    v_mfma_f32_16x16x32_bf16 v[88:91], v[10:13], v[60:63], v[88:91]
    v_mfma_f32_16x16x32_bf16 v[92:95], v[8:11], v[60:63], v[92:95]
L_ac4:
    s_bitcmp1_b32 s51, 5
    s_cbranch_scc0 L_ac5
    v_mfma_f32_16x16x32_bf16 v[88:91], v[10:13], v[64:67], v[88:91]
    v_mfma_f32_16x16x32_bf16 v[92:95], v[8:11], v[64:67], v[92:95]
    v_mfma_f32_16x16x32_bf16 v[88:91], v[10:13], v[68:71], v[88:91]
    v_mfma_f32_16x16x32_bf16 v[92:95], v[8:11], v[68:71], v[92:95]
L_ac5:
    s_bitcmp1_b32 s51, 6
    s_cbranch_scc0 L_ac6
    v_mfma_f32_16x16x32_bf16 v[88:91], v[10:13], v[72:75], v[88:91]
    v_mfma_f32_16x16x32_bf16 v[92:95], v[8:11], v[72:75], v[92:95]
    v_mfma_f32_16x16x32_bf16 v[88:91], v[10:13], v[76:79], v[88:91]
    v_mfma_f32_16x16x32_bf16 v[92:95], v[8:11], v[76:79], v[92:95]
L_ac6:
    s_mov_b32 s51, 0
    s_cmp_eq_u32 s52, 1
    s_cbranch_scc1 L_poll1
    s_cmp_eq_u32 s52, 2
    s_cbranch_scc1 L_poll2
    s_cmp_eq_u32 s52, 3
    s_cbranch_scc1 L_poll3
    s_cmp_eq_u32 s52, 4
    s_cbranch_scc1 L_poll4
    s_cmp_eq_u32 s52, 5
    s_cbranch_scc1 L_poll5
    s_cmp_eq_u32 s52, 6
    s_cbranch_scc1 L_poll6
    s_branch L_poll7
L_fin:
    s_cmp_eq_u32 s47, 0
    s_cbranch_scc1 L_pz
    s_cmp_eq_u32 s52, 1
    s_cbranch_scc1 L_pv1
    s_cmp_eq_u32 s52, 2
    s_cbranch_scc1 L_pv2
    s_cmp_eq_u32 s52, 3
    s_cbranch_scc1 L_pv3
    s_cmp_eq_u32 s52, 4
    s_cbranch_scc1 L_pv4
    s_cmp_eq_u32 s52, 5
    s_cbranch_scc1 L_pv5
    s_cmp_eq_u32 s52, 6
    s_cbranch_scc1 L_pv6
    s_waitcnt vmcnt(3)
    s_branch L_pvd
L_pv1:
    s_waitcnt vmcnt(15)
    s_branch L_pvd
L_pv2:
    s_waitcnt vmcnt(13)
    s_branch L_pvd
L_pv3:
    s_waitcnt vmcnt(11)
    s_branch L_pvd
L_pv4:
    s_waitcnt vmcnt(9)
    s_branch L_pvd
L_pv5:
    s_waitcnt vmcnt(7)
    s_branch L_pvd
L_pv6:
    s_waitcnt vmcnt(5)
L_pvd:
    s_bitcmp1_b32 s47, 0
    s_cbranch_scc0 L_ao0
    v_mfma_f32_16x16x32_bf16 v[88:91], v[10:13], v[24:27], v[88:91]
    v_mfma_f32_16x16x32_bf16 v[92:95], v[8:11], v[24:27], v[92:95]
    v_mfma_f32_16x16x32_bf16 v[88:91], v[10:13], v[28:31], v[88:91]
    v_mfma_f32_16x16x32_bf16 v[92:95], v[8:11], v[28:31], v[92:95]
L_ao0:
    s_bitcmp1_b32 s47, 1
    s_cbranch_scc0 L_ao1
    v_mfma_f32_16x16x32_bf16 v[88:91], v[10:13], v[32:35], v[88:91]
    v_mfma_f32_16x16x32_bf16 v[92:95], v[8:11], v[32:35], v[92:95]
    v_mfma_f32_16x16x32_bf16 v[88:91], v[10:13], v[36:39], v[88:91]
    v_mfma_f32_16x16x32_bf16 v[92:95], v[8:11], v[36:39], v[92:95]
L_ao1:
    s_bitcmp1_b32 s47, 2
    s_cbranch_scc0 L_ao2
    v_mfma_f32_16x16x32_bf16 v[88:91], v[10:13], v[40:43], v[88:91]
    v_mfma_f32_16x16x32_bf16 v[92:95], v[8:11], v[40:43], v[92:95]
    v_mfma_f32_16x16x32_bf16 v[88:91], v[10:13], v[44:47], v[88:91]
    v_mfma_f32_16x16x32_bf16 v[92:95], v[8:11], v[44:47], v[92:95]
L_ao2:
    s_bitcmp1_b32 s47, 3
    s_cbranch_scc0 L_ao3
    v_mfma_f32_16x16x32_bf16 v[88:91], v[10:13], v[48:51], v[88:91]
    v_mfma_f32_16x16x32_bf16 v[92:95], v[8:11], v[48:51], v[92:95]
    v_mfma_f32_16x16x32_bf16 v[88:91], v[10:13], v[52:55], v[88:91]
    v_mfma_f32_16x16x32_bf16 v[92:95], v[8:11], v[52:55], v[92:95]
L_ao3:
    s_bitcmp1_b32 s47, 4
    s_cbranch_scc0 L_ao4
    v_mfma_f32_16x16x32_bf16 v[88:91], v[10:13], v[56:59], v[88:91]
    v_mfma_f32_16x16x32_bf16 v[92:95], v[8:11], v[56:59], v[92:95]
    v_mfma_f32_16x16x32_bf16 v[88:91], v[10:13], v[60:63], v[88:91]
    v_mfma_f32_16x16x32_bf16 v[92:95], v[8:11], v[60:63], v[92:95]
L_ao4:
    s_bitcmp1_b32 s47, 5
    s_cbranch_scc0 L_ao5
    v_mfma_f32_16x16x32_bf16 v[88:91], v[10:13], v[64:67], v[88:91]
    v_mfma_f32_16x16x32_bf16 v[92:95], v[8:11], v[64:67], v[92:95]
    v_mfma_f32_16x16x32_bf16 v[88:91], v[10:13], v[68:71], v[88:91]
    v_mfma_f32_16x16x32_bf16 v[92:95], v[8:11], v[68:71], v[92:95]
L_ao5:
    s_bitcmp1_b32 s47, 6
    s_cbranch_scc0 L_ao6
    v_mfma_f32_16x16x32_bf16 v[88:91], v[10:13], v[72:75], v[88:91]
    v_mfma_f32_16x16x32_bf16 v[92:95], v[8:11], v[72:75], v[92:95]
    v_mfma_f32_16x16x32_bf16 v[88:91], v[10:13], v[76:79], v[88:91]
    v_mfma_f32_16x16x32_bf16 v[92:95], v[8:11], v[76:79], v[92:95]
L_ao6:
L_pz:
    s_cmp_eq_u32 s52, 0
    s_cbranch_scc1 L_pw0
    s_cmp_eq_u32 s52, 1
    s_cbranch_scc1 L_pw1
    s_cmp_eq_u32 s52, 2
    s_cbranch_scc1 L_pw2
    s_cmp_eq_u32 s52, 3
    s_cbranch_scc1 L_pw3
    s_cmp_eq_u32 s52, 4
    s_cbranch_scc1 L_pw4
    s_cmp_eq_u32 s52, 5
    s_cbranch_scc1 L_pw5
    s_cmp_eq_u32 s52, 6
    s_cbranch_scc1 L_pw6
    s_waitcnt vmcnt(2)
    s_branch L_pwd
L_pw0:
    s_waitcnt vmcnt(16)
    s_branch L_pwd
L_pw1:
    s_waitcnt vmcnt(14)
    s_branch L_pwd
L_pw2:
    s_waitcnt vmcnt(12)
    s_branch L_pwd
L_pw3:
    s_waitcnt vmcnt(10)
    s_branch L_pwd
L_pw4:
    s_waitcnt vmcnt(8)
    s_branch L_pwd
L_pw5:
    s_waitcnt vmcnt(6)
    s_branch L_pwd
L_pw6:
    s_waitcnt vmcnt(4)
L_pwd:
    v_mfma_f32_16x16x32_bf16 v[212:215], v[96:99], v[104:107], 0
    v_mfma_f32_16x16x32_bf16 v[216:219], v[96:99], v[108:111], 0
    v_mfma_f32_16x16x32_bf16 v[220:223], v[96:99], v[112:115], 0
    v_mfma_f32_16x16x32_bf16 v[224:227], v[96:99], v[116:119], 0
    s_nop 4
    v_cvt_pk_bf16_f32 v136, v212, v213
    v_cvt_pk_bf16_f32 v137, v214, v215
    v_cvt_pk_bf16_f32 v140, v216, v217
    v_cvt_pk_bf16_f32 v141, v218, v219
    v_cvt_pk_bf16_f32 v144, v220, v221
    v_cvt_pk_bf16_f32 v145, v222, v223
    v_cvt_pk_bf16_f32 v148, v224, v225
    v_cvt_pk_bf16_f32 v149, v226, v227
    s_nop 0
    v_mfma_f32_16x16x32_bf16 v[152:155], v[200:203], v[136:139], v[168:171]
    v_mfma_f32_16x16x32_bf16 v[156:159], v[200:203], v[140:143], v[168:171]
    v_mfma_f32_16x16x32_bf16 v[160:163], v[200:203], v[144:147], v[168:171]
    v_mfma_f32_16x16x32_bf16 v[164:167], v[200:203], v[148:151], v[168:171]
    s_cmp_eq_u32 s52, 7
    s_cbranch_scc1 L_an7
    s_cmp_eq_u32 s52, 6
    s_cbranch_scc1 L_an6
    s_cmp_eq_u32 s52, 5
    s_cbranch_scc1 L_an5
    s_cmp_eq_u32 s52, 4
    s_cbranch_scc1 L_an4
    s_cmp_eq_u32 s52, 3
    s_cbranch_scc1 L_an3
    s_cmp_eq_u32 s52, 2
    s_cbranch_scc1 L_an2
    s_cmp_eq_u32 s52, 1
    s_cbranch_scc1 L_an1
L_an0:
    s_waitcnt vmcnt(14)
    v_mfma_f32_16x16x32_bf16 v[88:91], v[10:13], v[24:27], v[88:91]
    v_mfma_f32_16x16x32_bf16 v[92:95], v[8:11], v[24:27], v[92:95]
    v_mfma_f32_16x16x32_bf16 v[88:91], v[10:13], v[28:31], v[88:91]
    v_mfma_f32_16x16x32_bf16 v[92:95], v[8:11], v[28:31], v[92:95]
L_an1:
    s_waitcnt vmcnt(12)
    v_mfma_f32_16x16x32_bf16 v[88:91], v[10:13], v[32:35], v[88:91]
    v_mfma_f32_16x16x32_bf16 v[92:95], v[8:11], v[32:35], v[92:95]
    v_mfma_f32_16x16x32_bf16 v[88:91], v[10:13], v[36:39], v[88:91]
    v_mfma_f32_16x16x32_bf16 v[92:95], v[8:11], v[36:39], v[92:95]
L_an2:
    s_waitcnt vmcnt(10)
    v_mfma_f32_16x16x32_bf16 v[88:91], v[10:13], v[40:43], v[88:91]
    v_mfma_f32_16x16x32_bf16 v[92:95], v[8:11], v[40:43], v[92:95]
    v_mfma_f32_16x16x32_bf16 v[88:91], v[10:13], v[44:47], v[88:91]
    v_mfma_f32_16x16x32_bf16 v[92:95], v[8:11], v[44:47], v[92:95]
L_an3:
    s_waitcnt vmcnt(8)
    v_mfma_f32_16x16x32_bf16 v[88:91], v[10:13], v[48:51], v[88:91]
    v_mfma_f32_16x16x32_bf16 v[92:95], v[8:11], v[48:51], v[92:95]
    v_mfma_f32_16x16x32_bf16 v[88:91], v[10:13], v[52:55], v[88:91]
    v_mfma_f32_16x16x32_bf16 v[92:95], v[8:11], v[52:55], v[92:95]
L_an4:
    s_waitcnt vmcnt(6)
    v_mfma_f32_16x16x32_bf16 v[88:91], v[10:13], v[56:59], v[88:91]
    v_mfma_f32_16x16x32_bf16 v[92:95], v[8:11], v[56:59], v[92:95]
    v_mfma_f32_16x16x32_bf16 v[88:91], v[10:13], v[60:63], v[88:91]
    v_mfma_f32_16x16x32_bf16 v[92:95], v[8:11], v[60:63], v[92:95]
L_an5:
    s_waitcnt vmcnt(4)
    v_mfma_f32_16x16x32_bf16 v[88:91], v[10:13], v[64:67], v[88:91]
    v_mfma_f32_16x16x32_bf16 v[92:95], v[8:11], v[64:67], v[92:95]
    v_mfma_f32_16x16x32_bf16 v[88:91], v[10:13], v[68:71], v[88:91]
    v_mfma_f32_16x16x32_bf16 v[92:95], v[8:11], v[68:71], v[92:95]
L_an6:
    s_waitcnt vmcnt(2)
    v_mfma_f32_16x16x32_bf16 v[88:91], v[10:13], v[72:75], v[88:91]
    v_mfma_f32_16x16x32_bf16 v[92:95], v[8:11], v[72:75], v[92:95]
    v_mfma_f32_16x16x32_bf16 v[88:91], v[10:13], v[76:79], v[88:91]
    v_mfma_f32_16x16x32_bf16 v[92:95], v[8:11], v[76:79], v[92:95]
L_an7:
    s_waitcnt vmcnt(0)
    v_mfma_f32_16x16x32_bf16 v[88:91], v[10:13], v[80:83], v[88:91]
    v_mfma_f32_16x16x32_bf16 v[92:95], v[8:11], v[80:83], v[92:95]
    v_mfma_f32_16x16x32_bf16 v[88:91], v[10:13], v[84:87], v[88:91]
    v_mfma_f32_16x16x32_bf16 v[92:95], v[8:11], v[84:87], v[92:95]
    s_nop 3
    v_rcp_f32 v152, v152
    v_rcp_f32 v156, v156
    v_rcp_f32 v160, v160
    v_rcp_f32 v164, v164
    v_cvt_pk_bf16_f32 v172, v88, v89
    v_cvt_pk_bf16_f32 v173, v90, v91
    v_cvt_pk_bf16_f32 v174, v92, v93
    v_cvt_pk_bf16_f32 v175, v94, v95
    ds_write_b128 v6, v[172:175]
    ds_write_b32 v21, v232 offset:40
    ds_read_b32 v235, v18 offset:40
    ds_read_b128 v[176:179], v7
    v_mfma_f32_16x16x32_bf16 v[24:27], v[172:175], v[104:107], 0
    v_mfma_f32_16x16x32_bf16 v[28:31], v[172:175], v[108:111], 0
    v_mfma_f32_16x16x32_bf16 v[32:35], v[172:175], v[112:115], 0
    v_mfma_f32_16x16x32_bf16 v[36:39], v[172:175], v[116:119], 0
    s_mov_b32 s45, 0
    s_nop 3
    s_cmp_eq_u32 s40, 0
    v_mul_f32 v24, v24, v152
    v_mul_f32 v25, v25, v152
    v_mul_f32 v26, v26, v152
    v_mul_f32 v27, v27, v152
    v_mul_f32 v28, v28, v156
    v_mul_f32 v29, v29, v156
    v_mul_f32 v30, v30, v156
    v_mul_f32 v31, v31, v156
    v_mul_f32 v32, v32, v160
    v_mul_f32 v33, v33, v160
    v_mul_f32 v34, v34, v160
    v_mul_f32 v35, v35, v160
    v_mul_f32 v36, v36, v164
    v_mul_f32 v37, v37, v164
    v_mul_f32 v38, v38, v164
    v_mul_f32 v39, v39, v164
    s_cbranch_scc0 L_o1
    v_cvt_pk_bf16_f32 v56, v24, v25
    v_cvt_pk_bf16_f32 v57, v26, v27
    v_cvt_pk_bf16_f32 v60, v28, v29
    v_cvt_pk_bf16_f32 v61, v30, v31
    v_cvt_pk_bf16_f32 v64, v32, v33
    v_cvt_pk_bf16_f32 v65, v34, v35
    v_cvt_pk_bf16_f32 v68, v36, v37
    v_cvt_pk_bf16_f32 v69, v38, v39
    s_branch L_ks0g
L_ks0:
    ds_read_b32 v235, v18 offset:40
    ds_read_b128 v[176:179], v7
L_ks0g:
    s_add_u32 s45, s45, 1
    s_waitcnt lgkmcnt(0)
    v_readfirstlane_b32 s46, v235
    s_cmp_gt_u32 s45, 0x40000
    s_cbranch_scc1 L_kd0
    s_cmp_eq_u32 s46, 0
    s_cbranch_scc1 L_ks0
L_kd0:
    v_mfma_f32_16x16x32_bf16 v[40:43], v[176:179], v[104:107], 0
    v_mfma_f32_16x16x32_bf16 v[44:47], v[176:179], v[108:111], 0
    v_mfma_f32_16x16x32_bf16 v[48:51], v[176:179], v[112:115], 0
    v_mfma_f32_16x16x32_bf16 v[52:55], v[176:179], v[116:119], 0
    s_nop 4
    v_mul_f32 v40, v40, v152
    v_mul_f32 v41, v41, v152
    v_mul_f32 v42, v42, v152
    v_mul_f32 v43, v43, v152
    v_cvt_pk_bf16_f32 v58, v40, v41
    v_cvt_pk_bf16_f32 v59, v42, v43
    buffer_store_dwordx4 v[56:59], v5, s[60:63], s48 offen sc1
    s_add_u32 s48, s48, 0x8000
    v_mul_f32 v44, v44, v156
    v_mul_f32 v45, v45, v156
    v_mul_f32 v46, v46, v156
    v_mul_f32 v47, v47, v156
    v_cvt_pk_bf16_f32 v62, v44, v45
    v_cvt_pk_bf16_f32 v63, v46, v47
    buffer_store_dwordx4 v[60:63], v5, s[60:63], s48 offen sc1
    s_add_u32 s48, s48, 0x8000
    v_mul_f32 v48, v48, v160
    v_mul_f32 v49, v49, v160
    v_mul_f32 v50, v50, v160
    v_mul_f32 v51, v51, v160
    v_cvt_pk_bf16_f32 v66, v48, v49
    v_cvt_pk_bf16_f32 v67, v50, v51
    buffer_store_dwordx4 v[64:67], v5, s[60:63], s48 offen sc1
    s_add_u32 s48, s48, 0x8000
    v_mul_f32 v52, v52, v164
    v_mul_f32 v53, v53, v164
    v_mul_f32 v54, v54, v164
    v_mul_f32 v55, v55, v164
    v_cvt_pk_bf16_f32 v70, v52, v53
    v_cvt_pk_bf16_f32 v71, v54, v55
    buffer_store_dwordx4 v[68:71], v5, s[60:63], s48 offen sc1
    s_branch L_o2
L_o1:
    v_cvt_pk_bf16_f32 v58, v24, v25
    v_cvt_pk_bf16_f32 v59, v26, v27
    v_cvt_pk_bf16_f32 v62, v28, v29
    v_cvt_pk_bf16_f32 v63, v30, v31
    v_cvt_pk_bf16_f32 v66, v32, v33
    v_cvt_pk_bf16_f32 v67, v34, v35
    v_cvt_pk_bf16_f32 v70, v36, v37
    v_cvt_pk_bf16_f32 v71, v38, v39
    s_branch L_ks1g
L_ks1:
    ds_read_b32 v235, v18 offset:40
    ds_read_b128 v[176:179], v7
L_ks1g:
    s_add_u32 s45, s45, 1
    s_waitcnt lgkmcnt(0)
    v_readfirstlane_b32 s46, v235
    s_cmp_gt_u32 s45, 0x40000
    s_cbranch_scc1 L_kd1
    s_cmp_eq_u32 s46, 0
    s_cbranch_scc1 L_ks1
L_kd1:
    v_mfma_f32_16x16x32_bf16 v[40:43], v[176:179], v[104:107], 0
    v_mfma_f32_16x16x32_bf16 v[44:47], v[176:179], v[108:111], 0
    v_mfma_f32_16x16x32_bf16 v[48:51], v[176:179], v[112:115], 0
    v_mfma_f32_16x16x32_bf16 v[52:55], v[176:179], v[116:119], 0
    s_nop 4
    v_mul_f32 v40, v40, v152
    v_mul_f32 v41, v41, v152
    v_mul_f32 v42, v42, v152
    v_mul_f32 v43, v43, v152
    v_cvt_pk_bf16_f32 v56, v40, v41
    v_cvt_pk_bf16_f32 v57, v42, v43
    buffer_store_dwordx4 v[56:59], v5, s[60:63], s48 offen sc1
    s_add_u32 s48, s48, 0x8000
    v_mul_f32 v44, v44, v156
    v_mul_f32 v45, v45, v156
    v_mul_f32 v46, v46, v156
    v_mul_f32 v47, v47, v156
    v_cvt_pk_bf16_f32 v60, v44, v45
    v_cvt_pk_bf16_f32 v61, v46, v47
    buffer_store_dwordx4 v[60:63], v5, s[60:63], s48 offen sc1
    s_add_u32 s48, s48, 0x8000
    v_mul_f32 v48, v48, v160
    v_mul_f32 v49, v49, v160
    v_mul_f32 v50, v50, v160
    v_mul_f32 v51, v51, v160
    v_cvt_pk_bf16_f32 v64, v48, v49
    v_cvt_pk_bf16_f32 v65, v50, v51
    buffer_store_dwordx4 v[64:67], v5, s[60:63], s48 offen sc1
    s_add_u32 s48, s48, 0x8000
    v_mul_f32 v52, v52, v164
    v_mul_f32 v53, v53, v164
    v_mul_f32 v54, v54, v164
    v_mul_f32 v55, v55, v164
    v_cvt_pk_bf16_f32 v68, v52, v53
    v_cvt_pk_bf16_f32 v69, v54, v55
    buffer_store_dwordx4 v[68:71], v5, s[60:63], s48 offen sc1
L_o2:
    s_lshl_b32 s59, s34, 3
    s_lshl_b32 s45, s3, 1
    s_add_u32 s59, s59, s45
    s_lshl_b32 s45, s59, 15
    s_add_u32 s45, s45, 0x400000
    v_add_u32 v242, 0x8000, v5
    s_mov_b32 s51, 0x55555555
    s_add_u32 s64, s26, s45
    s_addc_u32 s65, s27, 0
    s_mov_b32 s66, 0x10000
    s_mov_b32 s67, 0x20000
    s_lshl_b32 s52, s34, 8
    s_lshl_b32 s46, s3, 6
    s_add_u32 s52, s52, s46
    s_lshr_b32 vcc_lo, s52, 6
    s_mul_i32 vcc_lo, vcc_lo, 1984
    s_add_u32 s52, s52, vcc_lo
    s_add_u32 s52, s52, 0x980000
    s_lshl_b32 vcc_lo, s35, 7
    s_add_u32 s52, s52, vcc_lo
    v_lshrrev_b32 v6, 2, v4
    v_lshlrev_b32 v6, 7, v6
    v_and_b32 v7, 3, v4
    v_lshl_add_u32 v6, v7, 3, v6
    v_bfe_u32 v7, v4, 3, 1
    v_lshl_add_u32 v6, v7, 6, v6
    v_lshl_add_u32 v236, v23, 5, v6
    v_xor_b32 v237, 32, v236
    v_xor_b32 v238, 64, v236
    v_xor_b32 v239, 0x60, v236
    s_lshl_b32 s57, s3, 11
    s_add_u32 s57, s57, 131584
    v_lshrrev_b32 v7, 5, v4
    v_lshl_add_u32 v6, v23, 1, v7
    v_and_b32 v7, 7, v4
    v_xor_b32 v6, v6, v7
    v_lshlrev_b32 v6, 4, v6
    v_and_b32 v3, 15, v4
    v_lshl_add_u32 v6, v3, 7, v6
    v_add_u32 v15, s57, v6
    v_xor_b32 v18, 64, v15
    v_lshrrev_b32 v6, 3, v4
    v_lshlrev_b32 v3, 4, v7
    v_lshl_add_u32 v17, v6, 12, v3
    v_xor_b32 v7, v7, v6
    v_lshlrev_b32 v7, 4, v7
    v_lshl_add_u32 v6, v6, 7, v7
    v_add_u32 v16, s57, v6
    s_mov_b32 s50, 0
    s_mov_b32 s53, 0
    s_mov_b32 s54, 0
    s_lshl_b32 s55, s40, 4
    s_and_b32 s42, s34, 3
    s_lshl_b32 s42, s42, 3
    v_mov_b64 v[120:121], 0
    v_mov_b64 v[122:123], 0
    v_mov_b64 v[124:125], 0
    v_mov_b64 v[126:127], 0
    v_mov_b64 v[128:129], 0
    v_mov_b64 v[130:131], 0
    v_mov_b64 v[132:133], 0
    v_mov_b64 v[134:135], 0
    v_mov_b64 v[136:137], 0
    v_mov_b64 v[138:139], 0
    s_load_dwordx16 s[4:19], s[26:27], s52 glc
    v_mov_b64 v[140:141], 0
    v_mov_b64 v[142:143], 0
    v_mov_b64 v[144:145], 0
    v_mov_b64 v[146:147], 0
    v_mov_b64 v[148:149], 0
    v_mov_b64 v[150:151], 0
    s_waitcnt vmcnt(0)
    s_mov_b64 exec, 0xffff
    buffer_store_dword v234, v254, s[60:63], s49 offen sc1
    s_mov_b64 exec, -1
    s_waitcnt lgkmcnt(0)
    s_mov_b32 s54, 0
    s_cmp_eq_u64 s[4:5], s[72:73]
    s_cselect_b32 s46, 0x1, 0
    s_or_b32 s54, s54, s46
    s_cmp_eq_u64 s[6:7], s[72:73]
    s_cselect_b32 s46, 0x4, 0
    s_or_b32 s54, s54, s46
    s_cmp_eq_u64 s[8:9], s[72:73]
    s_cselect_b32 s46, 0x10, 0
    s_or_b32 s54, s54, s46
    s_cmp_eq_u64 s[10:11], s[72:73]
    s_cselect_b32 s46, 0x40, 0
    s_or_b32 s54, s54, s46
    s_cmp_eq_u64 s[12:13], s[72:73]
    s_cselect_b32 s46, 0x100, 0
    s_or_b32 s54, s54, s46
    s_cmp_eq_u64 s[14:15], s[72:73]
    s_cselect_b32 s46, 0x400, 0
    s_or_b32 s54, s54, s46
    s_cmp_eq_u64 s[16:17], s[72:73]
    s_cselect_b32 s46, 0x1000, 0
    s_or_b32 s54, s54, s46
    s_cmp_eq_u64 s[18:19], s[72:73]
    s_cselect_b32 s46, 0x4000, 0
    s_or_b32 s54, s54, s46
    s_lshl_b32 s46, s54, s55
    s_mov_b32 s47, s46
    s_lshr_b64 s[46:47], s[46:47], s42
    v_mov_b32 v235, s46
    s_mov_b64 exec, 1
    ds_or_b32 v14, v235 offset:64
    s_mov_b64 exec, -1
    s_setprio 2
    s_cmp_lg_u32 s50, 0
    s_cbranch_scc1 L_sel0_ok
    s_mov_b32 s45, 0
    s_cmp_lg_u32 s51, 0
    s_cbranch_scc1 L_sel0
    s_mov_b32 s66, 0
    s_mov_b32 s50, 0x55555555
    s_branch L_sel0_ok
L_sel0:
    ds_read_b32 v235, v14 offset:64
    ds_read_b32 v13, v20 offset:60
    s_add_u32 s45, s45, 1
    s_waitcnt lgkmcnt(0)
    v_and_b32 v13, v13, v235
    s_cmp_gt_u32 s45, 0x40000
    s_cselect_b32 s46, -1, 0
    v_readfirstlane_b32 s50, v13
    s_nop 3
    s_or_b32 s50, s50, s46
    s_and_b32 s50, s50, s51
    s_cbranch_scc1 L_sel0_ok
    s_cmp_lg_u32 s54, 0x5555
    s_cbranch_scc1 L_sel0_p
    s_sleep 1
    s_branch L_sel0
L_sel0_p:
    s_load_dwordx16 s[4:19], s[26:27], s52 glc
    s_add_u32 s45, s45, 8
    s_waitcnt lgkmcnt(0)
    s_mov_b32 s54, 0
    s_cmp_eq_u64 s[4:5], s[72:73]
    s_cselect_b32 s46, 0x1, 0
    s_or_b32 s54, s54, s46
    s_cmp_eq_u64 s[6:7], s[72:73]
    s_cselect_b32 s46, 0x4, 0
    s_or_b32 s54, s54, s46
    s_cmp_eq_u64 s[8:9], s[72:73]
    s_cselect_b32 s46, 0x10, 0
    s_or_b32 s54, s54, s46
    s_cmp_eq_u64 s[10:11], s[72:73]
    s_cselect_b32 s46, 0x40, 0
    s_or_b32 s54, s54, s46
    s_cmp_eq_u64 s[12:13], s[72:73]
    s_cselect_b32 s46, 0x100, 0
    s_or_b32 s54, s54, s46
    s_cmp_eq_u64 s[14:15], s[72:73]
    s_cselect_b32 s46, 0x400, 0
    s_or_b32 s54, s54, s46
    s_cmp_eq_u64 s[16:17], s[72:73]
    s_cselect_b32 s46, 0x1000, 0
    s_or_b32 s54, s54, s46
    s_cmp_eq_u64 s[18:19], s[72:73]
    s_cselect_b32 s46, 0x4000, 0
    s_or_b32 s54, s54, s46
    s_lshl_b32 s46, s54, s55
    s_mov_b32 s47, s46
    s_lshr_b64 s[46:47], s[46:47], s42
    v_mov_b32 v235, s46
    s_mov_b64 exec, 1
    ds_or_b32 v14, v235 offset:64
    s_mov_b64 exec, -1
    s_branch L_sel0
L_sel0_ok:
    s_ff1_i32_b32 s46, s50
    s_bitset0_b32 s50, s46
    s_add_u32 s48, s46, s42
    s_and_b32 s48, s48, 31
    s_lshl_b32 s48, s48, 10
    s_bitset0_b32 s51, s46
    s_lshl_b32 s28, s46, 12
    buffer_load_dwordx4 v[24:27], v5, s[64:67], s48 offen offset:0 sc1
    buffer_load_dwordx4 v[28:31], v242, s[64:67], s48 offen offset:0 sc1
    buffer_load_dwordx4 v[32:35], v5, s[64:67], s48 offen offset:1024 sc1
    buffer_load_dwordx4 v[36:39], v242, s[64:67], s48 offen offset:1024 sc1
    s_cmp_lg_u32 s50, 0
    s_cbranch_scc1 L_sel1_ok
    s_mov_b32 s45, 0
    s_cmp_lg_u32 s51, 0
    s_cbranch_scc1 L_sel1
    s_mov_b32 s66, 0
    s_mov_b32 s50, 0x55555555
    s_branch L_sel1_ok
L_sel1:
    ds_read_b32 v235, v14 offset:64
    ds_read_b32 v13, v20 offset:60
    s_add_u32 s45, s45, 1
    s_waitcnt lgkmcnt(0)
    v_and_b32 v13, v13, v235
    s_cmp_gt_u32 s45, 0x40000
    s_cselect_b32 s46, -1, 0
    v_readfirstlane_b32 s50, v13
    s_nop 3
    s_or_b32 s50, s50, s46
    s_and_b32 s50, s50, s51
    s_cbranch_scc1 L_sel1_ok
    s_cmp_lg_u32 s54, 0x5555
    s_cbranch_scc1 L_sel1_p
    s_sleep 1
    s_branch L_sel1
L_sel1_p:
    s_load_dwordx16 s[4:19], s[26:27], s52 glc
    s_add_u32 s45, s45, 8
    s_waitcnt lgkmcnt(0)
    s_mov_b32 s54, 0
    s_cmp_eq_u64 s[4:5], s[72:73]
    s_cselect_b32 s46, 0x1, 0
    s_or_b32 s54, s54, s46
    s_cmp_eq_u64 s[6:7], s[72:73]
    s_cselect_b32 s46, 0x4, 0
    s_or_b32 s54, s54, s46
    s_cmp_eq_u64 s[8:9], s[72:73]
    s_cselect_b32 s46, 0x10, 0
    s_or_b32 s54, s54, s46
    s_cmp_eq_u64 s[10:11], s[72:73]
    s_cselect_b32 s46, 0x40, 0
    s_or_b32 s54, s54, s46
    s_cmp_eq_u64 s[12:13], s[72:73]
    s_cselect_b32 s46, 0x100, 0
    s_or_b32 s54, s54, s46
    s_cmp_eq_u64 s[14:15], s[72:73]
    s_cselect_b32 s46, 0x400, 0
    s_or_b32 s54, s54, s46
    s_cmp_eq_u64 s[16:17], s[72:73]
    s_cselect_b32 s46, 0x1000, 0
    s_or_b32 s54, s54, s46
    s_cmp_eq_u64 s[18:19], s[72:73]
    s_cselect_b32 s46, 0x4000, 0
    s_or_b32 s54, s54, s46
    s_lshl_b32 s46, s54, s55
    s_mov_b32 s47, s46
    s_lshr_b64 s[46:47], s[46:47], s42
    v_mov_b32 v235, s46
    s_mov_b64 exec, 1
    ds_or_b32 v14, v235 offset:64
    s_mov_b64 exec, -1
    s_branch L_sel1
L_sel1_ok:
    s_ff1_i32_b32 s46, s50
    s_bitset0_b32 s50, s46
    s_add_u32 s48, s46, s42
    s_and_b32 s48, s48, 31
    s_lshl_b32 s48, s48, 10
    s_bitset0_b32 s51, s46
    s_lshl_b32 s29, s46, 12
    buffer_load_dwordx4 v[40:43], v5, s[64:67], s48 offen offset:0 sc1
    buffer_load_dwordx4 v[44:47], v242, s[64:67], s48 offen offset:0 sc1
    buffer_load_dwordx4 v[48:51], v5, s[64:67], s48 offen offset:1024 sc1
    buffer_load_dwordx4 v[52:55], v242, s[64:67], s48 offen offset:1024 sc1
    s_cmp_lg_u32 s50, 0
    s_cbranch_scc1 L_sel2_ok
    s_mov_b32 s45, 0
    s_cmp_lg_u32 s51, 0
    s_cbranch_scc1 L_sel2
    s_mov_b32 s66, 0
    s_mov_b32 s50, 0x55555555
    s_branch L_sel2_ok
L_sel2:
    ds_read_b32 v235, v14 offset:64
    ds_read_b32 v13, v20 offset:60
    s_add_u32 s45, s45, 1
    s_waitcnt lgkmcnt(0)
    v_and_b32 v13, v13, v235
    s_cmp_gt_u32 s45, 0x40000
    s_cselect_b32 s46, -1, 0
    v_readfirstlane_b32 s50, v13
    s_nop 3
    s_or_b32 s50, s50, s46
    s_and_b32 s50, s50, s51
    s_cbranch_scc1 L_sel2_ok
    s_cmp_lg_u32 s54, 0x5555
    s_cbranch_scc1 L_sel2_p
    s_sleep 1
    s_branch L_sel2
L_sel2_p:
    s_load_dwordx16 s[4:19], s[26:27], s52 glc
    s_add_u32 s45, s45, 8
    s_waitcnt lgkmcnt(0)
    s_mov_b32 s54, 0
    s_cmp_eq_u64 s[4:5], s[72:73]
    s_cselect_b32 s46, 0x1, 0
    s_or_b32 s54, s54, s46
    s_cmp_eq_u64 s[6:7], s[72:73]
    s_cselect_b32 s46, 0x4, 0
    s_or_b32 s54, s54, s46
    s_cmp_eq_u64 s[8:9], s[72:73]
    s_cselect_b32 s46, 0x10, 0
    s_or_b32 s54, s54, s46
    s_cmp_eq_u64 s[10:11], s[72:73]
    s_cselect_b32 s46, 0x40, 0
    s_or_b32 s54, s54, s46
    s_cmp_eq_u64 s[12:13], s[72:73]
    s_cselect_b32 s46, 0x100, 0
    s_or_b32 s54, s54, s46
    s_cmp_eq_u64 s[14:15], s[72:73]
    s_cselect_b32 s46, 0x400, 0
    s_or_b32 s54, s54, s46
    s_cmp_eq_u64 s[16:17], s[72:73]
    s_cselect_b32 s46, 0x1000, 0
    s_or_b32 s54, s54, s46
    s_cmp_eq_u64 s[18:19], s[72:73]
    s_cselect_b32 s46, 0x4000, 0
    s_or_b32 s54, s54, s46
    s_lshl_b32 s46, s54, s55
    s_mov_b32 s47, s46
    s_lshr_b64 s[46:47], s[46:47], s42
    v_mov_b32 v235, s46
    s_mov_b64 exec, 1
    ds_or_b32 v14, v235 offset:64
    s_mov_b64 exec, -1
    s_branch L_sel2
L_sel2_ok:
    s_ff1_i32_b32 s46, s50
    s_bitset0_b32 s50, s46
    s_add_u32 s48, s46, s42
    s_and_b32 s48, s48, 31
    s_lshl_b32 s48, s48, 10
    s_bitset0_b32 s51, s46
    s_lshl_b32 s30, s46, 12
    buffer_load_dwordx4 v[56:59], v5, s[64:67], s48 offen offset:0 sc1
    buffer_load_dwordx4 v[60:63], v242, s[64:67], s48 offen offset:0 sc1
    buffer_load_dwordx4 v[64:67], v5, s[64:67], s48 offen offset:1024 sc1
    buffer_load_dwordx4 v[68:71], v242, s[64:67], s48 offen offset:1024 sc1
    v_add_u32 v8, s28, v236
    v_add_u32 v9, s28, v237
    v_add_u32 v10, s28, v238
    v_add_u32 v11, s28, v239
    ds_read_b64_tr_b16 v[88:89], v8 offset:0
    ds_read_b64_tr_b16 v[90:91], v8 offset:2048
    ds_read_b64_tr_b16 v[92:93], v9 offset:0
    ds_read_b64_tr_b16 v[94:95], v9 offset:2048
    ds_read_b64_tr_b16 v[96:97], v10 offset:0
    ds_read_b64_tr_b16 v[98:99], v10 offset:2048
    ds_read_b64_tr_b16 v[100:101], v11 offset:0
    ds_read_b64_tr_b16 v[102:103], v11 offset:2048
L_gloop:
    s_cmp_lg_u32 s50, 0
    s_cbranch_scc1 L_sel3_ok
    s_mov_b32 s45, 0
    s_cmp_lg_u32 s51, 0
    s_cbranch_scc1 L_sel3
    s_mov_b32 s66, 0
    s_mov_b32 s50, 0x55555555
    s_branch L_sel3_ok
L_sel3:
    ds_read_b32 v235, v14 offset:64
    ds_read_b32 v13, v20 offset:60
    s_add_u32 s45, s45, 1
    s_waitcnt lgkmcnt(0)
    v_and_b32 v13, v13, v235
    s_cmp_gt_u32 s45, 0x40000
    s_cselect_b32 s46, -1, 0
    v_readfirstlane_b32 s50, v13
    s_nop 3
    s_or_b32 s50, s50, s46
    s_and_b32 s50, s50, s51
    s_cbranch_scc1 L_sel3_ok
    s_cmp_lg_u32 s54, 0x5555
    s_cbranch_scc1 L_sel3_p
    s_sleep 1
    s_branch L_sel3
L_sel3_p:
    s_load_dwordx16 s[4:19], s[26:27], s52 glc
    s_add_u32 s45, s45, 8
    s_waitcnt lgkmcnt(0)
    s_mov_b32 s54, 0
    s_cmp_eq_u64 s[4:5], s[72:73]
    s_cselect_b32 s46, 0x1, 0
    s_or_b32 s54, s54, s46
    s_cmp_eq_u64 s[6:7], s[72:73]
    s_cselect_b32 s46, 0x4, 0
    s_or_b32 s54, s54, s46
    s_cmp_eq_u64 s[8:9], s[72:73]
    s_cselect_b32 s46, 0x10, 0
    s_or_b32 s54, s54, s46
    s_cmp_eq_u64 s[10:11], s[72:73]
    s_cselect_b32 s46, 0x40, 0
    s_or_b32 s54, s54, s46
    s_cmp_eq_u64 s[12:13], s[72:73]
    s_cselect_b32 s46, 0x100, 0
    s_or_b32 s54, s54, s46
    s_cmp_eq_u64 s[14:15], s[72:73]
    s_cselect_b32 s46, 0x400, 0
    s_or_b32 s54, s54, s46
    s_cmp_eq_u64 s[16:17], s[72:73]
    s_cselect_b32 s46, 0x1000, 0
    s_or_b32 s54, s54, s46
    s_cmp_eq_u64 s[18:19], s[72:73]
    s_cselect_b32 s46, 0x4000, 0
    s_or_b32 s54, s54, s46
    s_lshl_b32 s46, s54, s55
    s_mov_b32 s47, s46
    s_lshr_b64 s[46:47], s[46:47], s42
    v_mov_b32 v235, s46
    s_mov_b64 exec, 1
    ds_or_b32 v14, v235 offset:64
    s_mov_b64 exec, -1
    s_branch L_sel3
L_sel3_ok:
    s_waitcnt vmcnt(10) lgkmcnt(0)
    v_mfma_f32_16x16x32_bf16 v[120:123], v[88:91], v[24:27], v[120:123]
    ds_read_b64_tr_b16 v[104:105], v8 offset:4096
    ds_read_b64_tr_b16 v[106:107], v8 offset:6144
    v_mfma_f32_16x16x32_bf16 v[124:127], v[92:95], v[24:27], v[124:127]
    ds_read_b64_tr_b16 v[108:109], v9 offset:4096
    ds_read_b64_tr_b16 v[110:111], v9 offset:6144
    v_mfma_f32_16x16x32_bf16 v[128:131], v[96:99], v[24:27], v[128:131]
    ds_read_b64_tr_b16 v[112:113], v10 offset:4096
    ds_read_b64_tr_b16 v[114:115], v10 offset:6144
    v_mfma_f32_16x16x32_bf16 v[132:135], v[100:103], v[24:27], v[132:135]
    ds_read_b64_tr_b16 v[116:117], v11 offset:4096
    ds_read_b64_tr_b16 v[118:119], v11 offset:6144
    v_mfma_f32_16x16x32_bf16 v[136:139], v[88:91], v[28:31], v[136:139]
    v_add_u32 v244, s29, v236
    v_add_u32 v245, s29, v237
    v_mfma_f32_16x16x32_bf16 v[140:143], v[92:95], v[28:31], v[140:143]
    v_add_u32 v246, s29, v238
    v_add_u32 v247, s29, v239
    v_mfma_f32_16x16x32_bf16 v[144:147], v[96:99], v[28:31], v[144:147]
    s_ff1_i32_b32 s46, s50
    s_bitset0_b32 s50, s46
    s_add_u32 s48, s46, s42
    v_mfma_f32_16x16x32_bf16 v[148:151], v[100:103], v[28:31], v[148:151]
    s_and_b32 s48, s48, 31
    s_lshl_b32 s48, s48, 10
    s_bitset0_b32 s51, s46
    s_waitcnt vmcnt(8) lgkmcnt(0)
    v_mfma_f32_16x16x32_bf16 v[120:123], v[104:107], v[32:35], v[120:123]
    ds_read_b64_tr_b16 v[88:89], v244 offset:0
    ds_read_b64_tr_b16 v[90:91], v244 offset:2048
    v_mfma_f32_16x16x32_bf16 v[124:127], v[108:111], v[32:35], v[124:127]
    ds_read_b64_tr_b16 v[92:93], v245 offset:0
    ds_read_b64_tr_b16 v[94:95], v245 offset:2048
    v_mfma_f32_16x16x32_bf16 v[128:131], v[112:115], v[32:35], v[128:131]
    ds_read_b64_tr_b16 v[96:97], v246 offset:0
    ds_read_b64_tr_b16 v[98:99], v246 offset:2048
    v_mfma_f32_16x16x32_bf16 v[132:135], v[116:119], v[32:35], v[132:135]
    ds_read_b64_tr_b16 v[100:101], v247 offset:0
    ds_read_b64_tr_b16 v[102:103], v247 offset:2048
    v_mfma_f32_16x16x32_bf16 v[136:139], v[104:107], v[36:39], v[136:139]
    buffer_load_dwordx4 v[72:75], v5, s[64:67], s48 offen offset:0 sc1
    s_lshl_b32 s31, s46, 12
    v_mfma_f32_16x16x32_bf16 v[140:143], v[108:111], v[36:39], v[140:143]
    buffer_load_dwordx4 v[76:79], v242, s[64:67], s48 offen offset:0 sc1
    v_mfma_f32_16x16x32_bf16 v[144:147], v[112:115], v[36:39], v[144:147]
    buffer_load_dwordx4 v[80:83], v5, s[64:67], s48 offen offset:1024 sc1
    v_mfma_f32_16x16x32_bf16 v[148:151], v[116:119], v[36:39], v[148:151]
    buffer_load_dwordx4 v[84:87], v242, s[64:67], s48 offen offset:1024 sc1
    s_cmp_lg_u32 s50, 0
    s_cbranch_scc1 L_sel4_ok
    s_mov_b32 s45, 0
    s_cmp_lg_u32 s51, 0
    s_cbranch_scc1 L_sel4
    s_mov_b32 s66, 0
    s_mov_b32 s50, 0x55555555
    s_branch L_sel4_ok
L_sel4:
    ds_read_b32 v235, v14 offset:64
    ds_read_b32 v13, v20 offset:60
    s_add_u32 s45, s45, 1
    s_waitcnt lgkmcnt(0)
    v_and_b32 v13, v13, v235
    s_cmp_gt_u32 s45, 0x40000
    s_cselect_b32 s46, -1, 0
    v_readfirstlane_b32 s50, v13
    s_nop 3
    s_or_b32 s50, s50, s46
    s_and_b32 s50, s50, s51
    s_cbranch_scc1 L_sel4_ok
    s_cmp_lg_u32 s54, 0x5555
    s_cbranch_scc1 L_sel4_p
    s_sleep 1
    s_branch L_sel4
L_sel4_p:
    s_load_dwordx16 s[4:19], s[26:27], s52 glc
    s_add_u32 s45, s45, 8
    s_waitcnt lgkmcnt(0)
    s_mov_b32 s54, 0
    s_cmp_eq_u64 s[4:5], s[72:73]
    s_cselect_b32 s46, 0x1, 0
    s_or_b32 s54, s54, s46
    s_cmp_eq_u64 s[6:7], s[72:73]
    s_cselect_b32 s46, 0x4, 0
    s_or_b32 s54, s54, s46
    s_cmp_eq_u64 s[8:9], s[72:73]
    s_cselect_b32 s46, 0x10, 0
    s_or_b32 s54, s54, s46
    s_cmp_eq_u64 s[10:11], s[72:73]
    s_cselect_b32 s46, 0x40, 0
    s_or_b32 s54, s54, s46
    s_cmp_eq_u64 s[12:13], s[72:73]
    s_cselect_b32 s46, 0x100, 0
    s_or_b32 s54, s54, s46
    s_cmp_eq_u64 s[14:15], s[72:73]
    s_cselect_b32 s46, 0x400, 0
    s_or_b32 s54, s54, s46
    s_cmp_eq_u64 s[16:17], s[72:73]
    s_cselect_b32 s46, 0x1000, 0
    s_or_b32 s54, s54, s46
    s_cmp_eq_u64 s[18:19], s[72:73]
    s_cselect_b32 s46, 0x4000, 0
    s_or_b32 s54, s54, s46
    s_lshl_b32 s46, s54, s55
    s_mov_b32 s47, s46
    s_lshr_b64 s[46:47], s[46:47], s42
    v_mov_b32 v235, s46
    s_mov_b64 exec, 1
    ds_or_b32 v14, v235 offset:64
    s_mov_b64 exec, -1
    s_branch L_sel4
L_sel4_ok:
    s_waitcnt vmcnt(10) lgkmcnt(0)
    v_mfma_f32_16x16x32_bf16 v[120:123], v[88:91], v[40:43], v[120:123]
    ds_read_b64_tr_b16 v[104:105], v244 offset:4096
    ds_read_b64_tr_b16 v[106:107], v244 offset:6144
    v_mfma_f32_16x16x32_bf16 v[124:127], v[92:95], v[40:43], v[124:127]
    ds_read_b64_tr_b16 v[108:109], v245 offset:4096
    ds_read_b64_tr_b16 v[110:111], v245 offset:6144
    v_mfma_f32_16x16x32_bf16 v[128:131], v[96:99], v[40:43], v[128:131]
    ds_read_b64_tr_b16 v[112:113], v246 offset:4096
    ds_read_b64_tr_b16 v[114:115], v246 offset:6144
    v_mfma_f32_16x16x32_bf16 v[132:135], v[100:103], v[40:43], v[132:135]
    ds_read_b64_tr_b16 v[116:117], v247 offset:4096
    ds_read_b64_tr_b16 v[118:119], v247 offset:6144
    v_mfma_f32_16x16x32_bf16 v[136:139], v[88:91], v[44:47], v[136:139]
    v_add_u32 v8, s30, v236
    v_add_u32 v9, s30, v237
    v_mfma_f32_16x16x32_bf16 v[140:143], v[92:95], v[44:47], v[140:143]
    v_add_u32 v10, s30, v238
    v_add_u32 v11, s30, v239
    v_mfma_f32_16x16x32_bf16 v[144:147], v[96:99], v[44:47], v[144:147]
    s_ff1_i32_b32 s46, s50
    s_bitset0_b32 s50, s46
    s_add_u32 s48, s46, s42
    v_mfma_f32_16x16x32_bf16 v[148:151], v[100:103], v[44:47], v[148:151]
    s_and_b32 s48, s48, 31
    s_lshl_b32 s48, s48, 10
    s_bitset0_b32 s51, s46
    s_waitcnt vmcnt(8) lgkmcnt(0)
    v_mfma_f32_16x16x32_bf16 v[120:123], v[104:107], v[48:51], v[120:123]
    ds_read_b64_tr_b16 v[88:89], v8 offset:0
    ds_read_b64_tr_b16 v[90:91], v8 offset:2048
    v_mfma_f32_16x16x32_bf16 v[124:127], v[108:111], v[48:51], v[124:127]
    ds_read_b64_tr_b16 v[92:93], v9 offset:0
    ds_read_b64_tr_b16 v[94:95], v9 offset:2048
    v_mfma_f32_16x16x32_bf16 v[128:131], v[112:115], v[48:51], v[128:131]
    ds_read_b64_tr_b16 v[96:97], v10 offset:0
    ds_read_b64_tr_b16 v[98:99], v10 offset:2048
    v_mfma_f32_16x16x32_bf16 v[132:135], v[116:119], v[48:51], v[132:135]
    ds_read_b64_tr_b16 v[100:101], v11 offset:0
    ds_read_b64_tr_b16 v[102:103], v11 offset:2048
    v_mfma_f32_16x16x32_bf16 v[136:139], v[104:107], v[52:55], v[136:139]
    buffer_load_dwordx4 v[24:27], v5, s[64:67], s48 offen offset:0 sc1
    s_lshl_b32 s28, s46, 12
    v_mfma_f32_16x16x32_bf16 v[140:143], v[108:111], v[52:55], v[140:143]
    buffer_load_dwordx4 v[28:31], v242, s[64:67], s48 offen offset:0 sc1
    v_mfma_f32_16x16x32_bf16 v[144:147], v[112:115], v[52:55], v[144:147]
    buffer_load_dwordx4 v[32:35], v5, s[64:67], s48 offen offset:1024 sc1
    v_mfma_f32_16x16x32_bf16 v[148:151], v[116:119], v[52:55], v[148:151]
    buffer_load_dwordx4 v[36:39], v242, s[64:67], s48 offen offset:1024 sc1
    s_cmp_lg_u32 s50, 0
    s_cbranch_scc1 L_sel5_ok
    s_mov_b32 s45, 0
    s_cmp_lg_u32 s51, 0
    s_cbranch_scc1 L_sel5
    s_mov_b32 s66, 0
    s_mov_b32 s50, 0x55555555
    s_branch L_sel5_ok
L_sel5:
    ds_read_b32 v235, v14 offset:64
    ds_read_b32 v13, v20 offset:60
    s_add_u32 s45, s45, 1
    s_waitcnt lgkmcnt(0)
    v_and_b32 v13, v13, v235
    s_cmp_gt_u32 s45, 0x40000
    s_cselect_b32 s46, -1, 0
    v_readfirstlane_b32 s50, v13
    s_nop 3
    s_or_b32 s50, s50, s46
    s_and_b32 s50, s50, s51
    s_cbranch_scc1 L_sel5_ok
    s_cmp_lg_u32 s54, 0x5555
    s_cbranch_scc1 L_sel5_p
    s_sleep 1
    s_branch L_sel5
L_sel5_p:
    s_load_dwordx16 s[4:19], s[26:27], s52 glc
    s_add_u32 s45, s45, 8
    s_waitcnt lgkmcnt(0)
    s_mov_b32 s54, 0
    s_cmp_eq_u64 s[4:5], s[72:73]
    s_cselect_b32 s46, 0x1, 0
    s_or_b32 s54, s54, s46
    s_cmp_eq_u64 s[6:7], s[72:73]
    s_cselect_b32 s46, 0x4, 0
    s_or_b32 s54, s54, s46
    s_cmp_eq_u64 s[8:9], s[72:73]
    s_cselect_b32 s46, 0x10, 0
    s_or_b32 s54, s54, s46
    s_cmp_eq_u64 s[10:11], s[72:73]
    s_cselect_b32 s46, 0x40, 0
    s_or_b32 s54, s54, s46
    s_cmp_eq_u64 s[12:13], s[72:73]
    s_cselect_b32 s46, 0x100, 0
    s_or_b32 s54, s54, s46
    s_cmp_eq_u64 s[14:15], s[72:73]
    s_cselect_b32 s46, 0x400, 0
    s_or_b32 s54, s54, s46
    s_cmp_eq_u64 s[16:17], s[72:73]
    s_cselect_b32 s46, 0x1000, 0
    s_or_b32 s54, s54, s46
    s_cmp_eq_u64 s[18:19], s[72:73]
    s_cselect_b32 s46, 0x4000, 0
    s_or_b32 s54, s54, s46
    s_lshl_b32 s46, s54, s55
    s_mov_b32 s47, s46
    s_lshr_b64 s[46:47], s[46:47], s42
    v_mov_b32 v235, s46
    s_mov_b64 exec, 1
    ds_or_b32 v14, v235 offset:64
    s_mov_b64 exec, -1
    s_branch L_sel5
L_sel5_ok:
    s_waitcnt vmcnt(10) lgkmcnt(0)
    v_mfma_f32_16x16x32_bf16 v[120:123], v[88:91], v[56:59], v[120:123]
    ds_read_b64_tr_b16 v[104:105], v8 offset:4096
    ds_read_b64_tr_b16 v[106:107], v8 offset:6144
    v_mfma_f32_16x16x32_bf16 v[124:127], v[92:95], v[56:59], v[124:127]
    ds_read_b64_tr_b16 v[108:109], v9 offset:4096
    ds_read_b64_tr_b16 v[110:111], v9 offset:6144
    v_mfma_f32_16x16x32_bf16 v[128:131], v[96:99], v[56:59], v[128:131]
    ds_read_b64_tr_b16 v[112:113], v10 offset:4096
    ds_read_b64_tr_b16 v[114:115], v10 offset:6144
    v_mfma_f32_16x16x32_bf16 v[132:135], v[100:103], v[56:59], v[132:135]
    ds_read_b64_tr_b16 v[116:117], v11 offset:4096
    ds_read_b64_tr_b16 v[118:119], v11 offset:6144
    v_mfma_f32_16x16x32_bf16 v[136:139], v[88:91], v[60:63], v[136:139]
    v_add_u32 v244, s31, v236
    v_add_u32 v245, s31, v237
    v_mfma_f32_16x16x32_bf16 v[140:143], v[92:95], v[60:63], v[140:143]
    v_add_u32 v246, s31, v238
    v_add_u32 v247, s31, v239
    v_mfma_f32_16x16x32_bf16 v[144:147], v[96:99], v[60:63], v[144:147]
    s_ff1_i32_b32 s46, s50
    s_bitset0_b32 s50, s46
    s_add_u32 s48, s46, s42
    v_mfma_f32_16x16x32_bf16 v[148:151], v[100:103], v[60:63], v[148:151]
    s_and_b32 s48, s48, 31
    s_lshl_b32 s48, s48, 10
    s_bitset0_b32 s51, s46
    s_waitcnt vmcnt(8) lgkmcnt(0)
    v_mfma_f32_16x16x32_bf16 v[120:123], v[104:107], v[64:67], v[120:123]
    ds_read_b64_tr_b16 v[88:89], v244 offset:0
    ds_read_b64_tr_b16 v[90:91], v244 offset:2048
    v_mfma_f32_16x16x32_bf16 v[124:127], v[108:111], v[64:67], v[124:127]
    ds_read_b64_tr_b16 v[92:93], v245 offset:0
    ds_read_b64_tr_b16 v[94:95], v245 offset:2048
    v_mfma_f32_16x16x32_bf16 v[128:131], v[112:115], v[64:67], v[128:131]
    ds_read_b64_tr_b16 v[96:97], v246 offset:0
    ds_read_b64_tr_b16 v[98:99], v246 offset:2048
    v_mfma_f32_16x16x32_bf16 v[132:135], v[116:119], v[64:67], v[132:135]
    ds_read_b64_tr_b16 v[100:101], v247 offset:0
    ds_read_b64_tr_b16 v[102:103], v247 offset:2048
    v_mfma_f32_16x16x32_bf16 v[136:139], v[104:107], v[68:71], v[136:139]
    buffer_load_dwordx4 v[40:43], v5, s[64:67], s48 offen offset:0 sc1
    s_lshl_b32 s29, s46, 12
    v_mfma_f32_16x16x32_bf16 v[140:143], v[108:111], v[68:71], v[140:143]
    buffer_load_dwordx4 v[44:47], v242, s[64:67], s48 offen offset:0 sc1
    v_mfma_f32_16x16x32_bf16 v[144:147], v[112:115], v[68:71], v[144:147]
    buffer_load_dwordx4 v[48:51], v5, s[64:67], s48 offen offset:1024 sc1
    v_mfma_f32_16x16x32_bf16 v[148:151], v[116:119], v[68:71], v[148:151]
    buffer_load_dwordx4 v[52:55], v242, s[64:67], s48 offen offset:1024 sc1
    s_cmp_lg_u32 s50, 0
    s_cbranch_scc1 L_sel6_ok
    s_mov_b32 s45, 0
    s_cmp_lg_u32 s51, 0
    s_cbranch_scc1 L_sel6
    s_mov_b32 s66, 0
    s_mov_b32 s50, 0x55555555
    s_branch L_sel6_ok
L_sel6:
    ds_read_b32 v235, v14 offset:64
    ds_read_b32 v13, v20 offset:60
    s_add_u32 s45, s45, 1
    s_waitcnt lgkmcnt(0)
    v_and_b32 v13, v13, v235
    s_cmp_gt_u32 s45, 0x40000
    s_cselect_b32 s46, -1, 0
    v_readfirstlane_b32 s50, v13
    s_nop 3
    s_or_b32 s50, s50, s46
    s_and_b32 s50, s50, s51
    s_cbranch_scc1 L_sel6_ok
    s_cmp_lg_u32 s54, 0x5555
    s_cbranch_scc1 L_sel6_p
    s_sleep 1
    s_branch L_sel6
L_sel6_p:
    s_load_dwordx16 s[4:19], s[26:27], s52 glc
    s_add_u32 s45, s45, 8
    s_waitcnt lgkmcnt(0)
    s_mov_b32 s54, 0
    s_cmp_eq_u64 s[4:5], s[72:73]
    s_cselect_b32 s46, 0x1, 0
    s_or_b32 s54, s54, s46
    s_cmp_eq_u64 s[6:7], s[72:73]
    s_cselect_b32 s46, 0x4, 0
    s_or_b32 s54, s54, s46
    s_cmp_eq_u64 s[8:9], s[72:73]
    s_cselect_b32 s46, 0x10, 0
    s_or_b32 s54, s54, s46
    s_cmp_eq_u64 s[10:11], s[72:73]
    s_cselect_b32 s46, 0x40, 0
    s_or_b32 s54, s54, s46
    s_cmp_eq_u64 s[12:13], s[72:73]
    s_cselect_b32 s46, 0x100, 0
    s_or_b32 s54, s54, s46
    s_cmp_eq_u64 s[14:15], s[72:73]
    s_cselect_b32 s46, 0x400, 0
    s_or_b32 s54, s54, s46
    s_cmp_eq_u64 s[16:17], s[72:73]
    s_cselect_b32 s46, 0x1000, 0
    s_or_b32 s54, s54, s46
    s_cmp_eq_u64 s[18:19], s[72:73]
    s_cselect_b32 s46, 0x4000, 0
    s_or_b32 s54, s54, s46
    s_lshl_b32 s46, s54, s55
    s_mov_b32 s47, s46
    s_lshr_b64 s[46:47], s[46:47], s42
    v_mov_b32 v235, s46
    s_mov_b64 exec, 1
    ds_or_b32 v14, v235 offset:64
    s_mov_b64 exec, -1
    s_branch L_sel6
L_sel6_ok:
    s_waitcnt vmcnt(10) lgkmcnt(0)
    v_mfma_f32_16x16x32_bf16 v[120:123], v[88:91], v[72:75], v[120:123]
    ds_read_b64_tr_b16 v[104:105], v244 offset:4096
    ds_read_b64_tr_b16 v[106:107], v244 offset:6144
    v_mfma_f32_16x16x32_bf16 v[124:127], v[92:95], v[72:75], v[124:127]
    ds_read_b64_tr_b16 v[108:109], v245 offset:4096
    ds_read_b64_tr_b16 v[110:111], v245 offset:6144
    v_mfma_f32_16x16x32_bf16 v[128:131], v[96:99], v[72:75], v[128:131]
    ds_read_b64_tr_b16 v[112:113], v246 offset:4096
    ds_read_b64_tr_b16 v[114:115], v246 offset:6144
    v_mfma_f32_16x16x32_bf16 v[132:135], v[100:103], v[72:75], v[132:135]
    ds_read_b64_tr_b16 v[116:117], v247 offset:4096
    ds_read_b64_tr_b16 v[118:119], v247 offset:6144
    v_mfma_f32_16x16x32_bf16 v[136:139], v[88:91], v[76:79], v[136:139]
    v_add_u32 v8, s28, v236
    v_add_u32 v9, s28, v237
    v_mfma_f32_16x16x32_bf16 v[140:143], v[92:95], v[76:79], v[140:143]
    v_add_u32 v10, s28, v238
    v_add_u32 v11, s28, v239
    v_mfma_f32_16x16x32_bf16 v[144:147], v[96:99], v[76:79], v[144:147]
    s_ff1_i32_b32 s46, s50
    s_bitset0_b32 s50, s46
    s_add_u32 s48, s46, s42
    v_mfma_f32_16x16x32_bf16 v[148:151], v[100:103], v[76:79], v[148:151]
    s_and_b32 s48, s48, 31
    s_lshl_b32 s48, s48, 10
    s_bitset0_b32 s51, s46
    s_waitcnt vmcnt(8) lgkmcnt(0)
    v_mfma_f32_16x16x32_bf16 v[120:123], v[104:107], v[80:83], v[120:123]
    ds_read_b64_tr_b16 v[88:89], v8 offset:0
    ds_read_b64_tr_b16 v[90:91], v8 offset:2048
    v_mfma_f32_16x16x32_bf16 v[124:127], v[108:111], v[80:83], v[124:127]
    ds_read_b64_tr_b16 v[92:93], v9 offset:0
    ds_read_b64_tr_b16 v[94:95], v9 offset:2048
    v_mfma_f32_16x16x32_bf16 v[128:131], v[112:115], v[80:83], v[128:131]
    ds_read_b64_tr_b16 v[96:97], v10 offset:0
    ds_read_b64_tr_b16 v[98:99], v10 offset:2048
    v_mfma_f32_16x16x32_bf16 v[132:135], v[116:119], v[80:83], v[132:135]
    ds_read_b64_tr_b16 v[100:101], v11 offset:0
    ds_read_b64_tr_b16 v[102:103], v11 offset:2048
    v_mfma_f32_16x16x32_bf16 v[136:139], v[104:107], v[84:87], v[136:139]
    buffer_load_dwordx4 v[56:59], v5, s[64:67], s48 offen offset:0 sc1
    buffer_load_dwordx4 v[60:63], v242, s[64:67], s48 offen offset:0 sc1
    v_mfma_f32_16x16x32_bf16 v[140:143], v[108:111], v[84:87], v[140:143]
    s_lshl_b32 s30, s46, 12
    buffer_load_dwordx4 v[64:67], v5, s[64:67], s48 offen offset:1024 sc1
    v_mfma_f32_16x16x32_bf16 v[144:147], v[112:115], v[84:87], v[144:147]
    s_add_u32 s53, s53, 1
    buffer_load_dwordx4 v[68:71], v242, s[64:67], s48 offen offset:1024 sc1
    v_mfma_f32_16x16x32_bf16 v[148:151], v[116:119], v[84:87], v[148:151]
    s_cmp_lt_u32 s53, 4
    s_cbranch_scc1 L_gloop
    s_lshl_b32 s48, s59, 16
    s_lshl_b32 s49, s35, 7
    s_add_u32 s48, s48, s49
    s_add_u32 s49, s48, 0x8000
    s_add_u32 s50, s48, 0x10000
    s_add_u32 s51, s48, 0x18000
    s_waitcnt lgkmcnt(0)
    v_cvt_pk_bf16_f32 v172, v120, v121
    v_cvt_pk_bf16_f32 v173, v122, v123
    v_cvt_pk_bf16_f32 v174, v124, v125
    v_cvt_pk_bf16_f32 v175, v126, v127
    v_cvt_pk_bf16_f32 v176, v128, v129
    v_cvt_pk_bf16_f32 v177, v130, v131
    v_cvt_pk_bf16_f32 v178, v132, v133
    v_cvt_pk_bf16_f32 v179, v134, v135
    v_cvt_pk_bf16_f32 v180, v136, v137
    v_cvt_pk_bf16_f32 v181, v138, v139
    v_cvt_pk_bf16_f32 v182, v140, v141
    v_cvt_pk_bf16_f32 v183, v142, v143
    v_cvt_pk_bf16_f32 v184, v144, v145
    v_cvt_pk_bf16_f32 v185, v146, v147
    v_cvt_pk_bf16_f32 v186, v148, v149
    v_cvt_pk_bf16_f32 v187, v150, v151
    s_nop 1
    v_permlane16_swap_b32 v172, v174
    v_permlane16_swap_b32 v173, v175
    v_permlane16_swap_b32 v176, v178
    v_permlane16_swap_b32 v177, v179
    v_permlane16_swap_b32 v180, v182
    v_permlane16_swap_b32 v181, v183
    v_permlane16_swap_b32 v184, v186
    v_permlane16_swap_b32 v185, v187
    ds_write_b128 v15, v[172:175]
    ds_write_b128 v18, v[176:179]
    ds_read_b128 v[88:91], v16 offset:0
    ds_read_b128 v[92:95], v16 offset:1024
    ds_write_b128 v15, v[180:183]
    ds_write_b128 v18, v[184:187]
    ds_read_b128 v[96:99], v16 offset:0
    ds_read_b128 v[100:103], v16 offset:1024
    s_waitcnt lgkmcnt(5)
    buffer_store_dwordx4 v[88:91], v17, s[68:71], s48 offen sc1
    s_waitcnt lgkmcnt(4)
    buffer_store_dwordx4 v[92:95], v17, s[68:71], s49 offen sc1
    s_waitcnt lgkmcnt(1)
    buffer_store_dwordx4 v[96:99], v17, s[68:71], s50 offen sc1
    s_waitcnt lgkmcnt(0)
    buffer_store_dwordx4 v[100:103], v17, s[68:71], s51 offen sc1
    s_endpgm
L_exit:
    s_endpgm
L_code_end:
.section .rodata,"a"
.p2align 6
.amdhsa_kernel concat_heads__linear_attn_block__ssm_conv_h3__prompt_kernel
  .amdhsa_next_free_vgpr 256
  .amdhsa_next_free_sgpr 102
  .amdhsa_accum_offset 256
  .amdhsa_group_segment_fixed_size 0
  .amdhsa_kernarg_size 96
  .amdhsa_user_sgpr_count 2
  .amdhsa_user_sgpr_kernarg_segment_ptr 1
  .amdhsa_system_sgpr_workgroup_id_x 1
.end_amdhsa_kernel
```

```asm
; @launch grid=(256,1,1) block=(512,1,1) lds=163840
.amdgcn_target "amdgcn-amd-amdhsa--gfx950"
.text
.globl concat_heads__linear_attn_block__ssm_conv_h3__prompt_kernel
.type concat_heads__linear_attn_block__ssm_conv_h3__prompt_kernel,@function
.p2align 8
concat_heads__linear_attn_block__ssm_conv_h3__prompt_kernel:
    s_cmp_ge_u32 s2, 256
    s_cbranch_scc1 L_exit
    s_load_dwordx16 s[4:19], s[0:1], 0
    s_load_dwordx8 s[20:27], s[0:1], 64
    s_getpc_b64 s[48:49]
L_pc:
    s_and_b32 s45, s2, 24
    s_lshl_b32 s45, s45, 4
    v_lshl_add_u32 v2, v0, 9, s45
    v_cmp_gt_u32 vcc, L_code_end-L_pc-4, v2
    s_and_saveexec_b64 s[50:51], vcc
    s_cbranch_execz L_pf
    global_load_dword v252, v2, s[48:49]
L_pf:
    s_mov_b64 exec, s[50:51]
    v_lshrrev_b32 v1, 6, v0
    v_and_b32 v4, 63, v0
    v_readfirstlane_b32 s3, v1
    v_lshlrev_b32 v5, 4, v4
    s_and_b32 s28, s2, 7
    s_lshr_b32 s29, s2, 3
    s_and_b32 s30, s28, 1
    s_lshl_b32 s30, s30, 3
    s_and_b32 s40, s29, 7
    s_add_u32 s30, s30, s40
    s_lshr_b32 s40, s28, 1
    s_and_b32 s41, s28, 4
    s_and_b32 s42, s28, 2
    s_lshl2_add_u32 s41, s42, s41
    s_lshr_b32 s42, s29, 3
    s_add_u32 s32, s41, s42
    s_add_u32 s42, s42, 3
    s_and_b32 s42, s42, 3
    s_add_u32 s31, s41, s42
    s_and_b32 s41, s30, 1
    s_lshl_b32 s33, s41, 1
    s_and_b32 s41, s30, 2
    s_lshl_b32 s41, s41, 2
    s_add_u32 s33, s33, s41
    s_and_b32 s41, s28, 1
    s_lshl_b32 s41, s41, 2
    s_add_u32 s33, s33, s41
    s_and_b32 s41, s31, 1
    s_lshl_b32 s41, s41, 1
    s_add_u32 s33, s33, s41
    s_lshl_b32 s41, s40, 2
    s_add_u32 s33, s33, s41
    s_and_b32 s33, s33, 15
    s_cmp_lt_u32 s3, 4
    s_cbranch_scc1 L_comp
    s_sub_u32 s3, s3, 4
    v_lshrrev_b32 v1, 3, v4
    v_and_b32 v2, 7, v4
    v_lshrrev_b32 v3, 4, v4
    v_xor_b32 v6, v2, v3
    v_lshlrev_b32 v6, 4, v6
    v_lshl_add_u32 v6, v1, 11, v6
    s_lshl_b32 s60, s30, 7
    s_lshl_b32 s61, s3, 5
    s_add_u32 s60, s60, s61
    s_lshl_b32 s60, s60, 11
    v_add_u32 v8, s60, v6
    v_xor_b32 v6, 64, v8
    v_add_u32 v9, 15360, v6
    v_add_u32 v10, 30720, v8
    v_add_u32 v11, 46080, v6
    v_and_b32 v3, 1, v3
    v_lshlrev_b32 v3, 2, v3
    v_xor_b32 v7, v2, v3
    v_lshlrev_b32 v7, 4, v7
    v_xor_b32 v6, 32, v7
    s_movk_i32 s61, 6144
    v_mad_u32_u24 v7, v1, s61, v7
    v_mad_u32_u24 v6, v1, s61, v6
    s_mul_i32 s60, s3, 98304
    v_add_u32 v12, s60, v7
    s_add_u32 s60, s60, 48128
    v_add_u32 v13, s60, v6
    s_lshl_b32 s65, s3, 12
    s_lshl_b32 s66, s3, 11
    s_add_u32 s66, s66, 0x4000
    s_mov_b32 s64, 0
    s_mov_b32 s67, s33
    s_lshl_b32 s74, s32, 7
    s_lshl_b32 s75, s31, 7
    s_add_u32 s75, s75, 2048
    s_mov_b32 s42, 0x400000
    s_mov_b32 s43, 0x20000
    s_mov_b32 s46, 0x600000
    s_mov_b32 s47, 0x20000
    s_waitcnt lgkmcnt(0)
    s_mov_b64 s[40:41], s[4:5]
    s_mov_b64 s[44:45], s[6:7]
    s_add_u32 m0, s64, s65
    s_lshl_b32 s60, s67, 7
    s_mul_i32 s63, s67, 393216
    buffer_load_dwordx4 v8, s[40:43], s60 offen offset:0  lds
    buffer_load_dwordx4 v9, s[40:43], s60 offen offset:1024  lds
    buffer_load_dwordx4 v10, s[40:43], s60 offen offset:2048  lds
    buffer_load_dwordx4 v11, s[40:43], s60 offen offset:3072  lds
    s_add_u32 m0, s64, s66
    s_add_u32 s61, s63, s74
    s_add_u32 s62, s63, s75
    buffer_load_dwordx4 v12, s[44:47], s61 offen offset:0  lds
    buffer_load_dwordx4 v13, s[44:47], s61 offen offset:1024  lds
    s_add_u32 m0, m0, 8192
    s_add_u32 s63, s62, 2048
    buffer_load_dwordx4 v12, s[44:47], s62 offen offset:0  lds
    buffer_load_dwordx4 v13, s[44:47], s62 offen offset:1024  lds
    s_add_u32 m0, m0, 8192
    s_add_u32 s67, s67, 1
    buffer_load_dwordx4 v12, s[44:47], s63 offen offset:0  lds
    buffer_load_dwordx4 v13, s[44:47], s63 offen offset:1024  lds
    s_and_b32 s67, s67, 15
    s_add_u32 s64, s64, 40960
    s_cmp_eq_u32 s64, 122880
    s_cselect_b32 s64, 0, s64
    s_barrier
    s_and_b32 s34, s28, 3
    s_lshl_b32 s34, s34, 2
    s_and_b32 vcc_lo, s29, 3
    s_add_u32 s34, s34, vcc_lo
    s_lshr_b32 s35, s28, 2
    s_lshl_b32 s35, s35, 3
    s_lshr_b32 vcc_lo, s29, 2
    s_add_u32 s35, s35, vcc_lo
    s_and_b32 s36, s29, 15
    s_lshr_b32 s37, s29, 4
    s_lshl_b32 vcc_lo, s28, 1
    s_add_u32 s37, s37, vcc_lo
    s_lshl_b32 s38, s28, 5
    s_add_u32 s38, s38, s29
    s_lshl_b32 s38, s38, 2
    v_mov_b32 v6, 0
    v_mov_b32 v14, 1
    v_mov_b32 v15, 162816
    v_lshlrev_b32 v255, 7, v4
    s_nop 0
    s_mov_b32 s48, s26
    s_mov_b32 s49, s27
    s_mov_b32 s50, 0x2000000
    s_mov_b32 s51, 0x20000
    s_mov_b32 s52, s24
    s_mov_b32 s53, s25
    s_mov_b32 s54, 0x100
    s_mov_b32 s55, 0x20000
    s_or_b32 s60, s2, s3
    s_cmp_eq_u32 s60, 0
    s_cbranch_scc0 L_noep
    s_memrealtime s[60:61]
    s_waitcnt lgkmcnt(0)
    s_or_b32 s60, s60, 1
    v_mov_b32 v7, s60
    s_mov_b64 exec, 1
    buffer_store_dword v7, v6, s[52:55], 0 offen sc1
    s_mov_b64 exec, -1
L_noep:
    s_mul_i32 s68, s3, 4608
    s_add_u32 s68, s68, 139776
    s_lshl_b32 s69, s37, 7
    s_lshl_b32 s70, s3, 5
    s_add_u32 s69, s69, s70
    v_lshrrev_b32 v28, 4, v4
    v_bfe_u32 v29, v4, 2, 2
    v_and_b32 v30, 3, v4
    v_and_b32 v31, 15, v4
    s_lshl_b32 s60, s3, 12
    s_add_u32 s60, s60, 139776
    v_add_u32 v247, s60, v5
    s_and_b32 s60, s3, 1
    s_lshl_b32 s60, s60, 6
    v_xor_b32 v247, s60, v247
    v_xor_b32 v248, 16, v247
    v_xor_b32 v249, 32, v247
    v_xor_b32 v250, 48, v247
    v_lshlrev_b32 v3, 12, v28
    v_lshl_add_u32 v25, v31, 4, v3
    s_lshl_b32 s60, s36, 18
    s_lshl_b32 s61, s3, 16
    s_add_u32 s60, s60, s61
    s_lshl_b32 s61, s37, 8
    s_sub_u32 s60, s60, s61
    s_add_u32 s60, s60, 3840
    v_add_u32 v25, s60, v25
    v_lshlrev_b32 v26, 5, v4
    v_and_b32 v3, 1, v28
    v_lshlrev_b32 v3, 2, v3
    v_xor_b32 v3, v2, v3
    v_lshrrev_b32 v27, 5, v4
    v_lshlrev_b32 v27, 1, v27
    v_xor_b32 v3, v27, v3
    v_lshlrev_b32 v3, 4, v3
    v_lshl_add_u32 v3, v1, 11, v3
    s_lshl_b32 s60, s35, 7
    v_add_u32 v20, s60, v3
    v_add_u32 v21, 15360, v20
    v_add_u32 v22, 30720, v20
    v_add_u32 v23, 46080, v20
    s_mov_b32 s70, 0xffff0000
    v_and_b32 v3, 1, v28
    s_movk_i32 s60, 2304
    v_mul_u32_u24 v3, s60, v3
    v_lshl_add_u32 v3, v31, 4, v3
    v_add_u32 v251, s68, v3
    s_mul_i32 s71, s3, 8320
    s_add_u32 s71, s71, 98304
    v_add_u32 v19, s71, v5
    s_movk_i32 s61, 4160
    v_and_b32 v24, 1, v29
    v_mul_u32_u24 v24, s61, v24
    v_lshl_add_u32 v24, v30, 4, v24
    v_add_u32 v24, s71, v24
    v_add_u32 v3, 1, v31
    v_and_b32 v16, 1, v3
    v_add_u32 v17, v16, v31
    v_mul_u32_u24 v3, s61, v16
    v_lshl_add_u32 v3, v28, 5, v3
    v_lshlrev_b32 v17, 1, v17
    v_sub_u32 v3, v3, v17
    s_add_u32 s60, s71, 3486
    v_add_u32 v240, s60, v3
    v_subrev_u32 v241, 1024, v240
    v_subrev_u32 v242, 2048, v240
    v_subrev_u32 v243, 3072, v240
    v_add_u32 v3, v31, v28
    s_add_u32 s60, s68, 208
    v_lshlrev_b32 v3, 4, v3
    v_add_u32 v244, s60, v3
    v_lshlrev_b32 v3, 5, v31
    v_lshl_add_u32 v16, v28, 3, v3
    s_add_u32 s60, s71, 504
    v_sub_u32 v245, s60, v16
    v_and_b32 v16, 1, v28
    v_lshl_add_u32 v3, v16, 9, v3
    v_lshrrev_b32 v16, 5, v4
    v_lshl_add_u32 v246, v16, 4, v3
    v_lshlrev_b32 v27, 4, v2
    v_lshl_add_u32 v16, v1, 11, v27
    v_lshl_add_u32 v17, v1, 12, v27
    s_add_u32 s39, s38, s3
    s_and_b32 s60, s39, 0xfffffffe
    s_lshl_b32 s60, s60, 1
    s_load_dword s71, s[20:21], s60
    s_lshl_b32 s61, s39, 12
    v_mov_b64 v[160:161], 0
    v_mov_b64 v[162:163], 0
    v_mov_b64 v[164:165], 0
    v_mov_b64 v[166:167], 0
    v_mov_b64 v[168:169], 0
    v_mov_b64 v[170:171], 0
    v_mov_b64 v[172:173], 0
    v_mov_b64 v[174:175], 0
    v_mov_b64 v[176:177], 0
    v_mov_b64 v[178:179], 0
    v_mov_b64 v[180:181], 0
    v_mov_b64 v[182:183], 0
    v_mov_b64 v[184:185], 0
    v_mov_b64 v[186:187], 0
    v_mov_b64 v[188:189], 0
    v_mov_b64 v[190:191], 0
    s_add_u32 s52, s18, s61
    s_addc_u32 s53, s19, 0
    s_mov_b32 s54, 0x1000
    s_mov_b32 s55, 0x20000
    s_mov_b32 s56, s8
    s_mov_b32 s57, s9
    s_mov_b32 s58, 0x200000
    s_mov_b32 s59, 0x20000
    s_waitcnt lgkmcnt(0)
    s_mov_b32 s20, s10
    s_mov_b32 s21, s11
    s_waitcnt vmcnt(0)
    s_barrier
    s_add_u32 m0, s64, s65
    s_lshl_b32 s60, s67, 7
    s_mul_i32 s63, s67, 393216
    buffer_load_dwordx4 v8, s[40:43], s60 offen offset:0  lds
    buffer_load_dwordx4 v9, s[40:43], s60 offen offset:1024  lds
    buffer_load_dwordx4 v10, s[40:43], s60 offen offset:2048  lds
    buffer_load_dwordx4 v11, s[40:43], s60 offen offset:3072  lds
    s_add_u32 m0, s64, s66
    s_add_u32 s61, s63, s74
    s_add_u32 s62, s63, s75
    buffer_load_dwordx4 v12, s[44:47], s61 offen offset:0  lds
    buffer_load_dwordx4 v13, s[44:47], s61 offen offset:1024  lds
    s_add_u32 m0, m0, 8192
    s_add_u32 s63, s62, 2048
    buffer_load_dwordx4 v12, s[44:47], s62 offen offset:0  lds
    buffer_load_dwordx4 v13, s[44:47], s62 offen offset:1024  lds
    s_add_u32 m0, m0, 8192
    s_add_u32 s67, s67, 1
    buffer_load_dwordx4 v12, s[44:47], s63 offen offset:0  lds
    buffer_load_dwordx4 v13, s[44:47], s63 offen offset:1024  lds
    s_and_b32 s67, s67, 15
    s_add_u32 s64, s64, 40960
    s_cmp_eq_u32 s64, 122880
    s_cselect_b32 s64, 0, s64
    s_add_u32 m0, s64, s65
    s_lshl_b32 s60, s67, 7
    s_mul_i32 s63, s67, 393216
    buffer_load_dwordx4 v8, s[40:43], s60 offen offset:0  lds
    buffer_load_dwordx4 v9, s[40:43], s60 offen offset:1024  lds
    buffer_load_dwordx4 v10, s[40:43], s60 offen offset:2048  lds
    buffer_load_dwordx4 v11, s[40:43], s60 offen offset:3072  lds
    s_add_u32 m0, s64, s66
    s_add_u32 s61, s63, s74
    s_add_u32 s62, s63, s75
    buffer_load_dwordx4 v12, s[44:47], s61 offen offset:0  lds
    buffer_load_dwordx4 v13, s[44:47], s61 offen offset:1024  lds
    s_add_u32 m0, m0, 8192
    s_add_u32 s63, s62, 2048
    buffer_load_dwordx4 v12, s[44:47], s62 offen offset:0  lds
    buffer_load_dwordx4 v13, s[44:47], s62 offen offset:1024  lds
    s_add_u32 m0, m0, 8192
    s_add_u32 s67, s67, 1
    buffer_load_dwordx4 v12, s[44:47], s63 offen offset:0  lds
    buffer_load_dwordx4 v13, s[44:47], s63 offen offset:1024  lds
    s_and_b32 s67, s67, 15
    s_add_u32 s64, s64, 40960
    s_cmp_eq_u32 s64, 122880
    s_cselect_b32 s64, 0, s64
    s_waitcnt vmcnt(10)
    s_barrier
    s_add_u32 m0, s64, s65
    s_lshl_b32 s60, s67, 7
    s_mul_i32 s63, s67, 393216
    buffer_load_dwordx4 v8, s[40:43], s60 offen offset:0  lds
    buffer_load_dwordx4 v9, s[40:43], s60 offen offset:1024  lds
    buffer_load_dwordx4 v10, s[40:43], s60 offen offset:2048  lds
    buffer_load_dwordx4 v11, s[40:43], s60 offen offset:3072  lds
    s_add_u32 m0, s64, s66
    s_add_u32 s61, s63, s74
    s_add_u32 s62, s63, s75
    buffer_load_dwordx4 v12, s[44:47], s61 offen offset:0  lds
    buffer_load_dwordx4 v13, s[44:47], s61 offen offset:1024  lds
    s_add_u32 m0, m0, 8192
    s_add_u32 s63, s62, 2048
    buffer_load_dwordx4 v12, s[44:47], s62 offen offset:0  lds
    buffer_load_dwordx4 v13, s[44:47], s62 offen offset:1024  lds
    s_add_u32 m0, m0, 8192
    s_add_u32 s67, s67, 1
    buffer_load_dwordx4 v12, s[44:47], s63 offen offset:0  lds
    buffer_load_dwordx4 v13, s[44:47], s63 offen offset:1024  lds
    s_and_b32 s67, s67, 15
    s_add_u32 s64, s64, 40960
    s_cmp_eq_u32 s64, 122880
    s_cselect_b32 s64, 0, s64
    s_waitcnt vmcnt(10)
    s_barrier
    s_add_u32 m0, s64, s65
    s_lshl_b32 s60, s67, 7
    s_mul_i32 s63, s67, 393216
    buffer_load_dwordx4 v8, s[40:43], s60 offen offset:0  lds
    buffer_load_dwordx4 v9, s[40:43], s60 offen offset:1024  lds
    buffer_load_dwordx4 v10, s[40:43], s60 offen offset:2048  lds
    buffer_load_dwordx4 v11, s[40:43], s60 offen offset:3072  lds
    s_add_u32 m0, s64, s66
    s_add_u32 s61, s63, s74
    s_add_u32 s62, s63, s75
    buffer_load_dwordx4 v12, s[44:47], s61 offen offset:0  lds
    buffer_load_dwordx4 v13, s[44:47], s61 offen offset:1024  lds
    s_add_u32 m0, m0, 8192
    s_add_u32 s63, s62, 2048
    buffer_load_dwordx4 v12, s[44:47], s62 offen offset:0  lds
    buffer_load_dwordx4 v13, s[44:47], s62 offen offset:1024  lds
    s_add_u32 m0, m0, 8192
    s_add_u32 s67, s67, 1
    buffer_load_dwordx4 v12, s[44:47], s63 offen offset:0  lds
    buffer_load_dwordx4 v13, s[44:47], s63 offen offset:1024  lds
    s_and_b32 s67, s67, 15
    s_add_u32 s64, s64, 40960
    s_cmp_eq_u32 s64, 122880
    s_cselect_b32 s64, 0, s64
    s_load_dword s72, s[24:25], 0
    s_lshl_b32 s33, s39, 7
    s_add_u32 s33, s33, 0x940000
    s_lshl_b32 s39, s39, 12
    s_lshl_b32 s60, s69, 11
    s_lshl_b32 s61, s36, 7
    s_add_u32 s60, s60, s61
    s_add_u32 s0, s20, s60
    s_addc_u32 s1, s21, 0
    s_lshl2_add_u32 s60, s29, s3
    s_lshl_b32 s60, s60, 14
    s_and_b32 s61, s28, 4
    s_lshl_b32 s61, s61, 8
    s_add_u32 s60, s60, s61
    s_add_u32 s6, s56, s60
    s_addc_u32 s7, s57, 0
    s_lshl2_add_u32 s60, s2, s3
    s_lshl_b32 s60, s60, 11
    s_add_u32 s8, s56, s60
    s_addc_u32 s9, s57, 0
    s_waitcnt vmcnt(10)
    s_barrier
    s_waitcnt lgkmcnt(0)
    s_mov_b32 s60, 0
L_eploop:
    s_cmp_lg_u32 s72, 0
    s_cbranch_scc1 L_epok
    s_sleep 8
    s_load_dword s72, s[24:25], 0 glc
    s_add_u32 s60, s60, 1
    s_cmp_gt_u32 s60, 0x4000
    s_waitcnt lgkmcnt(0)
    s_cbranch_scc0 L_eploop
L_epok:
    s_mov_b32 s73, s72
    v_mov_b32 v7, s72
    ds_write_b32 v15, v7 offset:56
    ds_write_b128 v251, v[160:163]
    s_add_u32 m0, s64, s65
    s_lshl_b32 s60, s67, 7
    s_mul_i32 s63, s67, 393216
    buffer_load_dwordx4 v8, s[40:43], s60 offen offset:0  lds
    buffer_load_dwordx4 v9, s[40:43], s60 offen offset:1024  lds
    buffer_load_dwordx4 v10, s[40:43], s60 offen offset:2048  lds
    buffer_load_dwordx4 v11, s[40:43], s60 offen offset:3072  lds
    s_add_u32 m0, s64, s66
    s_add_u32 s61, s63, s74
    s_add_u32 s62, s63, s75
    buffer_load_dwordx4 v12, s[44:47], s61 offen offset:0  lds
    buffer_load_dwordx4 v13, s[44:47], s61 offen offset:1024  lds
    s_add_u32 m0, m0, 8192
    s_add_u32 s63, s62, 2048
    buffer_load_dwordx4 v12, s[44:47], s62 offen offset:0  lds
    buffer_load_dwordx4 v13, s[44:47], s62 offen offset:1024  lds
    s_add_u32 m0, m0, 8192
    s_add_u32 s67, s67, 1
    buffer_load_dwordx4 v12, s[44:47], s63 offen offset:0  lds
    buffer_load_dwordx4 v13, s[44:47], s63 offen offset:1024  lds
    s_and_b32 s67, s67, 15
    s_add_u32 s64, s64, 40960
    s_cmp_eq_u32 s64, 122880
    s_cselect_b32 s64, 0, s64
    s_waitcnt vmcnt(10)
    s_barrier
    s_add_u32 m0, s64, s65
    s_lshl_b32 s60, s67, 7
    s_mul_i32 s63, s67, 393216
    buffer_load_dwordx4 v8, s[40:43], s60 offen offset:0  lds
    buffer_load_dwordx4 v9, s[40:43], s60 offen offset:1024  lds
    buffer_load_dwordx4 v10, s[40:43], s60 offen offset:2048  lds
    buffer_load_dwordx4 v11, s[40:43], s60 offen offset:3072  lds
    s_add_u32 m0, s64, s66
    s_add_u32 s61, s63, s74
    s_add_u32 s62, s63, s75
    buffer_load_dwordx4 v12, s[44:47], s61 offen offset:0  lds
    buffer_load_dwordx4 v13, s[44:47], s61 offen offset:1024  lds
    s_add_u32 m0, m0, 8192
    s_add_u32 s63, s62, 2048
    buffer_load_dwordx4 v12, s[44:47], s62 offen offset:0  lds
    buffer_load_dwordx4 v13, s[44:47], s62 offen offset:1024  lds
    s_add_u32 m0, m0, 8192
    s_add_u32 s67, s67, 1
    buffer_load_dwordx4 v12, s[44:47], s63 offen offset:0  lds
    buffer_load_dwordx4 v13, s[44:47], s63 offen offset:1024  lds
    s_and_b32 s67, s67, 15
    s_add_u32 s64, s64, 40960
    s_cmp_eq_u32 s64, 122880
    s_cselect_b32 s64, 0, s64
    s_waitcnt vmcnt(10)
    s_barrier
    s_add_u32 m0, s64, s65
    s_lshl_b32 s60, s67, 7
    s_mul_i32 s63, s67, 393216
    buffer_load_dwordx4 v8, s[40:43], s60 offen offset:0  lds
    buffer_load_dwordx4 v9, s[40:43], s60 offen offset:1024  lds
    buffer_load_dwordx4 v10, s[40:43], s60 offen offset:2048  lds
    buffer_load_dwordx4 v11, s[40:43], s60 offen offset:3072  lds
    s_add_u32 m0, s64, s66
    s_add_u32 s61, s63, s74
    s_add_u32 s62, s63, s75
    buffer_load_dwordx4 v12, s[44:47], s61 offen offset:0  lds
    buffer_load_dwordx4 v13, s[44:47], s61 offen offset:1024  lds
    s_add_u32 m0, m0, 8192
    s_add_u32 s63, s62, 2048
    buffer_load_dwordx4 v12, s[44:47], s62 offen offset:0  lds
    buffer_load_dwordx4 v13, s[44:47], s62 offen offset:1024  lds
    s_add_u32 m0, m0, 8192
    s_add_u32 s67, s67, 1
    buffer_load_dwordx4 v12, s[44:47], s63 offen offset:0  lds
    buffer_load_dwordx4 v13, s[44:47], s63 offen offset:1024  lds
    s_and_b32 s67, s67, 15
    s_add_u32 s64, s64, 40960
    s_cmp_eq_u32 s64, 122880
    s_cselect_b32 s64, 0, s64
    s_load_dword s5, s[52:53], 0x0
    s_load_dword s5, s[52:53], 0x80
    s_load_dword s5, s[52:53], 0x100
    s_load_dword s5, s[52:53], 0x180
    s_waitcnt vmcnt(10)
    s_barrier
    s_add_u32 m0, s64, s65
    s_lshl_b32 s60, s67, 7
    s_mul_i32 s63, s67, 393216
    buffer_load_dwordx4 v8, s[40:43], s60 offen offset:0  lds
    buffer_load_dwordx4 v9, s[40:43], s60 offen offset:1024  lds
    buffer_load_dwordx4 v10, s[40:43], s60 offen offset:2048  lds
    buffer_load_dwordx4 v11, s[40:43], s60 offen offset:3072  lds
    s_add_u32 m0, s64, s66
    s_add_u32 s61, s63, s74
    s_add_u32 s62, s63, s75
    buffer_load_dwordx4 v12, s[44:47], s61 offen offset:0  lds
    buffer_load_dwordx4 v13, s[44:47], s61 offen offset:1024  lds
    s_add_u32 m0, m0, 8192
    s_add_u32 s63, s62, 2048
    buffer_load_dwordx4 v12, s[44:47], s62 offen offset:0  lds
    buffer_load_dwordx4 v13, s[44:47], s62 offen offset:1024  lds
    s_add_u32 m0, m0, 8192
    s_add_u32 s67, s67, 1
    buffer_load_dwordx4 v12, s[44:47], s63 offen offset:0  lds
    buffer_load_dwordx4 v13, s[44:47], s63 offen offset:1024  lds
    s_and_b32 s67, s67, 15
    s_add_u32 s64, s64, 40960
    s_cmp_eq_u32 s64, 122880
    s_cselect_b32 s64, 0, s64
    s_load_dword s5, s[52:53], 0x200
    s_load_dword s5, s[52:53], 0x280
    s_load_dword s5, s[52:53], 0x300
    s_load_dword s5, s[52:53], 0x380
    s_waitcnt vmcnt(10)
    s_barrier
    s_add_u32 m0, s64, s65
    s_lshl_b32 s60, s67, 7
    s_mul_i32 s63, s67, 393216
    buffer_load_dwordx4 v8, s[40:43], s60 offen offset:0  lds
    buffer_load_dwordx4 v9, s[40:43], s60 offen offset:1024  lds
    buffer_load_dwordx4 v10, s[40:43], s60 offen offset:2048  lds
    buffer_load_dwordx4 v11, s[40:43], s60 offen offset:3072  lds
    s_add_u32 m0, s64, s66
    s_add_u32 s61, s63, s74
    s_add_u32 s62, s63, s75
    buffer_load_dwordx4 v12, s[44:47], s61 offen offset:0  lds
    buffer_load_dwordx4 v13, s[44:47], s61 offen offset:1024  lds
    s_add_u32 m0, m0, 8192
    s_add_u32 s63, s62, 2048
    buffer_load_dwordx4 v12, s[44:47], s62 offen offset:0  lds
    buffer_load_dwordx4 v13, s[44:47], s62 offen offset:1024  lds
    s_add_u32 m0, m0, 8192
    s_add_u32 s67, s67, 1
    buffer_load_dwordx4 v12, s[44:47], s63 offen offset:0  lds
    buffer_load_dwordx4 v13, s[44:47], s63 offen offset:1024  lds
    s_and_b32 s67, s67, 15
    s_add_u32 s64, s64, 40960
    s_cmp_eq_u32 s64, 122880
    s_cselect_b32 s64, 0, s64
    s_load_dword s5, s[52:53], 0x400
    s_load_dword s5, s[52:53], 0x480
    s_load_dword s5, s[52:53], 0x500
    s_load_dword s5, s[52:53], 0x580
    s_waitcnt vmcnt(10)
    s_barrier
    s_add_u32 m0, s64, s65
    s_lshl_b32 s60, s67, 7
    s_mul_i32 s63, s67, 393216
    buffer_load_dwordx4 v8, s[40:43], s60 offen offset:0  lds
    buffer_load_dwordx4 v9, s[40:43], s60 offen offset:1024  lds
    buffer_load_dwordx4 v10, s[40:43], s60 offen offset:2048  lds
    buffer_load_dwordx4 v11, s[40:43], s60 offen offset:3072  lds
    s_add_u32 m0, s64, s66
    s_add_u32 s61, s63, s74
    s_add_u32 s62, s63, s75
    buffer_load_dwordx4 v12, s[44:47], s61 offen offset:0  lds
    buffer_load_dwordx4 v13, s[44:47], s61 offen offset:1024  lds
    s_add_u32 m0, m0, 8192
    s_add_u32 s63, s62, 2048
    buffer_load_dwordx4 v12, s[44:47], s62 offen offset:0  lds
    buffer_load_dwordx4 v13, s[44:47], s62 offen offset:1024  lds
    s_add_u32 m0, m0, 8192
    s_add_u32 s67, s67, 1
    buffer_load_dwordx4 v12, s[44:47], s63 offen offset:0  lds
    buffer_load_dwordx4 v13, s[44:47], s63 offen offset:1024  lds
    s_and_b32 s67, s67, 15
    s_add_u32 s64, s64, 40960
    s_cmp_eq_u32 s64, 122880
    s_cselect_b32 s64, 0, s64
    s_load_dword s5, s[52:53], 0x600
    s_load_dword s5, s[52:53], 0x680
    s_load_dword s5, s[52:53], 0x700
    s_load_dword s5, s[52:53], 0x780
    s_waitcnt vmcnt(10)
    s_barrier
    s_add_u32 m0, s64, s65
    s_lshl_b32 s60, s67, 7
    s_mul_i32 s63, s67, 393216
    buffer_load_dwordx4 v8, s[40:43], s60 offen offset:0  lds
    buffer_load_dwordx4 v9, s[40:43], s60 offen offset:1024  lds
    buffer_load_dwordx4 v10, s[40:43], s60 offen offset:2048  lds
    buffer_load_dwordx4 v11, s[40:43], s60 offen offset:3072  lds
    s_add_u32 m0, s64, s66
    s_add_u32 s61, s63, s74
    s_add_u32 s62, s63, s75
    buffer_load_dwordx4 v12, s[44:47], s61 offen offset:0  lds
    buffer_load_dwordx4 v13, s[44:47], s61 offen offset:1024  lds
    s_add_u32 m0, m0, 8192
    s_add_u32 s63, s62, 2048
    buffer_load_dwordx4 v12, s[44:47], s62 offen offset:0  lds
    buffer_load_dwordx4 v13, s[44:47], s62 offen offset:1024  lds
    s_add_u32 m0, m0, 8192
    s_add_u32 s67, s67, 1
    buffer_load_dwordx4 v12, s[44:47], s63 offen offset:0  lds
    buffer_load_dwordx4 v13, s[44:47], s63 offen offset:1024  lds
    s_and_b32 s67, s67, 15
    s_add_u32 s64, s64, 40960
    s_cmp_eq_u32 s64, 122880
    s_cselect_b32 s64, 0, s64
    s_load_dword s5, s[52:53], 0x800
    s_load_dword s5, s[52:53], 0x880
    s_load_dword s5, s[52:53], 0x900
    s_load_dword s5, s[52:53], 0x980
    s_waitcnt vmcnt(10)
    s_barrier
    s_add_u32 m0, s64, s65
    s_lshl_b32 s60, s67, 7
    s_mul_i32 s63, s67, 393216
    buffer_load_dwordx4 v8, s[40:43], s60 offen offset:0  lds
    buffer_load_dwordx4 v9, s[40:43], s60 offen offset:1024  lds
    buffer_load_dwordx4 v10, s[40:43], s60 offen offset:2048  lds
    buffer_load_dwordx4 v11, s[40:43], s60 offen offset:3072  lds
    s_add_u32 m0, s64, s66
    s_add_u32 s61, s63, s74
    s_add_u32 s62, s63, s75
    buffer_load_dwordx4 v12, s[44:47], s61 offen offset:0  lds
    buffer_load_dwordx4 v13, s[44:47], s61 offen offset:1024  lds
    s_add_u32 m0, m0, 8192
    s_add_u32 s63, s62, 2048
    buffer_load_dwordx4 v12, s[44:47], s62 offen offset:0  lds
    buffer_load_dwordx4 v13, s[44:47], s62 offen offset:1024  lds
    s_add_u32 m0, m0, 8192
    s_add_u32 s67, s67, 1
    buffer_load_dwordx4 v12, s[44:47], s63 offen offset:0  lds
    buffer_load_dwordx4 v13, s[44:47], s63 offen offset:1024  lds
    s_and_b32 s67, s67, 15
    s_add_u32 s64, s64, 40960
    s_cmp_eq_u32 s64, 122880
    s_cselect_b32 s64, 0, s64
    s_load_dword s5, s[52:53], 0xa00
    s_load_dword s5, s[52:53], 0xa80
    s_load_dword s5, s[52:53], 0xb00
    s_load_dword s5, s[52:53], 0xb80
    s_waitcnt vmcnt(10)
    s_barrier
    s_add_u32 m0, s64, s65
    s_lshl_b32 s60, s67, 7
    s_mul_i32 s63, s67, 393216
    buffer_load_dwordx4 v8, s[40:43], s60 offen offset:0  lds
    buffer_load_dwordx4 v9, s[40:43], s60 offen offset:1024  lds
    buffer_load_dwordx4 v10, s[40:43], s60 offen offset:2048  lds
    buffer_load_dwordx4 v11, s[40:43], s60 offen offset:3072  lds
    s_add_u32 m0, s64, s66
    s_add_u32 s61, s63, s74
    s_add_u32 s62, s63, s75
    buffer_load_dwordx4 v12, s[44:47], s61 offen offset:0  lds
    buffer_load_dwordx4 v13, s[44:47], s61 offen offset:1024  lds
    s_add_u32 m0, m0, 8192
    s_add_u32 s63, s62, 2048
    buffer_load_dwordx4 v12, s[44:47], s62 offen offset:0  lds
    buffer_load_dwordx4 v13, s[44:47], s62 offen offset:1024  lds
    s_add_u32 m0, m0, 8192
    s_add_u32 s67, s67, 1
    buffer_load_dwordx4 v12, s[44:47], s63 offen offset:0  lds
    buffer_load_dwordx4 v13, s[44:47], s63 offen offset:1024  lds
    s_and_b32 s67, s67, 15
    s_add_u32 s64, s64, 40960
    s_cmp_eq_u32 s64, 122880
    s_cselect_b32 s64, 0, s64
    s_load_dword s5, s[52:53], 0xc00
    s_load_dword s5, s[52:53], 0xc80
    s_load_dword s5, s[52:53], 0xd00
    s_load_dword s5, s[52:53], 0xd80
    s_waitcnt vmcnt(10)
    s_barrier
    s_add_u32 m0, s64, s65
    s_lshl_b32 s60, s67, 7
    s_mul_i32 s63, s67, 393216
    buffer_load_dwordx4 v8, s[40:43], s60 offen offset:0  lds
    buffer_load_dwordx4 v9, s[40:43], s60 offen offset:1024  lds
    buffer_load_dwordx4 v10, s[40:43], s60 offen offset:2048  lds
    buffer_load_dwordx4 v11, s[40:43], s60 offen offset:3072  lds
    s_add_u32 m0, s64, s66
    s_add_u32 s61, s63, s74
    s_add_u32 s62, s63, s75
    buffer_load_dwordx4 v12, s[44:47], s61 offen offset:0  lds
    buffer_load_dwordx4 v13, s[44:47], s61 offen offset:1024  lds
    s_add_u32 m0, m0, 8192
    s_add_u32 s63, s62, 2048
    buffer_load_dwordx4 v12, s[44:47], s62 offen offset:0  lds
    buffer_load_dwordx4 v13, s[44:47], s62 offen offset:1024  lds
    s_add_u32 m0, m0, 8192
    s_add_u32 s67, s67, 1
    buffer_load_dwordx4 v12, s[44:47], s63 offen offset:0  lds
    buffer_load_dwordx4 v13, s[44:47], s63 offen offset:1024  lds
    s_and_b32 s67, s67, 15
    s_add_u32 s64, s64, 40960
    s_cmp_eq_u32 s64, 122880
    s_cselect_b32 s64, 0, s64
    s_load_dword s5, s[52:53], 0xe00
    s_load_dword s5, s[52:53], 0xe80
    s_load_dword s5, s[52:53], 0xf00
    s_load_dword s5, s[52:53], 0xf80
    s_waitcnt vmcnt(10)
    s_barrier
    s_add_u32 m0, s64, s65
    s_lshl_b32 s60, s67, 7
    s_mul_i32 s63, s67, 393216
    buffer_load_dwordx4 v8, s[40:43], s60 offen offset:0  lds
    buffer_load_dwordx4 v9, s[40:43], s60 offen offset:1024  lds
    buffer_load_dwordx4 v10, s[40:43], s60 offen offset:2048  lds
    buffer_load_dwordx4 v11, s[40:43], s60 offen offset:3072  lds
    s_add_u32 m0, s64, s66
    s_add_u32 s61, s63, s74
    s_add_u32 s62, s63, s75
    buffer_load_dwordx4 v12, s[44:47], s61 offen offset:0  lds
    buffer_load_dwordx4 v13, s[44:47], s61 offen offset:1024  lds
    s_add_u32 m0, m0, 8192
    s_add_u32 s63, s62, 2048
    buffer_load_dwordx4 v12, s[44:47], s62 offen offset:0  lds
    buffer_load_dwordx4 v13, s[44:47], s62 offen offset:1024  lds
    s_add_u32 m0, m0, 8192
    s_add_u32 s67, s67, 1
    buffer_load_dwordx4 v12, s[44:47], s63 offen offset:0  lds
    buffer_load_dwordx4 v13, s[44:47], s63 offen offset:1024  lds
    s_and_b32 s67, s67, 15
    s_add_u32 s64, s64, 40960
    s_cmp_eq_u32 s64, 122880
    s_cselect_b32 s64, 0, s64
    s_waitcnt lgkmcnt(0)
    s_load_dwordx16 s[4:19], s[26:27], s33 glc
    s_mov_b32 s40, s20
    s_mov_b32 s41, s21
    s_mov_b32 s42, 0x400000
    s_mov_b32 s43, 0x20000
    s_mov_b32 s44, s22
    s_mov_b32 s45, s23
    s_mov_b32 s46, 0x800000
    s_mov_b32 s47, 0x20000
    s_and_b32 s28, s34, 3
    s_lshl_b32 s74, s28, 2
    s_lshl_b32 s28, s28, 3
    s_add_u32 s65, s3, 5
    s_add_u32 s75, s3, 9
    s_cmp_eq_u32 s3, 3
    s_cselect_b32 s75, 4, s75
    s_add_u32 s31, s3, 12
    s_waitcnt vmcnt(10)
    s_barrier
    s_waitcnt lgkmcnt(0)
    s_cmp_eq_u64 s[4:5], s[72:73]
    s_cbranch_scc0 L_us
    s_cmp_eq_u64 s[6:7], s[72:73]
    s_cbranch_scc0 L_us
    s_cmp_eq_u64 s[8:9], s[72:73]
    s_cbranch_scc0 L_us
    s_cmp_eq_u64 s[10:11], s[72:73]
    s_cbranch_scc0 L_us
    s_cmp_eq_u64 s[12:13], s[72:73]
    s_cbranch_scc0 L_us
    s_cmp_eq_u64 s[14:15], s[72:73]
    s_cbranch_scc0 L_us
    s_cmp_eq_u64 s[16:17], s[72:73]
    s_cbranch_scc0 L_us
    s_cmp_eq_u64 s[18:19], s[72:73]
    s_cbranch_scc0 L_us
    s_branch L_upoll_done
L_us:
    s_mov_b32 s60, 0
    s_branch L_upoll_go
L_upoll:
    s_sleep 0
L_upoll_go:
    s_load_dwordx16 s[4:19], s[26:27], s33 glc
    s_add_u32 s60, s60, 1
    s_cmp_gt_u32 s60, 0x8000
    s_cbranch_scc1 L_upoll_done
    s_waitcnt lgkmcnt(0)
    s_cmp_eq_u64 s[4:5], s[72:73]
    s_cbranch_scc0 L_upoll
    s_cmp_eq_u64 s[6:7], s[72:73]
    s_cbranch_scc0 L_upoll
    s_cmp_eq_u64 s[8:9], s[72:73]
    s_cbranch_scc0 L_upoll
    s_cmp_eq_u64 s[10:11], s[72:73]
    s_cbranch_scc0 L_upoll
    s_cmp_eq_u64 s[12:13], s[72:73]
    s_cbranch_scc0 L_upoll
    s_cmp_eq_u64 s[14:15], s[72:73]
    s_cbranch_scc0 L_upoll
    s_cmp_eq_u64 s[16:17], s[72:73]
    s_cbranch_scc0 L_upoll
    s_cmp_eq_u64 s[18:19], s[72:73]
    s_cbranch_scc0 L_upoll
L_upoll_done:
    s_waitcnt lgkmcnt(0)
    buffer_load_dwordx4 v[32:35], v5, s[48:51], s39 offen offset:0 sc1
    buffer_load_dwordx4 v[36:39], v5, s[48:51], s39 offen offset:1024 sc1
    buffer_load_dwordx4 v[40:43], v5, s[48:51], s39 offen offset:2048 sc1
    buffer_load_dwordx4 v[44:47], v5, s[48:51], s39 offen offset:3072 sc1
    s_add_u32 m0, s68, 256
    s_nop 0
    buffer_load_dwordx4 v26, s[52:55], 0 offen  lds
    s_add_u32 m0, s68, 256
    s_movk_i32 s60, 1024
    s_nop 0
    buffer_load_dwordx4 v26, s[52:55], s60 offen offset:1024  lds
    s_add_u32 m0, s68, 2560
    s_nop 0
    buffer_load_dwordx4 v26, s[52:55], 16 offen  lds
    s_add_u32 m0, s68, 2560
    s_movk_i32 s60, 1040
    s_nop 0
    buffer_load_dwordx4 v26, s[52:55], s60 offen offset:1024  lds
    s_waitcnt vmcnt(8)
    s_barrier
    ds_write_b128 v24, v[160:163] offset:4096
    s_lshl_b32 m0, s65, 13
    s_add_u32 s60, s65, s74
    s_and_b32 s60, s60, 15
    s_lshl_b32 s60, s60, 17
    s_add_u32 s61, s60, 0x10000
    buffer_load_dwordx4 v20, s[56:59], s60 offen offset:0  lds
    buffer_load_dwordx4 v21, s[56:59], s60 offen offset:1024  lds
    buffer_load_dwordx4 v22, s[56:59], s60 offen offset:2048  lds
    buffer_load_dwordx4 v23, s[56:59], s60 offen offset:3072  lds
    s_add_u32 m0, m0, 4096
    s_nop 0
    buffer_load_dwordx4 v20, s[56:59], s61 offen offset:0  lds
    buffer_load_dwordx4 v21, s[56:59], s61 offen offset:1024  lds
    buffer_load_dwordx4 v22, s[56:59], s61 offen offset:2048  lds
    buffer_load_dwordx4 v23, s[56:59], s61 offen offset:3072  lds
    s_waitcnt vmcnt(12)
    v_mov_b32_dpp v48, v36 wave_rol:1 row_mask:0xf bank_mask:0xf
    v_mov_b32_dpp v49, v40 wave_rol:1 row_mask:0xf bank_mask:0xf
    v_mov_b32_dpp v50, v44 wave_rol:1 row_mask:0xf bank_mask:0xf
    v_mov_b32 v51, 0
    s_nop 0
    v_mov_b32_dpp v48, v32 wave_shl:1 row_mask:0xf bank_mask:0xf
    v_mov_b32_dpp v49, v36 wave_shl:1 row_mask:0xf bank_mask:0xf
    v_mov_b32_dpp v50, v40 wave_shl:1 row_mask:0xf bank_mask:0xf
    v_mov_b32_dpp v51, v44 wave_shl:1 row_mask:0xf bank_mask:0xf
    ds_write_b128 v19, v[32:35] offset:0
    v_alignbit_b32 v52, v33, v32, 16
    v_alignbit_b32 v53, v34, v33, 16
    v_alignbit_b32 v54, v35, v34, 16
    v_alignbit_b32 v55, v48, v35, 16
    ds_write_b128 v19, v[52:55] offset:4160
    ds_write_b128 v19, v[36:39] offset:1024
    v_alignbit_b32 v56, v37, v36, 16
    v_alignbit_b32 v57, v38, v37, 16
    v_alignbit_b32 v58, v39, v38, 16
    v_alignbit_b32 v59, v49, v39, 16
    ds_write_b128 v19, v[56:59] offset:5184
    ds_write_b128 v19, v[40:43] offset:2048
    v_alignbit_b32 v60, v41, v40, 16
    v_alignbit_b32 v61, v42, v41, 16
    v_alignbit_b32 v62, v43, v42, 16
    v_alignbit_b32 v63, v50, v43, 16
    ds_write_b128 v19, v[60:63] offset:6208
    ds_write_b128 v19, v[44:47] offset:3072
    v_alignbit_b32 v64, v45, v44, 16
    v_alignbit_b32 v65, v46, v45, 16
    v_alignbit_b32 v66, v47, v46, 16
    v_alignbit_b32 v67, v51, v47, 16
    ds_write_b128 v19, v[64:67] offset:7232
    s_mov_b32 s60, 0
L_fr:
    ds_read_b128 v[68:71], v15 offset:112
    s_add_u32 s60, s60, 1
    s_waitcnt lgkmcnt(0)
    v_and_b32 v68, v68, v69
    v_and_b32 v70, v70, v71
    v_and_b32 v68, v68, v70
    s_cmp_gt_u32 s60, 0x40000
    s_cbranch_scc1 L_fr_d
    v_readfirstlane_b32 s61, v68
    s_nop 3
    s_cmp_eq_u32 s61, 1
    s_cbranch_scc1 L_fr_d
    s_sleep 1
    s_branch L_fr
L_fr_d:
    s_lshl_b32 m0, s75, 13
    s_add_u32 s60, s75, s74
    s_and_b32 s60, s60, 15
    s_lshl_b32 s60, s60, 17
    s_add_u32 s61, s60, 0x10000
    buffer_load_dwordx4 v20, s[56:59], s60 offen offset:0  lds
    buffer_load_dwordx4 v21, s[56:59], s60 offen offset:1024  lds
    buffer_load_dwordx4 v22, s[56:59], s60 offen offset:2048  lds
    buffer_load_dwordx4 v23, s[56:59], s60 offen offset:3072  lds
    s_add_u32 m0, m0, 4096
    s_nop 0
    buffer_load_dwordx4 v20, s[56:59], s61 offen offset:0  lds
    buffer_load_dwordx4 v21, s[56:59], s61 offen offset:1024  lds
    buffer_load_dwordx4 v22, s[56:59], s61 offen offset:2048  lds
    buffer_load_dwordx4 v23, s[56:59], s61 offen offset:3072  lds
    s_lshl_b32 m0, s3, 13
    s_add_u32 s60, s3, s74
    s_and_b32 s60, s60, 15
    s_lshl_b32 s60, s60, 17
    s_add_u32 s61, s60, 0x10000
    buffer_load_dwordx4 v20, s[56:59], s60 offen offset:0  lds
    buffer_load_dwordx4 v21, s[56:59], s60 offen offset:1024  lds
    buffer_load_dwordx4 v22, s[56:59], s60 offen offset:2048  lds
    buffer_load_dwordx4 v23, s[56:59], s60 offen offset:3072  lds
    s_add_u32 m0, m0, 4096
    s_nop 0
    buffer_load_dwordx4 v20, s[56:59], s61 offen offset:0  lds
    buffer_load_dwordx4 v21, s[56:59], s61 offen offset:1024  lds
    buffer_load_dwordx4 v22, s[56:59], s61 offen offset:2048  lds
    buffer_load_dwordx4 v23, s[56:59], s61 offen offset:3072  lds
    s_lshl_b32 s30, s69, 11
    s_lshl_b32 s61, s36, 7
    s_add_u32 s30, s30, s61
    s_lshl_b32 s63, s69, 12
    s_add_u32 s63, s63, s61
    s_add_u32 s63, s63, 2048
    s_lshl_b32 s66, s34, 8
    s_lshl_b32 s61, s3, 6
    s_add_u32 s66, s66, s61
    s_lshr_b32 vcc_lo, s66, 6
    s_mul_i32 vcc_lo, vcc_lo, 1984
    s_add_u32 s66, s66, vcc_lo
    s_add_u32 s66, s66, 0x980000
    s_lshl_b32 vcc_lo, s35, 7
    s_add_u32 s66, s66, vcc_lo
    s_bitcmp1_b32 s3, 0
    s_cselect_b32 s60, 0, 16
    s_cselect_b32 s33, 16, 0
    s_lshl_b32 s71, s71, s60
    s_and_b32 s71, s71, 0xffff0000
    s_lshr_b32 s60, s3, 1
    v_lshl_add_u32 v19, s60, 2, v15
    s_mov_b32 s32, s38
    s_lshr_b32 vcc_lo, s32, 6
    s_mul_i32 vcc_lo, vcc_lo, 8128
    s_add_u32 s32, s32, vcc_lo
    s_add_u32 s32, s32, 0x9a0000
    s_lshl_b32 s67, s36, 6
    s_lshl_b32 s60, s37, 2
    s_add_u32 s60, s60, s3
    s_lshr_b32 vcc_lo, s67, 6
    s_mul_i32 vcc_lo, vcc_lo, 8128
    s_add_u32 s67, s67, vcc_lo
    s_add_u32 s67, s67, 0x9a0000
    s_lshl_b32 vcc_lo, s60, 7
    s_add_u32 s67, s67, vcc_lo
    s_mov_b32 s64, 0
    s_waitcnt vmcnt(24)
    ds_read2_b32 v[32:33], v240 offset0:132 offset1:133
    ds_read2_b32 v[34:35], v240 offset0:134 offset1:135
    ds_read_b128 v[64:67], v244 offset:2304
    ds_read2_b32 v[36:37], v240 offset0:4 offset1:5
    ds_read2_b32 v[38:39], v240 offset0:6 offset1:7
    ds_read_b128 v[68:71], v244 offset:2560
    ds_read2_b32 v[40:41], v241 offset0:132 offset1:133
    ds_read2_b32 v[42:43], v241 offset0:134 offset1:135
    ds_read_b128 v[72:75], v244 offset:2816
    ds_read2_b32 v[44:45], v241 offset0:4 offset1:5
    ds_read2_b32 v[46:47], v241 offset0:6 offset1:7
    ds_read_b128 v[76:79], v244 offset:3072
    ds_read2_b32 v[48:49], v242 offset0:132 offset1:133
    ds_read2_b32 v[50:51], v242 offset0:134 offset1:135
    ds_read_b128 v[80:83], v244 offset:3328
    ds_read2_b32 v[52:53], v242 offset0:4 offset1:5
    ds_read2_b32 v[54:55], v242 offset0:6 offset1:7
    ds_read_b128 v[84:87], v244 offset:3584
    ds_read2_b32 v[56:57], v243 offset0:132 offset1:133
    ds_read2_b32 v[58:59], v243 offset0:134 offset1:135
    ds_read_b128 v[88:91], v244 offset:3840
    ds_read2_b32 v[60:61], v243 offset0:4 offset1:5
    ds_read2_b32 v[62:63], v243 offset0:6 offset1:7
    ds_read_b128 v[92:95], v244 offset:4096
    s_mov_b32 s60, 0
L_kd:
    ds_read_b128 v[96:99], v15 offset:128
    s_add_u32 s60, s60, 1
    s_waitcnt lgkmcnt(0)
    v_and_b32 v96, v96, v97
    v_and_b32 v98, v98, v99
    v_and_b32 v96, v96, v98
    s_cmp_gt_u32 s60, 0x40000
    s_cbranch_scc1 L_kd_d
    v_readfirstlane_b32 s61, v96
    s_nop 3
    s_cmp_eq_u32 s61, 1
    s_cbranch_scc1 L_kd_d
    s_sleep 1
    s_branch L_kd
L_kd_d:
    s_setprio 0
    s_waitcnt lgkmcnt(0)
    v_mfma_f32_16x16x32_bf16 v[188:191], v[32:35], v[92:95], v[188:191]
    ds_read2_b32 v[96:97], v240 offset0:128 offset1:129
    v_mfma_f32_16x16x32_bf16 v[188:191], v[36:39], v[88:91], v[188:191]
    ds_read2_b32 v[98:99], v240 offset0:130 offset1:131
    v_mfma_f32_16x16x32_bf16 v[188:191], v[40:43], v[84:87], v[188:191]
    ds_read_b128 v[128:131], v244 offset:0
    v_mfma_f32_16x16x32_bf16 v[188:191], v[44:47], v[80:83], v[188:191]
    ds_read2_b32 v[100:101], v240 offset0:0 offset1:1
    v_mfma_f32_16x16x32_bf16 v[188:191], v[48:51], v[76:79], v[188:191]
    ds_read2_b32 v[102:103], v240 offset0:2 offset1:3
    v_mfma_f32_16x16x32_bf16 v[188:191], v[52:55], v[72:75], v[188:191]
    ds_read_b128 v[132:135], v244 offset:256
    v_mfma_f32_16x16x32_bf16 v[188:191], v[56:59], v[68:71], v[188:191]
    ds_read2_b32 v[104:105], v241 offset0:128 offset1:129
    v_mfma_f32_16x16x32_bf16 v[188:191], v[60:63], v[64:67], v[188:191]
    ds_read2_b32 v[106:107], v241 offset0:130 offset1:131
    v_mfma_f32_16x16x32_bf16 v[184:187], v[32:35], v[88:91], v[184:187]
    ds_read_b128 v[136:139], v244 offset:512
    v_mfma_f32_16x16x32_bf16 v[184:187], v[36:39], v[84:87], v[184:187]
    ds_read2_b32 v[108:109], v241 offset0:0 offset1:1
    v_mfma_f32_16x16x32_bf16 v[184:187], v[40:43], v[80:83], v[184:187]
    ds_read2_b32 v[110:111], v241 offset0:2 offset1:3
    v_mfma_f32_16x16x32_bf16 v[184:187], v[44:47], v[76:79], v[184:187]
    ds_read_b128 v[140:143], v244 offset:768
    v_mfma_f32_16x16x32_bf16 v[184:187], v[48:51], v[72:75], v[184:187]
    ds_read2_b32 v[112:113], v242 offset0:128 offset1:129
    v_mfma_f32_16x16x32_bf16 v[184:187], v[52:55], v[68:71], v[184:187]
    ds_read2_b32 v[114:115], v242 offset0:130 offset1:131
    v_mfma_f32_16x16x32_bf16 v[184:187], v[56:59], v[64:67], v[184:187]
    ds_read_b128 v[144:147], v244 offset:1024
    v_mfma_f32_16x16x32_bf16 v[180:183], v[32:35], v[84:87], v[180:183]
    ds_read2_b32 v[116:117], v242 offset0:0 offset1:1
    v_mfma_f32_16x16x32_bf16 v[180:183], v[36:39], v[80:83], v[180:183]
    ds_read2_b32 v[118:119], v242 offset0:2 offset1:3
    v_mfma_f32_16x16x32_bf16 v[180:183], v[40:43], v[76:79], v[180:183]
    ds_read_b128 v[148:151], v244 offset:1280
    v_mfma_f32_16x16x32_bf16 v[180:183], v[44:47], v[72:75], v[180:183]
    ds_read2_b32 v[120:121], v243 offset0:128 offset1:129
    v_mfma_f32_16x16x32_bf16 v[180:183], v[48:51], v[68:71], v[180:183]
    ds_read2_b32 v[122:123], v243 offset0:130 offset1:131
    v_mfma_f32_16x16x32_bf16 v[180:183], v[52:55], v[64:67], v[180:183]
    ds_read_b128 v[152:155], v244 offset:1536
    v_mfma_f32_16x16x32_bf16 v[176:179], v[32:35], v[80:83], v[176:179]
    ds_read2_b32 v[124:125], v243 offset0:0 offset1:1
    v_mfma_f32_16x16x32_bf16 v[176:179], v[36:39], v[76:79], v[176:179]
    ds_read2_b32 v[126:127], v243 offset0:2 offset1:3
    v_mfma_f32_16x16x32_bf16 v[176:179], v[40:43], v[72:75], v[176:179]
    ds_read_b128 v[156:159], v244 offset:1792
    v_mfma_f32_16x16x32_bf16 v[176:179], v[44:47], v[68:71], v[176:179]
    v_subrev_u32 v240, 128, v240
    v_mfma_f32_16x16x32_bf16 v[176:179], v[48:51], v[64:67], v[176:179]
    v_subrev_u32 v241, 128, v241
    v_mfma_f32_16x16x32_bf16 v[172:175], v[32:35], v[76:79], v[172:175]
    v_subrev_u32 v242, 128, v242
    v_mfma_f32_16x16x32_bf16 v[172:175], v[36:39], v[72:75], v[172:175]
    v_subrev_u32 v243, 128, v243
    v_mfma_f32_16x16x32_bf16 v[172:175], v[40:43], v[68:71], v[172:175]
    v_subrev_u32 v244, 64, v244
    v_mfma_f32_16x16x32_bf16 v[172:175], v[44:47], v[64:67], v[172:175]
    v_mfma_f32_16x16x32_bf16 v[168:171], v[32:35], v[72:75], v[168:171]
    v_mfma_f32_16x16x32_bf16 v[168:171], v[36:39], v[68:71], v[168:171]
    v_mfma_f32_16x16x32_bf16 v[168:171], v[40:43], v[64:67], v[168:171]
    v_mfma_f32_16x16x32_bf16 v[164:167], v[32:35], v[68:71], v[164:167]
    v_mfma_f32_16x16x32_bf16 v[164:167], v[36:39], v[64:67], v[164:167]
    v_mfma_f32_16x16x32_bf16 v[160:163], v[32:35], v[64:67], v[160:163]
    s_waitcnt lgkmcnt(0)
    s_waitcnt vmcnt(0)
    v_mfma_f32_16x16x32_bf16 v[188:191], v[96:99], v[156:159], v[188:191]
    ds_read2_b32 v[32:33], v240 offset0:132 offset1:133
    s_mov_b32 s61, 0
    v_mfma_f32_16x16x32_bf16 v[188:191], v[100:103], v[152:155], v[188:191]
    ds_read2_b32 v[34:35], v240 offset0:134 offset1:135
    s_lshl_b32 s60, s3, 1
    v_mfma_f32_16x16x32_bf16 v[188:191], v[104:107], v[148:151], v[188:191]
    ds_read_b128 v[64:67], v244 offset:2304
    s_bitset1_b32 s61, s60
    v_mfma_f32_16x16x32_bf16 v[188:191], v[108:111], v[144:147], v[188:191]
    ds_read2_b32 v[36:37], v240 offset0:4 offset1:5
    s_lshl_b32 s60, s75, 1
    v_mfma_f32_16x16x32_bf16 v[188:191], v[112:115], v[140:143], v[188:191]
    ds_read2_b32 v[38:39], v240 offset0:6 offset1:7
    s_bitset1_b32 s61, s60
    v_mfma_f32_16x16x32_bf16 v[188:191], v[116:119], v[136:139], v[188:191]
    ds_read_b128 v[68:71], v244 offset:2560
    s_lshl_b32 s60, s65, 1
    v_mfma_f32_16x16x32_bf16 v[188:191], v[120:123], v[132:135], v[188:191]
    ds_read2_b32 v[40:41], v241 offset0:132 offset1:133
    s_bitset1_b32 s61, s60
    v_mfma_f32_16x16x32_bf16 v[188:191], v[124:127], v[128:131], v[188:191]
    ds_read2_b32 v[42:43], v241 offset0:134 offset1:135
    v_mov_b32 v3, s61
    v_mfma_f32_16x16x32_bf16 v[184:187], v[96:99], v[152:155], v[184:187]
    ds_read_b128 v[72:75], v244 offset:2816
    s_mov_b64 exec, 1
    ds_or_b32 v15, v3 offset:60
    s_mov_b64 exec, -1
    v_mfma_f32_16x16x32_bf16 v[184:187], v[100:103], v[148:151], v[184:187]
    ds_read2_b32 v[44:45], v241 offset0:4 offset1:5
    s_add_u32 s60, s31, s74
    v_mfma_f32_16x16x32_bf16 v[184:187], v[104:107], v[144:147], v[184:187]
    ds_read2_b32 v[46:47], v241 offset0:6 offset1:7
    s_and_b32 s60, s60, 15
    v_mfma_f32_16x16x32_bf16 v[184:187], v[108:111], v[140:143], v[184:187]
    ds_read_b128 v[76:79], v244 offset:3072
    s_lshl_b32 s60, s60, 17
    v_mfma_f32_16x16x32_bf16 v[184:187], v[112:115], v[136:139], v[184:187]
    ds_read2_b32 v[48:49], v242 offset0:132 offset1:133
    s_add_u32 s61, s60, 0x10000
    v_mfma_f32_16x16x32_bf16 v[184:187], v[116:119], v[132:135], v[184:187]
    ds_read2_b32 v[50:51], v242 offset0:134 offset1:135
    buffer_load_dwordx4 v[192:195], v20, s[56:59], s60 offen offset:0
    v_mfma_f32_16x16x32_bf16 v[184:187], v[120:123], v[128:131], v[184:187]
    ds_read_b128 v[80:83], v244 offset:3328
    buffer_load_dwordx4 v[196:199], v21, s[56:59], s60 offen offset:1024
    v_mfma_f32_16x16x32_bf16 v[180:183], v[96:99], v[148:151], v[180:183]
    ds_read2_b32 v[52:53], v242 offset0:4 offset1:5
    buffer_load_dwordx4 v[200:203], v22, s[56:59], s60 offen offset:2048
    v_mfma_f32_16x16x32_bf16 v[180:183], v[100:103], v[144:147], v[180:183]
    ds_read2_b32 v[54:55], v242 offset0:6 offset1:7
    buffer_load_dwordx4 v[204:207], v23, s[56:59], s60 offen offset:3072
    v_mfma_f32_16x16x32_bf16 v[180:183], v[104:107], v[140:143], v[180:183]
    ds_read_b128 v[84:87], v244 offset:3584
    buffer_load_dwordx4 v[208:211], v20, s[56:59], s61 offen offset:0
    v_mfma_f32_16x16x32_bf16 v[180:183], v[108:111], v[136:139], v[180:183]
    ds_read2_b32 v[56:57], v243 offset0:132 offset1:133
    buffer_load_dwordx4 v[212:215], v21, s[56:59], s61 offen offset:1024
    v_mfma_f32_16x16x32_bf16 v[180:183], v[112:115], v[132:135], v[180:183]
    ds_read2_b32 v[58:59], v243 offset0:134 offset1:135
    buffer_load_dwordx4 v[216:219], v22, s[56:59], s61 offen offset:2048
    v_mfma_f32_16x16x32_bf16 v[180:183], v[116:119], v[128:131], v[180:183]
    ds_read_b128 v[88:91], v244 offset:3840
    buffer_load_dwordx4 v[220:223], v23, s[56:59], s61 offen offset:3072
    v_mfma_f32_16x16x32_bf16 v[176:179], v[96:99], v[144:147], v[176:179]
    ds_read2_b32 v[60:61], v243 offset0:4 offset1:5
    buffer_load_dwordx4 v[224:227], v16, s[40:43], s30 offen
    v_mfma_f32_16x16x32_bf16 v[176:179], v[100:103], v[140:143], v[176:179]
    ds_read2_b32 v[62:63], v243 offset0:6 offset1:7
    s_add_u32 s30, s30, 0x4000
    v_mfma_f32_16x16x32_bf16 v[176:179], v[104:107], v[136:139], v[176:179]
    ds_read_b128 v[92:95], v244 offset:4096
    buffer_load_dwordx4 v[228:231], v16, s[40:43], s30 offen
    v_mfma_f32_16x16x32_bf16 v[176:179], v[108:111], v[132:135], v[176:179]
    s_add_u32 s30, s30, 0x4000
    v_mfma_f32_16x16x32_bf16 v[176:179], v[112:115], v[128:131], v[176:179]
    buffer_load_dwordx4 v[232:235], v16, s[40:43], s30 offen
    v_mfma_f32_16x16x32_bf16 v[172:175], v[96:99], v[140:143], v[172:175]
    s_add_u32 s30, s30, 0x4000
    v_mfma_f32_16x16x32_bf16 v[172:175], v[100:103], v[136:139], v[172:175]
    buffer_load_dwordx4 v[236:239], v16, s[40:43], s30 offen
    v_mfma_f32_16x16x32_bf16 v[172:175], v[104:107], v[132:135], v[172:175]
    v_mfma_f32_16x16x32_bf16 v[172:175], v[108:111], v[128:131], v[172:175]
    v_mfma_f32_16x16x32_bf16 v[168:171], v[96:99], v[136:139], v[168:171]
    v_mfma_f32_16x16x32_bf16 v[168:171], v[100:103], v[132:135], v[168:171]
    v_mfma_f32_16x16x32_bf16 v[168:171], v[104:107], v[128:131], v[168:171]
    v_mfma_f32_16x16x32_bf16 v[164:167], v[96:99], v[132:135], v[164:167]
    v_mfma_f32_16x16x32_bf16 v[164:167], v[100:103], v[128:131], v[164:167]
    v_mfma_f32_16x16x32_bf16 v[160:163], v[96:99], v[128:131], v[160:163]
    s_waitcnt lgkmcnt(0)
    v_mfma_f32_16x16x32_bf16 v[188:191], v[32:35], v[92:95], v[188:191]
    ds_read2_b32 v[96:97], v240 offset0:128 offset1:129
    v_mfma_f32_16x16x32_bf16 v[188:191], v[36:39], v[88:91], v[188:191]
    ds_read2_b32 v[98:99], v240 offset0:130 offset1:131
    v_mfma_f32_16x16x32_bf16 v[188:191], v[40:43], v[84:87], v[188:191]
    ds_read_b128 v[128:131], v244 offset:0
    v_mfma_f32_16x16x32_bf16 v[188:191], v[44:47], v[80:83], v[188:191]
    ds_read2_b32 v[100:101], v240 offset0:0 offset1:1
    v_mfma_f32_16x16x32_bf16 v[188:191], v[48:51], v[76:79], v[188:191]
    ds_read2_b32 v[102:103], v240 offset0:2 offset1:3
    v_mfma_f32_16x16x32_bf16 v[188:191], v[52:55], v[72:75], v[188:191]
    ds_read_b128 v[132:135], v244 offset:256
    v_mfma_f32_16x16x32_bf16 v[188:191], v[56:59], v[68:71], v[188:191]
    ds_read2_b32 v[104:105], v241 offset0:128 offset1:129
    v_mfma_f32_16x16x32_bf16 v[188:191], v[60:63], v[64:67], v[188:191]
    ds_read2_b32 v[106:107], v241 offset0:130 offset1:131
    v_mfma_f32_16x16x32_bf16 v[184:187], v[32:35], v[88:91], v[184:187]
    ds_read_b128 v[136:139], v244 offset:512
    v_mfma_f32_16x16x32_bf16 v[184:187], v[36:39], v[84:87], v[184:187]
    ds_read2_b32 v[108:109], v241 offset0:0 offset1:1
    v_mfma_f32_16x16x32_bf16 v[184:187], v[40:43], v[80:83], v[184:187]
    ds_read2_b32 v[110:111], v241 offset0:2 offset1:3
    v_mfma_f32_16x16x32_bf16 v[184:187], v[44:47], v[76:79], v[184:187]
    ds_read_b128 v[140:143], v244 offset:768
    v_mfma_f32_16x16x32_bf16 v[184:187], v[48:51], v[72:75], v[184:187]
    ds_read2_b32 v[112:113], v242 offset0:128 offset1:129
    v_mfma_f32_16x16x32_bf16 v[184:187], v[52:55], v[68:71], v[184:187]
    ds_read2_b32 v[114:115], v242 offset0:130 offset1:131
    v_mfma_f32_16x16x32_bf16 v[184:187], v[56:59], v[64:67], v[184:187]
    ds_read_b128 v[144:147], v244 offset:1024
    v_mfma_f32_16x16x32_bf16 v[180:183], v[32:35], v[84:87], v[180:183]
    ds_read2_b32 v[116:117], v242 offset0:0 offset1:1
    v_mfma_f32_16x16x32_bf16 v[180:183], v[36:39], v[80:83], v[180:183]
    ds_read2_b32 v[118:119], v242 offset0:2 offset1:3
    v_mfma_f32_16x16x32_bf16 v[180:183], v[40:43], v[76:79], v[180:183]
    ds_read_b128 v[148:151], v244 offset:1280
    v_mfma_f32_16x16x32_bf16 v[180:183], v[44:47], v[72:75], v[180:183]
    ds_read2_b32 v[120:121], v243 offset0:128 offset1:129
    v_mfma_f32_16x16x32_bf16 v[180:183], v[48:51], v[68:71], v[180:183]
    ds_read2_b32 v[122:123], v243 offset0:130 offset1:131
    v_mfma_f32_16x16x32_bf16 v[180:183], v[52:55], v[64:67], v[180:183]
    ds_read_b128 v[152:155], v244 offset:1536
    v_mfma_f32_16x16x32_bf16 v[176:179], v[32:35], v[80:83], v[176:179]
    ds_read2_b32 v[124:125], v243 offset0:0 offset1:1
    v_mfma_f32_16x16x32_bf16 v[176:179], v[36:39], v[76:79], v[176:179]
    ds_read2_b32 v[126:127], v243 offset0:2 offset1:3
    v_mfma_f32_16x16x32_bf16 v[176:179], v[40:43], v[72:75], v[176:179]
    ds_read_b128 v[156:159], v244 offset:1792
    v_mfma_f32_16x16x32_bf16 v[176:179], v[44:47], v[68:71], v[176:179]
    v_subrev_u32 v240, 128, v240
    v_mfma_f32_16x16x32_bf16 v[176:179], v[48:51], v[64:67], v[176:179]
    v_subrev_u32 v241, 128, v241
    v_mfma_f32_16x16x32_bf16 v[172:175], v[32:35], v[76:79], v[172:175]
    v_subrev_u32 v242, 128, v242
    v_mfma_f32_16x16x32_bf16 v[172:175], v[36:39], v[72:75], v[172:175]
    v_subrev_u32 v243, 128, v243
    v_mfma_f32_16x16x32_bf16 v[172:175], v[40:43], v[68:71], v[172:175]
    v_subrev_u32 v244, 64, v244
    v_mfma_f32_16x16x32_bf16 v[172:175], v[44:47], v[64:67], v[172:175]
    v_mfma_f32_16x16x32_bf16 v[168:171], v[32:35], v[72:75], v[168:171]
    v_mfma_f32_16x16x32_bf16 v[168:171], v[36:39], v[68:71], v[168:171]
    v_mfma_f32_16x16x32_bf16 v[168:171], v[40:43], v[64:67], v[168:171]
    v_mfma_f32_16x16x32_bf16 v[164:167], v[32:35], v[68:71], v[164:167]
    v_mfma_f32_16x16x32_bf16 v[164:167], v[36:39], v[64:67], v[164:167]
    v_mfma_f32_16x16x32_bf16 v[160:163], v[32:35], v[64:67], v[160:163]
    s_waitcnt lgkmcnt(0)
    v_mfma_f32_16x16x32_bf16 v[188:191], v[96:99], v[156:159], v[188:191]
    ds_read2_b32 v[32:33], v240 offset0:132 offset1:133
    v_mfma_f32_16x16x32_bf16 v[188:191], v[100:103], v[152:155], v[188:191]
    ds_read2_b32 v[34:35], v240 offset0:134 offset1:135
    v_mfma_f32_16x16x32_bf16 v[188:191], v[104:107], v[148:151], v[188:191]
    ds_read_b128 v[64:67], v244 offset:2304
    v_mfma_f32_16x16x32_bf16 v[188:191], v[108:111], v[144:147], v[188:191]
    ds_read2_b32 v[36:37], v240 offset0:4 offset1:5
    v_mfma_f32_16x16x32_bf16 v[188:191], v[112:115], v[140:143], v[188:191]
    ds_read2_b32 v[38:39], v240 offset0:6 offset1:7
    v_mfma_f32_16x16x32_bf16 v[188:191], v[116:119], v[136:139], v[188:191]
    ds_read_b128 v[68:71], v244 offset:2560
    v_mfma_f32_16x16x32_bf16 v[188:191], v[120:123], v[132:135], v[188:191]
    ds_read2_b32 v[40:41], v241 offset0:132 offset1:133
    v_mfma_f32_16x16x32_bf16 v[188:191], v[124:127], v[128:131], v[188:191]
    ds_read2_b32 v[42:43], v241 offset0:134 offset1:135
    v_mfma_f32_16x16x32_bf16 v[184:187], v[96:99], v[152:155], v[184:187]
    ds_read_b128 v[72:75], v244 offset:2816
    v_mfma_f32_16x16x32_bf16 v[184:187], v[100:103], v[148:151], v[184:187]
    ds_read2_b32 v[44:45], v241 offset0:4 offset1:5
    v_mfma_f32_16x16x32_bf16 v[184:187], v[104:107], v[144:147], v[184:187]
    ds_read2_b32 v[46:47], v241 offset0:6 offset1:7
    v_mfma_f32_16x16x32_bf16 v[184:187], v[108:111], v[140:143], v[184:187]
    ds_read_b128 v[76:79], v244 offset:3072
    v_mfma_f32_16x16x32_bf16 v[184:187], v[112:115], v[136:139], v[184:187]
    ds_read2_b32 v[48:49], v242 offset0:132 offset1:133
    v_mfma_f32_16x16x32_bf16 v[184:187], v[116:119], v[132:135], v[184:187]
    ds_read2_b32 v[50:51], v242 offset0:134 offset1:135
    v_mfma_f32_16x16x32_bf16 v[184:187], v[120:123], v[128:131], v[184:187]
    ds_read_b128 v[80:83], v244 offset:3328
    v_mfma_f32_16x16x32_bf16 v[180:183], v[96:99], v[148:151], v[180:183]
    ds_read2_b32 v[52:53], v242 offset0:4 offset1:5
    v_mfma_f32_16x16x32_bf16 v[180:183], v[100:103], v[144:147], v[180:183]
    ds_read2_b32 v[54:55], v242 offset0:6 offset1:7
    v_mfma_f32_16x16x32_bf16 v[180:183], v[104:107], v[140:143], v[180:183]
    ds_read_b128 v[84:87], v244 offset:3584
    v_mfma_f32_16x16x32_bf16 v[180:183], v[108:111], v[136:139], v[180:183]
    ds_read2_b32 v[56:57], v243 offset0:132 offset1:133
    v_mfma_f32_16x16x32_bf16 v[180:183], v[112:115], v[132:135], v[180:183]
    ds_read2_b32 v[58:59], v243 offset0:134 offset1:135
    v_mfma_f32_16x16x32_bf16 v[180:183], v[116:119], v[128:131], v[180:183]
    ds_read_b128 v[88:91], v244 offset:3840
    v_mfma_f32_16x16x32_bf16 v[176:179], v[96:99], v[144:147], v[176:179]
    ds_read2_b32 v[60:61], v243 offset0:4 offset1:5
    v_mfma_f32_16x16x32_bf16 v[176:179], v[100:103], v[140:143], v[176:179]
    ds_read2_b32 v[62:63], v243 offset0:6 offset1:7
    v_mfma_f32_16x16x32_bf16 v[176:179], v[104:107], v[136:139], v[176:179]
    ds_read_b128 v[92:95], v244 offset:4096
    v_mfma_f32_16x16x32_bf16 v[176:179], v[108:111], v[132:135], v[176:179]
    v_mfma_f32_16x16x32_bf16 v[176:179], v[112:115], v[128:131], v[176:179]
    v_mfma_f32_16x16x32_bf16 v[172:175], v[96:99], v[140:143], v[172:175]
    v_mfma_f32_16x16x32_bf16 v[172:175], v[100:103], v[136:139], v[172:175]
    v_mfma_f32_16x16x32_bf16 v[172:175], v[104:107], v[132:135], v[172:175]
    v_mfma_f32_16x16x32_bf16 v[172:175], v[108:111], v[128:131], v[172:175]
    v_mfma_f32_16x16x32_bf16 v[168:171], v[96:99], v[136:139], v[168:171]
    v_mfma_f32_16x16x32_bf16 v[168:171], v[100:103], v[132:135], v[168:171]
    v_mfma_f32_16x16x32_bf16 v[168:171], v[104:107], v[128:131], v[168:171]
    v_mfma_f32_16x16x32_bf16 v[164:167], v[96:99], v[132:135], v[164:167]
    v_mfma_f32_16x16x32_bf16 v[164:167], v[100:103], v[128:131], v[164:167]
    v_mfma_f32_16x16x32_bf16 v[160:163], v[96:99], v[128:131], v[160:163]
    s_waitcnt lgkmcnt(0)
    v_mfma_f32_16x16x32_bf16 v[188:191], v[32:35], v[92:95], v[188:191]
    ds_read2_b32 v[96:97], v240 offset0:128 offset1:129
    v_mfma_f32_16x16x32_bf16 v[188:191], v[36:39], v[88:91], v[188:191]
    ds_read2_b32 v[98:99], v240 offset0:130 offset1:131
    v_mfma_f32_16x16x32_bf16 v[188:191], v[40:43], v[84:87], v[188:191]
    ds_read_b128 v[128:131], v244 offset:0
    v_mfma_f32_16x16x32_bf16 v[188:191], v[44:47], v[80:83], v[188:191]
    ds_read2_b32 v[100:101], v240 offset0:0 offset1:1
    v_mfma_f32_16x16x32_bf16 v[188:191], v[48:51], v[76:79], v[188:191]
    ds_read2_b32 v[102:103], v240 offset0:2 offset1:3
    v_mfma_f32_16x16x32_bf16 v[188:191], v[52:55], v[72:75], v[188:191]
    ds_read_b128 v[132:135], v244 offset:256
    v_mfma_f32_16x16x32_bf16 v[188:191], v[56:59], v[68:71], v[188:191]
    ds_read2_b32 v[104:105], v241 offset0:128 offset1:129
    v_mfma_f32_16x16x32_bf16 v[188:191], v[60:63], v[64:67], v[188:191]
    ds_read2_b32 v[106:107], v241 offset0:130 offset1:131
    v_mfma_f32_16x16x32_bf16 v[184:187], v[32:35], v[88:91], v[184:187]
    ds_read_b128 v[136:139], v244 offset:512
    v_mfma_f32_16x16x32_bf16 v[184:187], v[36:39], v[84:87], v[184:187]
    ds_read2_b32 v[108:109], v241 offset0:0 offset1:1
    v_mfma_f32_16x16x32_bf16 v[184:187], v[40:43], v[80:83], v[184:187]
    ds_read2_b32 v[110:111], v241 offset0:2 offset1:3
    v_mfma_f32_16x16x32_bf16 v[184:187], v[44:47], v[76:79], v[184:187]
    ds_read_b128 v[140:143], v244 offset:768
    v_mfma_f32_16x16x32_bf16 v[184:187], v[48:51], v[72:75], v[184:187]
    ds_read2_b32 v[112:113], v242 offset0:128 offset1:129
    v_mfma_f32_16x16x32_bf16 v[184:187], v[52:55], v[68:71], v[184:187]
    ds_read2_b32 v[114:115], v242 offset0:130 offset1:131
    v_mfma_f32_16x16x32_bf16 v[184:187], v[56:59], v[64:67], v[184:187]
    ds_read_b128 v[144:147], v244 offset:1024
    v_mfma_f32_16x16x32_bf16 v[180:183], v[32:35], v[84:87], v[180:183]
    ds_read2_b32 v[116:117], v242 offset0:0 offset1:1
    v_mfma_f32_16x16x32_bf16 v[180:183], v[36:39], v[80:83], v[180:183]
    ds_read2_b32 v[118:119], v242 offset0:2 offset1:3
    v_mfma_f32_16x16x32_bf16 v[180:183], v[40:43], v[76:79], v[180:183]
    ds_read_b128 v[148:151], v244 offset:1280
    v_mfma_f32_16x16x32_bf16 v[180:183], v[44:47], v[72:75], v[180:183]
    ds_read2_b32 v[120:121], v243 offset0:128 offset1:129
    v_mfma_f32_16x16x32_bf16 v[180:183], v[48:51], v[68:71], v[180:183]
    ds_read2_b32 v[122:123], v243 offset0:130 offset1:131
    v_mfma_f32_16x16x32_bf16 v[180:183], v[52:55], v[64:67], v[180:183]
    ds_read_b128 v[152:155], v244 offset:1536
    v_mfma_f32_16x16x32_bf16 v[176:179], v[32:35], v[80:83], v[176:179]
    ds_read2_b32 v[124:125], v243 offset0:0 offset1:1
    v_mfma_f32_16x16x32_bf16 v[176:179], v[36:39], v[76:79], v[176:179]
    ds_read2_b32 v[126:127], v243 offset0:2 offset1:3
    v_mfma_f32_16x16x32_bf16 v[176:179], v[40:43], v[72:75], v[176:179]
    ds_read_b128 v[156:159], v244 offset:1792
    v_mfma_f32_16x16x32_bf16 v[176:179], v[44:47], v[68:71], v[176:179]
    v_subrev_u32 v240, 128, v240
    v_mfma_f32_16x16x32_bf16 v[176:179], v[48:51], v[64:67], v[176:179]
    v_subrev_u32 v241, 128, v241
    v_mfma_f32_16x16x32_bf16 v[172:175], v[32:35], v[76:79], v[172:175]
    v_subrev_u32 v242, 128, v242
    v_mfma_f32_16x16x32_bf16 v[172:175], v[36:39], v[72:75], v[172:175]
    v_subrev_u32 v243, 128, v243
    v_mfma_f32_16x16x32_bf16 v[172:175], v[40:43], v[68:71], v[172:175]
    v_subrev_u32 v244, 64, v244
    v_mfma_f32_16x16x32_bf16 v[172:175], v[44:47], v[64:67], v[172:175]
    v_mfma_f32_16x16x32_bf16 v[168:171], v[32:35], v[72:75], v[168:171]
    v_mfma_f32_16x16x32_bf16 v[168:171], v[36:39], v[68:71], v[168:171]
    v_mfma_f32_16x16x32_bf16 v[168:171], v[40:43], v[64:67], v[168:171]
    v_mfma_f32_16x16x32_bf16 v[164:167], v[32:35], v[68:71], v[164:167]
    v_mfma_f32_16x16x32_bf16 v[164:167], v[36:39], v[64:67], v[164:167]
    v_mfma_f32_16x16x32_bf16 v[160:163], v[32:35], v[64:67], v[160:163]
    s_waitcnt lgkmcnt(0)
    v_mfma_f32_16x16x32_bf16 v[188:191], v[96:99], v[156:159], v[188:191]
    ds_read2_b32 v[32:33], v240 offset0:132 offset1:133
    v_mfma_f32_16x16x32_bf16 v[188:191], v[100:103], v[152:155], v[188:191]
    ds_read2_b32 v[34:35], v240 offset0:134 offset1:135
    v_mfma_f32_16x16x32_bf16 v[188:191], v[104:107], v[148:151], v[188:191]
    ds_read_b128 v[64:67], v244 offset:2304
    v_mfma_f32_16x16x32_bf16 v[188:191], v[108:111], v[144:147], v[188:191]
    ds_read2_b32 v[36:37], v240 offset0:4 offset1:5
    v_mfma_f32_16x16x32_bf16 v[188:191], v[112:115], v[140:143], v[188:191]
    ds_read2_b32 v[38:39], v240 offset0:6 offset1:7
    v_mfma_f32_16x16x32_bf16 v[188:191], v[116:119], v[136:139], v[188:191]
    ds_read_b128 v[68:71], v244 offset:2560
    v_mfma_f32_16x16x32_bf16 v[188:191], v[120:123], v[132:135], v[188:191]
    ds_read2_b32 v[40:41], v241 offset0:132 offset1:133
    v_mfma_f32_16x16x32_bf16 v[188:191], v[124:127], v[128:131], v[188:191]
    ds_read2_b32 v[42:43], v241 offset0:134 offset1:135
    v_mfma_f32_16x16x32_bf16 v[184:187], v[96:99], v[152:155], v[184:187]
    ds_read_b128 v[72:75], v244 offset:2816
    v_mfma_f32_16x16x32_bf16 v[184:187], v[100:103], v[148:151], v[184:187]
    ds_read2_b32 v[44:45], v241 offset0:4 offset1:5
    v_mfma_f32_16x16x32_bf16 v[184:187], v[104:107], v[144:147], v[184:187]
    ds_read2_b32 v[46:47], v241 offset0:6 offset1:7
    v_mfma_f32_16x16x32_bf16 v[184:187], v[108:111], v[140:143], v[184:187]
    ds_read_b128 v[76:79], v244 offset:3072
    v_mfma_f32_16x16x32_bf16 v[184:187], v[112:115], v[136:139], v[184:187]
    ds_read2_b32 v[48:49], v242 offset0:132 offset1:133
    v_mfma_f32_16x16x32_bf16 v[184:187], v[116:119], v[132:135], v[184:187]
    ds_read2_b32 v[50:51], v242 offset0:134 offset1:135
    v_mfma_f32_16x16x32_bf16 v[184:187], v[120:123], v[128:131], v[184:187]
    ds_read_b128 v[80:83], v244 offset:3328
    v_mfma_f32_16x16x32_bf16 v[180:183], v[96:99], v[148:151], v[180:183]
    ds_read2_b32 v[52:53], v242 offset0:4 offset1:5
    v_mfma_f32_16x16x32_bf16 v[180:183], v[100:103], v[144:147], v[180:183]
    ds_read2_b32 v[54:55], v242 offset0:6 offset1:7
    v_mfma_f32_16x16x32_bf16 v[180:183], v[104:107], v[140:143], v[180:183]
    ds_read_b128 v[84:87], v244 offset:3584
    v_mfma_f32_16x16x32_bf16 v[180:183], v[108:111], v[136:139], v[180:183]
    ds_read2_b32 v[56:57], v243 offset0:132 offset1:133
    v_mfma_f32_16x16x32_bf16 v[180:183], v[112:115], v[132:135], v[180:183]
    ds_read2_b32 v[58:59], v243 offset0:134 offset1:135
    v_mfma_f32_16x16x32_bf16 v[180:183], v[116:119], v[128:131], v[180:183]
    ds_read_b128 v[88:91], v244 offset:3840
    v_mfma_f32_16x16x32_bf16 v[176:179], v[96:99], v[144:147], v[176:179]
    ds_read2_b32 v[60:61], v243 offset0:4 offset1:5
    v_mfma_f32_16x16x32_bf16 v[176:179], v[100:103], v[140:143], v[176:179]
    ds_read2_b32 v[62:63], v243 offset0:6 offset1:7
    v_mfma_f32_16x16x32_bf16 v[176:179], v[104:107], v[136:139], v[176:179]
    ds_read_b128 v[92:95], v244 offset:4096
    v_mfma_f32_16x16x32_bf16 v[176:179], v[108:111], v[132:135], v[176:179]
    v_mfma_f32_16x16x32_bf16 v[176:179], v[112:115], v[128:131], v[176:179]
    v_mfma_f32_16x16x32_bf16 v[172:175], v[96:99], v[140:143], v[172:175]
    v_mfma_f32_16x16x32_bf16 v[172:175], v[100:103], v[136:139], v[172:175]
    v_mfma_f32_16x16x32_bf16 v[172:175], v[104:107], v[132:135], v[172:175]
    v_mfma_f32_16x16x32_bf16 v[172:175], v[108:111], v[128:131], v[172:175]
    v_mfma_f32_16x16x32_bf16 v[168:171], v[96:99], v[136:139], v[168:171]
    v_mfma_f32_16x16x32_bf16 v[168:171], v[100:103], v[132:135], v[168:171]
    v_mfma_f32_16x16x32_bf16 v[168:171], v[104:107], v[128:131], v[168:171]
    v_mfma_f32_16x16x32_bf16 v[164:167], v[96:99], v[132:135], v[164:167]
    v_mfma_f32_16x16x32_bf16 v[164:167], v[100:103], v[128:131], v[164:167]
    v_mfma_f32_16x16x32_bf16 v[160:163], v[96:99], v[128:131], v[160:163]
    s_waitcnt lgkmcnt(0)
    v_mfma_f32_16x16x32_bf16 v[188:191], v[32:35], v[92:95], v[188:191]
    ds_read2_b32 v[96:97], v240 offset0:128 offset1:129
    v_mfma_f32_16x16x32_bf16 v[188:191], v[36:39], v[88:91], v[188:191]
    ds_read2_b32 v[98:99], v240 offset0:130 offset1:131
    v_mfma_f32_16x16x32_bf16 v[188:191], v[40:43], v[84:87], v[188:191]
    ds_read_b128 v[128:131], v244 offset:0
    v_mfma_f32_16x16x32_bf16 v[188:191], v[44:47], v[80:83], v[188:191]
    ds_read2_b32 v[100:101], v240 offset0:0 offset1:1
    v_mfma_f32_16x16x32_bf16 v[188:191], v[48:51], v[76:79], v[188:191]
    ds_read2_b32 v[102:103], v240 offset0:2 offset1:3
    v_mfma_f32_16x16x32_bf16 v[188:191], v[52:55], v[72:75], v[188:191]
    ds_read_b128 v[132:135], v244 offset:256
    v_mfma_f32_16x16x32_bf16 v[188:191], v[56:59], v[68:71], v[188:191]
    ds_read2_b32 v[104:105], v241 offset0:128 offset1:129
    v_mfma_f32_16x16x32_bf16 v[188:191], v[60:63], v[64:67], v[188:191]
    ds_read2_b32 v[106:107], v241 offset0:130 offset1:131
    v_mfma_f32_16x16x32_bf16 v[184:187], v[32:35], v[88:91], v[184:187]
    ds_read_b128 v[136:139], v244 offset:512
    v_mfma_f32_16x16x32_bf16 v[184:187], v[36:39], v[84:87], v[184:187]
    ds_read2_b32 v[108:109], v241 offset0:0 offset1:1
    v_mfma_f32_16x16x32_bf16 v[184:187], v[40:43], v[80:83], v[184:187]
    ds_read2_b32 v[110:111], v241 offset0:2 offset1:3
    v_mfma_f32_16x16x32_bf16 v[184:187], v[44:47], v[76:79], v[184:187]
    ds_read_b128 v[140:143], v244 offset:768
    v_mfma_f32_16x16x32_bf16 v[184:187], v[48:51], v[72:75], v[184:187]
    ds_read2_b32 v[112:113], v242 offset0:128 offset1:129
    v_mfma_f32_16x16x32_bf16 v[184:187], v[52:55], v[68:71], v[184:187]
    ds_read2_b32 v[114:115], v242 offset0:130 offset1:131
    v_mfma_f32_16x16x32_bf16 v[184:187], v[56:59], v[64:67], v[184:187]
    ds_read_b128 v[144:147], v244 offset:1024
    v_mfma_f32_16x16x32_bf16 v[180:183], v[32:35], v[84:87], v[180:183]
    ds_read2_b32 v[116:117], v242 offset0:0 offset1:1
    v_mfma_f32_16x16x32_bf16 v[180:183], v[36:39], v[80:83], v[180:183]
    ds_read2_b32 v[118:119], v242 offset0:2 offset1:3
    v_mfma_f32_16x16x32_bf16 v[180:183], v[40:43], v[76:79], v[180:183]
    ds_read_b128 v[148:151], v244 offset:1280
    v_mfma_f32_16x16x32_bf16 v[180:183], v[44:47], v[72:75], v[180:183]
    ds_read2_b32 v[120:121], v243 offset0:128 offset1:129
    v_mfma_f32_16x16x32_bf16 v[180:183], v[48:51], v[68:71], v[180:183]
    ds_read2_b32 v[122:123], v243 offset0:130 offset1:131
    v_mfma_f32_16x16x32_bf16 v[180:183], v[52:55], v[64:67], v[180:183]
    ds_read_b128 v[152:155], v244 offset:1536
    v_mfma_f32_16x16x32_bf16 v[176:179], v[32:35], v[80:83], v[176:179]
    ds_read2_b32 v[124:125], v243 offset0:0 offset1:1
    v_mfma_f32_16x16x32_bf16 v[176:179], v[36:39], v[76:79], v[176:179]
    ds_read2_b32 v[126:127], v243 offset0:2 offset1:3
    v_mfma_f32_16x16x32_bf16 v[176:179], v[40:43], v[72:75], v[176:179]
    ds_read_b128 v[156:159], v244 offset:1792
    v_mfma_f32_16x16x32_bf16 v[176:179], v[44:47], v[68:71], v[176:179]
    v_subrev_u32 v240, 128, v240
    v_mfma_f32_16x16x32_bf16 v[176:179], v[48:51], v[64:67], v[176:179]
    v_subrev_u32 v241, 128, v241
    v_mfma_f32_16x16x32_bf16 v[172:175], v[32:35], v[76:79], v[172:175]
    v_subrev_u32 v242, 128, v242
    v_mfma_f32_16x16x32_bf16 v[172:175], v[36:39], v[72:75], v[172:175]
    v_subrev_u32 v243, 128, v243
    v_mfma_f32_16x16x32_bf16 v[172:175], v[40:43], v[68:71], v[172:175]
    v_subrev_u32 v244, 64, v244
    v_mfma_f32_16x16x32_bf16 v[172:175], v[44:47], v[64:67], v[172:175]
    v_mfma_f32_16x16x32_bf16 v[168:171], v[32:35], v[72:75], v[168:171]
    v_mfma_f32_16x16x32_bf16 v[168:171], v[36:39], v[68:71], v[168:171]
    v_mfma_f32_16x16x32_bf16 v[168:171], v[40:43], v[64:67], v[168:171]
    v_mfma_f32_16x16x32_bf16 v[164:167], v[32:35], v[68:71], v[164:167]
    v_mfma_f32_16x16x32_bf16 v[164:167], v[36:39], v[64:67], v[164:167]
    v_mfma_f32_16x16x32_bf16 v[160:163], v[32:35], v[64:67], v[160:163]
    s_waitcnt lgkmcnt(0)
    v_mfma_f32_16x16x32_bf16 v[188:191], v[96:99], v[156:159], v[188:191]
    v_mfma_f32_16x16x32_bf16 v[188:191], v[100:103], v[152:155], v[188:191]
    v_mfma_f32_16x16x32_bf16 v[188:191], v[104:107], v[148:151], v[188:191]
    v_mfma_f32_16x16x32_bf16 v[188:191], v[108:111], v[144:147], v[188:191]
    v_mfma_f32_16x16x32_bf16 v[188:191], v[112:115], v[140:143], v[188:191]
    v_mfma_f32_16x16x32_bf16 v[188:191], v[116:119], v[136:139], v[188:191]
    v_mfma_f32_16x16x32_bf16 v[188:191], v[120:123], v[132:135], v[188:191]
    v_mfma_f32_16x16x32_bf16 v[188:191], v[124:127], v[128:131], v[188:191]
    v_mfma_f32_16x16x32_bf16 v[184:187], v[96:99], v[152:155], v[184:187]
    v_mfma_f32_16x16x32_bf16 v[184:187], v[100:103], v[148:151], v[184:187]
    v_mfma_f32_16x16x32_bf16 v[184:187], v[104:107], v[144:147], v[184:187]
    v_mfma_f32_16x16x32_bf16 v[184:187], v[108:111], v[140:143], v[184:187]
    v_mfma_f32_16x16x32_bf16 v[184:187], v[112:115], v[136:139], v[184:187]
    v_mfma_f32_16x16x32_bf16 v[184:187], v[116:119], v[132:135], v[184:187]
    v_mfma_f32_16x16x32_bf16 v[184:187], v[120:123], v[128:131], v[184:187]
    v_mfma_f32_16x16x32_bf16 v[180:183], v[96:99], v[148:151], v[180:183]
    v_mfma_f32_16x16x32_bf16 v[180:183], v[100:103], v[144:147], v[180:183]
    v_mfma_f32_16x16x32_bf16 v[180:183], v[104:107], v[140:143], v[180:183]
    v_mfma_f32_16x16x32_bf16 v[180:183], v[108:111], v[136:139], v[180:183]
    v_mfma_f32_16x16x32_bf16 v[180:183], v[112:115], v[132:135], v[180:183]
    v_mfma_f32_16x16x32_bf16 v[180:183], v[116:119], v[128:131], v[180:183]
    v_mfma_f32_16x16x32_bf16 v[176:179], v[96:99], v[144:147], v[176:179]
    v_mfma_f32_16x16x32_bf16 v[176:179], v[100:103], v[140:143], v[176:179]
    v_mfma_f32_16x16x32_bf16 v[176:179], v[104:107], v[136:139], v[176:179]
    v_mfma_f32_16x16x32_bf16 v[176:179], v[108:111], v[132:135], v[176:179]
    v_mfma_f32_16x16x32_bf16 v[176:179], v[112:115], v[128:131], v[176:179]
    v_mfma_f32_16x16x32_bf16 v[172:175], v[96:99], v[140:143], v[172:175]
    v_mfma_f32_16x16x32_bf16 v[172:175], v[100:103], v[136:139], v[172:175]
    v_mfma_f32_16x16x32_bf16 v[172:175], v[104:107], v[132:135], v[172:175]
    v_mfma_f32_16x16x32_bf16 v[172:175], v[108:111], v[128:131], v[172:175]
    v_mfma_f32_16x16x32_bf16 v[168:171], v[96:99], v[136:139], v[168:171]
    v_mfma_f32_16x16x32_bf16 v[168:171], v[100:103], v[132:135], v[168:171]
    v_mfma_f32_16x16x32_bf16 v[168:171], v[104:107], v[128:131], v[168:171]
    v_mfma_f32_16x16x32_bf16 v[164:167], v[96:99], v[132:135], v[164:167]
    v_mfma_f32_16x16x32_bf16 v[164:167], v[100:103], v[128:131], v[164:167]
    v_mfma_f32_16x16x32_bf16 v[160:163], v[96:99], v[128:131], v[160:163]
    ds_read_b64 v[136:137], v245 offset:3584
    ds_read_b64 v[138:139], v245 offset:3072
    ds_read_b64 v[140:141], v245 offset:2560
    ds_read_b64 v[142:143], v245 offset:2048
    ds_read_b64 v[144:145], v245 offset:1536
    ds_read_b64 v[146:147], v245 offset:1024
    ds_read_b64 v[148:149], v245 offset:512
    ds_read_b64 v[150:151], v245 offset:0
    s_mov_b64 exec, 1
    ds_add_u32 v15, v14 offset:36
    s_mov_b64 exec, -1
    s_setprio 3
    s_waitcnt lgkmcnt(0)
    v_and_b32 v152, s70, v137
    v_lshlrev_b32 v153, 16, v137
    v_and_b32 v154, s70, v136
    v_lshlrev_b32 v155, 16, v136
    v_fmac_f32 v160, s71, v152
    v_fmac_f32 v161, s71, v153
    v_fmac_f32 v162, s71, v154
    v_fmac_f32 v163, s71, v155
    v_cvt_pk_bf16_f32 v136, v160, v161
    v_cvt_pk_bf16_f32 v137, v162, v163
    v_and_b32 v152, s70, v139
    v_lshlrev_b32 v153, 16, v139
    v_and_b32 v154, s70, v138
    v_lshlrev_b32 v155, 16, v138
    v_fmac_f32 v164, s71, v152
    v_fmac_f32 v165, s71, v153
    v_fmac_f32 v166, s71, v154
    v_fmac_f32 v167, s71, v155
    v_cvt_pk_bf16_f32 v138, v164, v165
    v_cvt_pk_bf16_f32 v139, v166, v167
    v_and_b32 v152, s70, v141
    v_lshlrev_b32 v153, 16, v141
    v_and_b32 v154, s70, v140
    v_lshlrev_b32 v155, 16, v140
    v_fmac_f32 v168, s71, v152
    v_fmac_f32 v169, s71, v153
    v_fmac_f32 v170, s71, v154
    v_fmac_f32 v171, s71, v155
    v_cvt_pk_bf16_f32 v140, v168, v169
    v_cvt_pk_bf16_f32 v141, v170, v171
    v_and_b32 v152, s70, v143
    v_lshlrev_b32 v153, 16, v143
    v_and_b32 v154, s70, v142
    v_lshlrev_b32 v155, 16, v142
    v_fmac_f32 v172, s71, v152
    v_fmac_f32 v173, s71, v153
    v_fmac_f32 v174, s71, v154
    v_fmac_f32 v175, s71, v155
    v_cvt_pk_bf16_f32 v142, v172, v173
    v_cvt_pk_bf16_f32 v143, v174, v175
    v_and_b32 v152, s70, v145
    v_lshlrev_b32 v153, 16, v145
    v_and_b32 v154, s70, v144
    v_lshlrev_b32 v155, 16, v144
    v_fmac_f32 v176, s71, v152
    v_fmac_f32 v177, s71, v153
    v_fmac_f32 v178, s71, v154
    v_fmac_f32 v179, s71, v155
    v_cvt_pk_bf16_f32 v144, v176, v177
    v_cvt_pk_bf16_f32 v145, v178, v179
    v_and_b32 v152, s70, v147
    v_lshlrev_b32 v153, 16, v147
    v_and_b32 v154, s70, v146
    v_lshlrev_b32 v155, 16, v146
    v_fmac_f32 v180, s71, v152
    v_fmac_f32 v181, s71, v153
    v_fmac_f32 v182, s71, v154
    v_fmac_f32 v183, s71, v155
    v_cvt_pk_bf16_f32 v146, v180, v181
    v_cvt_pk_bf16_f32 v147, v182, v183
    v_and_b32 v152, s70, v149
    v_lshlrev_b32 v153, 16, v149
    v_and_b32 v154, s70, v148
    v_lshlrev_b32 v155, 16, v148
    v_fmac_f32 v184, s71, v152
    v_fmac_f32 v185, s71, v153
    v_fmac_f32 v186, s71, v154
    v_fmac_f32 v187, s71, v155
    v_cvt_pk_bf16_f32 v148, v184, v185
    v_cvt_pk_bf16_f32 v149, v186, v187
    v_and_b32 v152, s70, v151
    v_lshlrev_b32 v153, 16, v151
    v_and_b32 v154, s70, v150
    v_lshlrev_b32 v155, 16, v150
    v_fmac_f32 v188, s71, v152
    v_fmac_f32 v189, s71, v153
    v_fmac_f32 v190, s71, v154
    v_fmac_f32 v191, s71, v155
    v_cvt_pk_bf16_f32 v150, v188, v189
    v_cvt_pk_bf16_f32 v151, v190, v191
    s_nop 1
    v_permlane16_swap_b32 v136, v138
    v_permlane16_swap_b32 v137, v139
    v_permlane16_swap_b32 v140, v142
    v_permlane16_swap_b32 v141, v143
    v_permlane16_swap_b32 v144, v146
    v_permlane16_swap_b32 v145, v147
    v_permlane16_swap_b32 v148, v150
    v_permlane16_swap_b32 v149, v151
    s_waitcnt vmcnt(4)
    buffer_store_dwordx4 v[136:139], v246, s[48:51], s39 offen offset:0 sc1
    buffer_store_dwordx4 v[140:143], v246, s[48:51], s39 offen offset:1024 sc1
    buffer_store_dwordx4 v[144:147], v246, s[48:51], s39 offen offset:2048 sc1
    buffer_store_dwordx4 v[148:151], v246, s[48:51], s39 offen offset:3072 sc1
    s_mov_b32 s60, 0
L_cdspin:
    ds_read_b32 v3, v15 offset:36
    s_add_u32 s60, s60, 1
    s_waitcnt lgkmcnt(0)
    v_readfirstlane_b32 s61, v3
    s_cmp_gt_u32 s60, 0x40000
    s_cbranch_scc1 L_cdspin_done
    s_cmp_ge_u32 s61, 4
    s_cbranch_scc1 L_cdspin_done
    s_sleep 0
    s_branch L_cdspin
L_cdspin_done:
    s_lshl_b32 s60, s3, 13
    s_add_u32 s60, s60, 98304
    v_add_u32 v21, s60, v5
    ds_write_b128 v21, v[192:195] offset:0
    ds_write_b128 v21, v[196:199] offset:1024
    ds_write_b128 v21, v[200:203] offset:2048
    ds_write_b128 v21, v[204:207] offset:3072
    ds_write_b128 v21, v[208:211] offset:4096
    ds_write_b128 v21, v[212:215] offset:5120
    ds_write_b128 v21, v[216:219] offset:6144
    ds_write_b128 v21, v[220:223] offset:7168
    s_mov_b32 s61, 0
    s_lshl_b32 s60, s31, 1
    s_bitset1_b32 s61, s60
    v_mov_b32 v3, s61
    s_mov_b64 exec, 1
    ds_or_b32 v15, v3 offset:60
    s_mov_b64 exec, -1
    s_lshl_b32 s65, s36, 18
    s_lshl_b32 s60, s69, 1
    s_add_u32 s65, s65, s60
    s_add_u32 s65, s65, 0x0
    v_lshrrev_b32 v18, 2, v4
    v_lshlrev_b32 v18, 12, v18
    v_lshl_add_u32 v18, v30, 4, v18
    v_lshl_add_u32 v20, v28, 3, v29
    v_lshlrev_b32 v20, 6, v20
    v_lshl_add_u32 v20, v30, 3, v20
    v_add_u32 v20, s68, v20
    s_movk_i32 s60, 144
    v_mul_u32_u24 v24, s60, v31
    v_lshl_add_u32 v24, v28, 4, v24
    v_add_u32 v24, s68, v24
    v_mul_u32_u24 v25, s60, v1
    v_add3_u32 v25, v25, v27, s68
    s_mov_b32 m0, s68
    s_waitcnt vmcnt(0)
    s_mov_b64 exec, 1
    ds_add_rtn_u32 v3, v15, v14 offset:32
    s_mov_b64 exec, -1
    s_waitcnt lgkmcnt(0)
    v_readfirstlane_b32 s60, v3
    s_nop 3
    s_cmp_eq_u32 s60, 3
    s_cbranch_scc0 L_yfl
    s_mov_b64 exec, -1
    buffer_store_dword v7, v255, s[48:51], s32 offen sc1
    s_mov_b64 exec, -1
L_yfl:
    s_setprio 0
    s_waitcnt vmcnt(0)
    v_lshlrev_b32 v96, 16, v224
    v_and_b32 v97, s70, v224
    v_lshlrev_b32 v98, 16, v225
    v_and_b32 v99, s70, v225
    v_lshlrev_b32 v100, 16, v226
    v_and_b32 v101, s70, v226
    v_lshlrev_b32 v102, 16, v227
    v_and_b32 v103, s70, v227
    v_lshlrev_b32 v104, 16, v228
    v_and_b32 v105, s70, v228
    v_lshlrev_b32 v106, 16, v229
    v_and_b32 v107, s70, v229
    v_lshlrev_b32 v108, 16, v230
    v_and_b32 v109, s70, v230
    v_lshlrev_b32 v110, 16, v231
    v_and_b32 v111, s70, v231
    v_lshlrev_b32 v112, 16, v232
    v_and_b32 v113, s70, v232
    v_lshlrev_b32 v114, 16, v233
    v_and_b32 v115, s70, v233
    v_lshlrev_b32 v116, 16, v234
    v_and_b32 v117, s70, v234
    v_lshlrev_b32 v118, 16, v235
    v_and_b32 v119, s70, v235
    v_lshlrev_b32 v120, 16, v236
    v_and_b32 v121, s70, v236
    v_lshlrev_b32 v122, 16, v237
    v_and_b32 v123, s70, v237
    v_lshlrev_b32 v124, 16, v238
    v_and_b32 v125, s70, v238
    v_lshlrev_b32 v126, 16, v239
    v_and_b32 v127, s70, v239
    s_mov_b32 s29, 0
L_yloop:
    s_cmp_eq_u32 s64, 0x5555
    s_cbranch_scc1 L_ynop
    s_load_dwordx16 s[4:19], s[26:27], s66 glc
    s_waitcnt lgkmcnt(0)
    s_mov_b32 s62, 0
    s_cmp_eq_u64 s[4:5], s[72:73]
    s_cselect_b32 s60, 0x1, 0
    s_or_b32 s62, s62, s60
    s_cmp_eq_u64 s[6:7], s[72:73]
    s_cselect_b32 s60, 0x4, 0
    s_or_b32 s62, s62, s60
    s_cmp_eq_u64 s[8:9], s[72:73]
    s_cselect_b32 s60, 0x10, 0
    s_or_b32 s62, s62, s60
    s_cmp_eq_u64 s[10:11], s[72:73]
    s_cselect_b32 s60, 0x40, 0
    s_or_b32 s62, s62, s60
    s_cmp_eq_u64 s[12:13], s[72:73]
    s_cselect_b32 s60, 0x100, 0
    s_or_b32 s62, s62, s60
    s_cmp_eq_u64 s[14:15], s[72:73]
    s_cselect_b32 s60, 0x400, 0
    s_or_b32 s62, s62, s60
    s_cmp_eq_u64 s[16:17], s[72:73]
    s_cselect_b32 s60, 0x1000, 0
    s_or_b32 s62, s62, s60
    s_cmp_eq_u64 s[18:19], s[72:73]
    s_cselect_b32 s60, 0x4000, 0
    s_or_b32 s62, s62, s60
    s_mov_b32 s64, s62
    s_lshl_b32 s60, s62, s33
    s_mov_b32 s61, s60
    s_lshr_b64 s[60:61], s[60:61], s28
    v_mov_b32 v3, s60
    s_mov_b64 exec, 1
    ds_or_b32 v19, v3 offset:64
    s_mov_b64 exec, -1
L_ynop:
    s_load_dwordx16 s[4:19], s[26:27], s67 glc
    s_add_u32 s29, s29, 1
    s_cmp_gt_u32 s29, 0x8000
    s_cbranch_scc1 L_ydone
    s_waitcnt lgkmcnt(0)
    s_cmp_eq_u64 s[4:5], s[72:73]
    s_cbranch_scc0 L_yloop
    s_cmp_eq_u64 s[6:7], s[72:73]
    s_cbranch_scc0 L_yloop
    s_cmp_eq_u64 s[8:9], s[72:73]
    s_cbranch_scc0 L_yloop
    s_cmp_eq_u64 s[10:11], s[72:73]
    s_cbranch_scc0 L_yloop
    s_cmp_eq_u64 s[12:13], s[72:73]
    s_cbranch_scc0 L_yloop
    s_cmp_eq_u64 s[14:15], s[72:73]
    s_cbranch_scc0 L_yloop
    s_cmp_eq_u64 s[16:17], s[72:73]
    s_cbranch_scc0 L_yloop
    s_cmp_eq_u64 s[18:19], s[72:73]
    s_cbranch_scc0 L_yloop
L_ydone:
    s_waitcnt lgkmcnt(0)
    buffer_load_dwordx4 v18, s[48:51], s65 offen offset:0 sc1 lds
    s_add_u32 s65, s65, 64512
    buffer_load_dwordx4 v18, s[48:51], s65 offen offset:1024 sc1 lds
    s_add_u32 s65, s65, 64512
    buffer_load_dwordx4 v18, s[48:51], s65 offen offset:2048 sc1 lds
    s_add_u32 s65, s65, 64512
    buffer_load_dwordx4 v18, s[48:51], s65 offen offset:3072 sc1 lds
    s_waitcnt vmcnt(0)
    ds_read_b64_tr_b16 v[48:49], v20 offset:0
    ds_read_b64_tr_b16 v[50:51], v20 offset:256
    ds_read_b64_tr_b16 v[52:53], v20 offset:2048
    ds_read_b64_tr_b16 v[54:55], v20 offset:2304
    ds_read_b64_tr_b16 v[56:57], v20 offset:32
    ds_read_b64_tr_b16 v[58:59], v20 offset:288
    ds_read_b64_tr_b16 v[60:61], v20 offset:2080
    ds_read_b64_tr_b16 v[62:63], v20 offset:2336
    s_waitcnt lgkmcnt(0)
    ds_write_b128 v24, v[48:51] offset:0
    ds_write_b128 v24, v[52:55] offset:64
    ds_write_b128 v24, v[56:59] offset:2304
    ds_write_b128 v24, v[60:63] offset:2368
    ds_read_b128 v[80:83], v25 offset:0
    ds_read_b128 v[84:87], v25 offset:1152
    ds_read_b128 v[88:91], v25 offset:2304
    ds_read_b128 v[92:95], v25 offset:3456
    s_waitcnt lgkmcnt(3)
    v_lshlrev_b32 v64, 16, v80
    v_and_b32 v65, s70, v80
    v_lshlrev_b32 v66, 16, v81
    v_and_b32 v67, s70, v81
    v_lshlrev_b32 v68, 16, v82
    v_and_b32 v69, s70, v82
    v_lshlrev_b32 v70, 16, v83
    v_and_b32 v71, s70, v83
    v_mul_f32 v64, v64, v96
    v_mul_f32 v65, v65, v97
    v_mul_f32 v66, v66, v98
    v_mul_f32 v67, v67, v99
    v_mul_f32 v68, v68, v100
    v_mul_f32 v69, v69, v101
    v_mul_f32 v70, v70, v102
    v_mul_f32 v71, v71, v103
    v_cvt_pk_bf16_f32 v224, v64, v65
    v_cvt_pk_bf16_f32 v225, v66, v67
    v_cvt_pk_bf16_f32 v226, v68, v69
    v_cvt_pk_bf16_f32 v227, v70, v71
    buffer_store_dwordx4 v[224:227], v17, s[44:47], s63 offen sc1
    s_add_u32 s63, s63, 0x8000
    s_waitcnt lgkmcnt(2)
    v_lshlrev_b32 v64, 16, v84
    v_and_b32 v65, s70, v84
    v_lshlrev_b32 v66, 16, v85
    v_and_b32 v67, s70, v85
    v_lshlrev_b32 v68, 16, v86
    v_and_b32 v69, s70, v86
    v_lshlrev_b32 v70, 16, v87
    v_and_b32 v71, s70, v87
    v_mul_f32 v64, v64, v104
    v_mul_f32 v65, v65, v105
    v_mul_f32 v66, v66, v106
    v_mul_f32 v67, v67, v107
    v_mul_f32 v68, v68, v108
    v_mul_f32 v69, v69, v109
    v_mul_f32 v70, v70, v110
    v_mul_f32 v71, v71, v111
    v_cvt_pk_bf16_f32 v228, v64, v65
    v_cvt_pk_bf16_f32 v229, v66, v67
    v_cvt_pk_bf16_f32 v230, v68, v69
    v_cvt_pk_bf16_f32 v231, v70, v71
    buffer_store_dwordx4 v[228:231], v17, s[44:47], s63 offen sc1
    s_add_u32 s63, s63, 0x8000
    s_waitcnt lgkmcnt(1)
    v_lshlrev_b32 v64, 16, v88
    v_and_b32 v65, s70, v88
    v_lshlrev_b32 v66, 16, v89
    v_and_b32 v67, s70, v89
    v_lshlrev_b32 v68, 16, v90
    v_and_b32 v69, s70, v90
    v_lshlrev_b32 v70, 16, v91
    v_and_b32 v71, s70, v91
    v_mul_f32 v64, v64, v112
    v_mul_f32 v65, v65, v113
    v_mul_f32 v66, v66, v114
    v_mul_f32 v67, v67, v115
    v_mul_f32 v68, v68, v116
    v_mul_f32 v69, v69, v117
    v_mul_f32 v70, v70, v118
    v_mul_f32 v71, v71, v119
    v_cvt_pk_bf16_f32 v232, v64, v65
    v_cvt_pk_bf16_f32 v233, v66, v67
    v_cvt_pk_bf16_f32 v234, v68, v69
    v_cvt_pk_bf16_f32 v235, v70, v71
    buffer_store_dwordx4 v[232:235], v17, s[44:47], s63 offen sc1
    s_add_u32 s63, s63, 0x8000
    s_waitcnt lgkmcnt(0)
    v_lshlrev_b32 v64, 16, v92
    v_and_b32 v65, s70, v92
    v_lshlrev_b32 v66, 16, v93
    v_and_b32 v67, s70, v93
    v_lshlrev_b32 v68, 16, v94
    v_and_b32 v69, s70, v94
    v_lshlrev_b32 v70, 16, v95
    v_and_b32 v71, s70, v95
    v_mul_f32 v64, v64, v120
    v_mul_f32 v65, v65, v121
    v_mul_f32 v66, v66, v122
    v_mul_f32 v67, v67, v123
    v_mul_f32 v68, v68, v124
    v_mul_f32 v69, v69, v125
    v_mul_f32 v70, v70, v126
    v_mul_f32 v71, v71, v127
    v_cvt_pk_bf16_f32 v236, v64, v65
    v_cvt_pk_bf16_f32 v237, v66, v67
    v_cvt_pk_bf16_f32 v238, v68, v69
    v_cvt_pk_bf16_f32 v239, v70, v71
    buffer_store_dwordx4 v[236:239], v17, s[44:47], s63 offen sc1
    s_endpgm
L_comp:
    s_and_b32 s34, s28, 3
    s_lshl_b32 s34, s34, 2
    s_and_b32 vcc_lo, s29, 3
    s_add_u32 s34, s34, vcc_lo
    s_lshr_b32 s35, s28, 2
    s_lshl_b32 s35, s35, 3
    s_lshr_b32 vcc_lo, s29, 2
    s_add_u32 s35, s35, vcc_lo
    s_and_b32 s36, s29, 15
    s_lshr_b32 s37, s29, 4
    s_lshl_b32 vcc_lo, s28, 1
    s_add_u32 s37, s37, vcc_lo
    s_lshl_b32 s38, s28, 5
    s_add_u32 s38, s38, s29
    s_lshl_b32 s38, s38, 2
    s_lshl_b32 s45, s37, 18
    s_lshl_b32 s46, s3, 16
    s_add_u32 s45, s45, s46
    s_lshl_b32 s46, s36, 7
    s_add_u32 s45, s45, s46
    v_lshrrev_b32 v2, 4, v4
    v_and_b32 v1, 15, v4
    v_lshlrev_b32 v3, 3, v1
    v_lshl_add_u32 v16, v2, 14, v3
    v_add_u32 v16, s45, v16
    v_subrev_u32 v17, 6144, v16
    s_movk_i32 s57, 4096
    s_movk_i32 s58, 8192
    s_movk_i32 s59, 12288
    s_mov_b32 s62, 0x400000
    s_mov_b32 s63, 0x20000
    s_mov_b32 s66, 0x400000
    s_mov_b32 s67, 0x20000
    s_mov_b32 s70, 8192
    s_mov_b32 s71, 0x20000
    v_lshlrev_b32 v18, 5, v1
    s_lshl_b32 s46, s36, 9
    v_add_u32 v18, s46, v18
    v_sub_u32 v3, 3, v2
    s_lshl_b32 s45, s3, 2
    s_sub_u32 s45, 12, s45
    v_add_u32 v3, s45, v3
    v_and_b32 v6, 7, v4
    v_xor_b32 v3, v3, v6
    v_lshlrev_b32 v3, 4, v3
    v_lshl_add_u32 v3, v1, 10, v3
    v_add_u32 v19, 139776, v3
    s_and_b32 s40, s3, 1
    s_lshr_b32 s41, s3, 1
    v_bfe_u32 v3, v4, 1, 3
    v_xor_b32 v3, v2, v3
    v_lshlrev_b32 v3, 4, v3
    v_lshl_add_u32 v3, v1, 7, v3
    s_lshl_b32 s45, s40, 13
    v_add_u32 v8, s45, v3
    v_xor_b32 v9, 64, v8
    v_bfe_u32 v22, v4, 2, 2
    v_lshl_add_u32 v3, v2, 3, v22
    v_lshlrev_b32 v3, 7, v3
    v_and_b32 v7, 3, v4
    v_lshlrev_b32 v6, 3, v7
    s_lshl_b32 s45, s41, 6
    v_add_u32 v6, s45, v6
    v_bfe_u32 v7, v4, 3, 1
    v_lshlrev_b32 v7, 6, v7
    v_xor_b32 v6, v6, v7
    v_bfe_u32 v23, v4, 4, 1
    v_lshlrev_b32 v7, 5, v23
    v_xor_b32 v6, v6, v7
    v_add_u32 v3, v3, v6
    v_add_u32 v12, 0x4000, v3
    v_xor_b32 v13, 32, v12
    v_mov_b32 v14, v12
    v_mov_b32 v15, v13
    v_mov_b32 v10, v8
    v_mov_b32 v11, v9
    s_lshl_b32 s39, s40, 5
    v_lshlrev_b32 v254, 7, v4
    v_mov_b32 v20, 162816
    v_mov_b32 v232, 1
    v_mov_b32 v233, 0
    v_lshlrev_b32 v6, 2, v4
    v_add_u32 v6, 162816, v6
    ds_write_b32 v6, v233
    s_lshl_b32 s45, s3, 2
    v_add_u32 v21, s45, v20
    s_mov_b32 s53, 0
    s_mov_b32 s56, 0xffff0000
    s_waitcnt lgkmcnt(0)
    s_nop 0
    s_mov_b64 s[60:61], s[12:13]
    s_mov_b64 s[64:65], s[14:15]
    s_mov_b64 s[68:69], s[16:17]
    s_barrier
    buffer_load_dwordx2 v[200:201], v17, s[60:63], 0 offen offset:0
    buffer_load_dwordx2 v[202:203], v17, s[60:63], 0 offen offset:2048
    buffer_load_dwordx2 v[204:205], v17, s[60:63], s57 offen offset:0
    buffer_load_dwordx2 v[206:207], v16, s[60:63], 0 offen offset:0
    buffer_load_dwordx2 v[208:209], v16, s[60:63], 0 offen offset:2048
    buffer_load_dwordx2 v[210:211], v16, s[60:63], s57 offen offset:0
    buffer_load_dwordx2 v[212:213], v16, s[60:63], s57 offen offset:2048
    buffer_load_dwordx2 v[214:215], v16, s[60:63], s58 offen offset:0
    buffer_load_dwordx2 v[216:217], v16, s[60:63], s58 offen offset:2048
    buffer_load_dwordx2 v[218:219], v16, s[60:63], s59 offen offset:0
    buffer_load_dwordx2 v[220:221], v16, s[60:63], s59 offen offset:2048
    buffer_load_dwordx4 v[242:245], v18, s[68:71], 0 offen offset:0
    buffer_load_dwordx4 v[246:249], v18, s[68:71], 0 offen offset:16
    buffer_load_dwordx2 v[222:223], v16, s[64:67], 0 offen offset:0
    buffer_load_dwordx2 v[224:225], v16, s[64:67], 0 offen offset:2048
    buffer_load_dwordx2 v[226:227], v16, s[64:67], s57 offen offset:0
    buffer_load_dwordx2 v[228:229], v16, s[64:67], s57 offen offset:2048
    buffer_load_dwordx2 v[230:231], v16, s[64:67], s58 offen offset:0
    buffer_load_dwordx2 v[236:237], v16, s[64:67], s58 offen offset:2048
    buffer_load_dwordx2 v[238:239], v16, s[64:67], s59 offen offset:0
    buffer_load_dwordx2 v[240:241], v16, s[64:67], s59 offen offset:2048
    v_xor_b32 v17, s39, v14
    v_xor_b32 v18, s39, v15
    s_barrier
    ds_read_b128 v[24:27], v10 offset:0
    ds_read_b128 v[28:31], v11 offset:0
    ds_read_b64_tr_b16 v[56:57], v14 offset:8192
    ds_read_b64_tr_b16 v[58:59], v14 offset:8704
    ds_read_b64_tr_b16 v[60:61], v14 offset:12288
    ds_read_b64_tr_b16 v[62:63], v14 offset:12800
    ds_read_b128 v[32:35], v10 offset:2048
    ds_read_b128 v[36:39], v11 offset:2048
    ds_read_b128 v[40:43], v10 offset:4096
    ds_read_b128 v[44:47], v11 offset:4096
    ds_read_b128 v[48:51], v10 offset:6144
    ds_read_b128 v[52:55], v11 offset:6144
    ds_read_b64_tr_b16 v[64:65], v15 offset:8192
    ds_read_b64_tr_b16 v[66:67], v15 offset:8704
    ds_read_b64_tr_b16 v[68:69], v15 offset:12288
    ds_read_b64_tr_b16 v[70:71], v15 offset:12800
    s_mov_b32 s52, 0
    s_waitcnt lgkmcnt(10)
    v_mfma_f32_16x16x32_bf16 v[136:139], v[24:27], v[56:59], 0
    v_mfma_f32_16x16x32_bf16 v[136:139], v[28:31], v[60:63], v[136:139]
    ds_read_b64_tr_b16 v[72:73], v17 offset:16384
    ds_read_b64_tr_b16 v[74:75], v17 offset:16896
    ds_read_b64_tr_b16 v[76:77], v17 offset:20480
    ds_read_b64_tr_b16 v[78:79], v17 offset:20992
    s_waitcnt lgkmcnt(8)
    v_mfma_f32_16x16x32_bf16 v[140:143], v[32:35], v[56:59], 0
    ds_read_b64_tr_b16 v[80:81], v18 offset:16384
    v_mfma_f32_16x16x32_bf16 v[140:143], v[36:39], v[60:63], v[140:143]
    ds_read_b64_tr_b16 v[82:83], v18 offset:16896
    v_mfma_f32_16x16x32_bf16 v[144:147], v[40:43], v[56:59], 0
    ds_read_b64_tr_b16 v[84:85], v18 offset:20480
    v_mfma_f32_16x16x32_bf16 v[144:147], v[44:47], v[60:63], v[144:147]
    ds_read_b64_tr_b16 v[86:87], v18 offset:20992
    v_mfma_f32_16x16x32_bf16 v[148:151], v[48:51], v[56:59], 0
    ds_read_b64_tr_b16 v[88:89], v14 offset:0
    v_mfma_f32_16x16x32_bf16 v[148:151], v[52:55], v[60:63], v[148:151]
    ds_read_b64_tr_b16 v[90:91], v14 offset:512
    s_waitcnt lgkmcnt(10)
    v_mfma_f32_16x16x32_bf16 v[152:155], v[24:27], v[64:67], 0
    ds_read_b64_tr_b16 v[92:93], v14 offset:4096
    v_mfma_f32_16x16x32_bf16 v[152:155], v[28:31], v[68:71], v[152:155]
    ds_read_b64_tr_b16 v[94:95], v14 offset:4608
    v_mfma_f32_16x16x32_bf16 v[156:159], v[32:35], v[64:67], 0
    ds_read_b64_tr_b16 v[96:97], v15 offset:0
    v_mfma_f32_16x16x32_bf16 v[156:159], v[36:39], v[68:71], v[156:159]
    ds_read_b64_tr_b16 v[98:99], v15 offset:512
    v_mfma_f32_16x16x32_bf16 v[160:163], v[40:43], v[64:67], 0
    ds_read_b64_tr_b16 v[100:101], v15 offset:4096
    v_mfma_f32_16x16x32_bf16 v[160:163], v[44:47], v[68:71], v[160:163]
    ds_read_b64_tr_b16 v[102:103], v15 offset:4608
    v_mfma_f32_16x16x32_bf16 v[164:167], v[48:51], v[64:67], 0
    v_mfma_f32_16x16x32_bf16 v[164:167], v[52:55], v[68:71], v[164:167]
    s_waitcnt lgkmcnt(0)
    v_mfma_f32_16x16x32_bf16 v[168:171], v[24:27], v[72:75], 0
    s_add_u32 s52, s52, 40960
    s_cmp_eq_u32 s52, 122880
    v_mfma_f32_16x16x32_bf16 v[168:171], v[28:31], v[76:79], v[168:171]
    s_cselect_b32 s52, 0, s52
    v_add_u32 v10, s52, v8
    v_mfma_f32_16x16x32_bf16 v[172:175], v[32:35], v[72:75], 0
    v_add_u32 v11, s52, v9
    v_add_u32 v14, s52, v12
    v_mfma_f32_16x16x32_bf16 v[172:175], v[36:39], v[76:79], v[172:175]
    v_add_u32 v15, s52, v13
    v_xor_b32 v17, s39, v14
    v_mfma_f32_16x16x32_bf16 v[176:179], v[40:43], v[72:75], 0
    v_xor_b32 v18, s39, v15
    s_mov_b32 s60, s26
    v_mfma_f32_16x16x32_bf16 v[176:179], v[44:47], v[76:79], v[176:179]
    s_mov_b32 s61, s27
    s_mov_b32 s62, 0x2000000
    v_mfma_f32_16x16x32_bf16 v[180:183], v[48:51], v[72:75], 0
    s_mov_b32 s63, 0x20000
    s_mov_b32 s68, s22
    v_mfma_f32_16x16x32_bf16 v[180:183], v[52:55], v[76:79], v[180:183]
    s_mov_b32 s69, s23
    s_mov_b32 s70, 0x800000
    v_mfma_f32_16x16x32_bf16 v[184:187], v[24:27], v[80:83], 0
    s_mov_b32 s71, 0x20000
    v_lshlrev_b32 v3, 12, v2
    v_mfma_f32_16x16x32_bf16 v[184:187], v[28:31], v[84:87], v[184:187]
    v_lshl_add_u32 v16, v1, 4, v3
    s_lshl_b32 s45, s36, 18
    v_mfma_f32_16x16x32_bf16 v[188:191], v[32:35], v[80:83], 0
    s_lshl_b32 s46, s3, 16
    s_add_u32 s45, s45, s46
    v_mfma_f32_16x16x32_bf16 v[188:191], v[36:39], v[84:87], v[188:191]
    s_lshl_b32 s46, s37, 8
    s_sub_u32 s45, s45, s46
    v_mfma_f32_16x16x32_bf16 v[192:195], v[40:43], v[80:83], 0
    s_add_u32 s45, s45, 3840
    v_add_u32 v16, s45, v16
    v_mfma_f32_16x16x32_bf16 v[192:195], v[44:47], v[84:87], v[192:195]
    s_lshl_b32 s45, s3, 12
    s_add_u32 s45, s45, 139776
    v_mfma_f32_16x16x32_bf16 v[196:199], v[48:51], v[80:83], 0
    v_add_u32 v1, s45, v5
    s_lshl_b32 s45, s40, 6
    v_mfma_f32_16x16x32_bf16 v[196:199], v[52:55], v[84:87], v[196:199]
    v_xor_b32 v1, s45, v1
    v_xor_b32 v2, 16, v1
    v_mfma_f32_16x16x32_bf16 v[104:107], v[88:91], v[24:27], 0
    v_xor_b32 v3, 32, v1
    v_xor_b32 v6, 48, v1
    v_mfma_f32_16x16x32_bf16 v[104:107], v[92:95], v[28:31], v[104:107]
    s_movk_i32 s57, 0x4000
    s_mov_b32 s58, 0x8000
    v_mfma_f32_16x16x32_bf16 v[112:115], v[88:91], v[32:35], 0
    s_mov_b32 s59, 0xc000
    s_lshl_b32 s43, s36, 2
    v_mfma_f32_16x16x32_bf16 v[112:115], v[92:95], v[36:39], v[112:115]
    s_add_u32 s43, s43, s3
    s_lshl_b32 s43, s43, 4
    v_mfma_f32_16x16x32_bf16 v[120:123], v[88:91], v[40:43], 0
    s_add_u32 s43, s43, s37
    s_lshl_b32 s43, s43, 2
    v_mfma_f32_16x16x32_bf16 v[120:123], v[92:95], v[44:47], v[120:123]
    s_lshr_b32 vcc_lo, s43, 6
    s_mul_i32 vcc_lo, vcc_lo, 1984
    v_mfma_f32_16x16x32_bf16 v[128:131], v[88:91], v[48:51], 0
    s_add_u32 s43, s43, vcc_lo
    s_add_u32 s43, s43, 0x940000
    v_mfma_f32_16x16x32_bf16 v[128:131], v[92:95], v[52:55], v[128:131]
    s_movk_i32 s42, 5
    v_mfma_f32_16x16x32_bf16 v[108:111], v[96:99], v[24:27], 0
    v_mfma_f32_16x16x32_bf16 v[108:111], v[100:103], v[28:31], v[108:111]
    v_mfma_f32_16x16x32_bf16 v[116:119], v[96:99], v[32:35], 0
    v_mfma_f32_16x16x32_bf16 v[116:119], v[100:103], v[36:39], v[116:119]
    v_mfma_f32_16x16x32_bf16 v[124:127], v[96:99], v[40:43], 0
    v_mfma_f32_16x16x32_bf16 v[124:127], v[100:103], v[44:47], v[124:127]
    v_mfma_f32_16x16x32_bf16 v[132:135], v[96:99], v[48:51], 0
    v_mfma_f32_16x16x32_bf16 v[132:135], v[100:103], v[52:55], v[132:135]
    s_waitcnt vmcnt(10)
    v_lshlrev_b32 v24, 16, v200
    v_and_b32 v25, s56, v200
    v_lshlrev_b32 v26, 16, v201
    v_and_b32 v27, s56, v201
    v_lshlrev_b32 v28, 16, v202
    v_and_b32 v29, s56, v202
    v_lshlrev_b32 v30, 16, v203
    v_and_b32 v31, s56, v203
    v_lshlrev_b32 v32, 16, v204
    v_and_b32 v33, s56, v204
    v_lshlrev_b32 v34, 16, v205
    v_and_b32 v35, s56, v205
    v_lshlrev_b32 v36, 16, v206
    v_and_b32 v37, s56, v206
    v_lshlrev_b32 v38, 16, v207
    v_and_b32 v39, s56, v207
    v_lshlrev_b32 v40, 16, v208
    v_and_b32 v41, s56, v208
    v_lshlrev_b32 v42, 16, v209
    v_and_b32 v43, s56, v209
    v_lshlrev_b32 v44, 16, v210
    v_and_b32 v45, s56, v210
    v_lshlrev_b32 v46, 16, v211
    v_and_b32 v47, s56, v211
    v_lshlrev_b32 v48, 16, v212
    v_and_b32 v49, s56, v212
    v_lshlrev_b32 v50, 16, v213
    v_and_b32 v51, s56, v213
    v_lshlrev_b32 v52, 16, v214
    v_and_b32 v53, s56, v214
    v_lshlrev_b32 v54, 16, v215
    v_and_b32 v55, s56, v215
    v_lshlrev_b32 v56, 16, v216
    v_and_b32 v57, s56, v216
    v_lshlrev_b32 v58, 16, v217
    v_and_b32 v59, s56, v217
    v_lshlrev_b32 v60, 16, v218
    v_and_b32 v61, s56, v218
    v_lshlrev_b32 v62, 16, v219
    v_and_b32 v63, s56, v219
    v_lshlrev_b32 v64, 16, v220
    v_and_b32 v65, s56, v220
    v_lshlrev_b32 v66, 16, v221
    v_and_b32 v67, s56, v221
    s_waitcnt vmcnt(8)
    v_lshlrev_b32 v68, 16, v242
    v_and_b32 v72, s56, v242
    v_lshlrev_b32 v76, 16, v243
    v_and_b32 v80, s56, v243
    v_lshlrev_b32 v69, 16, v244
    v_and_b32 v73, s56, v244
    v_lshlrev_b32 v77, 16, v245
    v_and_b32 v81, s56, v245
    v_lshlrev_b32 v70, 16, v246
    v_and_b32 v74, s56, v246
    v_lshlrev_b32 v78, 16, v247
    v_and_b32 v82, s56, v247
    v_lshlrev_b32 v71, 16, v248
    v_and_b32 v75, s56, v248
    v_lshlrev_b32 v79, 16, v249
    v_and_b32 v83, s56, v249
    v_pk_mul_f32 v[84:85], v[36:37], v[68:69]
    v_pk_mul_f32 v[86:87], v[38:39], v[70:71]
    v_pk_mul_f32 v[88:89], v[40:41], v[68:69]
    v_pk_mul_f32 v[90:91], v[42:43], v[70:71]
    v_pk_fma_f32 v[84:85], v[32:33], v[72:73], v[84:85]
    v_pk_fma_f32 v[86:87], v[34:35], v[74:75], v[86:87]
    v_pk_fma_f32 v[88:89], v[36:37], v[72:73], v[88:89]
    v_pk_fma_f32 v[90:91], v[38:39], v[74:75], v[90:91]
    v_pk_fma_f32 v[84:85], v[28:29], v[76:77], v[84:85]
    v_pk_fma_f32 v[86:87], v[30:31], v[78:79], v[86:87]
    v_pk_fma_f32 v[88:89], v[32:33], v[76:77], v[88:89]
    v_pk_fma_f32 v[90:91], v[34:35], v[78:79], v[90:91]
    v_pk_fma_f32 v[24:25], v[24:25], v[80:81], v[84:85]
    v_pk_fma_f32 v[26:27], v[26:27], v[82:83], v[86:87]
    v_pk_fma_f32 v[28:29], v[28:29], v[80:81], v[88:89]
    v_pk_fma_f32 v[30:31], v[30:31], v[82:83], v[90:91]
    v_pk_mul_f32 v[84:85], v[44:45], v[68:69]
    v_pk_mul_f32 v[86:87], v[46:47], v[70:71]
    v_pk_mul_f32 v[88:89], v[48:49], v[68:69]
    v_pk_mul_f32 v[90:91], v[50:51], v[70:71]
    v_pk_fma_f32 v[84:85], v[40:41], v[72:73], v[84:85]
    v_pk_fma_f32 v[86:87], v[42:43], v[74:75], v[86:87]
    v_pk_fma_f32 v[88:89], v[44:45], v[72:73], v[88:89]
    v_pk_fma_f32 v[90:91], v[46:47], v[74:75], v[90:91]
    v_pk_fma_f32 v[84:85], v[36:37], v[76:77], v[84:85]
    v_pk_fma_f32 v[86:87], v[38:39], v[78:79], v[86:87]
    v_pk_fma_f32 v[88:89], v[40:41], v[76:77], v[88:89]
    v_pk_fma_f32 v[90:91], v[42:43], v[78:79], v[90:91]
    v_pk_fma_f32 v[32:33], v[32:33], v[80:81], v[84:85]
    v_pk_fma_f32 v[34:35], v[34:35], v[82:83], v[86:87]
    v_pk_fma_f32 v[36:37], v[36:37], v[80:81], v[88:89]
    v_pk_fma_f32 v[38:39], v[38:39], v[82:83], v[90:91]
    v_pk_mul_f32 v[84:85], v[52:53], v[68:69]
    v_pk_mul_f32 v[86:87], v[54:55], v[70:71]
    v_pk_mul_f32 v[88:89], v[56:57], v[68:69]
    v_pk_mul_f32 v[90:91], v[58:59], v[70:71]
    v_pk_fma_f32 v[84:85], v[48:49], v[72:73], v[84:85]
    v_pk_fma_f32 v[86:87], v[50:51], v[74:75], v[86:87]
    v_pk_fma_f32 v[88:89], v[52:53], v[72:73], v[88:89]
    v_pk_fma_f32 v[90:91], v[54:55], v[74:75], v[90:91]
    v_pk_fma_f32 v[84:85], v[44:45], v[76:77], v[84:85]
    v_pk_fma_f32 v[86:87], v[46:47], v[78:79], v[86:87]
    v_pk_fma_f32 v[88:89], v[48:49], v[76:77], v[88:89]
    v_pk_fma_f32 v[90:91], v[50:51], v[78:79], v[90:91]
    v_pk_fma_f32 v[40:41], v[40:41], v[80:81], v[84:85]
    v_pk_fma_f32 v[42:43], v[42:43], v[82:83], v[86:87]
    v_pk_fma_f32 v[44:45], v[44:45], v[80:81], v[88:89]
    v_pk_fma_f32 v[46:47], v[46:47], v[82:83], v[90:91]
    v_pk_mul_f32 v[84:85], v[60:61], v[68:69]
    v_pk_mul_f32 v[86:87], v[62:63], v[70:71]
    v_pk_mul_f32 v[88:89], v[64:65], v[68:69]
    v_pk_mul_f32 v[90:91], v[66:67], v[70:71]
    v_pk_fma_f32 v[84:85], v[56:57], v[72:73], v[84:85]
    v_pk_fma_f32 v[86:87], v[58:59], v[74:75], v[86:87]
    v_pk_fma_f32 v[88:89], v[60:61], v[72:73], v[88:89]
    v_pk_fma_f32 v[90:91], v[62:63], v[74:75], v[90:91]
    v_pk_fma_f32 v[84:85], v[52:53], v[76:77], v[84:85]
    v_pk_fma_f32 v[86:87], v[54:55], v[78:79], v[86:87]
    v_pk_fma_f32 v[88:89], v[56:57], v[76:77], v[88:89]
    v_pk_fma_f32 v[90:91], v[58:59], v[78:79], v[90:91]
    v_pk_fma_f32 v[48:49], v[48:49], v[80:81], v[84:85]
    v_pk_fma_f32 v[50:51], v[50:51], v[82:83], v[86:87]
    v_pk_fma_f32 v[52:53], v[52:53], v[80:81], v[88:89]
    v_pk_fma_f32 v[54:55], v[54:55], v[82:83], v[90:91]
    s_waitcnt vmcnt(0)
    v_lshlrev_b32 v56, 16, v222
    v_and_b32 v57, s56, v222
    v_lshlrev_b32 v58, 16, v223
    v_and_b32 v59, s56, v223
    v_lshlrev_b32 v60, 16, v224
    v_and_b32 v61, s56, v224
    v_lshlrev_b32 v62, 16, v225
    v_and_b32 v63, s56, v225
    v_lshlrev_b32 v64, 16, v226
    v_and_b32 v65, s56, v226
    v_lshlrev_b32 v66, 16, v227
    v_and_b32 v67, s56, v227
    v_lshlrev_b32 v68, 16, v228
    v_and_b32 v69, s56, v228
    v_lshlrev_b32 v70, 16, v229
    v_and_b32 v71, s56, v229
    v_lshlrev_b32 v72, 16, v230
    v_and_b32 v73, s56, v230
    v_lshlrev_b32 v74, 16, v231
    v_and_b32 v75, s56, v231
    v_lshlrev_b32 v76, 16, v236
    v_and_b32 v77, s56, v236
    v_lshlrev_b32 v78, 16, v237
    v_and_b32 v79, s56, v237
    v_lshlrev_b32 v80, 16, v238
    v_and_b32 v81, s56, v238
    v_lshlrev_b32 v82, 16, v239
    v_and_b32 v83, s56, v239
    v_lshlrev_b32 v84, 16, v240
    v_and_b32 v85, s56, v240
    v_lshlrev_b32 v86, 16, v241
    v_and_b32 v87, s56, v241
    v_pk_mul_f32 v[24:25], v[24:25], v[56:57]
    v_pk_mul_f32 v[28:29], v[28:29], v[60:61]
    v_pk_mul_f32 v[32:33], v[32:33], v[64:65]
    v_pk_mul_f32 v[36:37], v[36:37], v[68:69]
    v_pk_mul_f32 v[40:41], v[40:41], v[72:73]
    v_pk_mul_f32 v[44:45], v[44:45], v[76:77]
    v_pk_mul_f32 v[48:49], v[48:49], v[80:81]
    v_pk_mul_f32 v[52:53], v[52:53], v[84:85]
    v_cvt_pk_bf16_f32 v200, v52, v48
    v_cvt_pk_bf16_f32 v201, v44, v40
    v_cvt_pk_bf16_f32 v202, v36, v32
    v_cvt_pk_bf16_f32 v203, v28, v24
    ds_write_b128 v19, v[200:203] offset:0
    v_cvt_pk_bf16_f32 v204, v53, v49
    v_cvt_pk_bf16_f32 v205, v45, v41
    v_cvt_pk_bf16_f32 v206, v37, v33
    v_cvt_pk_bf16_f32 v207, v29, v25
    ds_write_b128 v19, v[204:207] offset:256
    v_pk_mul_f32 v[26:27], v[26:27], v[58:59]
    v_pk_mul_f32 v[30:31], v[30:31], v[62:63]
    v_pk_mul_f32 v[34:35], v[34:35], v[66:67]
    v_pk_mul_f32 v[38:39], v[38:39], v[70:71]
    v_pk_mul_f32 v[42:43], v[42:43], v[74:75]
    v_pk_mul_f32 v[46:47], v[46:47], v[78:79]
    v_pk_mul_f32 v[50:51], v[50:51], v[82:83]
    v_pk_mul_f32 v[54:55], v[54:55], v[86:87]
    v_cvt_pk_bf16_f32 v208, v54, v50
    v_cvt_pk_bf16_f32 v209, v46, v42
    v_cvt_pk_bf16_f32 v210, v38, v34
    v_cvt_pk_bf16_f32 v211, v30, v26
    ds_write_b128 v19, v[208:211] offset:512
    v_cvt_pk_bf16_f32 v212, v55, v51
    v_cvt_pk_bf16_f32 v213, v47, v43
    v_cvt_pk_bf16_f32 v214, v39, v35
    v_cvt_pk_bf16_f32 v215, v31, v27
    ds_write_b128 v19, v[212:215] offset:768
    s_waitcnt lgkmcnt(0)
    s_barrier
    ds_read_b128 v[24:27], v10 offset:0
    ds_read_b128 v[28:31], v11 offset:0
    ds_read_b64_tr_b16 v[56:57], v14 offset:8192
    ds_read_b64_tr_b16 v[58:59], v14 offset:8704
    ds_read_b64_tr_b16 v[60:61], v14 offset:12288
    ds_read_b64_tr_b16 v[62:63], v14 offset:12800
    ds_read_b128 v[32:35], v10 offset:2048
    ds_read_b128 v[36:39], v11 offset:2048
    ds_read_b128 v[40:43], v10 offset:4096
    ds_read_b128 v[44:47], v11 offset:4096
    ds_read_b128 v[48:51], v10 offset:6144
    ds_read_b128 v[52:55], v11 offset:6144
    s_waitcnt lgkmcnt(6)
    ds_read_b64_tr_b16 v[64:65], v15 offset:8192
    ds_read_b64_tr_b16 v[66:67], v15 offset:8704
    ds_read_b64_tr_b16 v[68:69], v15 offset:12288
    ds_read_b64_tr_b16 v[70:71], v15 offset:12800
    ds_read_b64_tr_b16 v[72:73], v17 offset:16384
    ds_read_b64_tr_b16 v[74:75], v17 offset:16896
    ds_read_b64_tr_b16 v[76:77], v17 offset:20480
    ds_read_b64_tr_b16 v[78:79], v17 offset:20992
    s_waitcnt lgkmcnt(8)
    ds_read_b64_tr_b16 v[80:81], v18 offset:16384
    ds_read_b64_tr_b16 v[82:83], v18 offset:16896
    ds_read_b64_tr_b16 v[84:85], v18 offset:20480
    ds_read_b64_tr_b16 v[86:87], v18 offset:20992
    ds_read_b64_tr_b16 v[88:89], v14 offset:0
    ds_read_b64_tr_b16 v[90:91], v14 offset:512
    ds_read_b64_tr_b16 v[92:93], v14 offset:4096
    ds_read_b64_tr_b16 v[94:95], v14 offset:4608
    s_waitcnt lgkmcnt(8)
    ds_read_b128 v[236:239], v1 offset:0
    ds_read_b128 v[240:243], v2 offset:1024
    ds_read_b128 v[244:247], v3 offset:2048
    ds_read_b128 v[248:251], v6 offset:3072
    s_branch L_loop1
L_side:
    s_cmp_eq_u32 s53, 0
    s_cbranch_scc0 L_side2
    buffer_store_dwordx4 v[236:239], v16, s[60:63], 0 offen sc1
    buffer_store_dwordx4 v[240:243], v16, s[60:63], s57 offen sc1
    buffer_store_dwordx4 v[244:247], v16, s[60:63], s58 offen sc1
    buffer_store_dwordx4 v[248:251], v16, s[60:63], s59 offen sc1
    s_branch L_back
L_side2:
    v_readfirstlane_b32 s72, v234
    s_mov_b32 s45, 0
    s_waitcnt vmcnt(0)
    s_cmp_lg_u32 s72, 0
    s_cbranch_scc1 L_cepok
L_cep:
    ds_read_b32 v234, v20 offset:56
    s_add_u32 s45, s45, 1
    s_waitcnt lgkmcnt(0)
    v_readfirstlane_b32 s72, v234
    s_cmp_gt_u32 s45, 0x40000
    s_cbranch_scc1 L_cepok
    s_cmp_eq_u32 s72, 0
    s_cbranch_scc1 L_cep
L_cepok:
    s_mov_b32 s73, s72
    s_mov_b64 exec, 0xffff
    buffer_store_dword v234, v254, s[60:63], s43 offen sc1
    s_mov_b64 exec, -1
    s_branch L_back

L_loop1:
    v_mfma_f32_16x16x32_bf16 v[136:139], v[24:27], v[56:59], v[136:139]
    ds_read_b64_tr_b16 v[96:97], v15 offset:0
    v_mfma_f32_16x16x32_bf16 v[136:139], v[28:31], v[60:63], v[136:139]
    ds_read_b64_tr_b16 v[98:99], v15 offset:512
    v_mfma_f32_16x16x32_bf16 v[140:143], v[32:35], v[56:59], v[140:143]
    ds_read_b64_tr_b16 v[100:101], v15 offset:4096
    v_mfma_f32_16x16x32_bf16 v[140:143], v[36:39], v[60:63], v[140:143]
    ds_read_b64_tr_b16 v[102:103], v15 offset:4608
    v_mfma_f32_16x16x32_bf16 v[144:147], v[40:43], v[56:59], v[144:147]
    s_add_u32 s52, s52, 40960
    s_cmp_eq_u32 s52, 122880
    s_cselect_b32 s52, 0, s52
    v_mfma_f32_16x16x32_bf16 v[144:147], v[44:47], v[60:63], v[144:147]
    v_add_u32 v10, s52, v8
    v_add_u32 v11, s52, v9
    v_mfma_f32_16x16x32_bf16 v[148:151], v[48:51], v[56:59], v[148:151]
    v_add_u32 v14, s52, v12
    v_add_u32 v15, s52, v13
    v_mfma_f32_16x16x32_bf16 v[148:151], v[52:55], v[60:63], v[148:151]
    v_xor_b32 v17, s39, v14
    v_xor_b32 v18, s39, v15
    s_waitcnt lgkmcnt(0)
    v_mfma_f32_16x16x32_bf16 v[152:155], v[24:27], v[64:67], v[152:155]
    s_barrier
    v_mfma_f32_16x16x32_bf16 v[152:155], v[28:31], v[68:71], v[152:155]
    ds_read_b64_tr_b16 v[56:57], v14 offset:8192
    v_mfma_f32_16x16x32_bf16 v[156:159], v[32:35], v[64:67], v[156:159]
    ds_read_b64_tr_b16 v[58:59], v14 offset:8704
    v_mfma_f32_16x16x32_bf16 v[156:159], v[36:39], v[68:71], v[156:159]
    ds_read_b64_tr_b16 v[60:61], v14 offset:12288
    v_mfma_f32_16x16x32_bf16 v[160:163], v[40:43], v[64:67], v[160:163]
    ds_read_b64_tr_b16 v[62:63], v14 offset:12800
    v_mfma_f32_16x16x32_bf16 v[160:163], v[44:47], v[68:71], v[160:163]
    ds_read_b128 v[200:203], v10 offset:0
    v_mfma_f32_16x16x32_bf16 v[164:167], v[48:51], v[64:67], v[164:167]
    ds_read_b128 v[204:207], v11 offset:0
    v_mfma_f32_16x16x32_bf16 v[164:167], v[52:55], v[68:71], v[164:167]
    ds_read_b128 v[208:211], v10 offset:2048
    v_mfma_f32_16x16x32_bf16 v[168:171], v[24:27], v[72:75], v[168:171]
    ds_read_b64_tr_b16 v[64:65], v15 offset:8192
    v_mfma_f32_16x16x32_bf16 v[168:171], v[28:31], v[76:79], v[168:171]
    ds_read_b64_tr_b16 v[66:67], v15 offset:8704
    v_mfma_f32_16x16x32_bf16 v[172:175], v[32:35], v[72:75], v[172:175]
    ds_read_b64_tr_b16 v[68:69], v15 offset:12288
    v_mfma_f32_16x16x32_bf16 v[172:175], v[36:39], v[76:79], v[172:175]
    ds_read_b64_tr_b16 v[70:71], v15 offset:12800
    v_mfma_f32_16x16x32_bf16 v[176:179], v[40:43], v[72:75], v[176:179]
    ds_read_b128 v[212:215], v11 offset:2048
    v_mfma_f32_16x16x32_bf16 v[176:179], v[44:47], v[76:79], v[176:179]
    ds_read_b128 v[216:219], v10 offset:4096
    v_mfma_f32_16x16x32_bf16 v[180:183], v[48:51], v[72:75], v[180:183]
    ds_read_b128 v[220:223], v11 offset:4096
    v_mfma_f32_16x16x32_bf16 v[180:183], v[52:55], v[76:79], v[180:183]
    ds_read_b128 v[224:227], v10 offset:6144
    v_mfma_f32_16x16x32_bf16 v[184:187], v[24:27], v[80:83], v[184:187]
    ds_read_b64_tr_b16 v[72:73], v17 offset:16384
    v_mfma_f32_16x16x32_bf16 v[184:187], v[28:31], v[84:87], v[184:187]
    ds_read_b64_tr_b16 v[74:75], v17 offset:16896
    v_mfma_f32_16x16x32_bf16 v[188:191], v[32:35], v[80:83], v[188:191]
    ds_read_b64_tr_b16 v[76:77], v17 offset:20480
    v_mfma_f32_16x16x32_bf16 v[188:191], v[36:39], v[84:87], v[188:191]
    ds_read_b64_tr_b16 v[78:79], v17 offset:20992
    v_mfma_f32_16x16x32_bf16 v[192:195], v[40:43], v[80:83], v[192:195]
    ds_read_b128 v[228:231], v11 offset:6144
    v_mfma_f32_16x16x32_bf16 v[192:195], v[44:47], v[84:87], v[192:195]
    s_bitcmp1_b32 s42, s53
    v_mfma_f32_16x16x32_bf16 v[196:199], v[48:51], v[80:83], v[196:199]
    s_cbranch_scc1 L_side
L_back:
    v_mfma_f32_16x16x32_bf16 v[196:199], v[52:55], v[84:87], v[196:199]
    v_mfma_f32_16x16x32_bf16 v[104:107], v[88:91], v[24:27], v[104:107]
    ds_read_b64_tr_b16 v[80:81], v18 offset:16384
    v_mfma_f32_16x16x32_bf16 v[104:107], v[92:95], v[28:31], v[104:107]
    ds_read_b64_tr_b16 v[82:83], v18 offset:16896
    v_mfma_f32_16x16x32_bf16 v[112:115], v[88:91], v[32:35], v[112:115]
    ds_read_b64_tr_b16 v[84:85], v18 offset:20480
    v_mfma_f32_16x16x32_bf16 v[112:115], v[92:95], v[36:39], v[112:115]
    ds_read_b64_tr_b16 v[86:87], v18 offset:20992
    v_mfma_f32_16x16x32_bf16 v[120:123], v[88:91], v[40:43], v[120:123]
    ds_read_b32 v234, v20 offset:56
    v_mfma_f32_16x16x32_bf16 v[120:123], v[92:95], v[44:47], v[120:123]
    v_mfma_f32_16x16x32_bf16 v[128:131], v[88:91], v[48:51], v[128:131]
    v_mfma_f32_16x16x32_bf16 v[128:131], v[92:95], v[52:55], v[128:131]
    v_mfma_f32_16x16x32_bf16 v[108:111], v[96:99], v[24:27], v[108:111]
    s_waitcnt lgkmcnt(4)
    ds_read_b64_tr_b16 v[88:89], v14 offset:0
    v_mfma_f32_16x16x32_bf16 v[108:111], v[100:103], v[28:31], v[108:111]
    ds_read_b64_tr_b16 v[90:91], v14 offset:512
    v_mfma_f32_16x16x32_bf16 v[116:119], v[96:99], v[32:35], v[116:119]
    ds_read_b64_tr_b16 v[92:93], v14 offset:4096
    v_mfma_f32_16x16x32_bf16 v[116:119], v[100:103], v[36:39], v[116:119]
    ds_read_b64_tr_b16 v[94:95], v14 offset:4608
    v_mfma_f32_16x16x32_bf16 v[124:127], v[96:99], v[40:43], v[124:127]
    v_mfma_f32_16x16x32_bf16 v[124:127], v[100:103], v[44:47], v[124:127]
    v_mfma_f32_16x16x32_bf16 v[132:135], v[96:99], v[48:51], v[132:135]
    v_mfma_f32_16x16x32_bf16 v[132:135], v[100:103], v[52:55], v[132:135]
    v_mfma_f32_16x16x32_bf16 v[136:139], v[200:203], v[56:59], v[136:139]
    ds_read_b64_tr_b16 v[96:97], v15 offset:0
    v_mfma_f32_16x16x32_bf16 v[136:139], v[204:207], v[60:63], v[136:139]
    ds_read_b64_tr_b16 v[98:99], v15 offset:512
    v_mfma_f32_16x16x32_bf16 v[140:143], v[208:211], v[56:59], v[140:143]
    ds_read_b64_tr_b16 v[100:101], v15 offset:4096
    v_mfma_f32_16x16x32_bf16 v[140:143], v[212:215], v[60:63], v[140:143]
    ds_read_b64_tr_b16 v[102:103], v15 offset:4608
    v_mfma_f32_16x16x32_bf16 v[144:147], v[216:219], v[56:59], v[144:147]
    s_add_u32 s52, s52, 40960
    s_cmp_eq_u32 s52, 122880
    s_cselect_b32 s52, 0, s52
    v_mfma_f32_16x16x32_bf16 v[144:147], v[220:223], v[60:63], v[144:147]
    v_add_u32 v10, s52, v8
    v_add_u32 v11, s52, v9
    v_mfma_f32_16x16x32_bf16 v[148:151], v[224:227], v[56:59], v[148:151]
    v_add_u32 v14, s52, v12
    v_add_u32 v15, s52, v13
    v_mfma_f32_16x16x32_bf16 v[148:151], v[228:231], v[60:63], v[148:151]
    v_xor_b32 v17, s39, v14
    v_xor_b32 v18, s39, v15
    s_waitcnt lgkmcnt(0)
    v_mfma_f32_16x16x32_bf16 v[152:155], v[200:203], v[64:67], v[152:155]
    s_barrier
    v_mfma_f32_16x16x32_bf16 v[152:155], v[204:207], v[68:71], v[152:155]
    ds_read_b64_tr_b16 v[56:57], v14 offset:8192
    v_mfma_f32_16x16x32_bf16 v[156:159], v[208:211], v[64:67], v[156:159]
    ds_read_b64_tr_b16 v[58:59], v14 offset:8704
    v_mfma_f32_16x16x32_bf16 v[156:159], v[212:215], v[68:71], v[156:159]
    ds_read_b64_tr_b16 v[60:61], v14 offset:12288
    v_mfma_f32_16x16x32_bf16 v[160:163], v[216:219], v[64:67], v[160:163]
    ds_read_b64_tr_b16 v[62:63], v14 offset:12800
    v_mfma_f32_16x16x32_bf16 v[160:163], v[220:223], v[68:71], v[160:163]
    ds_read_b128 v[24:27], v10 offset:0
    v_mfma_f32_16x16x32_bf16 v[164:167], v[224:227], v[64:67], v[164:167]
    ds_read_b128 v[28:31], v11 offset:0
    v_mfma_f32_16x16x32_bf16 v[164:167], v[228:231], v[68:71], v[164:167]
    ds_read_b128 v[32:35], v10 offset:2048
    v_mfma_f32_16x16x32_bf16 v[168:171], v[200:203], v[72:75], v[168:171]
    ds_read_b64_tr_b16 v[64:65], v15 offset:8192
    v_mfma_f32_16x16x32_bf16 v[168:171], v[204:207], v[76:79], v[168:171]
    ds_read_b64_tr_b16 v[66:67], v15 offset:8704
    v_mfma_f32_16x16x32_bf16 v[172:175], v[208:211], v[72:75], v[172:175]
    ds_read_b64_tr_b16 v[68:69], v15 offset:12288
    v_mfma_f32_16x16x32_bf16 v[172:175], v[212:215], v[76:79], v[172:175]
    ds_read_b64_tr_b16 v[70:71], v15 offset:12800
    v_mfma_f32_16x16x32_bf16 v[176:179], v[216:219], v[72:75], v[176:179]
    ds_read_b128 v[36:39], v11 offset:2048
    v_mfma_f32_16x16x32_bf16 v[176:179], v[220:223], v[76:79], v[176:179]
    ds_read_b128 v[40:43], v10 offset:4096
    v_mfma_f32_16x16x32_bf16 v[180:183], v[224:227], v[72:75], v[180:183]
    ds_read_b128 v[44:47], v11 offset:4096
    v_mfma_f32_16x16x32_bf16 v[180:183], v[228:231], v[76:79], v[180:183]
    ds_read_b128 v[48:51], v10 offset:6144
    v_mfma_f32_16x16x32_bf16 v[184:187], v[200:203], v[80:83], v[184:187]
    ds_read_b64_tr_b16 v[72:73], v17 offset:16384
    v_mfma_f32_16x16x32_bf16 v[184:187], v[204:207], v[84:87], v[184:187]
    ds_read_b64_tr_b16 v[74:75], v17 offset:16896
    v_mfma_f32_16x16x32_bf16 v[188:191], v[208:211], v[80:83], v[188:191]
    ds_read_b64_tr_b16 v[76:77], v17 offset:20480
    v_mfma_f32_16x16x32_bf16 v[188:191], v[212:215], v[84:87], v[188:191]
    ds_read_b64_tr_b16 v[78:79], v17 offset:20992
    v_mfma_f32_16x16x32_bf16 v[192:195], v[216:219], v[80:83], v[192:195]
    ds_read_b128 v[52:55], v11 offset:6144
    v_mfma_f32_16x16x32_bf16 v[192:195], v[220:223], v[84:87], v[192:195]
    v_mfma_f32_16x16x32_bf16 v[196:199], v[224:227], v[80:83], v[196:199]
    v_mfma_f32_16x16x32_bf16 v[196:199], v[228:231], v[84:87], v[196:199]
    v_mfma_f32_16x16x32_bf16 v[104:107], v[88:91], v[200:203], v[104:107]
    ds_read_b64_tr_b16 v[80:81], v18 offset:16384
    v_mfma_f32_16x16x32_bf16 v[104:107], v[92:95], v[204:207], v[104:107]
    ds_read_b64_tr_b16 v[82:83], v18 offset:16896
    v_mfma_f32_16x16x32_bf16 v[112:115], v[88:91], v[208:211], v[112:115]
    ds_read_b64_tr_b16 v[84:85], v18 offset:20480
    v_mfma_f32_16x16x32_bf16 v[112:115], v[92:95], v[212:215], v[112:115]
    ds_read_b64_tr_b16 v[86:87], v18 offset:20992
    v_mfma_f32_16x16x32_bf16 v[120:123], v[88:91], v[216:219], v[120:123]
    v_mfma_f32_16x16x32_bf16 v[120:123], v[92:95], v[220:223], v[120:123]
    v_mfma_f32_16x16x32_bf16 v[128:131], v[88:91], v[224:227], v[128:131]
    v_mfma_f32_16x16x32_bf16 v[128:131], v[92:95], v[228:231], v[128:131]
    v_mfma_f32_16x16x32_bf16 v[108:111], v[96:99], v[200:203], v[108:111]
    s_waitcnt lgkmcnt(4)
    ds_read_b64_tr_b16 v[88:89], v14 offset:0
    v_mfma_f32_16x16x32_bf16 v[108:111], v[100:103], v[204:207], v[108:111]
    ds_read_b64_tr_b16 v[90:91], v14 offset:512
    v_mfma_f32_16x16x32_bf16 v[116:119], v[96:99], v[208:211], v[116:119]
    ds_read_b64_tr_b16 v[92:93], v14 offset:4096
    v_mfma_f32_16x16x32_bf16 v[116:119], v[100:103], v[212:215], v[116:119]
    ds_read_b64_tr_b16 v[94:95], v14 offset:4608
    v_mfma_f32_16x16x32_bf16 v[124:127], v[96:99], v[216:219], v[124:127]
    s_add_u32 s53, s53, 1
    v_mfma_f32_16x16x32_bf16 v[124:127], v[100:103], v[220:223], v[124:127]
    s_cmp_lt_u32 s53, 6
    v_mfma_f32_16x16x32_bf16 v[132:135], v[96:99], v[224:227], v[132:135]
    v_mfma_f32_16x16x32_bf16 v[132:135], v[100:103], v[228:231], v[132:135]
    s_cbranch_scc1 L_loop1
    v_mfma_f32_16x16x32_bf16 v[136:139], v[24:27], v[56:59], v[136:139]
    ds_read_b64_tr_b16 v[96:97], v15 offset:0
    v_mfma_f32_16x16x32_bf16 v[136:139], v[28:31], v[60:63], v[136:139]
    ds_read_b64_tr_b16 v[98:99], v15 offset:512
    v_mfma_f32_16x16x32_bf16 v[140:143], v[32:35], v[56:59], v[140:143]
    ds_read_b64_tr_b16 v[100:101], v15 offset:4096
    v_mfma_f32_16x16x32_bf16 v[140:143], v[36:39], v[60:63], v[140:143]
    ds_read_b64_tr_b16 v[102:103], v15 offset:4608
    v_mfma_f32_16x16x32_bf16 v[144:147], v[40:43], v[56:59], v[144:147]
    s_add_u32 s52, s52, 40960
    s_cmp_eq_u32 s52, 122880
    s_cselect_b32 s52, 0, s52
    v_mfma_f32_16x16x32_bf16 v[144:147], v[44:47], v[60:63], v[144:147]
    v_add_u32 v10, s52, v8
    v_add_u32 v11, s52, v9
    v_mfma_f32_16x16x32_bf16 v[148:151], v[48:51], v[56:59], v[148:151]
    v_add_u32 v14, s52, v12
    v_add_u32 v15, s52, v13
    v_mfma_f32_16x16x32_bf16 v[148:151], v[52:55], v[60:63], v[148:151]
    v_xor_b32 v17, s39, v14
    v_xor_b32 v18, s39, v15
    s_waitcnt lgkmcnt(0)
    v_mfma_f32_16x16x32_bf16 v[152:155], v[24:27], v[64:67], v[152:155]
    s_barrier
    v_mfma_f32_16x16x32_bf16 v[152:155], v[28:31], v[68:71], v[152:155]
    ds_read_b64_tr_b16 v[56:57], v14 offset:8192
    v_mfma_f32_16x16x32_bf16 v[156:159], v[32:35], v[64:67], v[156:159]
    ds_read_b64_tr_b16 v[58:59], v14 offset:8704
    v_mfma_f32_16x16x32_bf16 v[156:159], v[36:39], v[68:71], v[156:159]
    ds_read_b64_tr_b16 v[60:61], v14 offset:12288
    v_mfma_f32_16x16x32_bf16 v[160:163], v[40:43], v[64:67], v[160:163]
    ds_read_b64_tr_b16 v[62:63], v14 offset:12800
    v_mfma_f32_16x16x32_bf16 v[160:163], v[44:47], v[68:71], v[160:163]
    ds_read_b128 v[200:203], v10 offset:0
    v_mfma_f32_16x16x32_bf16 v[164:167], v[48:51], v[64:67], v[164:167]
    ds_read_b128 v[204:207], v11 offset:0
    v_mfma_f32_16x16x32_bf16 v[164:167], v[52:55], v[68:71], v[164:167]
    ds_read_b128 v[208:211], v10 offset:2048
    v_mfma_f32_16x16x32_bf16 v[168:171], v[24:27], v[72:75], v[168:171]
    ds_read_b64_tr_b16 v[64:65], v15 offset:8192
    v_mfma_f32_16x16x32_bf16 v[168:171], v[28:31], v[76:79], v[168:171]
    ds_read_b64_tr_b16 v[66:67], v15 offset:8704
    v_mfma_f32_16x16x32_bf16 v[172:175], v[32:35], v[72:75], v[172:175]
    ds_read_b64_tr_b16 v[68:69], v15 offset:12288
    v_mfma_f32_16x16x32_bf16 v[172:175], v[36:39], v[76:79], v[172:175]
    ds_read_b64_tr_b16 v[70:71], v15 offset:12800
    v_mfma_f32_16x16x32_bf16 v[176:179], v[40:43], v[72:75], v[176:179]
    ds_read_b128 v[212:215], v11 offset:2048
    v_mfma_f32_16x16x32_bf16 v[176:179], v[44:47], v[76:79], v[176:179]
    ds_read_b128 v[216:219], v10 offset:4096
    v_mfma_f32_16x16x32_bf16 v[180:183], v[48:51], v[72:75], v[180:183]
    ds_read_b128 v[220:223], v11 offset:4096
    v_mfma_f32_16x16x32_bf16 v[180:183], v[52:55], v[76:79], v[180:183]
    ds_read_b128 v[224:227], v10 offset:6144
    v_mfma_f32_16x16x32_bf16 v[184:187], v[24:27], v[80:83], v[184:187]
    ds_read_b64_tr_b16 v[72:73], v17 offset:16384
    v_mfma_f32_16x16x32_bf16 v[184:187], v[28:31], v[84:87], v[184:187]
    ds_read_b64_tr_b16 v[74:75], v17 offset:16896
    v_mfma_f32_16x16x32_bf16 v[188:191], v[32:35], v[80:83], v[188:191]
    ds_read_b64_tr_b16 v[76:77], v17 offset:20480
    v_mfma_f32_16x16x32_bf16 v[188:191], v[36:39], v[84:87], v[188:191]
    ds_read_b64_tr_b16 v[78:79], v17 offset:20992
    v_mfma_f32_16x16x32_bf16 v[192:195], v[40:43], v[80:83], v[192:195]
    ds_read_b128 v[228:231], v11 offset:6144
    v_mfma_f32_16x16x32_bf16 v[192:195], v[44:47], v[84:87], v[192:195]
    v_mfma_f32_16x16x32_bf16 v[196:199], v[48:51], v[80:83], v[196:199]
    v_mfma_f32_16x16x32_bf16 v[196:199], v[52:55], v[84:87], v[196:199]
    v_mfma_f32_16x16x32_bf16 v[104:107], v[88:91], v[24:27], v[104:107]
    ds_read_b64_tr_b16 v[80:81], v18 offset:16384
    v_mfma_f32_16x16x32_bf16 v[104:107], v[92:95], v[28:31], v[104:107]
    ds_read_b64_tr_b16 v[82:83], v18 offset:16896
    v_mfma_f32_16x16x32_bf16 v[112:115], v[88:91], v[32:35], v[112:115]
    ds_read_b64_tr_b16 v[84:85], v18 offset:20480
    v_mfma_f32_16x16x32_bf16 v[112:115], v[92:95], v[36:39], v[112:115]
    ds_read_b64_tr_b16 v[86:87], v18 offset:20992
    v_mfma_f32_16x16x32_bf16 v[120:123], v[88:91], v[40:43], v[120:123]
    v_mfma_f32_16x16x32_bf16 v[120:123], v[92:95], v[44:47], v[120:123]
    v_mfma_f32_16x16x32_bf16 v[128:131], v[88:91], v[48:51], v[128:131]
    v_mfma_f32_16x16x32_bf16 v[128:131], v[92:95], v[52:55], v[128:131]
    v_mfma_f32_16x16x32_bf16 v[108:111], v[96:99], v[24:27], v[108:111]
    s_waitcnt lgkmcnt(4)
    ds_read_b64_tr_b16 v[88:89], v14 offset:0
    v_mfma_f32_16x16x32_bf16 v[108:111], v[100:103], v[28:31], v[108:111]
    ds_read_b64_tr_b16 v[90:91], v14 offset:512
    v_mfma_f32_16x16x32_bf16 v[116:119], v[96:99], v[32:35], v[116:119]
    ds_read_b64_tr_b16 v[92:93], v14 offset:4096
    v_mfma_f32_16x16x32_bf16 v[116:119], v[100:103], v[36:39], v[116:119]
    ds_read_b64_tr_b16 v[94:95], v14 offset:4608
    v_mfma_f32_16x16x32_bf16 v[124:127], v[96:99], v[40:43], v[124:127]
    v_mfma_f32_16x16x32_bf16 v[124:127], v[100:103], v[44:47], v[124:127]
    v_mfma_f32_16x16x32_bf16 v[132:135], v[96:99], v[48:51], v[132:135]
    v_mfma_f32_16x16x32_bf16 v[132:135], v[100:103], v[52:55], v[132:135]
    v_mfma_f32_16x16x32_bf16 v[136:139], v[200:203], v[56:59], v[136:139]
    ds_read_b64_tr_b16 v[96:97], v15 offset:0
    v_mfma_f32_16x16x32_bf16 v[136:139], v[204:207], v[60:63], v[136:139]
    ds_read_b64_tr_b16 v[98:99], v15 offset:512
    v_mfma_f32_16x16x32_bf16 v[140:143], v[208:211], v[56:59], v[140:143]
    ds_read_b64_tr_b16 v[100:101], v15 offset:4096
    v_mfma_f32_16x16x32_bf16 v[140:143], v[212:215], v[60:63], v[140:143]
    ds_read_b64_tr_b16 v[102:103], v15 offset:4608
    v_mfma_f32_16x16x32_bf16 v[144:147], v[216:219], v[56:59], v[144:147]
    s_add_u32 s52, s52, 40960
    s_cmp_eq_u32 s52, 122880
    s_cselect_b32 s52, 0, s52
    v_mfma_f32_16x16x32_bf16 v[144:147], v[220:223], v[60:63], v[144:147]
    v_add_u32 v10, s52, v8
    v_add_u32 v11, s52, v9
    v_mfma_f32_16x16x32_bf16 v[148:151], v[224:227], v[56:59], v[148:151]
    v_add_u32 v14, s52, v12
    v_add_u32 v15, s52, v13
    v_mfma_f32_16x16x32_bf16 v[148:151], v[228:231], v[60:63], v[148:151]
    v_xor_b32 v17, s39, v14
    v_xor_b32 v18, s39, v15
    s_waitcnt lgkmcnt(0)
    v_mfma_f32_16x16x32_bf16 v[152:155], v[200:203], v[64:67], v[152:155]
    s_barrier
    v_mfma_f32_16x16x32_bf16 v[152:155], v[204:207], v[68:71], v[152:155]
    ds_read_b64_tr_b16 v[56:57], v14 offset:8192
    v_mfma_f32_16x16x32_bf16 v[156:159], v[208:211], v[64:67], v[156:159]
    ds_read_b64_tr_b16 v[58:59], v14 offset:8704
    v_mfma_f32_16x16x32_bf16 v[156:159], v[212:215], v[68:71], v[156:159]
    ds_read_b64_tr_b16 v[60:61], v14 offset:12288
    v_mfma_f32_16x16x32_bf16 v[160:163], v[216:219], v[64:67], v[160:163]
    ds_read_b64_tr_b16 v[62:63], v14 offset:12800
    v_mfma_f32_16x16x32_bf16 v[160:163], v[220:223], v[68:71], v[160:163]
    ds_read_b128 v[24:27], v10 offset:0
    v_mfma_f32_16x16x32_bf16 v[164:167], v[224:227], v[64:67], v[164:167]
    ds_read_b128 v[28:31], v11 offset:0
    v_mfma_f32_16x16x32_bf16 v[164:167], v[228:231], v[68:71], v[164:167]
    ds_read_b128 v[32:35], v10 offset:2048
    v_mfma_f32_16x16x32_bf16 v[168:171], v[200:203], v[72:75], v[168:171]
    ds_read_b64_tr_b16 v[64:65], v15 offset:8192
    s_mov_b32 s54, 0x3fb8aa3b
    s_mov_b32 s55, 0x3fb8aa3b
    s_mov_b32 s56, 0x358637bd
    v_mfma_f32_16x16x32_bf16 v[168:171], v[204:207], v[76:79], v[168:171]
    ds_read_b64_tr_b16 v[66:67], v15 offset:8704
    s_lshl_b32 s57, s31, 2
    s_add_u32 s57, s57, s3
    s_lshl_b32 s57, s57, 4
    v_mfma_f32_16x16x32_bf16 v[172:175], v[208:211], v[72:75], v[172:175]
    ds_read_b64_tr_b16 v[68:69], v15 offset:12288
    s_add_u32 s57, s57, s30
    s_lshl_b32 s58, s57, 10
    s_add_u32 s58, s58, 0x800000
    v_mfma_f32_16x16x32_bf16 v[172:175], v[212:215], v[76:79], v[172:175]
    ds_read_b64_tr_b16 v[70:71], v15 offset:12800
    s_lshr_b32 s59, s57, 4
    s_lshl_b32 s59, s59, 11
    s_lshl_b32 s45, s30, 4
    v_mfma_f32_16x16x32_bf16 v[176:179], v[216:219], v[72:75], v[176:179]
    ds_read_b128 v[36:39], v11 offset:2048
    s_add_u32 s59, s59, s45
    s_add_u32 s59, s59, 0x900000
    s_lshr_b32 s57, s57, 4
    v_mfma_f32_16x16x32_bf16 v[176:179], v[220:223], v[76:79], v[176:179]
    ds_read_b128 v[40:43], v10 offset:4096
    s_lshl_b32 s57, s57, 11
    s_add_u32 s57, s57, 0x960000
    v_and_b32 v19, 7, v4
    v_mfma_f32_16x16x32_bf16 v[180:183], v[224:227], v[72:75], v[180:183]
    ds_read_b128 v[44:47], v11 offset:4096
    v_lshlrev_b32 v19, 1, v19
    v_sub_u32 v19, s30, v19
    v_and_b32 v19, 15, v19
    v_mfma_f32_16x16x32_bf16 v[180:183], v[228:231], v[76:79], v[180:183]
    ds_read_b128 v[48:51], v10 offset:6144
    v_lshl_add_u32 v19, v19, 2, v254
    s_lshl_b32 s45, s3, 11
    s_add_u32 s45, s45, 131584
    v_mfma_f32_16x16x32_bf16 v[184:187], v[200:203], v[80:83], v[184:187]
    ds_read_b128 v[52:55], v11 offset:6144
    v_add_u32 v6, s45, v5
    v_xor_b32 v7, 2048, v6
    s_lshl_b32 s45, s3, 7
    v_mfma_f32_16x16x32_bf16 v[184:187], v[204:207], v[84:87], v[184:187]
    ds_read_b64_tr_b16 v[72:73], v17 offset:16384
    s_add_u32 s45, s45, 162304
    v_and_b32 v3, 0x30, v4
    v_add_u32 v16, s45, v3
    v_mfma_f32_16x16x32_bf16 v[188:191], v[208:211], v[80:83], v[188:191]
    ds_read_b64_tr_b16 v[74:75], v17 offset:16896
    v_xor_b32 v253, 128, v16
    v_xor_b32 v255, 4, v21
    v_mfma_f32_16x16x32_bf16 v[188:191], v[212:215], v[84:87], v[188:191]
    ds_read_b64_tr_b16 v[76:77], v17 offset:20480
    v_mfma_f32_16x16x32_bf16 v[192:195], v[216:219], v[80:83], v[192:195]
    ds_read_b64_tr_b16 v[78:79], v17 offset:20992
    v_mfma_f32_16x16x32_bf16 v[192:195], v[220:223], v[84:87], v[192:195]
    v_mfma_f32_16x16x32_bf16 v[196:199], v[224:227], v[80:83], v[196:199]
    v_mfma_f32_16x16x32_bf16 v[196:199], v[228:231], v[84:87], v[196:199]
    s_waitcnt lgkmcnt(4)
    v_mfma_f32_16x16x32_bf16 v[136:139], v[24:27], v[56:59], v[136:139]
    ds_read_b64_tr_b16 v[80:81], v18 offset:16384
    ds_read_b64_tr_b16 v[82:83], v18 offset:16896
    v_mfma_f32_16x16x32_bf16 v[136:139], v[28:31], v[60:63], v[136:139]
    ds_read_b64_tr_b16 v[84:85], v18 offset:20480
    ds_read_b64_tr_b16 v[86:87], v18 offset:20992
    v_mfma_f32_16x16x32_bf16 v[140:143], v[32:35], v[56:59], v[140:143]
    ds_read_b64_tr_b16 v[236:237], v14 offset:0
    ds_read_b64_tr_b16 v[238:239], v14 offset:512
    v_mfma_f32_16x16x32_bf16 v[140:143], v[36:39], v[60:63], v[140:143]
    ds_read_b64_tr_b16 v[240:241], v14 offset:4096
    ds_read_b64_tr_b16 v[242:243], v14 offset:4608
    v_mfma_f32_16x16x32_bf16 v[144:147], v[40:43], v[56:59], v[144:147]
    ds_read_b64_tr_b16 v[244:245], v15 offset:0
    ds_read_b64_tr_b16 v[246:247], v15 offset:512
    v_mfma_f32_16x16x32_bf16 v[144:147], v[44:47], v[60:63], v[144:147]
    ds_read_b64_tr_b16 v[248:249], v15 offset:4096
    ds_read_b64_tr_b16 v[250:251], v15 offset:4608
    v_mfma_f32_16x16x32_bf16 v[148:151], v[48:51], v[56:59], v[148:151]
    v_mfma_f32_16x16x32_bf16 v[148:151], v[52:55], v[60:63], v[148:151]
    v_mfma_f32_16x16x32_bf16 v[152:155], v[24:27], v[64:67], v[152:155]
    v_mfma_f32_16x16x32_bf16 v[152:155], v[28:31], v[68:71], v[152:155]
    s_waitcnt lgkmcnt(0)
    ds_write_b32 v21, v232 offset:112
    v_mfma_f32_16x16x32_bf16 v[156:159], v[32:35], v[64:67], v[156:159]
    v_mul_f32 v56, s54, v136
    v_mul_f32 v57, s54, v137
    v_mul_f32 v58, s54, v138
    v_mfma_f32_16x16x32_bf16 v[156:159], v[36:39], v[68:71], v[156:159]
    v_mul_f32 v59, s54, v139
    v_mul_f32 v60, s54, v140
    v_mul_f32 v61, s54, v141
    v_mfma_f32_16x16x32_bf16 v[160:163], v[40:43], v[64:67], v[160:163]
    v_mul_f32 v62, s54, v142
    v_mul_f32 v63, s54, v143
    v_exp_f32_e64 v56, v56 clamp
    v_mfma_f32_16x16x32_bf16 v[160:163], v[44:47], v[68:71], v[160:163]
    v_exp_f32_e64 v57, v57 clamp
    v_exp_f32_e64 v58, v58 clamp
    v_exp_f32_e64 v59, v59 clamp
    v_mfma_f32_16x16x32_bf16 v[164:167], v[48:51], v[64:67], v[164:167]
    v_exp_f32_e64 v60, v60 clamp
    v_exp_f32_e64 v61, v61 clamp
    v_exp_f32_e64 v62, v62 clamp
    v_mfma_f32_16x16x32_bf16 v[164:167], v[52:55], v[68:71], v[164:167]
    v_exp_f32_e64 v63, v63 clamp
    v_max_f32 v136, s56, v136
    v_max_f32 v137, s56, v137
    v_mfma_f32_16x16x32_bf16 v[168:171], v[24:27], v[72:75], v[168:171]
    v_max_f32 v138, s56, v138
    v_max_f32 v139, s56, v139
    v_max_f32 v140, s56, v140
    v_mfma_f32_16x16x32_bf16 v[168:171], v[28:31], v[76:79], v[168:171]
    v_max_f32 v141, s56, v141
    v_max_f32 v142, s56, v142
    v_max_f32 v143, s56, v143
    v_mfma_f32_16x16x32_bf16 v[172:175], v[32:35], v[72:75], v[172:175]
    v_add_f32 v56, v56, v136
    v_add_f32 v57, v57, v137
    v_add_f32 v58, v58, v138
    v_mfma_f32_16x16x32_bf16 v[172:175], v[36:39], v[76:79], v[172:175]
    v_add_f32 v59, v59, v139
    v_add_f32 v60, v60, v140
    v_add_f32 v61, v61, v141
    v_mfma_f32_16x16x32_bf16 v[176:179], v[40:43], v[72:75], v[176:179]
    v_add_f32 v62, v62, v142
    v_add_f32 v63, v63, v143
    v_cvt_pk_bf16_f32 v136, v56, v57
    v_mfma_f32_16x16x32_bf16 v[176:179], v[44:47], v[76:79], v[176:179]
    v_cvt_pk_bf16_f32 v137, v58, v59
    v_cvt_pk_bf16_f32 v138, v60, v61
    v_cvt_pk_bf16_f32 v139, v62, v63
    v_mfma_f32_16x16x32_bf16 v[180:183], v[48:51], v[72:75], v[180:183]
    v_mul_f32 v56, s54, v144
    v_mul_f32 v57, s54, v145
    v_mul_f32 v58, s54, v146
    v_mfma_f32_16x16x32_bf16 v[180:183], v[52:55], v[76:79], v[180:183]
    v_mul_f32 v59, s54, v147
    v_mul_f32 v60, s54, v148
    v_mul_f32 v61, s54, v149
    v_mfma_f32_16x16x32_bf16 v[184:187], v[24:27], v[80:83], v[184:187]
    v_mul_f32 v62, s54, v150
    v_mul_f32 v63, s54, v151
    v_exp_f32_e64 v56, v56 clamp
    v_mfma_f32_16x16x32_bf16 v[184:187], v[28:31], v[84:87], v[184:187]
    v_exp_f32_e64 v57, v57 clamp
    v_exp_f32_e64 v58, v58 clamp
    v_exp_f32_e64 v59, v59 clamp
    v_mfma_f32_16x16x32_bf16 v[188:191], v[32:35], v[80:83], v[188:191]
    v_exp_f32_e64 v60, v60 clamp
    v_exp_f32_e64 v61, v61 clamp
    v_exp_f32_e64 v62, v62 clamp
    v_mfma_f32_16x16x32_bf16 v[188:191], v[36:39], v[84:87], v[188:191]
    v_exp_f32_e64 v63, v63 clamp
    v_max_f32 v144, s56, v144
    v_max_f32 v145, s56, v145
    v_mfma_f32_16x16x32_bf16 v[192:195], v[40:43], v[80:83], v[192:195]
    v_max_f32 v146, s56, v146
    v_max_f32 v147, s56, v147
    v_max_f32 v148, s56, v148
    v_mfma_f32_16x16x32_bf16 v[192:195], v[44:47], v[84:87], v[192:195]
    v_max_f32 v149, s56, v149
    v_max_f32 v150, s56, v150
    v_max_f32 v151, s56, v151
    v_mfma_f32_16x16x32_bf16 v[196:199], v[48:51], v[80:83], v[196:199]
    v_add_f32 v56, v56, v144
    v_add_f32 v57, v57, v145
    v_add_f32 v58, v58, v146
    v_mfma_f32_16x16x32_bf16 v[196:199], v[52:55], v[84:87], v[196:199]
    v_add_f32 v59, v59, v147
    v_add_f32 v60, v60, v148
    v_add_f32 v61, v61, v149
    v_add_f32 v62, v62, v150
    v_add_f32 v63, v63, v151
    v_cvt_pk_bf16_f32 v140, v56, v57
    v_cvt_pk_bf16_f32 v141, v58, v59
    v_cvt_pk_bf16_f32 v142, v60, v61
    v_cvt_pk_bf16_f32 v143, v62, v63
    s_setprio 2
    v_cvt_pk_bf16_f32 v168, v168, v169
    v_cvt_pk_bf16_f32 v169, v170, v171
    v_cvt_pk_bf16_f32 v170, v172, v173
    v_cvt_pk_bf16_f32 v171, v174, v175
    v_cvt_pk_bf16_f32 v172, v176, v177
    v_cvt_pk_bf16_f32 v173, v178, v179
    v_cvt_pk_bf16_f32 v174, v180, v181
    v_cvt_pk_bf16_f32 v175, v182, v183
    v_cvt_pk_bf16_f32 v176, v184, v185
    v_cvt_pk_bf16_f32 v177, v186, v187
    v_cvt_pk_bf16_f32 v178, v188, v189
    v_cvt_pk_bf16_f32 v179, v190, v191
    v_cvt_pk_bf16_f32 v180, v192, v193
    v_cvt_pk_bf16_f32 v181, v194, v195
    v_cvt_pk_bf16_f32 v182, v196, v197
    v_cvt_pk_bf16_f32 v183, v198, v199
    v_mov_b32 v144, 0x3f803f80
    v_mov_b32 v145, 0x3f803f80
    v_mov_b32 v146, 0x3f803f80
    v_mov_b32 v147, 0x3f803f80
    s_nop 1
    v_mfma_f32_16x16x32_bf16 v[80:83], v[136:139], v[176:179], 0
    v_mfma_f32_16x16x32_bf16 v[64:67], v[136:139], v[144:147], 0
    v_mfma_f32_16x16x32_bf16 v[72:75], v[136:139], v[168:171], 0
    v_mfma_f32_16x16x32_bf16 v[80:83], v[140:143], v[180:183], v[80:83]
    v_mfma_f32_16x16x32_bf16 v[64:67], v[140:143], v[144:147], v[64:67]
    v_mfma_f32_16x16x32_bf16 v[72:75], v[140:143], v[172:175], v[72:75]
    v_pk_mul_f32 v[56:57], v[152:153], s[54:55]
    v_pk_mul_f32 v[58:59], v[154:155], s[54:55]
    v_pk_mul_f32 v[60:61], v[156:157], s[54:55]
    v_pk_mul_f32 v[62:63], v[158:159], s[54:55]
    v_exp_f32_e64 v56, v56 clamp
    v_exp_f32_e64 v57, v57 clamp
    v_exp_f32_e64 v58, v58 clamp
    v_exp_f32_e64 v59, v59 clamp
    v_exp_f32_e64 v60, v60 clamp
    v_exp_f32_e64 v61, v61 clamp
    v_exp_f32_e64 v62, v62 clamp
    v_exp_f32_e64 v63, v63 clamp
    v_max_f32 v152, s56, v152
    v_max_f32 v153, s56, v153
    v_max_f32 v154, s56, v154
    v_max_f32 v155, s56, v155
    v_max_f32 v156, s56, v156
    v_max_f32 v157, s56, v157
    v_max_f32 v158, s56, v158
    v_max_f32 v159, s56, v159
    v_pk_add_f32 v[56:57], v[56:57], v[152:153]
    v_pk_add_f32 v[58:59], v[58:59], v[154:155]
    v_pk_add_f32 v[60:61], v[60:61], v[156:157]
    v_pk_add_f32 v[62:63], v[62:63], v[158:159]
    v_cvt_pk_bf16_f32 v152, v56, v57
    v_cvt_pk_bf16_f32 v153, v58, v59
    v_cvt_pk_bf16_f32 v154, v60, v61
    v_cvt_pk_bf16_f32 v155, v62, v63
    ds_write_b128 v6, v[80:83]
    ds_write_b128 v16, v[64:67]
    v_pk_mul_f32 v[56:57], v[160:161], s[54:55]
    v_pk_mul_f32 v[58:59], v[162:163], s[54:55]
    v_pk_mul_f32 v[60:61], v[164:165], s[54:55]
    v_pk_mul_f32 v[62:63], v[166:167], s[54:55]
    v_exp_f32_e64 v56, v56 clamp
    v_exp_f32_e64 v57, v57 clamp
    v_exp_f32_e64 v58, v58 clamp
    v_exp_f32_e64 v59, v59 clamp
    v_exp_f32_e64 v60, v60 clamp
    v_exp_f32_e64 v61, v61 clamp
    v_exp_f32_e64 v62, v62 clamp
    v_exp_f32_e64 v63, v63 clamp
    v_max_f32 v160, s56, v160
    v_max_f32 v161, s56, v161
    v_max_f32 v162, s56, v162
    v_max_f32 v163, s56, v163
    v_max_f32 v164, s56, v164
    v_max_f32 v165, s56, v165
    v_max_f32 v166, s56, v166
    v_max_f32 v167, s56, v167
    v_pk_add_f32 v[56:57], v[56:57], v[160:161]
    v_pk_add_f32 v[58:59], v[58:59], v[162:163]
    v_pk_add_f32 v[60:61], v[60:61], v[164:165]
    v_pk_add_f32 v[62:63], v[62:63], v[166:167]
    v_cvt_pk_bf16_f32 v156, v56, v57
    v_cvt_pk_bf16_f32 v157, v58, v59
    v_cvt_pk_bf16_f32 v158, v60, v61
    v_cvt_pk_bf16_f32 v159, v62, v63
    s_nop 1
    v_mfma_f32_16x16x32_bf16 v[84:87], v[152:155], v[176:179], 0
    v_mfma_f32_16x16x32_bf16 v[68:71], v[152:155], v[144:147], 0
    v_mfma_f32_16x16x32_bf16 v[76:79], v[152:155], v[168:171], 0
    v_mfma_f32_16x16x32_bf16 v[84:87], v[156:159], v[180:183], v[84:87]
    v_mfma_f32_16x16x32_bf16 v[68:71], v[156:159], v[144:147], v[68:71]
    v_mfma_f32_16x16x32_bf16 v[76:79], v[156:159], v[172:175], v[76:79]
    v_mov_b32 v160, 0x3f803f80
    v_mov_b32 v161, 0x3f803f80
    v_mov_b32 v162, 0x3f803f80
    v_mov_b32 v163, 0x3f803f80
    s_nop 1
    ds_write_b128 v6, v[84:87] offset:1024
    ds_write_b128 v16, v[68:71] offset:64
    ds_write_b32 v21, v232 offset:0
    s_mov_b32 s45, 0
L_xspin:
    ds_read_b32 v235, v255 offset:0
    ds_read_b128 v[184:187], v7
    ds_read_b128 v[188:191], v7 offset:1024
    ds_read_b128 v[192:195], v253
    ds_read_b128 v[196:199], v253 offset:64
    s_add_u32 s45, s45, 1
    s_waitcnt lgkmcnt(4)
    v_readfirstlane_b32 s46, v235
    s_cmp_gt_u32 s45, 0x40000
    s_cbranch_scc1 L_xdone
    s_cmp_eq_u32 s46, 0
    s_cbranch_scc1 L_xspin
L_xdone:
    s_waitcnt lgkmcnt(2)
    v_pk_add_f32 v[72:73], v[72:73], v[184:185]
    v_pk_add_f32 v[74:75], v[74:75], v[186:187]
    v_pk_add_f32 v[76:77], v[76:77], v[188:189]
    v_pk_add_f32 v[78:79], v[78:79], v[190:191]
    v_cvt_pk_bf16_f32 v80, v72, v73
    v_cvt_pk_bf16_f32 v81, v74, v75
    v_cvt_pk_bf16_f32 v82, v76, v77
    v_cvt_pk_bf16_f32 v83, v78, v79
    buffer_store_dwordx4 v[80:83], v5, s[60:63], s58 offen sc1
    s_waitcnt lgkmcnt(0)
    v_pk_add_f32 v[64:65], v[64:65], v[192:193]
    v_pk_add_f32 v[66:67], v[66:67], v[194:195]
    v_pk_add_f32 v[68:69], v[68:69], v[196:197]
    v_pk_add_f32 v[70:71], v[70:71], v[198:199]
    v_cvt_pk_bf16_f32 v84, v64, v65
    v_cvt_pk_bf16_f32 v85, v66, v67
    v_cvt_pk_bf16_f32 v86, v68, v69
    v_cvt_pk_bf16_f32 v87, v70, v71
    s_mov_b32 exec_lo, 0x10001
    s_mov_b32 exec_hi, 0x10001
    buffer_store_dwordx4 v[84:87], v5, s[60:63], s59 offen sc1
    s_mov_b64 exec, -1
    ds_write_b32 v21, v232 offset:128
    v_mfma_f32_16x16x32_bf16 v[104:107], v[88:91], v[200:203], v[104:107]
    s_lshl_b32 s47, s32, 1
    s_add_u32 s47, s47, s41
    v_mfma_f32_16x16x32_bf16 v[104:107], v[92:95], v[204:207], v[104:107]
    s_lshl_b32 s44, s32, 2
    s_add_u32 s44, s44, s3
    v_mfma_f32_16x16x32_bf16 v[104:107], v[236:239], v[24:27], v[104:107]
    s_lshl_b32 s58, s44, 14
    s_add_u32 s58, s58, 0x800000
    v_mfma_f32_16x16x32_bf16 v[104:107], v[240:243], v[28:31], v[104:107]
    s_lshl_b32 s59, s44, 11
    s_add_u32 s59, s59, 0x900000
    v_mfma_f32_16x16x32_bf16 v[108:111], v[96:99], v[200:203], v[108:111]
    s_lshl_b32 s44, s44, 6
    s_lshr_b32 vcc_lo, s44, 6
    v_mfma_f32_16x16x32_bf16 v[108:111], v[100:103], v[204:207], v[108:111]
    s_mul_i32 vcc_lo, vcc_lo, 1984
    s_add_u32 s44, s44, vcc_lo
    v_mfma_f32_16x16x32_bf16 v[108:111], v[244:247], v[24:27], v[108:111]
    s_add_u32 s44, s44, 0x960000
    s_lshl_b32 vcc_lo, s30, 7
    v_mfma_f32_16x16x32_bf16 v[108:111], v[248:251], v[28:31], v[108:111]
    s_add_u32 s44, s44, vcc_lo
    s_lshl_b32 s45, s41, 2
    v_mfma_f32_16x16x32_bf16 v[112:115], v[88:91], v[208:211], v[112:115]
    v_add_u32 v14, s45, v20
    v_mov_b32 v6, 0x3f80
    v_mfma_f32_16x16x32_bf16 v[112:115], v[92:95], v[212:215], v[112:115]
    v_and_b32 v7, 1, v4
    v_lshlrev_b32 v7, 4, v7
    v_mfma_f32_16x16x32_bf16 v[112:115], v[236:239], v[32:35], v[112:115]
    v_lshlrev_b32 v6, v7, v6
    v_lshrrev_b32 v2, 4, v4
    v_mfma_f32_16x16x32_bf16 v[112:115], v[240:243], v[36:39], v[112:115]
    v_cmp_eq_u32 vcc, v2, v22
    v_bfe_u32 v7, v4, 1, 1
    v_mfma_f32_16x16x32_bf16 v[116:119], v[96:99], v[208:211], v[116:119]
    v_mov_b32 v8, 0
    v_cndmask_b32 v6, 0, v6, vcc
    v_mfma_f32_16x16x32_bf16 v[116:119], v[100:103], v[212:215], v[116:119]
    v_cmp_eq_u32 vcc, 0, v7
    v_mov_b32 v9, 0
    v_mfma_f32_16x16x32_bf16 v[116:119], v[244:247], v[32:35], v[116:119]
    v_mov_b32 v12, 0
    v_cndmask_b32 v10, 0, v6, vcc
    v_mfma_f32_16x16x32_bf16 v[116:119], v[248:251], v[36:39], v[116:119]
    v_cndmask_b32 v11, v6, v233, vcc
    v_mov_b32 v13, 0
    v_mfma_f32_16x16x32_bf16 v[120:123], v[88:91], v[216:219], v[120:123]
    s_lshl_b32 s45, s3, 10
    s_add_u32 s45, s45, 158208
    v_mfma_f32_16x16x32_bf16 v[120:123], v[92:95], v[220:223], v[120:123]
    v_add_u32 v6, s45, v5
    s_xor_b32 s45, s3, 1
    v_mfma_f32_16x16x32_bf16 v[120:123], v[236:239], v[40:43], v[120:123]
    s_lshl_b32 s45, s45, 10
    s_add_u32 s45, s45, 158208
    v_mfma_f32_16x16x32_bf16 v[120:123], v[240:243], v[44:47], v[120:123]
    v_add_u32 v7, s45, v5
    s_lshl_b32 s48, s30, 3
    v_mfma_f32_16x16x32_bf16 v[124:127], v[96:99], v[216:219], v[124:127]
    s_lshl_b32 s45, s40, 2
    s_add_u32 s48, s48, s45
    v_mfma_f32_16x16x32_bf16 v[124:127], v[100:103], v[220:223], v[124:127]
    s_lshl_b32 s48, s48, 15
    s_lshl_b32 s45, s47, 10
    v_mfma_f32_16x16x32_bf16 v[124:127], v[244:247], v[40:43], v[124:127]
    s_add_u32 s48, s48, s45
    s_add_u32 s48, s48, 0x400000
    v_mfma_f32_16x16x32_bf16 v[124:127], v[248:251], v[44:47], v[124:127]
    s_lshl_b32 s49, s30, 1
    s_add_u32 s49, s49, s40
    v_mfma_f32_16x16x32_bf16 v[128:131], v[88:91], v[224:227], v[128:131]
    s_lshl_b32 s49, s49, 7
    s_lshl_b32 s45, s47, 2
    v_mfma_f32_16x16x32_bf16 v[128:131], v[92:95], v[228:231], v[128:131]
    s_add_u32 s49, s49, s45
    s_lshr_b32 vcc_lo, s49, 6
    v_mfma_f32_16x16x32_bf16 v[128:131], v[236:239], v[48:51], v[128:131]
    s_mul_i32 vcc_lo, vcc_lo, 1984
    s_add_u32 s49, s49, vcc_lo
    v_mfma_f32_16x16x32_bf16 v[128:131], v[240:243], v[52:55], v[128:131]
    s_add_u32 s49, s49, 0x980000
    s_mov_b32 s50, 0
    v_mfma_f32_16x16x32_bf16 v[132:135], v[96:99], v[224:227], v[132:135]
    s_mov_b32 s51, 0
    s_mov_b32 s53, 0
    v_mfma_f32_16x16x32_bf16 v[132:135], v[100:103], v[228:231], v[132:135]
    s_mov_b32 s46, 0
    s_and_b32 s43, s30, 7
    v_mfma_f32_16x16x32_bf16 v[132:135], v[244:247], v[48:51], v[132:135]
    v_mfma_f32_16x16x32_bf16 v[132:135], v[248:251], v[52:55], v[132:135]
    s_waitcnt vmcnt(0)
    s_mov_b64 exec, 0xffff
    buffer_store_dword v234, v19, s[60:63], s57 offen sc1
    s_mov_b64 exec, -1
    s_load_dwordx16 s[4:19], s[26:27], s44 glc
    v_mul_f32 v204, s54, v104
    v_mul_f32 v205, s54, v105
    v_mul_f32 v206, s54, v106
    v_mul_f32 v207, s54, v107
    v_mul_f32 v208, s54, v108
    v_mul_f32 v209, s54, v109
    v_mul_f32 v210, s54, v110
    v_mul_f32 v211, s54, v111
    v_exp_f32_e64 v204, v204 clamp
    v_exp_f32_e64 v205, v205 clamp
    v_exp_f32_e64 v206, v206 clamp
    v_exp_f32_e64 v207, v207 clamp
    v_exp_f32_e64 v208, v208 clamp
    v_exp_f32_e64 v209, v209 clamp
    v_exp_f32_e64 v210, v210 clamp
    v_exp_f32_e64 v211, v211 clamp
    v_max_f32 v104, s56, v104
    v_max_f32 v105, s56, v105
    v_max_f32 v106, s56, v106
    v_max_f32 v107, s56, v107
    v_max_f32 v108, s56, v108
    v_max_f32 v109, s56, v109
    v_max_f32 v110, s56, v110
    v_max_f32 v111, s56, v111
    v_add_f32 v204, v204, v104
    v_add_f32 v205, v205, v105
    v_add_f32 v206, v206, v106
    v_add_f32 v207, v207, v107
    v_add_f32 v208, v208, v108
    v_add_f32 v209, v209, v109
    v_add_f32 v210, v210, v110
    v_add_f32 v211, v211, v111
    v_cvt_pk_bf16_f32 v104, v204, v205
    v_cvt_pk_bf16_f32 v105, v206, v207
    v_cvt_pk_bf16_f32 v106, v208, v209
    v_cvt_pk_bf16_f32 v107, v210, v211
    v_mul_f32 v204, s54, v112
    v_mul_f32 v205, s54, v113
    v_mul_f32 v206, s54, v114
    v_mul_f32 v207, s54, v115
    v_mul_f32 v208, s54, v116
    v_mul_f32 v209, s54, v117
    v_mul_f32 v210, s54, v118
    v_mul_f32 v211, s54, v119
    v_exp_f32_e64 v204, v204 clamp
    v_exp_f32_e64 v205, v205 clamp
    v_exp_f32_e64 v206, v206 clamp
    v_exp_f32_e64 v207, v207 clamp
    v_exp_f32_e64 v208, v208 clamp
    v_exp_f32_e64 v209, v209 clamp
    v_exp_f32_e64 v210, v210 clamp
    v_exp_f32_e64 v211, v211 clamp
    v_max_f32 v112, s56, v112
    v_max_f32 v113, s56, v113
    v_max_f32 v114, s56, v114
    v_max_f32 v115, s56, v115
    v_max_f32 v116, s56, v116
    v_max_f32 v117, s56, v117
    v_max_f32 v118, s56, v118
    v_max_f32 v119, s56, v119
    v_add_f32 v204, v204, v112
    v_add_f32 v205, v205, v113
    v_add_f32 v206, v206, v114
    v_add_f32 v207, v207, v115
    v_add_f32 v208, v208, v116
    v_add_f32 v209, v209, v117
    v_add_f32 v210, v210, v118
    v_add_f32 v211, v211, v119
    v_cvt_pk_bf16_f32 v108, v204, v205
    v_cvt_pk_bf16_f32 v109, v206, v207
    v_cvt_pk_bf16_f32 v110, v208, v209
    v_cvt_pk_bf16_f32 v111, v210, v211
    v_mul_f32 v204, s54, v120
    v_mul_f32 v205, s54, v121
    v_mul_f32 v206, s54, v122
    v_mul_f32 v207, s54, v123
    v_mul_f32 v208, s54, v124
    v_mul_f32 v209, s54, v125
    v_mul_f32 v210, s54, v126
    v_mul_f32 v211, s54, v127
    v_exp_f32_e64 v204, v204 clamp
    v_exp_f32_e64 v205, v205 clamp
    v_exp_f32_e64 v206, v206 clamp
    v_exp_f32_e64 v207, v207 clamp
    v_exp_f32_e64 v208, v208 clamp
    v_exp_f32_e64 v209, v209 clamp
    v_exp_f32_e64 v210, v210 clamp
    v_exp_f32_e64 v211, v211 clamp
    v_max_f32 v120, s56, v120
    v_max_f32 v121, s56, v121
    v_max_f32 v122, s56, v122
    v_max_f32 v123, s56, v123
    v_max_f32 v124, s56, v124
    v_max_f32 v125, s56, v125
    v_max_f32 v126, s56, v126
    v_max_f32 v127, s56, v127
    v_add_f32 v204, v204, v120
    v_add_f32 v205, v205, v121
    v_add_f32 v206, v206, v122
    v_add_f32 v207, v207, v123
    v_add_f32 v208, v208, v124
    v_add_f32 v209, v209, v125
    v_add_f32 v210, v210, v126
    v_add_f32 v211, v211, v127
    v_cvt_pk_bf16_f32 v112, v204, v205
    v_cvt_pk_bf16_f32 v113, v206, v207
    v_cvt_pk_bf16_f32 v114, v208, v209
    v_cvt_pk_bf16_f32 v115, v210, v211
    v_mul_f32 v204, s54, v128
    v_mul_f32 v205, s54, v129
    v_mul_f32 v206, s54, v130
    v_mul_f32 v207, s54, v131
    v_mul_f32 v208, s54, v132
    v_mul_f32 v209, s54, v133
    v_mul_f32 v210, s54, v134
    v_mul_f32 v211, s54, v135
    v_exp_f32_e64 v204, v204 clamp
    v_exp_f32_e64 v205, v205 clamp
    v_exp_f32_e64 v206, v206 clamp
    v_exp_f32_e64 v207, v207 clamp
    v_exp_f32_e64 v208, v208 clamp
    v_exp_f32_e64 v209, v209 clamp
    v_exp_f32_e64 v210, v210 clamp
    v_exp_f32_e64 v211, v211 clamp
    v_max_f32 v128, s56, v128
    v_max_f32 v129, s56, v129
    v_max_f32 v130, s56, v130
    v_max_f32 v131, s56, v131
    v_max_f32 v132, s56, v132
    v_max_f32 v133, s56, v133
    v_max_f32 v134, s56, v134
    v_max_f32 v135, s56, v135
    v_add_f32 v204, v204, v128
    v_add_f32 v205, v205, v129
    v_add_f32 v206, v206, v130
    v_add_f32 v207, v207, v131
    v_add_f32 v208, v208, v132
    v_add_f32 v209, v209, v133
    v_add_f32 v210, v210, v134
    v_add_f32 v211, v211, v135
    v_cvt_pk_bf16_f32 v116, v204, v205
    v_cvt_pk_bf16_f32 v117, v206, v207
    v_cvt_pk_bf16_f32 v118, v208, v209
    v_cvt_pk_bf16_f32 v119, v210, v211
    v_mov_b64 v[88:89], 0
    v_mov_b64 v[138:139], 0
    v_mov_b32 v168, s56
    v_mov_b64 v[90:91], 0
    v_mov_b64 v[142:143], 0
    v_mov_b32 v169, s56
    v_mov_b64 v[92:93], 0
    v_mov_b64 v[146:147], 0
    v_mov_b32 v170, s56
    v_mov_b64 v[94:95], 0
    v_mov_b64 v[150:151], 0
    v_mov_b32 v171, s56
    s_setprio 3
    s_cmp_eq_u32 s46, 0
    s_cbranch_scc1 L_poll0
L_go0:
    s_ff1_i32_b32 s45, s46
    s_bitset0_b32 s46, s45
    s_add_u32 s45, s45, s43
    s_and_b32 s45, s45, 7
    s_lshl_b32 s45, s45, 11
    s_add_u32 s45, s45, s58
    buffer_load_dwordx4 v[24:27], v5, s[60:63], s45 offen offset:0 sc1
    buffer_load_dwordx4 v[28:31], v5, s[60:63], s45 offen offset:1024 sc1
    s_bitset1_b32 s51, 0
    s_cmp_eq_u32 s46, 0
    s_cbranch_scc1 L_poll1
L_go1:
    s_ff1_i32_b32 s45, s46
    s_bitset0_b32 s46, s45
    s_add_u32 s45, s45, s43
    s_and_b32 s45, s45, 7
    s_lshl_b32 s45, s45, 11
    s_add_u32 s45, s45, s58
    buffer_load_dwordx4 v[32:35], v5, s[60:63], s45 offen offset:0 sc1
    buffer_load_dwordx4 v[36:39], v5, s[60:63], s45 offen offset:1024 sc1
    s_bitset1_b32 s51, 1
    s_cmp_eq_u32 s46, 0
    s_cbranch_scc1 L_poll2
L_go2:
    s_ff1_i32_b32 s45, s46
    s_bitset0_b32 s46, s45
    s_add_u32 s45, s45, s43
    s_and_b32 s45, s45, 7
    s_lshl_b32 s45, s45, 11
    s_add_u32 s45, s45, s58
    buffer_load_dwordx4 v[40:43], v5, s[60:63], s45 offen offset:0 sc1
    buffer_load_dwordx4 v[44:47], v5, s[60:63], s45 offen offset:1024 sc1
    s_bitset1_b32 s51, 2
    s_cmp_eq_u32 s46, 0
    s_cbranch_scc1 L_poll3
L_go3:
    s_ff1_i32_b32 s45, s46
    s_bitset0_b32 s46, s45
    s_add_u32 s45, s45, s43
    s_and_b32 s45, s45, 7
    s_lshl_b32 s45, s45, 11
    s_add_u32 s45, s45, s58
    buffer_load_dwordx4 v[48:51], v5, s[60:63], s45 offen offset:0 sc1
    buffer_load_dwordx4 v[52:55], v5, s[60:63], s45 offen offset:1024 sc1
    s_bitset1_b32 s51, 3
    s_cmp_eq_u32 s46, 0
    s_cbranch_scc1 L_poll4
L_go4:
    s_ff1_i32_b32 s45, s46
    s_bitset0_b32 s46, s45
    s_add_u32 s45, s45, s43
    s_and_b32 s45, s45, 7
    s_lshl_b32 s45, s45, 11
    s_add_u32 s45, s45, s58
    buffer_load_dwordx4 v[56:59], v5, s[60:63], s45 offen offset:0 sc1
    buffer_load_dwordx4 v[60:63], v5, s[60:63], s45 offen offset:1024 sc1
    s_bitset1_b32 s51, 4
    s_cmp_eq_u32 s46, 0
    s_cbranch_scc1 L_poll5
L_go5:
    s_ff1_i32_b32 s45, s46
    s_bitset0_b32 s46, s45
    s_add_u32 s45, s45, s43
    s_and_b32 s45, s45, 7
    s_lshl_b32 s45, s45, 11
    s_add_u32 s45, s45, s58
    buffer_load_dwordx4 v[64:67], v5, s[60:63], s45 offen offset:0 sc1
    buffer_load_dwordx4 v[68:71], v5, s[60:63], s45 offen offset:1024 sc1
    s_bitset1_b32 s51, 5
    s_cmp_eq_u32 s46, 0
    s_cbranch_scc1 L_poll6
L_go6:
    s_ff1_i32_b32 s45, s46
    s_bitset0_b32 s46, s45
    s_add_u32 s45, s45, s43
    s_and_b32 s45, s45, 7
    s_lshl_b32 s45, s45, 11
    s_add_u32 s45, s45, s58
    buffer_load_dwordx4 v[72:75], v5, s[60:63], s45 offen offset:0 sc1
    buffer_load_dwordx4 v[76:79], v5, s[60:63], s45 offen offset:1024 sc1
    s_bitset1_b32 s51, 6
    s_cmp_eq_u32 s46, 0
    s_cbranch_scc1 L_poll7
L_go7:
    s_ff1_i32_b32 s45, s46
    s_bitset0_b32 s46, s45
    s_add_u32 s45, s45, s43
    s_and_b32 s45, s45, 7
    s_lshl_b32 s45, s45, 11
    s_add_u32 s45, s45, s58
    buffer_load_dwordx4 v[80:83], v5, s[60:63], s45 offen offset:0 sc1
    buffer_load_dwordx4 v[84:87], v5, s[60:63], s45 offen offset:1024 sc1
    s_bitset1_b32 s51, 7
    s_branch L_fin
L_poll0:
    s_waitcnt lgkmcnt(0)
    s_cmp_eq_u64 s[18:19], s[72:73]
    s_addc_u32 s46, s46, s46
    s_cmp_eq_u64 s[16:17], s[72:73]
    s_addc_u32 s46, s46, s46
    s_cmp_eq_u64 s[14:15], s[72:73]
    s_addc_u32 s46, s46, s46
    s_cmp_eq_u64 s[12:13], s[72:73]
    s_addc_u32 s46, s46, s46
    s_cmp_eq_u64 s[10:11], s[72:73]
    s_addc_u32 s46, s46, s46
    s_cmp_eq_u64 s[8:9], s[72:73]
    s_addc_u32 s46, s46, s46
    s_cmp_eq_u64 s[6:7], s[72:73]
    s_addc_u32 s46, s46, s46
    s_cmp_eq_u64 s[4:5], s[72:73]
    s_addc_u32 s46, s46, s46
    s_add_u32 s53, s53, 1
    s_cmp_gt_u32 s53, 0x8000
    s_cselect_b32 s46, 0xff, s46
    s_andn2_b32 s46, s46, s50
    s_or_b32 s50, s50, s46
    s_cmp_eq_u32 s50, 0xff
    s_cbranch_scc0 L_pm0
    buffer_load_dwordx4 v[96:99], v5, s[60:63], s59 offen sc1
    s_mov_b32 s47, s51
    s_mov_b32 s52, 0
    s_branch L_go0
L_pm0:
    s_load_dwordx16 s[4:19], s[26:27], s44 glc
    s_cmp_lg_u32 s46, 0
    s_cbranch_scc1 L_go0
    s_branch L_poll0
L_poll1:
    s_waitcnt lgkmcnt(0)
    s_cmp_eq_u64 s[18:19], s[72:73]
    s_addc_u32 s46, s46, s46
    s_cmp_eq_u64 s[16:17], s[72:73]
    s_addc_u32 s46, s46, s46
    s_cmp_eq_u64 s[14:15], s[72:73]
    s_addc_u32 s46, s46, s46
    s_cmp_eq_u64 s[12:13], s[72:73]
    s_addc_u32 s46, s46, s46
    s_cmp_eq_u64 s[10:11], s[72:73]
    s_addc_u32 s46, s46, s46
    s_cmp_eq_u64 s[8:9], s[72:73]
    s_addc_u32 s46, s46, s46
    s_cmp_eq_u64 s[6:7], s[72:73]
    s_addc_u32 s46, s46, s46
    s_cmp_eq_u64 s[4:5], s[72:73]
    s_addc_u32 s46, s46, s46
    s_add_u32 s53, s53, 1
    s_cmp_gt_u32 s53, 0x8000
    s_cselect_b32 s46, 0xff, s46
    s_andn2_b32 s46, s46, s50
    s_or_b32 s50, s50, s46
    s_cmp_eq_u32 s50, 0xff
    s_cbranch_scc0 L_pm1
    buffer_load_dwordx4 v[96:99], v5, s[60:63], s59 offen sc1
    s_mov_b32 s47, s51
    s_mov_b32 s52, 1
    s_branch L_go1
L_pm1:
    s_load_dwordx16 s[4:19], s[26:27], s44 glc
    s_cmp_lg_u32 s46, 0
    s_cbranch_scc1 L_go1
    s_cmp_eq_u32 s51, 0
    s_cbranch_scc1 L_poll1
    s_mov_b32 s52, 1
    s_branch L_acc
L_poll2:
    s_waitcnt lgkmcnt(0)
    s_cmp_eq_u64 s[18:19], s[72:73]
    s_addc_u32 s46, s46, s46
    s_cmp_eq_u64 s[16:17], s[72:73]
    s_addc_u32 s46, s46, s46
    s_cmp_eq_u64 s[14:15], s[72:73]
    s_addc_u32 s46, s46, s46
    s_cmp_eq_u64 s[12:13], s[72:73]
    s_addc_u32 s46, s46, s46
    s_cmp_eq_u64 s[10:11], s[72:73]
    s_addc_u32 s46, s46, s46
    s_cmp_eq_u64 s[8:9], s[72:73]
    s_addc_u32 s46, s46, s46
    s_cmp_eq_u64 s[6:7], s[72:73]
    s_addc_u32 s46, s46, s46
    s_cmp_eq_u64 s[4:5], s[72:73]
    s_addc_u32 s46, s46, s46
    s_add_u32 s53, s53, 1
    s_cmp_gt_u32 s53, 0x8000
    s_cselect_b32 s46, 0xff, s46
    s_andn2_b32 s46, s46, s50
    s_or_b32 s50, s50, s46
    s_cmp_eq_u32 s50, 0xff
    s_cbranch_scc0 L_pm2
    buffer_load_dwordx4 v[96:99], v5, s[60:63], s59 offen sc1
    s_mov_b32 s47, s51
    s_mov_b32 s52, 2
    s_branch L_go2
L_pm2:
    s_load_dwordx16 s[4:19], s[26:27], s44 glc
    s_cmp_lg_u32 s46, 0
    s_cbranch_scc1 L_go2
    s_cmp_eq_u32 s51, 0
    s_cbranch_scc1 L_poll2
    s_mov_b32 s52, 2
    s_branch L_acc
L_poll3:
    s_waitcnt lgkmcnt(0)
    s_cmp_eq_u64 s[18:19], s[72:73]
    s_addc_u32 s46, s46, s46
    s_cmp_eq_u64 s[16:17], s[72:73]
    s_addc_u32 s46, s46, s46
    s_cmp_eq_u64 s[14:15], s[72:73]
    s_addc_u32 s46, s46, s46
    s_cmp_eq_u64 s[12:13], s[72:73]
    s_addc_u32 s46, s46, s46
    s_cmp_eq_u64 s[10:11], s[72:73]
    s_addc_u32 s46, s46, s46
    s_cmp_eq_u64 s[8:9], s[72:73]
    s_addc_u32 s46, s46, s46
    s_cmp_eq_u64 s[6:7], s[72:73]
    s_addc_u32 s46, s46, s46
    s_cmp_eq_u64 s[4:5], s[72:73]
    s_addc_u32 s46, s46, s46
    s_add_u32 s53, s53, 1
    s_cmp_gt_u32 s53, 0x8000
    s_cselect_b32 s46, 0xff, s46
    s_andn2_b32 s46, s46, s50
    s_or_b32 s50, s50, s46
    s_cmp_eq_u32 s50, 0xff
    s_cbranch_scc0 L_pm3
    buffer_load_dwordx4 v[96:99], v5, s[60:63], s59 offen sc1
    s_mov_b32 s47, s51
    s_mov_b32 s52, 3
    s_branch L_go3
L_pm3:
    s_load_dwordx16 s[4:19], s[26:27], s44 glc
    s_cmp_lg_u32 s46, 0
    s_cbranch_scc1 L_go3
    s_cmp_eq_u32 s51, 0
    s_cbranch_scc1 L_poll3
    s_mov_b32 s52, 3
    s_branch L_acc
L_poll4:
    s_waitcnt lgkmcnt(0)
    s_cmp_eq_u64 s[18:19], s[72:73]
    s_addc_u32 s46, s46, s46
    s_cmp_eq_u64 s[16:17], s[72:73]
    s_addc_u32 s46, s46, s46
    s_cmp_eq_u64 s[14:15], s[72:73]
    s_addc_u32 s46, s46, s46
    s_cmp_eq_u64 s[12:13], s[72:73]
    s_addc_u32 s46, s46, s46
    s_cmp_eq_u64 s[10:11], s[72:73]
    s_addc_u32 s46, s46, s46
    s_cmp_eq_u64 s[8:9], s[72:73]
    s_addc_u32 s46, s46, s46
    s_cmp_eq_u64 s[6:7], s[72:73]
    s_addc_u32 s46, s46, s46
    s_cmp_eq_u64 s[4:5], s[72:73]
    s_addc_u32 s46, s46, s46
    s_add_u32 s53, s53, 1
    s_cmp_gt_u32 s53, 0x8000
    s_cselect_b32 s46, 0xff, s46
    s_andn2_b32 s46, s46, s50
    s_or_b32 s50, s50, s46
    s_cmp_eq_u32 s50, 0xff
    s_cbranch_scc0 L_pm4
    buffer_load_dwordx4 v[96:99], v5, s[60:63], s59 offen sc1
    s_mov_b32 s47, s51
    s_mov_b32 s52, 4
    s_branch L_go4
L_pm4:
    s_load_dwordx16 s[4:19], s[26:27], s44 glc
    s_cmp_lg_u32 s46, 0
    s_cbranch_scc1 L_go4
    s_cmp_eq_u32 s51, 0
    s_cbranch_scc1 L_poll4
    s_mov_b32 s52, 4
    s_branch L_acc
L_poll5:
    s_waitcnt lgkmcnt(0)
    s_cmp_eq_u64 s[18:19], s[72:73]
    s_addc_u32 s46, s46, s46
    s_cmp_eq_u64 s[16:17], s[72:73]
    s_addc_u32 s46, s46, s46
    s_cmp_eq_u64 s[14:15], s[72:73]
    s_addc_u32 s46, s46, s46
    s_cmp_eq_u64 s[12:13], s[72:73]
    s_addc_u32 s46, s46, s46
    s_cmp_eq_u64 s[10:11], s[72:73]
    s_addc_u32 s46, s46, s46
    s_cmp_eq_u64 s[8:9], s[72:73]
    s_addc_u32 s46, s46, s46
    s_cmp_eq_u64 s[6:7], s[72:73]
    s_addc_u32 s46, s46, s46
    s_cmp_eq_u64 s[4:5], s[72:73]
    s_addc_u32 s46, s46, s46
    s_add_u32 s53, s53, 1
    s_cmp_gt_u32 s53, 0x8000
    s_cselect_b32 s46, 0xff, s46
    s_andn2_b32 s46, s46, s50
    s_or_b32 s50, s50, s46
    s_cmp_eq_u32 s50, 0xff
    s_cbranch_scc0 L_pm5
    buffer_load_dwordx4 v[96:99], v5, s[60:63], s59 offen sc1
    s_mov_b32 s47, s51
    s_mov_b32 s52, 5
    s_branch L_go5
L_pm5:
    s_load_dwordx16 s[4:19], s[26:27], s44 glc
    s_cmp_lg_u32 s46, 0
    s_cbranch_scc1 L_go5
    s_cmp_eq_u32 s51, 0
    s_cbranch_scc1 L_poll5
    s_mov_b32 s52, 5
    s_branch L_acc
L_poll6:
    s_waitcnt lgkmcnt(0)
    s_cmp_eq_u64 s[18:19], s[72:73]
    s_addc_u32 s46, s46, s46
    s_cmp_eq_u64 s[16:17], s[72:73]
    s_addc_u32 s46, s46, s46
    s_cmp_eq_u64 s[14:15], s[72:73]
    s_addc_u32 s46, s46, s46
    s_cmp_eq_u64 s[12:13], s[72:73]
    s_addc_u32 s46, s46, s46
    s_cmp_eq_u64 s[10:11], s[72:73]
    s_addc_u32 s46, s46, s46
    s_cmp_eq_u64 s[8:9], s[72:73]
    s_addc_u32 s46, s46, s46
    s_cmp_eq_u64 s[6:7], s[72:73]
    s_addc_u32 s46, s46, s46
    s_cmp_eq_u64 s[4:5], s[72:73]
    s_addc_u32 s46, s46, s46
    s_add_u32 s53, s53, 1
    s_cmp_gt_u32 s53, 0x8000
    s_cselect_b32 s46, 0xff, s46
    s_andn2_b32 s46, s46, s50
    s_or_b32 s50, s50, s46
    s_cmp_eq_u32 s50, 0xff
    s_cbranch_scc0 L_pm6
    buffer_load_dwordx4 v[96:99], v5, s[60:63], s59 offen sc1
    s_mov_b32 s47, s51
    s_mov_b32 s52, 6
    s_branch L_go6
L_pm6:
    s_load_dwordx16 s[4:19], s[26:27], s44 glc
    s_cmp_lg_u32 s46, 0
    s_cbranch_scc1 L_go6
    s_cmp_eq_u32 s51, 0
    s_cbranch_scc1 L_poll6
    s_mov_b32 s52, 6
    s_branch L_acc
L_poll7:
    s_waitcnt lgkmcnt(0)
    s_cmp_eq_u64 s[18:19], s[72:73]
    s_addc_u32 s46, s46, s46
    s_cmp_eq_u64 s[16:17], s[72:73]
    s_addc_u32 s46, s46, s46
    s_cmp_eq_u64 s[14:15], s[72:73]
    s_addc_u32 s46, s46, s46
    s_cmp_eq_u64 s[12:13], s[72:73]
    s_addc_u32 s46, s46, s46
    s_cmp_eq_u64 s[10:11], s[72:73]
    s_addc_u32 s46, s46, s46
    s_cmp_eq_u64 s[8:9], s[72:73]
    s_addc_u32 s46, s46, s46
    s_cmp_eq_u64 s[6:7], s[72:73]
    s_addc_u32 s46, s46, s46
    s_cmp_eq_u64 s[4:5], s[72:73]
    s_addc_u32 s46, s46, s46
    s_add_u32 s53, s53, 1
    s_cmp_gt_u32 s53, 0x8000
    s_cselect_b32 s46, 0xff, s46
    s_andn2_b32 s46, s46, s50
    s_or_b32 s50, s50, s46
    s_cmp_eq_u32 s50, 0xff
    s_cbranch_scc0 L_pm7
    buffer_load_dwordx4 v[96:99], v5, s[60:63], s59 offen sc1
    s_mov_b32 s47, s51
    s_mov_b32 s52, 7
    s_branch L_go7
L_pm7:
    s_load_dwordx16 s[4:19], s[26:27], s44 glc
    s_cmp_lg_u32 s46, 0
    s_cbranch_scc1 L_go7
    s_cmp_eq_u32 s51, 0
    s_cbranch_scc1 L_poll7
    s_mov_b32 s52, 7
    s_branch L_acc
L_acc:
    s_waitcnt vmcnt(0)
    s_bitcmp1_b32 s51, 0
    s_cbranch_scc0 L_ac0
    v_mfma_f32_16x16x32_bf16 v[88:91], v[10:13], v[24:27], v[88:91]
    v_mfma_f32_16x16x32_bf16 v[92:95], v[8:11], v[24:27], v[92:95]
    v_mfma_f32_16x16x32_bf16 v[88:91], v[10:13], v[28:31], v[88:91]
    v_mfma_f32_16x16x32_bf16 v[92:95], v[8:11], v[28:31], v[92:95]
L_ac0:
    s_bitcmp1_b32 s51, 1
    s_cbranch_scc0 L_ac1
    v_mfma_f32_16x16x32_bf16 v[88:91], v[10:13], v[32:35], v[88:91]
    v_mfma_f32_16x16x32_bf16 v[92:95], v[8:11], v[32:35], v[92:95]
    v_mfma_f32_16x16x32_bf16 v[88:91], v[10:13], v[36:39], v[88:91]
    v_mfma_f32_16x16x32_bf16 v[92:95], v[8:11], v[36:39], v[92:95]
L_ac1:
    s_bitcmp1_b32 s51, 2
    s_cbranch_scc0 L_ac2
    v_mfma_f32_16x16x32_bf16 v[88:91], v[10:13], v[40:43], v[88:91]
    v_mfma_f32_16x16x32_bf16 v[92:95], v[8:11], v[40:43], v[92:95]
    v_mfma_f32_16x16x32_bf16 v[88:91], v[10:13], v[44:47], v[88:91]
    v_mfma_f32_16x16x32_bf16 v[92:95], v[8:11], v[44:47], v[92:95]
L_ac2:
    s_bitcmp1_b32 s51, 3
    s_cbranch_scc0 L_ac3
    v_mfma_f32_16x16x32_bf16 v[88:91], v[10:13], v[48:51], v[88:91]
    v_mfma_f32_16x16x32_bf16 v[92:95], v[8:11], v[48:51], v[92:95]
    v_mfma_f32_16x16x32_bf16 v[88:91], v[10:13], v[52:55], v[88:91]
    v_mfma_f32_16x16x32_bf16 v[92:95], v[8:11], v[52:55], v[92:95]
L_ac3:
    s_bitcmp1_b32 s51, 4
    s_cbranch_scc0 L_ac4
    v_mfma_f32_16x16x32_bf16 v[88:91], v[10:13], v[56:59], v[88:91]
    v_mfma_f32_16x16x32_bf16 v[92:95], v[8:11], v[56:59], v[92:95]
    v_mfma_f32_16x16x32_bf16 v[88:91], v[10:13], v[60:63], v[88:91]
    v_mfma_f32_16x16x32_bf16 v[92:95], v[8:11], v[60:63], v[92:95]
L_ac4:
    s_bitcmp1_b32 s51, 5
    s_cbranch_scc0 L_ac5
    v_mfma_f32_16x16x32_bf16 v[88:91], v[10:13], v[64:67], v[88:91]
    v_mfma_f32_16x16x32_bf16 v[92:95], v[8:11], v[64:67], v[92:95]
    v_mfma_f32_16x16x32_bf16 v[88:91], v[10:13], v[68:71], v[88:91]
    v_mfma_f32_16x16x32_bf16 v[92:95], v[8:11], v[68:71], v[92:95]
L_ac5:
    s_bitcmp1_b32 s51, 6
    s_cbranch_scc0 L_ac6
    v_mfma_f32_16x16x32_bf16 v[88:91], v[10:13], v[72:75], v[88:91]
    v_mfma_f32_16x16x32_bf16 v[92:95], v[8:11], v[72:75], v[92:95]
    v_mfma_f32_16x16x32_bf16 v[88:91], v[10:13], v[76:79], v[88:91]
    v_mfma_f32_16x16x32_bf16 v[92:95], v[8:11], v[76:79], v[92:95]
L_ac6:
    s_mov_b32 s51, 0
    s_cmp_eq_u32 s52, 1
    s_cbranch_scc1 L_poll1
    s_cmp_eq_u32 s52, 2
    s_cbranch_scc1 L_poll2
    s_cmp_eq_u32 s52, 3
    s_cbranch_scc1 L_poll3
    s_cmp_eq_u32 s52, 4
    s_cbranch_scc1 L_poll4
    s_cmp_eq_u32 s52, 5
    s_cbranch_scc1 L_poll5
    s_cmp_eq_u32 s52, 6
    s_cbranch_scc1 L_poll6
    s_branch L_poll7
L_fin:
    s_cmp_eq_u32 s47, 0
    s_cbranch_scc1 L_pz
    s_cmp_eq_u32 s52, 1
    s_cbranch_scc1 L_pv1
    s_cmp_eq_u32 s52, 2
    s_cbranch_scc1 L_pv2
    s_cmp_eq_u32 s52, 3
    s_cbranch_scc1 L_pv3
    s_cmp_eq_u32 s52, 4
    s_cbranch_scc1 L_pv4
    s_cmp_eq_u32 s52, 5
    s_cbranch_scc1 L_pv5
    s_cmp_eq_u32 s52, 6
    s_cbranch_scc1 L_pv6
    s_waitcnt vmcnt(3)
    s_branch L_pvd
L_pv1:
    s_waitcnt vmcnt(15)
    s_branch L_pvd
L_pv2:
    s_waitcnt vmcnt(13)
    s_branch L_pvd
L_pv3:
    s_waitcnt vmcnt(11)
    s_branch L_pvd
L_pv4:
    s_waitcnt vmcnt(9)
    s_branch L_pvd
L_pv5:
    s_waitcnt vmcnt(7)
    s_branch L_pvd
L_pv6:
    s_waitcnt vmcnt(5)
L_pvd:
    s_bitcmp1_b32 s47, 0
    s_cbranch_scc0 L_ao0
    v_mfma_f32_16x16x32_bf16 v[88:91], v[10:13], v[24:27], v[88:91]
    v_mfma_f32_16x16x32_bf16 v[92:95], v[8:11], v[24:27], v[92:95]
    v_mfma_f32_16x16x32_bf16 v[88:91], v[10:13], v[28:31], v[88:91]
    v_mfma_f32_16x16x32_bf16 v[92:95], v[8:11], v[28:31], v[92:95]
L_ao0:
    s_bitcmp1_b32 s47, 1
    s_cbranch_scc0 L_ao1
    v_mfma_f32_16x16x32_bf16 v[88:91], v[10:13], v[32:35], v[88:91]
    v_mfma_f32_16x16x32_bf16 v[92:95], v[8:11], v[32:35], v[92:95]
    v_mfma_f32_16x16x32_bf16 v[88:91], v[10:13], v[36:39], v[88:91]
    v_mfma_f32_16x16x32_bf16 v[92:95], v[8:11], v[36:39], v[92:95]
L_ao1:
    s_bitcmp1_b32 s47, 2
    s_cbranch_scc0 L_ao2
    v_mfma_f32_16x16x32_bf16 v[88:91], v[10:13], v[40:43], v[88:91]
    v_mfma_f32_16x16x32_bf16 v[92:95], v[8:11], v[40:43], v[92:95]
    v_mfma_f32_16x16x32_bf16 v[88:91], v[10:13], v[44:47], v[88:91]
    v_mfma_f32_16x16x32_bf16 v[92:95], v[8:11], v[44:47], v[92:95]
L_ao2:
    s_bitcmp1_b32 s47, 3
    s_cbranch_scc0 L_ao3
    v_mfma_f32_16x16x32_bf16 v[88:91], v[10:13], v[48:51], v[88:91]
    v_mfma_f32_16x16x32_bf16 v[92:95], v[8:11], v[48:51], v[92:95]
    v_mfma_f32_16x16x32_bf16 v[88:91], v[10:13], v[52:55], v[88:91]
    v_mfma_f32_16x16x32_bf16 v[92:95], v[8:11], v[52:55], v[92:95]
L_ao3:
    s_bitcmp1_b32 s47, 4
    s_cbranch_scc0 L_ao4
    v_mfma_f32_16x16x32_bf16 v[88:91], v[10:13], v[56:59], v[88:91]
    v_mfma_f32_16x16x32_bf16 v[92:95], v[8:11], v[56:59], v[92:95]
    v_mfma_f32_16x16x32_bf16 v[88:91], v[10:13], v[60:63], v[88:91]
    v_mfma_f32_16x16x32_bf16 v[92:95], v[8:11], v[60:63], v[92:95]
L_ao4:
    s_bitcmp1_b32 s47, 5
    s_cbranch_scc0 L_ao5
    v_mfma_f32_16x16x32_bf16 v[88:91], v[10:13], v[64:67], v[88:91]
    v_mfma_f32_16x16x32_bf16 v[92:95], v[8:11], v[64:67], v[92:95]
    v_mfma_f32_16x16x32_bf16 v[88:91], v[10:13], v[68:71], v[88:91]
    v_mfma_f32_16x16x32_bf16 v[92:95], v[8:11], v[68:71], v[92:95]
L_ao5:
    s_bitcmp1_b32 s47, 6
    s_cbranch_scc0 L_ao6
    v_mfma_f32_16x16x32_bf16 v[88:91], v[10:13], v[72:75], v[88:91]
    v_mfma_f32_16x16x32_bf16 v[92:95], v[8:11], v[72:75], v[92:95]
    v_mfma_f32_16x16x32_bf16 v[88:91], v[10:13], v[76:79], v[88:91]
    v_mfma_f32_16x16x32_bf16 v[92:95], v[8:11], v[76:79], v[92:95]
L_ao6:
L_pz:
    s_cmp_eq_u32 s52, 0
    s_cbranch_scc1 L_pw0
    s_cmp_eq_u32 s52, 1
    s_cbranch_scc1 L_pw1
    s_cmp_eq_u32 s52, 2
    s_cbranch_scc1 L_pw2
    s_cmp_eq_u32 s52, 3
    s_cbranch_scc1 L_pw3
    s_cmp_eq_u32 s52, 4
    s_cbranch_scc1 L_pw4
    s_cmp_eq_u32 s52, 5
    s_cbranch_scc1 L_pw5
    s_cmp_eq_u32 s52, 6
    s_cbranch_scc1 L_pw6
    s_waitcnt vmcnt(2)
    s_branch L_pwd
L_pw0:
    s_waitcnt vmcnt(16)
    s_branch L_pwd
L_pw1:
    s_waitcnt vmcnt(14)
    s_branch L_pwd
L_pw2:
    s_waitcnt vmcnt(12)
    s_branch L_pwd
L_pw3:
    s_waitcnt vmcnt(10)
    s_branch L_pwd
L_pw4:
    s_waitcnt vmcnt(8)
    s_branch L_pwd
L_pw5:
    s_waitcnt vmcnt(6)
    s_branch L_pwd
L_pw6:
    s_waitcnt vmcnt(4)
L_pwd:
    v_mfma_f32_16x16x32_bf16 v[184:187], v[96:99], v[104:107], 0
    v_mfma_f32_16x16x32_bf16 v[188:191], v[96:99], v[108:111], 0
    v_mfma_f32_16x16x32_bf16 v[192:195], v[96:99], v[112:115], 0
    v_mfma_f32_16x16x32_bf16 v[196:199], v[96:99], v[116:119], 0
    s_nop 4
    v_cvt_pk_bf16_f32 v136, v184, v185
    v_cvt_pk_bf16_f32 v137, v186, v187
    v_cvt_pk_bf16_f32 v140, v188, v189
    v_cvt_pk_bf16_f32 v141, v190, v191
    v_cvt_pk_bf16_f32 v144, v192, v193
    v_cvt_pk_bf16_f32 v145, v194, v195
    v_cvt_pk_bf16_f32 v148, v196, v197
    v_cvt_pk_bf16_f32 v149, v198, v199
    s_nop 0
    v_mfma_f32_16x16x32_bf16 v[212:215], v[160:163], v[136:139], v[168:171]
    v_mfma_f32_16x16x32_bf16 v[216:219], v[160:163], v[140:143], v[168:171]
    v_mfma_f32_16x16x32_bf16 v[220:223], v[160:163], v[144:147], v[168:171]
    v_mfma_f32_16x16x32_bf16 v[224:227], v[160:163], v[148:151], v[168:171]
    s_cmp_eq_u32 s52, 7
    s_cbranch_scc1 L_an7
    s_cmp_eq_u32 s52, 6
    s_cbranch_scc1 L_an6
    s_cmp_eq_u32 s52, 5
    s_cbranch_scc1 L_an5
    s_cmp_eq_u32 s52, 4
    s_cbranch_scc1 L_an4
    s_cmp_eq_u32 s52, 3
    s_cbranch_scc1 L_an3
    s_cmp_eq_u32 s52, 2
    s_cbranch_scc1 L_an2
    s_cmp_eq_u32 s52, 1
    s_cbranch_scc1 L_an1
L_an0:
    s_waitcnt vmcnt(14)
    v_mfma_f32_16x16x32_bf16 v[88:91], v[10:13], v[24:27], v[88:91]
    v_mfma_f32_16x16x32_bf16 v[92:95], v[8:11], v[24:27], v[92:95]
    v_mfma_f32_16x16x32_bf16 v[88:91], v[10:13], v[28:31], v[88:91]
    v_mfma_f32_16x16x32_bf16 v[92:95], v[8:11], v[28:31], v[92:95]
L_an1:
    s_waitcnt vmcnt(12)
    v_mfma_f32_16x16x32_bf16 v[88:91], v[10:13], v[32:35], v[88:91]
    v_mfma_f32_16x16x32_bf16 v[92:95], v[8:11], v[32:35], v[92:95]
    v_mfma_f32_16x16x32_bf16 v[88:91], v[10:13], v[36:39], v[88:91]
    v_mfma_f32_16x16x32_bf16 v[92:95], v[8:11], v[36:39], v[92:95]
L_an2:
    s_waitcnt vmcnt(10)
    v_mfma_f32_16x16x32_bf16 v[88:91], v[10:13], v[40:43], v[88:91]
    v_mfma_f32_16x16x32_bf16 v[92:95], v[8:11], v[40:43], v[92:95]
    v_mfma_f32_16x16x32_bf16 v[88:91], v[10:13], v[44:47], v[88:91]
    v_mfma_f32_16x16x32_bf16 v[92:95], v[8:11], v[44:47], v[92:95]
L_an3:
    s_waitcnt vmcnt(8)
    v_mfma_f32_16x16x32_bf16 v[88:91], v[10:13], v[48:51], v[88:91]
    v_mfma_f32_16x16x32_bf16 v[92:95], v[8:11], v[48:51], v[92:95]
    v_mfma_f32_16x16x32_bf16 v[88:91], v[10:13], v[52:55], v[88:91]
    v_mfma_f32_16x16x32_bf16 v[92:95], v[8:11], v[52:55], v[92:95]
L_an4:
    s_waitcnt vmcnt(6)
    v_mfma_f32_16x16x32_bf16 v[88:91], v[10:13], v[56:59], v[88:91]
    v_mfma_f32_16x16x32_bf16 v[92:95], v[8:11], v[56:59], v[92:95]
    v_mfma_f32_16x16x32_bf16 v[88:91], v[10:13], v[60:63], v[88:91]
    v_mfma_f32_16x16x32_bf16 v[92:95], v[8:11], v[60:63], v[92:95]
L_an5:
    s_waitcnt vmcnt(4)
    v_mfma_f32_16x16x32_bf16 v[88:91], v[10:13], v[64:67], v[88:91]
    v_mfma_f32_16x16x32_bf16 v[92:95], v[8:11], v[64:67], v[92:95]
    v_mfma_f32_16x16x32_bf16 v[88:91], v[10:13], v[68:71], v[88:91]
    v_mfma_f32_16x16x32_bf16 v[92:95], v[8:11], v[68:71], v[92:95]
L_an6:
    s_waitcnt vmcnt(2)
    v_mfma_f32_16x16x32_bf16 v[88:91], v[10:13], v[72:75], v[88:91]
    v_mfma_f32_16x16x32_bf16 v[92:95], v[8:11], v[72:75], v[92:95]
    v_mfma_f32_16x16x32_bf16 v[88:91], v[10:13], v[76:79], v[88:91]
    v_mfma_f32_16x16x32_bf16 v[92:95], v[8:11], v[76:79], v[92:95]
L_an7:
    s_waitcnt vmcnt(0)
    v_mfma_f32_16x16x32_bf16 v[88:91], v[10:13], v[80:83], v[88:91]
    v_mfma_f32_16x16x32_bf16 v[92:95], v[8:11], v[80:83], v[92:95]
    v_mfma_f32_16x16x32_bf16 v[88:91], v[10:13], v[84:87], v[88:91]
    v_mfma_f32_16x16x32_bf16 v[92:95], v[8:11], v[84:87], v[92:95]
    s_nop 3
    v_rcp_f32 v212, v212
    v_rcp_f32 v216, v216
    v_rcp_f32 v220, v220
    v_rcp_f32 v224, v224
    v_cvt_pk_bf16_f32 v172, v88, v89
    v_cvt_pk_bf16_f32 v173, v90, v91
    v_cvt_pk_bf16_f32 v174, v92, v93
    v_cvt_pk_bf16_f32 v175, v94, v95
    ds_write_b128 v6, v[172:175]
    ds_write_b32 v21, v232 offset:40
    ds_read_b32 v235, v255 offset:40
    ds_read_b128 v[176:179], v7
    v_mfma_f32_16x16x32_bf16 v[24:27], v[172:175], v[104:107], 0
    v_mfma_f32_16x16x32_bf16 v[28:31], v[172:175], v[108:111], 0
    v_mfma_f32_16x16x32_bf16 v[32:35], v[172:175], v[112:115], 0
    v_mfma_f32_16x16x32_bf16 v[36:39], v[172:175], v[116:119], 0
    s_mov_b32 s45, 0
    s_nop 3
    s_cmp_eq_u32 s40, 0
    v_mul_f32 v24, v24, v212
    v_mul_f32 v25, v25, v212
    v_mul_f32 v26, v26, v212
    v_mul_f32 v27, v27, v212
    v_mul_f32 v28, v28, v216
    v_mul_f32 v29, v29, v216
    v_mul_f32 v30, v30, v216
    v_mul_f32 v31, v31, v216
    v_mul_f32 v32, v32, v220
    v_mul_f32 v33, v33, v220
    v_mul_f32 v34, v34, v220
    v_mul_f32 v35, v35, v220
    v_mul_f32 v36, v36, v224
    v_mul_f32 v37, v37, v224
    v_mul_f32 v38, v38, v224
    v_mul_f32 v39, v39, v224
    s_cbranch_scc0 L_o1
    v_cvt_pk_bf16_f32 v56, v24, v25
    v_cvt_pk_bf16_f32 v57, v26, v27
    v_cvt_pk_bf16_f32 v60, v28, v29
    v_cvt_pk_bf16_f32 v61, v30, v31
    v_cvt_pk_bf16_f32 v64, v32, v33
    v_cvt_pk_bf16_f32 v65, v34, v35
    v_cvt_pk_bf16_f32 v68, v36, v37
    v_cvt_pk_bf16_f32 v69, v38, v39
    s_branch L_ks0g
L_ks0:
    ds_read_b32 v235, v255 offset:40
    ds_read_b128 v[176:179], v7
L_ks0g:
    s_add_u32 s45, s45, 1
    s_waitcnt lgkmcnt(0)
    v_readfirstlane_b32 s46, v235
    s_cmp_gt_u32 s45, 0x40000
    s_cbranch_scc1 L_kd0
    s_cmp_eq_u32 s46, 0
    s_cbranch_scc1 L_ks0
L_kd0:
    v_mfma_f32_16x16x32_bf16 v[40:43], v[176:179], v[104:107], 0
    v_mfma_f32_16x16x32_bf16 v[44:47], v[176:179], v[108:111], 0
    v_mfma_f32_16x16x32_bf16 v[48:51], v[176:179], v[112:115], 0
    v_mfma_f32_16x16x32_bf16 v[52:55], v[176:179], v[116:119], 0
    s_nop 4
    v_mul_f32 v40, v40, v212
    v_mul_f32 v41, v41, v212
    v_mul_f32 v42, v42, v212
    v_mul_f32 v43, v43, v212
    v_cvt_pk_bf16_f32 v58, v40, v41
    v_cvt_pk_bf16_f32 v59, v42, v43
    buffer_store_dwordx4 v[56:59], v5, s[60:63], s48 offen sc1
    s_add_u32 s48, s48, 0x8000
    v_mul_f32 v44, v44, v216
    v_mul_f32 v45, v45, v216
    v_mul_f32 v46, v46, v216
    v_mul_f32 v47, v47, v216
    v_cvt_pk_bf16_f32 v62, v44, v45
    v_cvt_pk_bf16_f32 v63, v46, v47
    buffer_store_dwordx4 v[60:63], v5, s[60:63], s48 offen sc1
    s_add_u32 s48, s48, 0x8000
    v_mul_f32 v48, v48, v220
    v_mul_f32 v49, v49, v220
    v_mul_f32 v50, v50, v220
    v_mul_f32 v51, v51, v220
    v_cvt_pk_bf16_f32 v66, v48, v49
    v_cvt_pk_bf16_f32 v67, v50, v51
    buffer_store_dwordx4 v[64:67], v5, s[60:63], s48 offen sc1
    s_add_u32 s48, s48, 0x8000
    v_mul_f32 v52, v52, v224
    v_mul_f32 v53, v53, v224
    v_mul_f32 v54, v54, v224
    v_mul_f32 v55, v55, v224
    v_cvt_pk_bf16_f32 v70, v52, v53
    v_cvt_pk_bf16_f32 v71, v54, v55
    buffer_store_dwordx4 v[68:71], v5, s[60:63], s48 offen sc1
    s_branch L_o2
L_o1:
    v_cvt_pk_bf16_f32 v58, v24, v25
    v_cvt_pk_bf16_f32 v59, v26, v27
    v_cvt_pk_bf16_f32 v62, v28, v29
    v_cvt_pk_bf16_f32 v63, v30, v31
    v_cvt_pk_bf16_f32 v66, v32, v33
    v_cvt_pk_bf16_f32 v67, v34, v35
    v_cvt_pk_bf16_f32 v70, v36, v37
    v_cvt_pk_bf16_f32 v71, v38, v39
    s_branch L_ks1g
L_ks1:
    ds_read_b32 v235, v255 offset:40
    ds_read_b128 v[176:179], v7
L_ks1g:
    s_add_u32 s45, s45, 1
    s_waitcnt lgkmcnt(0)
    v_readfirstlane_b32 s46, v235
    s_cmp_gt_u32 s45, 0x40000
    s_cbranch_scc1 L_kd1
    s_cmp_eq_u32 s46, 0
    s_cbranch_scc1 L_ks1
L_kd1:
    v_mfma_f32_16x16x32_bf16 v[40:43], v[176:179], v[104:107], 0
    v_mfma_f32_16x16x32_bf16 v[44:47], v[176:179], v[108:111], 0
    v_mfma_f32_16x16x32_bf16 v[48:51], v[176:179], v[112:115], 0
    v_mfma_f32_16x16x32_bf16 v[52:55], v[176:179], v[116:119], 0
    s_nop 4
    v_mul_f32 v40, v40, v212
    v_mul_f32 v41, v41, v212
    v_mul_f32 v42, v42, v212
    v_mul_f32 v43, v43, v212
    v_cvt_pk_bf16_f32 v56, v40, v41
    v_cvt_pk_bf16_f32 v57, v42, v43
    buffer_store_dwordx4 v[56:59], v5, s[60:63], s48 offen sc1
    s_add_u32 s48, s48, 0x8000
    v_mul_f32 v44, v44, v216
    v_mul_f32 v45, v45, v216
    v_mul_f32 v46, v46, v216
    v_mul_f32 v47, v47, v216
    v_cvt_pk_bf16_f32 v60, v44, v45
    v_cvt_pk_bf16_f32 v61, v46, v47
    buffer_store_dwordx4 v[60:63], v5, s[60:63], s48 offen sc1
    s_add_u32 s48, s48, 0x8000
    v_mul_f32 v48, v48, v220
    v_mul_f32 v49, v49, v220
    v_mul_f32 v50, v50, v220
    v_mul_f32 v51, v51, v220
    v_cvt_pk_bf16_f32 v64, v48, v49
    v_cvt_pk_bf16_f32 v65, v50, v51
    buffer_store_dwordx4 v[64:67], v5, s[60:63], s48 offen sc1
    s_add_u32 s48, s48, 0x8000
    v_mul_f32 v52, v52, v224
    v_mul_f32 v53, v53, v224
    v_mul_f32 v54, v54, v224
    v_mul_f32 v55, v55, v224
    v_cvt_pk_bf16_f32 v68, v52, v53
    v_cvt_pk_bf16_f32 v69, v54, v55
    buffer_store_dwordx4 v[68:71], v5, s[60:63], s48 offen sc1
L_o2:
    s_lshl_b32 s59, s34, 3
    s_lshl_b32 s45, s3, 1
    s_add_u32 s59, s59, s45
    s_lshl_b32 s45, s59, 15
    s_add_u32 s45, s45, 0x400000
    v_add_u32 v242, 0x8000, v5
    s_mov_b32 s51, 0x55555555
    s_add_u32 s64, s26, s45
    s_addc_u32 s65, s27, 0
    s_mov_b32 s66, 0x10000
    s_mov_b32 s67, 0x20000
    s_lshl_b32 s52, s34, 8
    s_lshl_b32 s46, s3, 6
    s_add_u32 s52, s52, s46
    s_lshr_b32 vcc_lo, s52, 6
    s_mul_i32 vcc_lo, vcc_lo, 1984
    s_add_u32 s52, s52, vcc_lo
    s_add_u32 s52, s52, 0x980000
    s_lshl_b32 vcc_lo, s35, 7
    s_add_u32 s52, s52, vcc_lo
    v_lshrrev_b32 v6, 2, v4
    v_lshlrev_b32 v6, 7, v6
    v_and_b32 v7, 3, v4
    v_lshl_add_u32 v6, v7, 3, v6
    v_bfe_u32 v7, v4, 3, 1
    v_lshl_add_u32 v6, v7, 6, v6
    v_lshl_add_u32 v236, v23, 5, v6
    v_xor_b32 v237, 32, v236
    v_xor_b32 v238, 64, v236
    v_xor_b32 v239, 0x60, v236
    s_lshl_b32 s57, s3, 11
    s_add_u32 s57, s57, 131584
    v_lshrrev_b32 v7, 5, v4
    v_lshl_add_u32 v6, v23, 1, v7
    v_and_b32 v7, 7, v4
    v_xor_b32 v6, v6, v7
    v_lshlrev_b32 v6, 4, v6
    v_and_b32 v3, 15, v4
    v_lshl_add_u32 v6, v3, 7, v6
    v_add_u32 v15, s57, v6
    v_xor_b32 v18, 64, v15
    v_lshrrev_b32 v6, 3, v4
    v_lshlrev_b32 v3, 4, v7
    v_lshl_add_u32 v17, v6, 12, v3
    v_xor_b32 v7, v7, v6
    v_lshlrev_b32 v7, 4, v7
    v_lshl_add_u32 v6, v6, 7, v7
    v_add_u32 v16, s57, v6
    s_mov_b32 s50, 0
    s_mov_b32 s53, 0
    s_mov_b32 s54, 0
    s_lshl_b32 s55, s40, 4
    s_and_b32 s42, s34, 3
    s_lshl_b32 s42, s42, 3
    v_mov_b64 v[120:121], 0
    v_mov_b64 v[122:123], 0
    v_mov_b64 v[124:125], 0
    v_mov_b64 v[126:127], 0
    v_mov_b64 v[128:129], 0
    v_mov_b64 v[130:131], 0
    v_mov_b64 v[132:133], 0
    v_mov_b64 v[134:135], 0
    v_mov_b64 v[136:137], 0
    v_mov_b64 v[138:139], 0
    s_load_dwordx16 s[4:19], s[26:27], s52 glc
    v_mov_b64 v[140:141], 0
    v_mov_b64 v[142:143], 0
    v_mov_b64 v[144:145], 0
    v_mov_b64 v[146:147], 0
    v_mov_b64 v[148:149], 0
    v_mov_b64 v[150:151], 0
    s_waitcnt vmcnt(0)
    s_mov_b64 exec, 0xffff
    buffer_store_dword v234, v254, s[60:63], s49 offen sc1
    s_mov_b64 exec, -1
    s_waitcnt lgkmcnt(0)
    s_mov_b32 s54, 0
    s_cmp_eq_u64 s[4:5], s[72:73]
    s_cselect_b32 s46, 0x1, 0
    s_or_b32 s54, s54, s46
    s_cmp_eq_u64 s[6:7], s[72:73]
    s_cselect_b32 s46, 0x4, 0
    s_or_b32 s54, s54, s46
    s_cmp_eq_u64 s[8:9], s[72:73]
    s_cselect_b32 s46, 0x10, 0
    s_or_b32 s54, s54, s46
    s_cmp_eq_u64 s[10:11], s[72:73]
    s_cselect_b32 s46, 0x40, 0
    s_or_b32 s54, s54, s46
    s_cmp_eq_u64 s[12:13], s[72:73]
    s_cselect_b32 s46, 0x100, 0
    s_or_b32 s54, s54, s46
    s_cmp_eq_u64 s[14:15], s[72:73]
    s_cselect_b32 s46, 0x400, 0
    s_or_b32 s54, s54, s46
    s_cmp_eq_u64 s[16:17], s[72:73]
    s_cselect_b32 s46, 0x1000, 0
    s_or_b32 s54, s54, s46
    s_cmp_eq_u64 s[18:19], s[72:73]
    s_cselect_b32 s46, 0x4000, 0
    s_or_b32 s54, s54, s46
    s_lshl_b32 s46, s54, s55
    s_mov_b32 s47, s46
    s_lshr_b64 s[46:47], s[46:47], s42
    v_mov_b32 v235, s46
    s_mov_b64 exec, 1
    ds_or_b32 v14, v235 offset:64
    s_mov_b64 exec, -1
    s_setprio 2
    s_cmp_lg_u32 s50, 0
    s_cbranch_scc1 L_sel0_ok
    s_mov_b32 s45, 0
    s_cmp_lg_u32 s51, 0
    s_cbranch_scc1 L_sel0
    s_mov_b32 s66, 0
    s_mov_b32 s50, 0x55555555
    s_branch L_sel0_ok
L_sel0:
    ds_read_b32 v235, v14 offset:64
    ds_read_b32 v13, v20 offset:60
    s_add_u32 s45, s45, 1
    s_waitcnt lgkmcnt(0)
    v_and_b32 v13, v13, v235
    s_cmp_gt_u32 s45, 0x40000
    s_cselect_b32 s46, -1, 0
    v_readfirstlane_b32 s50, v13
    s_nop 3
    s_or_b32 s50, s50, s46
    s_and_b32 s50, s50, s51
    s_cbranch_scc1 L_sel0_ok
    s_cmp_lg_u32 s54, 0x5555
    s_cbranch_scc1 L_sel0_p
    s_sleep 1
    s_branch L_sel0
L_sel0_p:
    s_load_dwordx16 s[4:19], s[26:27], s52 glc
    s_add_u32 s45, s45, 8
    s_waitcnt lgkmcnt(0)
    s_mov_b32 s54, 0
    s_cmp_eq_u64 s[4:5], s[72:73]
    s_cselect_b32 s46, 0x1, 0
    s_or_b32 s54, s54, s46
    s_cmp_eq_u64 s[6:7], s[72:73]
    s_cselect_b32 s46, 0x4, 0
    s_or_b32 s54, s54, s46
    s_cmp_eq_u64 s[8:9], s[72:73]
    s_cselect_b32 s46, 0x10, 0
    s_or_b32 s54, s54, s46
    s_cmp_eq_u64 s[10:11], s[72:73]
    s_cselect_b32 s46, 0x40, 0
    s_or_b32 s54, s54, s46
    s_cmp_eq_u64 s[12:13], s[72:73]
    s_cselect_b32 s46, 0x100, 0
    s_or_b32 s54, s54, s46
    s_cmp_eq_u64 s[14:15], s[72:73]
    s_cselect_b32 s46, 0x400, 0
    s_or_b32 s54, s54, s46
    s_cmp_eq_u64 s[16:17], s[72:73]
    s_cselect_b32 s46, 0x1000, 0
    s_or_b32 s54, s54, s46
    s_cmp_eq_u64 s[18:19], s[72:73]
    s_cselect_b32 s46, 0x4000, 0
    s_or_b32 s54, s54, s46
    s_lshl_b32 s46, s54, s55
    s_mov_b32 s47, s46
    s_lshr_b64 s[46:47], s[46:47], s42
    v_mov_b32 v235, s46
    s_mov_b64 exec, 1
    ds_or_b32 v14, v235 offset:64
    s_mov_b64 exec, -1
    s_branch L_sel0
L_sel0_ok:
    s_ff1_i32_b32 s46, s50
    s_bitset0_b32 s50, s46
    s_add_u32 s48, s46, s42
    s_and_b32 s48, s48, 31
    s_lshl_b32 s48, s48, 10
    s_bitset0_b32 s51, s46
    s_lshl_b32 s28, s46, 12
    buffer_load_dwordx4 v[24:27], v5, s[64:67], s48 offen offset:0 sc1
    buffer_load_dwordx4 v[28:31], v242, s[64:67], s48 offen offset:0 sc1
    buffer_load_dwordx4 v[32:35], v5, s[64:67], s48 offen offset:1024 sc1
    buffer_load_dwordx4 v[36:39], v242, s[64:67], s48 offen offset:1024 sc1
    s_cmp_lg_u32 s50, 0
    s_cbranch_scc1 L_sel1_ok
    s_mov_b32 s45, 0
    s_cmp_lg_u32 s51, 0
    s_cbranch_scc1 L_sel1
    s_mov_b32 s66, 0
    s_mov_b32 s50, 0x55555555
    s_branch L_sel1_ok
L_sel1:
    ds_read_b32 v235, v14 offset:64
    ds_read_b32 v13, v20 offset:60
    s_add_u32 s45, s45, 1
    s_waitcnt lgkmcnt(0)
    v_and_b32 v13, v13, v235
    s_cmp_gt_u32 s45, 0x40000
    s_cselect_b32 s46, -1, 0
    v_readfirstlane_b32 s50, v13
    s_nop 3
    s_or_b32 s50, s50, s46
    s_and_b32 s50, s50, s51
    s_cbranch_scc1 L_sel1_ok
    s_cmp_lg_u32 s54, 0x5555
    s_cbranch_scc1 L_sel1_p
    s_sleep 1
    s_branch L_sel1
L_sel1_p:
    s_load_dwordx16 s[4:19], s[26:27], s52 glc
    s_add_u32 s45, s45, 8
    s_waitcnt lgkmcnt(0)
    s_mov_b32 s54, 0
    s_cmp_eq_u64 s[4:5], s[72:73]
    s_cselect_b32 s46, 0x1, 0
    s_or_b32 s54, s54, s46
    s_cmp_eq_u64 s[6:7], s[72:73]
    s_cselect_b32 s46, 0x4, 0
    s_or_b32 s54, s54, s46
    s_cmp_eq_u64 s[8:9], s[72:73]
    s_cselect_b32 s46, 0x10, 0
    s_or_b32 s54, s54, s46
    s_cmp_eq_u64 s[10:11], s[72:73]
    s_cselect_b32 s46, 0x40, 0
    s_or_b32 s54, s54, s46
    s_cmp_eq_u64 s[12:13], s[72:73]
    s_cselect_b32 s46, 0x100, 0
    s_or_b32 s54, s54, s46
    s_cmp_eq_u64 s[14:15], s[72:73]
    s_cselect_b32 s46, 0x400, 0
    s_or_b32 s54, s54, s46
    s_cmp_eq_u64 s[16:17], s[72:73]
    s_cselect_b32 s46, 0x1000, 0
    s_or_b32 s54, s54, s46
    s_cmp_eq_u64 s[18:19], s[72:73]
    s_cselect_b32 s46, 0x4000, 0
    s_or_b32 s54, s54, s46
    s_lshl_b32 s46, s54, s55
    s_mov_b32 s47, s46
    s_lshr_b64 s[46:47], s[46:47], s42
    v_mov_b32 v235, s46
    s_mov_b64 exec, 1
    ds_or_b32 v14, v235 offset:64
    s_mov_b64 exec, -1
    s_branch L_sel1
L_sel1_ok:
    s_ff1_i32_b32 s46, s50
    s_bitset0_b32 s50, s46
    s_add_u32 s48, s46, s42
    s_and_b32 s48, s48, 31
    s_lshl_b32 s48, s48, 10
    s_bitset0_b32 s51, s46
    s_lshl_b32 s29, s46, 12
    buffer_load_dwordx4 v[40:43], v5, s[64:67], s48 offen offset:0 sc1
    buffer_load_dwordx4 v[44:47], v242, s[64:67], s48 offen offset:0 sc1
    buffer_load_dwordx4 v[48:51], v5, s[64:67], s48 offen offset:1024 sc1
    buffer_load_dwordx4 v[52:55], v242, s[64:67], s48 offen offset:1024 sc1
    s_cmp_lg_u32 s50, 0
    s_cbranch_scc1 L_sel2_ok
    s_mov_b32 s45, 0
    s_cmp_lg_u32 s51, 0
    s_cbranch_scc1 L_sel2
    s_mov_b32 s66, 0
    s_mov_b32 s50, 0x55555555
    s_branch L_sel2_ok
L_sel2:
    ds_read_b32 v235, v14 offset:64
    ds_read_b32 v13, v20 offset:60
    s_add_u32 s45, s45, 1
    s_waitcnt lgkmcnt(0)
    v_and_b32 v13, v13, v235
    s_cmp_gt_u32 s45, 0x40000
    s_cselect_b32 s46, -1, 0
    v_readfirstlane_b32 s50, v13
    s_nop 3
    s_or_b32 s50, s50, s46
    s_and_b32 s50, s50, s51
    s_cbranch_scc1 L_sel2_ok
    s_cmp_lg_u32 s54, 0x5555
    s_cbranch_scc1 L_sel2_p
    s_sleep 1
    s_branch L_sel2
L_sel2_p:
    s_load_dwordx16 s[4:19], s[26:27], s52 glc
    s_add_u32 s45, s45, 8
    s_waitcnt lgkmcnt(0)
    s_mov_b32 s54, 0
    s_cmp_eq_u64 s[4:5], s[72:73]
    s_cselect_b32 s46, 0x1, 0
    s_or_b32 s54, s54, s46
    s_cmp_eq_u64 s[6:7], s[72:73]
    s_cselect_b32 s46, 0x4, 0
    s_or_b32 s54, s54, s46
    s_cmp_eq_u64 s[8:9], s[72:73]
    s_cselect_b32 s46, 0x10, 0
    s_or_b32 s54, s54, s46
    s_cmp_eq_u64 s[10:11], s[72:73]
    s_cselect_b32 s46, 0x40, 0
    s_or_b32 s54, s54, s46
    s_cmp_eq_u64 s[12:13], s[72:73]
    s_cselect_b32 s46, 0x100, 0
    s_or_b32 s54, s54, s46
    s_cmp_eq_u64 s[14:15], s[72:73]
    s_cselect_b32 s46, 0x400, 0
    s_or_b32 s54, s54, s46
    s_cmp_eq_u64 s[16:17], s[72:73]
    s_cselect_b32 s46, 0x1000, 0
    s_or_b32 s54, s54, s46
    s_cmp_eq_u64 s[18:19], s[72:73]
    s_cselect_b32 s46, 0x4000, 0
    s_or_b32 s54, s54, s46
    s_lshl_b32 s46, s54, s55
    s_mov_b32 s47, s46
    s_lshr_b64 s[46:47], s[46:47], s42
    v_mov_b32 v235, s46
    s_mov_b64 exec, 1
    ds_or_b32 v14, v235 offset:64
    s_mov_b64 exec, -1
    s_branch L_sel2
L_sel2_ok:
    s_ff1_i32_b32 s46, s50
    s_bitset0_b32 s50, s46
    s_add_u32 s48, s46, s42
    s_and_b32 s48, s48, 31
    s_lshl_b32 s48, s48, 10
    s_bitset0_b32 s51, s46
    s_lshl_b32 s30, s46, 12
    buffer_load_dwordx4 v[56:59], v5, s[64:67], s48 offen offset:0 sc1
    buffer_load_dwordx4 v[60:63], v242, s[64:67], s48 offen offset:0 sc1
    buffer_load_dwordx4 v[64:67], v5, s[64:67], s48 offen offset:1024 sc1
    buffer_load_dwordx4 v[68:71], v242, s[64:67], s48 offen offset:1024 sc1
    v_add_u32 v8, s28, v236
    v_add_u32 v9, s28, v237
    v_add_u32 v10, s28, v238
    v_add_u32 v11, s28, v239
    ds_read_b64_tr_b16 v[88:89], v8 offset:0
    ds_read_b64_tr_b16 v[90:91], v8 offset:2048
    ds_read_b64_tr_b16 v[92:93], v9 offset:0
    ds_read_b64_tr_b16 v[94:95], v9 offset:2048
    ds_read_b64_tr_b16 v[96:97], v10 offset:0
    ds_read_b64_tr_b16 v[98:99], v10 offset:2048
    ds_read_b64_tr_b16 v[100:101], v11 offset:0
    ds_read_b64_tr_b16 v[102:103], v11 offset:2048
L_gloop:
    s_cmp_lg_u32 s50, 0
    s_cbranch_scc1 L_sel3_ok
    s_mov_b32 s45, 0
    s_cmp_lg_u32 s51, 0
    s_cbranch_scc1 L_sel3
    s_mov_b32 s66, 0
    s_mov_b32 s50, 0x55555555
    s_branch L_sel3_ok
L_sel3:
    ds_read_b32 v235, v14 offset:64
    ds_read_b32 v13, v20 offset:60
    s_add_u32 s45, s45, 1
    s_waitcnt lgkmcnt(0)
    v_and_b32 v13, v13, v235
    s_cmp_gt_u32 s45, 0x40000
    s_cselect_b32 s46, -1, 0
    v_readfirstlane_b32 s50, v13
    s_nop 3
    s_or_b32 s50, s50, s46
    s_and_b32 s50, s50, s51
    s_cbranch_scc1 L_sel3_ok
    s_cmp_lg_u32 s54, 0x5555
    s_cbranch_scc1 L_sel3_p
    s_sleep 1
    s_branch L_sel3
L_sel3_p:
    s_load_dwordx16 s[4:19], s[26:27], s52 glc
    s_add_u32 s45, s45, 8
    s_waitcnt lgkmcnt(0)
    s_mov_b32 s54, 0
    s_cmp_eq_u64 s[4:5], s[72:73]
    s_cselect_b32 s46, 0x1, 0
    s_or_b32 s54, s54, s46
    s_cmp_eq_u64 s[6:7], s[72:73]
    s_cselect_b32 s46, 0x4, 0
    s_or_b32 s54, s54, s46
    s_cmp_eq_u64 s[8:9], s[72:73]
    s_cselect_b32 s46, 0x10, 0
    s_or_b32 s54, s54, s46
    s_cmp_eq_u64 s[10:11], s[72:73]
    s_cselect_b32 s46, 0x40, 0
    s_or_b32 s54, s54, s46
    s_cmp_eq_u64 s[12:13], s[72:73]
    s_cselect_b32 s46, 0x100, 0
    s_or_b32 s54, s54, s46
    s_cmp_eq_u64 s[14:15], s[72:73]
    s_cselect_b32 s46, 0x400, 0
    s_or_b32 s54, s54, s46
    s_cmp_eq_u64 s[16:17], s[72:73]
    s_cselect_b32 s46, 0x1000, 0
    s_or_b32 s54, s54, s46
    s_cmp_eq_u64 s[18:19], s[72:73]
    s_cselect_b32 s46, 0x4000, 0
    s_or_b32 s54, s54, s46
    s_lshl_b32 s46, s54, s55
    s_mov_b32 s47, s46
    s_lshr_b64 s[46:47], s[46:47], s42
    v_mov_b32 v235, s46
    s_mov_b64 exec, 1
    ds_or_b32 v14, v235 offset:64
    s_mov_b64 exec, -1
    s_branch L_sel3
L_sel3_ok:
    s_waitcnt vmcnt(10) lgkmcnt(0)
    v_mfma_f32_16x16x32_bf16 v[120:123], v[88:91], v[24:27], v[120:123]
    ds_read_b64_tr_b16 v[104:105], v8 offset:4096
    ds_read_b64_tr_b16 v[106:107], v8 offset:6144
    v_mfma_f32_16x16x32_bf16 v[124:127], v[92:95], v[24:27], v[124:127]
    ds_read_b64_tr_b16 v[108:109], v9 offset:4096
    ds_read_b64_tr_b16 v[110:111], v9 offset:6144
    v_mfma_f32_16x16x32_bf16 v[128:131], v[96:99], v[24:27], v[128:131]
    ds_read_b64_tr_b16 v[112:113], v10 offset:4096
    ds_read_b64_tr_b16 v[114:115], v10 offset:6144
    v_mfma_f32_16x16x32_bf16 v[132:135], v[100:103], v[24:27], v[132:135]
    ds_read_b64_tr_b16 v[116:117], v11 offset:4096
    ds_read_b64_tr_b16 v[118:119], v11 offset:6144
    v_mfma_f32_16x16x32_bf16 v[136:139], v[88:91], v[28:31], v[136:139]
    v_add_u32 v244, s29, v236
    v_add_u32 v245, s29, v237
    v_mfma_f32_16x16x32_bf16 v[140:143], v[92:95], v[28:31], v[140:143]
    v_add_u32 v246, s29, v238
    v_add_u32 v247, s29, v239
    v_mfma_f32_16x16x32_bf16 v[144:147], v[96:99], v[28:31], v[144:147]
    s_ff1_i32_b32 s46, s50
    s_bitset0_b32 s50, s46
    s_add_u32 s48, s46, s42
    v_mfma_f32_16x16x32_bf16 v[148:151], v[100:103], v[28:31], v[148:151]
    s_and_b32 s48, s48, 31
    s_lshl_b32 s48, s48, 10
    s_bitset0_b32 s51, s46
    s_waitcnt vmcnt(8) lgkmcnt(0)
    v_mfma_f32_16x16x32_bf16 v[120:123], v[104:107], v[32:35], v[120:123]
    ds_read_b64_tr_b16 v[88:89], v244 offset:0
    ds_read_b64_tr_b16 v[90:91], v244 offset:2048
    v_mfma_f32_16x16x32_bf16 v[124:127], v[108:111], v[32:35], v[124:127]
    ds_read_b64_tr_b16 v[92:93], v245 offset:0
    ds_read_b64_tr_b16 v[94:95], v245 offset:2048
    v_mfma_f32_16x16x32_bf16 v[128:131], v[112:115], v[32:35], v[128:131]
    ds_read_b64_tr_b16 v[96:97], v246 offset:0
    ds_read_b64_tr_b16 v[98:99], v246 offset:2048
    v_mfma_f32_16x16x32_bf16 v[132:135], v[116:119], v[32:35], v[132:135]
    ds_read_b64_tr_b16 v[100:101], v247 offset:0
    ds_read_b64_tr_b16 v[102:103], v247 offset:2048
    v_mfma_f32_16x16x32_bf16 v[136:139], v[104:107], v[36:39], v[136:139]
    buffer_load_dwordx4 v[72:75], v5, s[64:67], s48 offen offset:0 sc1
    s_lshl_b32 s31, s46, 12
    v_mfma_f32_16x16x32_bf16 v[140:143], v[108:111], v[36:39], v[140:143]
    buffer_load_dwordx4 v[76:79], v242, s[64:67], s48 offen offset:0 sc1
    v_mfma_f32_16x16x32_bf16 v[144:147], v[112:115], v[36:39], v[144:147]
    buffer_load_dwordx4 v[80:83], v5, s[64:67], s48 offen offset:1024 sc1
    v_mfma_f32_16x16x32_bf16 v[148:151], v[116:119], v[36:39], v[148:151]
    buffer_load_dwordx4 v[84:87], v242, s[64:67], s48 offen offset:1024 sc1
    s_cmp_lg_u32 s50, 0
    s_cbranch_scc1 L_sel4_ok
    s_mov_b32 s45, 0
    s_cmp_lg_u32 s51, 0
    s_cbranch_scc1 L_sel4
    s_mov_b32 s66, 0
    s_mov_b32 s50, 0x55555555
    s_branch L_sel4_ok
L_sel4:
    ds_read_b32 v235, v14 offset:64
    ds_read_b32 v13, v20 offset:60
    s_add_u32 s45, s45, 1
    s_waitcnt lgkmcnt(0)
    v_and_b32 v13, v13, v235
    s_cmp_gt_u32 s45, 0x40000
    s_cselect_b32 s46, -1, 0
    v_readfirstlane_b32 s50, v13
    s_nop 3
    s_or_b32 s50, s50, s46
    s_and_b32 s50, s50, s51
    s_cbranch_scc1 L_sel4_ok
    s_cmp_lg_u32 s54, 0x5555
    s_cbranch_scc1 L_sel4_p
    s_sleep 1
    s_branch L_sel4
L_sel4_p:
    s_load_dwordx16 s[4:19], s[26:27], s52 glc
    s_add_u32 s45, s45, 8
    s_waitcnt lgkmcnt(0)
    s_mov_b32 s54, 0
    s_cmp_eq_u64 s[4:5], s[72:73]
    s_cselect_b32 s46, 0x1, 0
    s_or_b32 s54, s54, s46
    s_cmp_eq_u64 s[6:7], s[72:73]
    s_cselect_b32 s46, 0x4, 0
    s_or_b32 s54, s54, s46
    s_cmp_eq_u64 s[8:9], s[72:73]
    s_cselect_b32 s46, 0x10, 0
    s_or_b32 s54, s54, s46
    s_cmp_eq_u64 s[10:11], s[72:73]
    s_cselect_b32 s46, 0x40, 0
    s_or_b32 s54, s54, s46
    s_cmp_eq_u64 s[12:13], s[72:73]
    s_cselect_b32 s46, 0x100, 0
    s_or_b32 s54, s54, s46
    s_cmp_eq_u64 s[14:15], s[72:73]
    s_cselect_b32 s46, 0x400, 0
    s_or_b32 s54, s54, s46
    s_cmp_eq_u64 s[16:17], s[72:73]
    s_cselect_b32 s46, 0x1000, 0
    s_or_b32 s54, s54, s46
    s_cmp_eq_u64 s[18:19], s[72:73]
    s_cselect_b32 s46, 0x4000, 0
    s_or_b32 s54, s54, s46
    s_lshl_b32 s46, s54, s55
    s_mov_b32 s47, s46
    s_lshr_b64 s[46:47], s[46:47], s42
    v_mov_b32 v235, s46
    s_mov_b64 exec, 1
    ds_or_b32 v14, v235 offset:64
    s_mov_b64 exec, -1
    s_branch L_sel4
L_sel4_ok:
    s_waitcnt vmcnt(10) lgkmcnt(0)
    v_mfma_f32_16x16x32_bf16 v[120:123], v[88:91], v[40:43], v[120:123]
    ds_read_b64_tr_b16 v[104:105], v244 offset:4096
    ds_read_b64_tr_b16 v[106:107], v244 offset:6144
    v_mfma_f32_16x16x32_bf16 v[124:127], v[92:95], v[40:43], v[124:127]
    ds_read_b64_tr_b16 v[108:109], v245 offset:4096
    ds_read_b64_tr_b16 v[110:111], v245 offset:6144
    v_mfma_f32_16x16x32_bf16 v[128:131], v[96:99], v[40:43], v[128:131]
    ds_read_b64_tr_b16 v[112:113], v246 offset:4096
    ds_read_b64_tr_b16 v[114:115], v246 offset:6144
    v_mfma_f32_16x16x32_bf16 v[132:135], v[100:103], v[40:43], v[132:135]
    ds_read_b64_tr_b16 v[116:117], v247 offset:4096
    ds_read_b64_tr_b16 v[118:119], v247 offset:6144
    v_mfma_f32_16x16x32_bf16 v[136:139], v[88:91], v[44:47], v[136:139]
    v_add_u32 v8, s30, v236
    v_add_u32 v9, s30, v237
    v_mfma_f32_16x16x32_bf16 v[140:143], v[92:95], v[44:47], v[140:143]
    v_add_u32 v10, s30, v238
    v_add_u32 v11, s30, v239
    v_mfma_f32_16x16x32_bf16 v[144:147], v[96:99], v[44:47], v[144:147]
    s_ff1_i32_b32 s46, s50
    s_bitset0_b32 s50, s46
    s_add_u32 s48, s46, s42
    v_mfma_f32_16x16x32_bf16 v[148:151], v[100:103], v[44:47], v[148:151]
    s_and_b32 s48, s48, 31
    s_lshl_b32 s48, s48, 10
    s_bitset0_b32 s51, s46
    s_waitcnt vmcnt(8) lgkmcnt(0)
    v_mfma_f32_16x16x32_bf16 v[120:123], v[104:107], v[48:51], v[120:123]
    ds_read_b64_tr_b16 v[88:89], v8 offset:0
    ds_read_b64_tr_b16 v[90:91], v8 offset:2048
    v_mfma_f32_16x16x32_bf16 v[124:127], v[108:111], v[48:51], v[124:127]
    ds_read_b64_tr_b16 v[92:93], v9 offset:0
    ds_read_b64_tr_b16 v[94:95], v9 offset:2048
    v_mfma_f32_16x16x32_bf16 v[128:131], v[112:115], v[48:51], v[128:131]
    ds_read_b64_tr_b16 v[96:97], v10 offset:0
    ds_read_b64_tr_b16 v[98:99], v10 offset:2048
    v_mfma_f32_16x16x32_bf16 v[132:135], v[116:119], v[48:51], v[132:135]
    ds_read_b64_tr_b16 v[100:101], v11 offset:0
    ds_read_b64_tr_b16 v[102:103], v11 offset:2048
    v_mfma_f32_16x16x32_bf16 v[136:139], v[104:107], v[52:55], v[136:139]
    buffer_load_dwordx4 v[24:27], v5, s[64:67], s48 offen offset:0 sc1
    s_lshl_b32 s28, s46, 12
    v_mfma_f32_16x16x32_bf16 v[140:143], v[108:111], v[52:55], v[140:143]
    buffer_load_dwordx4 v[28:31], v242, s[64:67], s48 offen offset:0 sc1
    v_mfma_f32_16x16x32_bf16 v[144:147], v[112:115], v[52:55], v[144:147]
    buffer_load_dwordx4 v[32:35], v5, s[64:67], s48 offen offset:1024 sc1
    v_mfma_f32_16x16x32_bf16 v[148:151], v[116:119], v[52:55], v[148:151]
    buffer_load_dwordx4 v[36:39], v242, s[64:67], s48 offen offset:1024 sc1
    s_cmp_lg_u32 s50, 0
    s_cbranch_scc1 L_sel5_ok
    s_mov_b32 s45, 0
    s_cmp_lg_u32 s51, 0
    s_cbranch_scc1 L_sel5
    s_mov_b32 s66, 0
    s_mov_b32 s50, 0x55555555
    s_branch L_sel5_ok
L_sel5:
    ds_read_b32 v235, v14 offset:64
    ds_read_b32 v13, v20 offset:60
    s_add_u32 s45, s45, 1
    s_waitcnt lgkmcnt(0)
    v_and_b32 v13, v13, v235
    s_cmp_gt_u32 s45, 0x40000
    s_cselect_b32 s46, -1, 0
    v_readfirstlane_b32 s50, v13
    s_nop 3
    s_or_b32 s50, s50, s46
    s_and_b32 s50, s50, s51
    s_cbranch_scc1 L_sel5_ok
    s_cmp_lg_u32 s54, 0x5555
    s_cbranch_scc1 L_sel5_p
    s_sleep 1
    s_branch L_sel5
L_sel5_p:
    s_load_dwordx16 s[4:19], s[26:27], s52 glc
    s_add_u32 s45, s45, 8
    s_waitcnt lgkmcnt(0)
    s_mov_b32 s54, 0
    s_cmp_eq_u64 s[4:5], s[72:73]
    s_cselect_b32 s46, 0x1, 0
    s_or_b32 s54, s54, s46
    s_cmp_eq_u64 s[6:7], s[72:73]
    s_cselect_b32 s46, 0x4, 0
    s_or_b32 s54, s54, s46
    s_cmp_eq_u64 s[8:9], s[72:73]
    s_cselect_b32 s46, 0x10, 0
    s_or_b32 s54, s54, s46
    s_cmp_eq_u64 s[10:11], s[72:73]
    s_cselect_b32 s46, 0x40, 0
    s_or_b32 s54, s54, s46
    s_cmp_eq_u64 s[12:13], s[72:73]
    s_cselect_b32 s46, 0x100, 0
    s_or_b32 s54, s54, s46
    s_cmp_eq_u64 s[14:15], s[72:73]
    s_cselect_b32 s46, 0x400, 0
    s_or_b32 s54, s54, s46
    s_cmp_eq_u64 s[16:17], s[72:73]
    s_cselect_b32 s46, 0x1000, 0
    s_or_b32 s54, s54, s46
    s_cmp_eq_u64 s[18:19], s[72:73]
    s_cselect_b32 s46, 0x4000, 0
    s_or_b32 s54, s54, s46
    s_lshl_b32 s46, s54, s55
    s_mov_b32 s47, s46
    s_lshr_b64 s[46:47], s[46:47], s42
    v_mov_b32 v235, s46
    s_mov_b64 exec, 1
    ds_or_b32 v14, v235 offset:64
    s_mov_b64 exec, -1
    s_branch L_sel5
L_sel5_ok:
    s_waitcnt vmcnt(10) lgkmcnt(0)
    v_mfma_f32_16x16x32_bf16 v[120:123], v[88:91], v[56:59], v[120:123]
    ds_read_b64_tr_b16 v[104:105], v8 offset:4096
    ds_read_b64_tr_b16 v[106:107], v8 offset:6144
    v_mfma_f32_16x16x32_bf16 v[124:127], v[92:95], v[56:59], v[124:127]
    ds_read_b64_tr_b16 v[108:109], v9 offset:4096
    ds_read_b64_tr_b16 v[110:111], v9 offset:6144
    v_mfma_f32_16x16x32_bf16 v[128:131], v[96:99], v[56:59], v[128:131]
    ds_read_b64_tr_b16 v[112:113], v10 offset:4096
    ds_read_b64_tr_b16 v[114:115], v10 offset:6144
    v_mfma_f32_16x16x32_bf16 v[132:135], v[100:103], v[56:59], v[132:135]
    ds_read_b64_tr_b16 v[116:117], v11 offset:4096
    ds_read_b64_tr_b16 v[118:119], v11 offset:6144
    v_mfma_f32_16x16x32_bf16 v[136:139], v[88:91], v[60:63], v[136:139]
    v_add_u32 v244, s31, v236
    v_add_u32 v245, s31, v237
    v_mfma_f32_16x16x32_bf16 v[140:143], v[92:95], v[60:63], v[140:143]
    v_add_u32 v246, s31, v238
    v_add_u32 v247, s31, v239
    v_mfma_f32_16x16x32_bf16 v[144:147], v[96:99], v[60:63], v[144:147]
    s_ff1_i32_b32 s46, s50
    s_bitset0_b32 s50, s46
    s_add_u32 s48, s46, s42
    v_mfma_f32_16x16x32_bf16 v[148:151], v[100:103], v[60:63], v[148:151]
    s_and_b32 s48, s48, 31
    s_lshl_b32 s48, s48, 10
    s_bitset0_b32 s51, s46
    s_waitcnt vmcnt(8) lgkmcnt(0)
    v_mfma_f32_16x16x32_bf16 v[120:123], v[104:107], v[64:67], v[120:123]
    ds_read_b64_tr_b16 v[88:89], v244 offset:0
    ds_read_b64_tr_b16 v[90:91], v244 offset:2048
    v_mfma_f32_16x16x32_bf16 v[124:127], v[108:111], v[64:67], v[124:127]
    ds_read_b64_tr_b16 v[92:93], v245 offset:0
    ds_read_b64_tr_b16 v[94:95], v245 offset:2048
    v_mfma_f32_16x16x32_bf16 v[128:131], v[112:115], v[64:67], v[128:131]
    ds_read_b64_tr_b16 v[96:97], v246 offset:0
    ds_read_b64_tr_b16 v[98:99], v246 offset:2048
    v_mfma_f32_16x16x32_bf16 v[132:135], v[116:119], v[64:67], v[132:135]
    ds_read_b64_tr_b16 v[100:101], v247 offset:0
    ds_read_b64_tr_b16 v[102:103], v247 offset:2048
    v_mfma_f32_16x16x32_bf16 v[136:139], v[104:107], v[68:71], v[136:139]
    buffer_load_dwordx4 v[40:43], v5, s[64:67], s48 offen offset:0 sc1
    s_lshl_b32 s29, s46, 12
    v_mfma_f32_16x16x32_bf16 v[140:143], v[108:111], v[68:71], v[140:143]
    buffer_load_dwordx4 v[44:47], v242, s[64:67], s48 offen offset:0 sc1
    v_mfma_f32_16x16x32_bf16 v[144:147], v[112:115], v[68:71], v[144:147]
    buffer_load_dwordx4 v[48:51], v5, s[64:67], s48 offen offset:1024 sc1
    v_mfma_f32_16x16x32_bf16 v[148:151], v[116:119], v[68:71], v[148:151]
    buffer_load_dwordx4 v[52:55], v242, s[64:67], s48 offen offset:1024 sc1
    s_cmp_lg_u32 s50, 0
    s_cbranch_scc1 L_sel6_ok
    s_mov_b32 s45, 0
    s_cmp_lg_u32 s51, 0
    s_cbranch_scc1 L_sel6
    s_mov_b32 s66, 0
    s_mov_b32 s50, 0x55555555
    s_branch L_sel6_ok
L_sel6:
    ds_read_b32 v235, v14 offset:64
    ds_read_b32 v13, v20 offset:60
    s_add_u32 s45, s45, 1
    s_waitcnt lgkmcnt(0)
    v_and_b32 v13, v13, v235
    s_cmp_gt_u32 s45, 0x40000
    s_cselect_b32 s46, -1, 0
    v_readfirstlane_b32 s50, v13
    s_nop 3
    s_or_b32 s50, s50, s46
    s_and_b32 s50, s50, s51
    s_cbranch_scc1 L_sel6_ok
    s_cmp_lg_u32 s54, 0x5555
    s_cbranch_scc1 L_sel6_p
    s_sleep 1
    s_branch L_sel6
L_sel6_p:
    s_load_dwordx16 s[4:19], s[26:27], s52 glc
    s_add_u32 s45, s45, 8
    s_waitcnt lgkmcnt(0)
    s_mov_b32 s54, 0
    s_cmp_eq_u64 s[4:5], s[72:73]
    s_cselect_b32 s46, 0x1, 0
    s_or_b32 s54, s54, s46
    s_cmp_eq_u64 s[6:7], s[72:73]
    s_cselect_b32 s46, 0x4, 0
    s_or_b32 s54, s54, s46
    s_cmp_eq_u64 s[8:9], s[72:73]
    s_cselect_b32 s46, 0x10, 0
    s_or_b32 s54, s54, s46
    s_cmp_eq_u64 s[10:11], s[72:73]
    s_cselect_b32 s46, 0x40, 0
    s_or_b32 s54, s54, s46
    s_cmp_eq_u64 s[12:13], s[72:73]
    s_cselect_b32 s46, 0x100, 0
    s_or_b32 s54, s54, s46
    s_cmp_eq_u64 s[14:15], s[72:73]
    s_cselect_b32 s46, 0x400, 0
    s_or_b32 s54, s54, s46
    s_cmp_eq_u64 s[16:17], s[72:73]
    s_cselect_b32 s46, 0x1000, 0
    s_or_b32 s54, s54, s46
    s_cmp_eq_u64 s[18:19], s[72:73]
    s_cselect_b32 s46, 0x4000, 0
    s_or_b32 s54, s54, s46
    s_lshl_b32 s46, s54, s55
    s_mov_b32 s47, s46
    s_lshr_b64 s[46:47], s[46:47], s42
    v_mov_b32 v235, s46
    s_mov_b64 exec, 1
    ds_or_b32 v14, v235 offset:64
    s_mov_b64 exec, -1
    s_branch L_sel6
L_sel6_ok:
    s_waitcnt vmcnt(10) lgkmcnt(0)
    v_mfma_f32_16x16x32_bf16 v[120:123], v[88:91], v[72:75], v[120:123]
    ds_read_b64_tr_b16 v[104:105], v244 offset:4096
    ds_read_b64_tr_b16 v[106:107], v244 offset:6144
    v_mfma_f32_16x16x32_bf16 v[124:127], v[92:95], v[72:75], v[124:127]
    ds_read_b64_tr_b16 v[108:109], v245 offset:4096
    ds_read_b64_tr_b16 v[110:111], v245 offset:6144
    v_mfma_f32_16x16x32_bf16 v[128:131], v[96:99], v[72:75], v[128:131]
    ds_read_b64_tr_b16 v[112:113], v246 offset:4096
    ds_read_b64_tr_b16 v[114:115], v246 offset:6144
    v_mfma_f32_16x16x32_bf16 v[132:135], v[100:103], v[72:75], v[132:135]
    ds_read_b64_tr_b16 v[116:117], v247 offset:4096
    ds_read_b64_tr_b16 v[118:119], v247 offset:6144
    v_mfma_f32_16x16x32_bf16 v[136:139], v[88:91], v[76:79], v[136:139]
    v_add_u32 v8, s28, v236
    v_add_u32 v9, s28, v237
    v_mfma_f32_16x16x32_bf16 v[140:143], v[92:95], v[76:79], v[140:143]
    v_add_u32 v10, s28, v238
    v_add_u32 v11, s28, v239
    v_mfma_f32_16x16x32_bf16 v[144:147], v[96:99], v[76:79], v[144:147]
    s_ff1_i32_b32 s46, s50
    s_bitset0_b32 s50, s46
    s_add_u32 s48, s46, s42
    v_mfma_f32_16x16x32_bf16 v[148:151], v[100:103], v[76:79], v[148:151]
    s_and_b32 s48, s48, 31
    s_lshl_b32 s48, s48, 10
    s_bitset0_b32 s51, s46
    s_waitcnt vmcnt(8) lgkmcnt(0)
    v_mfma_f32_16x16x32_bf16 v[120:123], v[104:107], v[80:83], v[120:123]
    ds_read_b64_tr_b16 v[88:89], v8 offset:0
    ds_read_b64_tr_b16 v[90:91], v8 offset:2048
    v_mfma_f32_16x16x32_bf16 v[124:127], v[108:111], v[80:83], v[124:127]
    ds_read_b64_tr_b16 v[92:93], v9 offset:0
    ds_read_b64_tr_b16 v[94:95], v9 offset:2048
    v_mfma_f32_16x16x32_bf16 v[128:131], v[112:115], v[80:83], v[128:131]
    ds_read_b64_tr_b16 v[96:97], v10 offset:0
    ds_read_b64_tr_b16 v[98:99], v10 offset:2048
    v_mfma_f32_16x16x32_bf16 v[132:135], v[116:119], v[80:83], v[132:135]
    ds_read_b64_tr_b16 v[100:101], v11 offset:0
    ds_read_b64_tr_b16 v[102:103], v11 offset:2048
    v_mfma_f32_16x16x32_bf16 v[136:139], v[104:107], v[84:87], v[136:139]
    buffer_load_dwordx4 v[56:59], v5, s[64:67], s48 offen offset:0 sc1
    buffer_load_dwordx4 v[60:63], v242, s[64:67], s48 offen offset:0 sc1
    v_mfma_f32_16x16x32_bf16 v[140:143], v[108:111], v[84:87], v[140:143]
    s_lshl_b32 s30, s46, 12
    buffer_load_dwordx4 v[64:67], v5, s[64:67], s48 offen offset:1024 sc1
    v_mfma_f32_16x16x32_bf16 v[144:147], v[112:115], v[84:87], v[144:147]
    s_add_u32 s53, s53, 1
    buffer_load_dwordx4 v[68:71], v242, s[64:67], s48 offen offset:1024 sc1
    v_mfma_f32_16x16x32_bf16 v[148:151], v[116:119], v[84:87], v[148:151]
    s_cmp_lt_u32 s53, 4
    s_cbranch_scc1 L_gloop
    s_lshl_b32 s48, s59, 16
    s_lshl_b32 s49, s35, 7
    s_add_u32 s48, s48, s49
    s_add_u32 s49, s48, 0x8000
    s_add_u32 s50, s48, 0x10000
    s_add_u32 s51, s48, 0x18000
    s_waitcnt lgkmcnt(0)
    v_cvt_pk_bf16_f32 v172, v120, v121
    v_cvt_pk_bf16_f32 v173, v122, v123
    v_cvt_pk_bf16_f32 v174, v124, v125
    v_cvt_pk_bf16_f32 v175, v126, v127
    v_cvt_pk_bf16_f32 v176, v128, v129
    v_cvt_pk_bf16_f32 v177, v130, v131
    v_cvt_pk_bf16_f32 v178, v132, v133
    v_cvt_pk_bf16_f32 v179, v134, v135
    v_cvt_pk_bf16_f32 v180, v136, v137
    v_cvt_pk_bf16_f32 v181, v138, v139
    v_cvt_pk_bf16_f32 v182, v140, v141
    v_cvt_pk_bf16_f32 v183, v142, v143
    v_cvt_pk_bf16_f32 v184, v144, v145
    v_cvt_pk_bf16_f32 v185, v146, v147
    v_cvt_pk_bf16_f32 v186, v148, v149
    v_cvt_pk_bf16_f32 v187, v150, v151
    s_nop 1
    v_permlane16_swap_b32 v172, v174
    v_permlane16_swap_b32 v173, v175
    v_permlane16_swap_b32 v176, v178
    v_permlane16_swap_b32 v177, v179
    v_permlane16_swap_b32 v180, v182
    v_permlane16_swap_b32 v181, v183
    v_permlane16_swap_b32 v184, v186
    v_permlane16_swap_b32 v185, v187
    ds_write_b128 v15, v[172:175]
    ds_write_b128 v18, v[176:179]
    ds_read_b128 v[88:91], v16 offset:0
    ds_read_b128 v[92:95], v16 offset:1024
    ds_write_b128 v15, v[180:183]
    ds_write_b128 v18, v[184:187]
    ds_read_b128 v[96:99], v16 offset:0
    ds_read_b128 v[100:103], v16 offset:1024
    s_waitcnt lgkmcnt(5)
    buffer_store_dwordx4 v[88:91], v17, s[68:71], s48 offen sc1
    s_waitcnt lgkmcnt(4)
    buffer_store_dwordx4 v[92:95], v17, s[68:71], s49 offen sc1
    s_waitcnt lgkmcnt(1)
    buffer_store_dwordx4 v[96:99], v17, s[68:71], s50 offen sc1
    s_waitcnt lgkmcnt(0)
    buffer_store_dwordx4 v[100:103], v17, s[68:71], s51 offen sc1
    s_endpgm
L_exit:
    s_endpgm
L_code_end:
.section .rodata,"a"
.p2align 6
.amdhsa_kernel concat_heads__linear_attn_block__ssm_conv_h3__prompt_kernel
  .amdhsa_next_free_vgpr 256
  .amdhsa_next_free_sgpr 102
  .amdhsa_accum_offset 256
  .amdhsa_group_segment_fixed_size 0
  .amdhsa_kernarg_size 96
  .amdhsa_user_sgpr_count 2
  .amdhsa_user_sgpr_kernarg_segment_ptr 1
  .amdhsa_system_sgpr_workgroup_id_x 1
.end_amdhsa_kernel
```

```asm
; @launch grid=(256,1,1) block=(512,1,1) lds=163840
.amdgcn_target "amdgcn-amd-amdhsa--gfx950"
.text
.globl concat_heads__linear_attn_block__ssm_conv_h3__prompt_kernel
.type concat_heads__linear_attn_block__ssm_conv_h3__prompt_kernel,@function
.p2align 8
concat_heads__linear_attn_block__ssm_conv_h3__prompt_kernel:
    s_cmp_ge_u32 s2, 256
    s_cbranch_scc1 L_exit
    s_load_dwordx16 s[4:19], s[0:1], 0
    s_load_dwordx8 s[20:27], s[0:1], 64
    s_getpc_b64 s[48:49]
L_pc:
    s_and_b32 s45, s2, 24
    s_lshl_b32 s45, s45, 4
    v_lshl_add_u32 v2, v0, 9, s45
    v_cmp_gt_u32 vcc, L_code_end-L_pc-4, v2
    s_and_saveexec_b64 s[50:51], vcc
    s_cbranch_execz L_pf
    global_load_dword v252, v2, s[48:49]
L_pf:
    s_mov_b64 exec, s[50:51]
    v_lshrrev_b32 v1, 6, v0
    v_and_b32 v4, 63, v0
    v_readfirstlane_b32 s3, v1
    v_lshlrev_b32 v5, 4, v4
    s_and_b32 s28, s2, 7
    s_lshr_b32 s29, s2, 3
    s_and_b32 s30, s28, 1
    s_lshl_b32 s30, s30, 3
    s_and_b32 s40, s29, 7
    s_add_u32 s30, s30, s40
    s_lshr_b32 s40, s28, 1
    s_and_b32 s41, s28, 4
    s_and_b32 s42, s28, 2
    s_lshl2_add_u32 s41, s42, s41
    s_lshr_b32 s42, s29, 3
    s_add_u32 s32, s41, s42
    s_add_u32 s42, s42, 3
    s_and_b32 s42, s42, 3
    s_add_u32 s31, s41, s42
    s_and_b32 s41, s30, 1
    s_lshl_b32 s33, s41, 1
    s_and_b32 s41, s30, 2
    s_lshl_b32 s41, s41, 2
    s_add_u32 s33, s33, s41
    s_and_b32 s41, s28, 1
    s_lshl_b32 s41, s41, 2
    s_add_u32 s33, s33, s41
    s_and_b32 s41, s31, 1
    s_lshl_b32 s41, s41, 1
    s_add_u32 s33, s33, s41
    s_lshl_b32 s41, s40, 2
    s_add_u32 s33, s33, s41
    s_and_b32 s33, s33, 15
    s_cmp_lt_u32 s3, 4
    s_cbranch_scc1 L_comp
    s_sub_u32 s3, s3, 4
    v_lshrrev_b32 v1, 3, v4
    v_and_b32 v2, 7, v4
    v_lshrrev_b32 v3, 4, v4
    v_xor_b32 v6, v2, v3
    v_lshlrev_b32 v6, 4, v6
    v_lshl_add_u32 v6, v1, 11, v6
    s_lshl_b32 s60, s30, 7
    s_lshl_b32 s61, s3, 5
    s_add_u32 s60, s60, s61
    s_lshl_b32 s60, s60, 11
    v_add_u32 v8, s60, v6
    v_xor_b32 v6, 64, v8
    v_add_u32 v9, 15360, v6
    v_add_u32 v10, 30720, v8
    v_add_u32 v11, 46080, v6
    v_and_b32 v3, 1, v3
    v_lshlrev_b32 v3, 2, v3
    v_xor_b32 v7, v2, v3
    v_lshlrev_b32 v7, 4, v7
    v_xor_b32 v6, 32, v7
    s_movk_i32 s61, 6144
    v_mad_u32_u24 v7, v1, s61, v7
    v_mad_u32_u24 v6, v1, s61, v6
    s_mul_i32 s60, s3, 98304
    v_add_u32 v12, s60, v7
    s_add_u32 s60, s60, 48128
    v_add_u32 v13, s60, v6
    s_lshl_b32 s65, s3, 12
    s_lshl_b32 s66, s3, 11
    s_add_u32 s66, s66, 0x4000
    s_mov_b32 s64, 0
    s_mov_b32 s67, s33
    s_lshl_b32 s74, s32, 7
    s_lshl_b32 s75, s31, 7
    s_add_u32 s75, s75, 2048
    s_mov_b32 s42, 0x400000
    s_mov_b32 s43, 0x20000
    s_mov_b32 s46, 0x600000
    s_mov_b32 s47, 0x20000
    s_waitcnt lgkmcnt(0)
    s_mov_b64 s[40:41], s[4:5]
    s_mov_b64 s[44:45], s[6:7]
    s_add_u32 m0, s64, s65
    s_lshl_b32 s60, s67, 7
    s_mul_i32 s63, s67, 393216
    buffer_load_dwordx4 v8, s[40:43], s60 offen offset:0  lds
    buffer_load_dwordx4 v9, s[40:43], s60 offen offset:1024  lds
    buffer_load_dwordx4 v10, s[40:43], s60 offen offset:2048  lds
    buffer_load_dwordx4 v11, s[40:43], s60 offen offset:3072  lds
    s_add_u32 m0, s64, s66
    s_add_u32 s61, s63, s74
    s_add_u32 s62, s63, s75
    buffer_load_dwordx4 v12, s[44:47], s61 offen offset:0  lds
    buffer_load_dwordx4 v13, s[44:47], s61 offen offset:1024  lds
    s_add_u32 m0, m0, 8192
    s_add_u32 s63, s62, 2048
    buffer_load_dwordx4 v12, s[44:47], s62 offen offset:0  lds
    buffer_load_dwordx4 v13, s[44:47], s62 offen offset:1024  lds
    s_add_u32 m0, m0, 8192
    s_add_u32 s67, s67, 1
    buffer_load_dwordx4 v12, s[44:47], s63 offen offset:0  lds
    buffer_load_dwordx4 v13, s[44:47], s63 offen offset:1024  lds
    s_and_b32 s67, s67, 15
    s_add_u32 s64, s64, 40960
    s_cmp_eq_u32 s64, 122880
    s_cselect_b32 s64, 0, s64
    s_barrier
    s_and_b32 s34, s28, 3
    s_lshl_b32 s34, s34, 2
    s_and_b32 vcc_lo, s29, 3
    s_add_u32 s34, s34, vcc_lo
    s_lshr_b32 s35, s28, 2
    s_lshl_b32 s35, s35, 3
    s_lshr_b32 vcc_lo, s29, 2
    s_add_u32 s35, s35, vcc_lo
    s_and_b32 s36, s29, 15
    s_lshr_b32 s37, s29, 4
    s_lshl_b32 vcc_lo, s28, 1
    s_add_u32 s37, s37, vcc_lo
    s_lshl_b32 s38, s28, 5
    s_add_u32 s38, s38, s29
    s_lshl_b32 s38, s38, 2
    v_mov_b32 v6, 0
    v_mov_b32 v14, 1
    v_mov_b32 v15, 162816
    v_lshlrev_b32 v255, 7, v4
    s_nop 0
    s_mov_b32 s48, s26
    s_mov_b32 s49, s27
    s_mov_b32 s50, 0x2000000
    s_mov_b32 s51, 0x20000
    s_mov_b32 s52, s24
    s_mov_b32 s53, s25
    s_mov_b32 s54, 0x100
    s_mov_b32 s55, 0x20000
    s_or_b32 s60, s2, s3
    s_cmp_eq_u32 s60, 0
    s_cbranch_scc0 L_noep
    s_memrealtime s[60:61]
    s_waitcnt lgkmcnt(0)
    s_or_b32 s60, s60, 1
    v_mov_b32 v7, s60
    s_mov_b64 exec, 1
    buffer_store_dword v7, v6, s[52:55], 0 offen sc1
    s_mov_b64 exec, -1
L_noep:
    s_mul_i32 s68, s3, 4608
    s_add_u32 s68, s68, 139776
    s_lshl_b32 s69, s37, 7
    s_lshl_b32 s70, s3, 5
    s_add_u32 s69, s69, s70
    v_lshrrev_b32 v28, 4, v4
    v_bfe_u32 v29, v4, 2, 2
    v_and_b32 v30, 3, v4
    v_and_b32 v31, 15, v4
    s_lshl_b32 s60, s3, 12
    s_add_u32 s60, s60, 139776
    v_add_u32 v247, s60, v5
    s_and_b32 s60, s3, 1
    s_lshl_b32 s60, s60, 6
    v_xor_b32 v247, s60, v247
    v_xor_b32 v248, 16, v247
    v_xor_b32 v249, 32, v247
    v_xor_b32 v250, 48, v247
    v_lshlrev_b32 v3, 12, v28
    v_lshl_add_u32 v25, v31, 4, v3
    s_lshl_b32 s60, s36, 18
    s_lshl_b32 s61, s3, 16
    s_add_u32 s60, s60, s61
    s_lshl_b32 s61, s37, 8
    s_sub_u32 s60, s60, s61
    s_add_u32 s60, s60, 3840
    v_add_u32 v25, s60, v25
    v_lshlrev_b32 v26, 5, v4
    v_and_b32 v3, 1, v28
    v_lshlrev_b32 v3, 2, v3
    v_xor_b32 v3, v2, v3
    v_lshrrev_b32 v27, 5, v4
    v_lshlrev_b32 v27, 1, v27
    v_xor_b32 v3, v27, v3
    v_lshlrev_b32 v3, 4, v3
    v_lshl_add_u32 v3, v1, 11, v3
    s_lshl_b32 s60, s35, 7
    v_add_u32 v20, s60, v3
    v_add_u32 v21, 15360, v20
    v_add_u32 v22, 30720, v20
    v_add_u32 v23, 46080, v20
    s_mov_b32 s70, 0xffff0000
    v_and_b32 v3, 1, v28
    s_movk_i32 s60, 2304
    v_mul_u32_u24 v3, s60, v3
    v_lshl_add_u32 v3, v31, 4, v3
    v_add_u32 v251, s68, v3
    s_mul_i32 s71, s3, 8320
    s_add_u32 s71, s71, 98304
    v_add_u32 v19, s71, v5
    s_movk_i32 s61, 4160
    v_and_b32 v24, 1, v29
    v_mul_u32_u24 v24, s61, v24
    v_lshl_add_u32 v24, v30, 4, v24
    v_add_u32 v24, s71, v24
    v_add_u32 v3, 1, v31
    v_and_b32 v16, 1, v3
    v_add_u32 v17, v16, v31
    v_mul_u32_u24 v3, s61, v16
    v_lshl_add_u32 v3, v28, 5, v3
    v_lshlrev_b32 v17, 1, v17
    v_sub_u32 v3, v3, v17
    s_add_u32 s60, s71, 3486
    v_add_u32 v240, s60, v3
    v_subrev_u32 v241, 1024, v240
    v_subrev_u32 v242, 2048, v240
    v_subrev_u32 v243, 3072, v240
    v_add_u32 v3, v31, v28
    s_add_u32 s60, s68, 208
    v_lshlrev_b32 v3, 4, v3
    v_add_u32 v244, s60, v3
    v_lshlrev_b32 v3, 5, v31
    v_lshl_add_u32 v16, v28, 3, v3
    s_add_u32 s60, s71, 504
    v_sub_u32 v245, s60, v16
    v_and_b32 v16, 1, v28
    v_lshl_add_u32 v3, v16, 9, v3
    v_lshrrev_b32 v16, 5, v4
    v_lshl_add_u32 v246, v16, 4, v3
    v_lshlrev_b32 v27, 4, v2
    v_lshl_add_u32 v16, v1, 11, v27
    v_lshl_add_u32 v17, v1, 12, v27
    s_add_u32 s39, s38, s3
    s_and_b32 s60, s39, 0xfffffffe
    s_lshl_b32 s60, s60, 1
    s_load_dword s71, s[20:21], s60
    s_lshl_b32 s61, s39, 12
    v_mov_b64 v[160:161], 0
    v_mov_b64 v[162:163], 0
    v_mov_b64 v[164:165], 0
    v_mov_b64 v[166:167], 0
    v_mov_b64 v[168:169], 0
    v_mov_b64 v[170:171], 0
    v_mov_b64 v[172:173], 0
    v_mov_b64 v[174:175], 0
    v_mov_b64 v[176:177], 0
    v_mov_b64 v[178:179], 0
    v_mov_b64 v[180:181], 0
    v_mov_b64 v[182:183], 0
    v_mov_b64 v[184:185], 0
    v_mov_b64 v[186:187], 0
    v_mov_b64 v[188:189], 0
    v_mov_b64 v[190:191], 0
    s_add_u32 s52, s18, s61
    s_addc_u32 s53, s19, 0
    s_mov_b32 s54, 0x1000
    s_mov_b32 s55, 0x20000
    s_mov_b32 s56, s8
    s_mov_b32 s57, s9
    s_mov_b32 s58, 0x200000
    s_mov_b32 s59, 0x20000
    s_waitcnt lgkmcnt(0)
    s_mov_b32 s20, s10
    s_mov_b32 s21, s11
    s_waitcnt vmcnt(0)
    s_barrier
    s_add_u32 m0, s64, s65
    s_lshl_b32 s60, s67, 7
    s_mul_i32 s63, s67, 393216
    buffer_load_dwordx4 v8, s[40:43], s60 offen offset:0  lds
    buffer_load_dwordx4 v9, s[40:43], s60 offen offset:1024  lds
    buffer_load_dwordx4 v10, s[40:43], s60 offen offset:2048  lds
    buffer_load_dwordx4 v11, s[40:43], s60 offen offset:3072  lds
    s_add_u32 m0, s64, s66
    s_add_u32 s61, s63, s74
    s_add_u32 s62, s63, s75
    buffer_load_dwordx4 v12, s[44:47], s61 offen offset:0  lds
    buffer_load_dwordx4 v13, s[44:47], s61 offen offset:1024  lds
    s_add_u32 m0, m0, 8192
    s_add_u32 s63, s62, 2048
    buffer_load_dwordx4 v12, s[44:47], s62 offen offset:0  lds
    buffer_load_dwordx4 v13, s[44:47], s62 offen offset:1024  lds
    s_add_u32 m0, m0, 8192
    s_add_u32 s67, s67, 1
    buffer_load_dwordx4 v12, s[44:47], s63 offen offset:0  lds
    buffer_load_dwordx4 v13, s[44:47], s63 offen offset:1024  lds
    s_and_b32 s67, s67, 15
    s_add_u32 s64, s64, 40960
    s_cmp_eq_u32 s64, 122880
    s_cselect_b32 s64, 0, s64
    s_add_u32 m0, s64, s65
    s_lshl_b32 s60, s67, 7
    s_mul_i32 s63, s67, 393216
    buffer_load_dwordx4 v8, s[40:43], s60 offen offset:0  lds
    buffer_load_dwordx4 v9, s[40:43], s60 offen offset:1024  lds
    buffer_load_dwordx4 v10, s[40:43], s60 offen offset:2048  lds
    buffer_load_dwordx4 v11, s[40:43], s60 offen offset:3072  lds
    s_add_u32 m0, s64, s66
    s_add_u32 s61, s63, s74
    s_add_u32 s62, s63, s75
    buffer_load_dwordx4 v12, s[44:47], s61 offen offset:0  lds
    buffer_load_dwordx4 v13, s[44:47], s61 offen offset:1024  lds
    s_add_u32 m0, m0, 8192
    s_add_u32 s63, s62, 2048
    buffer_load_dwordx4 v12, s[44:47], s62 offen offset:0  lds
    buffer_load_dwordx4 v13, s[44:47], s62 offen offset:1024  lds
    s_add_u32 m0, m0, 8192
    s_add_u32 s67, s67, 1
    buffer_load_dwordx4 v12, s[44:47], s63 offen offset:0  lds
    buffer_load_dwordx4 v13, s[44:47], s63 offen offset:1024  lds
    s_and_b32 s67, s67, 15
    s_add_u32 s64, s64, 40960
    s_cmp_eq_u32 s64, 122880
    s_cselect_b32 s64, 0, s64
    s_waitcnt vmcnt(10)
    s_barrier
    s_add_u32 m0, s64, s65
    s_lshl_b32 s60, s67, 7
    s_mul_i32 s63, s67, 393216
    buffer_load_dwordx4 v8, s[40:43], s60 offen offset:0  lds
    buffer_load_dwordx4 v9, s[40:43], s60 offen offset:1024  lds
    buffer_load_dwordx4 v10, s[40:43], s60 offen offset:2048  lds
    buffer_load_dwordx4 v11, s[40:43], s60 offen offset:3072  lds
    s_add_u32 m0, s64, s66
    s_add_u32 s61, s63, s74
    s_add_u32 s62, s63, s75
    buffer_load_dwordx4 v12, s[44:47], s61 offen offset:0  lds
    buffer_load_dwordx4 v13, s[44:47], s61 offen offset:1024  lds
    s_add_u32 m0, m0, 8192
    s_add_u32 s63, s62, 2048
    buffer_load_dwordx4 v12, s[44:47], s62 offen offset:0  lds
    buffer_load_dwordx4 v13, s[44:47], s62 offen offset:1024  lds
    s_add_u32 m0, m0, 8192
    s_add_u32 s67, s67, 1
    buffer_load_dwordx4 v12, s[44:47], s63 offen offset:0  lds
    buffer_load_dwordx4 v13, s[44:47], s63 offen offset:1024  lds
    s_and_b32 s67, s67, 15
    s_add_u32 s64, s64, 40960
    s_cmp_eq_u32 s64, 122880
    s_cselect_b32 s64, 0, s64
    s_waitcnt vmcnt(10)
    s_barrier
    s_add_u32 m0, s64, s65
    s_lshl_b32 s60, s67, 7
    s_mul_i32 s63, s67, 393216
    buffer_load_dwordx4 v8, s[40:43], s60 offen offset:0  lds
    buffer_load_dwordx4 v9, s[40:43], s60 offen offset:1024  lds
    buffer_load_dwordx4 v10, s[40:43], s60 offen offset:2048  lds
    buffer_load_dwordx4 v11, s[40:43], s60 offen offset:3072  lds
    s_add_u32 m0, s64, s66
    s_add_u32 s61, s63, s74
    s_add_u32 s62, s63, s75
    buffer_load_dwordx4 v12, s[44:47], s61 offen offset:0  lds
    buffer_load_dwordx4 v13, s[44:47], s61 offen offset:1024  lds
    s_add_u32 m0, m0, 8192
    s_add_u32 s63, s62, 2048
    buffer_load_dwordx4 v12, s[44:47], s62 offen offset:0  lds
    buffer_load_dwordx4 v13, s[44:47], s62 offen offset:1024  lds
    s_add_u32 m0, m0, 8192
    s_add_u32 s67, s67, 1
    buffer_load_dwordx4 v12, s[44:47], s63 offen offset:0  lds
    buffer_load_dwordx4 v13, s[44:47], s63 offen offset:1024  lds
    s_and_b32 s67, s67, 15
    s_add_u32 s64, s64, 40960
    s_cmp_eq_u32 s64, 122880
    s_cselect_b32 s64, 0, s64
    s_load_dword s72, s[24:25], 0
    s_lshl_b32 s33, s39, 7
    s_add_u32 s33, s33, 0x940000
    s_lshl_b32 s39, s39, 12
    s_lshl_b32 s60, s69, 11
    s_lshl_b32 s61, s36, 7
    s_add_u32 s60, s60, s61
    s_add_u32 s0, s20, s60
    s_addc_u32 s1, s21, 0
    s_lshl2_add_u32 s60, s29, s3
    s_lshl_b32 s60, s60, 14
    s_and_b32 s61, s28, 4
    s_lshl_b32 s61, s61, 8
    s_add_u32 s60, s60, s61
    s_add_u32 s6, s56, s60
    s_addc_u32 s7, s57, 0
    s_lshl2_add_u32 s60, s2, s3
    s_lshl_b32 s60, s60, 11
    s_add_u32 s8, s56, s60
    s_addc_u32 s9, s57, 0
    s_waitcnt vmcnt(10)
    s_barrier
    s_waitcnt lgkmcnt(0)
    s_mov_b32 s60, 0
L_eploop:
    s_cmp_lg_u32 s72, 0
    s_cbranch_scc1 L_epok
    s_sleep 8
    s_load_dword s72, s[24:25], 0 glc
    s_add_u32 s60, s60, 1
    s_cmp_gt_u32 s60, 0x4000
    s_waitcnt lgkmcnt(0)
    s_cbranch_scc0 L_eploop
L_epok:
    s_mov_b32 s73, s72
    v_mov_b32 v7, s72
    ds_write_b32 v15, v7 offset:56
    ds_write_b128 v251, v[160:163]
    s_add_u32 m0, s64, s65
    s_lshl_b32 s60, s67, 7
    s_mul_i32 s63, s67, 393216
    buffer_load_dwordx4 v8, s[40:43], s60 offen offset:0  lds
    buffer_load_dwordx4 v9, s[40:43], s60 offen offset:1024  lds
    buffer_load_dwordx4 v10, s[40:43], s60 offen offset:2048  lds
    buffer_load_dwordx4 v11, s[40:43], s60 offen offset:3072  lds
    s_add_u32 m0, s64, s66
    s_add_u32 s61, s63, s74
    s_add_u32 s62, s63, s75
    buffer_load_dwordx4 v12, s[44:47], s61 offen offset:0  lds
    buffer_load_dwordx4 v13, s[44:47], s61 offen offset:1024  lds
    s_add_u32 m0, m0, 8192
    s_add_u32 s63, s62, 2048
    buffer_load_dwordx4 v12, s[44:47], s62 offen offset:0  lds
    buffer_load_dwordx4 v13, s[44:47], s62 offen offset:1024  lds
    s_add_u32 m0, m0, 8192
    s_add_u32 s67, s67, 1
    buffer_load_dwordx4 v12, s[44:47], s63 offen offset:0  lds
    buffer_load_dwordx4 v13, s[44:47], s63 offen offset:1024  lds
    s_and_b32 s67, s67, 15
    s_add_u32 s64, s64, 40960
    s_cmp_eq_u32 s64, 122880
    s_cselect_b32 s64, 0, s64
    s_waitcnt vmcnt(10)
    s_barrier
    s_add_u32 m0, s64, s65
    s_lshl_b32 s60, s67, 7
    s_mul_i32 s63, s67, 393216
    buffer_load_dwordx4 v8, s[40:43], s60 offen offset:0  lds
    buffer_load_dwordx4 v9, s[40:43], s60 offen offset:1024  lds
    buffer_load_dwordx4 v10, s[40:43], s60 offen offset:2048  lds
    buffer_load_dwordx4 v11, s[40:43], s60 offen offset:3072  lds
    s_add_u32 m0, s64, s66
    s_add_u32 s61, s63, s74
    s_add_u32 s62, s63, s75
    buffer_load_dwordx4 v12, s[44:47], s61 offen offset:0  lds
    buffer_load_dwordx4 v13, s[44:47], s61 offen offset:1024  lds
    s_add_u32 m0, m0, 8192
    s_add_u32 s63, s62, 2048
    buffer_load_dwordx4 v12, s[44:47], s62 offen offset:0  lds
    buffer_load_dwordx4 v13, s[44:47], s62 offen offset:1024  lds
    s_add_u32 m0, m0, 8192
    s_add_u32 s67, s67, 1
    buffer_load_dwordx4 v12, s[44:47], s63 offen offset:0  lds
    buffer_load_dwordx4 v13, s[44:47], s63 offen offset:1024  lds
    s_and_b32 s67, s67, 15
    s_add_u32 s64, s64, 40960
    s_cmp_eq_u32 s64, 122880
    s_cselect_b32 s64, 0, s64
    s_waitcnt vmcnt(10)
    s_barrier
    s_add_u32 m0, s64, s65
    s_lshl_b32 s60, s67, 7
    s_mul_i32 s63, s67, 393216
    buffer_load_dwordx4 v8, s[40:43], s60 offen offset:0  lds
    buffer_load_dwordx4 v9, s[40:43], s60 offen offset:1024  lds
    buffer_load_dwordx4 v10, s[40:43], s60 offen offset:2048  lds
    buffer_load_dwordx4 v11, s[40:43], s60 offen offset:3072  lds
    s_add_u32 m0, s64, s66
    s_add_u32 s61, s63, s74
    s_add_u32 s62, s63, s75
    buffer_load_dwordx4 v12, s[44:47], s61 offen offset:0  lds
    buffer_load_dwordx4 v13, s[44:47], s61 offen offset:1024  lds
    s_add_u32 m0, m0, 8192
    s_add_u32 s63, s62, 2048
    buffer_load_dwordx4 v12, s[44:47], s62 offen offset:0  lds
    buffer_load_dwordx4 v13, s[44:47], s62 offen offset:1024  lds
    s_add_u32 m0, m0, 8192
    s_add_u32 s67, s67, 1
    buffer_load_dwordx4 v12, s[44:47], s63 offen offset:0  lds
    buffer_load_dwordx4 v13, s[44:47], s63 offen offset:1024  lds
    s_and_b32 s67, s67, 15
    s_add_u32 s64, s64, 40960
    s_cmp_eq_u32 s64, 122880
    s_cselect_b32 s64, 0, s64
    s_load_dword s5, s[52:53], 0x0
    s_load_dword s5, s[52:53], 0x80
    s_load_dword s5, s[52:53], 0x100
    s_load_dword s5, s[52:53], 0x180
    s_waitcnt vmcnt(10)
    s_barrier
    s_add_u32 m0, s64, s65
    s_lshl_b32 s60, s67, 7
    s_mul_i32 s63, s67, 393216
    buffer_load_dwordx4 v8, s[40:43], s60 offen offset:0  lds
    buffer_load_dwordx4 v9, s[40:43], s60 offen offset:1024  lds
    buffer_load_dwordx4 v10, s[40:43], s60 offen offset:2048  lds
    buffer_load_dwordx4 v11, s[40:43], s60 offen offset:3072  lds
    s_add_u32 m0, s64, s66
    s_add_u32 s61, s63, s74
    s_add_u32 s62, s63, s75
    buffer_load_dwordx4 v12, s[44:47], s61 offen offset:0  lds
    buffer_load_dwordx4 v13, s[44:47], s61 offen offset:1024  lds
    s_add_u32 m0, m0, 8192
    s_add_u32 s63, s62, 2048
    buffer_load_dwordx4 v12, s[44:47], s62 offen offset:0  lds
    buffer_load_dwordx4 v13, s[44:47], s62 offen offset:1024  lds
    s_add_u32 m0, m0, 8192
    s_add_u32 s67, s67, 1
    buffer_load_dwordx4 v12, s[44:47], s63 offen offset:0  lds
    buffer_load_dwordx4 v13, s[44:47], s63 offen offset:1024  lds
    s_and_b32 s67, s67, 15
    s_add_u32 s64, s64, 40960
    s_cmp_eq_u32 s64, 122880
    s_cselect_b32 s64, 0, s64
    s_load_dword s5, s[52:53], 0x200
    s_load_dword s5, s[52:53], 0x280
    s_load_dword s5, s[52:53], 0x300
    s_load_dword s5, s[52:53], 0x380
    s_waitcnt vmcnt(10)
    s_barrier
    s_add_u32 m0, s64, s65
    s_lshl_b32 s60, s67, 7
    s_mul_i32 s63, s67, 393216
    buffer_load_dwordx4 v8, s[40:43], s60 offen offset:0  lds
    buffer_load_dwordx4 v9, s[40:43], s60 offen offset:1024  lds
    buffer_load_dwordx4 v10, s[40:43], s60 offen offset:2048  lds
    buffer_load_dwordx4 v11, s[40:43], s60 offen offset:3072  lds
    s_add_u32 m0, s64, s66
    s_add_u32 s61, s63, s74
    s_add_u32 s62, s63, s75
    buffer_load_dwordx4 v12, s[44:47], s61 offen offset:0  lds
    buffer_load_dwordx4 v13, s[44:47], s61 offen offset:1024  lds
    s_add_u32 m0, m0, 8192
    s_add_u32 s63, s62, 2048
    buffer_load_dwordx4 v12, s[44:47], s62 offen offset:0  lds
    buffer_load_dwordx4 v13, s[44:47], s62 offen offset:1024  lds
    s_add_u32 m0, m0, 8192
    s_add_u32 s67, s67, 1
    buffer_load_dwordx4 v12, s[44:47], s63 offen offset:0  lds
    buffer_load_dwordx4 v13, s[44:47], s63 offen offset:1024  lds
    s_and_b32 s67, s67, 15
    s_add_u32 s64, s64, 40960
    s_cmp_eq_u32 s64, 122880
    s_cselect_b32 s64, 0, s64
    s_load_dword s5, s[52:53], 0x400
    s_load_dword s5, s[52:53], 0x480
    s_load_dword s5, s[52:53], 0x500
    s_load_dword s5, s[52:53], 0x580
    s_waitcnt vmcnt(10)
    s_barrier
    s_add_u32 m0, s64, s65
    s_lshl_b32 s60, s67, 7
    s_mul_i32 s63, s67, 393216
    buffer_load_dwordx4 v8, s[40:43], s60 offen offset:0  lds
    buffer_load_dwordx4 v9, s[40:43], s60 offen offset:1024  lds
    buffer_load_dwordx4 v10, s[40:43], s60 offen offset:2048  lds
    buffer_load_dwordx4 v11, s[40:43], s60 offen offset:3072  lds
    s_add_u32 m0, s64, s66
    s_add_u32 s61, s63, s74
    s_add_u32 s62, s63, s75
    buffer_load_dwordx4 v12, s[44:47], s61 offen offset:0  lds
    buffer_load_dwordx4 v13, s[44:47], s61 offen offset:1024  lds
    s_add_u32 m0, m0, 8192
    s_add_u32 s63, s62, 2048
    buffer_load_dwordx4 v12, s[44:47], s62 offen offset:0  lds
    buffer_load_dwordx4 v13, s[44:47], s62 offen offset:1024  lds
    s_add_u32 m0, m0, 8192
    s_add_u32 s67, s67, 1
    buffer_load_dwordx4 v12, s[44:47], s63 offen offset:0  lds
    buffer_load_dwordx4 v13, s[44:47], s63 offen offset:1024  lds
    s_and_b32 s67, s67, 15
    s_add_u32 s64, s64, 40960
    s_cmp_eq_u32 s64, 122880
    s_cselect_b32 s64, 0, s64
    s_load_dword s5, s[52:53], 0x600
    s_load_dword s5, s[52:53], 0x680
    s_load_dword s5, s[52:53], 0x700
    s_load_dword s5, s[52:53], 0x780
    s_waitcnt vmcnt(10)
    s_barrier
    s_add_u32 m0, s64, s65
    s_lshl_b32 s60, s67, 7
    s_mul_i32 s63, s67, 393216
    buffer_load_dwordx4 v8, s[40:43], s60 offen offset:0  lds
    buffer_load_dwordx4 v9, s[40:43], s60 offen offset:1024  lds
    buffer_load_dwordx4 v10, s[40:43], s60 offen offset:2048  lds
    buffer_load_dwordx4 v11, s[40:43], s60 offen offset:3072  lds
    s_add_u32 m0, s64, s66
    s_add_u32 s61, s63, s74
    s_add_u32 s62, s63, s75
    buffer_load_dwordx4 v12, s[44:47], s61 offen offset:0  lds
    buffer_load_dwordx4 v13, s[44:47], s61 offen offset:1024  lds
    s_add_u32 m0, m0, 8192
    s_add_u32 s63, s62, 2048
    buffer_load_dwordx4 v12, s[44:47], s62 offen offset:0  lds
    buffer_load_dwordx4 v13, s[44:47], s62 offen offset:1024  lds
    s_add_u32 m0, m0, 8192
    s_add_u32 s67, s67, 1
    buffer_load_dwordx4 v12, s[44:47], s63 offen offset:0  lds
    buffer_load_dwordx4 v13, s[44:47], s63 offen offset:1024  lds
    s_and_b32 s67, s67, 15
    s_add_u32 s64, s64, 40960
    s_cmp_eq_u32 s64, 122880
    s_cselect_b32 s64, 0, s64
    s_load_dword s5, s[52:53], 0x800
    s_load_dword s5, s[52:53], 0x880
    s_load_dword s5, s[52:53], 0x900
    s_load_dword s5, s[52:53], 0x980
    s_waitcnt vmcnt(10)
    s_barrier
    s_add_u32 m0, s64, s65
    s_lshl_b32 s60, s67, 7
    s_mul_i32 s63, s67, 393216
    buffer_load_dwordx4 v8, s[40:43], s60 offen offset:0  lds
    buffer_load_dwordx4 v9, s[40:43], s60 offen offset:1024  lds
    buffer_load_dwordx4 v10, s[40:43], s60 offen offset:2048  lds
    buffer_load_dwordx4 v11, s[40:43], s60 offen offset:3072  lds
    s_add_u32 m0, s64, s66
    s_add_u32 s61, s63, s74
    s_add_u32 s62, s63, s75
    buffer_load_dwordx4 v12, s[44:47], s61 offen offset:0  lds
    buffer_load_dwordx4 v13, s[44:47], s61 offen offset:1024  lds
    s_add_u32 m0, m0, 8192
    s_add_u32 s63, s62, 2048
    buffer_load_dwordx4 v12, s[44:47], s62 offen offset:0  lds
    buffer_load_dwordx4 v13, s[44:47], s62 offen offset:1024  lds
    s_add_u32 m0, m0, 8192
    s_add_u32 s67, s67, 1
    buffer_load_dwordx4 v12, s[44:47], s63 offen offset:0  lds
    buffer_load_dwordx4 v13, s[44:47], s63 offen offset:1024  lds
    s_and_b32 s67, s67, 15
    s_add_u32 s64, s64, 40960
    s_cmp_eq_u32 s64, 122880
    s_cselect_b32 s64, 0, s64
    s_load_dword s5, s[52:53], 0xa00
    s_load_dword s5, s[52:53], 0xa80
    s_load_dword s5, s[52:53], 0xb00
    s_load_dword s5, s[52:53], 0xb80
    s_waitcnt vmcnt(10)
    s_barrier
    s_add_u32 m0, s64, s65
    s_lshl_b32 s60, s67, 7
    s_mul_i32 s63, s67, 393216
    buffer_load_dwordx4 v8, s[40:43], s60 offen offset:0  lds
    buffer_load_dwordx4 v9, s[40:43], s60 offen offset:1024  lds
    buffer_load_dwordx4 v10, s[40:43], s60 offen offset:2048  lds
    buffer_load_dwordx4 v11, s[40:43], s60 offen offset:3072  lds
    s_add_u32 m0, s64, s66
    s_add_u32 s61, s63, s74
    s_add_u32 s62, s63, s75
    buffer_load_dwordx4 v12, s[44:47], s61 offen offset:0  lds
    buffer_load_dwordx4 v13, s[44:47], s61 offen offset:1024  lds
    s_add_u32 m0, m0, 8192
    s_add_u32 s63, s62, 2048
    buffer_load_dwordx4 v12, s[44:47], s62 offen offset:0  lds
    buffer_load_dwordx4 v13, s[44:47], s62 offen offset:1024  lds
    s_add_u32 m0, m0, 8192
    s_add_u32 s67, s67, 1
    buffer_load_dwordx4 v12, s[44:47], s63 offen offset:0  lds
    buffer_load_dwordx4 v13, s[44:47], s63 offen offset:1024  lds
    s_and_b32 s67, s67, 15
    s_add_u32 s64, s64, 40960
    s_cmp_eq_u32 s64, 122880
    s_cselect_b32 s64, 0, s64
    s_load_dword s5, s[52:53], 0xc00
    s_load_dword s5, s[52:53], 0xc80
    s_load_dword s5, s[52:53], 0xd00
    s_load_dword s5, s[52:53], 0xd80
    s_waitcnt vmcnt(10)
    s_barrier
    s_add_u32 m0, s64, s65
    s_lshl_b32 s60, s67, 7
    s_mul_i32 s63, s67, 393216
    buffer_load_dwordx4 v8, s[40:43], s60 offen offset:0  lds
    buffer_load_dwordx4 v9, s[40:43], s60 offen offset:1024  lds
    buffer_load_dwordx4 v10, s[40:43], s60 offen offset:2048  lds
    buffer_load_dwordx4 v11, s[40:43], s60 offen offset:3072  lds
    s_add_u32 m0, s64, s66
    s_add_u32 s61, s63, s74
    s_add_u32 s62, s63, s75
    buffer_load_dwordx4 v12, s[44:47], s61 offen offset:0  lds
    buffer_load_dwordx4 v13, s[44:47], s61 offen offset:1024  lds
    s_add_u32 m0, m0, 8192
    s_add_u32 s63, s62, 2048
    buffer_load_dwordx4 v12, s[44:47], s62 offen offset:0  lds
    buffer_load_dwordx4 v13, s[44:47], s62 offen offset:1024  lds
    s_add_u32 m0, m0, 8192
    s_add_u32 s67, s67, 1
    buffer_load_dwordx4 v12, s[44:47], s63 offen offset:0  lds
    buffer_load_dwordx4 v13, s[44:47], s63 offen offset:1024  lds
    s_and_b32 s67, s67, 15
    s_add_u32 s64, s64, 40960
    s_cmp_eq_u32 s64, 122880
    s_cselect_b32 s64, 0, s64
    s_load_dword s5, s[52:53], 0xe00
    s_load_dword s5, s[52:53], 0xe80
    s_load_dword s5, s[52:53], 0xf00
    s_load_dword s5, s[52:53], 0xf80
    s_waitcnt vmcnt(10)
    s_barrier
    s_add_u32 m0, s64, s65
    s_lshl_b32 s60, s67, 7
    s_mul_i32 s63, s67, 393216
    buffer_load_dwordx4 v8, s[40:43], s60 offen offset:0  lds
    buffer_load_dwordx4 v9, s[40:43], s60 offen offset:1024  lds
    buffer_load_dwordx4 v10, s[40:43], s60 offen offset:2048  lds
    buffer_load_dwordx4 v11, s[40:43], s60 offen offset:3072  lds
    s_add_u32 m0, s64, s66
    s_add_u32 s61, s63, s74
    s_add_u32 s62, s63, s75
    buffer_load_dwordx4 v12, s[44:47], s61 offen offset:0  lds
    buffer_load_dwordx4 v13, s[44:47], s61 offen offset:1024  lds
    s_add_u32 m0, m0, 8192
    s_add_u32 s63, s62, 2048
    buffer_load_dwordx4 v12, s[44:47], s62 offen offset:0  lds
    buffer_load_dwordx4 v13, s[44:47], s62 offen offset:1024  lds
    s_add_u32 m0, m0, 8192
    s_add_u32 s67, s67, 1
    buffer_load_dwordx4 v12, s[44:47], s63 offen offset:0  lds
    buffer_load_dwordx4 v13, s[44:47], s63 offen offset:1024  lds
    s_and_b32 s67, s67, 15
    s_add_u32 s64, s64, 40960
    s_cmp_eq_u32 s64, 122880
    s_cselect_b32 s64, 0, s64
    s_waitcnt lgkmcnt(0)
    s_load_dwordx16 s[4:19], s[26:27], s33 glc
    s_mov_b32 s40, s20
    s_mov_b32 s41, s21
    s_mov_b32 s42, 0x400000
    s_mov_b32 s43, 0x20000
    s_mov_b32 s44, s22
    s_mov_b32 s45, s23
    s_mov_b32 s46, 0x800000
    s_mov_b32 s47, 0x20000
    s_and_b32 s28, s34, 3
    s_lshl_b32 s74, s28, 2
    s_lshl_b32 s28, s28, 3
    s_add_u32 s65, s3, 5
    s_add_u32 s75, s3, 9
    s_cmp_eq_u32 s3, 3
    s_cselect_b32 s75, 4, s75
    s_add_u32 s31, s3, 12
    s_waitcnt vmcnt(10)
    s_barrier
    s_waitcnt lgkmcnt(0)
    s_cmp_eq_u64 s[4:5], s[72:73]
    s_cbranch_scc0 L_us
    s_cmp_eq_u64 s[6:7], s[72:73]
    s_cbranch_scc0 L_us
    s_cmp_eq_u64 s[8:9], s[72:73]
    s_cbranch_scc0 L_us
    s_cmp_eq_u64 s[10:11], s[72:73]
    s_cbranch_scc0 L_us
    s_cmp_eq_u64 s[12:13], s[72:73]
    s_cbranch_scc0 L_us
    s_cmp_eq_u64 s[14:15], s[72:73]
    s_cbranch_scc0 L_us
    s_cmp_eq_u64 s[16:17], s[72:73]
    s_cbranch_scc0 L_us
    s_cmp_eq_u64 s[18:19], s[72:73]
    s_cbranch_scc0 L_us
    s_branch L_upoll_done
L_us:
    s_mov_b32 s60, 0
    s_branch L_upoll_go
L_upoll:
    s_sleep 0
L_upoll_go:
    s_load_dwordx16 s[4:19], s[26:27], s33 glc
    s_add_u32 s60, s60, 1
    s_cmp_gt_u32 s60, 0x8000
    s_cbranch_scc1 L_upoll_done
    s_waitcnt lgkmcnt(0)
    s_cmp_eq_u64 s[4:5], s[72:73]
    s_cbranch_scc0 L_upoll
    s_cmp_eq_u64 s[6:7], s[72:73]
    s_cbranch_scc0 L_upoll
    s_cmp_eq_u64 s[8:9], s[72:73]
    s_cbranch_scc0 L_upoll
    s_cmp_eq_u64 s[10:11], s[72:73]
    s_cbranch_scc0 L_upoll
    s_cmp_eq_u64 s[12:13], s[72:73]
    s_cbranch_scc0 L_upoll
    s_cmp_eq_u64 s[14:15], s[72:73]
    s_cbranch_scc0 L_upoll
    s_cmp_eq_u64 s[16:17], s[72:73]
    s_cbranch_scc0 L_upoll
    s_cmp_eq_u64 s[18:19], s[72:73]
    s_cbranch_scc0 L_upoll
L_upoll_done:
    s_waitcnt lgkmcnt(0)
    buffer_load_dwordx4 v[32:35], v5, s[48:51], s39 offen offset:0 sc1
    buffer_load_dwordx4 v[36:39], v5, s[48:51], s39 offen offset:1024 sc1
    buffer_load_dwordx4 v[40:43], v5, s[48:51], s39 offen offset:2048 sc1
    buffer_load_dwordx4 v[44:47], v5, s[48:51], s39 offen offset:3072 sc1
    s_add_u32 m0, s68, 256
    s_nop 0
    buffer_load_dwordx4 v26, s[52:55], 0 offen  lds
    s_add_u32 m0, s68, 256
    s_movk_i32 s60, 1024
    s_nop 0
    buffer_load_dwordx4 v26, s[52:55], s60 offen offset:1024  lds
    s_add_u32 m0, s68, 2560
    s_nop 0
    buffer_load_dwordx4 v26, s[52:55], 16 offen  lds
    s_add_u32 m0, s68, 2560
    s_movk_i32 s60, 1040
    s_nop 0
    buffer_load_dwordx4 v26, s[52:55], s60 offen offset:1024  lds
    s_waitcnt vmcnt(8)
    s_barrier
    ds_write_b128 v24, v[160:163] offset:4096
    s_lshl_b32 m0, s65, 13
    s_add_u32 s60, s65, s74
    s_and_b32 s60, s60, 15
    s_lshl_b32 s60, s60, 17
    s_add_u32 s61, s60, 0x10000
    buffer_load_dwordx4 v20, s[56:59], s60 offen offset:0  lds
    buffer_load_dwordx4 v21, s[56:59], s60 offen offset:1024  lds
    buffer_load_dwordx4 v22, s[56:59], s60 offen offset:2048  lds
    buffer_load_dwordx4 v23, s[56:59], s60 offen offset:3072  lds
    s_add_u32 m0, m0, 4096
    s_nop 0
    buffer_load_dwordx4 v20, s[56:59], s61 offen offset:0  lds
    buffer_load_dwordx4 v21, s[56:59], s61 offen offset:1024  lds
    buffer_load_dwordx4 v22, s[56:59], s61 offen offset:2048  lds
    buffer_load_dwordx4 v23, s[56:59], s61 offen offset:3072  lds
    s_waitcnt vmcnt(12)
    v_mov_b32_dpp v48, v36 wave_rol:1 row_mask:0xf bank_mask:0xf
    v_mov_b32_dpp v49, v40 wave_rol:1 row_mask:0xf bank_mask:0xf
    v_mov_b32_dpp v50, v44 wave_rol:1 row_mask:0xf bank_mask:0xf
    v_mov_b32 v51, 0
    s_nop 0
    v_mov_b32_dpp v48, v32 wave_shl:1 row_mask:0xf bank_mask:0xf
    v_mov_b32_dpp v49, v36 wave_shl:1 row_mask:0xf bank_mask:0xf
    v_mov_b32_dpp v50, v40 wave_shl:1 row_mask:0xf bank_mask:0xf
    v_mov_b32_dpp v51, v44 wave_shl:1 row_mask:0xf bank_mask:0xf
    ds_write_b128 v19, v[32:35] offset:0
    v_alignbit_b32 v52, v33, v32, 16
    v_alignbit_b32 v53, v34, v33, 16
    v_alignbit_b32 v54, v35, v34, 16
    v_alignbit_b32 v55, v48, v35, 16
    ds_write_b128 v19, v[52:55] offset:4160
    ds_write_b128 v19, v[36:39] offset:1024
    v_alignbit_b32 v56, v37, v36, 16
    v_alignbit_b32 v57, v38, v37, 16
    v_alignbit_b32 v58, v39, v38, 16
    v_alignbit_b32 v59, v49, v39, 16
    ds_write_b128 v19, v[56:59] offset:5184
    ds_write_b128 v19, v[40:43] offset:2048
    v_alignbit_b32 v60, v41, v40, 16
    v_alignbit_b32 v61, v42, v41, 16
    v_alignbit_b32 v62, v43, v42, 16
    v_alignbit_b32 v63, v50, v43, 16
    ds_write_b128 v19, v[60:63] offset:6208
    ds_write_b128 v19, v[44:47] offset:3072
    v_alignbit_b32 v64, v45, v44, 16
    v_alignbit_b32 v65, v46, v45, 16
    v_alignbit_b32 v66, v47, v46, 16
    v_alignbit_b32 v67, v51, v47, 16
    ds_write_b128 v19, v[64:67] offset:7232
    s_mov_b32 s60, 0
L_fr:
    ds_read_b128 v[68:71], v15 offset:112
    s_add_u32 s60, s60, 1
    s_waitcnt lgkmcnt(0)
    v_and_b32 v68, v68, v69
    v_and_b32 v70, v70, v71
    v_and_b32 v68, v68, v70
    s_cmp_gt_u32 s60, 0x40000
    s_cbranch_scc1 L_fr_d
    v_readfirstlane_b32 s61, v68
    s_nop 3
    s_cmp_eq_u32 s61, 1
    s_cbranch_scc1 L_fr_d
    s_sleep 1
    s_branch L_fr
L_fr_d:
    s_lshl_b32 m0, s75, 13
    s_add_u32 s60, s75, s74
    s_and_b32 s60, s60, 15
    s_lshl_b32 s60, s60, 17
    s_add_u32 s61, s60, 0x10000
    buffer_load_dwordx4 v20, s[56:59], s60 offen offset:0  lds
    buffer_load_dwordx4 v21, s[56:59], s60 offen offset:1024  lds
    buffer_load_dwordx4 v22, s[56:59], s60 offen offset:2048  lds
    buffer_load_dwordx4 v23, s[56:59], s60 offen offset:3072  lds
    s_add_u32 m0, m0, 4096
    s_nop 0
    buffer_load_dwordx4 v20, s[56:59], s61 offen offset:0  lds
    buffer_load_dwordx4 v21, s[56:59], s61 offen offset:1024  lds
    buffer_load_dwordx4 v22, s[56:59], s61 offen offset:2048  lds
    buffer_load_dwordx4 v23, s[56:59], s61 offen offset:3072  lds
    s_lshl_b32 m0, s3, 13
    s_add_u32 s60, s3, s74
    s_and_b32 s60, s60, 15
    s_lshl_b32 s60, s60, 17
    s_add_u32 s61, s60, 0x10000
    buffer_load_dwordx4 v20, s[56:59], s60 offen offset:0  lds
    buffer_load_dwordx4 v21, s[56:59], s60 offen offset:1024  lds
    buffer_load_dwordx4 v22, s[56:59], s60 offen offset:2048  lds
    buffer_load_dwordx4 v23, s[56:59], s60 offen offset:3072  lds
    s_add_u32 m0, m0, 4096
    s_nop 0
    buffer_load_dwordx4 v20, s[56:59], s61 offen offset:0  lds
    buffer_load_dwordx4 v21, s[56:59], s61 offen offset:1024  lds
    buffer_load_dwordx4 v22, s[56:59], s61 offen offset:2048  lds
    buffer_load_dwordx4 v23, s[56:59], s61 offen offset:3072  lds
    s_lshl_b32 s30, s69, 11
    s_lshl_b32 s61, s36, 7
    s_add_u32 s30, s30, s61
    s_lshl_b32 s63, s69, 12
    s_add_u32 s63, s63, s61
    s_add_u32 s63, s63, 2048
    s_lshl_b32 s66, s34, 8
    s_lshl_b32 s61, s3, 6
    s_add_u32 s66, s66, s61
    s_lshr_b32 vcc_lo, s66, 6
    s_mul_i32 vcc_lo, vcc_lo, 1984
    s_add_u32 s66, s66, vcc_lo
    s_add_u32 s66, s66, 0x980000
    s_lshl_b32 vcc_lo, s35, 7
    s_add_u32 s66, s66, vcc_lo
    s_bitcmp1_b32 s3, 0
    s_cselect_b32 s60, 0, 16
    s_cselect_b32 s33, 16, 0
    s_lshl_b32 s71, s71, s60
    s_and_b32 s71, s71, 0xffff0000
    s_lshr_b32 s60, s3, 1
    v_lshl_add_u32 v19, s60, 2, v15
    s_mov_b32 s32, s38
    s_lshr_b32 vcc_lo, s32, 6
    s_mul_i32 vcc_lo, vcc_lo, 8128
    s_add_u32 s32, s32, vcc_lo
    s_add_u32 s32, s32, 0x9a0000
    s_lshl_b32 s67, s36, 6
    s_lshl_b32 s60, s37, 2
    s_add_u32 s60, s60, s3
    s_lshr_b32 vcc_lo, s67, 6
    s_mul_i32 vcc_lo, vcc_lo, 8128
    s_add_u32 s67, s67, vcc_lo
    s_add_u32 s67, s67, 0x9a0000
    s_lshl_b32 vcc_lo, s60, 7
    s_add_u32 s67, s67, vcc_lo
    s_mov_b32 s64, 0
    s_waitcnt vmcnt(24)
    ds_read2_b32 v[32:33], v240 offset0:132 offset1:133
    ds_read2_b32 v[34:35], v240 offset0:134 offset1:135
    ds_read_b128 v[64:67], v244 offset:2304
    ds_read2_b32 v[36:37], v240 offset0:4 offset1:5
    ds_read2_b32 v[38:39], v240 offset0:6 offset1:7
    ds_read_b128 v[68:71], v244 offset:2560
    ds_read2_b32 v[40:41], v241 offset0:132 offset1:133
    ds_read2_b32 v[42:43], v241 offset0:134 offset1:135
    ds_read_b128 v[72:75], v244 offset:2816
    ds_read2_b32 v[44:45], v241 offset0:4 offset1:5
    ds_read2_b32 v[46:47], v241 offset0:6 offset1:7
    ds_read_b128 v[76:79], v244 offset:3072
    ds_read2_b32 v[48:49], v242 offset0:132 offset1:133
    ds_read2_b32 v[50:51], v242 offset0:134 offset1:135
    ds_read_b128 v[80:83], v244 offset:3328
    ds_read2_b32 v[52:53], v242 offset0:4 offset1:5
    ds_read2_b32 v[54:55], v242 offset0:6 offset1:7
    ds_read_b128 v[84:87], v244 offset:3584
    ds_read2_b32 v[56:57], v243 offset0:132 offset1:133
    ds_read2_b32 v[58:59], v243 offset0:134 offset1:135
    ds_read_b128 v[88:91], v244 offset:3840
    ds_read2_b32 v[60:61], v243 offset0:4 offset1:5
    ds_read2_b32 v[62:63], v243 offset0:6 offset1:7
    ds_read_b128 v[92:95], v244 offset:4096
    s_mov_b32 s60, 0
L_kd:
    ds_read_b128 v[96:99], v15 offset:128
    s_add_u32 s60, s60, 1
    s_waitcnt lgkmcnt(0)
    v_and_b32 v96, v96, v97
    v_and_b32 v98, v98, v99
    v_and_b32 v96, v96, v98
    s_cmp_gt_u32 s60, 0x40000
    s_cbranch_scc1 L_kd_d
    v_readfirstlane_b32 s61, v96
    s_nop 3
    s_cmp_eq_u32 s61, 1
    s_cbranch_scc1 L_kd_d
    s_sleep 1
    s_branch L_kd
L_kd_d:
    s_setprio 0
    s_waitcnt lgkmcnt(0)
    v_mfma_f32_16x16x32_bf16 v[188:191], v[32:35], v[92:95], v[188:191]
    ds_read2_b32 v[96:97], v240 offset0:128 offset1:129
    v_mfma_f32_16x16x32_bf16 v[188:191], v[36:39], v[88:91], v[188:191]
    ds_read2_b32 v[98:99], v240 offset0:130 offset1:131
    v_mfma_f32_16x16x32_bf16 v[188:191], v[40:43], v[84:87], v[188:191]
    ds_read_b128 v[128:131], v244 offset:0
    v_mfma_f32_16x16x32_bf16 v[188:191], v[44:47], v[80:83], v[188:191]
    ds_read2_b32 v[100:101], v240 offset0:0 offset1:1
    v_mfma_f32_16x16x32_bf16 v[188:191], v[48:51], v[76:79], v[188:191]
    ds_read2_b32 v[102:103], v240 offset0:2 offset1:3
    v_mfma_f32_16x16x32_bf16 v[188:191], v[52:55], v[72:75], v[188:191]
    ds_read_b128 v[132:135], v244 offset:256
    v_mfma_f32_16x16x32_bf16 v[188:191], v[56:59], v[68:71], v[188:191]
    ds_read2_b32 v[104:105], v241 offset0:128 offset1:129
    v_mfma_f32_16x16x32_bf16 v[188:191], v[60:63], v[64:67], v[188:191]
    ds_read2_b32 v[106:107], v241 offset0:130 offset1:131
    v_mfma_f32_16x16x32_bf16 v[184:187], v[32:35], v[88:91], v[184:187]
    ds_read_b128 v[136:139], v244 offset:512
    v_mfma_f32_16x16x32_bf16 v[184:187], v[36:39], v[84:87], v[184:187]
    ds_read2_b32 v[108:109], v241 offset0:0 offset1:1
    v_mfma_f32_16x16x32_bf16 v[184:187], v[40:43], v[80:83], v[184:187]
    ds_read2_b32 v[110:111], v241 offset0:2 offset1:3
    v_mfma_f32_16x16x32_bf16 v[184:187], v[44:47], v[76:79], v[184:187]
    ds_read_b128 v[140:143], v244 offset:768
    v_mfma_f32_16x16x32_bf16 v[184:187], v[48:51], v[72:75], v[184:187]
    ds_read2_b32 v[112:113], v242 offset0:128 offset1:129
    v_mfma_f32_16x16x32_bf16 v[184:187], v[52:55], v[68:71], v[184:187]
    ds_read2_b32 v[114:115], v242 offset0:130 offset1:131
    v_mfma_f32_16x16x32_bf16 v[184:187], v[56:59], v[64:67], v[184:187]
    ds_read_b128 v[144:147], v244 offset:1024
    v_mfma_f32_16x16x32_bf16 v[180:183], v[32:35], v[84:87], v[180:183]
    ds_read2_b32 v[116:117], v242 offset0:0 offset1:1
    v_mfma_f32_16x16x32_bf16 v[180:183], v[36:39], v[80:83], v[180:183]
    ds_read2_b32 v[118:119], v242 offset0:2 offset1:3
    v_mfma_f32_16x16x32_bf16 v[180:183], v[40:43], v[76:79], v[180:183]
    ds_read_b128 v[148:151], v244 offset:1280
    v_mfma_f32_16x16x32_bf16 v[180:183], v[44:47], v[72:75], v[180:183]
    ds_read2_b32 v[120:121], v243 offset0:128 offset1:129
    v_mfma_f32_16x16x32_bf16 v[180:183], v[48:51], v[68:71], v[180:183]
    ds_read2_b32 v[122:123], v243 offset0:130 offset1:131
    v_mfma_f32_16x16x32_bf16 v[180:183], v[52:55], v[64:67], v[180:183]
    ds_read_b128 v[152:155], v244 offset:1536
    v_mfma_f32_16x16x32_bf16 v[176:179], v[32:35], v[80:83], v[176:179]
    ds_read2_b32 v[124:125], v243 offset0:0 offset1:1
    v_mfma_f32_16x16x32_bf16 v[176:179], v[36:39], v[76:79], v[176:179]
    ds_read2_b32 v[126:127], v243 offset0:2 offset1:3
    v_mfma_f32_16x16x32_bf16 v[176:179], v[40:43], v[72:75], v[176:179]
    ds_read_b128 v[156:159], v244 offset:1792
    v_mfma_f32_16x16x32_bf16 v[176:179], v[44:47], v[68:71], v[176:179]
    v_subrev_u32 v240, 128, v240
    v_mfma_f32_16x16x32_bf16 v[176:179], v[48:51], v[64:67], v[176:179]
    v_subrev_u32 v241, 128, v241
    v_mfma_f32_16x16x32_bf16 v[172:175], v[32:35], v[76:79], v[172:175]
    v_subrev_u32 v242, 128, v242
    v_mfma_f32_16x16x32_bf16 v[172:175], v[36:39], v[72:75], v[172:175]
    v_subrev_u32 v243, 128, v243
    v_mfma_f32_16x16x32_bf16 v[172:175], v[40:43], v[68:71], v[172:175]
    v_subrev_u32 v244, 64, v244
    v_mfma_f32_16x16x32_bf16 v[172:175], v[44:47], v[64:67], v[172:175]
    v_mfma_f32_16x16x32_bf16 v[168:171], v[32:35], v[72:75], v[168:171]
    v_mfma_f32_16x16x32_bf16 v[168:171], v[36:39], v[68:71], v[168:171]
    v_mfma_f32_16x16x32_bf16 v[168:171], v[40:43], v[64:67], v[168:171]
    v_mfma_f32_16x16x32_bf16 v[164:167], v[32:35], v[68:71], v[164:167]
    v_mfma_f32_16x16x32_bf16 v[164:167], v[36:39], v[64:67], v[164:167]
    v_mfma_f32_16x16x32_bf16 v[160:163], v[32:35], v[64:67], v[160:163]
    s_waitcnt lgkmcnt(0)
    s_waitcnt vmcnt(0)
    v_mfma_f32_16x16x32_bf16 v[188:191], v[96:99], v[156:159], v[188:191]
    ds_read2_b32 v[32:33], v240 offset0:132 offset1:133
    s_mov_b32 s61, 0
    v_mfma_f32_16x16x32_bf16 v[188:191], v[100:103], v[152:155], v[188:191]
    ds_read2_b32 v[34:35], v240 offset0:134 offset1:135
    s_lshl_b32 s60, s3, 1
    v_mfma_f32_16x16x32_bf16 v[188:191], v[104:107], v[148:151], v[188:191]
    ds_read_b128 v[64:67], v244 offset:2304
    s_bitset1_b32 s61, s60
    v_mfma_f32_16x16x32_bf16 v[188:191], v[108:111], v[144:147], v[188:191]
    ds_read2_b32 v[36:37], v240 offset0:4 offset1:5
    s_lshl_b32 s60, s75, 1
    v_mfma_f32_16x16x32_bf16 v[188:191], v[112:115], v[140:143], v[188:191]
    ds_read2_b32 v[38:39], v240 offset0:6 offset1:7
    s_bitset1_b32 s61, s60
    v_mfma_f32_16x16x32_bf16 v[188:191], v[116:119], v[136:139], v[188:191]
    ds_read_b128 v[68:71], v244 offset:2560
    s_lshl_b32 s60, s65, 1
    v_mfma_f32_16x16x32_bf16 v[188:191], v[120:123], v[132:135], v[188:191]
    ds_read2_b32 v[40:41], v241 offset0:132 offset1:133
    s_bitset1_b32 s61, s60
    v_mfma_f32_16x16x32_bf16 v[188:191], v[124:127], v[128:131], v[188:191]
    ds_read2_b32 v[42:43], v241 offset0:134 offset1:135
    v_mov_b32 v3, s61
    v_mfma_f32_16x16x32_bf16 v[184:187], v[96:99], v[152:155], v[184:187]
    ds_read_b128 v[72:75], v244 offset:2816
    s_mov_b64 exec, 1
    ds_or_b32 v15, v3 offset:60
    s_mov_b64 exec, -1
    v_mfma_f32_16x16x32_bf16 v[184:187], v[100:103], v[148:151], v[184:187]
    ds_read2_b32 v[44:45], v241 offset0:4 offset1:5
    s_add_u32 s60, s31, s74
    v_mfma_f32_16x16x32_bf16 v[184:187], v[104:107], v[144:147], v[184:187]
    ds_read2_b32 v[46:47], v241 offset0:6 offset1:7
    s_and_b32 s60, s60, 15
    v_mfma_f32_16x16x32_bf16 v[184:187], v[108:111], v[140:143], v[184:187]
    ds_read_b128 v[76:79], v244 offset:3072
    s_lshl_b32 s60, s60, 17
    v_mfma_f32_16x16x32_bf16 v[184:187], v[112:115], v[136:139], v[184:187]
    ds_read2_b32 v[48:49], v242 offset0:132 offset1:133
    s_add_u32 s61, s60, 0x10000
    v_mfma_f32_16x16x32_bf16 v[184:187], v[116:119], v[132:135], v[184:187]
    ds_read2_b32 v[50:51], v242 offset0:134 offset1:135
    buffer_load_dwordx4 v[192:195], v20, s[56:59], s60 offen offset:0
    v_mfma_f32_16x16x32_bf16 v[184:187], v[120:123], v[128:131], v[184:187]
    ds_read_b128 v[80:83], v244 offset:3328
    buffer_load_dwordx4 v[196:199], v21, s[56:59], s60 offen offset:1024
    v_mfma_f32_16x16x32_bf16 v[180:183], v[96:99], v[148:151], v[180:183]
    ds_read2_b32 v[52:53], v242 offset0:4 offset1:5
    buffer_load_dwordx4 v[200:203], v22, s[56:59], s60 offen offset:2048
    v_mfma_f32_16x16x32_bf16 v[180:183], v[100:103], v[144:147], v[180:183]
    ds_read2_b32 v[54:55], v242 offset0:6 offset1:7
    buffer_load_dwordx4 v[204:207], v23, s[56:59], s60 offen offset:3072
    v_mfma_f32_16x16x32_bf16 v[180:183], v[104:107], v[140:143], v[180:183]
    ds_read_b128 v[84:87], v244 offset:3584
    buffer_load_dwordx4 v[208:211], v20, s[56:59], s61 offen offset:0
    v_mfma_f32_16x16x32_bf16 v[180:183], v[108:111], v[136:139], v[180:183]
    ds_read2_b32 v[56:57], v243 offset0:132 offset1:133
    buffer_load_dwordx4 v[212:215], v21, s[56:59], s61 offen offset:1024
    v_mfma_f32_16x16x32_bf16 v[180:183], v[112:115], v[132:135], v[180:183]
    ds_read2_b32 v[58:59], v243 offset0:134 offset1:135
    buffer_load_dwordx4 v[216:219], v22, s[56:59], s61 offen offset:2048
    v_mfma_f32_16x16x32_bf16 v[180:183], v[116:119], v[128:131], v[180:183]
    ds_read_b128 v[88:91], v244 offset:3840
    buffer_load_dwordx4 v[220:223], v23, s[56:59], s61 offen offset:3072
    v_mfma_f32_16x16x32_bf16 v[176:179], v[96:99], v[144:147], v[176:179]
    ds_read2_b32 v[60:61], v243 offset0:4 offset1:5
    buffer_load_dwordx4 v[224:227], v16, s[40:43], s30 offen
    v_mfma_f32_16x16x32_bf16 v[176:179], v[100:103], v[140:143], v[176:179]
    ds_read2_b32 v[62:63], v243 offset0:6 offset1:7
    s_add_u32 s30, s30, 0x4000
    v_mfma_f32_16x16x32_bf16 v[176:179], v[104:107], v[136:139], v[176:179]
    ds_read_b128 v[92:95], v244 offset:4096
    buffer_load_dwordx4 v[228:231], v16, s[40:43], s30 offen
    v_mfma_f32_16x16x32_bf16 v[176:179], v[108:111], v[132:135], v[176:179]
    s_add_u32 s30, s30, 0x4000
    v_mfma_f32_16x16x32_bf16 v[176:179], v[112:115], v[128:131], v[176:179]
    buffer_load_dwordx4 v[232:235], v16, s[40:43], s30 offen
    v_mfma_f32_16x16x32_bf16 v[172:175], v[96:99], v[140:143], v[172:175]
    s_add_u32 s30, s30, 0x4000
    v_mfma_f32_16x16x32_bf16 v[172:175], v[100:103], v[136:139], v[172:175]
    buffer_load_dwordx4 v[236:239], v16, s[40:43], s30 offen
    v_mfma_f32_16x16x32_bf16 v[172:175], v[104:107], v[132:135], v[172:175]
    v_mfma_f32_16x16x32_bf16 v[172:175], v[108:111], v[128:131], v[172:175]
    v_mfma_f32_16x16x32_bf16 v[168:171], v[96:99], v[136:139], v[168:171]
    v_mfma_f32_16x16x32_bf16 v[168:171], v[100:103], v[132:135], v[168:171]
    v_mfma_f32_16x16x32_bf16 v[168:171], v[104:107], v[128:131], v[168:171]
    v_mfma_f32_16x16x32_bf16 v[164:167], v[96:99], v[132:135], v[164:167]
    v_mfma_f32_16x16x32_bf16 v[164:167], v[100:103], v[128:131], v[164:167]
    v_mfma_f32_16x16x32_bf16 v[160:163], v[96:99], v[128:131], v[160:163]
    s_waitcnt lgkmcnt(0)
    v_mfma_f32_16x16x32_bf16 v[188:191], v[32:35], v[92:95], v[188:191]
    ds_read2_b32 v[96:97], v240 offset0:128 offset1:129
    v_mfma_f32_16x16x32_bf16 v[188:191], v[36:39], v[88:91], v[188:191]
    ds_read2_b32 v[98:99], v240 offset0:130 offset1:131
    v_mfma_f32_16x16x32_bf16 v[188:191], v[40:43], v[84:87], v[188:191]
    ds_read_b128 v[128:131], v244 offset:0
    v_mfma_f32_16x16x32_bf16 v[188:191], v[44:47], v[80:83], v[188:191]
    ds_read2_b32 v[100:101], v240 offset0:0 offset1:1
    v_mfma_f32_16x16x32_bf16 v[188:191], v[48:51], v[76:79], v[188:191]
    ds_read2_b32 v[102:103], v240 offset0:2 offset1:3
    v_mfma_f32_16x16x32_bf16 v[188:191], v[52:55], v[72:75], v[188:191]
    ds_read_b128 v[132:135], v244 offset:256
    v_mfma_f32_16x16x32_bf16 v[188:191], v[56:59], v[68:71], v[188:191]
    ds_read2_b32 v[104:105], v241 offset0:128 offset1:129
    v_mfma_f32_16x16x32_bf16 v[188:191], v[60:63], v[64:67], v[188:191]
    ds_read2_b32 v[106:107], v241 offset0:130 offset1:131
    v_mfma_f32_16x16x32_bf16 v[184:187], v[32:35], v[88:91], v[184:187]
    ds_read_b128 v[136:139], v244 offset:512
    v_mfma_f32_16x16x32_bf16 v[184:187], v[36:39], v[84:87], v[184:187]
    ds_read2_b32 v[108:109], v241 offset0:0 offset1:1
    v_mfma_f32_16x16x32_bf16 v[184:187], v[40:43], v[80:83], v[184:187]
    ds_read2_b32 v[110:111], v241 offset0:2 offset1:3
    v_mfma_f32_16x16x32_bf16 v[184:187], v[44:47], v[76:79], v[184:187]
    ds_read_b128 v[140:143], v244 offset:768
    v_mfma_f32_16x16x32_bf16 v[184:187], v[48:51], v[72:75], v[184:187]
    ds_read2_b32 v[112:113], v242 offset0:128 offset1:129
    v_mfma_f32_16x16x32_bf16 v[184:187], v[52:55], v[68:71], v[184:187]
    ds_read2_b32 v[114:115], v242 offset0:130 offset1:131
    v_mfma_f32_16x16x32_bf16 v[184:187], v[56:59], v[64:67], v[184:187]
    ds_read_b128 v[144:147], v244 offset:1024
    v_mfma_f32_16x16x32_bf16 v[180:183], v[32:35], v[84:87], v[180:183]
    ds_read2_b32 v[116:117], v242 offset0:0 offset1:1
    v_mfma_f32_16x16x32_bf16 v[180:183], v[36:39], v[80:83], v[180:183]
    ds_read2_b32 v[118:119], v242 offset0:2 offset1:3
    v_mfma_f32_16x16x32_bf16 v[180:183], v[40:43], v[76:79], v[180:183]
    ds_read_b128 v[148:151], v244 offset:1280
    v_mfma_f32_16x16x32_bf16 v[180:183], v[44:47], v[72:75], v[180:183]
    ds_read2_b32 v[120:121], v243 offset0:128 offset1:129
    v_mfma_f32_16x16x32_bf16 v[180:183], v[48:51], v[68:71], v[180:183]
    ds_read2_b32 v[122:123], v243 offset0:130 offset1:131
    v_mfma_f32_16x16x32_bf16 v[180:183], v[52:55], v[64:67], v[180:183]
    ds_read_b128 v[152:155], v244 offset:1536
    v_mfma_f32_16x16x32_bf16 v[176:179], v[32:35], v[80:83], v[176:179]
    ds_read2_b32 v[124:125], v243 offset0:0 offset1:1
    v_mfma_f32_16x16x32_bf16 v[176:179], v[36:39], v[76:79], v[176:179]
    ds_read2_b32 v[126:127], v243 offset0:2 offset1:3
    v_mfma_f32_16x16x32_bf16 v[176:179], v[40:43], v[72:75], v[176:179]
    ds_read_b128 v[156:159], v244 offset:1792
    v_mfma_f32_16x16x32_bf16 v[176:179], v[44:47], v[68:71], v[176:179]
    v_subrev_u32 v240, 128, v240
    v_mfma_f32_16x16x32_bf16 v[176:179], v[48:51], v[64:67], v[176:179]
    v_subrev_u32 v241, 128, v241
    v_mfma_f32_16x16x32_bf16 v[172:175], v[32:35], v[76:79], v[172:175]
    v_subrev_u32 v242, 128, v242
    v_mfma_f32_16x16x32_bf16 v[172:175], v[36:39], v[72:75], v[172:175]
    v_subrev_u32 v243, 128, v243
    v_mfma_f32_16x16x32_bf16 v[172:175], v[40:43], v[68:71], v[172:175]
    v_subrev_u32 v244, 64, v244
    v_mfma_f32_16x16x32_bf16 v[172:175], v[44:47], v[64:67], v[172:175]
    v_mfma_f32_16x16x32_bf16 v[168:171], v[32:35], v[72:75], v[168:171]
    v_mfma_f32_16x16x32_bf16 v[168:171], v[36:39], v[68:71], v[168:171]
    v_mfma_f32_16x16x32_bf16 v[168:171], v[40:43], v[64:67], v[168:171]
    v_mfma_f32_16x16x32_bf16 v[164:167], v[32:35], v[68:71], v[164:167]
    v_mfma_f32_16x16x32_bf16 v[164:167], v[36:39], v[64:67], v[164:167]
    v_mfma_f32_16x16x32_bf16 v[160:163], v[32:35], v[64:67], v[160:163]
    s_waitcnt lgkmcnt(0)
    v_mfma_f32_16x16x32_bf16 v[188:191], v[96:99], v[156:159], v[188:191]
    ds_read2_b32 v[32:33], v240 offset0:132 offset1:133
    v_mfma_f32_16x16x32_bf16 v[188:191], v[100:103], v[152:155], v[188:191]
    ds_read2_b32 v[34:35], v240 offset0:134 offset1:135
    v_mfma_f32_16x16x32_bf16 v[188:191], v[104:107], v[148:151], v[188:191]
    ds_read_b128 v[64:67], v244 offset:2304
    v_mfma_f32_16x16x32_bf16 v[188:191], v[108:111], v[144:147], v[188:191]
    ds_read2_b32 v[36:37], v240 offset0:4 offset1:5
    v_mfma_f32_16x16x32_bf16 v[188:191], v[112:115], v[140:143], v[188:191]
    ds_read2_b32 v[38:39], v240 offset0:6 offset1:7
    v_mfma_f32_16x16x32_bf16 v[188:191], v[116:119], v[136:139], v[188:191]
    ds_read_b128 v[68:71], v244 offset:2560
    v_mfma_f32_16x16x32_bf16 v[188:191], v[120:123], v[132:135], v[188:191]
    ds_read2_b32 v[40:41], v241 offset0:132 offset1:133
    v_mfma_f32_16x16x32_bf16 v[188:191], v[124:127], v[128:131], v[188:191]
    ds_read2_b32 v[42:43], v241 offset0:134 offset1:135
    v_mfma_f32_16x16x32_bf16 v[184:187], v[96:99], v[152:155], v[184:187]
    ds_read_b128 v[72:75], v244 offset:2816
    v_mfma_f32_16x16x32_bf16 v[184:187], v[100:103], v[148:151], v[184:187]
    ds_read2_b32 v[44:45], v241 offset0:4 offset1:5
    v_mfma_f32_16x16x32_bf16 v[184:187], v[104:107], v[144:147], v[184:187]
    ds_read2_b32 v[46:47], v241 offset0:6 offset1:7
    v_mfma_f32_16x16x32_bf16 v[184:187], v[108:111], v[140:143], v[184:187]
    ds_read_b128 v[76:79], v244 offset:3072
    v_mfma_f32_16x16x32_bf16 v[184:187], v[112:115], v[136:139], v[184:187]
    ds_read2_b32 v[48:49], v242 offset0:132 offset1:133
    v_mfma_f32_16x16x32_bf16 v[184:187], v[116:119], v[132:135], v[184:187]
    ds_read2_b32 v[50:51], v242 offset0:134 offset1:135
    v_mfma_f32_16x16x32_bf16 v[184:187], v[120:123], v[128:131], v[184:187]
    ds_read_b128 v[80:83], v244 offset:3328
    v_mfma_f32_16x16x32_bf16 v[180:183], v[96:99], v[148:151], v[180:183]
    ds_read2_b32 v[52:53], v242 offset0:4 offset1:5
    v_mfma_f32_16x16x32_bf16 v[180:183], v[100:103], v[144:147], v[180:183]
    ds_read2_b32 v[54:55], v242 offset0:6 offset1:7
    v_mfma_f32_16x16x32_bf16 v[180:183], v[104:107], v[140:143], v[180:183]
    ds_read_b128 v[84:87], v244 offset:3584
    v_mfma_f32_16x16x32_bf16 v[180:183], v[108:111], v[136:139], v[180:183]
    ds_read2_b32 v[56:57], v243 offset0:132 offset1:133
    v_mfma_f32_16x16x32_bf16 v[180:183], v[112:115], v[132:135], v[180:183]
    ds_read2_b32 v[58:59], v243 offset0:134 offset1:135
    v_mfma_f32_16x16x32_bf16 v[180:183], v[116:119], v[128:131], v[180:183]
    ds_read_b128 v[88:91], v244 offset:3840
    v_mfma_f32_16x16x32_bf16 v[176:179], v[96:99], v[144:147], v[176:179]
    ds_read2_b32 v[60:61], v243 offset0:4 offset1:5
    v_mfma_f32_16x16x32_bf16 v[176:179], v[100:103], v[140:143], v[176:179]
    ds_read2_b32 v[62:63], v243 offset0:6 offset1:7
    v_mfma_f32_16x16x32_bf16 v[176:179], v[104:107], v[136:139], v[176:179]
    ds_read_b128 v[92:95], v244 offset:4096
    v_mfma_f32_16x16x32_bf16 v[176:179], v[108:111], v[132:135], v[176:179]
    v_mfma_f32_16x16x32_bf16 v[176:179], v[112:115], v[128:131], v[176:179]
    v_mfma_f32_16x16x32_bf16 v[172:175], v[96:99], v[140:143], v[172:175]
    v_mfma_f32_16x16x32_bf16 v[172:175], v[100:103], v[136:139], v[172:175]
    v_mfma_f32_16x16x32_bf16 v[172:175], v[104:107], v[132:135], v[172:175]
    v_mfma_f32_16x16x32_bf16 v[172:175], v[108:111], v[128:131], v[172:175]
    v_mfma_f32_16x16x32_bf16 v[168:171], v[96:99], v[136:139], v[168:171]
    v_mfma_f32_16x16x32_bf16 v[168:171], v[100:103], v[132:135], v[168:171]
    v_mfma_f32_16x16x32_bf16 v[168:171], v[104:107], v[128:131], v[168:171]
    v_mfma_f32_16x16x32_bf16 v[164:167], v[96:99], v[132:135], v[164:167]
    v_mfma_f32_16x16x32_bf16 v[164:167], v[100:103], v[128:131], v[164:167]
    v_mfma_f32_16x16x32_bf16 v[160:163], v[96:99], v[128:131], v[160:163]
    s_waitcnt lgkmcnt(0)
    v_mfma_f32_16x16x32_bf16 v[188:191], v[32:35], v[92:95], v[188:191]
    ds_read2_b32 v[96:97], v240 offset0:128 offset1:129
    v_mfma_f32_16x16x32_bf16 v[188:191], v[36:39], v[88:91], v[188:191]
    ds_read2_b32 v[98:99], v240 offset0:130 offset1:131
    v_mfma_f32_16x16x32_bf16 v[188:191], v[40:43], v[84:87], v[188:191]
    ds_read_b128 v[128:131], v244 offset:0
    v_mfma_f32_16x16x32_bf16 v[188:191], v[44:47], v[80:83], v[188:191]
    ds_read2_b32 v[100:101], v240 offset0:0 offset1:1
    v_mfma_f32_16x16x32_bf16 v[188:191], v[48:51], v[76:79], v[188:191]
    ds_read2_b32 v[102:103], v240 offset0:2 offset1:3
    v_mfma_f32_16x16x32_bf16 v[188:191], v[52:55], v[72:75], v[188:191]
    ds_read_b128 v[132:135], v244 offset:256
    v_mfma_f32_16x16x32_bf16 v[188:191], v[56:59], v[68:71], v[188:191]
    ds_read2_b32 v[104:105], v241 offset0:128 offset1:129
    v_mfma_f32_16x16x32_bf16 v[188:191], v[60:63], v[64:67], v[188:191]
    ds_read2_b32 v[106:107], v241 offset0:130 offset1:131
    v_mfma_f32_16x16x32_bf16 v[184:187], v[32:35], v[88:91], v[184:187]
    ds_read_b128 v[136:139], v244 offset:512
    v_mfma_f32_16x16x32_bf16 v[184:187], v[36:39], v[84:87], v[184:187]
    ds_read2_b32 v[108:109], v241 offset0:0 offset1:1
    v_mfma_f32_16x16x32_bf16 v[184:187], v[40:43], v[80:83], v[184:187]
    ds_read2_b32 v[110:111], v241 offset0:2 offset1:3
    v_mfma_f32_16x16x32_bf16 v[184:187], v[44:47], v[76:79], v[184:187]
    ds_read_b128 v[140:143], v244 offset:768
    v_mfma_f32_16x16x32_bf16 v[184:187], v[48:51], v[72:75], v[184:187]
    ds_read2_b32 v[112:113], v242 offset0:128 offset1:129
    v_mfma_f32_16x16x32_bf16 v[184:187], v[52:55], v[68:71], v[184:187]
    ds_read2_b32 v[114:115], v242 offset0:130 offset1:131
    v_mfma_f32_16x16x32_bf16 v[184:187], v[56:59], v[64:67], v[184:187]
    ds_read_b128 v[144:147], v244 offset:1024
    v_mfma_f32_16x16x32_bf16 v[180:183], v[32:35], v[84:87], v[180:183]
    ds_read2_b32 v[116:117], v242 offset0:0 offset1:1
    v_mfma_f32_16x16x32_bf16 v[180:183], v[36:39], v[80:83], v[180:183]
    ds_read2_b32 v[118:119], v242 offset0:2 offset1:3
    v_mfma_f32_16x16x32_bf16 v[180:183], v[40:43], v[76:79], v[180:183]
    ds_read_b128 v[148:151], v244 offset:1280
    v_mfma_f32_16x16x32_bf16 v[180:183], v[44:47], v[72:75], v[180:183]
    ds_read2_b32 v[120:121], v243 offset0:128 offset1:129
    v_mfma_f32_16x16x32_bf16 v[180:183], v[48:51], v[68:71], v[180:183]
    ds_read2_b32 v[122:123], v243 offset0:130 offset1:131
    v_mfma_f32_16x16x32_bf16 v[180:183], v[52:55], v[64:67], v[180:183]
    ds_read_b128 v[152:155], v244 offset:1536
    v_mfma_f32_16x16x32_bf16 v[176:179], v[32:35], v[80:83], v[176:179]
    ds_read2_b32 v[124:125], v243 offset0:0 offset1:1
    v_mfma_f32_16x16x32_bf16 v[176:179], v[36:39], v[76:79], v[176:179]
    ds_read2_b32 v[126:127], v243 offset0:2 offset1:3
    v_mfma_f32_16x16x32_bf16 v[176:179], v[40:43], v[72:75], v[176:179]
    ds_read_b128 v[156:159], v244 offset:1792
    v_mfma_f32_16x16x32_bf16 v[176:179], v[44:47], v[68:71], v[176:179]
    v_subrev_u32 v240, 128, v240
    v_mfma_f32_16x16x32_bf16 v[176:179], v[48:51], v[64:67], v[176:179]
    v_subrev_u32 v241, 128, v241
    v_mfma_f32_16x16x32_bf16 v[172:175], v[32:35], v[76:79], v[172:175]
    v_subrev_u32 v242, 128, v242
    v_mfma_f32_16x16x32_bf16 v[172:175], v[36:39], v[72:75], v[172:175]
    v_subrev_u32 v243, 128, v243
    v_mfma_f32_16x16x32_bf16 v[172:175], v[40:43], v[68:71], v[172:175]
    v_subrev_u32 v244, 64, v244
    v_mfma_f32_16x16x32_bf16 v[172:175], v[44:47], v[64:67], v[172:175]
    v_mfma_f32_16x16x32_bf16 v[168:171], v[32:35], v[72:75], v[168:171]
    v_mfma_f32_16x16x32_bf16 v[168:171], v[36:39], v[68:71], v[168:171]
    v_mfma_f32_16x16x32_bf16 v[168:171], v[40:43], v[64:67], v[168:171]
    v_mfma_f32_16x16x32_bf16 v[164:167], v[32:35], v[68:71], v[164:167]
    v_mfma_f32_16x16x32_bf16 v[164:167], v[36:39], v[64:67], v[164:167]
    v_mfma_f32_16x16x32_bf16 v[160:163], v[32:35], v[64:67], v[160:163]
    s_waitcnt lgkmcnt(0)
    v_mfma_f32_16x16x32_bf16 v[188:191], v[96:99], v[156:159], v[188:191]
    ds_read2_b32 v[32:33], v240 offset0:132 offset1:133
    v_mfma_f32_16x16x32_bf16 v[188:191], v[100:103], v[152:155], v[188:191]
    ds_read2_b32 v[34:35], v240 offset0:134 offset1:135
    v_mfma_f32_16x16x32_bf16 v[188:191], v[104:107], v[148:151], v[188:191]
    ds_read_b128 v[64:67], v244 offset:2304
    v_mfma_f32_16x16x32_bf16 v[188:191], v[108:111], v[144:147], v[188:191]
    ds_read2_b32 v[36:37], v240 offset0:4 offset1:5
    v_mfma_f32_16x16x32_bf16 v[188:191], v[112:115], v[140:143], v[188:191]
    ds_read2_b32 v[38:39], v240 offset0:6 offset1:7
    v_mfma_f32_16x16x32_bf16 v[188:191], v[116:119], v[136:139], v[188:191]
    ds_read_b128 v[68:71], v244 offset:2560
    v_mfma_f32_16x16x32_bf16 v[188:191], v[120:123], v[132:135], v[188:191]
    ds_read2_b32 v[40:41], v241 offset0:132 offset1:133
    v_mfma_f32_16x16x32_bf16 v[188:191], v[124:127], v[128:131], v[188:191]
    ds_read2_b32 v[42:43], v241 offset0:134 offset1:135
    v_mfma_f32_16x16x32_bf16 v[184:187], v[96:99], v[152:155], v[184:187]
    ds_read_b128 v[72:75], v244 offset:2816
    v_mfma_f32_16x16x32_bf16 v[184:187], v[100:103], v[148:151], v[184:187]
    ds_read2_b32 v[44:45], v241 offset0:4 offset1:5
    v_mfma_f32_16x16x32_bf16 v[184:187], v[104:107], v[144:147], v[184:187]
    ds_read2_b32 v[46:47], v241 offset0:6 offset1:7
    v_mfma_f32_16x16x32_bf16 v[184:187], v[108:111], v[140:143], v[184:187]
    ds_read_b128 v[76:79], v244 offset:3072
    v_mfma_f32_16x16x32_bf16 v[184:187], v[112:115], v[136:139], v[184:187]
    ds_read2_b32 v[48:49], v242 offset0:132 offset1:133
    v_mfma_f32_16x16x32_bf16 v[184:187], v[116:119], v[132:135], v[184:187]
    ds_read2_b32 v[50:51], v242 offset0:134 offset1:135
    v_mfma_f32_16x16x32_bf16 v[184:187], v[120:123], v[128:131], v[184:187]
    ds_read_b128 v[80:83], v244 offset:3328
    v_mfma_f32_16x16x32_bf16 v[180:183], v[96:99], v[148:151], v[180:183]
    ds_read2_b32 v[52:53], v242 offset0:4 offset1:5
    v_mfma_f32_16x16x32_bf16 v[180:183], v[100:103], v[144:147], v[180:183]
    ds_read2_b32 v[54:55], v242 offset0:6 offset1:7
    v_mfma_f32_16x16x32_bf16 v[180:183], v[104:107], v[140:143], v[180:183]
    ds_read_b128 v[84:87], v244 offset:3584
    v_mfma_f32_16x16x32_bf16 v[180:183], v[108:111], v[136:139], v[180:183]
    ds_read2_b32 v[56:57], v243 offset0:132 offset1:133
    v_mfma_f32_16x16x32_bf16 v[180:183], v[112:115], v[132:135], v[180:183]
    ds_read2_b32 v[58:59], v243 offset0:134 offset1:135
    v_mfma_f32_16x16x32_bf16 v[180:183], v[116:119], v[128:131], v[180:183]
    ds_read_b128 v[88:91], v244 offset:3840
    v_mfma_f32_16x16x32_bf16 v[176:179], v[96:99], v[144:147], v[176:179]
    ds_read2_b32 v[60:61], v243 offset0:4 offset1:5
    v_mfma_f32_16x16x32_bf16 v[176:179], v[100:103], v[140:143], v[176:179]
    ds_read2_b32 v[62:63], v243 offset0:6 offset1:7
    v_mfma_f32_16x16x32_bf16 v[176:179], v[104:107], v[136:139], v[176:179]
    ds_read_b128 v[92:95], v244 offset:4096
    v_mfma_f32_16x16x32_bf16 v[176:179], v[108:111], v[132:135], v[176:179]
    v_mfma_f32_16x16x32_bf16 v[176:179], v[112:115], v[128:131], v[176:179]
    v_mfma_f32_16x16x32_bf16 v[172:175], v[96:99], v[140:143], v[172:175]
    v_mfma_f32_16x16x32_bf16 v[172:175], v[100:103], v[136:139], v[172:175]
    v_mfma_f32_16x16x32_bf16 v[172:175], v[104:107], v[132:135], v[172:175]
    v_mfma_f32_16x16x32_bf16 v[172:175], v[108:111], v[128:131], v[172:175]
    v_mfma_f32_16x16x32_bf16 v[168:171], v[96:99], v[136:139], v[168:171]
    v_mfma_f32_16x16x32_bf16 v[168:171], v[100:103], v[132:135], v[168:171]
    v_mfma_f32_16x16x32_bf16 v[168:171], v[104:107], v[128:131], v[168:171]
    v_mfma_f32_16x16x32_bf16 v[164:167], v[96:99], v[132:135], v[164:167]
    v_mfma_f32_16x16x32_bf16 v[164:167], v[100:103], v[128:131], v[164:167]
    v_mfma_f32_16x16x32_bf16 v[160:163], v[96:99], v[128:131], v[160:163]
    s_waitcnt lgkmcnt(0)
    v_mfma_f32_16x16x32_bf16 v[188:191], v[32:35], v[92:95], v[188:191]
    ds_read2_b32 v[96:97], v240 offset0:128 offset1:129
    v_mfma_f32_16x16x32_bf16 v[188:191], v[36:39], v[88:91], v[188:191]
    ds_read2_b32 v[98:99], v240 offset0:130 offset1:131
    v_mfma_f32_16x16x32_bf16 v[188:191], v[40:43], v[84:87], v[188:191]
    ds_read_b128 v[128:131], v244 offset:0
    v_mfma_f32_16x16x32_bf16 v[188:191], v[44:47], v[80:83], v[188:191]
    ds_read2_b32 v[100:101], v240 offset0:0 offset1:1
    v_mfma_f32_16x16x32_bf16 v[188:191], v[48:51], v[76:79], v[188:191]
    ds_read2_b32 v[102:103], v240 offset0:2 offset1:3
    v_mfma_f32_16x16x32_bf16 v[188:191], v[52:55], v[72:75], v[188:191]
    ds_read_b128 v[132:135], v244 offset:256
    v_mfma_f32_16x16x32_bf16 v[188:191], v[56:59], v[68:71], v[188:191]
    ds_read2_b32 v[104:105], v241 offset0:128 offset1:129
    v_mfma_f32_16x16x32_bf16 v[188:191], v[60:63], v[64:67], v[188:191]
    ds_read2_b32 v[106:107], v241 offset0:130 offset1:131
    v_mfma_f32_16x16x32_bf16 v[184:187], v[32:35], v[88:91], v[184:187]
    ds_read_b128 v[136:139], v244 offset:512
    v_mfma_f32_16x16x32_bf16 v[184:187], v[36:39], v[84:87], v[184:187]
    ds_read2_b32 v[108:109], v241 offset0:0 offset1:1
    v_mfma_f32_16x16x32_bf16 v[184:187], v[40:43], v[80:83], v[184:187]
    ds_read2_b32 v[110:111], v241 offset0:2 offset1:3
    v_mfma_f32_16x16x32_bf16 v[184:187], v[44:47], v[76:79], v[184:187]
    ds_read_b128 v[140:143], v244 offset:768
    v_mfma_f32_16x16x32_bf16 v[184:187], v[48:51], v[72:75], v[184:187]
    ds_read2_b32 v[112:113], v242 offset0:128 offset1:129
    v_mfma_f32_16x16x32_bf16 v[184:187], v[52:55], v[68:71], v[184:187]
    ds_read2_b32 v[114:115], v242 offset0:130 offset1:131
    v_mfma_f32_16x16x32_bf16 v[184:187], v[56:59], v[64:67], v[184:187]
    ds_read_b128 v[144:147], v244 offset:1024
    v_mfma_f32_16x16x32_bf16 v[180:183], v[32:35], v[84:87], v[180:183]
    ds_read2_b32 v[116:117], v242 offset0:0 offset1:1
    v_mfma_f32_16x16x32_bf16 v[180:183], v[36:39], v[80:83], v[180:183]
    ds_read2_b32 v[118:119], v242 offset0:2 offset1:3
    v_mfma_f32_16x16x32_bf16 v[180:183], v[40:43], v[76:79], v[180:183]
    ds_read_b128 v[148:151], v244 offset:1280
    v_mfma_f32_16x16x32_bf16 v[180:183], v[44:47], v[72:75], v[180:183]
    ds_read2_b32 v[120:121], v243 offset0:128 offset1:129
    v_mfma_f32_16x16x32_bf16 v[180:183], v[48:51], v[68:71], v[180:183]
    ds_read2_b32 v[122:123], v243 offset0:130 offset1:131
    v_mfma_f32_16x16x32_bf16 v[180:183], v[52:55], v[64:67], v[180:183]
    ds_read_b128 v[152:155], v244 offset:1536
    v_mfma_f32_16x16x32_bf16 v[176:179], v[32:35], v[80:83], v[176:179]
    ds_read2_b32 v[124:125], v243 offset0:0 offset1:1
    v_mfma_f32_16x16x32_bf16 v[176:179], v[36:39], v[76:79], v[176:179]
    ds_read2_b32 v[126:127], v243 offset0:2 offset1:3
    v_mfma_f32_16x16x32_bf16 v[176:179], v[40:43], v[72:75], v[176:179]
    ds_read_b128 v[156:159], v244 offset:1792
    v_mfma_f32_16x16x32_bf16 v[176:179], v[44:47], v[68:71], v[176:179]
    v_subrev_u32 v240, 128, v240
    v_mfma_f32_16x16x32_bf16 v[176:179], v[48:51], v[64:67], v[176:179]
    v_subrev_u32 v241, 128, v241
    v_mfma_f32_16x16x32_bf16 v[172:175], v[32:35], v[76:79], v[172:175]
    v_subrev_u32 v242, 128, v242
    v_mfma_f32_16x16x32_bf16 v[172:175], v[36:39], v[72:75], v[172:175]
    v_subrev_u32 v243, 128, v243
    v_mfma_f32_16x16x32_bf16 v[172:175], v[40:43], v[68:71], v[172:175]
    v_subrev_u32 v244, 64, v244
    v_mfma_f32_16x16x32_bf16 v[172:175], v[44:47], v[64:67], v[172:175]
    v_mfma_f32_16x16x32_bf16 v[168:171], v[32:35], v[72:75], v[168:171]
    v_mfma_f32_16x16x32_bf16 v[168:171], v[36:39], v[68:71], v[168:171]
    v_mfma_f32_16x16x32_bf16 v[168:171], v[40:43], v[64:67], v[168:171]
    v_mfma_f32_16x16x32_bf16 v[164:167], v[32:35], v[68:71], v[164:167]
    v_mfma_f32_16x16x32_bf16 v[164:167], v[36:39], v[64:67], v[164:167]
    v_mfma_f32_16x16x32_bf16 v[160:163], v[32:35], v[64:67], v[160:163]
    s_waitcnt lgkmcnt(0)
    v_mfma_f32_16x16x32_bf16 v[188:191], v[96:99], v[156:159], v[188:191]
    v_mfma_f32_16x16x32_bf16 v[188:191], v[100:103], v[152:155], v[188:191]
    v_mfma_f32_16x16x32_bf16 v[188:191], v[104:107], v[148:151], v[188:191]
    v_mfma_f32_16x16x32_bf16 v[188:191], v[108:111], v[144:147], v[188:191]
    v_mfma_f32_16x16x32_bf16 v[188:191], v[112:115], v[140:143], v[188:191]
    v_mfma_f32_16x16x32_bf16 v[188:191], v[116:119], v[136:139], v[188:191]
    v_mfma_f32_16x16x32_bf16 v[188:191], v[120:123], v[132:135], v[188:191]
    v_mfma_f32_16x16x32_bf16 v[188:191], v[124:127], v[128:131], v[188:191]
    v_mfma_f32_16x16x32_bf16 v[184:187], v[96:99], v[152:155], v[184:187]
    v_mfma_f32_16x16x32_bf16 v[184:187], v[100:103], v[148:151], v[184:187]
    v_mfma_f32_16x16x32_bf16 v[184:187], v[104:107], v[144:147], v[184:187]
    v_mfma_f32_16x16x32_bf16 v[184:187], v[108:111], v[140:143], v[184:187]
    v_mfma_f32_16x16x32_bf16 v[184:187], v[112:115], v[136:139], v[184:187]
    v_mfma_f32_16x16x32_bf16 v[184:187], v[116:119], v[132:135], v[184:187]
    v_mfma_f32_16x16x32_bf16 v[184:187], v[120:123], v[128:131], v[184:187]
    v_mfma_f32_16x16x32_bf16 v[180:183], v[96:99], v[148:151], v[180:183]
    v_mfma_f32_16x16x32_bf16 v[180:183], v[100:103], v[144:147], v[180:183]
    v_mfma_f32_16x16x32_bf16 v[180:183], v[104:107], v[140:143], v[180:183]
    v_mfma_f32_16x16x32_bf16 v[180:183], v[108:111], v[136:139], v[180:183]
    v_mfma_f32_16x16x32_bf16 v[180:183], v[112:115], v[132:135], v[180:183]
    v_mfma_f32_16x16x32_bf16 v[180:183], v[116:119], v[128:131], v[180:183]
    v_mfma_f32_16x16x32_bf16 v[176:179], v[96:99], v[144:147], v[176:179]
    v_mfma_f32_16x16x32_bf16 v[176:179], v[100:103], v[140:143], v[176:179]
    v_mfma_f32_16x16x32_bf16 v[176:179], v[104:107], v[136:139], v[176:179]
    v_mfma_f32_16x16x32_bf16 v[176:179], v[108:111], v[132:135], v[176:179]
    v_mfma_f32_16x16x32_bf16 v[176:179], v[112:115], v[128:131], v[176:179]
    v_mfma_f32_16x16x32_bf16 v[172:175], v[96:99], v[140:143], v[172:175]
    v_mfma_f32_16x16x32_bf16 v[172:175], v[100:103], v[136:139], v[172:175]
    v_mfma_f32_16x16x32_bf16 v[172:175], v[104:107], v[132:135], v[172:175]
    v_mfma_f32_16x16x32_bf16 v[172:175], v[108:111], v[128:131], v[172:175]
    v_mfma_f32_16x16x32_bf16 v[168:171], v[96:99], v[136:139], v[168:171]
    v_mfma_f32_16x16x32_bf16 v[168:171], v[100:103], v[132:135], v[168:171]
    v_mfma_f32_16x16x32_bf16 v[168:171], v[104:107], v[128:131], v[168:171]
    v_mfma_f32_16x16x32_bf16 v[164:167], v[96:99], v[132:135], v[164:167]
    v_mfma_f32_16x16x32_bf16 v[164:167], v[100:103], v[128:131], v[164:167]
    v_mfma_f32_16x16x32_bf16 v[160:163], v[96:99], v[128:131], v[160:163]
    ds_read_b64 v[136:137], v245 offset:3584
    ds_read_b64 v[138:139], v245 offset:3072
    ds_read_b64 v[140:141], v245 offset:2560
    ds_read_b64 v[142:143], v245 offset:2048
    ds_read_b64 v[144:145], v245 offset:1536
    ds_read_b64 v[146:147], v245 offset:1024
    ds_read_b64 v[148:149], v245 offset:512
    ds_read_b64 v[150:151], v245 offset:0
    s_mov_b64 exec, 1
    ds_add_u32 v15, v14 offset:36
    s_mov_b64 exec, -1
    s_setprio 3
    s_waitcnt lgkmcnt(0)
    v_and_b32 v152, s70, v137
    v_lshlrev_b32 v153, 16, v137
    v_and_b32 v154, s70, v136
    v_lshlrev_b32 v155, 16, v136
    v_fmac_f32 v160, s71, v152
    v_fmac_f32 v161, s71, v153
    v_fmac_f32 v162, s71, v154
    v_fmac_f32 v163, s71, v155
    v_cvt_pk_bf16_f32 v136, v160, v161
    v_cvt_pk_bf16_f32 v137, v162, v163
    v_and_b32 v152, s70, v139
    v_lshlrev_b32 v153, 16, v139
    v_and_b32 v154, s70, v138
    v_lshlrev_b32 v155, 16, v138
    v_fmac_f32 v164, s71, v152
    v_fmac_f32 v165, s71, v153
    v_fmac_f32 v166, s71, v154
    v_fmac_f32 v167, s71, v155
    v_cvt_pk_bf16_f32 v138, v164, v165
    v_cvt_pk_bf16_f32 v139, v166, v167
    v_and_b32 v152, s70, v141
    v_lshlrev_b32 v153, 16, v141
    v_and_b32 v154, s70, v140
    v_lshlrev_b32 v155, 16, v140
    v_fmac_f32 v168, s71, v152
    v_fmac_f32 v169, s71, v153
    v_fmac_f32 v170, s71, v154
    v_fmac_f32 v171, s71, v155
    v_cvt_pk_bf16_f32 v140, v168, v169
    v_cvt_pk_bf16_f32 v141, v170, v171
    v_and_b32 v152, s70, v143
    v_lshlrev_b32 v153, 16, v143
    v_and_b32 v154, s70, v142
    v_lshlrev_b32 v155, 16, v142
    v_fmac_f32 v172, s71, v152
    v_fmac_f32 v173, s71, v153
    v_fmac_f32 v174, s71, v154
    v_fmac_f32 v175, s71, v155
    v_cvt_pk_bf16_f32 v142, v172, v173
    v_cvt_pk_bf16_f32 v143, v174, v175
    v_and_b32 v152, s70, v145
    v_lshlrev_b32 v153, 16, v145
    v_and_b32 v154, s70, v144
    v_lshlrev_b32 v155, 16, v144
    v_fmac_f32 v176, s71, v152
    v_fmac_f32 v177, s71, v153
    v_fmac_f32 v178, s71, v154
    v_fmac_f32 v179, s71, v155
    v_cvt_pk_bf16_f32 v144, v176, v177
    v_cvt_pk_bf16_f32 v145, v178, v179
    v_and_b32 v152, s70, v147
    v_lshlrev_b32 v153, 16, v147
    v_and_b32 v154, s70, v146
    v_lshlrev_b32 v155, 16, v146
    v_fmac_f32 v180, s71, v152
    v_fmac_f32 v181, s71, v153
    v_fmac_f32 v182, s71, v154
    v_fmac_f32 v183, s71, v155
    v_cvt_pk_bf16_f32 v146, v180, v181
    v_cvt_pk_bf16_f32 v147, v182, v183
    v_and_b32 v152, s70, v149
    v_lshlrev_b32 v153, 16, v149
    v_and_b32 v154, s70, v148
    v_lshlrev_b32 v155, 16, v148
    v_fmac_f32 v184, s71, v152
    v_fmac_f32 v185, s71, v153
    v_fmac_f32 v186, s71, v154
    v_fmac_f32 v187, s71, v155
    v_cvt_pk_bf16_f32 v148, v184, v185
    v_cvt_pk_bf16_f32 v149, v186, v187
    v_and_b32 v152, s70, v151
    v_lshlrev_b32 v153, 16, v151
    v_and_b32 v154, s70, v150
    v_lshlrev_b32 v155, 16, v150
    v_fmac_f32 v188, s71, v152
    v_fmac_f32 v189, s71, v153
    v_fmac_f32 v190, s71, v154
    v_fmac_f32 v191, s71, v155
    v_cvt_pk_bf16_f32 v150, v188, v189
    v_cvt_pk_bf16_f32 v151, v190, v191
    s_nop 1
    v_permlane16_swap_b32 v136, v138
    v_permlane16_swap_b32 v137, v139
    v_permlane16_swap_b32 v140, v142
    v_permlane16_swap_b32 v141, v143
    v_permlane16_swap_b32 v144, v146
    v_permlane16_swap_b32 v145, v147
    v_permlane16_swap_b32 v148, v150
    v_permlane16_swap_b32 v149, v151
    s_waitcnt vmcnt(4)
    buffer_store_dwordx4 v[136:139], v246, s[48:51], s39 offen offset:0 sc1
    buffer_store_dwordx4 v[140:143], v246, s[48:51], s39 offen offset:1024 sc1
    buffer_store_dwordx4 v[144:147], v246, s[48:51], s39 offen offset:2048 sc1
    buffer_store_dwordx4 v[148:151], v246, s[48:51], s39 offen offset:3072 sc1
    s_mov_b32 s60, 0
L_cdspin:
    ds_read_b32 v3, v15 offset:36
    s_add_u32 s60, s60, 1
    s_waitcnt lgkmcnt(0)
    v_readfirstlane_b32 s61, v3
    s_cmp_gt_u32 s60, 0x40000
    s_cbranch_scc1 L_cdspin_done
    s_cmp_ge_u32 s61, 4
    s_cbranch_scc1 L_cdspin_done
    s_sleep 0
    s_branch L_cdspin
L_cdspin_done:
    s_lshl_b32 s60, s3, 13
    s_add_u32 s60, s60, 98304
    v_add_u32 v21, s60, v5
    ds_write_b128 v21, v[192:195] offset:0
    ds_write_b128 v21, v[196:199] offset:1024
    ds_write_b128 v21, v[200:203] offset:2048
    ds_write_b128 v21, v[204:207] offset:3072
    ds_write_b128 v21, v[208:211] offset:4096
    ds_write_b128 v21, v[212:215] offset:5120
    ds_write_b128 v21, v[216:219] offset:6144
    ds_write_b128 v21, v[220:223] offset:7168
    s_mov_b32 s61, 0
    s_lshl_b32 s60, s31, 1
    s_bitset1_b32 s61, s60
    v_mov_b32 v3, s61
    s_mov_b64 exec, 1
    ds_or_b32 v15, v3 offset:60
    s_mov_b64 exec, -1
    s_lshl_b32 s65, s36, 18
    s_lshl_b32 s60, s69, 1
    s_add_u32 s65, s65, s60
    s_add_u32 s65, s65, 0x0
    v_lshrrev_b32 v18, 2, v4
    v_lshlrev_b32 v18, 12, v18
    v_lshl_add_u32 v18, v30, 4, v18
    v_lshl_add_u32 v20, v28, 3, v29
    v_lshlrev_b32 v20, 6, v20
    v_lshl_add_u32 v20, v30, 3, v20
    v_add_u32 v20, s68, v20
    s_movk_i32 s60, 144
    v_mul_u32_u24 v24, s60, v31
    v_lshl_add_u32 v24, v28, 4, v24
    v_add_u32 v24, s68, v24
    v_mul_u32_u24 v25, s60, v1
    v_add3_u32 v25, v25, v27, s68
    s_mov_b32 m0, s68
    s_waitcnt vmcnt(0)
    s_mov_b64 exec, 1
    ds_add_rtn_u32 v3, v15, v14 offset:32
    s_mov_b64 exec, -1
    s_waitcnt lgkmcnt(0)
    v_readfirstlane_b32 s60, v3
    s_nop 3
    s_cmp_eq_u32 s60, 3
    s_cbranch_scc0 L_yfl
    s_mov_b64 exec, -1
    buffer_store_dword v7, v255, s[48:51], s32 offen sc1
    s_mov_b64 exec, -1
L_yfl:
    s_setprio 0
    s_waitcnt vmcnt(0)
    v_lshlrev_b32 v96, 16, v224
    v_and_b32 v97, s70, v224
    v_lshlrev_b32 v98, 16, v225
    v_and_b32 v99, s70, v225
    v_lshlrev_b32 v100, 16, v226
    v_and_b32 v101, s70, v226
    v_lshlrev_b32 v102, 16, v227
    v_and_b32 v103, s70, v227
    v_lshlrev_b32 v104, 16, v228
    v_and_b32 v105, s70, v228
    v_lshlrev_b32 v106, 16, v229
    v_and_b32 v107, s70, v229
    v_lshlrev_b32 v108, 16, v230
    v_and_b32 v109, s70, v230
    v_lshlrev_b32 v110, 16, v231
    v_and_b32 v111, s70, v231
    v_lshlrev_b32 v112, 16, v232
    v_and_b32 v113, s70, v232
    v_lshlrev_b32 v114, 16, v233
    v_and_b32 v115, s70, v233
    v_lshlrev_b32 v116, 16, v234
    v_and_b32 v117, s70, v234
    v_lshlrev_b32 v118, 16, v235
    v_and_b32 v119, s70, v235
    v_lshlrev_b32 v120, 16, v236
    v_and_b32 v121, s70, v236
    v_lshlrev_b32 v122, 16, v237
    v_and_b32 v123, s70, v237
    v_lshlrev_b32 v124, 16, v238
    v_and_b32 v125, s70, v238
    v_lshlrev_b32 v126, 16, v239
    v_and_b32 v127, s70, v239
    s_mov_b32 s29, 0
L_yloop:
    s_cmp_eq_u32 s64, 0x5555
    s_cbranch_scc1 L_ynop
    s_load_dwordx16 s[4:19], s[26:27], s66 glc
    s_waitcnt lgkmcnt(0)
    s_mov_b32 s62, 0
    s_cmp_eq_u64 s[4:5], s[72:73]
    s_cselect_b32 s60, 0x1, 0
    s_or_b32 s62, s62, s60
    s_cmp_eq_u64 s[6:7], s[72:73]
    s_cselect_b32 s60, 0x4, 0
    s_or_b32 s62, s62, s60
    s_cmp_eq_u64 s[8:9], s[72:73]
    s_cselect_b32 s60, 0x10, 0
    s_or_b32 s62, s62, s60
    s_cmp_eq_u64 s[10:11], s[72:73]
    s_cselect_b32 s60, 0x40, 0
    s_or_b32 s62, s62, s60
    s_cmp_eq_u64 s[12:13], s[72:73]
    s_cselect_b32 s60, 0x100, 0
    s_or_b32 s62, s62, s60
    s_cmp_eq_u64 s[14:15], s[72:73]
    s_cselect_b32 s60, 0x400, 0
    s_or_b32 s62, s62, s60
    s_cmp_eq_u64 s[16:17], s[72:73]
    s_cselect_b32 s60, 0x1000, 0
    s_or_b32 s62, s62, s60
    s_cmp_eq_u64 s[18:19], s[72:73]
    s_cselect_b32 s60, 0x4000, 0
    s_or_b32 s62, s62, s60
    s_mov_b32 s64, s62
    s_lshl_b32 s60, s62, s33
    s_mov_b32 s61, s60
    s_lshr_b64 s[60:61], s[60:61], s28
    v_mov_b32 v3, s60
    s_mov_b64 exec, 1
    ds_or_b32 v19, v3 offset:64
    s_mov_b64 exec, -1
L_ynop:
    s_load_dwordx16 s[4:19], s[26:27], s67 glc
    s_add_u32 s29, s29, 1
    s_cmp_gt_u32 s29, 0x8000
    s_cbranch_scc1 L_ydone
    s_waitcnt lgkmcnt(0)
    s_cmp_eq_u64 s[4:5], s[72:73]
    s_cbranch_scc0 L_yloop
    s_cmp_eq_u64 s[6:7], s[72:73]
    s_cbranch_scc0 L_yloop
    s_cmp_eq_u64 s[8:9], s[72:73]
    s_cbranch_scc0 L_yloop
    s_cmp_eq_u64 s[10:11], s[72:73]
    s_cbranch_scc0 L_yloop
    s_cmp_eq_u64 s[12:13], s[72:73]
    s_cbranch_scc0 L_yloop
    s_cmp_eq_u64 s[14:15], s[72:73]
    s_cbranch_scc0 L_yloop
    s_cmp_eq_u64 s[16:17], s[72:73]
    s_cbranch_scc0 L_yloop
    s_cmp_eq_u64 s[18:19], s[72:73]
    s_cbranch_scc0 L_yloop
L_ydone:
    s_waitcnt lgkmcnt(0)
    buffer_load_dwordx4 v18, s[48:51], s65 offen offset:0 sc1 lds
    s_add_u32 s65, s65, 64512
    buffer_load_dwordx4 v18, s[48:51], s65 offen offset:1024 sc1 lds
    s_add_u32 s65, s65, 64512
    buffer_load_dwordx4 v18, s[48:51], s65 offen offset:2048 sc1 lds
    s_add_u32 s65, s65, 64512
    buffer_load_dwordx4 v18, s[48:51], s65 offen offset:3072 sc1 lds
    s_waitcnt vmcnt(0)
    ds_read_b64_tr_b16 v[48:49], v20 offset:0
    ds_read_b64_tr_b16 v[50:51], v20 offset:256
    ds_read_b64_tr_b16 v[52:53], v20 offset:2048
    ds_read_b64_tr_b16 v[54:55], v20 offset:2304
    ds_read_b64_tr_b16 v[56:57], v20 offset:32
    ds_read_b64_tr_b16 v[58:59], v20 offset:288
    ds_read_b64_tr_b16 v[60:61], v20 offset:2080
    ds_read_b64_tr_b16 v[62:63], v20 offset:2336
    s_waitcnt lgkmcnt(0)
    ds_write_b128 v24, v[48:51] offset:0
    ds_write_b128 v24, v[52:55] offset:64
    ds_write_b128 v24, v[56:59] offset:2304
    ds_write_b128 v24, v[60:63] offset:2368
    ds_read_b128 v[80:83], v25 offset:0
    ds_read_b128 v[84:87], v25 offset:1152
    ds_read_b128 v[88:91], v25 offset:2304
    ds_read_b128 v[92:95], v25 offset:3456
    s_waitcnt lgkmcnt(3)
    v_lshlrev_b32 v64, 16, v80
    v_and_b32 v65, s70, v80
    v_lshlrev_b32 v66, 16, v81
    v_and_b32 v67, s70, v81
    v_lshlrev_b32 v68, 16, v82
    v_and_b32 v69, s70, v82
    v_lshlrev_b32 v70, 16, v83
    v_and_b32 v71, s70, v83
    v_mul_f32 v64, v64, v96
    v_mul_f32 v65, v65, v97
    v_mul_f32 v66, v66, v98
    v_mul_f32 v67, v67, v99
    v_mul_f32 v68, v68, v100
    v_mul_f32 v69, v69, v101
    v_mul_f32 v70, v70, v102
    v_mul_f32 v71, v71, v103
    v_cvt_pk_bf16_f32 v224, v64, v65
    v_cvt_pk_bf16_f32 v225, v66, v67
    v_cvt_pk_bf16_f32 v226, v68, v69
    v_cvt_pk_bf16_f32 v227, v70, v71
    buffer_store_dwordx4 v[224:227], v17, s[44:47], s63 offen sc1
    s_add_u32 s63, s63, 0x8000
    s_waitcnt lgkmcnt(2)
    v_lshlrev_b32 v64, 16, v84
    v_and_b32 v65, s70, v84
    v_lshlrev_b32 v66, 16, v85
    v_and_b32 v67, s70, v85
    v_lshlrev_b32 v68, 16, v86
    v_and_b32 v69, s70, v86
    v_lshlrev_b32 v70, 16, v87
    v_and_b32 v71, s70, v87
    v_mul_f32 v64, v64, v104
    v_mul_f32 v65, v65, v105
    v_mul_f32 v66, v66, v106
    v_mul_f32 v67, v67, v107
    v_mul_f32 v68, v68, v108
    v_mul_f32 v69, v69, v109
    v_mul_f32 v70, v70, v110
    v_mul_f32 v71, v71, v111
    v_cvt_pk_bf16_f32 v228, v64, v65
    v_cvt_pk_bf16_f32 v229, v66, v67
    v_cvt_pk_bf16_f32 v230, v68, v69
    v_cvt_pk_bf16_f32 v231, v70, v71
    buffer_store_dwordx4 v[228:231], v17, s[44:47], s63 offen sc1
    s_add_u32 s63, s63, 0x8000
    s_waitcnt lgkmcnt(1)
    v_lshlrev_b32 v64, 16, v88
    v_and_b32 v65, s70, v88
    v_lshlrev_b32 v66, 16, v89
    v_and_b32 v67, s70, v89
    v_lshlrev_b32 v68, 16, v90
    v_and_b32 v69, s70, v90
    v_lshlrev_b32 v70, 16, v91
    v_and_b32 v71, s70, v91
    v_mul_f32 v64, v64, v112
    v_mul_f32 v65, v65, v113
    v_mul_f32 v66, v66, v114
    v_mul_f32 v67, v67, v115
    v_mul_f32 v68, v68, v116
    v_mul_f32 v69, v69, v117
    v_mul_f32 v70, v70, v118
    v_mul_f32 v71, v71, v119
    v_cvt_pk_bf16_f32 v232, v64, v65
    v_cvt_pk_bf16_f32 v233, v66, v67
    v_cvt_pk_bf16_f32 v234, v68, v69
    v_cvt_pk_bf16_f32 v235, v70, v71
    buffer_store_dwordx4 v[232:235], v17, s[44:47], s63 offen sc1
    s_add_u32 s63, s63, 0x8000
    s_waitcnt lgkmcnt(0)
    v_lshlrev_b32 v64, 16, v92
    v_and_b32 v65, s70, v92
    v_lshlrev_b32 v66, 16, v93
    v_and_b32 v67, s70, v93
    v_lshlrev_b32 v68, 16, v94
    v_and_b32 v69, s70, v94
    v_lshlrev_b32 v70, 16, v95
    v_and_b32 v71, s70, v95
    v_mul_f32 v64, v64, v120
    v_mul_f32 v65, v65, v121
    v_mul_f32 v66, v66, v122
    v_mul_f32 v67, v67, v123
    v_mul_f32 v68, v68, v124
    v_mul_f32 v69, v69, v125
    v_mul_f32 v70, v70, v126
    v_mul_f32 v71, v71, v127
    v_cvt_pk_bf16_f32 v236, v64, v65
    v_cvt_pk_bf16_f32 v237, v66, v67
    v_cvt_pk_bf16_f32 v238, v68, v69
    v_cvt_pk_bf16_f32 v239, v70, v71
    buffer_store_dwordx4 v[236:239], v17, s[44:47], s63 offen sc1
    s_endpgm
L_comp:
    s_and_b32 s34, s28, 3
    s_lshl_b32 s34, s34, 2
    s_and_b32 vcc_lo, s29, 3
    s_add_u32 s34, s34, vcc_lo
    s_lshr_b32 s35, s28, 2
    s_lshl_b32 s35, s35, 3
    s_lshr_b32 vcc_lo, s29, 2
    s_add_u32 s35, s35, vcc_lo
    s_and_b32 s36, s29, 15
    s_lshr_b32 s37, s29, 4
    s_lshl_b32 vcc_lo, s28, 1
    s_add_u32 s37, s37, vcc_lo
    s_lshl_b32 s38, s28, 5
    s_add_u32 s38, s38, s29
    s_lshl_b32 s38, s38, 2
    s_lshl_b32 s45, s37, 18
    s_lshl_b32 s46, s3, 16
    s_add_u32 s45, s45, s46
    s_lshl_b32 s46, s36, 7
    s_add_u32 s45, s45, s46
    v_lshrrev_b32 v2, 4, v4
    v_and_b32 v1, 15, v4
    v_lshlrev_b32 v3, 3, v1
    v_lshl_add_u32 v16, v2, 14, v3
    v_add_u32 v16, s45, v16
    v_subrev_u32 v17, 6144, v16
    s_movk_i32 s57, 4096
    s_movk_i32 s58, 8192
    s_movk_i32 s59, 12288
    s_mov_b32 s62, 0x400000
    s_mov_b32 s63, 0x20000
    s_mov_b32 s66, 0x400000
    s_mov_b32 s67, 0x20000
    s_mov_b32 s70, 8192
    s_mov_b32 s71, 0x20000
    v_lshlrev_b32 v18, 5, v1
    s_lshl_b32 s46, s36, 9
    v_add_u32 v18, s46, v18
    v_sub_u32 v3, 3, v2
    s_lshl_b32 s45, s3, 2
    s_sub_u32 s45, 12, s45
    v_add_u32 v3, s45, v3
    v_and_b32 v6, 7, v4
    v_xor_b32 v3, v3, v6
    v_lshlrev_b32 v3, 4, v3
    v_lshl_add_u32 v3, v1, 10, v3
    v_add_u32 v19, 139776, v3
    s_and_b32 s40, s3, 1
    s_lshr_b32 s41, s3, 1
    v_bfe_u32 v3, v4, 1, 3
    v_xor_b32 v3, v2, v3
    v_lshlrev_b32 v3, 4, v3
    v_lshl_add_u32 v3, v1, 7, v3
    s_lshl_b32 s45, s40, 13
    v_add_u32 v8, s45, v3
    v_xor_b32 v9, 64, v8
    v_bfe_u32 v22, v4, 2, 2
    v_lshl_add_u32 v3, v2, 3, v22
    v_lshlrev_b32 v3, 7, v3
    v_and_b32 v7, 3, v4
    v_lshlrev_b32 v6, 3, v7
    s_lshl_b32 s45, s41, 6
    v_add_u32 v6, s45, v6
    v_bfe_u32 v7, v4, 3, 1
    v_lshlrev_b32 v7, 6, v7
    v_xor_b32 v6, v6, v7
    v_bfe_u32 v23, v4, 4, 1
    v_lshlrev_b32 v7, 5, v23
    v_xor_b32 v6, v6, v7
    v_add_u32 v3, v3, v6
    v_add_u32 v12, 0x4000, v3
    v_xor_b32 v13, 32, v12
    v_mov_b32 v14, v12
    v_mov_b32 v15, v13
    v_mov_b32 v10, v8
    v_mov_b32 v11, v9
    s_lshl_b32 s39, s40, 5
    v_lshlrev_b32 v254, 7, v4
    v_mov_b32 v20, 162816
    v_mov_b32 v232, 1
    v_mov_b32 v233, 0
    v_lshlrev_b32 v6, 2, v4
    v_add_u32 v6, 162816, v6
    ds_write_b32 v6, v233
    s_lshl_b32 s45, s3, 2
    v_add_u32 v21, s45, v20
    s_mov_b32 s53, 0
    s_mov_b32 s56, 0xffff0000
    s_waitcnt lgkmcnt(0)
    s_nop 0
    s_mov_b64 s[60:61], s[12:13]
    s_mov_b64 s[64:65], s[14:15]
    s_mov_b64 s[68:69], s[16:17]
    s_barrier
    buffer_load_dwordx2 v[200:201], v17, s[60:63], 0 offen offset:0
    buffer_load_dwordx2 v[202:203], v17, s[60:63], 0 offen offset:2048
    buffer_load_dwordx2 v[204:205], v17, s[60:63], s57 offen offset:0
    buffer_load_dwordx2 v[206:207], v16, s[60:63], 0 offen offset:0
    buffer_load_dwordx2 v[208:209], v16, s[60:63], 0 offen offset:2048
    buffer_load_dwordx2 v[210:211], v16, s[60:63], s57 offen offset:0
    buffer_load_dwordx2 v[212:213], v16, s[60:63], s57 offen offset:2048
    buffer_load_dwordx2 v[214:215], v16, s[60:63], s58 offen offset:0
    buffer_load_dwordx2 v[216:217], v16, s[60:63], s58 offen offset:2048
    buffer_load_dwordx2 v[218:219], v16, s[60:63], s59 offen offset:0
    buffer_load_dwordx2 v[220:221], v16, s[60:63], s59 offen offset:2048
    buffer_load_dwordx4 v[242:245], v18, s[68:71], 0 offen offset:0
    buffer_load_dwordx4 v[246:249], v18, s[68:71], 0 offen offset:16
    buffer_load_dwordx2 v[222:223], v16, s[64:67], 0 offen offset:0
    buffer_load_dwordx2 v[224:225], v16, s[64:67], 0 offen offset:2048
    buffer_load_dwordx2 v[226:227], v16, s[64:67], s57 offen offset:0
    buffer_load_dwordx2 v[228:229], v16, s[64:67], s57 offen offset:2048
    buffer_load_dwordx2 v[230:231], v16, s[64:67], s58 offen offset:0
    buffer_load_dwordx2 v[236:237], v16, s[64:67], s58 offen offset:2048
    buffer_load_dwordx2 v[238:239], v16, s[64:67], s59 offen offset:0
    buffer_load_dwordx2 v[240:241], v16, s[64:67], s59 offen offset:2048
    v_xor_b32 v17, s39, v14
    v_xor_b32 v18, s39, v15
    s_barrier
    ds_read_b128 v[24:27], v10 offset:0
    ds_read_b128 v[28:31], v11 offset:0
    ds_read_b64_tr_b16 v[56:57], v14 offset:8192
    ds_read_b64_tr_b16 v[58:59], v14 offset:8704
    ds_read_b64_tr_b16 v[60:61], v14 offset:12288
    ds_read_b64_tr_b16 v[62:63], v14 offset:12800
    ds_read_b128 v[32:35], v10 offset:2048
    ds_read_b128 v[36:39], v11 offset:2048
    ds_read_b128 v[40:43], v10 offset:4096
    ds_read_b128 v[44:47], v11 offset:4096
    ds_read_b128 v[48:51], v10 offset:6144
    ds_read_b128 v[52:55], v11 offset:6144
    ds_read_b64_tr_b16 v[64:65], v15 offset:8192
    ds_read_b64_tr_b16 v[66:67], v15 offset:8704
    ds_read_b64_tr_b16 v[68:69], v15 offset:12288
    ds_read_b64_tr_b16 v[70:71], v15 offset:12800
    s_mov_b32 s52, 0
    s_waitcnt lgkmcnt(10)
    v_mfma_f32_16x16x32_bf16 v[136:139], v[24:27], v[56:59], 0
    v_mfma_f32_16x16x32_bf16 v[136:139], v[28:31], v[60:63], v[136:139]
    ds_read_b64_tr_b16 v[72:73], v17 offset:16384
    ds_read_b64_tr_b16 v[74:75], v17 offset:16896
    ds_read_b64_tr_b16 v[76:77], v17 offset:20480
    ds_read_b64_tr_b16 v[78:79], v17 offset:20992
    s_waitcnt lgkmcnt(8)
    v_mfma_f32_16x16x32_bf16 v[140:143], v[32:35], v[56:59], 0
    ds_read_b64_tr_b16 v[80:81], v18 offset:16384
    v_mfma_f32_16x16x32_bf16 v[140:143], v[36:39], v[60:63], v[140:143]
    ds_read_b64_tr_b16 v[82:83], v18 offset:16896
    v_mfma_f32_16x16x32_bf16 v[144:147], v[40:43], v[56:59], 0
    ds_read_b64_tr_b16 v[84:85], v18 offset:20480
    v_mfma_f32_16x16x32_bf16 v[144:147], v[44:47], v[60:63], v[144:147]
    ds_read_b64_tr_b16 v[86:87], v18 offset:20992
    v_mfma_f32_16x16x32_bf16 v[148:151], v[48:51], v[56:59], 0
    ds_read_b64_tr_b16 v[88:89], v14 offset:0
    v_mfma_f32_16x16x32_bf16 v[148:151], v[52:55], v[60:63], v[148:151]
    ds_read_b64_tr_b16 v[90:91], v14 offset:512
    s_waitcnt lgkmcnt(10)
    v_mfma_f32_16x16x32_bf16 v[152:155], v[24:27], v[64:67], 0
    ds_read_b64_tr_b16 v[92:93], v14 offset:4096
    v_mfma_f32_16x16x32_bf16 v[152:155], v[28:31], v[68:71], v[152:155]
    ds_read_b64_tr_b16 v[94:95], v14 offset:4608
    v_mfma_f32_16x16x32_bf16 v[156:159], v[32:35], v[64:67], 0
    ds_read_b64_tr_b16 v[96:97], v15 offset:0
    v_mfma_f32_16x16x32_bf16 v[156:159], v[36:39], v[68:71], v[156:159]
    ds_read_b64_tr_b16 v[98:99], v15 offset:512
    v_mfma_f32_16x16x32_bf16 v[160:163], v[40:43], v[64:67], 0
    ds_read_b64_tr_b16 v[100:101], v15 offset:4096
    v_mfma_f32_16x16x32_bf16 v[160:163], v[44:47], v[68:71], v[160:163]
    ds_read_b64_tr_b16 v[102:103], v15 offset:4608
    v_mfma_f32_16x16x32_bf16 v[164:167], v[48:51], v[64:67], 0
    v_mfma_f32_16x16x32_bf16 v[164:167], v[52:55], v[68:71], v[164:167]
    s_waitcnt lgkmcnt(0)
    v_mfma_f32_16x16x32_bf16 v[168:171], v[24:27], v[72:75], 0
    s_add_u32 s52, s52, 40960
    s_cmp_eq_u32 s52, 122880
    v_mfma_f32_16x16x32_bf16 v[168:171], v[28:31], v[76:79], v[168:171]
    s_cselect_b32 s52, 0, s52
    v_add_u32 v10, s52, v8
    v_mfma_f32_16x16x32_bf16 v[172:175], v[32:35], v[72:75], 0
    v_add_u32 v11, s52, v9
    v_add_u32 v14, s52, v12
    v_mfma_f32_16x16x32_bf16 v[172:175], v[36:39], v[76:79], v[172:175]
    v_add_u32 v15, s52, v13
    v_xor_b32 v17, s39, v14
    v_mfma_f32_16x16x32_bf16 v[176:179], v[40:43], v[72:75], 0
    v_xor_b32 v18, s39, v15
    s_mov_b32 s60, s26
    v_mfma_f32_16x16x32_bf16 v[176:179], v[44:47], v[76:79], v[176:179]
    s_mov_b32 s61, s27
    s_mov_b32 s62, 0x2000000
    v_mfma_f32_16x16x32_bf16 v[180:183], v[48:51], v[72:75], 0
    s_mov_b32 s63, 0x20000
    s_mov_b32 s68, s22
    v_mfma_f32_16x16x32_bf16 v[180:183], v[52:55], v[76:79], v[180:183]
    s_mov_b32 s69, s23
    s_mov_b32 s70, 0x800000
    v_mfma_f32_16x16x32_bf16 v[184:187], v[24:27], v[80:83], 0
    s_mov_b32 s71, 0x20000
    v_lshlrev_b32 v3, 12, v2
    v_mfma_f32_16x16x32_bf16 v[184:187], v[28:31], v[84:87], v[184:187]
    v_lshl_add_u32 v16, v1, 4, v3
    s_lshl_b32 s45, s36, 18
    v_mfma_f32_16x16x32_bf16 v[188:191], v[32:35], v[80:83], 0
    s_lshl_b32 s46, s3, 16
    s_add_u32 s45, s45, s46
    v_mfma_f32_16x16x32_bf16 v[188:191], v[36:39], v[84:87], v[188:191]
    s_lshl_b32 s46, s37, 8
    s_sub_u32 s45, s45, s46
    v_mfma_f32_16x16x32_bf16 v[192:195], v[40:43], v[80:83], 0
    s_add_u32 s45, s45, 3840
    v_add_u32 v16, s45, v16
    v_mfma_f32_16x16x32_bf16 v[192:195], v[44:47], v[84:87], v[192:195]
    s_lshl_b32 s45, s3, 12
    s_add_u32 s45, s45, 139776
    v_mfma_f32_16x16x32_bf16 v[196:199], v[48:51], v[80:83], 0
    v_add_u32 v1, s45, v5
    s_lshl_b32 s45, s40, 6
    v_mfma_f32_16x16x32_bf16 v[196:199], v[52:55], v[84:87], v[196:199]
    v_xor_b32 v1, s45, v1
    v_xor_b32 v2, 16, v1
    v_mfma_f32_16x16x32_bf16 v[104:107], v[88:91], v[24:27], 0
    v_xor_b32 v3, 32, v1
    v_xor_b32 v6, 48, v1
    v_mfma_f32_16x16x32_bf16 v[104:107], v[92:95], v[28:31], v[104:107]
    s_movk_i32 s57, 0x4000
    s_mov_b32 s58, 0x8000
    v_mfma_f32_16x16x32_bf16 v[112:115], v[88:91], v[32:35], 0
    s_mov_b32 s59, 0xc000
    s_lshl_b32 s43, s36, 2
    v_mfma_f32_16x16x32_bf16 v[112:115], v[92:95], v[36:39], v[112:115]
    s_add_u32 s43, s43, s3
    s_lshl_b32 s43, s43, 4
    v_mfma_f32_16x16x32_bf16 v[120:123], v[88:91], v[40:43], 0
    s_add_u32 s43, s43, s37
    s_lshl_b32 s43, s43, 2
    v_mfma_f32_16x16x32_bf16 v[120:123], v[92:95], v[44:47], v[120:123]
    s_lshr_b32 vcc_lo, s43, 6
    s_mul_i32 vcc_lo, vcc_lo, 1984
    v_mfma_f32_16x16x32_bf16 v[128:131], v[88:91], v[48:51], 0
    s_add_u32 s43, s43, vcc_lo
    s_add_u32 s43, s43, 0x940000
    v_mfma_f32_16x16x32_bf16 v[128:131], v[92:95], v[52:55], v[128:131]
    s_movk_i32 s42, 5
    v_mfma_f32_16x16x32_bf16 v[108:111], v[96:99], v[24:27], 0
    v_mfma_f32_16x16x32_bf16 v[108:111], v[100:103], v[28:31], v[108:111]
    v_mfma_f32_16x16x32_bf16 v[116:119], v[96:99], v[32:35], 0
    v_mfma_f32_16x16x32_bf16 v[116:119], v[100:103], v[36:39], v[116:119]
    v_mfma_f32_16x16x32_bf16 v[124:127], v[96:99], v[40:43], 0
    v_mfma_f32_16x16x32_bf16 v[124:127], v[100:103], v[44:47], v[124:127]
    v_mfma_f32_16x16x32_bf16 v[132:135], v[96:99], v[48:51], 0
    v_mfma_f32_16x16x32_bf16 v[132:135], v[100:103], v[52:55], v[132:135]
    s_waitcnt vmcnt(10)
    v_lshlrev_b32 v24, 16, v200
    v_and_b32 v25, s56, v200
    v_lshlrev_b32 v26, 16, v201
    v_and_b32 v27, s56, v201
    v_lshlrev_b32 v28, 16, v202
    v_and_b32 v29, s56, v202
    v_lshlrev_b32 v30, 16, v203
    v_and_b32 v31, s56, v203
    v_lshlrev_b32 v32, 16, v204
    v_and_b32 v33, s56, v204
    v_lshlrev_b32 v34, 16, v205
    v_and_b32 v35, s56, v205
    v_lshlrev_b32 v36, 16, v206
    v_and_b32 v37, s56, v206
    v_lshlrev_b32 v38, 16, v207
    v_and_b32 v39, s56, v207
    v_lshlrev_b32 v40, 16, v208
    v_and_b32 v41, s56, v208
    v_lshlrev_b32 v42, 16, v209
    v_and_b32 v43, s56, v209
    v_lshlrev_b32 v44, 16, v210
    v_and_b32 v45, s56, v210
    v_lshlrev_b32 v46, 16, v211
    v_and_b32 v47, s56, v211
    v_lshlrev_b32 v48, 16, v212
    v_and_b32 v49, s56, v212
    v_lshlrev_b32 v50, 16, v213
    v_and_b32 v51, s56, v213
    v_lshlrev_b32 v52, 16, v214
    v_and_b32 v53, s56, v214
    v_lshlrev_b32 v54, 16, v215
    v_and_b32 v55, s56, v215
    v_lshlrev_b32 v56, 16, v216
    v_and_b32 v57, s56, v216
    v_lshlrev_b32 v58, 16, v217
    v_and_b32 v59, s56, v217
    v_lshlrev_b32 v60, 16, v218
    v_and_b32 v61, s56, v218
    v_lshlrev_b32 v62, 16, v219
    v_and_b32 v63, s56, v219
    v_lshlrev_b32 v64, 16, v220
    v_and_b32 v65, s56, v220
    v_lshlrev_b32 v66, 16, v221
    v_and_b32 v67, s56, v221
    s_waitcnt vmcnt(8)
    v_lshlrev_b32 v68, 16, v242
    v_and_b32 v72, s56, v242
    v_lshlrev_b32 v76, 16, v243
    v_and_b32 v80, s56, v243
    v_lshlrev_b32 v69, 16, v244
    v_and_b32 v73, s56, v244
    v_lshlrev_b32 v77, 16, v245
    v_and_b32 v81, s56, v245
    v_lshlrev_b32 v70, 16, v246
    v_and_b32 v74, s56, v246
    v_lshlrev_b32 v78, 16, v247
    v_and_b32 v82, s56, v247
    v_lshlrev_b32 v71, 16, v248
    v_and_b32 v75, s56, v248
    v_lshlrev_b32 v79, 16, v249
    v_and_b32 v83, s56, v249
    v_pk_mul_f32 v[84:85], v[36:37], v[68:69]
    v_pk_mul_f32 v[86:87], v[38:39], v[70:71]
    v_pk_mul_f32 v[88:89], v[40:41], v[68:69]
    v_pk_mul_f32 v[90:91], v[42:43], v[70:71]
    v_pk_fma_f32 v[84:85], v[32:33], v[72:73], v[84:85]
    v_pk_fma_f32 v[86:87], v[34:35], v[74:75], v[86:87]
    v_pk_fma_f32 v[88:89], v[36:37], v[72:73], v[88:89]
    v_pk_fma_f32 v[90:91], v[38:39], v[74:75], v[90:91]
    v_pk_fma_f32 v[84:85], v[28:29], v[76:77], v[84:85]
    v_pk_fma_f32 v[86:87], v[30:31], v[78:79], v[86:87]
    v_pk_fma_f32 v[88:89], v[32:33], v[76:77], v[88:89]
    v_pk_fma_f32 v[90:91], v[34:35], v[78:79], v[90:91]
    v_pk_fma_f32 v[24:25], v[24:25], v[80:81], v[84:85]
    v_pk_fma_f32 v[26:27], v[26:27], v[82:83], v[86:87]
    v_pk_fma_f32 v[28:29], v[28:29], v[80:81], v[88:89]
    v_pk_fma_f32 v[30:31], v[30:31], v[82:83], v[90:91]
    v_pk_mul_f32 v[84:85], v[44:45], v[68:69]
    v_pk_mul_f32 v[86:87], v[46:47], v[70:71]
    v_pk_mul_f32 v[88:89], v[48:49], v[68:69]
    v_pk_mul_f32 v[90:91], v[50:51], v[70:71]
    v_pk_fma_f32 v[84:85], v[40:41], v[72:73], v[84:85]
    v_pk_fma_f32 v[86:87], v[42:43], v[74:75], v[86:87]
    v_pk_fma_f32 v[88:89], v[44:45], v[72:73], v[88:89]
    v_pk_fma_f32 v[90:91], v[46:47], v[74:75], v[90:91]
    v_pk_fma_f32 v[84:85], v[36:37], v[76:77], v[84:85]
    v_pk_fma_f32 v[86:87], v[38:39], v[78:79], v[86:87]
    v_pk_fma_f32 v[88:89], v[40:41], v[76:77], v[88:89]
    v_pk_fma_f32 v[90:91], v[42:43], v[78:79], v[90:91]
    v_pk_fma_f32 v[32:33], v[32:33], v[80:81], v[84:85]
    v_pk_fma_f32 v[34:35], v[34:35], v[82:83], v[86:87]
    v_pk_fma_f32 v[36:37], v[36:37], v[80:81], v[88:89]
    v_pk_fma_f32 v[38:39], v[38:39], v[82:83], v[90:91]
    v_pk_mul_f32 v[84:85], v[52:53], v[68:69]
    v_pk_mul_f32 v[86:87], v[54:55], v[70:71]
    v_pk_mul_f32 v[88:89], v[56:57], v[68:69]
    v_pk_mul_f32 v[90:91], v[58:59], v[70:71]
    v_pk_fma_f32 v[84:85], v[48:49], v[72:73], v[84:85]
    v_pk_fma_f32 v[86:87], v[50:51], v[74:75], v[86:87]
    v_pk_fma_f32 v[88:89], v[52:53], v[72:73], v[88:89]
    v_pk_fma_f32 v[90:91], v[54:55], v[74:75], v[90:91]
    v_pk_fma_f32 v[84:85], v[44:45], v[76:77], v[84:85]
    v_pk_fma_f32 v[86:87], v[46:47], v[78:79], v[86:87]
    v_pk_fma_f32 v[88:89], v[48:49], v[76:77], v[88:89]
    v_pk_fma_f32 v[90:91], v[50:51], v[78:79], v[90:91]
    v_pk_fma_f32 v[40:41], v[40:41], v[80:81], v[84:85]
    v_pk_fma_f32 v[42:43], v[42:43], v[82:83], v[86:87]
    v_pk_fma_f32 v[44:45], v[44:45], v[80:81], v[88:89]
    v_pk_fma_f32 v[46:47], v[46:47], v[82:83], v[90:91]
    v_pk_mul_f32 v[84:85], v[60:61], v[68:69]
    v_pk_mul_f32 v[86:87], v[62:63], v[70:71]
    v_pk_mul_f32 v[88:89], v[64:65], v[68:69]
    v_pk_mul_f32 v[90:91], v[66:67], v[70:71]
    v_pk_fma_f32 v[84:85], v[56:57], v[72:73], v[84:85]
    v_pk_fma_f32 v[86:87], v[58:59], v[74:75], v[86:87]
    v_pk_fma_f32 v[88:89], v[60:61], v[72:73], v[88:89]
    v_pk_fma_f32 v[90:91], v[62:63], v[74:75], v[90:91]
    v_pk_fma_f32 v[84:85], v[52:53], v[76:77], v[84:85]
    v_pk_fma_f32 v[86:87], v[54:55], v[78:79], v[86:87]
    v_pk_fma_f32 v[88:89], v[56:57], v[76:77], v[88:89]
    v_pk_fma_f32 v[90:91], v[58:59], v[78:79], v[90:91]
    v_pk_fma_f32 v[48:49], v[48:49], v[80:81], v[84:85]
    v_pk_fma_f32 v[50:51], v[50:51], v[82:83], v[86:87]
    v_pk_fma_f32 v[52:53], v[52:53], v[80:81], v[88:89]
    v_pk_fma_f32 v[54:55], v[54:55], v[82:83], v[90:91]
    s_waitcnt vmcnt(0)
    v_lshlrev_b32 v56, 16, v222
    v_and_b32 v57, s56, v222
    v_lshlrev_b32 v58, 16, v223
    v_and_b32 v59, s56, v223
    v_lshlrev_b32 v60, 16, v224
    v_and_b32 v61, s56, v224
    v_lshlrev_b32 v62, 16, v225
    v_and_b32 v63, s56, v225
    v_lshlrev_b32 v64, 16, v226
    v_and_b32 v65, s56, v226
    v_lshlrev_b32 v66, 16, v227
    v_and_b32 v67, s56, v227
    v_lshlrev_b32 v68, 16, v228
    v_and_b32 v69, s56, v228
    v_lshlrev_b32 v70, 16, v229
    v_and_b32 v71, s56, v229
    v_lshlrev_b32 v72, 16, v230
    v_and_b32 v73, s56, v230
    v_lshlrev_b32 v74, 16, v231
    v_and_b32 v75, s56, v231
    v_lshlrev_b32 v76, 16, v236
    v_and_b32 v77, s56, v236
    v_lshlrev_b32 v78, 16, v237
    v_and_b32 v79, s56, v237
    v_lshlrev_b32 v80, 16, v238
    v_and_b32 v81, s56, v238
    v_lshlrev_b32 v82, 16, v239
    v_and_b32 v83, s56, v239
    v_lshlrev_b32 v84, 16, v240
    v_and_b32 v85, s56, v240
    v_lshlrev_b32 v86, 16, v241
    v_and_b32 v87, s56, v241
    v_pk_mul_f32 v[24:25], v[24:25], v[56:57]
    v_pk_mul_f32 v[28:29], v[28:29], v[60:61]
    v_pk_mul_f32 v[32:33], v[32:33], v[64:65]
    v_pk_mul_f32 v[36:37], v[36:37], v[68:69]
    v_pk_mul_f32 v[40:41], v[40:41], v[72:73]
    v_pk_mul_f32 v[44:45], v[44:45], v[76:77]
    v_pk_mul_f32 v[48:49], v[48:49], v[80:81]
    v_pk_mul_f32 v[52:53], v[52:53], v[84:85]
    v_cvt_pk_bf16_f32 v200, v52, v48
    v_cvt_pk_bf16_f32 v201, v44, v40
    v_cvt_pk_bf16_f32 v202, v36, v32
    v_cvt_pk_bf16_f32 v203, v28, v24
    ds_write_b128 v19, v[200:203] offset:0
    v_cvt_pk_bf16_f32 v204, v53, v49
    v_cvt_pk_bf16_f32 v205, v45, v41
    v_cvt_pk_bf16_f32 v206, v37, v33
    v_cvt_pk_bf16_f32 v207, v29, v25
    ds_write_b128 v19, v[204:207] offset:256
    v_pk_mul_f32 v[26:27], v[26:27], v[58:59]
    v_pk_mul_f32 v[30:31], v[30:31], v[62:63]
    v_pk_mul_f32 v[34:35], v[34:35], v[66:67]
    v_pk_mul_f32 v[38:39], v[38:39], v[70:71]
    v_pk_mul_f32 v[42:43], v[42:43], v[74:75]
    v_pk_mul_f32 v[46:47], v[46:47], v[78:79]
    v_pk_mul_f32 v[50:51], v[50:51], v[82:83]
    v_pk_mul_f32 v[54:55], v[54:55], v[86:87]
    v_cvt_pk_bf16_f32 v208, v54, v50
    v_cvt_pk_bf16_f32 v209, v46, v42
    v_cvt_pk_bf16_f32 v210, v38, v34
    v_cvt_pk_bf16_f32 v211, v30, v26
    ds_write_b128 v19, v[208:211] offset:512
    v_cvt_pk_bf16_f32 v212, v55, v51
    v_cvt_pk_bf16_f32 v213, v47, v43
    v_cvt_pk_bf16_f32 v214, v39, v35
    v_cvt_pk_bf16_f32 v215, v31, v27
    ds_write_b128 v19, v[212:215] offset:768
    s_waitcnt lgkmcnt(0)
    s_barrier
    ds_read_b128 v[24:27], v10 offset:0
    ds_read_b128 v[28:31], v11 offset:0
    ds_read_b64_tr_b16 v[56:57], v14 offset:8192
    ds_read_b64_tr_b16 v[58:59], v14 offset:8704
    ds_read_b64_tr_b16 v[60:61], v14 offset:12288
    ds_read_b64_tr_b16 v[62:63], v14 offset:12800
    ds_read_b128 v[32:35], v10 offset:2048
    ds_read_b128 v[36:39], v11 offset:2048
    ds_read_b128 v[40:43], v10 offset:4096
    ds_read_b128 v[44:47], v11 offset:4096
    ds_read_b128 v[48:51], v10 offset:6144
    ds_read_b128 v[52:55], v11 offset:6144
    s_waitcnt lgkmcnt(6)
    ds_read_b64_tr_b16 v[64:65], v15 offset:8192
    ds_read_b64_tr_b16 v[66:67], v15 offset:8704
    ds_read_b64_tr_b16 v[68:69], v15 offset:12288
    ds_read_b64_tr_b16 v[70:71], v15 offset:12800
    ds_read_b64_tr_b16 v[72:73], v17 offset:16384
    ds_read_b64_tr_b16 v[74:75], v17 offset:16896
    ds_read_b64_tr_b16 v[76:77], v17 offset:20480
    ds_read_b64_tr_b16 v[78:79], v17 offset:20992
    s_waitcnt lgkmcnt(8)
    ds_read_b64_tr_b16 v[80:81], v18 offset:16384
    ds_read_b64_tr_b16 v[82:83], v18 offset:16896
    ds_read_b64_tr_b16 v[84:85], v18 offset:20480
    ds_read_b64_tr_b16 v[86:87], v18 offset:20992
    ds_read_b64_tr_b16 v[88:89], v14 offset:0
    ds_read_b64_tr_b16 v[90:91], v14 offset:512
    ds_read_b64_tr_b16 v[92:93], v14 offset:4096
    ds_read_b64_tr_b16 v[94:95], v14 offset:4608
    s_waitcnt lgkmcnt(8)
    ds_read_b128 v[236:239], v1 offset:0
    ds_read_b128 v[240:243], v2 offset:1024
    ds_read_b128 v[244:247], v3 offset:2048
    ds_read_b128 v[248:251], v6 offset:3072
    s_branch L_loop1
L_side:
    s_cmp_eq_u32 s53, 0
    s_cbranch_scc0 L_side2
    buffer_store_dwordx4 v[236:239], v16, s[60:63], 0 offen sc1
    buffer_store_dwordx4 v[240:243], v16, s[60:63], s57 offen sc1
    buffer_store_dwordx4 v[244:247], v16, s[60:63], s58 offen sc1
    buffer_store_dwordx4 v[248:251], v16, s[60:63], s59 offen sc1
    s_branch L_back
L_side2:
    v_readfirstlane_b32 s72, v234
    s_mov_b32 s45, 0
    s_waitcnt vmcnt(0)
    s_cmp_lg_u32 s72, 0
    s_cbranch_scc1 L_cepok
L_cep:
    ds_read_b32 v234, v20 offset:56
    s_add_u32 s45, s45, 1
    s_waitcnt lgkmcnt(0)
    v_readfirstlane_b32 s72, v234
    s_cmp_gt_u32 s45, 0x40000
    s_cbranch_scc1 L_cepok
    s_cmp_eq_u32 s72, 0
    s_cbranch_scc1 L_cep
L_cepok:
    s_mov_b32 s73, s72
    s_mov_b64 exec, 0xffff
    buffer_store_dword v234, v254, s[60:63], s43 offen sc1
    s_mov_b64 exec, -1
    s_branch L_back

L_loop1:
    v_mfma_f32_16x16x32_bf16 v[136:139], v[24:27], v[56:59], v[136:139]
    ds_read_b64_tr_b16 v[96:97], v15 offset:0
    v_mfma_f32_16x16x32_bf16 v[136:139], v[28:31], v[60:63], v[136:139]
    ds_read_b64_tr_b16 v[98:99], v15 offset:512
    v_mfma_f32_16x16x32_bf16 v[140:143], v[32:35], v[56:59], v[140:143]
    ds_read_b64_tr_b16 v[100:101], v15 offset:4096
    v_mfma_f32_16x16x32_bf16 v[140:143], v[36:39], v[60:63], v[140:143]
    ds_read_b64_tr_b16 v[102:103], v15 offset:4608
    v_mfma_f32_16x16x32_bf16 v[144:147], v[40:43], v[56:59], v[144:147]
    s_add_u32 s52, s52, 40960
    s_cmp_eq_u32 s52, 122880
    s_cselect_b32 s52, 0, s52
    v_mfma_f32_16x16x32_bf16 v[144:147], v[44:47], v[60:63], v[144:147]
    v_add_u32 v10, s52, v8
    v_add_u32 v11, s52, v9
    v_mfma_f32_16x16x32_bf16 v[148:151], v[48:51], v[56:59], v[148:151]
    v_add_u32 v14, s52, v12
    v_add_u32 v15, s52, v13
    v_mfma_f32_16x16x32_bf16 v[148:151], v[52:55], v[60:63], v[148:151]
    v_xor_b32 v17, s39, v14
    v_xor_b32 v18, s39, v15
    s_waitcnt lgkmcnt(0)
    v_mfma_f32_16x16x32_bf16 v[152:155], v[24:27], v[64:67], v[152:155]
    s_barrier
    v_mfma_f32_16x16x32_bf16 v[152:155], v[28:31], v[68:71], v[152:155]
    ds_read_b64_tr_b16 v[56:57], v14 offset:8192
    v_mfma_f32_16x16x32_bf16 v[156:159], v[32:35], v[64:67], v[156:159]
    ds_read_b64_tr_b16 v[58:59], v14 offset:8704
    v_mfma_f32_16x16x32_bf16 v[156:159], v[36:39], v[68:71], v[156:159]
    ds_read_b64_tr_b16 v[60:61], v14 offset:12288
    v_mfma_f32_16x16x32_bf16 v[160:163], v[40:43], v[64:67], v[160:163]
    ds_read_b64_tr_b16 v[62:63], v14 offset:12800
    v_mfma_f32_16x16x32_bf16 v[160:163], v[44:47], v[68:71], v[160:163]
    ds_read_b128 v[200:203], v10 offset:0
    v_mfma_f32_16x16x32_bf16 v[164:167], v[48:51], v[64:67], v[164:167]
    ds_read_b128 v[204:207], v11 offset:0
    v_mfma_f32_16x16x32_bf16 v[164:167], v[52:55], v[68:71], v[164:167]
    ds_read_b128 v[208:211], v10 offset:2048
    v_mfma_f32_16x16x32_bf16 v[168:171], v[24:27], v[72:75], v[168:171]
    ds_read_b64_tr_b16 v[64:65], v15 offset:8192
    v_mfma_f32_16x16x32_bf16 v[168:171], v[28:31], v[76:79], v[168:171]
    ds_read_b64_tr_b16 v[66:67], v15 offset:8704
    v_mfma_f32_16x16x32_bf16 v[172:175], v[32:35], v[72:75], v[172:175]
    ds_read_b64_tr_b16 v[68:69], v15 offset:12288
    v_mfma_f32_16x16x32_bf16 v[172:175], v[36:39], v[76:79], v[172:175]
    ds_read_b64_tr_b16 v[70:71], v15 offset:12800
    v_mfma_f32_16x16x32_bf16 v[176:179], v[40:43], v[72:75], v[176:179]
    ds_read_b128 v[212:215], v11 offset:2048
    v_mfma_f32_16x16x32_bf16 v[176:179], v[44:47], v[76:79], v[176:179]
    ds_read_b128 v[216:219], v10 offset:4096
    v_mfma_f32_16x16x32_bf16 v[180:183], v[48:51], v[72:75], v[180:183]
    ds_read_b128 v[220:223], v11 offset:4096
    v_mfma_f32_16x16x32_bf16 v[180:183], v[52:55], v[76:79], v[180:183]
    ds_read_b128 v[224:227], v10 offset:6144
    v_mfma_f32_16x16x32_bf16 v[184:187], v[24:27], v[80:83], v[184:187]
    ds_read_b64_tr_b16 v[72:73], v17 offset:16384
    v_mfma_f32_16x16x32_bf16 v[184:187], v[28:31], v[84:87], v[184:187]
    ds_read_b64_tr_b16 v[74:75], v17 offset:16896
    v_mfma_f32_16x16x32_bf16 v[188:191], v[32:35], v[80:83], v[188:191]
    ds_read_b64_tr_b16 v[76:77], v17 offset:20480
    v_mfma_f32_16x16x32_bf16 v[188:191], v[36:39], v[84:87], v[188:191]
    ds_read_b64_tr_b16 v[78:79], v17 offset:20992
    v_mfma_f32_16x16x32_bf16 v[192:195], v[40:43], v[80:83], v[192:195]
    ds_read_b128 v[228:231], v11 offset:6144
    v_mfma_f32_16x16x32_bf16 v[192:195], v[44:47], v[84:87], v[192:195]
    s_bitcmp1_b32 s42, s53
    v_mfma_f32_16x16x32_bf16 v[196:199], v[48:51], v[80:83], v[196:199]
    s_cbranch_scc1 L_side
L_back:
    v_mfma_f32_16x16x32_bf16 v[196:199], v[52:55], v[84:87], v[196:199]
    v_mfma_f32_16x16x32_bf16 v[104:107], v[88:91], v[24:27], v[104:107]
    ds_read_b64_tr_b16 v[80:81], v18 offset:16384
    v_mfma_f32_16x16x32_bf16 v[104:107], v[92:95], v[28:31], v[104:107]
    ds_read_b64_tr_b16 v[82:83], v18 offset:16896
    v_mfma_f32_16x16x32_bf16 v[112:115], v[88:91], v[32:35], v[112:115]
    ds_read_b64_tr_b16 v[84:85], v18 offset:20480
    v_mfma_f32_16x16x32_bf16 v[112:115], v[92:95], v[36:39], v[112:115]
    ds_read_b64_tr_b16 v[86:87], v18 offset:20992
    v_mfma_f32_16x16x32_bf16 v[120:123], v[88:91], v[40:43], v[120:123]
    ds_read_b32 v234, v20 offset:56
    v_mfma_f32_16x16x32_bf16 v[120:123], v[92:95], v[44:47], v[120:123]
    v_mfma_f32_16x16x32_bf16 v[128:131], v[88:91], v[48:51], v[128:131]
    v_mfma_f32_16x16x32_bf16 v[128:131], v[92:95], v[52:55], v[128:131]
    v_mfma_f32_16x16x32_bf16 v[108:111], v[96:99], v[24:27], v[108:111]
    s_waitcnt lgkmcnt(4)
    ds_read_b64_tr_b16 v[88:89], v14 offset:0
    v_mfma_f32_16x16x32_bf16 v[108:111], v[100:103], v[28:31], v[108:111]
    ds_read_b64_tr_b16 v[90:91], v14 offset:512
    v_mfma_f32_16x16x32_bf16 v[116:119], v[96:99], v[32:35], v[116:119]
    ds_read_b64_tr_b16 v[92:93], v14 offset:4096
    v_mfma_f32_16x16x32_bf16 v[116:119], v[100:103], v[36:39], v[116:119]
    ds_read_b64_tr_b16 v[94:95], v14 offset:4608
    v_mfma_f32_16x16x32_bf16 v[124:127], v[96:99], v[40:43], v[124:127]
    v_mfma_f32_16x16x32_bf16 v[124:127], v[100:103], v[44:47], v[124:127]
    v_mfma_f32_16x16x32_bf16 v[132:135], v[96:99], v[48:51], v[132:135]
    v_mfma_f32_16x16x32_bf16 v[132:135], v[100:103], v[52:55], v[132:135]
    v_mfma_f32_16x16x32_bf16 v[136:139], v[200:203], v[56:59], v[136:139]
    ds_read_b64_tr_b16 v[96:97], v15 offset:0
    v_mfma_f32_16x16x32_bf16 v[136:139], v[204:207], v[60:63], v[136:139]
    ds_read_b64_tr_b16 v[98:99], v15 offset:512
    v_mfma_f32_16x16x32_bf16 v[140:143], v[208:211], v[56:59], v[140:143]
    ds_read_b64_tr_b16 v[100:101], v15 offset:4096
    v_mfma_f32_16x16x32_bf16 v[140:143], v[212:215], v[60:63], v[140:143]
    ds_read_b64_tr_b16 v[102:103], v15 offset:4608
    v_mfma_f32_16x16x32_bf16 v[144:147], v[216:219], v[56:59], v[144:147]
    s_add_u32 s52, s52, 40960
    s_cmp_eq_u32 s52, 122880
    s_cselect_b32 s52, 0, s52
    v_mfma_f32_16x16x32_bf16 v[144:147], v[220:223], v[60:63], v[144:147]
    v_add_u32 v10, s52, v8
    v_add_u32 v11, s52, v9
    v_mfma_f32_16x16x32_bf16 v[148:151], v[224:227], v[56:59], v[148:151]
    v_add_u32 v14, s52, v12
    v_add_u32 v15, s52, v13
    v_mfma_f32_16x16x32_bf16 v[148:151], v[228:231], v[60:63], v[148:151]
    v_xor_b32 v17, s39, v14
    v_xor_b32 v18, s39, v15
    s_waitcnt lgkmcnt(0)
    v_mfma_f32_16x16x32_bf16 v[152:155], v[200:203], v[64:67], v[152:155]
    s_barrier
    v_mfma_f32_16x16x32_bf16 v[152:155], v[204:207], v[68:71], v[152:155]
    ds_read_b64_tr_b16 v[56:57], v14 offset:8192
    v_mfma_f32_16x16x32_bf16 v[156:159], v[208:211], v[64:67], v[156:159]
    ds_read_b64_tr_b16 v[58:59], v14 offset:8704
    v_mfma_f32_16x16x32_bf16 v[156:159], v[212:215], v[68:71], v[156:159]
    ds_read_b64_tr_b16 v[60:61], v14 offset:12288
    v_mfma_f32_16x16x32_bf16 v[160:163], v[216:219], v[64:67], v[160:163]
    ds_read_b64_tr_b16 v[62:63], v14 offset:12800
    v_mfma_f32_16x16x32_bf16 v[160:163], v[220:223], v[68:71], v[160:163]
    ds_read_b128 v[24:27], v10 offset:0
    v_mfma_f32_16x16x32_bf16 v[164:167], v[224:227], v[64:67], v[164:167]
    ds_read_b128 v[28:31], v11 offset:0
    v_mfma_f32_16x16x32_bf16 v[164:167], v[228:231], v[68:71], v[164:167]
    ds_read_b128 v[32:35], v10 offset:2048
    v_mfma_f32_16x16x32_bf16 v[168:171], v[200:203], v[72:75], v[168:171]
    ds_read_b64_tr_b16 v[64:65], v15 offset:8192
    v_mfma_f32_16x16x32_bf16 v[168:171], v[204:207], v[76:79], v[168:171]
    ds_read_b64_tr_b16 v[66:67], v15 offset:8704
    v_mfma_f32_16x16x32_bf16 v[172:175], v[208:211], v[72:75], v[172:175]
    ds_read_b64_tr_b16 v[68:69], v15 offset:12288
    v_mfma_f32_16x16x32_bf16 v[172:175], v[212:215], v[76:79], v[172:175]
    ds_read_b64_tr_b16 v[70:71], v15 offset:12800
    v_mfma_f32_16x16x32_bf16 v[176:179], v[216:219], v[72:75], v[176:179]
    ds_read_b128 v[36:39], v11 offset:2048
    v_mfma_f32_16x16x32_bf16 v[176:179], v[220:223], v[76:79], v[176:179]
    ds_read_b128 v[40:43], v10 offset:4096
    v_mfma_f32_16x16x32_bf16 v[180:183], v[224:227], v[72:75], v[180:183]
    ds_read_b128 v[44:47], v11 offset:4096
    v_mfma_f32_16x16x32_bf16 v[180:183], v[228:231], v[76:79], v[180:183]
    ds_read_b128 v[48:51], v10 offset:6144
    v_mfma_f32_16x16x32_bf16 v[184:187], v[200:203], v[80:83], v[184:187]
    ds_read_b64_tr_b16 v[72:73], v17 offset:16384
    v_mfma_f32_16x16x32_bf16 v[184:187], v[204:207], v[84:87], v[184:187]
    ds_read_b64_tr_b16 v[74:75], v17 offset:16896
    v_mfma_f32_16x16x32_bf16 v[188:191], v[208:211], v[80:83], v[188:191]
    ds_read_b64_tr_b16 v[76:77], v17 offset:20480
    v_mfma_f32_16x16x32_bf16 v[188:191], v[212:215], v[84:87], v[188:191]
    ds_read_b64_tr_b16 v[78:79], v17 offset:20992
    v_mfma_f32_16x16x32_bf16 v[192:195], v[216:219], v[80:83], v[192:195]
    ds_read_b128 v[52:55], v11 offset:6144
    v_mfma_f32_16x16x32_bf16 v[192:195], v[220:223], v[84:87], v[192:195]
    v_mfma_f32_16x16x32_bf16 v[196:199], v[224:227], v[80:83], v[196:199]
    v_mfma_f32_16x16x32_bf16 v[196:199], v[228:231], v[84:87], v[196:199]
    v_mfma_f32_16x16x32_bf16 v[104:107], v[88:91], v[200:203], v[104:107]
    ds_read_b64_tr_b16 v[80:81], v18 offset:16384
    v_mfma_f32_16x16x32_bf16 v[104:107], v[92:95], v[204:207], v[104:107]
    ds_read_b64_tr_b16 v[82:83], v18 offset:16896
    v_mfma_f32_16x16x32_bf16 v[112:115], v[88:91], v[208:211], v[112:115]
    ds_read_b64_tr_b16 v[84:85], v18 offset:20480
    v_mfma_f32_16x16x32_bf16 v[112:115], v[92:95], v[212:215], v[112:115]
    ds_read_b64_tr_b16 v[86:87], v18 offset:20992
    v_mfma_f32_16x16x32_bf16 v[120:123], v[88:91], v[216:219], v[120:123]
    v_mfma_f32_16x16x32_bf16 v[120:123], v[92:95], v[220:223], v[120:123]
    v_mfma_f32_16x16x32_bf16 v[128:131], v[88:91], v[224:227], v[128:131]
    v_mfma_f32_16x16x32_bf16 v[128:131], v[92:95], v[228:231], v[128:131]
    v_mfma_f32_16x16x32_bf16 v[108:111], v[96:99], v[200:203], v[108:111]
    s_waitcnt lgkmcnt(4)
    ds_read_b64_tr_b16 v[88:89], v14 offset:0
    v_mfma_f32_16x16x32_bf16 v[108:111], v[100:103], v[204:207], v[108:111]
    ds_read_b64_tr_b16 v[90:91], v14 offset:512
    v_mfma_f32_16x16x32_bf16 v[116:119], v[96:99], v[208:211], v[116:119]
    ds_read_b64_tr_b16 v[92:93], v14 offset:4096
    v_mfma_f32_16x16x32_bf16 v[116:119], v[100:103], v[212:215], v[116:119]
    ds_read_b64_tr_b16 v[94:95], v14 offset:4608
    v_mfma_f32_16x16x32_bf16 v[124:127], v[96:99], v[216:219], v[124:127]
    s_add_u32 s53, s53, 1
    v_mfma_f32_16x16x32_bf16 v[124:127], v[100:103], v[220:223], v[124:127]
    s_cmp_lt_u32 s53, 6
    v_mfma_f32_16x16x32_bf16 v[132:135], v[96:99], v[224:227], v[132:135]
    v_mfma_f32_16x16x32_bf16 v[132:135], v[100:103], v[228:231], v[132:135]
    s_cbranch_scc1 L_loop1
    v_mfma_f32_16x16x32_bf16 v[136:139], v[24:27], v[56:59], v[136:139]
    ds_read_b64_tr_b16 v[96:97], v15 offset:0
    v_mfma_f32_16x16x32_bf16 v[136:139], v[28:31], v[60:63], v[136:139]
    ds_read_b64_tr_b16 v[98:99], v15 offset:512
    v_mfma_f32_16x16x32_bf16 v[140:143], v[32:35], v[56:59], v[140:143]
    ds_read_b64_tr_b16 v[100:101], v15 offset:4096
    v_mfma_f32_16x16x32_bf16 v[140:143], v[36:39], v[60:63], v[140:143]
    ds_read_b64_tr_b16 v[102:103], v15 offset:4608
    v_mfma_f32_16x16x32_bf16 v[144:147], v[40:43], v[56:59], v[144:147]
    s_add_u32 s52, s52, 40960
    s_cmp_eq_u32 s52, 122880
    s_cselect_b32 s52, 0, s52
    v_mfma_f32_16x16x32_bf16 v[144:147], v[44:47], v[60:63], v[144:147]
    v_add_u32 v10, s52, v8
    v_add_u32 v11, s52, v9
    v_mfma_f32_16x16x32_bf16 v[148:151], v[48:51], v[56:59], v[148:151]
    v_add_u32 v14, s52, v12
    v_add_u32 v15, s52, v13
    v_mfma_f32_16x16x32_bf16 v[148:151], v[52:55], v[60:63], v[148:151]
    v_xor_b32 v17, s39, v14
    v_xor_b32 v18, s39, v15
    s_waitcnt lgkmcnt(0)
    v_mfma_f32_16x16x32_bf16 v[152:155], v[24:27], v[64:67], v[152:155]
    s_barrier
    v_mfma_f32_16x16x32_bf16 v[152:155], v[28:31], v[68:71], v[152:155]
    ds_read_b64_tr_b16 v[56:57], v14 offset:8192
    v_mfma_f32_16x16x32_bf16 v[156:159], v[32:35], v[64:67], v[156:159]
    ds_read_b64_tr_b16 v[58:59], v14 offset:8704
    v_mfma_f32_16x16x32_bf16 v[156:159], v[36:39], v[68:71], v[156:159]
    ds_read_b64_tr_b16 v[60:61], v14 offset:12288
    v_mfma_f32_16x16x32_bf16 v[160:163], v[40:43], v[64:67], v[160:163]
    ds_read_b64_tr_b16 v[62:63], v14 offset:12800
    v_mfma_f32_16x16x32_bf16 v[160:163], v[44:47], v[68:71], v[160:163]
    ds_read_b128 v[200:203], v10 offset:0
    v_mfma_f32_16x16x32_bf16 v[164:167], v[48:51], v[64:67], v[164:167]
    ds_read_b128 v[204:207], v11 offset:0
    v_mfma_f32_16x16x32_bf16 v[164:167], v[52:55], v[68:71], v[164:167]
    ds_read_b128 v[208:211], v10 offset:2048
    v_mfma_f32_16x16x32_bf16 v[168:171], v[24:27], v[72:75], v[168:171]
    ds_read_b64_tr_b16 v[64:65], v15 offset:8192
    v_mfma_f32_16x16x32_bf16 v[168:171], v[28:31], v[76:79], v[168:171]
    ds_read_b64_tr_b16 v[66:67], v15 offset:8704
    v_mfma_f32_16x16x32_bf16 v[172:175], v[32:35], v[72:75], v[172:175]
    ds_read_b64_tr_b16 v[68:69], v15 offset:12288
    v_mfma_f32_16x16x32_bf16 v[172:175], v[36:39], v[76:79], v[172:175]
    ds_read_b64_tr_b16 v[70:71], v15 offset:12800
    v_mfma_f32_16x16x32_bf16 v[176:179], v[40:43], v[72:75], v[176:179]
    ds_read_b128 v[212:215], v11 offset:2048
    v_mfma_f32_16x16x32_bf16 v[176:179], v[44:47], v[76:79], v[176:179]
    ds_read_b128 v[216:219], v10 offset:4096
    v_mfma_f32_16x16x32_bf16 v[180:183], v[48:51], v[72:75], v[180:183]
    ds_read_b128 v[220:223], v11 offset:4096
    v_mfma_f32_16x16x32_bf16 v[180:183], v[52:55], v[76:79], v[180:183]
    ds_read_b128 v[224:227], v10 offset:6144
    v_mfma_f32_16x16x32_bf16 v[184:187], v[24:27], v[80:83], v[184:187]
    ds_read_b64_tr_b16 v[72:73], v17 offset:16384
    v_mfma_f32_16x16x32_bf16 v[184:187], v[28:31], v[84:87], v[184:187]
    ds_read_b64_tr_b16 v[74:75], v17 offset:16896
    v_mfma_f32_16x16x32_bf16 v[188:191], v[32:35], v[80:83], v[188:191]
    ds_read_b64_tr_b16 v[76:77], v17 offset:20480
    v_mfma_f32_16x16x32_bf16 v[188:191], v[36:39], v[84:87], v[188:191]
    ds_read_b64_tr_b16 v[78:79], v17 offset:20992
    v_mfma_f32_16x16x32_bf16 v[192:195], v[40:43], v[80:83], v[192:195]
    ds_read_b128 v[228:231], v11 offset:6144
    v_mfma_f32_16x16x32_bf16 v[192:195], v[44:47], v[84:87], v[192:195]
    v_mfma_f32_16x16x32_bf16 v[196:199], v[48:51], v[80:83], v[196:199]
    v_mfma_f32_16x16x32_bf16 v[196:199], v[52:55], v[84:87], v[196:199]
    v_mfma_f32_16x16x32_bf16 v[104:107], v[88:91], v[24:27], v[104:107]
    ds_read_b64_tr_b16 v[80:81], v18 offset:16384
    v_mfma_f32_16x16x32_bf16 v[104:107], v[92:95], v[28:31], v[104:107]
    ds_read_b64_tr_b16 v[82:83], v18 offset:16896
    v_mfma_f32_16x16x32_bf16 v[112:115], v[88:91], v[32:35], v[112:115]
    ds_read_b64_tr_b16 v[84:85], v18 offset:20480
    v_mfma_f32_16x16x32_bf16 v[112:115], v[92:95], v[36:39], v[112:115]
    ds_read_b64_tr_b16 v[86:87], v18 offset:20992
    v_mfma_f32_16x16x32_bf16 v[120:123], v[88:91], v[40:43], v[120:123]
    v_mfma_f32_16x16x32_bf16 v[120:123], v[92:95], v[44:47], v[120:123]
    v_mfma_f32_16x16x32_bf16 v[128:131], v[88:91], v[48:51], v[128:131]
    v_mfma_f32_16x16x32_bf16 v[128:131], v[92:95], v[52:55], v[128:131]
    v_mfma_f32_16x16x32_bf16 v[108:111], v[96:99], v[24:27], v[108:111]
    s_waitcnt lgkmcnt(4)
    ds_read_b64_tr_b16 v[88:89], v14 offset:0
    v_mfma_f32_16x16x32_bf16 v[108:111], v[100:103], v[28:31], v[108:111]
    ds_read_b64_tr_b16 v[90:91], v14 offset:512
    v_mfma_f32_16x16x32_bf16 v[116:119], v[96:99], v[32:35], v[116:119]
    ds_read_b64_tr_b16 v[92:93], v14 offset:4096
    v_mfma_f32_16x16x32_bf16 v[116:119], v[100:103], v[36:39], v[116:119]
    ds_read_b64_tr_b16 v[94:95], v14 offset:4608
    v_mfma_f32_16x16x32_bf16 v[124:127], v[96:99], v[40:43], v[124:127]
    v_mfma_f32_16x16x32_bf16 v[124:127], v[100:103], v[44:47], v[124:127]
    v_mfma_f32_16x16x32_bf16 v[132:135], v[96:99], v[48:51], v[132:135]
    v_mfma_f32_16x16x32_bf16 v[132:135], v[100:103], v[52:55], v[132:135]
    v_mfma_f32_16x16x32_bf16 v[136:139], v[200:203], v[56:59], v[136:139]
    ds_read_b64_tr_b16 v[96:97], v15 offset:0
    v_mfma_f32_16x16x32_bf16 v[136:139], v[204:207], v[60:63], v[136:139]
    ds_read_b64_tr_b16 v[98:99], v15 offset:512
    v_mfma_f32_16x16x32_bf16 v[140:143], v[208:211], v[56:59], v[140:143]
    ds_read_b64_tr_b16 v[100:101], v15 offset:4096
    v_mfma_f32_16x16x32_bf16 v[140:143], v[212:215], v[60:63], v[140:143]
    ds_read_b64_tr_b16 v[102:103], v15 offset:4608
    v_mfma_f32_16x16x32_bf16 v[144:147], v[216:219], v[56:59], v[144:147]
    s_add_u32 s52, s52, 40960
    s_cmp_eq_u32 s52, 122880
    s_cselect_b32 s52, 0, s52
    v_mfma_f32_16x16x32_bf16 v[144:147], v[220:223], v[60:63], v[144:147]
    v_add_u32 v10, s52, v8
    v_add_u32 v11, s52, v9
    v_mfma_f32_16x16x32_bf16 v[148:151], v[224:227], v[56:59], v[148:151]
    v_add_u32 v14, s52, v12
    v_add_u32 v15, s52, v13
    v_mfma_f32_16x16x32_bf16 v[148:151], v[228:231], v[60:63], v[148:151]
    v_xor_b32 v17, s39, v14
    v_xor_b32 v18, s39, v15
    s_waitcnt lgkmcnt(0)
    v_mfma_f32_16x16x32_bf16 v[152:155], v[200:203], v[64:67], v[152:155]
    s_barrier
    v_mfma_f32_16x16x32_bf16 v[152:155], v[204:207], v[68:71], v[152:155]
    ds_read_b64_tr_b16 v[56:57], v14 offset:8192
    v_mfma_f32_16x16x32_bf16 v[156:159], v[208:211], v[64:67], v[156:159]
    ds_read_b64_tr_b16 v[58:59], v14 offset:8704
    v_mfma_f32_16x16x32_bf16 v[156:159], v[212:215], v[68:71], v[156:159]
    ds_read_b64_tr_b16 v[60:61], v14 offset:12288
    v_mfma_f32_16x16x32_bf16 v[160:163], v[216:219], v[64:67], v[160:163]
    ds_read_b64_tr_b16 v[62:63], v14 offset:12800
    v_mfma_f32_16x16x32_bf16 v[160:163], v[220:223], v[68:71], v[160:163]
    ds_read_b128 v[24:27], v10 offset:0
    v_mfma_f32_16x16x32_bf16 v[164:167], v[224:227], v[64:67], v[164:167]
    ds_read_b128 v[28:31], v11 offset:0
    v_mfma_f32_16x16x32_bf16 v[164:167], v[228:231], v[68:71], v[164:167]
    ds_read_b128 v[32:35], v10 offset:2048
    v_mfma_f32_16x16x32_bf16 v[168:171], v[200:203], v[72:75], v[168:171]
    ds_read_b64_tr_b16 v[64:65], v15 offset:8192
    s_mov_b32 s54, 0x3fb8aa3b
    s_mov_b32 s55, 0x3fb8aa3b
    s_mov_b32 s56, 0x358637bd
    v_mfma_f32_16x16x32_bf16 v[168:171], v[204:207], v[76:79], v[168:171]
    ds_read_b64_tr_b16 v[66:67], v15 offset:8704
    s_lshl_b32 s57, s31, 2
    s_add_u32 s57, s57, s3
    s_lshl_b32 s57, s57, 4
    v_mfma_f32_16x16x32_bf16 v[172:175], v[208:211], v[72:75], v[172:175]
    ds_read_b64_tr_b16 v[68:69], v15 offset:12288
    s_add_u32 s57, s57, s30
    s_lshl_b32 s58, s57, 10
    s_add_u32 s58, s58, 0x800000
    v_mfma_f32_16x16x32_bf16 v[172:175], v[212:215], v[76:79], v[172:175]
    ds_read_b64_tr_b16 v[70:71], v15 offset:12800
    s_lshr_b32 s59, s57, 4
    s_lshl_b32 s59, s59, 11
    s_lshl_b32 s45, s30, 4
    v_mfma_f32_16x16x32_bf16 v[176:179], v[216:219], v[72:75], v[176:179]
    ds_read_b128 v[36:39], v11 offset:2048
    s_add_u32 s59, s59, s45
    s_add_u32 s59, s59, 0x900000
    s_lshr_b32 s57, s57, 4
    v_mfma_f32_16x16x32_bf16 v[176:179], v[220:223], v[76:79], v[176:179]
    ds_read_b128 v[40:43], v10 offset:4096
    s_lshl_b32 s57, s57, 11
    s_add_u32 s57, s57, 0x960000
    v_and_b32 v19, 7, v4
    v_mfma_f32_16x16x32_bf16 v[180:183], v[224:227], v[72:75], v[180:183]
    ds_read_b128 v[44:47], v11 offset:4096
    v_lshlrev_b32 v19, 1, v19
    v_sub_u32 v19, s30, v19
    v_and_b32 v19, 15, v19
    v_mfma_f32_16x16x32_bf16 v[180:183], v[228:231], v[76:79], v[180:183]
    ds_read_b128 v[48:51], v10 offset:6144
    v_lshl_add_u32 v19, v19, 2, v254
    s_lshl_b32 s45, s3, 11
    s_add_u32 s45, s45, 131584
    v_mfma_f32_16x16x32_bf16 v[184:187], v[200:203], v[80:83], v[184:187]
    ds_read_b128 v[52:55], v11 offset:6144
    v_add_u32 v6, s45, v5
    v_xor_b32 v7, 2048, v6
    s_lshl_b32 s45, s3, 7
    v_mfma_f32_16x16x32_bf16 v[184:187], v[204:207], v[84:87], v[184:187]
    ds_read_b64_tr_b16 v[72:73], v17 offset:16384
    s_add_u32 s45, s45, 162304
    v_and_b32 v3, 0x30, v4
    v_add_u32 v16, s45, v3
    v_mfma_f32_16x16x32_bf16 v[188:191], v[208:211], v[80:83], v[188:191]
    ds_read_b64_tr_b16 v[74:75], v17 offset:16896
    v_xor_b32 v253, 128, v16
    v_xor_b32 v255, 4, v21
    v_mfma_f32_16x16x32_bf16 v[188:191], v[212:215], v[84:87], v[188:191]
    ds_read_b64_tr_b16 v[76:77], v17 offset:20480
    v_mfma_f32_16x16x32_bf16 v[192:195], v[216:219], v[80:83], v[192:195]
    ds_read_b64_tr_b16 v[78:79], v17 offset:20992
    v_mfma_f32_16x16x32_bf16 v[192:195], v[220:223], v[84:87], v[192:195]
    v_mfma_f32_16x16x32_bf16 v[196:199], v[224:227], v[80:83], v[196:199]
    v_mfma_f32_16x16x32_bf16 v[196:199], v[228:231], v[84:87], v[196:199]
    s_waitcnt lgkmcnt(4)
    v_mfma_f32_16x16x32_bf16 v[136:139], v[24:27], v[56:59], v[136:139]
    ds_read_b64_tr_b16 v[80:81], v18 offset:16384
    ds_read_b64_tr_b16 v[82:83], v18 offset:16896
    v_mfma_f32_16x16x32_bf16 v[136:139], v[28:31], v[60:63], v[136:139]
    ds_read_b64_tr_b16 v[84:85], v18 offset:20480
    ds_read_b64_tr_b16 v[86:87], v18 offset:20992
    v_mfma_f32_16x16x32_bf16 v[140:143], v[32:35], v[56:59], v[140:143]
    ds_read_b64_tr_b16 v[236:237], v14 offset:0
    ds_read_b64_tr_b16 v[238:239], v14 offset:512
    v_mfma_f32_16x16x32_bf16 v[140:143], v[36:39], v[60:63], v[140:143]
    ds_read_b64_tr_b16 v[240:241], v14 offset:4096
    ds_read_b64_tr_b16 v[242:243], v14 offset:4608
    v_mfma_f32_16x16x32_bf16 v[144:147], v[40:43], v[56:59], v[144:147]
    ds_read_b64_tr_b16 v[244:245], v15 offset:0
    ds_read_b64_tr_b16 v[246:247], v15 offset:512
    v_mfma_f32_16x16x32_bf16 v[144:147], v[44:47], v[60:63], v[144:147]
    ds_read_b64_tr_b16 v[248:249], v15 offset:4096
    ds_read_b64_tr_b16 v[250:251], v15 offset:4608
    v_mfma_f32_16x16x32_bf16 v[148:151], v[48:51], v[56:59], v[148:151]
    v_mfma_f32_16x16x32_bf16 v[148:151], v[52:55], v[60:63], v[148:151]
    v_mfma_f32_16x16x32_bf16 v[152:155], v[24:27], v[64:67], v[152:155]
    v_mfma_f32_16x16x32_bf16 v[152:155], v[28:31], v[68:71], v[152:155]
    s_waitcnt lgkmcnt(0)
    ds_write_b32 v21, v232 offset:112
    v_mfma_f32_16x16x32_bf16 v[156:159], v[32:35], v[64:67], v[156:159]
    v_mul_f32 v56, s54, v136
    v_mul_f32 v57, s54, v137
    v_mul_f32 v58, s54, v138
    v_mfma_f32_16x16x32_bf16 v[156:159], v[36:39], v[68:71], v[156:159]
    v_mul_f32 v59, s54, v139
    v_mul_f32 v60, s54, v140
    v_mul_f32 v61, s54, v141
    v_mfma_f32_16x16x32_bf16 v[160:163], v[40:43], v[64:67], v[160:163]
    v_mul_f32 v62, s54, v142
    v_mul_f32 v63, s54, v143
    v_exp_f32_e64 v56, v56 clamp
    v_mfma_f32_16x16x32_bf16 v[160:163], v[44:47], v[68:71], v[160:163]
    v_exp_f32_e64 v57, v57 clamp
    v_exp_f32_e64 v58, v58 clamp
    v_exp_f32_e64 v59, v59 clamp
    v_mfma_f32_16x16x32_bf16 v[164:167], v[48:51], v[64:67], v[164:167]
    v_exp_f32_e64 v60, v60 clamp
    v_exp_f32_e64 v61, v61 clamp
    v_exp_f32_e64 v62, v62 clamp
    v_mfma_f32_16x16x32_bf16 v[164:167], v[52:55], v[68:71], v[164:167]
    v_exp_f32_e64 v63, v63 clamp
    v_max_f32 v136, s56, v136
    v_max_f32 v137, s56, v137
    v_mfma_f32_16x16x32_bf16 v[168:171], v[24:27], v[72:75], v[168:171]
    v_max_f32 v138, s56, v138
    v_max_f32 v139, s56, v139
    v_max_f32 v140, s56, v140
    v_mfma_f32_16x16x32_bf16 v[168:171], v[28:31], v[76:79], v[168:171]
    v_max_f32 v141, s56, v141
    v_max_f32 v142, s56, v142
    v_max_f32 v143, s56, v143
    v_mfma_f32_16x16x32_bf16 v[172:175], v[32:35], v[72:75], v[172:175]
    v_add_f32 v56, v56, v136
    v_add_f32 v57, v57, v137
    v_add_f32 v58, v58, v138
    v_mfma_f32_16x16x32_bf16 v[172:175], v[36:39], v[76:79], v[172:175]
    v_add_f32 v59, v59, v139
    v_add_f32 v60, v60, v140
    v_add_f32 v61, v61, v141
    v_mfma_f32_16x16x32_bf16 v[176:179], v[40:43], v[72:75], v[176:179]
    v_add_f32 v62, v62, v142
    v_add_f32 v63, v63, v143
    v_cvt_pk_bf16_f32 v136, v56, v57
    v_mfma_f32_16x16x32_bf16 v[176:179], v[44:47], v[76:79], v[176:179]
    v_cvt_pk_bf16_f32 v137, v58, v59
    v_cvt_pk_bf16_f32 v138, v60, v61
    v_cvt_pk_bf16_f32 v139, v62, v63
    v_mfma_f32_16x16x32_bf16 v[180:183], v[48:51], v[72:75], v[180:183]
    v_mul_f32 v56, s54, v144
    v_mul_f32 v57, s54, v145
    v_mul_f32 v58, s54, v146
    v_mfma_f32_16x16x32_bf16 v[180:183], v[52:55], v[76:79], v[180:183]
    v_mul_f32 v59, s54, v147
    v_mul_f32 v60, s54, v148
    v_mul_f32 v61, s54, v149
    v_mfma_f32_16x16x32_bf16 v[184:187], v[24:27], v[80:83], v[184:187]
    v_mul_f32 v62, s54, v150
    v_mul_f32 v63, s54, v151
    v_exp_f32_e64 v56, v56 clamp
    v_mfma_f32_16x16x32_bf16 v[184:187], v[28:31], v[84:87], v[184:187]
    v_exp_f32_e64 v57, v57 clamp
    v_exp_f32_e64 v58, v58 clamp
    v_exp_f32_e64 v59, v59 clamp
    v_mfma_f32_16x16x32_bf16 v[188:191], v[32:35], v[80:83], v[188:191]
    v_exp_f32_e64 v60, v60 clamp
    v_exp_f32_e64 v61, v61 clamp
    v_exp_f32_e64 v62, v62 clamp
    v_mfma_f32_16x16x32_bf16 v[188:191], v[36:39], v[84:87], v[188:191]
    v_exp_f32_e64 v63, v63 clamp
    v_max_f32 v144, s56, v144
    v_max_f32 v145, s56, v145
    v_mfma_f32_16x16x32_bf16 v[192:195], v[40:43], v[80:83], v[192:195]
    v_max_f32 v146, s56, v146
    v_max_f32 v147, s56, v147
    v_max_f32 v148, s56, v148
    v_mfma_f32_16x16x32_bf16 v[192:195], v[44:47], v[84:87], v[192:195]
    v_max_f32 v149, s56, v149
    v_max_f32 v150, s56, v150
    v_max_f32 v151, s56, v151
    v_mfma_f32_16x16x32_bf16 v[196:199], v[48:51], v[80:83], v[196:199]
    v_add_f32 v56, v56, v144
    v_add_f32 v57, v57, v145
    v_add_f32 v58, v58, v146
    v_mfma_f32_16x16x32_bf16 v[196:199], v[52:55], v[84:87], v[196:199]
    v_add_f32 v59, v59, v147
    v_add_f32 v60, v60, v148
    v_add_f32 v61, v61, v149
    v_add_f32 v62, v62, v150
    v_add_f32 v63, v63, v151
    v_cvt_pk_bf16_f32 v140, v56, v57
    v_cvt_pk_bf16_f32 v141, v58, v59
    v_cvt_pk_bf16_f32 v142, v60, v61
    v_cvt_pk_bf16_f32 v143, v62, v63
    s_setprio 2
    v_cvt_pk_bf16_f32 v168, v168, v169
    v_cvt_pk_bf16_f32 v169, v170, v171
    v_cvt_pk_bf16_f32 v170, v172, v173
    v_cvt_pk_bf16_f32 v171, v174, v175
    v_cvt_pk_bf16_f32 v172, v176, v177
    v_cvt_pk_bf16_f32 v173, v178, v179
    v_cvt_pk_bf16_f32 v174, v180, v181
    v_cvt_pk_bf16_f32 v175, v182, v183
    v_cvt_pk_bf16_f32 v176, v184, v185
    v_cvt_pk_bf16_f32 v177, v186, v187
    v_cvt_pk_bf16_f32 v178, v188, v189
    v_cvt_pk_bf16_f32 v179, v190, v191
    v_cvt_pk_bf16_f32 v180, v192, v193
    v_cvt_pk_bf16_f32 v181, v194, v195
    v_cvt_pk_bf16_f32 v182, v196, v197
    v_cvt_pk_bf16_f32 v183, v198, v199
    v_mov_b32 v144, 0x3f803f80
    v_mov_b32 v145, 0x3f803f80
    v_mov_b32 v146, 0x3f803f80
    v_mov_b32 v147, 0x3f803f80
    s_nop 1
    v_mfma_f32_16x16x32_bf16 v[80:83], v[136:139], v[176:179], 0
    v_mfma_f32_16x16x32_bf16 v[64:67], v[136:139], v[144:147], 0
    v_mfma_f32_16x16x32_bf16 v[72:75], v[136:139], v[168:171], 0
    v_mfma_f32_16x16x32_bf16 v[80:83], v[140:143], v[180:183], v[80:83]
    v_mfma_f32_16x16x32_bf16 v[64:67], v[140:143], v[144:147], v[64:67]
    v_mfma_f32_16x16x32_bf16 v[72:75], v[140:143], v[172:175], v[72:75]
    v_pk_mul_f32 v[56:57], v[152:153], s[54:55]
    v_pk_mul_f32 v[58:59], v[154:155], s[54:55]
    v_pk_mul_f32 v[60:61], v[156:157], s[54:55]
    v_pk_mul_f32 v[62:63], v[158:159], s[54:55]
    v_exp_f32_e64 v56, v56 clamp
    v_exp_f32_e64 v57, v57 clamp
    v_exp_f32_e64 v58, v58 clamp
    v_exp_f32_e64 v59, v59 clamp
    v_exp_f32_e64 v60, v60 clamp
    v_exp_f32_e64 v61, v61 clamp
    v_exp_f32_e64 v62, v62 clamp
    v_exp_f32_e64 v63, v63 clamp
    v_max_f32 v152, s56, v152
    v_max_f32 v153, s56, v153
    v_max_f32 v154, s56, v154
    v_max_f32 v155, s56, v155
    v_max_f32 v156, s56, v156
    v_max_f32 v157, s56, v157
    v_max_f32 v158, s56, v158
    v_max_f32 v159, s56, v159
    v_pk_add_f32 v[56:57], v[56:57], v[152:153]
    v_pk_add_f32 v[58:59], v[58:59], v[154:155]
    v_pk_add_f32 v[60:61], v[60:61], v[156:157]
    v_pk_add_f32 v[62:63], v[62:63], v[158:159]
    v_cvt_pk_bf16_f32 v152, v56, v57
    v_cvt_pk_bf16_f32 v153, v58, v59
    v_cvt_pk_bf16_f32 v154, v60, v61
    v_cvt_pk_bf16_f32 v155, v62, v63
    ds_write_b128 v6, v[80:83]
    ds_write_b128 v16, v[64:67]
    v_pk_mul_f32 v[56:57], v[160:161], s[54:55]
    v_pk_mul_f32 v[58:59], v[162:163], s[54:55]
    v_pk_mul_f32 v[60:61], v[164:165], s[54:55]
    v_pk_mul_f32 v[62:63], v[166:167], s[54:55]
    v_exp_f32_e64 v56, v56 clamp
    v_exp_f32_e64 v57, v57 clamp
    v_exp_f32_e64 v58, v58 clamp
    v_exp_f32_e64 v59, v59 clamp
    v_exp_f32_e64 v60, v60 clamp
    v_exp_f32_e64 v61, v61 clamp
    v_exp_f32_e64 v62, v62 clamp
    v_exp_f32_e64 v63, v63 clamp
    v_max_f32 v160, s56, v160
    v_max_f32 v161, s56, v161
    v_max_f32 v162, s56, v162
    v_max_f32 v163, s56, v163
    v_max_f32 v164, s56, v164
    v_max_f32 v165, s56, v165
    v_max_f32 v166, s56, v166
    v_max_f32 v167, s56, v167
    v_pk_add_f32 v[56:57], v[56:57], v[160:161]
    v_pk_add_f32 v[58:59], v[58:59], v[162:163]
    v_pk_add_f32 v[60:61], v[60:61], v[164:165]
    v_pk_add_f32 v[62:63], v[62:63], v[166:167]
    v_cvt_pk_bf16_f32 v156, v56, v57
    v_cvt_pk_bf16_f32 v157, v58, v59
    v_cvt_pk_bf16_f32 v158, v60, v61
    v_cvt_pk_bf16_f32 v159, v62, v63
    s_nop 1
    v_mfma_f32_16x16x32_bf16 v[84:87], v[152:155], v[176:179], 0
    v_mfma_f32_16x16x32_bf16 v[68:71], v[152:155], v[144:147], 0
    v_mfma_f32_16x16x32_bf16 v[76:79], v[152:155], v[168:171], 0
    v_mfma_f32_16x16x32_bf16 v[84:87], v[156:159], v[180:183], v[84:87]
    v_mfma_f32_16x16x32_bf16 v[68:71], v[156:159], v[144:147], v[68:71]
    v_mfma_f32_16x16x32_bf16 v[76:79], v[156:159], v[172:175], v[76:79]
    v_mov_b32 v160, 0x3f803f80
    v_mov_b32 v161, 0x3f803f80
    v_mov_b32 v162, 0x3f803f80
    v_mov_b32 v163, 0x3f803f80
    s_nop 1
    ds_write_b128 v6, v[84:87] offset:1024
    ds_write_b128 v16, v[68:71] offset:64
    ds_write_b32 v21, v232 offset:0
    s_mov_b32 s45, 0
L_xspin:
    ds_read_b32 v235, v255 offset:0
    ds_read_b128 v[184:187], v7
    ds_read_b128 v[188:191], v7 offset:1024
    ds_read_b128 v[192:195], v253
    ds_read_b128 v[196:199], v253 offset:64
    s_add_u32 s45, s45, 1
    s_waitcnt lgkmcnt(4)
    v_readfirstlane_b32 s46, v235
    s_cmp_gt_u32 s45, 0x40000
    s_cbranch_scc1 L_xdone
    s_cmp_eq_u32 s46, 0
    s_cbranch_scc1 L_xspin
L_xdone:
    s_waitcnt lgkmcnt(2)
    v_pk_add_f32 v[72:73], v[72:73], v[184:185]
    v_pk_add_f32 v[74:75], v[74:75], v[186:187]
    v_pk_add_f32 v[76:77], v[76:77], v[188:189]
    v_pk_add_f32 v[78:79], v[78:79], v[190:191]
    v_cvt_pk_bf16_f32 v80, v72, v73
    v_cvt_pk_bf16_f32 v81, v74, v75
    v_cvt_pk_bf16_f32 v82, v76, v77
    v_cvt_pk_bf16_f32 v83, v78, v79
    buffer_store_dwordx4 v[80:83], v5, s[60:63], s58 offen sc1
    s_waitcnt lgkmcnt(0)
    v_pk_add_f32 v[64:65], v[64:65], v[192:193]
    v_pk_add_f32 v[66:67], v[66:67], v[194:195]
    v_pk_add_f32 v[68:69], v[68:69], v[196:197]
    v_pk_add_f32 v[70:71], v[70:71], v[198:199]
    v_cvt_pk_bf16_f32 v84, v64, v65
    v_cvt_pk_bf16_f32 v85, v66, v67
    v_cvt_pk_bf16_f32 v86, v68, v69
    v_cvt_pk_bf16_f32 v87, v70, v71
    s_mov_b32 exec_lo, 0x10001
    s_mov_b32 exec_hi, 0x10001
    buffer_store_dwordx4 v[84:87], v5, s[60:63], s59 offen sc1
    s_mov_b64 exec, -1
    v_mfma_f32_16x16x32_bf16 v[104:107], v[88:91], v[200:203], v[104:107]
    s_lshl_b32 s47, s32, 1
    s_add_u32 s47, s47, s41
    v_mfma_f32_16x16x32_bf16 v[104:107], v[92:95], v[204:207], v[104:107]
    s_lshl_b32 s44, s32, 2
    s_add_u32 s44, s44, s3
    v_mfma_f32_16x16x32_bf16 v[104:107], v[236:239], v[24:27], v[104:107]
    s_lshl_b32 s58, s44, 14
    s_add_u32 s58, s58, 0x800000
    v_mfma_f32_16x16x32_bf16 v[104:107], v[240:243], v[28:31], v[104:107]
    s_lshl_b32 s59, s44, 11
    s_add_u32 s59, s59, 0x900000
    v_mfma_f32_16x16x32_bf16 v[108:111], v[96:99], v[200:203], v[108:111]
    s_lshl_b32 s44, s44, 6
    s_lshr_b32 vcc_lo, s44, 6
    v_mfma_f32_16x16x32_bf16 v[108:111], v[100:103], v[204:207], v[108:111]
    s_mul_i32 vcc_lo, vcc_lo, 1984
    s_add_u32 s44, s44, vcc_lo
    v_mfma_f32_16x16x32_bf16 v[108:111], v[244:247], v[24:27], v[108:111]
    s_add_u32 s44, s44, 0x960000
    s_lshl_b32 vcc_lo, s30, 7
    v_mfma_f32_16x16x32_bf16 v[108:111], v[248:251], v[28:31], v[108:111]
    s_add_u32 s44, s44, vcc_lo
    s_lshl_b32 s45, s41, 2
    v_mfma_f32_16x16x32_bf16 v[112:115], v[88:91], v[208:211], v[112:115]
    v_add_u32 v14, s45, v20
    v_mov_b32 v6, 0x3f80
    v_mfma_f32_16x16x32_bf16 v[112:115], v[92:95], v[212:215], v[112:115]
    v_and_b32 v7, 1, v4
    v_lshlrev_b32 v7, 4, v7
    v_mfma_f32_16x16x32_bf16 v[112:115], v[236:239], v[32:35], v[112:115]
    v_lshlrev_b32 v6, v7, v6
    v_lshrrev_b32 v2, 4, v4
    v_mfma_f32_16x16x32_bf16 v[112:115], v[240:243], v[36:39], v[112:115]
    v_cmp_eq_u32 vcc, v2, v22
    v_bfe_u32 v7, v4, 1, 1
    v_mfma_f32_16x16x32_bf16 v[116:119], v[96:99], v[208:211], v[116:119]
    v_mov_b32 v8, 0
    v_cndmask_b32 v6, 0, v6, vcc
    v_mfma_f32_16x16x32_bf16 v[116:119], v[100:103], v[212:215], v[116:119]
    v_cmp_eq_u32 vcc, 0, v7
    v_mov_b32 v9, 0
    v_mfma_f32_16x16x32_bf16 v[116:119], v[244:247], v[32:35], v[116:119]
    v_mov_b32 v12, 0
    v_cndmask_b32 v10, 0, v6, vcc
    v_mfma_f32_16x16x32_bf16 v[116:119], v[248:251], v[36:39], v[116:119]
    v_cndmask_b32 v11, v6, v233, vcc
    v_mov_b32 v13, 0
    v_mfma_f32_16x16x32_bf16 v[120:123], v[88:91], v[216:219], v[120:123]
    s_lshl_b32 s45, s3, 10
    s_add_u32 s45, s45, 158208
    v_mfma_f32_16x16x32_bf16 v[120:123], v[92:95], v[220:223], v[120:123]
    v_add_u32 v6, s45, v5
    s_xor_b32 s45, s3, 1
    v_mfma_f32_16x16x32_bf16 v[120:123], v[236:239], v[40:43], v[120:123]
    s_lshl_b32 s45, s45, 10
    s_add_u32 s45, s45, 158208
    v_mfma_f32_16x16x32_bf16 v[120:123], v[240:243], v[44:47], v[120:123]
    v_add_u32 v7, s45, v5
    s_lshl_b32 s48, s30, 3
    v_mfma_f32_16x16x32_bf16 v[124:127], v[96:99], v[216:219], v[124:127]
    s_lshl_b32 s45, s40, 2
    s_add_u32 s48, s48, s45
    v_mfma_f32_16x16x32_bf16 v[124:127], v[100:103], v[220:223], v[124:127]
    s_lshl_b32 s48, s48, 15
    s_lshl_b32 s45, s47, 10
    v_mfma_f32_16x16x32_bf16 v[124:127], v[244:247], v[40:43], v[124:127]
    s_add_u32 s48, s48, s45
    s_add_u32 s48, s48, 0x400000
    v_mfma_f32_16x16x32_bf16 v[124:127], v[248:251], v[44:47], v[124:127]
    s_lshl_b32 s49, s30, 1
    s_add_u32 s49, s49, s40
    v_mfma_f32_16x16x32_bf16 v[128:131], v[88:91], v[224:227], v[128:131]
    s_lshl_b32 s49, s49, 7
    s_lshl_b32 s45, s47, 2
    v_mfma_f32_16x16x32_bf16 v[128:131], v[92:95], v[228:231], v[128:131]
    s_add_u32 s49, s49, s45
    s_lshr_b32 vcc_lo, s49, 6
    v_mfma_f32_16x16x32_bf16 v[128:131], v[236:239], v[48:51], v[128:131]
    s_mul_i32 vcc_lo, vcc_lo, 1984
    s_add_u32 s49, s49, vcc_lo
    v_mfma_f32_16x16x32_bf16 v[128:131], v[240:243], v[52:55], v[128:131]
    s_add_u32 s49, s49, 0x980000
    s_mov_b32 s50, 0
    v_mfma_f32_16x16x32_bf16 v[132:135], v[96:99], v[224:227], v[132:135]
    s_mov_b32 s51, 0
    s_mov_b32 s53, 0
    v_mfma_f32_16x16x32_bf16 v[132:135], v[100:103], v[228:231], v[132:135]
    s_mov_b32 s46, 0
    s_and_b32 s43, s30, 7
    v_mfma_f32_16x16x32_bf16 v[132:135], v[244:247], v[48:51], v[132:135]
    v_mfma_f32_16x16x32_bf16 v[132:135], v[248:251], v[52:55], v[132:135]
    v_pk_mul_f32 v[204:205], v[104:105], s[54:55]
    v_pk_mul_f32 v[206:207], v[106:107], s[54:55]
    v_pk_mul_f32 v[208:209], v[108:109], s[54:55]
    v_pk_mul_f32 v[210:211], v[110:111], s[54:55]
    v_exp_f32_e64 v204, v204 clamp
    v_exp_f32_e64 v205, v205 clamp
    v_exp_f32_e64 v206, v206 clamp
    v_exp_f32_e64 v207, v207 clamp
    v_exp_f32_e64 v208, v208 clamp
    v_exp_f32_e64 v209, v209 clamp
    v_exp_f32_e64 v210, v210 clamp
    v_exp_f32_e64 v211, v211 clamp
    v_max_f32 v104, s56, v104
    v_max_f32 v105, s56, v105
    v_max_f32 v106, s56, v106
    v_max_f32 v107, s56, v107
    v_max_f32 v108, s56, v108
    v_max_f32 v109, s56, v109
    v_max_f32 v110, s56, v110
    v_max_f32 v111, s56, v111
    v_pk_add_f32 v[204:205], v[204:205], v[104:105]
    v_pk_add_f32 v[206:207], v[206:207], v[106:107]
    v_pk_add_f32 v[208:209], v[208:209], v[108:109]
    v_pk_add_f32 v[210:211], v[210:211], v[110:111]
    v_cvt_pk_bf16_f32 v104, v204, v205
    v_cvt_pk_bf16_f32 v105, v206, v207
    v_cvt_pk_bf16_f32 v106, v208, v209
    v_cvt_pk_bf16_f32 v107, v210, v211
    s_waitcnt vmcnt(0)
    s_mov_b64 exec, 0xffff
    buffer_store_dword v234, v19, s[60:63], s57 offen sc1
    s_mov_b64 exec, -1
    s_load_dwordx16 s[4:19], s[26:27], s44 glc
    v_pk_mul_f32 v[204:205], v[112:113], s[54:55]
    v_pk_mul_f32 v[206:207], v[114:115], s[54:55]
    v_pk_mul_f32 v[208:209], v[116:117], s[54:55]
    v_pk_mul_f32 v[210:211], v[118:119], s[54:55]
    v_exp_f32_e64 v204, v204 clamp
    v_exp_f32_e64 v205, v205 clamp
    v_exp_f32_e64 v206, v206 clamp
    v_exp_f32_e64 v207, v207 clamp
    v_exp_f32_e64 v208, v208 clamp
    v_exp_f32_e64 v209, v209 clamp
    v_exp_f32_e64 v210, v210 clamp
    v_exp_f32_e64 v211, v211 clamp
    v_max_f32 v112, s56, v112
    v_max_f32 v113, s56, v113
    v_max_f32 v114, s56, v114
    v_max_f32 v115, s56, v115
    v_max_f32 v116, s56, v116
    v_max_f32 v117, s56, v117
    v_max_f32 v118, s56, v118
    v_max_f32 v119, s56, v119
    v_pk_add_f32 v[204:205], v[204:205], v[112:113]
    v_pk_add_f32 v[206:207], v[206:207], v[114:115]
    v_pk_add_f32 v[208:209], v[208:209], v[116:117]
    v_pk_add_f32 v[210:211], v[210:211], v[118:119]
    v_cvt_pk_bf16_f32 v108, v204, v205
    v_cvt_pk_bf16_f32 v109, v206, v207
    v_cvt_pk_bf16_f32 v110, v208, v209
    v_cvt_pk_bf16_f32 v111, v210, v211
    v_pk_mul_f32 v[204:205], v[120:121], s[54:55]
    v_pk_mul_f32 v[206:207], v[122:123], s[54:55]
    v_pk_mul_f32 v[208:209], v[124:125], s[54:55]
    v_pk_mul_f32 v[210:211], v[126:127], s[54:55]
    v_exp_f32_e64 v204, v204 clamp
    v_exp_f32_e64 v205, v205 clamp
    v_exp_f32_e64 v206, v206 clamp
    v_exp_f32_e64 v207, v207 clamp
    v_exp_f32_e64 v208, v208 clamp
    v_exp_f32_e64 v209, v209 clamp
    v_exp_f32_e64 v210, v210 clamp
    v_exp_f32_e64 v211, v211 clamp
    v_max_f32 v120, s56, v120
    v_max_f32 v121, s56, v121
    v_max_f32 v122, s56, v122
    v_max_f32 v123, s56, v123
    v_max_f32 v124, s56, v124
    v_max_f32 v125, s56, v125
    v_max_f32 v126, s56, v126
    v_max_f32 v127, s56, v127
    v_pk_add_f32 v[204:205], v[204:205], v[120:121]
    v_pk_add_f32 v[206:207], v[206:207], v[122:123]
    v_pk_add_f32 v[208:209], v[208:209], v[124:125]
    v_pk_add_f32 v[210:211], v[210:211], v[126:127]
    v_cvt_pk_bf16_f32 v112, v204, v205
    v_cvt_pk_bf16_f32 v113, v206, v207
    v_cvt_pk_bf16_f32 v114, v208, v209
    v_cvt_pk_bf16_f32 v115, v210, v211
    v_pk_mul_f32 v[204:205], v[128:129], s[54:55]
    v_pk_mul_f32 v[206:207], v[130:131], s[54:55]
    v_pk_mul_f32 v[208:209], v[132:133], s[54:55]
    v_pk_mul_f32 v[210:211], v[134:135], s[54:55]
    v_exp_f32_e64 v204, v204 clamp
    v_exp_f32_e64 v205, v205 clamp
    v_exp_f32_e64 v206, v206 clamp
    v_exp_f32_e64 v207, v207 clamp
    v_exp_f32_e64 v208, v208 clamp
    v_exp_f32_e64 v209, v209 clamp
    v_exp_f32_e64 v210, v210 clamp
    v_exp_f32_e64 v211, v211 clamp
    v_max_f32 v128, s56, v128
    v_max_f32 v129, s56, v129
    v_max_f32 v130, s56, v130
    v_max_f32 v131, s56, v131
    v_max_f32 v132, s56, v132
    v_max_f32 v133, s56, v133
    v_max_f32 v134, s56, v134
    v_max_f32 v135, s56, v135
    v_pk_add_f32 v[204:205], v[204:205], v[128:129]
    v_pk_add_f32 v[206:207], v[206:207], v[130:131]
    v_pk_add_f32 v[208:209], v[208:209], v[132:133]
    v_pk_add_f32 v[210:211], v[210:211], v[134:135]
    v_cvt_pk_bf16_f32 v116, v204, v205
    v_cvt_pk_bf16_f32 v117, v206, v207
    v_cvt_pk_bf16_f32 v118, v208, v209
    v_cvt_pk_bf16_f32 v119, v210, v211
    ds_write_b32 v21, v232 offset:128
    v_mov_b64 v[88:89], 0
    v_mov_b64 v[138:139], 0
    v_mov_b32 v168, s56
    v_mov_b64 v[90:91], 0
    v_mov_b64 v[142:143], 0
    v_mov_b32 v169, s56
    v_mov_b64 v[92:93], 0
    v_mov_b64 v[146:147], 0
    v_mov_b32 v170, s56
    v_mov_b64 v[94:95], 0
    v_mov_b64 v[150:151], 0
    v_mov_b32 v171, s56
    s_setprio 3
    s_cmp_eq_u32 s46, 0
    s_cbranch_scc1 L_poll0
L_go0:
    s_ff1_i32_b32 s45, s46
    s_bitset0_b32 s46, s45
    s_add_u32 s45, s45, s43
    s_and_b32 s45, s45, 7
    s_lshl_b32 s45, s45, 11
    s_add_u32 s45, s45, s58
    buffer_load_dwordx4 v[24:27], v5, s[60:63], s45 offen offset:0 sc1
    buffer_load_dwordx4 v[28:31], v5, s[60:63], s45 offen offset:1024 sc1
    s_bitset1_b32 s51, 0
    s_cmp_eq_u32 s46, 0
    s_cbranch_scc1 L_poll1
L_go1:
    s_ff1_i32_b32 s45, s46
    s_bitset0_b32 s46, s45
    s_add_u32 s45, s45, s43
    s_and_b32 s45, s45, 7
    s_lshl_b32 s45, s45, 11
    s_add_u32 s45, s45, s58
    buffer_load_dwordx4 v[32:35], v5, s[60:63], s45 offen offset:0 sc1
    buffer_load_dwordx4 v[36:39], v5, s[60:63], s45 offen offset:1024 sc1
    s_bitset1_b32 s51, 1
    s_cmp_eq_u32 s46, 0
    s_cbranch_scc1 L_poll2
L_go2:
    s_ff1_i32_b32 s45, s46
    s_bitset0_b32 s46, s45
    s_add_u32 s45, s45, s43
    s_and_b32 s45, s45, 7
    s_lshl_b32 s45, s45, 11
    s_add_u32 s45, s45, s58
    buffer_load_dwordx4 v[40:43], v5, s[60:63], s45 offen offset:0 sc1
    buffer_load_dwordx4 v[44:47], v5, s[60:63], s45 offen offset:1024 sc1
    s_bitset1_b32 s51, 2
    s_cmp_eq_u32 s46, 0
    s_cbranch_scc1 L_poll3
L_go3:
    s_ff1_i32_b32 s45, s46
    s_bitset0_b32 s46, s45
    s_add_u32 s45, s45, s43
    s_and_b32 s45, s45, 7
    s_lshl_b32 s45, s45, 11
    s_add_u32 s45, s45, s58
    buffer_load_dwordx4 v[48:51], v5, s[60:63], s45 offen offset:0 sc1
    buffer_load_dwordx4 v[52:55], v5, s[60:63], s45 offen offset:1024 sc1
    s_bitset1_b32 s51, 3
    s_cmp_eq_u32 s46, 0
    s_cbranch_scc1 L_poll4
L_go4:
    s_ff1_i32_b32 s45, s46
    s_bitset0_b32 s46, s45
    s_add_u32 s45, s45, s43
    s_and_b32 s45, s45, 7
    s_lshl_b32 s45, s45, 11
    s_add_u32 s45, s45, s58
    buffer_load_dwordx4 v[56:59], v5, s[60:63], s45 offen offset:0 sc1
    buffer_load_dwordx4 v[60:63], v5, s[60:63], s45 offen offset:1024 sc1
    s_bitset1_b32 s51, 4
    s_cmp_eq_u32 s46, 0
    s_cbranch_scc1 L_poll5
L_go5:
    s_ff1_i32_b32 s45, s46
    s_bitset0_b32 s46, s45
    s_add_u32 s45, s45, s43
    s_and_b32 s45, s45, 7
    s_lshl_b32 s45, s45, 11
    s_add_u32 s45, s45, s58
    buffer_load_dwordx4 v[64:67], v5, s[60:63], s45 offen offset:0 sc1
    buffer_load_dwordx4 v[68:71], v5, s[60:63], s45 offen offset:1024 sc1
    s_bitset1_b32 s51, 5
    s_cmp_eq_u32 s46, 0
    s_cbranch_scc1 L_poll6
L_go6:
    s_ff1_i32_b32 s45, s46
    s_bitset0_b32 s46, s45
    s_add_u32 s45, s45, s43
    s_and_b32 s45, s45, 7
    s_lshl_b32 s45, s45, 11
    s_add_u32 s45, s45, s58
    buffer_load_dwordx4 v[72:75], v5, s[60:63], s45 offen offset:0 sc1
    buffer_load_dwordx4 v[76:79], v5, s[60:63], s45 offen offset:1024 sc1
    s_bitset1_b32 s51, 6
    s_cmp_eq_u32 s46, 0
    s_cbranch_scc1 L_poll7
L_go7:
    s_ff1_i32_b32 s45, s46
    s_bitset0_b32 s46, s45
    s_add_u32 s45, s45, s43
    s_and_b32 s45, s45, 7
    s_lshl_b32 s45, s45, 11
    s_add_u32 s45, s45, s58
    buffer_load_dwordx4 v[80:83], v5, s[60:63], s45 offen offset:0 sc1
    buffer_load_dwordx4 v[84:87], v5, s[60:63], s45 offen offset:1024 sc1
    s_bitset1_b32 s51, 7
    s_branch L_fin
L_poll0:
    s_waitcnt lgkmcnt(0)
    s_cmp_eq_u64 s[18:19], s[72:73]
    s_addc_u32 s46, s46, s46
    s_cmp_eq_u64 s[16:17], s[72:73]
    s_addc_u32 s46, s46, s46
    s_cmp_eq_u64 s[14:15], s[72:73]
    s_addc_u32 s46, s46, s46
    s_cmp_eq_u64 s[12:13], s[72:73]
    s_addc_u32 s46, s46, s46
    s_cmp_eq_u64 s[10:11], s[72:73]
    s_addc_u32 s46, s46, s46
    s_cmp_eq_u64 s[8:9], s[72:73]
    s_addc_u32 s46, s46, s46
    s_cmp_eq_u64 s[6:7], s[72:73]
    s_addc_u32 s46, s46, s46
    s_cmp_eq_u64 s[4:5], s[72:73]
    s_addc_u32 s46, s46, s46
    s_add_u32 s53, s53, 1
    s_cmp_gt_u32 s53, 0x8000
    s_cselect_b32 s46, 0xff, s46
    s_andn2_b32 s46, s46, s50
    s_or_b32 s50, s50, s46
    s_cmp_eq_u32 s50, 0xff
    s_cbranch_scc0 L_pm0
    buffer_load_dwordx4 v[96:99], v5, s[60:63], s59 offen sc1
    s_mov_b32 s47, s51
    s_mov_b32 s52, 0
    s_branch L_go0
L_pm0:
    s_load_dwordx16 s[4:19], s[26:27], s44 glc
    s_cmp_lg_u32 s46, 0
    s_cbranch_scc1 L_go0
    s_branch L_poll0
L_poll1:
    s_waitcnt lgkmcnt(0)
    s_cmp_eq_u64 s[18:19], s[72:73]
    s_addc_u32 s46, s46, s46
    s_cmp_eq_u64 s[16:17], s[72:73]
    s_addc_u32 s46, s46, s46
    s_cmp_eq_u64 s[14:15], s[72:73]
    s_addc_u32 s46, s46, s46
    s_cmp_eq_u64 s[12:13], s[72:73]
    s_addc_u32 s46, s46, s46
    s_cmp_eq_u64 s[10:11], s[72:73]
    s_addc_u32 s46, s46, s46
    s_cmp_eq_u64 s[8:9], s[72:73]
    s_addc_u32 s46, s46, s46
    s_cmp_eq_u64 s[6:7], s[72:73]
    s_addc_u32 s46, s46, s46
    s_cmp_eq_u64 s[4:5], s[72:73]
    s_addc_u32 s46, s46, s46
    s_add_u32 s53, s53, 1
    s_cmp_gt_u32 s53, 0x8000
    s_cselect_b32 s46, 0xff, s46
    s_andn2_b32 s46, s46, s50
    s_or_b32 s50, s50, s46
    s_cmp_eq_u32 s50, 0xff
    s_cbranch_scc0 L_pm1
    buffer_load_dwordx4 v[96:99], v5, s[60:63], s59 offen sc1
    s_mov_b32 s47, s51
    s_mov_b32 s52, 1
    s_branch L_go1
L_pm1:
    s_load_dwordx16 s[4:19], s[26:27], s44 glc
    s_cmp_lg_u32 s46, 0
    s_cbranch_scc1 L_go1
    s_cmp_eq_u32 s51, 0
    s_cbranch_scc1 L_poll1
    s_mov_b32 s52, 1
    s_branch L_acc
L_poll2:
    s_waitcnt lgkmcnt(0)
    s_cmp_eq_u64 s[18:19], s[72:73]
    s_addc_u32 s46, s46, s46
    s_cmp_eq_u64 s[16:17], s[72:73]
    s_addc_u32 s46, s46, s46
    s_cmp_eq_u64 s[14:15], s[72:73]
    s_addc_u32 s46, s46, s46
    s_cmp_eq_u64 s[12:13], s[72:73]
    s_addc_u32 s46, s46, s46
    s_cmp_eq_u64 s[10:11], s[72:73]
    s_addc_u32 s46, s46, s46
    s_cmp_eq_u64 s[8:9], s[72:73]
    s_addc_u32 s46, s46, s46
    s_cmp_eq_u64 s[6:7], s[72:73]
    s_addc_u32 s46, s46, s46
    s_cmp_eq_u64 s[4:5], s[72:73]
    s_addc_u32 s46, s46, s46
    s_add_u32 s53, s53, 1
    s_cmp_gt_u32 s53, 0x8000
    s_cselect_b32 s46, 0xff, s46
    s_andn2_b32 s46, s46, s50
    s_or_b32 s50, s50, s46
    s_cmp_eq_u32 s50, 0xff
    s_cbranch_scc0 L_pm2
    buffer_load_dwordx4 v[96:99], v5, s[60:63], s59 offen sc1
    s_mov_b32 s47, s51
    s_mov_b32 s52, 2
    s_branch L_go2
L_pm2:
    s_load_dwordx16 s[4:19], s[26:27], s44 glc
    s_cmp_lg_u32 s46, 0
    s_cbranch_scc1 L_go2
    s_cmp_eq_u32 s51, 0
    s_cbranch_scc1 L_poll2
    s_mov_b32 s52, 2
    s_branch L_acc
L_poll3:
    s_waitcnt lgkmcnt(0)
    s_cmp_eq_u64 s[18:19], s[72:73]
    s_addc_u32 s46, s46, s46
    s_cmp_eq_u64 s[16:17], s[72:73]
    s_addc_u32 s46, s46, s46
    s_cmp_eq_u64 s[14:15], s[72:73]
    s_addc_u32 s46, s46, s46
    s_cmp_eq_u64 s[12:13], s[72:73]
    s_addc_u32 s46, s46, s46
    s_cmp_eq_u64 s[10:11], s[72:73]
    s_addc_u32 s46, s46, s46
    s_cmp_eq_u64 s[8:9], s[72:73]
    s_addc_u32 s46, s46, s46
    s_cmp_eq_u64 s[6:7], s[72:73]
    s_addc_u32 s46, s46, s46
    s_cmp_eq_u64 s[4:5], s[72:73]
    s_addc_u32 s46, s46, s46
    s_add_u32 s53, s53, 1
    s_cmp_gt_u32 s53, 0x8000
    s_cselect_b32 s46, 0xff, s46
    s_andn2_b32 s46, s46, s50
    s_or_b32 s50, s50, s46
    s_cmp_eq_u32 s50, 0xff
    s_cbranch_scc0 L_pm3
    buffer_load_dwordx4 v[96:99], v5, s[60:63], s59 offen sc1
    s_mov_b32 s47, s51
    s_mov_b32 s52, 3
    s_branch L_go3
L_pm3:
    s_load_dwordx16 s[4:19], s[26:27], s44 glc
    s_cmp_lg_u32 s46, 0
    s_cbranch_scc1 L_go3
    s_cmp_eq_u32 s51, 0
    s_cbranch_scc1 L_poll3
    s_mov_b32 s52, 3
    s_branch L_acc
L_poll4:
    s_waitcnt lgkmcnt(0)
    s_cmp_eq_u64 s[18:19], s[72:73]
    s_addc_u32 s46, s46, s46
    s_cmp_eq_u64 s[16:17], s[72:73]
    s_addc_u32 s46, s46, s46
    s_cmp_eq_u64 s[14:15], s[72:73]
    s_addc_u32 s46, s46, s46
    s_cmp_eq_u64 s[12:13], s[72:73]
    s_addc_u32 s46, s46, s46
    s_cmp_eq_u64 s[10:11], s[72:73]
    s_addc_u32 s46, s46, s46
    s_cmp_eq_u64 s[8:9], s[72:73]
    s_addc_u32 s46, s46, s46
    s_cmp_eq_u64 s[6:7], s[72:73]
    s_addc_u32 s46, s46, s46
    s_cmp_eq_u64 s[4:5], s[72:73]
    s_addc_u32 s46, s46, s46
    s_add_u32 s53, s53, 1
    s_cmp_gt_u32 s53, 0x8000
    s_cselect_b32 s46, 0xff, s46
    s_andn2_b32 s46, s46, s50
    s_or_b32 s50, s50, s46
    s_cmp_eq_u32 s50, 0xff
    s_cbranch_scc0 L_pm4
    buffer_load_dwordx4 v[96:99], v5, s[60:63], s59 offen sc1
    s_mov_b32 s47, s51
    s_mov_b32 s52, 4
    s_branch L_go4
L_pm4:
    s_load_dwordx16 s[4:19], s[26:27], s44 glc
    s_cmp_lg_u32 s46, 0
    s_cbranch_scc1 L_go4
    s_cmp_eq_u32 s51, 0
    s_cbranch_scc1 L_poll4
    s_mov_b32 s52, 4
    s_branch L_acc
L_poll5:
    s_waitcnt lgkmcnt(0)
    s_cmp_eq_u64 s[18:19], s[72:73]
    s_addc_u32 s46, s46, s46
    s_cmp_eq_u64 s[16:17], s[72:73]
    s_addc_u32 s46, s46, s46
    s_cmp_eq_u64 s[14:15], s[72:73]
    s_addc_u32 s46, s46, s46
    s_cmp_eq_u64 s[12:13], s[72:73]
    s_addc_u32 s46, s46, s46
    s_cmp_eq_u64 s[10:11], s[72:73]
    s_addc_u32 s46, s46, s46
    s_cmp_eq_u64 s[8:9], s[72:73]
    s_addc_u32 s46, s46, s46
    s_cmp_eq_u64 s[6:7], s[72:73]
    s_addc_u32 s46, s46, s46
    s_cmp_eq_u64 s[4:5], s[72:73]
    s_addc_u32 s46, s46, s46
    s_add_u32 s53, s53, 1
    s_cmp_gt_u32 s53, 0x8000
    s_cselect_b32 s46, 0xff, s46
    s_andn2_b32 s46, s46, s50
    s_or_b32 s50, s50, s46
    s_cmp_eq_u32 s50, 0xff
    s_cbranch_scc0 L_pm5
    buffer_load_dwordx4 v[96:99], v5, s[60:63], s59 offen sc1
    s_mov_b32 s47, s51
    s_mov_b32 s52, 5
    s_branch L_go5
L_pm5:
    s_load_dwordx16 s[4:19], s[26:27], s44 glc
    s_cmp_lg_u32 s46, 0
    s_cbranch_scc1 L_go5
    s_cmp_eq_u32 s51, 0
    s_cbranch_scc1 L_poll5
    s_mov_b32 s52, 5
    s_branch L_acc
L_poll6:
    s_waitcnt lgkmcnt(0)
    s_cmp_eq_u64 s[18:19], s[72:73]
    s_addc_u32 s46, s46, s46
    s_cmp_eq_u64 s[16:17], s[72:73]
    s_addc_u32 s46, s46, s46
    s_cmp_eq_u64 s[14:15], s[72:73]
    s_addc_u32 s46, s46, s46
    s_cmp_eq_u64 s[12:13], s[72:73]
    s_addc_u32 s46, s46, s46
    s_cmp_eq_u64 s[10:11], s[72:73]
    s_addc_u32 s46, s46, s46
    s_cmp_eq_u64 s[8:9], s[72:73]
    s_addc_u32 s46, s46, s46
    s_cmp_eq_u64 s[6:7], s[72:73]
    s_addc_u32 s46, s46, s46
    s_cmp_eq_u64 s[4:5], s[72:73]
    s_addc_u32 s46, s46, s46
    s_add_u32 s53, s53, 1
    s_cmp_gt_u32 s53, 0x8000
    s_cselect_b32 s46, 0xff, s46
    s_andn2_b32 s46, s46, s50
    s_or_b32 s50, s50, s46
    s_cmp_eq_u32 s50, 0xff
    s_cbranch_scc0 L_pm6
    buffer_load_dwordx4 v[96:99], v5, s[60:63], s59 offen sc1
    s_mov_b32 s47, s51
    s_mov_b32 s52, 6
    s_branch L_go6
L_pm6:
    s_load_dwordx16 s[4:19], s[26:27], s44 glc
    s_cmp_lg_u32 s46, 0
    s_cbranch_scc1 L_go6
    s_cmp_eq_u32 s51, 0
    s_cbranch_scc1 L_poll6
    s_mov_b32 s52, 6
    s_branch L_acc
L_poll7:
    s_waitcnt lgkmcnt(0)
    s_cmp_eq_u64 s[18:19], s[72:73]
    s_addc_u32 s46, s46, s46
    s_cmp_eq_u64 s[16:17], s[72:73]
    s_addc_u32 s46, s46, s46
    s_cmp_eq_u64 s[14:15], s[72:73]
    s_addc_u32 s46, s46, s46
    s_cmp_eq_u64 s[12:13], s[72:73]
    s_addc_u32 s46, s46, s46
    s_cmp_eq_u64 s[10:11], s[72:73]
    s_addc_u32 s46, s46, s46
    s_cmp_eq_u64 s[8:9], s[72:73]
    s_addc_u32 s46, s46, s46
    s_cmp_eq_u64 s[6:7], s[72:73]
    s_addc_u32 s46, s46, s46
    s_cmp_eq_u64 s[4:5], s[72:73]
    s_addc_u32 s46, s46, s46
    s_add_u32 s53, s53, 1
    s_cmp_gt_u32 s53, 0x8000
    s_cselect_b32 s46, 0xff, s46
    s_andn2_b32 s46, s46, s50
    s_or_b32 s50, s50, s46
    s_cmp_eq_u32 s50, 0xff
    s_cbranch_scc0 L_pm7
    buffer_load_dwordx4 v[96:99], v5, s[60:63], s59 offen sc1
    s_mov_b32 s47, s51
    s_mov_b32 s52, 7
    s_branch L_go7
L_pm7:
    s_load_dwordx16 s[4:19], s[26:27], s44 glc
    s_cmp_lg_u32 s46, 0
    s_cbranch_scc1 L_go7
    s_cmp_eq_u32 s51, 0
    s_cbranch_scc1 L_poll7
    s_mov_b32 s52, 7
    s_branch L_acc
L_acc:
    s_waitcnt vmcnt(0)
    s_bitcmp1_b32 s51, 0
    s_cbranch_scc0 L_ac0
    v_mfma_f32_16x16x32_bf16 v[88:91], v[10:13], v[24:27], v[88:91]
    v_mfma_f32_16x16x32_bf16 v[92:95], v[8:11], v[24:27], v[92:95]
    v_mfma_f32_16x16x32_bf16 v[88:91], v[10:13], v[28:31], v[88:91]
    v_mfma_f32_16x16x32_bf16 v[92:95], v[8:11], v[28:31], v[92:95]
L_ac0:
    s_bitcmp1_b32 s51, 1
    s_cbranch_scc0 L_ac1
    v_mfma_f32_16x16x32_bf16 v[88:91], v[10:13], v[32:35], v[88:91]
    v_mfma_f32_16x16x32_bf16 v[92:95], v[8:11], v[32:35], v[92:95]
    v_mfma_f32_16x16x32_bf16 v[88:91], v[10:13], v[36:39], v[88:91]
    v_mfma_f32_16x16x32_bf16 v[92:95], v[8:11], v[36:39], v[92:95]
L_ac1:
    s_bitcmp1_b32 s51, 2
    s_cbranch_scc0 L_ac2
    v_mfma_f32_16x16x32_bf16 v[88:91], v[10:13], v[40:43], v[88:91]
    v_mfma_f32_16x16x32_bf16 v[92:95], v[8:11], v[40:43], v[92:95]
    v_mfma_f32_16x16x32_bf16 v[88:91], v[10:13], v[44:47], v[88:91]
    v_mfma_f32_16x16x32_bf16 v[92:95], v[8:11], v[44:47], v[92:95]
L_ac2:
    s_bitcmp1_b32 s51, 3
    s_cbranch_scc0 L_ac3
    v_mfma_f32_16x16x32_bf16 v[88:91], v[10:13], v[48:51], v[88:91]
    v_mfma_f32_16x16x32_bf16 v[92:95], v[8:11], v[48:51], v[92:95]
    v_mfma_f32_16x16x32_bf16 v[88:91], v[10:13], v[52:55], v[88:91]
    v_mfma_f32_16x16x32_bf16 v[92:95], v[8:11], v[52:55], v[92:95]
L_ac3:
    s_bitcmp1_b32 s51, 4
    s_cbranch_scc0 L_ac4
    v_mfma_f32_16x16x32_bf16 v[88:91], v[10:13], v[56:59], v[88:91]
    v_mfma_f32_16x16x32_bf16 v[92:95], v[8:11], v[56:59], v[92:95]
    v_mfma_f32_16x16x32_bf16 v[88:91], v[10:13], v[60:63], v[88:91]
    v_mfma_f32_16x16x32_bf16 v[92:95], v[8:11], v[60:63], v[92:95]
L_ac4:
    s_bitcmp1_b32 s51, 5
    s_cbranch_scc0 L_ac5
    v_mfma_f32_16x16x32_bf16 v[88:91], v[10:13], v[64:67], v[88:91]
    v_mfma_f32_16x16x32_bf16 v[92:95], v[8:11], v[64:67], v[92:95]
    v_mfma_f32_16x16x32_bf16 v[88:91], v[10:13], v[68:71], v[88:91]
    v_mfma_f32_16x16x32_bf16 v[92:95], v[8:11], v[68:71], v[92:95]
L_ac5:
    s_bitcmp1_b32 s51, 6
    s_cbranch_scc0 L_ac6
    v_mfma_f32_16x16x32_bf16 v[88:91], v[10:13], v[72:75], v[88:91]
    v_mfma_f32_16x16x32_bf16 v[92:95], v[8:11], v[72:75], v[92:95]
    v_mfma_f32_16x16x32_bf16 v[88:91], v[10:13], v[76:79], v[88:91]
    v_mfma_f32_16x16x32_bf16 v[92:95], v[8:11], v[76:79], v[92:95]
L_ac6:
    s_mov_b32 s51, 0
    s_cmp_eq_u32 s52, 1
    s_cbranch_scc1 L_poll1
    s_cmp_eq_u32 s52, 2
    s_cbranch_scc1 L_poll2
    s_cmp_eq_u32 s52, 3
    s_cbranch_scc1 L_poll3
    s_cmp_eq_u32 s52, 4
    s_cbranch_scc1 L_poll4
    s_cmp_eq_u32 s52, 5
    s_cbranch_scc1 L_poll5
    s_cmp_eq_u32 s52, 6
    s_cbranch_scc1 L_poll6
    s_branch L_poll7
L_fin:
    s_cmp_eq_u32 s47, 0
    s_cbranch_scc1 L_pz
    s_cmp_eq_u32 s52, 1
    s_cbranch_scc1 L_pv1
    s_cmp_eq_u32 s52, 2
    s_cbranch_scc1 L_pv2
    s_cmp_eq_u32 s52, 3
    s_cbranch_scc1 L_pv3
    s_cmp_eq_u32 s52, 4
    s_cbranch_scc1 L_pv4
    s_cmp_eq_u32 s52, 5
    s_cbranch_scc1 L_pv5
    s_cmp_eq_u32 s52, 6
    s_cbranch_scc1 L_pv6
    s_waitcnt vmcnt(3)
    s_branch L_pvd
L_pv1:
    s_waitcnt vmcnt(15)
    s_branch L_pvd
L_pv2:
    s_waitcnt vmcnt(13)
    s_branch L_pvd
L_pv3:
    s_waitcnt vmcnt(11)
    s_branch L_pvd
L_pv4:
    s_waitcnt vmcnt(9)
    s_branch L_pvd
L_pv5:
    s_waitcnt vmcnt(7)
    s_branch L_pvd
L_pv6:
    s_waitcnt vmcnt(5)
L_pvd:
    s_bitcmp1_b32 s47, 0
    s_cbranch_scc0 L_ao0
    v_mfma_f32_16x16x32_bf16 v[88:91], v[10:13], v[24:27], v[88:91]
    v_mfma_f32_16x16x32_bf16 v[92:95], v[8:11], v[24:27], v[92:95]
    v_mfma_f32_16x16x32_bf16 v[88:91], v[10:13], v[28:31], v[88:91]
    v_mfma_f32_16x16x32_bf16 v[92:95], v[8:11], v[28:31], v[92:95]
L_ao0:
    s_bitcmp1_b32 s47, 1
    s_cbranch_scc0 L_ao1
    v_mfma_f32_16x16x32_bf16 v[88:91], v[10:13], v[32:35], v[88:91]
    v_mfma_f32_16x16x32_bf16 v[92:95], v[8:11], v[32:35], v[92:95]
    v_mfma_f32_16x16x32_bf16 v[88:91], v[10:13], v[36:39], v[88:91]
    v_mfma_f32_16x16x32_bf16 v[92:95], v[8:11], v[36:39], v[92:95]
L_ao1:
    s_bitcmp1_b32 s47, 2
    s_cbranch_scc0 L_ao2
    v_mfma_f32_16x16x32_bf16 v[88:91], v[10:13], v[40:43], v[88:91]
    v_mfma_f32_16x16x32_bf16 v[92:95], v[8:11], v[40:43], v[92:95]
    v_mfma_f32_16x16x32_bf16 v[88:91], v[10:13], v[44:47], v[88:91]
    v_mfma_f32_16x16x32_bf16 v[92:95], v[8:11], v[44:47], v[92:95]
L_ao2:
    s_bitcmp1_b32 s47, 3
    s_cbranch_scc0 L_ao3
    v_mfma_f32_16x16x32_bf16 v[88:91], v[10:13], v[48:51], v[88:91]
    v_mfma_f32_16x16x32_bf16 v[92:95], v[8:11], v[48:51], v[92:95]
    v_mfma_f32_16x16x32_bf16 v[88:91], v[10:13], v[52:55], v[88:91]
    v_mfma_f32_16x16x32_bf16 v[92:95], v[8:11], v[52:55], v[92:95]
L_ao3:
    s_bitcmp1_b32 s47, 4
    s_cbranch_scc0 L_ao4
    v_mfma_f32_16x16x32_bf16 v[88:91], v[10:13], v[56:59], v[88:91]
    v_mfma_f32_16x16x32_bf16 v[92:95], v[8:11], v[56:59], v[92:95]
    v_mfma_f32_16x16x32_bf16 v[88:91], v[10:13], v[60:63], v[88:91]
    v_mfma_f32_16x16x32_bf16 v[92:95], v[8:11], v[60:63], v[92:95]
L_ao4:
    s_bitcmp1_b32 s47, 5
    s_cbranch_scc0 L_ao5
    v_mfma_f32_16x16x32_bf16 v[88:91], v[10:13], v[64:67], v[88:91]
    v_mfma_f32_16x16x32_bf16 v[92:95], v[8:11], v[64:67], v[92:95]
    v_mfma_f32_16x16x32_bf16 v[88:91], v[10:13], v[68:71], v[88:91]
    v_mfma_f32_16x16x32_bf16 v[92:95], v[8:11], v[68:71], v[92:95]
L_ao5:
    s_bitcmp1_b32 s47, 6
    s_cbranch_scc0 L_ao6
    v_mfma_f32_16x16x32_bf16 v[88:91], v[10:13], v[72:75], v[88:91]
    v_mfma_f32_16x16x32_bf16 v[92:95], v[8:11], v[72:75], v[92:95]
    v_mfma_f32_16x16x32_bf16 v[88:91], v[10:13], v[76:79], v[88:91]
    v_mfma_f32_16x16x32_bf16 v[92:95], v[8:11], v[76:79], v[92:95]
L_ao6:
L_pz:
    s_cmp_eq_u32 s52, 0
    s_cbranch_scc1 L_pw0
    s_cmp_eq_u32 s52, 1
    s_cbranch_scc1 L_pw1
    s_cmp_eq_u32 s52, 2
    s_cbranch_scc1 L_pw2
    s_cmp_eq_u32 s52, 3
    s_cbranch_scc1 L_pw3
    s_cmp_eq_u32 s52, 4
    s_cbranch_scc1 L_pw4
    s_cmp_eq_u32 s52, 5
    s_cbranch_scc1 L_pw5
    s_cmp_eq_u32 s52, 6
    s_cbranch_scc1 L_pw6
    s_waitcnt vmcnt(2)
    s_branch L_pwd
L_pw0:
    s_waitcnt vmcnt(16)
    s_branch L_pwd
L_pw1:
    s_waitcnt vmcnt(14)
    s_branch L_pwd
L_pw2:
    s_waitcnt vmcnt(12)
    s_branch L_pwd
L_pw3:
    s_waitcnt vmcnt(10)
    s_branch L_pwd
L_pw4:
    s_waitcnt vmcnt(8)
    s_branch L_pwd
L_pw5:
    s_waitcnt vmcnt(6)
    s_branch L_pwd
L_pw6:
    s_waitcnt vmcnt(4)
L_pwd:
    v_mfma_f32_16x16x32_bf16 v[184:187], v[96:99], v[104:107], 0
    v_mfma_f32_16x16x32_bf16 v[188:191], v[96:99], v[108:111], 0
    v_mfma_f32_16x16x32_bf16 v[192:195], v[96:99], v[112:115], 0
    v_mfma_f32_16x16x32_bf16 v[196:199], v[96:99], v[116:119], 0
    s_nop 4
    v_cvt_pk_bf16_f32 v136, v184, v185
    v_cvt_pk_bf16_f32 v137, v186, v187
    v_cvt_pk_bf16_f32 v140, v188, v189
    v_cvt_pk_bf16_f32 v141, v190, v191
    v_cvt_pk_bf16_f32 v144, v192, v193
    v_cvt_pk_bf16_f32 v145, v194, v195
    v_cvt_pk_bf16_f32 v148, v196, v197
    v_cvt_pk_bf16_f32 v149, v198, v199
    s_nop 0
    v_mfma_f32_16x16x32_bf16 v[212:215], v[160:163], v[136:139], v[168:171]
    v_mfma_f32_16x16x32_bf16 v[216:219], v[160:163], v[140:143], v[168:171]
    v_mfma_f32_16x16x32_bf16 v[220:223], v[160:163], v[144:147], v[168:171]
    v_mfma_f32_16x16x32_bf16 v[224:227], v[160:163], v[148:151], v[168:171]
    s_cmp_eq_u32 s52, 7
    s_cbranch_scc1 L_an7
    s_cmp_eq_u32 s52, 6
    s_cbranch_scc1 L_an6
    s_cmp_eq_u32 s52, 5
    s_cbranch_scc1 L_an5
    s_cmp_eq_u32 s52, 4
    s_cbranch_scc1 L_an4
    s_cmp_eq_u32 s52, 3
    s_cbranch_scc1 L_an3
    s_cmp_eq_u32 s52, 2
    s_cbranch_scc1 L_an2
    s_cmp_eq_u32 s52, 1
    s_cbranch_scc1 L_an1
L_an0:
    s_waitcnt vmcnt(14)
    v_mfma_f32_16x16x32_bf16 v[88:91], v[10:13], v[24:27], v[88:91]
    v_mfma_f32_16x16x32_bf16 v[92:95], v[8:11], v[24:27], v[92:95]
    v_mfma_f32_16x16x32_bf16 v[88:91], v[10:13], v[28:31], v[88:91]
    v_mfma_f32_16x16x32_bf16 v[92:95], v[8:11], v[28:31], v[92:95]
L_an1:
    s_waitcnt vmcnt(12)
    v_mfma_f32_16x16x32_bf16 v[88:91], v[10:13], v[32:35], v[88:91]
    v_mfma_f32_16x16x32_bf16 v[92:95], v[8:11], v[32:35], v[92:95]
    v_mfma_f32_16x16x32_bf16 v[88:91], v[10:13], v[36:39], v[88:91]
    v_mfma_f32_16x16x32_bf16 v[92:95], v[8:11], v[36:39], v[92:95]
L_an2:
    s_waitcnt vmcnt(10)
    v_mfma_f32_16x16x32_bf16 v[88:91], v[10:13], v[40:43], v[88:91]
    v_mfma_f32_16x16x32_bf16 v[92:95], v[8:11], v[40:43], v[92:95]
    v_mfma_f32_16x16x32_bf16 v[88:91], v[10:13], v[44:47], v[88:91]
    v_mfma_f32_16x16x32_bf16 v[92:95], v[8:11], v[44:47], v[92:95]
L_an3:
    s_waitcnt vmcnt(8)
    v_mfma_f32_16x16x32_bf16 v[88:91], v[10:13], v[48:51], v[88:91]
    v_mfma_f32_16x16x32_bf16 v[92:95], v[8:11], v[48:51], v[92:95]
    v_mfma_f32_16x16x32_bf16 v[88:91], v[10:13], v[52:55], v[88:91]
    v_mfma_f32_16x16x32_bf16 v[92:95], v[8:11], v[52:55], v[92:95]
L_an4:
    s_waitcnt vmcnt(6)
    v_mfma_f32_16x16x32_bf16 v[88:91], v[10:13], v[56:59], v[88:91]
    v_mfma_f32_16x16x32_bf16 v[92:95], v[8:11], v[56:59], v[92:95]
    v_mfma_f32_16x16x32_bf16 v[88:91], v[10:13], v[60:63], v[88:91]
    v_mfma_f32_16x16x32_bf16 v[92:95], v[8:11], v[60:63], v[92:95]
L_an5:
    s_waitcnt vmcnt(4)
    v_mfma_f32_16x16x32_bf16 v[88:91], v[10:13], v[64:67], v[88:91]
    v_mfma_f32_16x16x32_bf16 v[92:95], v[8:11], v[64:67], v[92:95]
    v_mfma_f32_16x16x32_bf16 v[88:91], v[10:13], v[68:71], v[88:91]
    v_mfma_f32_16x16x32_bf16 v[92:95], v[8:11], v[68:71], v[92:95]
L_an6:
    s_waitcnt vmcnt(2)
    v_mfma_f32_16x16x32_bf16 v[88:91], v[10:13], v[72:75], v[88:91]
    v_mfma_f32_16x16x32_bf16 v[92:95], v[8:11], v[72:75], v[92:95]
    v_mfma_f32_16x16x32_bf16 v[88:91], v[10:13], v[76:79], v[88:91]
    v_mfma_f32_16x16x32_bf16 v[92:95], v[8:11], v[76:79], v[92:95]
L_an7:
    s_waitcnt vmcnt(0)
    v_mfma_f32_16x16x32_bf16 v[88:91], v[10:13], v[80:83], v[88:91]
    v_mfma_f32_16x16x32_bf16 v[92:95], v[8:11], v[80:83], v[92:95]
    v_mfma_f32_16x16x32_bf16 v[88:91], v[10:13], v[84:87], v[88:91]
    v_mfma_f32_16x16x32_bf16 v[92:95], v[8:11], v[84:87], v[92:95]
    s_nop 3
    v_rcp_f32 v212, v212
    v_rcp_f32 v216, v216
    v_rcp_f32 v220, v220
    v_rcp_f32 v224, v224
    v_cvt_pk_bf16_f32 v172, v88, v89
    v_cvt_pk_bf16_f32 v173, v90, v91
    v_cvt_pk_bf16_f32 v174, v92, v93
    v_cvt_pk_bf16_f32 v175, v94, v95
    ds_write_b128 v6, v[172:175]
    ds_write_b32 v21, v232 offset:40
    ds_read_b32 v235, v255 offset:40
    ds_read_b128 v[176:179], v7
    v_mfma_f32_16x16x32_bf16 v[24:27], v[172:175], v[104:107], 0
    v_mfma_f32_16x16x32_bf16 v[28:31], v[172:175], v[108:111], 0
    v_mfma_f32_16x16x32_bf16 v[32:35], v[172:175], v[112:115], 0
    v_mfma_f32_16x16x32_bf16 v[36:39], v[172:175], v[116:119], 0
    s_mov_b32 s45, 0
    s_nop 3
    s_cmp_eq_u32 s40, 0
    v_mul_f32 v24, v24, v212
    v_mul_f32 v25, v25, v212
    v_mul_f32 v26, v26, v212
    v_mul_f32 v27, v27, v212
    v_mul_f32 v28, v28, v216
    v_mul_f32 v29, v29, v216
    v_mul_f32 v30, v30, v216
    v_mul_f32 v31, v31, v216
    v_mul_f32 v32, v32, v220
    v_mul_f32 v33, v33, v220
    v_mul_f32 v34, v34, v220
    v_mul_f32 v35, v35, v220
    v_mul_f32 v36, v36, v224
    v_mul_f32 v37, v37, v224
    v_mul_f32 v38, v38, v224
    v_mul_f32 v39, v39, v224
    s_cbranch_scc0 L_o1
    v_cvt_pk_bf16_f32 v56, v24, v25
    v_cvt_pk_bf16_f32 v57, v26, v27
    v_cvt_pk_bf16_f32 v60, v28, v29
    v_cvt_pk_bf16_f32 v61, v30, v31
    v_cvt_pk_bf16_f32 v64, v32, v33
    v_cvt_pk_bf16_f32 v65, v34, v35
    v_cvt_pk_bf16_f32 v68, v36, v37
    v_cvt_pk_bf16_f32 v69, v38, v39
    s_branch L_ks0g
L_ks0:
    ds_read_b32 v235, v255 offset:40
    ds_read_b128 v[176:179], v7
L_ks0g:
    s_add_u32 s45, s45, 1
    s_waitcnt lgkmcnt(0)
    v_readfirstlane_b32 s46, v235
    s_cmp_gt_u32 s45, 0x40000
    s_cbranch_scc1 L_kd0
    s_cmp_eq_u32 s46, 0
    s_cbranch_scc1 L_ks0
L_kd0:
    v_mfma_f32_16x16x32_bf16 v[40:43], v[176:179], v[104:107], 0
    v_mfma_f32_16x16x32_bf16 v[44:47], v[176:179], v[108:111], 0
    v_mfma_f32_16x16x32_bf16 v[48:51], v[176:179], v[112:115], 0
    v_mfma_f32_16x16x32_bf16 v[52:55], v[176:179], v[116:119], 0
    s_nop 4
    v_mul_f32 v40, v40, v212
    v_mul_f32 v41, v41, v212
    v_mul_f32 v42, v42, v212
    v_mul_f32 v43, v43, v212
    v_cvt_pk_bf16_f32 v58, v40, v41
    v_cvt_pk_bf16_f32 v59, v42, v43
    buffer_store_dwordx4 v[56:59], v5, s[60:63], s48 offen sc1
    s_add_u32 s48, s48, 0x8000
    v_mul_f32 v44, v44, v216
    v_mul_f32 v45, v45, v216
    v_mul_f32 v46, v46, v216
    v_mul_f32 v47, v47, v216
    v_cvt_pk_bf16_f32 v62, v44, v45
    v_cvt_pk_bf16_f32 v63, v46, v47
    buffer_store_dwordx4 v[60:63], v5, s[60:63], s48 offen sc1
    s_add_u32 s48, s48, 0x8000
    v_mul_f32 v48, v48, v220
    v_mul_f32 v49, v49, v220
    v_mul_f32 v50, v50, v220
    v_mul_f32 v51, v51, v220
    v_cvt_pk_bf16_f32 v66, v48, v49
    v_cvt_pk_bf16_f32 v67, v50, v51
    buffer_store_dwordx4 v[64:67], v5, s[60:63], s48 offen sc1
    s_add_u32 s48, s48, 0x8000
    v_mul_f32 v52, v52, v224
    v_mul_f32 v53, v53, v224
    v_mul_f32 v54, v54, v224
    v_mul_f32 v55, v55, v224
    v_cvt_pk_bf16_f32 v70, v52, v53
    v_cvt_pk_bf16_f32 v71, v54, v55
    buffer_store_dwordx4 v[68:71], v5, s[60:63], s48 offen sc1
    s_branch L_o2
L_o1:
    v_cvt_pk_bf16_f32 v58, v24, v25
    v_cvt_pk_bf16_f32 v59, v26, v27
    v_cvt_pk_bf16_f32 v62, v28, v29
    v_cvt_pk_bf16_f32 v63, v30, v31
    v_cvt_pk_bf16_f32 v66, v32, v33
    v_cvt_pk_bf16_f32 v67, v34, v35
    v_cvt_pk_bf16_f32 v70, v36, v37
    v_cvt_pk_bf16_f32 v71, v38, v39
    s_branch L_ks1g
L_ks1:
    ds_read_b32 v235, v255 offset:40
    ds_read_b128 v[176:179], v7
L_ks1g:
    s_add_u32 s45, s45, 1
    s_waitcnt lgkmcnt(0)
    v_readfirstlane_b32 s46, v235
    s_cmp_gt_u32 s45, 0x40000
    s_cbranch_scc1 L_kd1
    s_cmp_eq_u32 s46, 0
    s_cbranch_scc1 L_ks1
L_kd1:
    v_mfma_f32_16x16x32_bf16 v[40:43], v[176:179], v[104:107], 0
    v_mfma_f32_16x16x32_bf16 v[44:47], v[176:179], v[108:111], 0
    v_mfma_f32_16x16x32_bf16 v[48:51], v[176:179], v[112:115], 0
    v_mfma_f32_16x16x32_bf16 v[52:55], v[176:179], v[116:119], 0
    s_nop 4
    v_mul_f32 v40, v40, v212
    v_mul_f32 v41, v41, v212
    v_mul_f32 v42, v42, v212
    v_mul_f32 v43, v43, v212
    v_cvt_pk_bf16_f32 v56, v40, v41
    v_cvt_pk_bf16_f32 v57, v42, v43
    buffer_store_dwordx4 v[56:59], v5, s[60:63], s48 offen sc1
    s_add_u32 s48, s48, 0x8000
    v_mul_f32 v44, v44, v216
    v_mul_f32 v45, v45, v216
    v_mul_f32 v46, v46, v216
    v_mul_f32 v47, v47, v216
    v_cvt_pk_bf16_f32 v60, v44, v45
    v_cvt_pk_bf16_f32 v61, v46, v47
    buffer_store_dwordx4 v[60:63], v5, s[60:63], s48 offen sc1
    s_add_u32 s48, s48, 0x8000
    v_mul_f32 v48, v48, v220
    v_mul_f32 v49, v49, v220
    v_mul_f32 v50, v50, v220
    v_mul_f32 v51, v51, v220
    v_cvt_pk_bf16_f32 v64, v48, v49
    v_cvt_pk_bf16_f32 v65, v50, v51
    buffer_store_dwordx4 v[64:67], v5, s[60:63], s48 offen sc1
    s_add_u32 s48, s48, 0x8000
    v_mul_f32 v52, v52, v224
    v_mul_f32 v53, v53, v224
    v_mul_f32 v54, v54, v224
    v_mul_f32 v55, v55, v224
    v_cvt_pk_bf16_f32 v68, v52, v53
    v_cvt_pk_bf16_f32 v69, v54, v55
    buffer_store_dwordx4 v[68:71], v5, s[60:63], s48 offen sc1
L_o2:
    s_lshl_b32 s59, s34, 3
    s_lshl_b32 s45, s3, 1
    s_add_u32 s59, s59, s45
    s_lshl_b32 s45, s59, 15
    s_add_u32 s45, s45, 0x400000
    v_add_u32 v242, 0x8000, v5
    s_mov_b32 s51, 0x55555555
    s_add_u32 s64, s26, s45
    s_addc_u32 s65, s27, 0
    s_mov_b32 s66, 0x10000
    s_mov_b32 s67, 0x20000
    s_lshl_b32 s52, s34, 8
    s_lshl_b32 s46, s3, 6
    s_add_u32 s52, s52, s46
    s_lshr_b32 vcc_lo, s52, 6
    s_mul_i32 vcc_lo, vcc_lo, 1984
    s_add_u32 s52, s52, vcc_lo
    s_add_u32 s52, s52, 0x980000
    s_lshl_b32 vcc_lo, s35, 7
    s_add_u32 s52, s52, vcc_lo
    v_lshrrev_b32 v6, 2, v4
    v_lshlrev_b32 v6, 7, v6
    v_and_b32 v7, 3, v4
    v_lshl_add_u32 v6, v7, 3, v6
    v_bfe_u32 v7, v4, 3, 1
    v_lshl_add_u32 v6, v7, 6, v6
    v_lshl_add_u32 v236, v23, 5, v6
    v_xor_b32 v237, 32, v236
    v_xor_b32 v238, 64, v236
    v_xor_b32 v239, 0x60, v236
    s_lshl_b32 s57, s3, 11
    s_add_u32 s57, s57, 131584
    v_lshrrev_b32 v7, 5, v4
    v_lshl_add_u32 v6, v23, 1, v7
    v_and_b32 v7, 7, v4
    v_xor_b32 v6, v6, v7
    v_lshlrev_b32 v6, 4, v6
    v_and_b32 v3, 15, v4
    v_lshl_add_u32 v6, v3, 7, v6
    v_add_u32 v15, s57, v6
    v_xor_b32 v18, 64, v15
    v_lshrrev_b32 v6, 3, v4
    v_lshlrev_b32 v3, 4, v7
    v_lshl_add_u32 v17, v6, 12, v3
    v_xor_b32 v7, v7, v6
    v_lshlrev_b32 v7, 4, v7
    v_lshl_add_u32 v6, v6, 7, v7
    v_add_u32 v16, s57, v6
    s_mov_b32 s50, 0
    s_mov_b32 s53, 0
    s_mov_b32 s54, 0
    s_lshl_b32 s55, s40, 4
    s_and_b32 s42, s34, 3
    s_lshl_b32 s42, s42, 3
    v_mov_b64 v[120:121], 0
    v_mov_b64 v[122:123], 0
    v_mov_b64 v[124:125], 0
    v_mov_b64 v[126:127], 0
    v_mov_b64 v[128:129], 0
    v_mov_b64 v[130:131], 0
    v_mov_b64 v[132:133], 0
    v_mov_b64 v[134:135], 0
    v_mov_b64 v[136:137], 0
    v_mov_b64 v[138:139], 0
    s_load_dwordx16 s[4:19], s[26:27], s52 glc
    v_mov_b64 v[140:141], 0
    v_mov_b64 v[142:143], 0
    v_mov_b64 v[144:145], 0
    v_mov_b64 v[146:147], 0
    v_mov_b64 v[148:149], 0
    v_mov_b64 v[150:151], 0
    s_waitcnt vmcnt(0)
    s_mov_b64 exec, 0xffff
    buffer_store_dword v234, v254, s[60:63], s49 offen sc1
    s_mov_b64 exec, -1
    s_waitcnt lgkmcnt(0)
    s_mov_b32 s54, 0
    s_cmp_eq_u64 s[4:5], s[72:73]
    s_cselect_b32 s46, 0x1, 0
    s_or_b32 s54, s54, s46
    s_cmp_eq_u64 s[6:7], s[72:73]
    s_cselect_b32 s46, 0x4, 0
    s_or_b32 s54, s54, s46
    s_cmp_eq_u64 s[8:9], s[72:73]
    s_cselect_b32 s46, 0x10, 0
    s_or_b32 s54, s54, s46
    s_cmp_eq_u64 s[10:11], s[72:73]
    s_cselect_b32 s46, 0x40, 0
    s_or_b32 s54, s54, s46
    s_cmp_eq_u64 s[12:13], s[72:73]
    s_cselect_b32 s46, 0x100, 0
    s_or_b32 s54, s54, s46
    s_cmp_eq_u64 s[14:15], s[72:73]
    s_cselect_b32 s46, 0x400, 0
    s_or_b32 s54, s54, s46
    s_cmp_eq_u64 s[16:17], s[72:73]
    s_cselect_b32 s46, 0x1000, 0
    s_or_b32 s54, s54, s46
    s_cmp_eq_u64 s[18:19], s[72:73]
    s_cselect_b32 s46, 0x4000, 0
    s_or_b32 s54, s54, s46
    s_lshl_b32 s46, s54, s55
    s_mov_b32 s47, s46
    s_lshr_b64 s[46:47], s[46:47], s42
    v_mov_b32 v235, s46
    s_mov_b64 exec, 1
    ds_or_b32 v14, v235 offset:64
    s_mov_b64 exec, -1
    s_setprio 2
    s_cmp_lg_u32 s50, 0
    s_cbranch_scc1 L_sel0_ok
    s_mov_b32 s45, 0
    s_cmp_lg_u32 s51, 0
    s_cbranch_scc1 L_sel0
    s_mov_b32 s66, 0
    s_mov_b32 s50, 0x55555555
    s_branch L_sel0_ok
L_sel0:
    ds_read_b32 v235, v14 offset:64
    ds_read_b32 v13, v20 offset:60
    s_add_u32 s45, s45, 1
    s_waitcnt lgkmcnt(0)
    v_and_b32 v13, v13, v235
    s_cmp_gt_u32 s45, 0x40000
    s_cselect_b32 s46, -1, 0
    v_readfirstlane_b32 s50, v13
    s_nop 3
    s_or_b32 s50, s50, s46
    s_and_b32 s50, s50, s51
    s_cbranch_scc1 L_sel0_ok
    s_cmp_lg_u32 s54, 0x5555
    s_cbranch_scc1 L_sel0_p
    s_sleep 1
    s_branch L_sel0
L_sel0_p:
    s_load_dwordx16 s[4:19], s[26:27], s52 glc
    s_add_u32 s45, s45, 8
    s_waitcnt lgkmcnt(0)
    s_mov_b32 s54, 0
    s_cmp_eq_u64 s[4:5], s[72:73]
    s_cselect_b32 s46, 0x1, 0
    s_or_b32 s54, s54, s46
    s_cmp_eq_u64 s[6:7], s[72:73]
    s_cselect_b32 s46, 0x4, 0
    s_or_b32 s54, s54, s46
    s_cmp_eq_u64 s[8:9], s[72:73]
    s_cselect_b32 s46, 0x10, 0
    s_or_b32 s54, s54, s46
    s_cmp_eq_u64 s[10:11], s[72:73]
    s_cselect_b32 s46, 0x40, 0
    s_or_b32 s54, s54, s46
    s_cmp_eq_u64 s[12:13], s[72:73]
    s_cselect_b32 s46, 0x100, 0
    s_or_b32 s54, s54, s46
    s_cmp_eq_u64 s[14:15], s[72:73]
    s_cselect_b32 s46, 0x400, 0
    s_or_b32 s54, s54, s46
    s_cmp_eq_u64 s[16:17], s[72:73]
    s_cselect_b32 s46, 0x1000, 0
    s_or_b32 s54, s54, s46
    s_cmp_eq_u64 s[18:19], s[72:73]
    s_cselect_b32 s46, 0x4000, 0
    s_or_b32 s54, s54, s46
    s_lshl_b32 s46, s54, s55
    s_mov_b32 s47, s46
    s_lshr_b64 s[46:47], s[46:47], s42
    v_mov_b32 v235, s46
    s_mov_b64 exec, 1
    ds_or_b32 v14, v235 offset:64
    s_mov_b64 exec, -1
    s_branch L_sel0
L_sel0_ok:
    s_ff1_i32_b32 s46, s50
    s_bitset0_b32 s50, s46
    s_add_u32 s48, s46, s42
    s_and_b32 s48, s48, 31
    s_lshl_b32 s48, s48, 10
    s_bitset0_b32 s51, s46
    s_lshl_b32 s28, s46, 12
    buffer_load_dwordx4 v[24:27], v5, s[64:67], s48 offen offset:0 sc1
    buffer_load_dwordx4 v[28:31], v242, s[64:67], s48 offen offset:0 sc1
    buffer_load_dwordx4 v[32:35], v5, s[64:67], s48 offen offset:1024 sc1
    buffer_load_dwordx4 v[36:39], v242, s[64:67], s48 offen offset:1024 sc1
    s_cmp_lg_u32 s50, 0
    s_cbranch_scc1 L_sel1_ok
    s_mov_b32 s45, 0
    s_cmp_lg_u32 s51, 0
    s_cbranch_scc1 L_sel1
    s_mov_b32 s66, 0
    s_mov_b32 s50, 0x55555555
    s_branch L_sel1_ok
L_sel1:
    ds_read_b32 v235, v14 offset:64
    ds_read_b32 v13, v20 offset:60
    s_add_u32 s45, s45, 1
    s_waitcnt lgkmcnt(0)
    v_and_b32 v13, v13, v235
    s_cmp_gt_u32 s45, 0x40000
    s_cselect_b32 s46, -1, 0
    v_readfirstlane_b32 s50, v13
    s_nop 3
    s_or_b32 s50, s50, s46
    s_and_b32 s50, s50, s51
    s_cbranch_scc1 L_sel1_ok
    s_cmp_lg_u32 s54, 0x5555
    s_cbranch_scc1 L_sel1_p
    s_sleep 1
    s_branch L_sel1
L_sel1_p:
    s_load_dwordx16 s[4:19], s[26:27], s52 glc
    s_add_u32 s45, s45, 8
    s_waitcnt lgkmcnt(0)
    s_mov_b32 s54, 0
    s_cmp_eq_u64 s[4:5], s[72:73]
    s_cselect_b32 s46, 0x1, 0
    s_or_b32 s54, s54, s46
    s_cmp_eq_u64 s[6:7], s[72:73]
    s_cselect_b32 s46, 0x4, 0
    s_or_b32 s54, s54, s46
    s_cmp_eq_u64 s[8:9], s[72:73]
    s_cselect_b32 s46, 0x10, 0
    s_or_b32 s54, s54, s46
    s_cmp_eq_u64 s[10:11], s[72:73]
    s_cselect_b32 s46, 0x40, 0
    s_or_b32 s54, s54, s46
    s_cmp_eq_u64 s[12:13], s[72:73]
    s_cselect_b32 s46, 0x100, 0
    s_or_b32 s54, s54, s46
    s_cmp_eq_u64 s[14:15], s[72:73]
    s_cselect_b32 s46, 0x400, 0
    s_or_b32 s54, s54, s46
    s_cmp_eq_u64 s[16:17], s[72:73]
    s_cselect_b32 s46, 0x1000, 0
    s_or_b32 s54, s54, s46
    s_cmp_eq_u64 s[18:19], s[72:73]
    s_cselect_b32 s46, 0x4000, 0
    s_or_b32 s54, s54, s46
    s_lshl_b32 s46, s54, s55
    s_mov_b32 s47, s46
    s_lshr_b64 s[46:47], s[46:47], s42
    v_mov_b32 v235, s46
    s_mov_b64 exec, 1
    ds_or_b32 v14, v235 offset:64
    s_mov_b64 exec, -1
    s_branch L_sel1
L_sel1_ok:
    s_ff1_i32_b32 s46, s50
    s_bitset0_b32 s50, s46
    s_add_u32 s48, s46, s42
    s_and_b32 s48, s48, 31
    s_lshl_b32 s48, s48, 10
    s_bitset0_b32 s51, s46
    s_lshl_b32 s29, s46, 12
    buffer_load_dwordx4 v[40:43], v5, s[64:67], s48 offen offset:0 sc1
    buffer_load_dwordx4 v[44:47], v242, s[64:67], s48 offen offset:0 sc1
    buffer_load_dwordx4 v[48:51], v5, s[64:67], s48 offen offset:1024 sc1
    buffer_load_dwordx4 v[52:55], v242, s[64:67], s48 offen offset:1024 sc1
    s_cmp_lg_u32 s50, 0
    s_cbranch_scc1 L_sel2_ok
    s_mov_b32 s45, 0
    s_cmp_lg_u32 s51, 0
    s_cbranch_scc1 L_sel2
    s_mov_b32 s66, 0
    s_mov_b32 s50, 0x55555555
    s_branch L_sel2_ok
L_sel2:
    ds_read_b32 v235, v14 offset:64
    ds_read_b32 v13, v20 offset:60
    s_add_u32 s45, s45, 1
    s_waitcnt lgkmcnt(0)
    v_and_b32 v13, v13, v235
    s_cmp_gt_u32 s45, 0x40000
    s_cselect_b32 s46, -1, 0
    v_readfirstlane_b32 s50, v13
    s_nop 3
    s_or_b32 s50, s50, s46
    s_and_b32 s50, s50, s51
    s_cbranch_scc1 L_sel2_ok
    s_cmp_lg_u32 s54, 0x5555
    s_cbranch_scc1 L_sel2_p
    s_sleep 1
    s_branch L_sel2
L_sel2_p:
    s_load_dwordx16 s[4:19], s[26:27], s52 glc
    s_add_u32 s45, s45, 8
    s_waitcnt lgkmcnt(0)
    s_mov_b32 s54, 0
    s_cmp_eq_u64 s[4:5], s[72:73]
    s_cselect_b32 s46, 0x1, 0
    s_or_b32 s54, s54, s46
    s_cmp_eq_u64 s[6:7], s[72:73]
    s_cselect_b32 s46, 0x4, 0
    s_or_b32 s54, s54, s46
    s_cmp_eq_u64 s[8:9], s[72:73]
    s_cselect_b32 s46, 0x10, 0
    s_or_b32 s54, s54, s46
    s_cmp_eq_u64 s[10:11], s[72:73]
    s_cselect_b32 s46, 0x40, 0
    s_or_b32 s54, s54, s46
    s_cmp_eq_u64 s[12:13], s[72:73]
    s_cselect_b32 s46, 0x100, 0
    s_or_b32 s54, s54, s46
    s_cmp_eq_u64 s[14:15], s[72:73]
    s_cselect_b32 s46, 0x400, 0
    s_or_b32 s54, s54, s46
    s_cmp_eq_u64 s[16:17], s[72:73]
    s_cselect_b32 s46, 0x1000, 0
    s_or_b32 s54, s54, s46
    s_cmp_eq_u64 s[18:19], s[72:73]
    s_cselect_b32 s46, 0x4000, 0
    s_or_b32 s54, s54, s46
    s_lshl_b32 s46, s54, s55
    s_mov_b32 s47, s46
    s_lshr_b64 s[46:47], s[46:47], s42
    v_mov_b32 v235, s46
    s_mov_b64 exec, 1
    ds_or_b32 v14, v235 offset:64
    s_mov_b64 exec, -1
    s_branch L_sel2
L_sel2_ok:
    s_ff1_i32_b32 s46, s50
    s_bitset0_b32 s50, s46
    s_add_u32 s48, s46, s42
    s_and_b32 s48, s48, 31
    s_lshl_b32 s48, s48, 10
    s_bitset0_b32 s51, s46
    s_lshl_b32 s30, s46, 12
    buffer_load_dwordx4 v[56:59], v5, s[64:67], s48 offen offset:0 sc1
    buffer_load_dwordx4 v[60:63], v242, s[64:67], s48 offen offset:0 sc1
    buffer_load_dwordx4 v[64:67], v5, s[64:67], s48 offen offset:1024 sc1
    buffer_load_dwordx4 v[68:71], v242, s[64:67], s48 offen offset:1024 sc1
    v_add_u32 v8, s28, v236
    v_add_u32 v9, s28, v237
    v_add_u32 v10, s28, v238
    v_add_u32 v11, s28, v239
    ds_read_b64_tr_b16 v[88:89], v8 offset:0
    ds_read_b64_tr_b16 v[90:91], v8 offset:2048
    ds_read_b64_tr_b16 v[92:93], v9 offset:0
    ds_read_b64_tr_b16 v[94:95], v9 offset:2048
    ds_read_b64_tr_b16 v[96:97], v10 offset:0
    ds_read_b64_tr_b16 v[98:99], v10 offset:2048
    ds_read_b64_tr_b16 v[100:101], v11 offset:0
    ds_read_b64_tr_b16 v[102:103], v11 offset:2048
L_gloop:
    s_cmp_lg_u32 s50, 0
    s_cbranch_scc1 L_sel3_ok
    s_mov_b32 s45, 0
    s_cmp_lg_u32 s51, 0
    s_cbranch_scc1 L_sel3
    s_mov_b32 s66, 0
    s_mov_b32 s50, 0x55555555
    s_branch L_sel3_ok
L_sel3:
    ds_read_b32 v235, v14 offset:64
    ds_read_b32 v13, v20 offset:60
    s_add_u32 s45, s45, 1
    s_waitcnt lgkmcnt(0)
    v_and_b32 v13, v13, v235
    s_cmp_gt_u32 s45, 0x40000
    s_cselect_b32 s46, -1, 0
    v_readfirstlane_b32 s50, v13
    s_nop 3
    s_or_b32 s50, s50, s46
    s_and_b32 s50, s50, s51
    s_cbranch_scc1 L_sel3_ok
    s_cmp_lg_u32 s54, 0x5555
    s_cbranch_scc1 L_sel3_p
    s_sleep 1
    s_branch L_sel3
L_sel3_p:
    s_load_dwordx16 s[4:19], s[26:27], s52 glc
    s_add_u32 s45, s45, 8
    s_waitcnt lgkmcnt(0)
    s_mov_b32 s54, 0
    s_cmp_eq_u64 s[4:5], s[72:73]
    s_cselect_b32 s46, 0x1, 0
    s_or_b32 s54, s54, s46
    s_cmp_eq_u64 s[6:7], s[72:73]
    s_cselect_b32 s46, 0x4, 0
    s_or_b32 s54, s54, s46
    s_cmp_eq_u64 s[8:9], s[72:73]
    s_cselect_b32 s46, 0x10, 0
    s_or_b32 s54, s54, s46
    s_cmp_eq_u64 s[10:11], s[72:73]
    s_cselect_b32 s46, 0x40, 0
    s_or_b32 s54, s54, s46
    s_cmp_eq_u64 s[12:13], s[72:73]
    s_cselect_b32 s46, 0x100, 0
    s_or_b32 s54, s54, s46
    s_cmp_eq_u64 s[14:15], s[72:73]
    s_cselect_b32 s46, 0x400, 0
    s_or_b32 s54, s54, s46
    s_cmp_eq_u64 s[16:17], s[72:73]
    s_cselect_b32 s46, 0x1000, 0
    s_or_b32 s54, s54, s46
    s_cmp_eq_u64 s[18:19], s[72:73]
    s_cselect_b32 s46, 0x4000, 0
    s_or_b32 s54, s54, s46
    s_lshl_b32 s46, s54, s55
    s_mov_b32 s47, s46
    s_lshr_b64 s[46:47], s[46:47], s42
    v_mov_b32 v235, s46
    s_mov_b64 exec, 1
    ds_or_b32 v14, v235 offset:64
    s_mov_b64 exec, -1
    s_branch L_sel3
L_sel3_ok:
    s_waitcnt vmcnt(10) lgkmcnt(0)
    v_mfma_f32_16x16x32_bf16 v[120:123], v[88:91], v[24:27], v[120:123]
    ds_read_b64_tr_b16 v[104:105], v8 offset:4096
    ds_read_b64_tr_b16 v[106:107], v8 offset:6144
    v_mfma_f32_16x16x32_bf16 v[124:127], v[92:95], v[24:27], v[124:127]
    ds_read_b64_tr_b16 v[108:109], v9 offset:4096
    ds_read_b64_tr_b16 v[110:111], v9 offset:6144
    v_mfma_f32_16x16x32_bf16 v[128:131], v[96:99], v[24:27], v[128:131]
    ds_read_b64_tr_b16 v[112:113], v10 offset:4096
    ds_read_b64_tr_b16 v[114:115], v10 offset:6144
    v_mfma_f32_16x16x32_bf16 v[132:135], v[100:103], v[24:27], v[132:135]
    ds_read_b64_tr_b16 v[116:117], v11 offset:4096
    ds_read_b64_tr_b16 v[118:119], v11 offset:6144
    v_mfma_f32_16x16x32_bf16 v[136:139], v[88:91], v[28:31], v[136:139]
    v_add_u32 v244, s29, v236
    v_add_u32 v245, s29, v237
    v_mfma_f32_16x16x32_bf16 v[140:143], v[92:95], v[28:31], v[140:143]
    v_add_u32 v246, s29, v238
    v_add_u32 v247, s29, v239
    v_mfma_f32_16x16x32_bf16 v[144:147], v[96:99], v[28:31], v[144:147]
    s_ff1_i32_b32 s46, s50
    s_bitset0_b32 s50, s46
    s_add_u32 s48, s46, s42
    v_mfma_f32_16x16x32_bf16 v[148:151], v[100:103], v[28:31], v[148:151]
    s_and_b32 s48, s48, 31
    s_lshl_b32 s48, s48, 10
    s_bitset0_b32 s51, s46
    s_waitcnt vmcnt(8) lgkmcnt(0)
    v_mfma_f32_16x16x32_bf16 v[120:123], v[104:107], v[32:35], v[120:123]
    ds_read_b64_tr_b16 v[88:89], v244 offset:0
    ds_read_b64_tr_b16 v[90:91], v244 offset:2048
    v_mfma_f32_16x16x32_bf16 v[124:127], v[108:111], v[32:35], v[124:127]
    ds_read_b64_tr_b16 v[92:93], v245 offset:0
    ds_read_b64_tr_b16 v[94:95], v245 offset:2048
    v_mfma_f32_16x16x32_bf16 v[128:131], v[112:115], v[32:35], v[128:131]
    ds_read_b64_tr_b16 v[96:97], v246 offset:0
    ds_read_b64_tr_b16 v[98:99], v246 offset:2048
    v_mfma_f32_16x16x32_bf16 v[132:135], v[116:119], v[32:35], v[132:135]
    ds_read_b64_tr_b16 v[100:101], v247 offset:0
    ds_read_b64_tr_b16 v[102:103], v247 offset:2048
    v_mfma_f32_16x16x32_bf16 v[136:139], v[104:107], v[36:39], v[136:139]
    buffer_load_dwordx4 v[72:75], v5, s[64:67], s48 offen offset:0 sc1
    s_lshl_b32 s31, s46, 12
    v_mfma_f32_16x16x32_bf16 v[140:143], v[108:111], v[36:39], v[140:143]
    buffer_load_dwordx4 v[76:79], v242, s[64:67], s48 offen offset:0 sc1
    v_mfma_f32_16x16x32_bf16 v[144:147], v[112:115], v[36:39], v[144:147]
    buffer_load_dwordx4 v[80:83], v5, s[64:67], s48 offen offset:1024 sc1
    v_mfma_f32_16x16x32_bf16 v[148:151], v[116:119], v[36:39], v[148:151]
    buffer_load_dwordx4 v[84:87], v242, s[64:67], s48 offen offset:1024 sc1
    s_cmp_lg_u32 s50, 0
    s_cbranch_scc1 L_sel4_ok
    s_mov_b32 s45, 0
    s_cmp_lg_u32 s51, 0
    s_cbranch_scc1 L_sel4
    s_mov_b32 s66, 0
    s_mov_b32 s50, 0x55555555
    s_branch L_sel4_ok
L_sel4:
    ds_read_b32 v235, v14 offset:64
    ds_read_b32 v13, v20 offset:60
    s_add_u32 s45, s45, 1
    s_waitcnt lgkmcnt(0)
    v_and_b32 v13, v13, v235
    s_cmp_gt_u32 s45, 0x40000
    s_cselect_b32 s46, -1, 0
    v_readfirstlane_b32 s50, v13
    s_nop 3
    s_or_b32 s50, s50, s46
    s_and_b32 s50, s50, s51
    s_cbranch_scc1 L_sel4_ok
    s_cmp_lg_u32 s54, 0x5555
    s_cbranch_scc1 L_sel4_p
    s_sleep 1
    s_branch L_sel4
L_sel4_p:
    s_load_dwordx16 s[4:19], s[26:27], s52 glc
    s_add_u32 s45, s45, 8
    s_waitcnt lgkmcnt(0)
    s_mov_b32 s54, 0
    s_cmp_eq_u64 s[4:5], s[72:73]
    s_cselect_b32 s46, 0x1, 0
    s_or_b32 s54, s54, s46
    s_cmp_eq_u64 s[6:7], s[72:73]
    s_cselect_b32 s46, 0x4, 0
    s_or_b32 s54, s54, s46
    s_cmp_eq_u64 s[8:9], s[72:73]
    s_cselect_b32 s46, 0x10, 0
    s_or_b32 s54, s54, s46
    s_cmp_eq_u64 s[10:11], s[72:73]
    s_cselect_b32 s46, 0x40, 0
    s_or_b32 s54, s54, s46
    s_cmp_eq_u64 s[12:13], s[72:73]
    s_cselect_b32 s46, 0x100, 0
    s_or_b32 s54, s54, s46
    s_cmp_eq_u64 s[14:15], s[72:73]
    s_cselect_b32 s46, 0x400, 0
    s_or_b32 s54, s54, s46
    s_cmp_eq_u64 s[16:17], s[72:73]
    s_cselect_b32 s46, 0x1000, 0
    s_or_b32 s54, s54, s46
    s_cmp_eq_u64 s[18:19], s[72:73]
    s_cselect_b32 s46, 0x4000, 0
    s_or_b32 s54, s54, s46
    s_lshl_b32 s46, s54, s55
    s_mov_b32 s47, s46
    s_lshr_b64 s[46:47], s[46:47], s42
    v_mov_b32 v235, s46
    s_mov_b64 exec, 1
    ds_or_b32 v14, v235 offset:64
    s_mov_b64 exec, -1
    s_branch L_sel4
L_sel4_ok:
    s_waitcnt vmcnt(10) lgkmcnt(0)
    v_mfma_f32_16x16x32_bf16 v[120:123], v[88:91], v[40:43], v[120:123]
    ds_read_b64_tr_b16 v[104:105], v244 offset:4096
    ds_read_b64_tr_b16 v[106:107], v244 offset:6144
    v_mfma_f32_16x16x32_bf16 v[124:127], v[92:95], v[40:43], v[124:127]
    ds_read_b64_tr_b16 v[108:109], v245 offset:4096
    ds_read_b64_tr_b16 v[110:111], v245 offset:6144
    v_mfma_f32_16x16x32_bf16 v[128:131], v[96:99], v[40:43], v[128:131]
    ds_read_b64_tr_b16 v[112:113], v246 offset:4096
    ds_read_b64_tr_b16 v[114:115], v246 offset:6144
    v_mfma_f32_16x16x32_bf16 v[132:135], v[100:103], v[40:43], v[132:135]
    ds_read_b64_tr_b16 v[116:117], v247 offset:4096
    ds_read_b64_tr_b16 v[118:119], v247 offset:6144
    v_mfma_f32_16x16x32_bf16 v[136:139], v[88:91], v[44:47], v[136:139]
    v_add_u32 v8, s30, v236
    v_add_u32 v9, s30, v237
    v_mfma_f32_16x16x32_bf16 v[140:143], v[92:95], v[44:47], v[140:143]
    v_add_u32 v10, s30, v238
    v_add_u32 v11, s30, v239
    v_mfma_f32_16x16x32_bf16 v[144:147], v[96:99], v[44:47], v[144:147]
    s_ff1_i32_b32 s46, s50
    s_bitset0_b32 s50, s46
    s_add_u32 s48, s46, s42
    v_mfma_f32_16x16x32_bf16 v[148:151], v[100:103], v[44:47], v[148:151]
    s_and_b32 s48, s48, 31
    s_lshl_b32 s48, s48, 10
    s_bitset0_b32 s51, s46
    s_waitcnt vmcnt(8) lgkmcnt(0)
    v_mfma_f32_16x16x32_bf16 v[120:123], v[104:107], v[48:51], v[120:123]
    ds_read_b64_tr_b16 v[88:89], v8 offset:0
    ds_read_b64_tr_b16 v[90:91], v8 offset:2048
    v_mfma_f32_16x16x32_bf16 v[124:127], v[108:111], v[48:51], v[124:127]
    ds_read_b64_tr_b16 v[92:93], v9 offset:0
    ds_read_b64_tr_b16 v[94:95], v9 offset:2048
    v_mfma_f32_16x16x32_bf16 v[128:131], v[112:115], v[48:51], v[128:131]
    ds_read_b64_tr_b16 v[96:97], v10 offset:0
    ds_read_b64_tr_b16 v[98:99], v10 offset:2048
    v_mfma_f32_16x16x32_bf16 v[132:135], v[116:119], v[48:51], v[132:135]
    ds_read_b64_tr_b16 v[100:101], v11 offset:0
    ds_read_b64_tr_b16 v[102:103], v11 offset:2048
    v_mfma_f32_16x16x32_bf16 v[136:139], v[104:107], v[52:55], v[136:139]
    buffer_load_dwordx4 v[24:27], v5, s[64:67], s48 offen offset:0 sc1
    s_lshl_b32 s28, s46, 12
    v_mfma_f32_16x16x32_bf16 v[140:143], v[108:111], v[52:55], v[140:143]
    buffer_load_dwordx4 v[28:31], v242, s[64:67], s48 offen offset:0 sc1
    v_mfma_f32_16x16x32_bf16 v[144:147], v[112:115], v[52:55], v[144:147]
    buffer_load_dwordx4 v[32:35], v5, s[64:67], s48 offen offset:1024 sc1
    v_mfma_f32_16x16x32_bf16 v[148:151], v[116:119], v[52:55], v[148:151]
    buffer_load_dwordx4 v[36:39], v242, s[64:67], s48 offen offset:1024 sc1
    s_cmp_lg_u32 s50, 0
    s_cbranch_scc1 L_sel5_ok
    s_mov_b32 s45, 0
    s_cmp_lg_u32 s51, 0
    s_cbranch_scc1 L_sel5
    s_mov_b32 s66, 0
    s_mov_b32 s50, 0x55555555
    s_branch L_sel5_ok
L_sel5:
    ds_read_b32 v235, v14 offset:64
    ds_read_b32 v13, v20 offset:60
    s_add_u32 s45, s45, 1
    s_waitcnt lgkmcnt(0)
    v_and_b32 v13, v13, v235
    s_cmp_gt_u32 s45, 0x40000
    s_cselect_b32 s46, -1, 0
    v_readfirstlane_b32 s50, v13
    s_nop 3
    s_or_b32 s50, s50, s46
    s_and_b32 s50, s50, s51
    s_cbranch_scc1 L_sel5_ok
    s_cmp_lg_u32 s54, 0x5555
    s_cbranch_scc1 L_sel5_p
    s_sleep 1
    s_branch L_sel5
L_sel5_p:
    s_load_dwordx16 s[4:19], s[26:27], s52 glc
    s_add_u32 s45, s45, 8
    s_waitcnt lgkmcnt(0)
    s_mov_b32 s54, 0
    s_cmp_eq_u64 s[4:5], s[72:73]
    s_cselect_b32 s46, 0x1, 0
    s_or_b32 s54, s54, s46
    s_cmp_eq_u64 s[6:7], s[72:73]
    s_cselect_b32 s46, 0x4, 0
    s_or_b32 s54, s54, s46
    s_cmp_eq_u64 s[8:9], s[72:73]
    s_cselect_b32 s46, 0x10, 0
    s_or_b32 s54, s54, s46
    s_cmp_eq_u64 s[10:11], s[72:73]
    s_cselect_b32 s46, 0x40, 0
    s_or_b32 s54, s54, s46
    s_cmp_eq_u64 s[12:13], s[72:73]
    s_cselect_b32 s46, 0x100, 0
    s_or_b32 s54, s54, s46
    s_cmp_eq_u64 s[14:15], s[72:73]
    s_cselect_b32 s46, 0x400, 0
    s_or_b32 s54, s54, s46
    s_cmp_eq_u64 s[16:17], s[72:73]
    s_cselect_b32 s46, 0x1000, 0
    s_or_b32 s54, s54, s46
    s_cmp_eq_u64 s[18:19], s[72:73]
    s_cselect_b32 s46, 0x4000, 0
    s_or_b32 s54, s54, s46
    s_lshl_b32 s46, s54, s55
    s_mov_b32 s47, s46
    s_lshr_b64 s[46:47], s[46:47], s42
    v_mov_b32 v235, s46
    s_mov_b64 exec, 1
    ds_or_b32 v14, v235 offset:64
    s_mov_b64 exec, -1
    s_branch L_sel5
L_sel5_ok:
    s_waitcnt vmcnt(10) lgkmcnt(0)
    v_mfma_f32_16x16x32_bf16 v[120:123], v[88:91], v[56:59], v[120:123]
    ds_read_b64_tr_b16 v[104:105], v8 offset:4096
    ds_read_b64_tr_b16 v[106:107], v8 offset:6144
    v_mfma_f32_16x16x32_bf16 v[124:127], v[92:95], v[56:59], v[124:127]
    ds_read_b64_tr_b16 v[108:109], v9 offset:4096
    ds_read_b64_tr_b16 v[110:111], v9 offset:6144
    v_mfma_f32_16x16x32_bf16 v[128:131], v[96:99], v[56:59], v[128:131]
    ds_read_b64_tr_b16 v[112:113], v10 offset:4096
    ds_read_b64_tr_b16 v[114:115], v10 offset:6144
    v_mfma_f32_16x16x32_bf16 v[132:135], v[100:103], v[56:59], v[132:135]
    ds_read_b64_tr_b16 v[116:117], v11 offset:4096
    ds_read_b64_tr_b16 v[118:119], v11 offset:6144
    v_mfma_f32_16x16x32_bf16 v[136:139], v[88:91], v[60:63], v[136:139]
    v_add_u32 v244, s31, v236
    v_add_u32 v245, s31, v237
    v_mfma_f32_16x16x32_bf16 v[140:143], v[92:95], v[60:63], v[140:143]
    v_add_u32 v246, s31, v238
    v_add_u32 v247, s31, v239
    v_mfma_f32_16x16x32_bf16 v[144:147], v[96:99], v[60:63], v[144:147]
    s_ff1_i32_b32 s46, s50
    s_bitset0_b32 s50, s46
    s_add_u32 s48, s46, s42
    v_mfma_f32_16x16x32_bf16 v[148:151], v[100:103], v[60:63], v[148:151]
    s_and_b32 s48, s48, 31
    s_lshl_b32 s48, s48, 10
    s_bitset0_b32 s51, s46
    s_waitcnt vmcnt(8) lgkmcnt(0)
    v_mfma_f32_16x16x32_bf16 v[120:123], v[104:107], v[64:67], v[120:123]
    ds_read_b64_tr_b16 v[88:89], v244 offset:0
    ds_read_b64_tr_b16 v[90:91], v244 offset:2048
    v_mfma_f32_16x16x32_bf16 v[124:127], v[108:111], v[64:67], v[124:127]
    ds_read_b64_tr_b16 v[92:93], v245 offset:0
    ds_read_b64_tr_b16 v[94:95], v245 offset:2048
    v_mfma_f32_16x16x32_bf16 v[128:131], v[112:115], v[64:67], v[128:131]
    ds_read_b64_tr_b16 v[96:97], v246 offset:0
    ds_read_b64_tr_b16 v[98:99], v246 offset:2048
    v_mfma_f32_16x16x32_bf16 v[132:135], v[116:119], v[64:67], v[132:135]
    ds_read_b64_tr_b16 v[100:101], v247 offset:0
    ds_read_b64_tr_b16 v[102:103], v247 offset:2048
    v_mfma_f32_16x16x32_bf16 v[136:139], v[104:107], v[68:71], v[136:139]
    buffer_load_dwordx4 v[40:43], v5, s[64:67], s48 offen offset:0 sc1
    s_lshl_b32 s29, s46, 12
    v_mfma_f32_16x16x32_bf16 v[140:143], v[108:111], v[68:71], v[140:143]
    buffer_load_dwordx4 v[44:47], v242, s[64:67], s48 offen offset:0 sc1
    v_mfma_f32_16x16x32_bf16 v[144:147], v[112:115], v[68:71], v[144:147]
    buffer_load_dwordx4 v[48:51], v5, s[64:67], s48 offen offset:1024 sc1
    v_mfma_f32_16x16x32_bf16 v[148:151], v[116:119], v[68:71], v[148:151]
    buffer_load_dwordx4 v[52:55], v242, s[64:67], s48 offen offset:1024 sc1
    s_cmp_lg_u32 s50, 0
    s_cbranch_scc1 L_sel6_ok
    s_mov_b32 s45, 0
    s_cmp_lg_u32 s51, 0
    s_cbranch_scc1 L_sel6
    s_mov_b32 s66, 0
    s_mov_b32 s50, 0x55555555
    s_branch L_sel6_ok
L_sel6:
    ds_read_b32 v235, v14 offset:64
    ds_read_b32 v13, v20 offset:60
    s_add_u32 s45, s45, 1
    s_waitcnt lgkmcnt(0)
    v_and_b32 v13, v13, v235
    s_cmp_gt_u32 s45, 0x40000
    s_cselect_b32 s46, -1, 0
    v_readfirstlane_b32 s50, v13
    s_nop 3
    s_or_b32 s50, s50, s46
    s_and_b32 s50, s50, s51
    s_cbranch_scc1 L_sel6_ok
    s_cmp_lg_u32 s54, 0x5555
    s_cbranch_scc1 L_sel6_p
    s_sleep 1
    s_branch L_sel6
L_sel6_p:
    s_load_dwordx16 s[4:19], s[26:27], s52 glc
    s_add_u32 s45, s45, 8
    s_waitcnt lgkmcnt(0)
    s_mov_b32 s54, 0
    s_cmp_eq_u64 s[4:5], s[72:73]
    s_cselect_b32 s46, 0x1, 0
    s_or_b32 s54, s54, s46
    s_cmp_eq_u64 s[6:7], s[72:73]
    s_cselect_b32 s46, 0x4, 0
    s_or_b32 s54, s54, s46
    s_cmp_eq_u64 s[8:9], s[72:73]
    s_cselect_b32 s46, 0x10, 0
    s_or_b32 s54, s54, s46
    s_cmp_eq_u64 s[10:11], s[72:73]
    s_cselect_b32 s46, 0x40, 0
    s_or_b32 s54, s54, s46
    s_cmp_eq_u64 s[12:13], s[72:73]
    s_cselect_b32 s46, 0x100, 0
    s_or_b32 s54, s54, s46
    s_cmp_eq_u64 s[14:15], s[72:73]
    s_cselect_b32 s46, 0x400, 0
    s_or_b32 s54, s54, s46
    s_cmp_eq_u64 s[16:17], s[72:73]
    s_cselect_b32 s46, 0x1000, 0
    s_or_b32 s54, s54, s46
    s_cmp_eq_u64 s[18:19], s[72:73]
    s_cselect_b32 s46, 0x4000, 0
    s_or_b32 s54, s54, s46
    s_lshl_b32 s46, s54, s55
    s_mov_b32 s47, s46
    s_lshr_b64 s[46:47], s[46:47], s42
    v_mov_b32 v235, s46
    s_mov_b64 exec, 1
    ds_or_b32 v14, v235 offset:64
    s_mov_b64 exec, -1
    s_branch L_sel6
L_sel6_ok:
    s_waitcnt vmcnt(10) lgkmcnt(0)
    v_mfma_f32_16x16x32_bf16 v[120:123], v[88:91], v[72:75], v[120:123]
    ds_read_b64_tr_b16 v[104:105], v244 offset:4096
    ds_read_b64_tr_b16 v[106:107], v244 offset:6144
    v_mfma_f32_16x16x32_bf16 v[124:127], v[92:95], v[72:75], v[124:127]
    ds_read_b64_tr_b16 v[108:109], v245 offset:4096
    ds_read_b64_tr_b16 v[110:111], v245 offset:6144
    v_mfma_f32_16x16x32_bf16 v[128:131], v[96:99], v[72:75], v[128:131]
    ds_read_b64_tr_b16 v[112:113], v246 offset:4096
    ds_read_b64_tr_b16 v[114:115], v246 offset:6144
    v_mfma_f32_16x16x32_bf16 v[132:135], v[100:103], v[72:75], v[132:135]
    ds_read_b64_tr_b16 v[116:117], v247 offset:4096
    ds_read_b64_tr_b16 v[118:119], v247 offset:6144
    v_mfma_f32_16x16x32_bf16 v[136:139], v[88:91], v[76:79], v[136:139]
    v_add_u32 v8, s28, v236
    v_add_u32 v9, s28, v237
    v_mfma_f32_16x16x32_bf16 v[140:143], v[92:95], v[76:79], v[140:143]
    v_add_u32 v10, s28, v238
    v_add_u32 v11, s28, v239
    v_mfma_f32_16x16x32_bf16 v[144:147], v[96:99], v[76:79], v[144:147]
    s_ff1_i32_b32 s46, s50
    s_bitset0_b32 s50, s46
    s_add_u32 s48, s46, s42
    v_mfma_f32_16x16x32_bf16 v[148:151], v[100:103], v[76:79], v[148:151]
    s_and_b32 s48, s48, 31
    s_lshl_b32 s48, s48, 10
    s_bitset0_b32 s51, s46
    s_waitcnt vmcnt(8) lgkmcnt(0)
    v_mfma_f32_16x16x32_bf16 v[120:123], v[104:107], v[80:83], v[120:123]
    ds_read_b64_tr_b16 v[88:89], v8 offset:0
    ds_read_b64_tr_b16 v[90:91], v8 offset:2048
    v_mfma_f32_16x16x32_bf16 v[124:127], v[108:111], v[80:83], v[124:127]
    ds_read_b64_tr_b16 v[92:93], v9 offset:0
    ds_read_b64_tr_b16 v[94:95], v9 offset:2048
    v_mfma_f32_16x16x32_bf16 v[128:131], v[112:115], v[80:83], v[128:131]
    ds_read_b64_tr_b16 v[96:97], v10 offset:0
    ds_read_b64_tr_b16 v[98:99], v10 offset:2048
    v_mfma_f32_16x16x32_bf16 v[132:135], v[116:119], v[80:83], v[132:135]
    ds_read_b64_tr_b16 v[100:101], v11 offset:0
    ds_read_b64_tr_b16 v[102:103], v11 offset:2048
    v_mfma_f32_16x16x32_bf16 v[136:139], v[104:107], v[84:87], v[136:139]
    buffer_load_dwordx4 v[56:59], v5, s[64:67], s48 offen offset:0 sc1
    buffer_load_dwordx4 v[60:63], v242, s[64:67], s48 offen offset:0 sc1
    v_mfma_f32_16x16x32_bf16 v[140:143], v[108:111], v[84:87], v[140:143]
    s_lshl_b32 s30, s46, 12
    buffer_load_dwordx4 v[64:67], v5, s[64:67], s48 offen offset:1024 sc1
    v_mfma_f32_16x16x32_bf16 v[144:147], v[112:115], v[84:87], v[144:147]
    s_add_u32 s53, s53, 1
    buffer_load_dwordx4 v[68:71], v242, s[64:67], s48 offen offset:1024 sc1
    v_mfma_f32_16x16x32_bf16 v[148:151], v[116:119], v[84:87], v[148:151]
    s_cmp_lt_u32 s53, 4
    s_cbranch_scc1 L_gloop
    s_lshl_b32 s48, s59, 16
    s_lshl_b32 s49, s35, 7
    s_add_u32 s48, s48, s49
    s_add_u32 s49, s48, 0x8000
    s_add_u32 s50, s48, 0x10000
    s_add_u32 s51, s48, 0x18000
    s_waitcnt lgkmcnt(0)
    v_cvt_pk_bf16_f32 v172, v120, v121
    v_cvt_pk_bf16_f32 v173, v122, v123
    v_cvt_pk_bf16_f32 v174, v124, v125
    v_cvt_pk_bf16_f32 v175, v126, v127
    v_cvt_pk_bf16_f32 v176, v128, v129
    v_cvt_pk_bf16_f32 v177, v130, v131
    v_cvt_pk_bf16_f32 v178, v132, v133
    v_cvt_pk_bf16_f32 v179, v134, v135
    v_cvt_pk_bf16_f32 v180, v136, v137
    v_cvt_pk_bf16_f32 v181, v138, v139
    v_cvt_pk_bf16_f32 v182, v140, v141
    v_cvt_pk_bf16_f32 v183, v142, v143
    v_cvt_pk_bf16_f32 v184, v144, v145
    v_cvt_pk_bf16_f32 v185, v146, v147
    v_cvt_pk_bf16_f32 v186, v148, v149
    v_cvt_pk_bf16_f32 v187, v150, v151
    s_nop 1
    v_permlane16_swap_b32 v172, v174
    v_permlane16_swap_b32 v173, v175
    v_permlane16_swap_b32 v176, v178
    v_permlane16_swap_b32 v177, v179
    v_permlane16_swap_b32 v180, v182
    v_permlane16_swap_b32 v181, v183
    v_permlane16_swap_b32 v184, v186
    v_permlane16_swap_b32 v185, v187
    ds_write_b128 v15, v[172:175]
    ds_write_b128 v18, v[176:179]
    ds_read_b128 v[88:91], v16 offset:0
    ds_read_b128 v[92:95], v16 offset:1024
    ds_write_b128 v15, v[180:183]
    ds_write_b128 v18, v[184:187]
    ds_read_b128 v[96:99], v16 offset:0
    ds_read_b128 v[100:103], v16 offset:1024
    s_waitcnt lgkmcnt(5)
    buffer_store_dwordx4 v[88:91], v17, s[68:71], s48 offen sc1
    s_waitcnt lgkmcnt(4)
    buffer_store_dwordx4 v[92:95], v17, s[68:71], s49 offen sc1
    s_waitcnt lgkmcnt(1)
    buffer_store_dwordx4 v[96:99], v17, s[68:71], s50 offen sc1
    s_waitcnt lgkmcnt(0)
    buffer_store_dwordx4 v[100:103], v17, s[68:71], s51 offen sc1
    s_endpgm
L_exit:
    s_endpgm
L_code_end:
.section .rodata,"a"
.p2align 6
.amdhsa_kernel concat_heads__linear_attn_block__ssm_conv_h3__prompt_kernel
  .amdhsa_next_free_vgpr 256
  .amdhsa_next_free_sgpr 102
  .amdhsa_accum_offset 256
  .amdhsa_group_segment_fixed_size 0
  .amdhsa_kernarg_size 96
  .amdhsa_user_sgpr_count 2
  .amdhsa_user_sgpr_kernarg_segment_ptr 1
  .amdhsa_system_sgpr_workgroup_id_x 1
.end_amdhsa_kernel
```
